```python
import torch

def _softmax(x, axis=-1):
    return torch.softmax(x, dim=axis)

def _gelu(x):
    return torch.nn.functional.gelu(x, approximate='tanh')

def _silu(x):
    return torch.nn.functional.silu(x)

def _sigmoid(x):
    return torch.sigmoid(x)

def _layernorm(x, axis=-1, eps=1e-05):
    m = x.mean(dim=axis, keepdim=True)
    v = x.var(dim=axis, keepdim=True, unbiased=False)
    return (x - m) / torch.sqrt(v + eps)

def _scatter_add(tgt, idx, src, axis=0):
    return tgt.clone().index_add_(axis, idx, src)

def _segment_sum(src, seg, n):
    out = torch.zeros((n,) + src.shape[1:], dtype=src.dtype)
    return out.index_add_(0, seg, src)

def _pad(x, pw):
    flat = tuple((v for pair in reversed(pw) for v in pair))
    return torch.nn.functional.pad(x, flat)
kernel_name = 'sequential_preLN__memory_aug_recurrent_mem_tr__glu_gated_glu__prompt'

def setup_inputs():

    _w = lambda a: (lambda t: t.to(torch.bfloat16) if t.is_floating_point() else t)(torch.as_tensor(a))

    def _A_setup():
        B, S, Dm = (1, 2048, 1024)
        H, Dh = (32, 128)
        M, seg = (8, 32)
        seg = min(seg, S)
        S = S // seg * seg
        return {'x': _w((lambda *s: torch.randn(*s, dtype=torch.bfloat16) * 0.05)(B, S, Dm)), 'mem0': _w((lambda *s: torch.randn(*s, dtype=torch.bfloat16) * 0.2)(B, M, Dm)), 'Wq': _w((lambda *s: torch.randn(*s, dtype=torch.bfloat16) * 1.6)(Dm, H, Dh) * Dm ** (-0.5)), 'Wk': _w((lambda *s: torch.randn(*s, dtype=torch.bfloat16) * 1.6)(Dm, H, Dh) * Dm ** (-0.5)), 'Wv': _w((lambda *s: torch.randn(*s, dtype=torch.bfloat16) * 0.2)(Dm, H, Dh) * Dm ** (-0.5)), 'Wo': _w((lambda *s: torch.randn(*s, dtype=torch.bfloat16) * 0.2)(H, Dh, Dm) * (H * Dh) ** (-0.5)), 'seg_len': seg}
    _A_in = _A_setup()

    def _B_setup():
        B, S, D, F = (1, 2048, 1024, 3584)
        return {'x': _w((lambda *s: torch.randn(*s, dtype=torch.bfloat16) * 0.05)(B, S, D)), 'w_gate': _w((lambda *s: torch.randn(*s, dtype=torch.bfloat16) * 0.05)(D, F)), 'w_up': _w((lambda *s: torch.randn(*s, dtype=torch.bfloat16) * 0.05)(D, F)), 'w_down': _w((lambda *s: torch.randn(*s, dtype=torch.bfloat16) * 0.05)(F, D))}
    _B_in = _B_setup()
    return {'A_x': _A_in['x'], 'A_mem0': _A_in['mem0'], 'A_Wq': _A_in['Wq'], 'A_Wk': _A_in['Wk'], 'A_Wv': _A_in['Wv'], 'A_Wo': _A_in['Wo'], 'A_seg_len': _A_in['seg_len'], 'B_x': _B_in['x'], 'B_w_gate': _B_in['w_gate'], 'B_w_up': _B_in['w_up'], 'B_w_down': _B_in['w_down']}

def reference(A_x, A_mem0, A_Wq, A_Wk, A_Wv, A_Wo, A_seg_len, B_x, B_w_gate, B_w_up, B_w_down):

    def _A_ref(x, mem0, Wq, Wk, Wv, Wo, seg_len):
        B, S, Dm = x.shape
        H, Dh = (Wq.shape[1], Wq.shape[2])
        M = mem0.shape[1]
        scale = Dh ** (-0.5)
        n_seg = S // seg_len
        L = M + seg_len
        idx = torch.arange(L)
        mask = (idx[:, None] < M) | (idx[:, None] >= idx[None, :])
        mem = mem0
        outs = []
        for s in range(n_seg):
            xs = x[:, s * seg_len:(s + 1) * seg_len, :].clone()
            h = torch.concatenate([mem, xs], axis=1)
            q = torch.einsum('btd,dhe->bhte', h, Wq)
            k = torch.einsum('btd,dhe->bhte', h, Wk)
            v = torch.einsum('btd,dhe->bhte', h, Wv)
            scores = torch.einsum('bhqe,bhke->bhqk', q, k) * scale
            scores = torch.where(mask[None, None], scores, -1000000000.0)
            p = _softmax(scores, axis=-1)
            o = torch.einsum('bhqk,bhke->bhqe', p, v)
            o = torch.einsum('bhte,hed->btd', o, Wo)
            mem = o[:, :M, :].clone()
            outs.append(o[:, M:, :])
        return torch.concatenate(outs, axis=1)

    def _B_ref(x, w_gate, w_up, w_down):
        g = torch.einsum('bsd,df->bsf', x, w_gate)
        u = torch.einsum('bsd,df->bsf', x, w_up)
        h = _sigmoid(g) * u
        return torch.einsum('bsf,fd->bsd', h, w_down)
    x = A_x
    h = x + _A_ref(_layernorm(x, axis=-1), A_mem0, A_Wq, A_Wk, A_Wv, A_Wo, A_seg_len)
    h2 = h + _B_ref(_layernorm(h, axis=-1), B_w_gate, B_w_up, B_w_down)
    return h2
```

```asm
; @launch kernel=mega_kernel grid=(256,1,1) block=(256,1,1) lds=163840
.amdgcn_target "amdgcn-amd-amdhsa--gfx950"
.text
.globl mega_kernel
.p2align 8
.type mega_kernel,@function
mega_kernel:
    s_load_dwordx2 s[4:5], s[0:1], 104
    s_load_dwordx2 s[6:7], s[0:1], 96
    v_lshrrev_b32 v2, 6, v0
    s_nop 0
    v_readfirstlane_b32 s62, v2
    s_getreg_b32 s40, hwreg(HW_REG_XCC_ID)
    s_and_b32 s40, s40, 7
    s_waitcnt lgkmcnt(0)
    s_cmp_eq_u32 s62, 0
    s_cbranch_scc1 mega_kernel_w0
    s_cmp_lg_u32 s62, 1
    s_cbranch_scc1 mega_kernel_rolewait
    s_mov_b32 s16, 0
    s_mov_b32 s17, 0
    s_mov_b64 exec, 1
    s_cmp_gt_u32 s40, 1
    s_cbranch_scc1 mega_kernel_nocal
    s_add_u32 s8, s4, 169345024
    s_addc_u32 s9, s5, 0
    s_and_b32 s10, s2, 63
    s_lshl_b32 s10, s10, 7
    s_and_b32 s11, s2, 192
    s_lshl_b32 s11, s11, 8
    s_add_u32 s10, s10, s11
    v_mov_b32 v3, s10
    v_add_u32 v5, 8192, v3
    v_mov_b32 v4, 0
    s_mov_b32 s16, -1
    s_mov_b32 s17, -1
    s_memtime s[12:13]
    s_waitcnt lgkmcnt(0)
    global_store_dword v3, v4, s[8:9] sc1
    s_waitcnt vmcnt(0)
    s_memtime s[14:15]
    s_waitcnt lgkmcnt(0)
    s_sub_u32 s14, s14, s12
    s_min_u32 s16, s16, s14
    s_memtime s[12:13]
    s_waitcnt lgkmcnt(0)
    global_store_dword v5, v4, s[8:9] sc1
    s_waitcnt vmcnt(0)
    s_memtime s[14:15]
    s_waitcnt lgkmcnt(0)
    s_sub_u32 s14, s14, s12
    s_min_u32 s17, s17, s14
    s_memtime s[12:13]
    s_waitcnt lgkmcnt(0)
    global_store_dword v3, v4, s[8:9] sc1
    s_waitcnt vmcnt(0)
    s_memtime s[14:15]
    s_waitcnt lgkmcnt(0)
    s_sub_u32 s14, s14, s12
    s_min_u32 s16, s16, s14
    s_memtime s[12:13]
    s_waitcnt lgkmcnt(0)
    global_store_dword v5, v4, s[8:9] sc1
    s_waitcnt vmcnt(0)
    s_memtime s[14:15]
    s_waitcnt lgkmcnt(0)
    s_sub_u32 s14, s14, s12
    s_min_u32 s17, s17, s14
mega_kernel_nocal:
    v_mov_b32 v3, 163824
    v_mov_b32 v4, s16
    v_mov_b32 v5, s17
    ds_write_b32 v3, v4 offset:4
    ds_write_b32 v3, v5 offset:8
    s_mov_b64 exec, -1
    s_branch mega_kernel_rolewait
mega_kernel_w0:
    s_mov_b64 exec, 1
    s_lshl_b32 s41, s40, 4
    v_mov_b32 v3, s41
    v_mov_b32 v4, 1
    global_atomic_add v5, v3, v4, s[6:7] sc0 sc1
    s_waitcnt vmcnt(0)
    v_readfirstlane_b32 s42, v5
    s_lshl_b32 s46, s40, 5
    s_add_u32 s46, s46, s42
    v_mov_b32 v3, 4
    s_cmp_gt_u32 s40, 1
    s_cbranch_scc1 mega_kernel_nc
    s_cmp_gt_u32 s42, 31
    s_cbranch_scc1 mega_kernel_nofull
    s_cmp_lg_u32 s42, 31
    s_cbranch_scc1 mega_kernel_rolewr
    global_atomic_add v3, v4, s[6:7] sc1
    s_branch mega_kernel_rolewr
mega_kernel_nc:
    s_cmp_lg_u32 s42, 31
    s_cbranch_scc1 mega_kernel_nofull
    global_atomic_add v5, v3, v4, s[6:7] sc0 sc1
    s_waitcnt vmcnt(0)
    v_readfirstlane_b32 s44, v5
    s_mov_b32 s45, 1
    s_cmp_eq_u32 s44, 7
    s_cbranch_scc1 mega_kernel_cas
mega_kernel_nofull:
    s_mov_b32 s43, 6000
mega_kernel_dpoll:
    v_mov_b32 v3, 128
    global_load_dword v8, v3, s[6:7] sc1
    s_cmp_lg_u32 s42, 31
    s_cbranch_scc1 mega_kernel_dp1
    v_mov_b32 v3, 4
    global_load_dword v9, v3, s[6:7] sc1
    s_waitcnt vmcnt(0)
    v_readfirstlane_b32 s44, v9
    s_mov_b32 s45, 1
    s_cmp_eq_u32 s44, 8
    s_cbranch_scc1 mega_kernel_cas
mega_kernel_dp1:
    s_waitcnt vmcnt(0)
    v_readfirstlane_b32 s44, v8
    s_cmp_lg_u32 s44, 0
    s_cbranch_scc1 mega_kernel_decided
    s_sub_u32 s43, s43, 1
    s_cmp_lg_u32 s43, 0
    s_cbranch_scc1 mega_kernel_dpoll
    s_mov_b32 s45, 2
mega_kernel_cas:
    v_mov_b32 v12, s45
    v_mov_b32 v13, 0
    v_mov_b32 v3, 128
    global_atomic_cmpswap v14, v3, v[12:13], s[6:7] sc0 sc1
    s_waitcnt vmcnt(0)
    v_readfirstlane_b32 s44, v14
    s_cmp_eq_u32 s44, 0
    s_cselect_b32 s44, s45, s44
mega_kernel_decided:
    s_cmp_eq_u32 s44, 1
    s_cbranch_scc0 mega_kernel_slowrole
    s_cmp_lt_u32 s42, 32
    s_cbranch_scc1 mega_kernel_rolewr
    s_mov_b32 s46, -1
    s_branch mega_kernel_rolewr
mega_kernel_redo:
    s_waitcnt vmcnt(0) lgkmcnt(0)
    s_barrier
    s_load_dwordx2 s[4:5], s[0:1], 104
    s_load_dwordx2 s[6:7], s[0:1], 96
    v_lshrrev_b32 v2, 6, v0
    s_nop 0
    v_readfirstlane_b32 s62, v2
    s_waitcnt lgkmcnt(0)
    s_cmp_lg_u32 s62, 0
    s_cbranch_scc1 mega_kernel_rolewait
    s_mov_b64 exec, 1
    v_mov_b32 v4, 1
mega_kernel_slowrole:
    s_mov_b32 s46, -1
    v_mov_b32 v3, 8
    global_atomic_add v5, v3, v4, s[6:7] sc0 sc1
    s_waitcnt vmcnt(0)
    v_readfirstlane_b32 s41, v5
    s_cmp_lt_u32 s41, 256
    s_cbranch_scc0 mega_kernel_rolewr
    s_add_u32 s46, s41, 256
mega_kernel_rolewr:
    v_mov_b32 v3, 163824
    v_mov_b32 v4, s46
    ds_write_b32 v3, v4
    s_mov_b64 exec, -1
mega_kernel_rolewait:
    s_waitcnt lgkmcnt(0)
    s_barrier
    v_mov_b32 v3, 163824
    ds_read_b32 v4, v3
    ds_read_b32 v5, v3 offset:4
    ds_read_b32 v6, v3 offset:8
    s_waitcnt lgkmcnt(0)
    v_readfirstlane_b32 s46, v4
    v_readfirstlane_b32 s47, v5
    v_readfirstlane_b32 s48, v6
    s_barrier
    s_cmp_eq_u32 s46, -1
    s_cbranch_scc1 mega_kernel_exit0
    s_lshr_b32 s60, s46, 8
    s_and_b32 s61, s46, 255
    s_cmp_lg_u32 s62, 0
    s_cbranch_scc1 mega_kernel_noxc
    s_cmp_ge_u32 s46, 64
    s_cbranch_scc1 mega_kernel_noxc
    s_cmp_lt_u32 s48, s47
    s_cselect_b32 s40, 0x10001, 1
    s_mov_b64 exec, 1
    v_mov_b32 v3, 68
    v_mov_b32 v4, s40
    global_atomic_add v3, v4, s[6:7] sc1
    s_mov_b64 exec, -1
mega_kernel_noxc:
    s_cmp_lt_u32 s61, 64
    s_cbranch_scc0 mega_kernel_notchain
    s_load_dwordx2 s[4:5], s[0:1], 104
    s_load_dwordx2 s[6:7], s[0:1], 96
    s_load_dwordx2 s[8:9], s[0:1], 16
    s_load_dwordx2 s[10:11], s[0:1], 24
    s_load_dwordx2 s[12:13], s[0:1], 32
    s_load_dwordx2 s[14:15], s[0:1], 40
    s_mov_b32 s38, s62
    s_mov_b32 s53, s60
    s_mov_b32 s54, s61
    s_lshr_b32 s36, s54, 5
    s_and_b32 s37, s54, 31
    s_waitcnt lgkmcnt(0)
    s_add_u32 s20, s4, 167772160
    s_addc_u32 s21, s5, 0
    s_mov_b32 s22, 1638400
    s_mov_b32 s23, 0x20000
    s_add_u32 s24, s4, 4194304
    s_addc_u32 s25, s5, 0
    s_mov_b32 s26, 33554432
    s_mov_b32 s27, 0x20000
    s_add_u32 s28, s4, 54525952
    s_addc_u32 s29, s5, 0
    s_mov_b32 s30, 8388608
    s_mov_b32 s31, 0x20000
    s_add_u32 s16, s4, 169607168
    s_addc_u32 s17, s5, 0
    s_mov_b32 s18, 548864
    s_mov_b32 s19, 0x20000
    v_and_b32 v64, 63, v0
    v_and_b32 v65, 15, v64
    v_lshrrev_b32 v66, 4, v64
    s_lshl_b32 s55, s36, 11
    s_lshl_b32 s56, s37, 6
    s_add_u32 s55, s55, s56
    v_lshlrev_b32 v2, 4, v64
    s_lshl_b32 s56, s38, 12
    v_add_u32 v1, s56, v2
    v_and_b32 v67, 8, v64
    v_mov_b32 v3, 0x44444444
    v_mov_b32 v68, 0xeeeeeeee
    v_cmp_ne_u32 vcc, 0, v67
    s_nop 1
    v_cndmask_b32 v3, v3, v68, vcc
    v_lshrrev_b32 v67, 3, v65
    v_lshlrev_b32 v67, 4, v67
    v_lshrrev_b32 v68, 2, v65
    v_and_b32 v68, 1, v68
    v_lshl_add_u32 v67, v68, 2, v67
    v_and_b32 v68, 3, v65
    v_add_u32 v67, v67, v68
    s_and_b32 s56, s38, 1
    s_lshl_b32 s56, s56, 3
    v_add_u32 v67, s56, v67
    v_lshlrev_b32 v67, 4, v67
    v_lshrrev_b32 v68, 1, v66
    v_lshlrev_b32 v68, 10, v68
    v_and_b32 v69, 1, v66
    v_lshl_add_u32 v68, v69, 9, v68
    s_lshl_b32 s56, s54, 12
    v_add_u32 v68, s56, v68
    v_add_u32 v4, v67, v68
    s_lshr_b32 s56, s38, 1
    s_lshl_b32 s56, s56, 11
    s_and_b32 s57, s38, 1
    s_lshl_b32 s57, s57, 8
    s_add_u32 s56, s56, s57
    s_add_u32 s56, s56, 16777216
    v_add_u32 v68, s56, v68
    v_lshl_add_u32 v5, v65, 4, v68
    s_lshl_b32 s56, s38, 4
    s_add_u32 s56, s56, s55
    v_add_u32 v69, s56, v65
    v_and_b32 v67, 1, v66
    v_lshlrev_b32 v67, 3, v67
    v_lshl_add_u32 v67, v69, 4, v67
    v_add_u32 v67, 4194304, v67
    v_mov_b32 v68, 1073741824
    v_cmp_gt_u32 vcc, 2, v66
    s_nop 1
    v_cndmask_b32 v20, v68, v67, vcc
    s_lshl_b32 s56, s38, 9
    s_add_u32 s56, s56, 16384
    v_lshlrev_b32 v67, 5, v65
    v_lshl_add_u32 v67, v66, 3, v67
    v_add_u32 v6, s56, v67
    v_lshrrev_b32 v67, 1, v66
    v_lshlrev_b32 v67, 4, v67
    v_and_b32 v68, 1, v66
    v_lshl_add_u32 v67, v68, 2, v67
    v_lshrrev_b32 v68, 2, v65
    v_add_u32 v67, v67, v68
    v_lshlrev_b32 v67, 5, v67
    v_and_b32 v68, 3, v65
    v_lshl_add_u32 v67, v68, 3, v67
    v_add_u32 v7, 16384, v67
    v_and_b32 v70, 7, v65
    v_lshrrev_b32 v71, 3, v65
    s_and_b32 s56, s54, 62
    s_lshl_b32 s56, s56, 11
    s_add_u32 s56, s56, 65536
    v_lshl_add_u32 v67, v66, 3, v70
    v_lshlrev_b32 v67, 4, v67
    v_lshl_add_u32 v68, v71, 9, v67
    v_add_u32 v9, s56, v68
    v_add_u32 v68, 768, v67
    v_mov_b32 v69, 1280
    v_cmp_le_u32 vcc, 2, v66
    s_nop 1
    v_cndmask_b32 v68, v69, v68, vcc
    v_lshl_add_u32 v68, v71, 3, v68
    v_add_u32 v10, s56, v68
    s_lshl_b32 s56, s54, 11
    s_add_u32 s56, s56, 65536
    s_lshl_b32 s57, s38, 9
    s_cmp_eq_u32 s38, 2
    s_cselect_b32 s58, 768, s57
    s_add_u32 s58, s58, s56
    v_add_u32 v68, s58, v67
    v_mov_b32 v69, 1073741824
    v_cmp_gt_u32 vcc, 8, v65
    s_nop 1
    v_cndmask_b32 v68, v69, v68, vcc
    s_cmp_eq_u32 s38, 2
    s_cselect_b32 s58, 2, 0
    v_cmp_le_u32 vcc, s58, v66
    s_nop 1
    v_cndmask_b32 v8, v69, v68, vcc
    s_cmp_lg_u32 s38, 3
    s_cbranch_scc1 mega_kernel_ch_sw3
    v_lshrrev_b32 v8, 5, v64
    v_lshlrev_b32 v8, 2, v8
mega_kernel_ch_sw3:
    s_lshl_b32 s56, s38, 11
    s_add_u32 s56, s56, 32768
    v_add_u32 v11, s56, v2
    v_add_u32 v12, 0x10000, v11
    s_lshl_b32 s56, s36, 15
    s_add_u32 s56, s56, 196608
    s_lshl_b32 s57, s37, 10
    s_lshl_b32 s58, s38, 8
    s_add_u32 s57, s57, s58
    s_add_u32 s57, s57, s56
    v_lshrrev_b32 v67, 1, v66
    v_lshlrev_b32 v67, 7, v67
    v_lshl_add_u32 v67, v65, 4, v67
    v_and_b32 v68, 1, v66
    v_lshl_add_u32 v67, v68, 3, v67
    v_add_u32 v67, s57, v67
    v_mov_b32 v69, 1073741824
    v_cmp_gt_u32 vcc, 8, v65
    s_nop 1
    v_cndmask_b32 v13, v69, v67, vcc
    s_lshl_b32 s57, s38, 13
    s_add_u32 s57, s57, s56
    v_add_u32 v14, s57, v2
    s_mul_i32 s56, s38, 1152
    s_add_u32 s56, s56, 18432
    v_and_b32 v67, 1, v66
    v_mul_u32_u24 v67, 576, v67
    v_lshrrev_b32 v68, 1, v66
    v_lshl_add_u32 v68, v68, 4, v65
    v_lshl_add_u32 v67, v68, 2, v67
    v_add_u32 v15, s56, v67
    v_and_b32 v70, 7, v64
    v_lshrrev_b32 v71, 3, v64
    v_and_b32 v71, 3, v71
    v_lshrrev_b32 v72, 5, v64
    v_mul_u32_u24 v67, 144, v70
    v_lshl_add_u32 v67, v71, 5, v67
    v_lshl_add_u32 v67, v72, 4, v67
    v_add_u32 v16, 18432, v67
    s_lshl_b32 s56, s36, 14
    s_lshl_b32 s57, s37, 9
    s_add_u32 s56, s56, s57
    v_lshlrev_b32 v67, 7, v71
    v_lshl_add_u32 v67, v70, 4, v67
    v_lshl_add_u32 v67, v72, 3, v67
    v_add_u32 v17, s56, v67
    s_lshl_b32 s57, s54, 11
    s_add_u32 s57, s57, 65536
    s_lshl_b32 s58, s36, 15
    s_lshl_b32 s59, s37, 10
    s_add_u32 s58, s58, s59
    s_add_u32 s58, s58, 196608
    s_add_u32 s59, s56, 32768
    s_mov_b32 s60, s56
    s_add_u32 s61, s57, 512
    s_cmp_eq_u32 s38, 1
    s_cselect_b32 s60, s59, s60
    s_cselect_b32 s61, 1073741824, s61
    s_cmp_eq_u32 s38, 2
    s_cselect_b32 s60, s57, s60
    s_cselect_b32 s61, s57, s61
    s_cmp_eq_u32 s38, 3
    s_cselect_b32 s60, s58, s60
    s_cselect_b32 s61, s58, s61
    v_mov_b32 v67, s60
    v_mov_b32 v68, s61
    v_cmp_gt_u32 vcc, 32, v64
    s_nop 1
    v_cndmask_b32 v67, v68, v67, vcc
    v_add_u32 v67, v67, v2
    s_cmp_eq_u32 s38, 0
    s_cselect_b32 s60, 48, 64
    v_mov_b32 v69, 1073741824
    v_cmp_gt_u32 vcc, s60, v64
    s_nop 1
    v_cndmask_b32 v18, v69, v67, vcc
    v_lshrrev_b32 v67, 1, v66
    v_lshlrev_b32 v67, 8, v67
    v_and_b32 v68, 1, v66
    v_lshl_add_u32 v67, v68, 7, v67
    v_and_b32 v68, 7, v65
    v_lshl_add_u32 v67, v68, 4, v67
    s_lshl_b32 s56, s54, 10
    v_add_u32 v67, s56, v67
    v_cmp_le_u32 vcc, 8, v65
    s_nop 1
    v_cndmask_b32 v19, v69, v67, vcc
    v_lshlrev_b32 v67, 7, v64
    s_lshl_b32 s56, s54, 12
    v_add_u32 v67, s56, v67
    v_add_u32 v68, 16773120, v67
    v_cmp_gt_u32 vcc, 32, v64
    s_nop 1
    v_cndmask_b32 v21, v68, v67, vcc
    v_mov_b32 v56, -1
    v_mov_b32 v57, -1
    v_mov_b32 v58, -1
    v_mov_b32 v59, -1
    s_mov_b32 s50, 0x00003f80
    s_mov_b32 s51, 0x3f800000
    s_mov_b32 s52, 0x3e0293ee
    v_and_b32 v64, 63, v0
    v_and_b32 v67, 7, v64
    v_lshrrev_b32 v68, 3, v64
    v_and_b32 v68, 1, v68
    v_mul_u32_u24 v65, 144, v67
    v_lshl_add_u32 v65, v68, 4, v65
    s_lshl_b32 s56, s38, 5
    s_add_u32 s56, s56, 18432
    v_add_u32 v16, s56, v65
    s_lshl_b32 s56, s36, 14
    s_lshl_b32 s57, s37, 9
    s_add_u32 s56, s56, s57
    s_lshl_b32 s57, s38, 7
    s_add_u32 s56, s56, s57
    v_lshlrev_b32 v65, 4, v67
    v_lshl_add_u32 v65, v68, 3, v65
    v_add_u32 v65, s56, v65
    v_mov_b32 v66, 1073741824
    v_cmp_gt_u32 vcc, 16, v64
    s_nop 1
    v_cndmask_b32 v17, v66, v65, vcc
    s_lshl_b32 s56, s36, 15
    s_lshr_b32 s57, s37, 4
    s_lshl_b32 s57, s57, 14
    s_add_u32 s56, s56, s57
    s_lshl_b32 s57, s38, 12
    s_add_u32 s56, s56, s57
    s_add_u32 s56, s56, 196608
    v_add_u32 v14, s56, v2
    s_lshl_b32 s56, s38, 11
    s_add_u32 s56, s56, 18432
    v_add_u32 v15, s56, v2
    s_lshl_b32 s56, s38, 9
    s_add_u32 s56, s56, 18432
    v_and_b32 v65, 0x1ff, v2
    v_add_u32 v16, s56, v65
    s_lshl_b32 s56, s36, 14
    s_lshl_b32 s57, s37, 9
    s_add_u32 s56, s56, s57
    s_lshl_b32 s57, s38, 7
    s_add_u32 s56, s56, s57
    v_lshrrev_b32 v65, 5, v64
    v_bfe_u32 v66, v64, 4, 1
    v_lshl_add_u32 v65, v66, 1, v65
    v_bfe_u32 v66, v64, 3, 1
    v_lshl_add_u32 v65, v66, 2, v65
    v_lshlrev_b32 v65, 4, v65
    v_bfe_u32 v66, v64, 2, 1
    v_lshl_add_u32 v65, v66, 3, v65
    v_add_u32 v65, s56, v65
    v_and_b32 v66, 3, v64
    v_cmp_eq_u32 vcc, 0, v66
    v_mov_b32 v66, 1073741824
    s_nop 0
    v_cndmask_b32 v17, v66, v65, vcc
    v_and_b32 v64, 63, v0
    v_and_b32 v65, 15, v64
    v_lshrrev_b32 v66, 4, v64
    v_lshrrev_b32 v67, 2, v65
    v_and_b32 v68, 3, v64
    v_lshrrev_b32 v69, 3, v64
    s_lshl_b32 s56, s38, 7
    v_add_u32 v69, s56, v69
    v_lshlrev_b32 v69, 13, v69
    v_lshrrev_b32 v70, 5, v64
    v_lshlrev_b32 v70, 1, v70
    v_and_b32 v71, 7, v64
    v_xor_b32 v70, v70, v71
    v_lshl_add_u32 v24, v70, 4, v69
    v_xor_b32 v25, 64, v24
    v_lshrrev_b32 v69, 1, v66
    v_lshlrev_b32 v69, 4, v69
    v_and_b32 v70, 1, v66
    v_lshl_add_u32 v69, v70, 2, v69
    v_lshrrev_b32 v71, 1, v67
    v_lshl_add_u32 v69, v71, 3, v69
    v_lshl_add_u32 v70, v71, 1, v70
    v_and_b32 v71, 1, v67
    v_add_u32 v72, v69, v71
    v_lshlrev_b32 v73, 7, v72
    v_lshlrev_b32 v70, 1, v70
    v_lshrrev_b32 v74, 1, v68
    s_lshl_b32 s56, s38, 1
    v_add_u32 v75, s56, v74
    v_xor_b32 v75, v75, v70
    v_lshl_add_u32 v73, v75, 4, v73
    v_and_b32 v75, 1, v68
    v_lshl_add_u32 v73, v75, 3, v73
    v_add_u32 v26, 32768, v73
    v_lshrrev_b32 v69, 2, v64
    v_lshrrev_b32 v70, 3, v69
    v_lshlrev_b32 v70, 1, v70
    v_xor_b32 v69, v69, v70
    v_lshrrev_b32 v70, 2, v69
    v_and_b32 v70, 1, v70
    v_lshlrev_b32 v70, 1, v70
    v_xor_b32 v70, v70, v68
    s_lshl_b32 s56, s38, 9
    v_add_u32 v69, s56, v69
    v_lshlrev_b32 v69, 11, v69
    v_lshl_add_u32 v27, v70, 4, v69
    v_lshrrev_b32 v69, 1, v66
    v_lshlrev_b32 v69, 4, v69
    v_and_b32 v70, 1, v66
    v_lshl_add_u32 v69, v70, 2, v69
    v_lshrrev_b32 v71, 1, v67
    v_lshl_add_u32 v69, v71, 3, v69
    v_and_b32 v72, 1, v67
    v_add_u32 v69, v69, v72
    v_lshlrev_b32 v70, 1, v70
    v_xor_b32 v72, 0, v71
    v_lshl_add_u32 v72, v72, 1, v69
    v_lshlrev_b32 v72, 6, v72
    v_add_u32 v73, 0, v74
    v_xor_b32 v73, v73, v70
    v_lshl_add_u32 v72, v73, 4, v72
    v_lshl_add_u32 v72, v75, 3, v72
    s_lshl_b32 s56, s38, 14
    s_add_u32 s56, s56, 32768
    v_add_u32 v28, s56, v72
    v_xor_b32 v72, 0, v71
    v_lshl_add_u32 v72, v72, 1, v69
    v_lshlrev_b32 v72, 6, v72
    v_add_u32 v73, 2, v74
    v_xor_b32 v73, v73, v70
    v_lshl_add_u32 v72, v73, 4, v72
    v_lshl_add_u32 v72, v75, 3, v72
    s_lshl_b32 s56, s38, 14
    s_add_u32 s56, s56, 32768
    v_add_u32 v29, s56, v72
    v_xor_b32 v72, 1, v71
    v_lshl_add_u32 v72, v72, 1, v69
    v_lshlrev_b32 v72, 6, v72
    v_add_u32 v73, 0, v74
    v_xor_b32 v73, v73, v70
    v_lshl_add_u32 v72, v73, 4, v72
    v_lshl_add_u32 v72, v75, 3, v72
    s_lshl_b32 s56, s38, 14
    s_add_u32 s56, s56, 32768
    v_add_u32 v30, s56, v72
    v_xor_b32 v72, 1, v71
    v_lshl_add_u32 v72, v72, 1, v69
    v_lshlrev_b32 v72, 6, v72
    v_add_u32 v73, 2, v74
    v_xor_b32 v73, v73, v70
    v_lshl_add_u32 v72, v73, 4, v72
    v_lshl_add_u32 v72, v75, 3, v72
    s_lshl_b32 s56, s38, 14
    s_add_u32 s56, s56, 32768
    v_add_u32 v31, s56, v72
    v_lshrrev_b32 v69, 3, v64
    s_lshl_b32 s56, s38, 8
    v_add_u32 v69, s56, v69
    v_lshlrev_b32 v69, 11, v69
    v_lshrrev_b32 v70, 5, v64
    v_lshlrev_b32 v70, 1, v70
    v_and_b32 v71, 7, v64
    v_xor_b32 v70, v70, v71
    v_lshl_add_u32 v27, v70, 4, v69
    v_xor_b32 v32, 64, v27
    v_lshrrev_b32 v69, 1, v66
    v_lshlrev_b32 v69, 4, v69
    v_and_b32 v70, 1, v66
    v_lshl_add_u32 v69, v70, 2, v69
    v_lshrrev_b32 v71, 1, v67
    v_lshl_add_u32 v69, v71, 3, v69
    v_lshl_add_u32 v70, v71, 1, v70
    v_and_b32 v71, 1, v67
    v_add_u32 v69, v69, v71
    v_lshlrev_b32 v69, 7, v69
    v_lshlrev_b32 v70, 1, v70
    s_lshl_b32 s56, s38, 14
    s_add_u32 s56, s56, 32768
    v_add_u32 v69, s56, v69
    v_and_b32 v75, 1, v68
    v_lshl_add_u32 v69, v75, 3, v69
    v_lshrrev_b32 v74, 1, v68
    v_add_u32 v73, 0, v74
    v_xor_b32 v73, v73, v70
    v_lshl_add_u32 v28, v73, 4, v69
    v_add_u32 v73, 2, v74
    v_xor_b32 v73, v73, v70
    v_lshl_add_u32 v29, v73, 4, v69
    v_add_u32 v73, 4, v74
    v_xor_b32 v73, v73, v70
    v_lshl_add_u32 v30, v73, 4, v69
    v_add_u32 v73, 6, v74
    v_xor_b32 v73, v73, v70
    v_lshl_add_u32 v31, v73, 4, v69
    v_and_b32 v69, 15, v64
    v_lshlrev_b32 v69, 3, v69
    s_and_b32 s56, s54, 7
    v_add_u32 v69, s56, v69
    v_and_b32 v72, 0, v64
    v_lshlrev_b32 v72, 7, v72
    s_lshl_b32 s56, s38, 7
    v_add_u32 v42, s56, v69
    v_lshl_add_u32 v42, v42, 13, v72
    s_lshl_b32 s56, s38, 8
    v_add_u32 v41, s56, v69
    v_lshl_add_u32 v41, v41, 11, v72
    s_and_b32 s57, s54, 56
    s_lshl_b32 s57, s57, 7
    s_mov_b32 s32, s8
    s_mov_b32 s33, s9
    s_mov_b32 s34, 8388608
    s_mov_b32 s35, 0x20000
    s_add_u32 s57, s57, 384
    s_mov_b64 exec, 65535
    buffer_load_dword v40, v42, s[32:35], s57 offen
    s_mov_b64 exec, -1
    s_and_b32 s57, s54, 56
    s_lshl_b32 s57, s57, 7
    s_add_u32 s57, s57, 4194304
    s_mov_b32 s32, s8
    s_mov_b32 s33, s9
    s_mov_b32 s34, 8388608
    s_mov_b32 s35, 0x20000
    s_add_u32 s57, s57, 384
    s_mov_b64 exec, 65535
    buffer_load_dword v40, v42, s[32:35], s57 offen
    s_mov_b64 exec, -1
    s_mov_b32 s32, s8
    s_mov_b32 s33, s9
    s_mov_b32 s34, 8388608
    s_mov_b32 s35, 0x20000
    s_lshl_b32 s56, s38, 14
    s_add_u32 s56, s56, 32768
    s_lshl_b32 s57, s55, 1
    s_add_u32 m0, s56, 0
    s_nop 0
    buffer_load_dwordx4 v24, s[32:35], s57 offen lds
    s_add_u32 s57, s57, 65536
    s_add_u32 m0, s56, 1024
    s_nop 0
    buffer_load_dwordx4 v25, s[32:35], s57 offen lds
    s_add_u32 s57, s57, 65536
    s_add_u32 m0, s56, 2048
    s_nop 0
    buffer_load_dwordx4 v24, s[32:35], s57 offen lds
    s_add_u32 s57, s57, 65536
    s_add_u32 m0, s56, 3072
    s_nop 0
    buffer_load_dwordx4 v25, s[32:35], s57 offen lds
    s_add_u32 s57, s57, 65536
    s_add_u32 m0, s56, 4096
    s_nop 0
    buffer_load_dwordx4 v24, s[32:35], s57 offen lds
    s_add_u32 s57, s57, 65536
    s_add_u32 m0, s56, 5120
    s_nop 0
    buffer_load_dwordx4 v25, s[32:35], s57 offen lds
    s_add_u32 s57, s57, 65536
    s_add_u32 m0, s56, 6144
    s_nop 0
    buffer_load_dwordx4 v24, s[32:35], s57 offen lds
    s_add_u32 s57, s57, 65536
    s_add_u32 m0, s56, 7168
    s_nop 0
    buffer_load_dwordx4 v25, s[32:35], s57 offen lds
    s_add_u32 s57, s57, 65536
    s_add_u32 m0, s56, 8192
    s_nop 0
    buffer_load_dwordx4 v24, s[32:35], s57 offen lds
    s_add_u32 s57, s57, 65536
    s_add_u32 m0, s56, 9216
    s_nop 0
    buffer_load_dwordx4 v25, s[32:35], s57 offen lds
    s_add_u32 s57, s57, 65536
    s_add_u32 m0, s56, 10240
    s_nop 0
    buffer_load_dwordx4 v24, s[32:35], s57 offen lds
    s_add_u32 s57, s57, 65536
    s_add_u32 m0, s56, 11264
    s_nop 0
    buffer_load_dwordx4 v25, s[32:35], s57 offen lds
    s_add_u32 s57, s57, 65536
    s_add_u32 m0, s56, 12288
    s_nop 0
    buffer_load_dwordx4 v24, s[32:35], s57 offen lds
    s_add_u32 s57, s57, 65536
    s_add_u32 m0, s56, 13312
    s_nop 0
    buffer_load_dwordx4 v25, s[32:35], s57 offen lds
    s_add_u32 s57, s57, 65536
    s_add_u32 m0, s56, 14336
    s_nop 0
    buffer_load_dwordx4 v24, s[32:35], s57 offen lds
    s_add_u32 s57, s57, 65536
    s_add_u32 m0, s56, 15360
    s_nop 0
    buffer_load_dwordx4 v25, s[32:35], s57 offen lds
    s_mov_b32 s32, s8
    s_mov_b32 s33, s9
    s_mov_b32 s34, 8388608
    s_mov_b32 s35, 0x20000
    s_lshl_b32 s56, s38, 14
    s_add_u32 s56, s56, 98304
    s_lshl_b32 s57, s55, 1
    s_add_u32 s57, s57, 4194304
    s_add_u32 m0, s56, 0
    s_nop 0
    buffer_load_dwordx4 v24, s[32:35], s57 offen lds
    s_add_u32 s57, s57, 65536
    s_add_u32 m0, s56, 1024
    s_nop 0
    buffer_load_dwordx4 v25, s[32:35], s57 offen lds
    s_add_u32 s57, s57, 65536
    s_add_u32 m0, s56, 2048
    s_nop 0
    buffer_load_dwordx4 v24, s[32:35], s57 offen lds
    s_add_u32 s57, s57, 65536
    s_add_u32 m0, s56, 3072
    s_nop 0
    buffer_load_dwordx4 v25, s[32:35], s57 offen lds
    s_add_u32 s57, s57, 65536
    s_add_u32 m0, s56, 4096
    s_nop 0
    buffer_load_dwordx4 v24, s[32:35], s57 offen lds
    s_add_u32 s57, s57, 65536
    s_add_u32 m0, s56, 5120
    s_nop 0
    buffer_load_dwordx4 v25, s[32:35], s57 offen lds
    s_add_u32 s57, s57, 65536
    s_add_u32 m0, s56, 6144
    s_nop 0
    buffer_load_dwordx4 v24, s[32:35], s57 offen lds
    s_add_u32 s57, s57, 65536
    s_add_u32 m0, s56, 7168
    s_nop 0
    buffer_load_dwordx4 v25, s[32:35], s57 offen lds
    s_add_u32 s57, s57, 65536
    s_add_u32 m0, s56, 8192
    s_nop 0
    buffer_load_dwordx4 v24, s[32:35], s57 offen lds
    s_add_u32 s57, s57, 65536
    s_add_u32 m0, s56, 9216
    s_nop 0
    buffer_load_dwordx4 v25, s[32:35], s57 offen lds
    s_add_u32 s57, s57, 65536
    s_add_u32 m0, s56, 10240
    s_nop 0
    buffer_load_dwordx4 v24, s[32:35], s57 offen lds
    s_add_u32 s57, s57, 65536
    s_add_u32 m0, s56, 11264
    s_nop 0
    buffer_load_dwordx4 v25, s[32:35], s57 offen lds
    s_add_u32 s57, s57, 65536
    s_add_u32 m0, s56, 12288
    s_nop 0
    buffer_load_dwordx4 v24, s[32:35], s57 offen lds
    s_add_u32 s57, s57, 65536
    s_add_u32 m0, s56, 13312
    s_nop 0
    buffer_load_dwordx4 v25, s[32:35], s57 offen lds
    s_add_u32 s57, s57, 65536
    s_add_u32 m0, s56, 14336
    s_nop 0
    buffer_load_dwordx4 v24, s[32:35], s57 offen lds
    s_add_u32 s57, s57, 65536
    s_add_u32 m0, s56, 15360
    s_nop 0
    buffer_load_dwordx4 v25, s[32:35], s57 offen lds
    s_waitcnt vmcnt(16)
    s_barrier
    ds_read_b64_tr_b16 a[0:1], v26 offset:0
    ds_read_b64_tr_b16 a[2:3], v26 offset:256
    ds_read_b64_tr_b16 a[4:5], v26 offset:4096
    ds_read_b64_tr_b16 a[6:7], v26 offset:4352
    ds_read_b64_tr_b16 a[8:9], v26 offset:8192
    ds_read_b64_tr_b16 a[10:11], v26 offset:8448
    ds_read_b64_tr_b16 a[12:13], v26 offset:12288
    ds_read_b64_tr_b16 a[14:15], v26 offset:12544
    ds_read_b64_tr_b16 a[16:17], v26 offset:16384
    ds_read_b64_tr_b16 a[18:19], v26 offset:16640
    ds_read_b64_tr_b16 a[20:21], v26 offset:20480
    ds_read_b64_tr_b16 a[22:23], v26 offset:20736
    ds_read_b64_tr_b16 a[24:25], v26 offset:24576
    ds_read_b64_tr_b16 a[26:27], v26 offset:24832
    ds_read_b64_tr_b16 a[28:29], v26 offset:28672
    ds_read_b64_tr_b16 a[30:31], v26 offset:28928
    ds_read_b64_tr_b16 a[32:33], v26 offset:32768
    ds_read_b64_tr_b16 a[34:35], v26 offset:33024
    ds_read_b64_tr_b16 a[36:37], v26 offset:36864
    ds_read_b64_tr_b16 a[38:39], v26 offset:37120
    ds_read_b64_tr_b16 a[40:41], v26 offset:40960
    ds_read_b64_tr_b16 a[42:43], v26 offset:41216
    ds_read_b64_tr_b16 a[44:45], v26 offset:45056
    ds_read_b64_tr_b16 a[46:47], v26 offset:45312
    ds_read_b64_tr_b16 a[48:49], v26 offset:49152
    ds_read_b64_tr_b16 a[50:51], v26 offset:49408
    ds_read_b64_tr_b16 a[52:53], v26 offset:53248
    ds_read_b64_tr_b16 a[54:55], v26 offset:53504
    ds_read_b64_tr_b16 a[56:57], v26 offset:57344
    ds_read_b64_tr_b16 a[58:59], v26 offset:57600
    ds_read_b64_tr_b16 a[60:61], v26 offset:61440
    ds_read_b64_tr_b16 a[62:63], v26 offset:61696
    s_waitcnt lgkmcnt(0)
    s_barrier
    s_mov_b32 s32, s10
    s_mov_b32 s33, s11
    s_mov_b32 s34, 8388608
    s_mov_b32 s35, 0x20000
    s_lshl_b32 s56, s38, 14
    s_add_u32 s56, s56, 32768
    s_lshl_b32 s57, s55, 1
    s_add_u32 m0, s56, 0
    s_nop 0
    buffer_load_dwordx4 v24, s[32:35], s57 offen lds
    s_add_u32 s57, s57, 65536
    s_add_u32 m0, s56, 1024
    s_nop 0
    buffer_load_dwordx4 v25, s[32:35], s57 offen lds
    s_add_u32 s57, s57, 65536
    s_add_u32 m0, s56, 2048
    s_nop 0
    buffer_load_dwordx4 v24, s[32:35], s57 offen lds
    s_add_u32 s57, s57, 65536
    s_add_u32 m0, s56, 3072
    s_nop 0
    buffer_load_dwordx4 v25, s[32:35], s57 offen lds
    s_add_u32 s57, s57, 65536
    s_add_u32 m0, s56, 4096
    s_nop 0
    buffer_load_dwordx4 v24, s[32:35], s57 offen lds
    s_add_u32 s57, s57, 65536
    s_add_u32 m0, s56, 5120
    s_nop 0
    buffer_load_dwordx4 v25, s[32:35], s57 offen lds
    s_add_u32 s57, s57, 65536
    s_add_u32 m0, s56, 6144
    s_nop 0
    buffer_load_dwordx4 v24, s[32:35], s57 offen lds
    s_add_u32 s57, s57, 65536
    s_add_u32 m0, s56, 7168
    s_nop 0
    buffer_load_dwordx4 v25, s[32:35], s57 offen lds
    s_add_u32 s57, s57, 65536
    s_add_u32 m0, s56, 8192
    s_nop 0
    buffer_load_dwordx4 v24, s[32:35], s57 offen lds
    s_add_u32 s57, s57, 65536
    s_add_u32 m0, s56, 9216
    s_nop 0
    buffer_load_dwordx4 v25, s[32:35], s57 offen lds
    s_add_u32 s57, s57, 65536
    s_add_u32 m0, s56, 10240
    s_nop 0
    buffer_load_dwordx4 v24, s[32:35], s57 offen lds
    s_add_u32 s57, s57, 65536
    s_add_u32 m0, s56, 11264
    s_nop 0
    buffer_load_dwordx4 v25, s[32:35], s57 offen lds
    s_add_u32 s57, s57, 65536
    s_add_u32 m0, s56, 12288
    s_nop 0
    buffer_load_dwordx4 v24, s[32:35], s57 offen lds
    s_add_u32 s57, s57, 65536
    s_add_u32 m0, s56, 13312
    s_nop 0
    buffer_load_dwordx4 v25, s[32:35], s57 offen lds
    s_add_u32 s57, s57, 65536
    s_add_u32 m0, s56, 14336
    s_nop 0
    buffer_load_dwordx4 v24, s[32:35], s57 offen lds
    s_add_u32 s57, s57, 65536
    s_add_u32 m0, s56, 15360
    s_nop 0
    buffer_load_dwordx4 v25, s[32:35], s57 offen lds
    s_and_b32 s57, s54, 56
    s_lshl_b32 s57, s57, 7
    s_mov_b32 s32, s10
    s_mov_b32 s33, s11
    s_mov_b32 s34, 8388608
    s_mov_b32 s35, 0x20000
    s_add_u32 s57, s57, 384
    s_mov_b64 exec, 65535
    buffer_load_dword v40, v42, s[32:35], s57 offen
    s_mov_b64 exec, -1
    s_waitcnt vmcnt(17)
    s_barrier
    v_add_u32 v26, 0x10000, v26
    ds_read_b64_tr_b16 a[64:65], v26 offset:0
    ds_read_b64_tr_b16 a[66:67], v26 offset:256
    ds_read_b64_tr_b16 a[68:69], v26 offset:4096
    ds_read_b64_tr_b16 a[70:71], v26 offset:4352
    ds_read_b64_tr_b16 a[72:73], v26 offset:8192
    ds_read_b64_tr_b16 a[74:75], v26 offset:8448
    ds_read_b64_tr_b16 a[76:77], v26 offset:12288
    ds_read_b64_tr_b16 a[78:79], v26 offset:12544
    ds_read_b64_tr_b16 a[80:81], v26 offset:16384
    ds_read_b64_tr_b16 a[82:83], v26 offset:16640
    ds_read_b64_tr_b16 a[84:85], v26 offset:20480
    ds_read_b64_tr_b16 a[86:87], v26 offset:20736
    ds_read_b64_tr_b16 a[88:89], v26 offset:24576
    ds_read_b64_tr_b16 a[90:91], v26 offset:24832
    ds_read_b64_tr_b16 a[92:93], v26 offset:28672
    ds_read_b64_tr_b16 a[94:95], v26 offset:28928
    ds_read_b64_tr_b16 a[96:97], v26 offset:32768
    ds_read_b64_tr_b16 a[98:99], v26 offset:33024
    ds_read_b64_tr_b16 a[100:101], v26 offset:36864
    ds_read_b64_tr_b16 a[102:103], v26 offset:37120
    ds_read_b64_tr_b16 a[104:105], v26 offset:40960
    ds_read_b64_tr_b16 a[106:107], v26 offset:41216
    ds_read_b64_tr_b16 a[108:109], v26 offset:45056
    ds_read_b64_tr_b16 a[110:111], v26 offset:45312
    ds_read_b64_tr_b16 a[112:113], v26 offset:49152
    ds_read_b64_tr_b16 a[114:115], v26 offset:49408
    ds_read_b64_tr_b16 a[116:117], v26 offset:53248
    ds_read_b64_tr_b16 a[118:119], v26 offset:53504
    ds_read_b64_tr_b16 a[120:121], v26 offset:57344
    ds_read_b64_tr_b16 a[122:123], v26 offset:57600
    ds_read_b64_tr_b16 a[124:125], v26 offset:61440
    ds_read_b64_tr_b16 a[126:127], v26 offset:61696
    s_waitcnt lgkmcnt(0)
    v_subrev_u32 v26, 0x10000, v26
    s_waitcnt lgkmcnt(0)
    s_barrier
    s_mov_b32 s32, s10
    s_mov_b32 s33, s11
    s_mov_b32 s34, 8388608
    s_mov_b32 s35, 0x20000
    s_lshl_b32 s56, s38, 14
    s_add_u32 s56, s56, 98304
    s_lshl_b32 s57, s55, 1
    s_add_u32 s57, s57, 4194304
    s_add_u32 m0, s56, 0
    s_nop 0
    buffer_load_dwordx4 v24, s[32:35], s57 offen lds
    s_add_u32 s57, s57, 65536
    s_add_u32 m0, s56, 1024
    s_nop 0
    buffer_load_dwordx4 v25, s[32:35], s57 offen lds
    s_add_u32 s57, s57, 65536
    s_add_u32 m0, s56, 2048
    s_nop 0
    buffer_load_dwordx4 v24, s[32:35], s57 offen lds
    s_add_u32 s57, s57, 65536
    s_add_u32 m0, s56, 3072
    s_nop 0
    buffer_load_dwordx4 v25, s[32:35], s57 offen lds
    s_add_u32 s57, s57, 65536
    s_add_u32 m0, s56, 4096
    s_nop 0
    buffer_load_dwordx4 v24, s[32:35], s57 offen lds
    s_add_u32 s57, s57, 65536
    s_add_u32 m0, s56, 5120
    s_nop 0
    buffer_load_dwordx4 v25, s[32:35], s57 offen lds
    s_add_u32 s57, s57, 65536
    s_add_u32 m0, s56, 6144
    s_nop 0
    buffer_load_dwordx4 v24, s[32:35], s57 offen lds
    s_add_u32 s57, s57, 65536
    s_add_u32 m0, s56, 7168
    s_nop 0
    buffer_load_dwordx4 v25, s[32:35], s57 offen lds
    s_add_u32 s57, s57, 65536
    s_add_u32 m0, s56, 8192
    s_nop 0
    buffer_load_dwordx4 v24, s[32:35], s57 offen lds
    s_add_u32 s57, s57, 65536
    s_add_u32 m0, s56, 9216
    s_nop 0
    buffer_load_dwordx4 v25, s[32:35], s57 offen lds
    s_add_u32 s57, s57, 65536
    s_add_u32 m0, s56, 10240
    s_nop 0
    buffer_load_dwordx4 v24, s[32:35], s57 offen lds
    s_add_u32 s57, s57, 65536
    s_add_u32 m0, s56, 11264
    s_nop 0
    buffer_load_dwordx4 v25, s[32:35], s57 offen lds
    s_add_u32 s57, s57, 65536
    s_add_u32 m0, s56, 12288
    s_nop 0
    buffer_load_dwordx4 v24, s[32:35], s57 offen lds
    s_add_u32 s57, s57, 65536
    s_add_u32 m0, s56, 13312
    s_nop 0
    buffer_load_dwordx4 v25, s[32:35], s57 offen lds
    s_add_u32 s57, s57, 65536
    s_add_u32 m0, s56, 14336
    s_nop 0
    buffer_load_dwordx4 v24, s[32:35], s57 offen lds
    s_add_u32 s57, s57, 65536
    s_add_u32 m0, s56, 15360
    s_nop 0
    buffer_load_dwordx4 v25, s[32:35], s57 offen lds
    s_and_b32 s57, s54, 56
    s_lshl_b32 s57, s57, 7
    s_add_u32 s57, s57, 4194304
    s_mov_b32 s32, s10
    s_mov_b32 s33, s11
    s_mov_b32 s34, 8388608
    s_mov_b32 s35, 0x20000
    s_add_u32 s57, s57, 384
    s_mov_b64 exec, 65535
    buffer_load_dword v40, v42, s[32:35], s57 offen
    s_mov_b64 exec, -1
    s_waitcnt vmcnt(18)
    s_barrier
    ds_read_b64_tr_b16 a[128:129], v26 offset:0
    ds_read_b64_tr_b16 a[130:131], v26 offset:256
    ds_read_b64_tr_b16 a[132:133], v26 offset:4096
    ds_read_b64_tr_b16 a[134:135], v26 offset:4352
    ds_read_b64_tr_b16 a[136:137], v26 offset:8192
    ds_read_b64_tr_b16 a[138:139], v26 offset:8448
    ds_read_b64_tr_b16 a[140:141], v26 offset:12288
    ds_read_b64_tr_b16 a[142:143], v26 offset:12544
    ds_read_b64_tr_b16 a[144:145], v26 offset:16384
    ds_read_b64_tr_b16 a[146:147], v26 offset:16640
    ds_read_b64_tr_b16 a[148:149], v26 offset:20480
    ds_read_b64_tr_b16 a[150:151], v26 offset:20736
    ds_read_b64_tr_b16 a[152:153], v26 offset:24576
    ds_read_b64_tr_b16 a[154:155], v26 offset:24832
    ds_read_b64_tr_b16 a[156:157], v26 offset:28672
    ds_read_b64_tr_b16 a[158:159], v26 offset:28928
    ds_read_b64_tr_b16 a[160:161], v26 offset:32768
    ds_read_b64_tr_b16 a[162:163], v26 offset:33024
    ds_read_b64_tr_b16 a[164:165], v26 offset:36864
    ds_read_b64_tr_b16 a[166:167], v26 offset:37120
    ds_read_b64_tr_b16 a[168:169], v26 offset:40960
    ds_read_b64_tr_b16 a[170:171], v26 offset:41216
    ds_read_b64_tr_b16 a[172:173], v26 offset:45056
    ds_read_b64_tr_b16 a[174:175], v26 offset:45312
    ds_read_b64_tr_b16 a[176:177], v26 offset:49152
    ds_read_b64_tr_b16 a[178:179], v26 offset:49408
    ds_read_b64_tr_b16 a[180:181], v26 offset:53248
    ds_read_b64_tr_b16 a[182:183], v26 offset:53504
    ds_read_b64_tr_b16 a[184:185], v26 offset:57344
    ds_read_b64_tr_b16 a[186:187], v26 offset:57600
    ds_read_b64_tr_b16 a[188:189], v26 offset:61440
    ds_read_b64_tr_b16 a[190:191], v26 offset:61696
    s_waitcnt lgkmcnt(0)
    s_barrier
    s_mov_b32 s32, s14
    s_mov_b32 s33, s15
    s_mov_b32 s34, 8388608
    s_mov_b32 s35, 0x20000
    s_lshl_b32 s56, s38, 14
    s_add_u32 s56, s56, 32768
    s_lshl_b32 s57, s36, 22
    s_lshr_b32 s58, s37, 4
    s_lshl_b32 s58, s58, 21
    s_add_u32 s57, s57, s58
    s_and_b32 s58, s37, 15
    s_lshl_b32 s58, s58, 7
    s_add_u32 s57, s57, s58
    s_add_u32 m0, s56, 0
    s_nop 0
    buffer_load_dwordx4 v27, s[32:35], s57 offen lds
    s_add_u32 s57, s57, 16384
    s_add_u32 m0, s56, 1024
    s_nop 0
    buffer_load_dwordx4 v32, s[32:35], s57 offen lds
    s_add_u32 s57, s57, 16384
    s_add_u32 m0, s56, 2048
    s_nop 0
    buffer_load_dwordx4 v27, s[32:35], s57 offen lds
    s_add_u32 s57, s57, 16384
    s_add_u32 m0, s56, 3072
    s_nop 0
    buffer_load_dwordx4 v32, s[32:35], s57 offen lds
    s_add_u32 s57, s57, 16384
    s_add_u32 m0, s56, 4096
    s_nop 0
    buffer_load_dwordx4 v27, s[32:35], s57 offen lds
    s_add_u32 s57, s57, 16384
    s_add_u32 m0, s56, 5120
    s_nop 0
    buffer_load_dwordx4 v32, s[32:35], s57 offen lds
    s_add_u32 s57, s57, 16384
    s_add_u32 m0, s56, 6144
    s_nop 0
    buffer_load_dwordx4 v27, s[32:35], s57 offen lds
    s_add_u32 s57, s57, 16384
    s_add_u32 m0, s56, 7168
    s_nop 0
    buffer_load_dwordx4 v32, s[32:35], s57 offen lds
    s_add_u32 s57, s57, 16384
    s_add_u32 m0, s56, 8192
    s_nop 0
    buffer_load_dwordx4 v27, s[32:35], s57 offen lds
    s_add_u32 s57, s57, 16384
    s_add_u32 m0, s56, 9216
    s_nop 0
    buffer_load_dwordx4 v32, s[32:35], s57 offen lds
    s_add_u32 s57, s57, 16384
    s_add_u32 m0, s56, 10240
    s_nop 0
    buffer_load_dwordx4 v27, s[32:35], s57 offen lds
    s_add_u32 s57, s57, 16384
    s_add_u32 m0, s56, 11264
    s_nop 0
    buffer_load_dwordx4 v32, s[32:35], s57 offen lds
    s_add_u32 s57, s57, 16384
    s_add_u32 m0, s56, 12288
    s_nop 0
    buffer_load_dwordx4 v27, s[32:35], s57 offen lds
    s_add_u32 s57, s57, 16384
    s_add_u32 m0, s56, 13312
    s_nop 0
    buffer_load_dwordx4 v32, s[32:35], s57 offen lds
    s_add_u32 s57, s57, 16384
    s_add_u32 m0, s56, 14336
    s_nop 0
    buffer_load_dwordx4 v27, s[32:35], s57 offen lds
    s_add_u32 s57, s57, 16384
    s_add_u32 m0, s56, 15360
    s_nop 0
    buffer_load_dwordx4 v32, s[32:35], s57 offen lds
    s_lshl_b32 s57, s36, 22
    s_lshr_b32 s58, s37, 4
    s_lshl_b32 s58, s58, 21
    s_add_u32 s57, s57, s58
    s_and_b32 s58, s37, 8
    s_lshl_b32 s58, s58, 7
    s_add_u32 s57, s57, s58
    s_mov_b32 s32, s14
    s_mov_b32 s33, s15
    s_mov_b32 s34, 8388608
    s_mov_b32 s35, 0x20000
    s_add_u32 s57, s57, 384
    s_mov_b64 exec, 65535
    buffer_load_dword v40, v41, s[32:35], s57 offen
    s_mov_b64 exec, -1
    s_waitcnt vmcnt(18)
    s_barrier
    v_add_u32 v26, 0x10000, v26
    ds_read_b64_tr_b16 a[192:193], v26 offset:0
    ds_read_b64_tr_b16 a[194:195], v26 offset:256
    ds_read_b64_tr_b16 a[196:197], v26 offset:4096
    ds_read_b64_tr_b16 a[198:199], v26 offset:4352
    ds_read_b64_tr_b16 a[200:201], v26 offset:8192
    ds_read_b64_tr_b16 a[202:203], v26 offset:8448
    ds_read_b64_tr_b16 a[204:205], v26 offset:12288
    ds_read_b64_tr_b16 a[206:207], v26 offset:12544
    ds_read_b64_tr_b16 a[208:209], v26 offset:16384
    ds_read_b64_tr_b16 a[210:211], v26 offset:16640
    ds_read_b64_tr_b16 a[212:213], v26 offset:20480
    ds_read_b64_tr_b16 a[214:215], v26 offset:20736
    ds_read_b64_tr_b16 a[216:217], v26 offset:24576
    ds_read_b64_tr_b16 a[218:219], v26 offset:24832
    ds_read_b64_tr_b16 a[220:221], v26 offset:28672
    ds_read_b64_tr_b16 a[222:223], v26 offset:28928
    ds_read_b64_tr_b16 a[224:225], v26 offset:32768
    ds_read_b64_tr_b16 a[226:227], v26 offset:33024
    ds_read_b64_tr_b16 a[228:229], v26 offset:36864
    ds_read_b64_tr_b16 a[230:231], v26 offset:37120
    ds_read_b64_tr_b16 a[232:233], v26 offset:40960
    ds_read_b64_tr_b16 a[234:235], v26 offset:41216
    ds_read_b64_tr_b16 a[236:237], v26 offset:45056
    ds_read_b64_tr_b16 a[238:239], v26 offset:45312
    ds_read_b64_tr_b16 a[240:241], v26 offset:49152
    ds_read_b64_tr_b16 a[242:243], v26 offset:49408
    ds_read_b64_tr_b16 a[244:245], v26 offset:53248
    ds_read_b64_tr_b16 a[246:247], v26 offset:53504
    ds_read_b64_tr_b16 a[248:249], v26 offset:57344
    ds_read_b64_tr_b16 a[250:251], v26 offset:57600
    ds_read_b64_tr_b16 a[252:253], v26 offset:61440
    ds_read_b64_tr_b16 a[254:255], v26 offset:61696
    s_waitcnt lgkmcnt(0)
    v_subrev_u32 v26, 0x10000, v26
    s_waitcnt lgkmcnt(0)
    s_barrier
    s_mov_b32 s32, s14
    s_mov_b32 s33, s15
    s_mov_b32 s34, 8388608
    s_mov_b32 s35, 0x20000
    s_lshl_b32 s56, s38, 14
    s_add_u32 s56, s56, 98304
    s_lshl_b32 s57, s36, 22
    s_lshr_b32 s58, s37, 4
    s_lshl_b32 s58, s58, 21
    s_add_u32 s57, s57, s58
    s_and_b32 s58, s37, 15
    s_lshl_b32 s58, s58, 7
    s_add_u32 s57, s57, s58
    s_add_u32 s57, s57, 262144
    s_add_u32 m0, s56, 0
    s_nop 0
    buffer_load_dwordx4 v27, s[32:35], s57 offen lds
    s_add_u32 s57, s57, 16384
    s_add_u32 m0, s56, 1024
    s_nop 0
    buffer_load_dwordx4 v32, s[32:35], s57 offen lds
    s_add_u32 s57, s57, 16384
    s_add_u32 m0, s56, 2048
    s_nop 0
    buffer_load_dwordx4 v27, s[32:35], s57 offen lds
    s_add_u32 s57, s57, 16384
    s_add_u32 m0, s56, 3072
    s_nop 0
    buffer_load_dwordx4 v32, s[32:35], s57 offen lds
    s_add_u32 s57, s57, 16384
    s_add_u32 m0, s56, 4096
    s_nop 0
    buffer_load_dwordx4 v27, s[32:35], s57 offen lds
    s_add_u32 s57, s57, 16384
    s_add_u32 m0, s56, 5120
    s_nop 0
    buffer_load_dwordx4 v32, s[32:35], s57 offen lds
    s_add_u32 s57, s57, 16384
    s_add_u32 m0, s56, 6144
    s_nop 0
    buffer_load_dwordx4 v27, s[32:35], s57 offen lds
    s_add_u32 s57, s57, 16384
    s_add_u32 m0, s56, 7168
    s_nop 0
    buffer_load_dwordx4 v32, s[32:35], s57 offen lds
    s_add_u32 s57, s57, 16384
    s_add_u32 m0, s56, 8192
    s_nop 0
    buffer_load_dwordx4 v27, s[32:35], s57 offen lds
    s_add_u32 s57, s57, 16384
    s_add_u32 m0, s56, 9216
    s_nop 0
    buffer_load_dwordx4 v32, s[32:35], s57 offen lds
    s_add_u32 s57, s57, 16384
    s_add_u32 m0, s56, 10240
    s_nop 0
    buffer_load_dwordx4 v27, s[32:35], s57 offen lds
    s_add_u32 s57, s57, 16384
    s_add_u32 m0, s56, 11264
    s_nop 0
    buffer_load_dwordx4 v32, s[32:35], s57 offen lds
    s_add_u32 s57, s57, 16384
    s_add_u32 m0, s56, 12288
    s_nop 0
    buffer_load_dwordx4 v27, s[32:35], s57 offen lds
    s_add_u32 s57, s57, 16384
    s_add_u32 m0, s56, 13312
    s_nop 0
    buffer_load_dwordx4 v32, s[32:35], s57 offen lds
    s_add_u32 s57, s57, 16384
    s_add_u32 m0, s56, 14336
    s_nop 0
    buffer_load_dwordx4 v27, s[32:35], s57 offen lds
    s_add_u32 s57, s57, 16384
    s_add_u32 m0, s56, 15360
    s_nop 0
    buffer_load_dwordx4 v32, s[32:35], s57 offen lds
    s_lshl_b32 s57, s36, 22
    s_lshr_b32 s58, s37, 4
    s_lshl_b32 s58, s58, 21
    s_add_u32 s57, s57, s58
    s_and_b32 s58, s37, 8
    s_lshl_b32 s58, s58, 7
    s_add_u32 s57, s57, s58
    s_add_u32 s57, s57, 262144
    s_mov_b32 s32, s14
    s_mov_b32 s33, s15
    s_mov_b32 s34, 8388608
    s_mov_b32 s35, 0x20000
    s_add_u32 s57, s57, 384
    s_mov_b64 exec, 65535
    buffer_load_dword v40, v41, s[32:35], s57 offen
    s_mov_b64 exec, -1
    s_waitcnt vmcnt(18)
    s_barrier
    ds_read_b64_tr_b16 v[128:129], v28 offset:0
    ds_read_b64_tr_b16 v[130:131], v28 offset:256
    ds_read_b64_tr_b16 v[132:133], v28 offset:4096
    ds_read_b64_tr_b16 v[134:135], v28 offset:4352
    ds_read_b64_tr_b16 v[136:137], v29 offset:0
    ds_read_b64_tr_b16 v[138:139], v29 offset:256
    ds_read_b64_tr_b16 v[140:141], v29 offset:4096
    ds_read_b64_tr_b16 v[142:143], v29 offset:4352
    ds_read_b64_tr_b16 v[144:145], v30 offset:0
    ds_read_b64_tr_b16 v[146:147], v30 offset:256
    ds_read_b64_tr_b16 v[148:149], v30 offset:4096
    ds_read_b64_tr_b16 v[150:151], v30 offset:4352
    ds_read_b64_tr_b16 v[152:153], v31 offset:0
    ds_read_b64_tr_b16 v[154:155], v31 offset:256
    ds_read_b64_tr_b16 v[156:157], v31 offset:4096
    ds_read_b64_tr_b16 v[158:159], v31 offset:4352
    ds_read_b64_tr_b16 v[160:161], v28 offset:8192
    ds_read_b64_tr_b16 v[162:163], v28 offset:8448
    ds_read_b64_tr_b16 v[164:165], v28 offset:12288
    ds_read_b64_tr_b16 v[166:167], v28 offset:12544
    ds_read_b64_tr_b16 v[168:169], v29 offset:8192
    ds_read_b64_tr_b16 v[170:171], v29 offset:8448
    ds_read_b64_tr_b16 v[172:173], v29 offset:12288
    ds_read_b64_tr_b16 v[174:175], v29 offset:12544
    ds_read_b64_tr_b16 v[176:177], v30 offset:8192
    ds_read_b64_tr_b16 v[178:179], v30 offset:8448
    ds_read_b64_tr_b16 v[180:181], v30 offset:12288
    ds_read_b64_tr_b16 v[182:183], v30 offset:12544
    ds_read_b64_tr_b16 v[184:185], v31 offset:8192
    ds_read_b64_tr_b16 v[186:187], v31 offset:8448
    ds_read_b64_tr_b16 v[188:189], v31 offset:12288
    ds_read_b64_tr_b16 v[190:191], v31 offset:12544
    s_waitcnt lgkmcnt(0)
    s_barrier
    s_mov_b32 s32, s12
    s_mov_b32 s33, s13
    s_mov_b32 s34, 8388608
    s_mov_b32 s35, 0x20000
    s_lshl_b32 s56, s38, 14
    s_add_u32 s56, s56, 32768
    s_lshl_b32 s57, s55, 1
    s_add_u32 m0, s56, 0
    s_nop 0
    buffer_load_dwordx4 v24, s[32:35], s57 offen lds
    s_add_u32 s57, s57, 65536
    s_add_u32 m0, s56, 1024
    s_nop 0
    buffer_load_dwordx4 v25, s[32:35], s57 offen lds
    s_add_u32 s57, s57, 65536
    s_add_u32 m0, s56, 2048
    s_nop 0
    buffer_load_dwordx4 v24, s[32:35], s57 offen lds
    s_add_u32 s57, s57, 65536
    s_add_u32 m0, s56, 3072
    s_nop 0
    buffer_load_dwordx4 v25, s[32:35], s57 offen lds
    s_add_u32 s57, s57, 65536
    s_add_u32 m0, s56, 4096
    s_nop 0
    buffer_load_dwordx4 v24, s[32:35], s57 offen lds
    s_add_u32 s57, s57, 65536
    s_add_u32 m0, s56, 5120
    s_nop 0
    buffer_load_dwordx4 v25, s[32:35], s57 offen lds
    s_add_u32 s57, s57, 65536
    s_add_u32 m0, s56, 6144
    s_nop 0
    buffer_load_dwordx4 v24, s[32:35], s57 offen lds
    s_add_u32 s57, s57, 65536
    s_add_u32 m0, s56, 7168
    s_nop 0
    buffer_load_dwordx4 v25, s[32:35], s57 offen lds
    s_add_u32 s57, s57, 65536
    s_add_u32 m0, s56, 8192
    s_nop 0
    buffer_load_dwordx4 v24, s[32:35], s57 offen lds
    s_add_u32 s57, s57, 65536
    s_add_u32 m0, s56, 9216
    s_nop 0
    buffer_load_dwordx4 v25, s[32:35], s57 offen lds
    s_add_u32 s57, s57, 65536
    s_add_u32 m0, s56, 10240
    s_nop 0
    buffer_load_dwordx4 v24, s[32:35], s57 offen lds
    s_add_u32 s57, s57, 65536
    s_add_u32 m0, s56, 11264
    s_nop 0
    buffer_load_dwordx4 v25, s[32:35], s57 offen lds
    s_add_u32 s57, s57, 65536
    s_add_u32 m0, s56, 12288
    s_nop 0
    buffer_load_dwordx4 v24, s[32:35], s57 offen lds
    s_add_u32 s57, s57, 65536
    s_add_u32 m0, s56, 13312
    s_nop 0
    buffer_load_dwordx4 v25, s[32:35], s57 offen lds
    s_add_u32 s57, s57, 65536
    s_add_u32 m0, s56, 14336
    s_nop 0
    buffer_load_dwordx4 v24, s[32:35], s57 offen lds
    s_add_u32 s57, s57, 65536
    s_add_u32 m0, s56, 15360
    s_nop 0
    buffer_load_dwordx4 v25, s[32:35], s57 offen lds
    s_and_b32 s57, s54, 56
    s_lshl_b32 s57, s57, 7
    s_mov_b32 s32, s12
    s_mov_b32 s33, s13
    s_mov_b32 s34, 8388608
    s_mov_b32 s35, 0x20000
    s_add_u32 s57, s57, 384
    s_mov_b64 exec, 65535
    buffer_load_dword v40, v42, s[32:35], s57 offen
    s_mov_b64 exec, -1
    s_waitcnt vmcnt(18)
    s_barrier
    v_add_u32 v28, 0x10000, v28
    v_add_u32 v29, 0x10000, v29
    v_add_u32 v30, 0x10000, v30
    v_add_u32 v31, 0x10000, v31
    ds_read_b64_tr_b16 v[192:193], v28 offset:0
    ds_read_b64_tr_b16 v[194:195], v28 offset:256
    ds_read_b64_tr_b16 v[196:197], v28 offset:4096
    ds_read_b64_tr_b16 v[198:199], v28 offset:4352
    ds_read_b64_tr_b16 v[200:201], v29 offset:0
    ds_read_b64_tr_b16 v[202:203], v29 offset:256
    ds_read_b64_tr_b16 v[204:205], v29 offset:4096
    ds_read_b64_tr_b16 v[206:207], v29 offset:4352
    ds_read_b64_tr_b16 v[208:209], v30 offset:0
    ds_read_b64_tr_b16 v[210:211], v30 offset:256
    ds_read_b64_tr_b16 v[212:213], v30 offset:4096
    ds_read_b64_tr_b16 v[214:215], v30 offset:4352
    ds_read_b64_tr_b16 v[216:217], v31 offset:0
    ds_read_b64_tr_b16 v[218:219], v31 offset:256
    ds_read_b64_tr_b16 v[220:221], v31 offset:4096
    ds_read_b64_tr_b16 v[222:223], v31 offset:4352
    ds_read_b64_tr_b16 v[224:225], v28 offset:8192
    ds_read_b64_tr_b16 v[226:227], v28 offset:8448
    ds_read_b64_tr_b16 v[228:229], v28 offset:12288
    ds_read_b64_tr_b16 v[230:231], v28 offset:12544
    ds_read_b64_tr_b16 v[232:233], v29 offset:8192
    ds_read_b64_tr_b16 v[234:235], v29 offset:8448
    ds_read_b64_tr_b16 v[236:237], v29 offset:12288
    ds_read_b64_tr_b16 v[238:239], v29 offset:12544
    ds_read_b64_tr_b16 v[240:241], v30 offset:8192
    ds_read_b64_tr_b16 v[242:243], v30 offset:8448
    ds_read_b64_tr_b16 v[244:245], v30 offset:12288
    ds_read_b64_tr_b16 v[246:247], v30 offset:12544
    ds_read_b64_tr_b16 v[248:249], v31 offset:8192
    ds_read_b64_tr_b16 v[250:251], v31 offset:8448
    ds_read_b64_tr_b16 v[252:253], v31 offset:12288
    ds_read_b64_tr_b16 v[254:255], v31 offset:12544
    s_waitcnt lgkmcnt(0)
    v_subrev_u32 v28, 0x10000, v28
    v_subrev_u32 v29, 0x10000, v29
    v_subrev_u32 v30, 0x10000, v30
    v_subrev_u32 v31, 0x10000, v31
    s_waitcnt lgkmcnt(0)
    s_barrier
    s_mov_b32 s32, s12
    s_mov_b32 s33, s13
    s_mov_b32 s34, 8388608
    s_mov_b32 s35, 0x20000
    s_lshl_b32 s56, s38, 14
    s_add_u32 s56, s56, 98304
    s_lshl_b32 s57, s55, 1
    s_add_u32 s57, s57, 4194304
    s_add_u32 m0, s56, 0
    s_nop 0
    buffer_load_dwordx4 v24, s[32:35], s57 offen lds
    s_add_u32 s57, s57, 65536
    s_add_u32 m0, s56, 1024
    s_nop 0
    buffer_load_dwordx4 v25, s[32:35], s57 offen lds
    s_add_u32 s57, s57, 65536
    s_add_u32 m0, s56, 2048
    s_nop 0
    buffer_load_dwordx4 v24, s[32:35], s57 offen lds
    s_add_u32 s57, s57, 65536
    s_add_u32 m0, s56, 3072
    s_nop 0
    buffer_load_dwordx4 v25, s[32:35], s57 offen lds
    s_add_u32 s57, s57, 65536
    s_add_u32 m0, s56, 4096
    s_nop 0
    buffer_load_dwordx4 v24, s[32:35], s57 offen lds
    s_add_u32 s57, s57, 65536
    s_add_u32 m0, s56, 5120
    s_nop 0
    buffer_load_dwordx4 v25, s[32:35], s57 offen lds
    s_add_u32 s57, s57, 65536
    s_add_u32 m0, s56, 6144
    s_nop 0
    buffer_load_dwordx4 v24, s[32:35], s57 offen lds
    s_add_u32 s57, s57, 65536
    s_add_u32 m0, s56, 7168
    s_nop 0
    buffer_load_dwordx4 v25, s[32:35], s57 offen lds
    s_add_u32 s57, s57, 65536
    s_add_u32 m0, s56, 8192
    s_nop 0
    buffer_load_dwordx4 v24, s[32:35], s57 offen lds
    s_add_u32 s57, s57, 65536
    s_add_u32 m0, s56, 9216
    s_nop 0
    buffer_load_dwordx4 v25, s[32:35], s57 offen lds
    s_add_u32 s57, s57, 65536
    s_add_u32 m0, s56, 10240
    s_nop 0
    buffer_load_dwordx4 v24, s[32:35], s57 offen lds
    s_add_u32 s57, s57, 65536
    s_add_u32 m0, s56, 11264
    s_nop 0
    buffer_load_dwordx4 v25, s[32:35], s57 offen lds
    s_add_u32 s57, s57, 65536
    s_add_u32 m0, s56, 12288
    s_nop 0
    buffer_load_dwordx4 v24, s[32:35], s57 offen lds
    s_add_u32 s57, s57, 65536
    s_add_u32 m0, s56, 13312
    s_nop 0
    buffer_load_dwordx4 v25, s[32:35], s57 offen lds
    s_add_u32 s57, s57, 65536
    s_add_u32 m0, s56, 14336
    s_nop 0
    buffer_load_dwordx4 v24, s[32:35], s57 offen lds
    s_add_u32 s57, s57, 65536
    s_add_u32 m0, s56, 15360
    s_nop 0
    buffer_load_dwordx4 v25, s[32:35], s57 offen lds
    s_and_b32 s57, s54, 56
    s_lshl_b32 s57, s57, 7
    s_add_u32 s57, s57, 4194304
    s_mov_b32 s32, s12
    s_mov_b32 s33, s13
    s_mov_b32 s34, 8388608
    s_mov_b32 s35, 0x20000
    s_add_u32 s57, s57, 384
    s_mov_b64 exec, 65535
    buffer_load_dword v40, v42, s[32:35], s57 offen
    s_mov_b64 exec, -1
    s_waitcnt vmcnt(18)
    s_barrier
    ds_read_b64_tr_b16 v[64:65], v26 offset:0
    ds_read_b64_tr_b16 v[66:67], v26 offset:256
    ds_read_b64_tr_b16 v[68:69], v26 offset:4096
    ds_read_b64_tr_b16 v[70:71], v26 offset:4352
    ds_read_b64_tr_b16 v[72:73], v26 offset:8192
    ds_read_b64_tr_b16 v[74:75], v26 offset:8448
    ds_read_b64_tr_b16 v[76:77], v26 offset:12288
    ds_read_b64_tr_b16 v[78:79], v26 offset:12544
    ds_read_b64_tr_b16 v[80:81], v26 offset:16384
    ds_read_b64_tr_b16 v[82:83], v26 offset:16640
    ds_read_b64_tr_b16 v[84:85], v26 offset:20480
    ds_read_b64_tr_b16 v[86:87], v26 offset:20736
    ds_read_b64_tr_b16 v[88:89], v26 offset:24576
    ds_read_b64_tr_b16 v[90:91], v26 offset:24832
    ds_read_b64_tr_b16 v[92:93], v26 offset:28672
    ds_read_b64_tr_b16 v[94:95], v26 offset:28928
    ds_read_b64_tr_b16 v[96:97], v26 offset:32768
    ds_read_b64_tr_b16 v[98:99], v26 offset:33024
    ds_read_b64_tr_b16 v[100:101], v26 offset:36864
    ds_read_b64_tr_b16 v[102:103], v26 offset:37120
    ds_read_b64_tr_b16 v[104:105], v26 offset:40960
    ds_read_b64_tr_b16 v[106:107], v26 offset:41216
    ds_read_b64_tr_b16 v[108:109], v26 offset:45056
    ds_read_b64_tr_b16 v[110:111], v26 offset:45312
    ds_read_b64_tr_b16 v[112:113], v26 offset:49152
    ds_read_b64_tr_b16 v[114:115], v26 offset:49408
    ds_read_b64_tr_b16 v[116:117], v26 offset:53248
    ds_read_b64_tr_b16 v[118:119], v26 offset:53504
    ds_read_b64_tr_b16 v[120:121], v26 offset:57344
    ds_read_b64_tr_b16 v[122:123], v26 offset:57600
    ds_read_b64_tr_b16 v[124:125], v26 offset:61440
    ds_read_b64_tr_b16 v[126:127], v26 offset:61696
    s_waitcnt lgkmcnt(0)
    s_barrier
    ds_write_b128 v11, v[64:67] offset:0
    ds_write_b128 v11, v[68:71] offset:1024
    ds_write_b128 v11, v[72:75] offset:8192
    ds_write_b128 v11, v[76:79] offset:9216
    ds_write_b128 v11, v[80:83] offset:16384
    ds_write_b128 v11, v[84:87] offset:17408
    ds_write_b128 v11, v[88:91] offset:24576
    ds_write_b128 v11, v[92:95] offset:25600
    ds_write_b128 v11, v[96:99] offset:32768
    ds_write_b128 v11, v[100:103] offset:33792
    ds_write_b128 v11, v[104:107] offset:40960
    ds_write_b128 v11, v[108:111] offset:41984
    ds_write_b128 v11, v[112:115] offset:49152
    ds_write_b128 v11, v[116:119] offset:50176
    ds_write_b128 v11, v[120:123] offset:57344
    ds_write_b128 v11, v[124:127] offset:58368
    s_waitcnt vmcnt(0)
    s_barrier
    v_add_u32 v26, 0x10000, v26
    ds_read_b64_tr_b16 v[64:65], v26 offset:0
    ds_read_b64_tr_b16 v[66:67], v26 offset:256
    ds_read_b64_tr_b16 v[68:69], v26 offset:4096
    ds_read_b64_tr_b16 v[70:71], v26 offset:4352
    ds_read_b64_tr_b16 v[72:73], v26 offset:8192
    ds_read_b64_tr_b16 v[74:75], v26 offset:8448
    ds_read_b64_tr_b16 v[76:77], v26 offset:12288
    ds_read_b64_tr_b16 v[78:79], v26 offset:12544
    ds_read_b64_tr_b16 v[80:81], v26 offset:16384
    ds_read_b64_tr_b16 v[82:83], v26 offset:16640
    ds_read_b64_tr_b16 v[84:85], v26 offset:20480
    ds_read_b64_tr_b16 v[86:87], v26 offset:20736
    ds_read_b64_tr_b16 v[88:89], v26 offset:24576
    ds_read_b64_tr_b16 v[90:91], v26 offset:24832
    ds_read_b64_tr_b16 v[92:93], v26 offset:28672
    ds_read_b64_tr_b16 v[94:95], v26 offset:28928
    ds_read_b64_tr_b16 v[96:97], v26 offset:32768
    ds_read_b64_tr_b16 v[98:99], v26 offset:33024
    ds_read_b64_tr_b16 v[100:101], v26 offset:36864
    ds_read_b64_tr_b16 v[102:103], v26 offset:37120
    ds_read_b64_tr_b16 v[104:105], v26 offset:40960
    ds_read_b64_tr_b16 v[106:107], v26 offset:41216
    ds_read_b64_tr_b16 v[108:109], v26 offset:45056
    ds_read_b64_tr_b16 v[110:111], v26 offset:45312
    ds_read_b64_tr_b16 v[112:113], v26 offset:49152
    ds_read_b64_tr_b16 v[114:115], v26 offset:49408
    ds_read_b64_tr_b16 v[116:117], v26 offset:53248
    ds_read_b64_tr_b16 v[118:119], v26 offset:53504
    ds_read_b64_tr_b16 v[120:121], v26 offset:57344
    ds_read_b64_tr_b16 v[122:123], v26 offset:57600
    ds_read_b64_tr_b16 v[124:125], v26 offset:61440
    ds_read_b64_tr_b16 v[126:127], v26 offset:61696
    s_waitcnt lgkmcnt(0)
    v_subrev_u32 v26, 0x10000, v26
    s_waitcnt lgkmcnt(0)
    s_barrier
    ds_write_b128 v12, v[64:67] offset:0
    ds_write_b128 v12, v[68:71] offset:1024
    ds_write_b128 v12, v[72:75] offset:8192
    ds_write_b128 v12, v[76:79] offset:9216
    ds_write_b128 v12, v[80:83] offset:16384
    ds_write_b128 v12, v[84:87] offset:17408
    ds_write_b128 v12, v[88:91] offset:24576
    ds_write_b128 v12, v[92:95] offset:25600
    ds_write_b128 v12, v[96:99] offset:32768
    ds_write_b128 v12, v[100:103] offset:33792
    ds_write_b128 v12, v[104:107] offset:40960
    ds_write_b128 v12, v[108:111] offset:41984
    ds_write_b128 v12, v[112:115] offset:49152
    ds_write_b128 v12, v[116:119] offset:50176
    ds_write_b128 v12, v[120:123] offset:57344
    ds_write_b128 v12, v[124:127] offset:58368
    s_waitcnt lgkmcnt(0)
    s_mov_b32 s43, 131072
    v_mov_b32 v64, 64
mega_kernel_ch_xc:
    global_load_dwordx4 v[68:71], v64, s[6:7] sc1
    global_load_dword v72, v64, s[6:7] offset:64 sc1
    s_waitcnt vmcnt(0)
    v_readfirstlane_b32 s56, v69
    v_readfirstlane_b32 s58, v71
    v_readfirstlane_b32 s59, v72
mega_kernel_ch_xc_d:
    s_sub_u32 s60, s59, s53
    s_cmp_eq_u32 s60, 2
    s_cbranch_scc1 mega_kernel_redo
    s_cmp_eq_u32 s59, 0
    s_cbranch_scc1 mega_kernel_ch_xc_w
    s_cmp_lg_u32 s58, 64
    s_cbranch_scc1 mega_kernel_ch_xc_w
    s_and_b32 s57, s56, 0xffff
    s_cmp_eq_u32 s57, 64
    s_cbranch_scc1 mega_kernel_ch_xc_ok
    s_cmp_eq_u32 s53, 1
    s_cbranch_scc1 mega_kernel_ch_xc_ok
mega_kernel_ch_xc_w:
    s_cmp_eq_u32 s43, 0
    s_cbranch_scc1 mega_kernel_ch_xc_x
    s_sub_u32 s43, s43, 1
    s_sleep 2
    s_branch mega_kernel_ch_xc
mega_kernel_ch_xc_x:
    s_cmp_lg_u32 s59, 0
    s_cbranch_scc1 mega_kernel_ch_xc_ok
    v_mov_b32 v68, 2
    v_mov_b32 v69, 0
    v_mov_b32 v70, 128
    s_mov_b64 exec, 1
    global_atomic_cmpswap v72, v70, v[68:69], s[6:7] sc0 sc1
    s_waitcnt vmcnt(0)
    s_mov_b64 exec, -1
    s_nop 3
    v_readfirstlane_b32 s59, v72
    s_cmp_eq_u32 s59, 0
    s_cselect_b32 s59, 2, s59
    s_branch mega_kernel_ch_xc_d
mega_kernel_ch_xc_ok:
    s_cmp_eq_u32 s53, 1
    s_cselect_b32 s56, 0, s56
    s_lshr_b32 s56, s56, 16
    s_cmp_gt_u32 s56, 32
    s_cselect_b32 s56, 1, 0
    s_lshl_b32 s56, s56, 13
    s_lshr_b32 s57, s54, 2
    s_lshl_b32 s57, s57, 14
    s_and_b32 s58, s54, 3
    s_lshl_b32 s58, s58, 11
    s_add_u32 s57, s57, s58
    s_add_u32 s57, s57, s56
    s_xor_b32 s57, s57, 8192
    s_lshr_b32 s58, s38, 1
    s_lshl_b32 s58, s58, 9
    s_add_u32 s57, s57, s58
    s_and_b32 s58, s38, 1
    s_lshl_b32 s58, s58, 7
    s_add_u32 s57, s57, s58
    v_and_b32 v64, 0x70, v2
    v_and_b32 v65, 0x80, v2
    v_lshl_add_u32 v64, v65, 1, v64
    v_and_b32 v65, 0x100, v2
    v_lshl_add_u32 v64, v65, 2, v64
    v_add_u32 v64, s57, v64
    v_and_b32 v65, 0x200, v2
    v_lshlrev_b32 v65, 4, v65
    v_xor_b32 v1, v64, v65
    s_xor_b32 s57, s36, 1
    s_lshl_b32 s57, s57, 5
    s_and_b32 s58, s37, 15
    s_lshl_b32 s58, s58, 1
    s_add_u32 s57, s57, s58
    s_lshr_b32 s58, s38, 1
    s_add_u32 s57, s57, s58
    s_lshr_b32 s58, s57, 2
    s_lshl_b32 s58, s58, 14
    s_add_u32 s56, s56, s58
    s_and_b32 s58, s57, 3
    s_lshl_b32 s58, s58, 11
    s_add_u32 s56, s56, s58
    s_lshr_b32 s58, s37, 4
    s_lshl_b32 s58, s58, 10
    s_add_u32 s56, s56, s58
    s_and_b32 s58, s38, 1
    s_lshl_b32 s58, s58, 9
    s_add_u32 s56, s56, s58
    v_and_b32 v64, 0x1ff, v2
    v_and_b32 v65, 0x200, v2
    v_lshl_add_u32 v64, v65, 21, v64
    v_add_u32 v64, s56, v64
    s_cmp_eq_u32 s38, 3
    s_cbranch_scc1 mega_kernel_ch_xw3
    v_mov_b32 v19, v64
    s_branch mega_kernel_ch_xw4
mega_kernel_ch_xw3:
    v_mov_b32 v4, v64
mega_kernel_ch_xw4:
    s_and_b32 s91, s54, 60
    s_lshl_b32 s91, s91, 4
    s_mov_b32 s32, s91
    s_cmp_lg_u32 s38, 3
    s_cbranch_scc1 mega_kernel_ch_if_ok
mega_kernel_ch_if:
    buffer_load_dword v0, v8, s[16:19], s32 offen sc1
    s_waitcnt vmcnt(0)
    v_cmp_gt_u32 vcc, 4, v0
    s_cbranch_vccz mega_kernel_ch_if_ok
    s_cmp_eq_u32 s43, 0
    s_cbranch_scc1 mega_kernel_ch_if_ok
    s_sub_u32 s43, s43, 1
    s_sleep 2
    s_branch mega_kernel_ch_if
mega_kernel_ch_if_ok:
    s_lshl_b32 s92, s36, 14
    s_xor_b32 s93, s92, 16384
    s_add_u32 s93, s93, 32768
    s_lshl_b32 s44, s38, 12
    s_add_u32 s92, s92, s44
    s_lshl_b32 s94, s54, 4
    s_add_u32 s94, s94, 17408
    s_mov_b32 s39, -1
    s_mov_b32 s41, 0
    s_mov_b32 s44, s92
    s_mov_b32 s45, s93
    s_mov_b32 s47, 0
    s_mov_b32 s48, 4294901760
    s_mov_b32 s42, 524288
    s_mov_b32 s33, s94
    s_barrier
    s_lshl_b32 s56, s38, 2
    s_add_u32 s56, s56, 0
    s_lshl_b32 s56, s56, 13
    v_add_u32 v72, s56, v11
    ds_read_b128 v[24:27], v72 offset:0
    ds_read_b128 v[28:31], v72 offset:1024
    s_lshl_b32 s56, s38, 2
    s_add_u32 s56, s56, 1
    s_lshl_b32 s56, s56, 13
    v_add_u32 v72, s56, v11
    ds_read_b128 v[120:123], v72 offset:0
    ds_read_b128 v[124:127], v72 offset:1024
    s_waitcnt lgkmcnt(0)
    s_lshl_b32 s56, s53, 2
    s_add_u32 s56, s56, s38
    s_cmp_eq_u32 s56, 0
    s_cbranch_scc1 mega_kernel_ch_f0_top
    s_lshl_b32 s56, s53, 2
    s_add_u32 s56, s56, s38
    s_cmp_eq_u32 s56, 1
    s_cbranch_scc1 mega_kernel_ch_f1_top
    s_lshl_b32 s56, s53, 2
    s_add_u32 s56, s56, s38
    s_cmp_eq_u32 s56, 2
    s_cbranch_scc1 mega_kernel_ch_f2_top
    s_lshl_b32 s56, s53, 2
    s_add_u32 s56, s56, s38
    s_cmp_eq_u32 s56, 3
    s_cbranch_scc1 mega_kernel_ch_f3_top
    s_lshl_b32 s56, s53, 2
    s_add_u32 s56, s56, s38
    s_cmp_eq_u32 s56, 4
    s_cbranch_scc1 mega_kernel_ch_s0_top
    s_lshl_b32 s56, s53, 2
    s_add_u32 s56, s56, s38
    s_cmp_eq_u32 s56, 5
    s_cbranch_scc1 mega_kernel_ch_s1_top
    s_lshl_b32 s56, s53, 2
    s_add_u32 s56, s56, s38
    s_cmp_eq_u32 s56, 6
    s_cbranch_scc1 mega_kernel_ch_s2_top
    s_lshl_b32 s56, s53, 2
    s_add_u32 s56, s56, s38
    s_cmp_eq_u32 s56, 7
    s_cbranch_scc1 mega_kernel_ch_s3_top
    s_branch mega_kernel_ch_fin
mega_kernel_ch_f0_top:
    s_sleep 4
    buffer_load_dwordx4 v[96:99], v2, s[20:23], s44 offen offset:0 sc1
    buffer_load_dwordx4 v[100:103], v2, s[20:23], s44 offen offset:1024 sc1
    buffer_load_dwordx4 v[104:107], v2, s[20:23], s44 offen offset:2048 sc1
    buffer_load_dwordx4 v[108:111], v2, s[20:23], s44 offen offset:3072 sc1
    buffer_load_dwordx4 v[32:35], v4, s[24:27], s47 offen offset:0 sc1
    buffer_load_dwordx4 v[36:39], v4, s[24:27], s47 offen offset:2048 sc1
    buffer_load_dwordx4 v[44:47], v5, s[24:27], s47 offen sc1
    s_add_u32 s39, s39, 1
    s_mov_b32 s40, s41
    s_add_u32 s46, s40, 4096
    s_add_u32 s41, s40, 262144
    s_and_b32 s41, s41, 1048575
    s_and_b32 s49, s41, 262144
    s_add_u32 s49, s49, 1048576
    s_add_u32 s48, s48, 65536
    v_mov_b32 v48, 0
    v_mov_b32 v49, 0
    v_mov_b32 v50, 0
    v_mov_b32 v51, 0
    v_mov_b32 v52, 0
    v_mov_b32 v53, 0
    v_mov_b32 v54, 0
    v_mov_b32 v55, 0
    v_mov_b32 v60, 0
    v_mov_b32 v61, 0
    v_mov_b32 v62, 0
    v_mov_b32 v63, 0
    s_waitcnt vmcnt(6)
mega_kernel_ch_f0_tc0:
    v_max_u32 v40, v96, v98
    v_cmp_eq_u32 vcc, -1, v40
    s_cbranch_vccnz mega_kernel_ch_f0_tc0_f
mega_kernel_ch_f0_tc0_ok:
    ds_write_b128 v2, v[96:99] offset:0
    v_smfmac_f32_16x16x64_bf16 v[48:51], v[96:99], a[0:7], v3
    v_smfmac_f32_16x16x64_bf16 v[52:55], v[96:99], a[128:135], v3
    v_smfmac_f32_16x16x64_bf16 v[60:63], v[96:99], v[24:31], v3
    s_waitcnt vmcnt(5)
mega_kernel_ch_f0_tc1:
    v_max_u32 v40, v100, v102
    v_cmp_eq_u32 vcc, -1, v40
    s_cbranch_vccnz mega_kernel_ch_f0_tc1_f
mega_kernel_ch_f0_tc1_ok:
    ds_write_b128 v2, v[100:103] offset:1024
    v_smfmac_f32_16x16x64_bf16 v[48:51], v[100:103], a[8:15], v3
    v_smfmac_f32_16x16x64_bf16 v[52:55], v[100:103], a[136:143], v3
    v_smfmac_f32_16x16x64_bf16 v[60:63], v[100:103], v[120:127], v3
    s_waitcnt vmcnt(4)
mega_kernel_ch_f0_tc2:
    v_max_u32 v40, v104, v106
    v_cmp_eq_u32 vcc, -1, v40
    s_cbranch_vccnz mega_kernel_ch_f0_tc2_f
mega_kernel_ch_f0_tc2_ok:
    ds_write_b128 v2, v[104:107] offset:2048
    v_smfmac_f32_16x16x64_bf16 v[48:51], v[104:107], a[16:23], v3
    v_smfmac_f32_16x16x64_bf16 v[52:55], v[104:107], a[144:151], v3
    s_waitcnt vmcnt(3)
mega_kernel_ch_f0_tc3:
    v_max_u32 v40, v108, v110
    v_cmp_eq_u32 vcc, -1, v40
    s_cbranch_vccnz mega_kernel_ch_f0_tc3_f
mega_kernel_ch_f0_tc3_ok:
    ds_write_b128 v2, v[108:111] offset:3072
    v_smfmac_f32_16x16x64_bf16 v[48:51], v[108:111], a[24:31], v3
    v_smfmac_f32_16x16x64_bf16 v[52:55], v[108:111], a[152:159], v3
    s_waitcnt lgkmcnt(0)
    s_barrier
    ds_read_b128 v[64:67], v2 offset:4096
    ds_read_b128 v[68:71], v2 offset:8192
    ds_read_b128 v[72:75], v2 offset:12288
    ds_read_b128 v[76:79], v2 offset:5120
    ds_read_b128 v[80:83], v2 offset:9216
    ds_read_b128 v[84:87], v2 offset:13312
    ds_read_b128 v[88:91], v2 offset:6144
    ds_read_b128 v[92:95], v2 offset:10240
    ds_read_b128 v[112:115], v2 offset:14336
    ds_read_b128 v[116:119], v2 offset:7168
    ds_read_b128 v[120:123], v2 offset:11264
    ds_read_b128 v[124:127], v2 offset:15360
    buffer_store_dwordx4 v[56:59], v18, s[20:23], s42 offen
    s_waitcnt lgkmcnt(11)
    v_smfmac_f32_16x16x64_bf16 v[48:51], v[64:67], a[32:39], v3
    v_smfmac_f32_16x16x64_bf16 v[52:55], v[64:67], a[160:167], v3
    s_waitcnt lgkmcnt(10)
    v_smfmac_f32_16x16x64_bf16 v[48:51], v[68:71], a[64:71], v3
    v_smfmac_f32_16x16x64_bf16 v[52:55], v[68:71], a[192:199], v3
    s_waitcnt lgkmcnt(9)
    v_smfmac_f32_16x16x64_bf16 v[48:51], v[72:75], a[96:103], v3
    v_smfmac_f32_16x16x64_bf16 v[52:55], v[72:75], a[224:231], v3
    s_waitcnt lgkmcnt(8)
    v_smfmac_f32_16x16x64_bf16 v[48:51], v[76:79], a[40:47], v3
    v_smfmac_f32_16x16x64_bf16 v[52:55], v[76:79], a[168:175], v3
    s_waitcnt lgkmcnt(7)
    v_smfmac_f32_16x16x64_bf16 v[48:51], v[80:83], a[72:79], v3
    v_smfmac_f32_16x16x64_bf16 v[52:55], v[80:83], a[200:207], v3
    s_waitcnt lgkmcnt(6)
    v_smfmac_f32_16x16x64_bf16 v[48:51], v[84:87], a[104:111], v3
    v_smfmac_f32_16x16x64_bf16 v[52:55], v[84:87], a[232:239], v3
    s_waitcnt lgkmcnt(5)
    v_smfmac_f32_16x16x64_bf16 v[48:51], v[88:91], a[48:55], v3
    v_smfmac_f32_16x16x64_bf16 v[52:55], v[88:91], a[176:183], v3
    s_waitcnt lgkmcnt(4)
    v_smfmac_f32_16x16x64_bf16 v[48:51], v[92:95], a[80:87], v3
    v_smfmac_f32_16x16x64_bf16 v[52:55], v[92:95], a[208:215], v3
    s_waitcnt lgkmcnt(3)
    v_smfmac_f32_16x16x64_bf16 v[48:51], v[112:115], a[112:119], v3
    v_smfmac_f32_16x16x64_bf16 v[52:55], v[112:115], a[240:247], v3
    s_waitcnt lgkmcnt(2)
    v_smfmac_f32_16x16x64_bf16 v[48:51], v[116:119], a[56:63], v3
    v_smfmac_f32_16x16x64_bf16 v[52:55], v[116:119], a[184:191], v3
    s_waitcnt lgkmcnt(1)
    v_smfmac_f32_16x16x64_bf16 v[48:51], v[120:123], a[88:95], v3
    v_smfmac_f32_16x16x64_bf16 v[52:55], v[120:123], a[216:223], v3
    s_waitcnt lgkmcnt(0)
    v_smfmac_f32_16x16x64_bf16 v[48:51], v[124:127], a[120:127], v3
    v_smfmac_f32_16x16x64_bf16 v[52:55], v[124:127], a[248:255], v3
    s_nop 7
    v_permlane32_swap_b32 v48, v52
    v_permlane32_swap_b32 v49, v53
    v_permlane32_swap_b32 v50, v54
    v_permlane32_swap_b32 v51, v55
    v_add_f32 v48, v48, v52
    v_add_f32 v49, v49, v53
    v_add_f32 v50, v50, v54
    v_add_f32 v51, v51, v55
    v_cvt_pk_bf16_f32 v52, v48, v49
    v_cvt_pk_bf16_f32 v53, v50, v51
    ds_write_b64 v6, v[52:53]
    s_waitcnt lgkmcnt(0)
    s_barrier
    ds_read_b64_tr_b16 v[48:49], v7 offset:0
    ds_read_b64_tr_b16 v[50:51], v7 offset:256
    ds_read_b64_tr_b16 v[52:53], v7 offset:1024
    ds_read_b64_tr_b16 v[54:55], v7 offset:1280
    ds_read_b128 v[24:27], v11 offset:16384
    ds_read_b128 v[28:31], v11 offset:17408
    ds_read_b128 v[96:99], v11 offset:24576
    ds_read_b128 v[100:103], v11 offset:25600
    s_waitcnt lgkmcnt(4)
    s_waitcnt vmcnt(2)
    v_mfma_f32_16x16x32_bf16 v[40:43], v[32:35], v[48:51], 0
    v_mfma_f32_16x16x32_bf16 v[40:43], v[36:39], v[52:55], v[40:43]
    s_nop 7
    buffer_store_dwordx4 v[40:43], v8, s[20:23], s40 offen
    s_waitcnt lgkmcnt(2)
    v_smfmac_f32_16x16x64_bf16 v[60:63], v[104:107], v[24:31], v3
    ds_read_b128 v[24:27], v11 offset:32768
    ds_read_b128 v[28:31], v11 offset:33792
    s_waitcnt lgkmcnt(2)
    v_smfmac_f32_16x16x64_bf16 v[60:63], v[108:111], v[96:103], v3
    ds_read_b128 v[96:99], v12 offset:0
    ds_read_b128 v[100:103], v12 offset:1024
    ds_read_b128 v[104:107], v12 offset:32768
    ds_read_b128 v[108:111], v12 offset:33792
    s_waitcnt lgkmcnt(4)
    v_smfmac_f32_16x16x64_bf16 v[60:63], v[64:67], v[24:31], v3
    ds_read_b128 v[24:27], v11 offset:40960
    ds_read_b128 v[28:31], v11 offset:41984
    s_waitcnt lgkmcnt(4)
    v_smfmac_f32_16x16x64_bf16 v[60:63], v[68:71], v[96:103], v3
    ds_read_b128 v[96:99], v12 offset:8192
    ds_read_b128 v[100:103], v12 offset:9216
    ds_read_b128 v[64:67], v12 offset:40960
    ds_read_b128 v[68:71], v12 offset:41984
    s_waitcnt lgkmcnt(6)
    v_smfmac_f32_16x16x64_bf16 v[60:63], v[72:75], v[104:111], v3
    ds_read_b128 v[104:107], v11 offset:49152
    ds_read_b128 v[108:111], v11 offset:50176
    s_waitcnt lgkmcnt(6)
    v_smfmac_f32_16x16x64_bf16 v[60:63], v[76:79], v[24:31], v3
    ds_read_b128 v[24:27], v12 offset:16384
    ds_read_b128 v[28:31], v12 offset:17408
    ds_read_b128 v[72:75], v12 offset:49152
    ds_read_b128 v[76:79], v12 offset:50176
    s_waitcnt lgkmcnt(8)
    v_smfmac_f32_16x16x64_bf16 v[60:63], v[80:83], v[96:103], v3
    ds_read_b128 v[96:99], v11 offset:57344
    ds_read_b128 v[100:103], v11 offset:58368
    s_waitcnt lgkmcnt(8)
    v_smfmac_f32_16x16x64_bf16 v[60:63], v[84:87], v[64:71], v3
    ds_read_b128 v[64:67], v12 offset:24576
    ds_read_b128 v[68:71], v12 offset:25600
    buffer_load_dwordx4 v[32:35], v9, s[20:23], s40 offen sc1
    buffer_load_dwordx4 v[36:39], v9, s[20:23], s40 offen offset:2048 sc1
    buffer_load_dwordx2 v[40:41], v10, s[20:23], s40 offen sc1
    buffer_load_dwordx2 v[42:43], v10, s[20:23], s40 offen offset:2048 sc1
    s_waitcnt lgkmcnt(8)
    v_smfmac_f32_16x16x64_bf16 v[60:63], v[88:91], v[104:111], v3
    ds_read_b128 v[80:83], v12 offset:57344
    ds_read_b128 v[84:87], v12 offset:58368
    s_waitcnt lgkmcnt(8)
    v_smfmac_f32_16x16x64_bf16 v[60:63], v[92:95], v[24:31], v3
    s_waitcnt lgkmcnt(6)
    v_smfmac_f32_16x16x64_bf16 v[60:63], v[112:115], v[72:79], v3
    s_waitcnt lgkmcnt(4)
    v_smfmac_f32_16x16x64_bf16 v[60:63], v[116:119], v[96:103], v3
    s_waitcnt lgkmcnt(2)
    v_smfmac_f32_16x16x64_bf16 v[60:63], v[120:123], v[64:71], v3
    s_waitcnt lgkmcnt(0)
    v_smfmac_f32_16x16x64_bf16 v[60:63], v[124:127], v[80:87], v3
    s_nop 7
    v_mov_b32 v24, v60
    v_mov_b32 v25, v61
    v_mov_b32 v26, v62
    v_mov_b32 v27, v63
    v_permlane32_swap_b32 v24, v60
    v_permlane32_swap_b32 v25, v61
    v_permlane32_swap_b32 v26, v62
    v_permlane32_swap_b32 v27, v63
    v_add_f32 v24, v24, v60
    v_add_f32 v25, v25, v61
    v_add_f32 v26, v26, v62
    v_add_f32 v27, v27, v63
    v_cvt_pk_bf16_f32 v22, v24, v25
    v_cvt_pk_bf16_f32 v23, v26, v27
    s_cmp_eq_u32 s39, 63
    s_cbranch_scc1 mega_kernel_ch_f0_last
    s_cmp_ge_u32 s39, 60
    s_cbranch_scc1 mega_kernel_ch_f0_e1
mega_kernel_ch_f0_e1r:
    s_waitcnt vmcnt(0)
mega_kernel_ch_f0_sp_c:
    v_max3_u32 v28, v32, v34, v36
    v_max3_u32 v28, v28, v38, v40
    v_max_u32 v28, v28, v42
    v_cmp_eq_u32 vcc, -1, v28
    s_cbranch_vccnz mega_kernel_ch_f0_sp_f
mega_kernel_ch_f0_sp_ok:
    v_add_f32 v64, v32, v36
    v_add_f32 v65, v33, v37
    v_add_f32 v66, v34, v38
    v_add_f32 v67, v35, v39
    v_add_f32 v68, v40, v42
    v_add_f32 v69, v41, v43
    v_max3_f32 v70, v64, v65, v66
    v_max3_f32 v70, v70, v67, v68
    v_max_f32 v70, v70, v69
    s_nop 1
    v_max_f32_dpp v70, v70, v70 row_ror:8 row_mask:0xf bank_mask:0xf
    v_mov_b32 v71, v70
    s_nop 1
    v_permlane16_swap_b32 v71, v70
    v_max_f32 v70, v70, v71
    v_mov_b32 v71, v70
    s_nop 1
    v_permlane32_swap_b32 v71, v70
    v_max_f32 v70, v70, v71
    v_mul_f32 v70, s52, v70
    v_fma_f32 v64, v64, s52, -v70
    v_fma_f32 v65, v65, s52, -v70
    v_fma_f32 v66, v66, s52, -v70
    v_fma_f32 v67, v67, s52, -v70
    v_fma_f32 v68, v68, s52, -v70
    v_fma_f32 v69, v69, s52, -v70
    v_exp_f32 v64, v64
    v_exp_f32 v65, v65
    v_exp_f32 v66, v66
    v_exp_f32 v67, v67
    v_exp_f32 v68, v68
    v_exp_f32 v69, v69
    v_cvt_pk_bf16_f32 v72, v64, v65
    v_cvt_pk_bf16_f32 v73, v66, v67
    v_cvt_pk_bf16_f32 v76, v68, v69
    v_mov_b32_dpp v74, v72 row_ror:8 row_mask:0xf bank_mask:0xf
    v_mov_b32_dpp v75, v73 row_ror:8 row_mask:0xf bank_mask:0xf
    v_mov_b32_dpp v77, v76 row_ror:8 row_mask:0xf bank_mask:0xf
    s_nop 0
    v_mfma_f32_16x16x32_bf16 v[80:83], v[44:47], v[72:75], 0
    s_nop 5
    v_mfma_f32_16x16x16bf16_1k v[80:83], v[22:23], v[76:77], v[80:83]
    v_add_f32 v70, v64, v65
    v_add_f32 v71, v66, v67
    v_add_f32 v70, v70, v68
    v_add_f32 v71, v71, v69
    v_add_f32 v70, v70, v71
    s_nop 1
    v_add_f32_dpp v70, v70, v70 row_ror:8 row_mask:0xf bank_mask:0xf
    v_mov_b32 v71, v70
    s_nop 1
    v_permlane16_swap_b32 v71, v70
    v_add_f32 v70, v70, v71
    v_mov_b32 v71, v70
    s_nop 1
    v_permlane32_swap_b32 v71, v70
    v_add_f32 v70, v70, v71
    v_rcp_f32 v70, v70
    s_nop 0
    v_mul_f32 v80, v80, v70
    v_mul_f32 v81, v81, v70
    v_mul_f32 v82, v82, v70
    v_mul_f32 v83, v83, v70
    v_cvt_pk_bf16_f32 v84, v80, v81
    v_cvt_pk_bf16_f32 v85, v82, v83
    buffer_store_dwordx2 v[84:85], v13, s[20:23], s40 offen
    ds_read_b128 v[24:27], v11 offset:0
    ds_read_b128 v[28:31], v11 offset:1024
    ds_read_b128 v[120:123], v11 offset:8192
    ds_read_b128 v[124:127], v11 offset:9216
    s_add_u32 s44, s41, s92
    s_add_u32 s45, s41, s93
    s_add_u32 s47, s47, 262144
    s_xor_b32 s42, s41, 524288
    s_add_u32 s56, s39, 2
    s_lshr_b32 s56, s56, 2
    s_lshl_b32 s56, s56, 10
    s_add_u32 s32, s56, s91
    s_lshl_b32 s56, s39, 13
    s_add_u32 s33, s56, s94
    v_mov_b32 v32, 0
    v_mov_b32 v33, 0
    v_mov_b32 v34, 0
    v_mov_b32 v35, 0
    v_mov_b32 v36, 0
    v_mov_b32 v37, 0
    v_mov_b32 v38, 0
    v_mov_b32 v39, 0
    v_mov_b32 v112, 0
    v_mov_b32 v113, 0
    v_mov_b32 v114, 0
    v_mov_b32 v115, 0
    v_mov_b32 v116, 0
    v_mov_b32 v117, 0
    v_mov_b32 v118, 0
    v_mov_b32 v119, 0
    s_sleep 6
    buffer_load_dwordx4 v[96:99], v14, s[20:23], s40 offen offset:0 sc1
    buffer_load_dwordx4 v[100:103], v14, s[20:23], s40 offen offset:1024 sc1
    buffer_load_dwordx4 v[104:107], v14, s[20:23], s40 offen offset:2048 sc1
    buffer_load_dwordx4 v[108:111], v14, s[20:23], s40 offen offset:3072 sc1
    s_waitcnt vmcnt(3)
mega_kernel_ch_f0_oc0:
    v_max_u32 v40, v96, v98
    v_cmp_eq_u32 vcc, -1, v40
    s_cbranch_vccnz mega_kernel_ch_f0_oc0_f
mega_kernel_ch_f0_oc0_ok:
    v_smfmac_f32_16x16x64_bf16 v[32:35], v[96:99], v[128:135], v3
    v_smfmac_f32_16x16x64_bf16 v[36:39], v[96:99], v[136:143], v3
    v_smfmac_f32_16x16x64_bf16 v[112:115], v[96:99], v[144:151], v3
    v_smfmac_f32_16x16x64_bf16 v[116:119], v[96:99], v[152:159], v3
    s_waitcnt vmcnt(2)
mega_kernel_ch_f0_oc1:
    v_max_u32 v40, v100, v102
    v_cmp_eq_u32 vcc, -1, v40
    s_cbranch_vccnz mega_kernel_ch_f0_oc1_f
mega_kernel_ch_f0_oc1_ok:
    v_smfmac_f32_16x16x64_bf16 v[32:35], v[100:103], v[160:167], v3
    v_smfmac_f32_16x16x64_bf16 v[36:39], v[100:103], v[168:175], v3
    v_smfmac_f32_16x16x64_bf16 v[112:115], v[100:103], v[176:183], v3
    v_smfmac_f32_16x16x64_bf16 v[116:119], v[100:103], v[184:191], v3
    s_waitcnt vmcnt(1)
mega_kernel_ch_f0_oc2:
    v_max_u32 v40, v104, v106
    v_cmp_eq_u32 vcc, -1, v40
    s_cbranch_vccnz mega_kernel_ch_f0_oc2_f
mega_kernel_ch_f0_oc2_ok:
    v_smfmac_f32_16x16x64_bf16 v[32:35], v[104:107], v[192:199], v3
    v_smfmac_f32_16x16x64_bf16 v[36:39], v[104:107], v[200:207], v3
    v_smfmac_f32_16x16x64_bf16 v[112:115], v[104:107], v[208:215], v3
    v_smfmac_f32_16x16x64_bf16 v[116:119], v[104:107], v[216:223], v3
    s_waitcnt vmcnt(0)
mega_kernel_ch_f0_oc3:
    v_max_u32 v40, v108, v110
    v_cmp_eq_u32 vcc, -1, v40
    s_cbranch_vccnz mega_kernel_ch_f0_oc3_f
mega_kernel_ch_f0_oc3_ok:
    v_smfmac_f32_16x16x64_bf16 v[32:35], v[108:111], v[224:231], v3
    v_smfmac_f32_16x16x64_bf16 v[36:39], v[108:111], v[232:239], v3
    v_smfmac_f32_16x16x64_bf16 v[112:115], v[108:111], v[240:247], v3
    v_smfmac_f32_16x16x64_bf16 v[116:119], v[108:111], v[248:255], v3
    s_nop 5
    v_permlane32_swap_b32 v32, v36
    v_permlane32_swap_b32 v33, v37
    v_permlane32_swap_b32 v34, v38
    v_permlane32_swap_b32 v35, v39
    v_add_f32 v32, v32, v36
    v_add_f32 v33, v33, v37
    v_add_f32 v34, v34, v38
    v_add_f32 v35, v35, v39
    ds_write_b128 v15, v[32:35]
    v_permlane32_swap_b32 v112, v116
    v_permlane32_swap_b32 v113, v117
    v_permlane32_swap_b32 v114, v118
    v_permlane32_swap_b32 v115, v119
    v_add_f32 v112, v112, v116
    v_add_f32 v113, v113, v117
    v_add_f32 v114, v114, v118
    v_add_f32 v115, v115, v119
    ds_write_b128 v15, v[112:115] offset:1024
    s_waitcnt lgkmcnt(0)
    s_barrier
    s_bfe_u32 s59, s39, 0x10001
    ds_read_b128 v[96:99], v16 offset:0
    ds_read_b128 v[100:103], v16 offset:2048
    ds_read_b128 v[104:107], v16 offset:4096
    ds_read_b128 v[108:111], v16 offset:6144
    buffer_store_dwordx2 v[22:23], v20, s[28:31], s48 offen sc1
    v_xor_b32 v116, 139264, v19
    s_waitcnt lgkmcnt(2)
    v_add_f32 v96, v96, v100
    v_add_f32 v97, v97, v101
    v_add_f32 v98, v98, v102
    v_add_f32 v99, v99, v103
    s_waitcnt lgkmcnt(0)
    v_add_f32 v104, v104, v108
    v_add_f32 v105, v105, v109
    v_add_f32 v106, v106, v110
    v_add_f32 v107, v107, v111
    v_add_f32 v96, v96, v104
    v_add_f32 v97, v97, v105
    v_add_f32 v98, v98, v106
    v_add_f32 v99, v99, v107
    v_bfi_b32 v96, 1, s59, v96
    v_bfi_b32 v98, 1, s59, v98
    buffer_store_dwordx4 v[96:99], v19, s[20:23], s49 offen sc1
    buffer_store_dwordx4 v[96:99], v116, s[20:23], s49 offen
    s_sleep 6
    buffer_load_dwordx4 v[72:75], v1, s[20:23], s49 offen sc1
    s_sleep 3
    buffer_load_dwordx4 v[76:79], v1, s[20:23], s49 offen sc1
    s_sleep 3
    buffer_load_dwordx4 v[80:83], v1, s[20:23], s49 offen sc1
    s_waitcnt vmcnt(2)
    v_bitop3_b32 v112, v72, v74, s59 bitop3:0x7e
    v_and_b32 v112, 1, v112
    v_cmp_ne_u32 vcc, 0, v112
    s_cbranch_vccnz mega_kernel_ch_f0_xf0
    v_permlane32_swap_b32 v72, v73
    v_permlane32_swap_b32 v74, v75
    v_add_f32 v114, v72, v73
    v_add_f32 v115, v74, v75
mega_kernel_ch_f0_xok:
    s_nop 1
    v_permlane16_swap_b32 v114, v115
    v_add_f32 v114, v114, v115
    s_nop 1
    v_mov_b32_dpp v115, v114 quad_perm:[1,1,3,3] row_mask:0xf bank_mask:0xf
    v_cvt_pk_bf16_f32 v112, v114, v115
    s_nop 1
    v_mov_b32_dpp v113, v112 quad_perm:[2,2,2,2] row_mask:0xf bank_mask:0xf
    buffer_store_dwordx2 v[112:113], v17, s[20:23], s41 offen
    s_branch mega_kernel_ch_f0_top
mega_kernel_ch_f0_last:
    buffer_store_dwordx2 v[22:23], v20, s[28:31], s48 offen sc1
    s_waitcnt vmcnt(0)
    s_barrier
    s_branch mega_kernel_ch_fin
mega_kernel_ch_f0_tc0_f:
    s_cmp_eq_u32 s43, 0
    s_cbranch_scc1 mega_kernel_ch_f0_tc0_ok
    s_mov_b32 s90, 0
    s_branch mega_kernel_ch_f0_tretry
mega_kernel_ch_f0_tc1_f:
    s_cmp_eq_u32 s43, 0
    s_cbranch_scc1 mega_kernel_ch_f0_tc1_ok
    s_mov_b32 s90, 1
    s_branch mega_kernel_ch_f0_tretry
mega_kernel_ch_f0_tc2_f:
    s_cmp_eq_u32 s43, 0
    s_cbranch_scc1 mega_kernel_ch_f0_tc2_ok
    s_mov_b32 s90, 2
    s_branch mega_kernel_ch_f0_tretry
mega_kernel_ch_f0_tc3_f:
    s_cmp_eq_u32 s43, 0
    s_cbranch_scc1 mega_kernel_ch_f0_tc3_ok
    s_mov_b32 s90, 3
    s_branch mega_kernel_ch_f0_tretry
mega_kernel_ch_f0_tretry:
    s_sub_u32 s43, s43, 1
    s_waitcnt vmcnt(0)
    v_max_u32 v40, v96, v98
    v_cmp_eq_u32 vcc, -1, v40
    s_cbranch_vccz mega_kernel_ch_f0_tr_L0
    buffer_load_dwordx4 v[96:99], v2, s[20:23], s44 offen offset:0 sc1
mega_kernel_ch_f0_tr_L0:
    v_max_u32 v40, v100, v102
    v_cmp_eq_u32 vcc, -1, v40
    s_cbranch_vccz mega_kernel_ch_f0_tr_L1
    buffer_load_dwordx4 v[100:103], v2, s[20:23], s44 offen offset:1024 sc1
mega_kernel_ch_f0_tr_L1:
    v_max_u32 v40, v104, v106
    v_cmp_eq_u32 vcc, -1, v40
    s_cbranch_vccz mega_kernel_ch_f0_tr_L2
    buffer_load_dwordx4 v[104:107], v2, s[20:23], s44 offen offset:2048 sc1
mega_kernel_ch_f0_tr_L2:
    v_max_u32 v40, v108, v110
    v_cmp_eq_u32 vcc, -1, v40
    s_cbranch_vccz mega_kernel_ch_f0_tr_L3
    buffer_load_dwordx4 v[108:111], v2, s[20:23], s44 offen offset:3072 sc1
mega_kernel_ch_f0_tr_L3:
    s_waitcnt vmcnt(0)
    s_cmp_eq_u32 s90, 0
    s_cbranch_scc1 mega_kernel_ch_f0_tc0
    s_cmp_eq_u32 s90, 1
    s_cbranch_scc1 mega_kernel_ch_f0_tc1
    s_cmp_eq_u32 s90, 2
    s_cbranch_scc1 mega_kernel_ch_f0_tc2
    s_branch mega_kernel_ch_f0_tc3
mega_kernel_ch_f0_e1:
    buffer_store_dwordx2 v[22:23], v20, s[28:31], s48 offen sc1
    s_branch mega_kernel_ch_f0_e1r
mega_kernel_ch_f0_sp_f:
    s_cmp_eq_u32 s43, 0
    s_cbranch_scc1 mega_kernel_ch_f0_sp_ok
    s_sub_u32 s43, s43, 1
    buffer_load_dwordx4 v[32:35], v9, s[20:23], s40 offen sc1
    buffer_load_dwordx4 v[36:39], v9, s[20:23], s40 offen offset:2048 sc1
    buffer_load_dwordx2 v[40:41], v10, s[20:23], s40 offen sc1
    buffer_load_dwordx2 v[42:43], v10, s[20:23], s40 offen offset:2048 sc1
    s_waitcnt vmcnt(0)
    s_branch mega_kernel_ch_f0_sp_c
mega_kernel_ch_f0_oc0_f:
    s_cmp_eq_u32 s43, 0
    s_cbranch_scc1 mega_kernel_ch_f0_oc0_ok
    s_mov_b32 s90, 0
    s_branch mega_kernel_ch_f0_oretry
mega_kernel_ch_f0_oc1_f:
    s_cmp_eq_u32 s43, 0
    s_cbranch_scc1 mega_kernel_ch_f0_oc1_ok
    s_mov_b32 s90, 1
    s_branch mega_kernel_ch_f0_oretry
mega_kernel_ch_f0_oc2_f:
    s_cmp_eq_u32 s43, 0
    s_cbranch_scc1 mega_kernel_ch_f0_oc2_ok
    s_mov_b32 s90, 2
    s_branch mega_kernel_ch_f0_oretry
mega_kernel_ch_f0_oc3_f:
    s_cmp_eq_u32 s43, 0
    s_cbranch_scc1 mega_kernel_ch_f0_oc3_ok
    s_mov_b32 s90, 3
    s_branch mega_kernel_ch_f0_oretry
mega_kernel_ch_f0_oretry:
    s_sub_u32 s43, s43, 1
    s_waitcnt vmcnt(0)
    v_max_u32 v40, v96, v98
    v_cmp_eq_u32 vcc, -1, v40
    s_cbranch_vccz mega_kernel_ch_f0_or_0
    buffer_load_dwordx4 v[96:99], v14, s[20:23], s40 offen offset:0 sc1
mega_kernel_ch_f0_or_0:
    v_max_u32 v40, v100, v102
    v_cmp_eq_u32 vcc, -1, v40
    s_cbranch_vccz mega_kernel_ch_f0_or_1
    buffer_load_dwordx4 v[100:103], v14, s[20:23], s40 offen offset:1024 sc1
mega_kernel_ch_f0_or_1:
    v_max_u32 v40, v104, v106
    v_cmp_eq_u32 vcc, -1, v40
    s_cbranch_vccz mega_kernel_ch_f0_or_2
    buffer_load_dwordx4 v[104:107], v14, s[20:23], s40 offen offset:2048 sc1
mega_kernel_ch_f0_or_2:
    v_max_u32 v40, v108, v110
    v_cmp_eq_u32 vcc, -1, v40
    s_cbranch_vccz mega_kernel_ch_f0_or_3
    buffer_load_dwordx4 v[108:111], v14, s[20:23], s40 offen offset:3072 sc1
mega_kernel_ch_f0_or_3:
    s_waitcnt vmcnt(0)
    s_cmp_eq_u32 s90, 0
    s_cbranch_scc1 mega_kernel_ch_f0_oc0
    s_cmp_eq_u32 s90, 1
    s_cbranch_scc1 mega_kernel_ch_f0_oc1
    s_cmp_eq_u32 s90, 2
    s_cbranch_scc1 mega_kernel_ch_f0_oc2
    s_branch mega_kernel_ch_f0_oc3
mega_kernel_ch_f0_xf0:
    s_cmp_eq_u32 s43, 0
    s_cbranch_scc1 mega_kernel_ch_f0_xok
    s_sub_u32 s43, s43, 1
    buffer_load_dwordx4 v[72:75], v1, s[20:23], s49 offen sc1
    s_waitcnt vmcnt(2)
    v_bitop3_b32 v112, v76, v78, s59 bitop3:0x7e
    v_and_b32 v112, 1, v112
    v_cmp_ne_u32 vcc, 0, v112
    s_cbranch_vccnz mega_kernel_ch_f0_xg1
    v_permlane32_swap_b32 v76, v77
    v_permlane32_swap_b32 v78, v79
    v_add_f32 v114, v76, v77
    v_add_f32 v115, v78, v79
    s_branch mega_kernel_ch_f0_xok
mega_kernel_ch_f0_xg1:
    buffer_load_dwordx4 v[76:79], v1, s[20:23], s49 offen sc1
    s_waitcnt vmcnt(2)
    v_bitop3_b32 v112, v80, v82, s59 bitop3:0x7e
    v_and_b32 v112, 1, v112
    v_cmp_ne_u32 vcc, 0, v112
    s_cbranch_vccnz mega_kernel_ch_f0_xg2
    v_permlane32_swap_b32 v80, v81
    v_permlane32_swap_b32 v82, v83
    v_add_f32 v114, v80, v81
    v_add_f32 v115, v82, v83
    s_branch mega_kernel_ch_f0_xok
mega_kernel_ch_f0_xg2:
    buffer_load_dwordx4 v[80:83], v1, s[20:23], s49 offen sc1
    s_waitcnt vmcnt(2)
    v_bitop3_b32 v112, v72, v74, s59 bitop3:0x7e
    v_and_b32 v112, 1, v112
    v_cmp_ne_u32 vcc, 0, v112
    s_cbranch_vccnz mega_kernel_ch_f0_xf0
    v_permlane32_swap_b32 v72, v73
    v_permlane32_swap_b32 v74, v75
    v_add_f32 v114, v72, v73
    v_add_f32 v115, v74, v75
    s_branch mega_kernel_ch_f0_xok
mega_kernel_ch_f1_top:
    s_sleep 4
    buffer_load_dwordx4 v[96:99], v2, s[20:23], s44 offen offset:0 sc1
    buffer_load_dwordx4 v[100:103], v2, s[20:23], s44 offen offset:1024 sc1
    buffer_load_dwordx4 v[104:107], v2, s[20:23], s44 offen offset:2048 sc1
    buffer_load_dwordx4 v[108:111], v2, s[20:23], s44 offen offset:3072 sc1
    buffer_load_dwordx4 v[32:35], v4, s[24:27], s47 offen offset:0 sc1
    buffer_load_dwordx4 v[36:39], v4, s[24:27], s47 offen offset:2048 sc1
    buffer_load_dwordx4 v[44:47], v5, s[24:27], s47 offen sc1
    s_add_u32 s39, s39, 1
    s_mov_b32 s40, s41
    s_add_u32 s46, s40, 4096
    s_add_u32 s41, s40, 262144
    s_and_b32 s41, s41, 1048575
    s_and_b32 s49, s41, 262144
    s_add_u32 s49, s49, 1048576
    s_add_u32 s48, s48, 65536
    v_mov_b32 v48, 0
    v_mov_b32 v49, 0
    v_mov_b32 v50, 0
    v_mov_b32 v51, 0
    v_mov_b32 v52, 0
    v_mov_b32 v53, 0
    v_mov_b32 v54, 0
    v_mov_b32 v55, 0
    v_mov_b32 v60, 0
    v_mov_b32 v61, 0
    v_mov_b32 v62, 0
    v_mov_b32 v63, 0
    s_waitcnt vmcnt(6)
mega_kernel_ch_f1_tc0:
    v_max_u32 v40, v96, v98
    v_cmp_eq_u32 vcc, -1, v40
    s_cbranch_vccnz mega_kernel_ch_f1_tc0_f
mega_kernel_ch_f1_tc0_ok:
    ds_write_b128 v2, v[96:99] offset:4096
    v_smfmac_f32_16x16x64_bf16 v[48:51], v[96:99], a[32:39], v3
    v_smfmac_f32_16x16x64_bf16 v[52:55], v[96:99], a[160:167], v3
    v_smfmac_f32_16x16x64_bf16 v[60:63], v[96:99], v[24:31], v3
    s_waitcnt vmcnt(5)
mega_kernel_ch_f1_tc1:
    v_max_u32 v40, v100, v102
    v_cmp_eq_u32 vcc, -1, v40
    s_cbranch_vccnz mega_kernel_ch_f1_tc1_f
mega_kernel_ch_f1_tc1_ok:
    ds_write_b128 v2, v[100:103] offset:5120
    v_smfmac_f32_16x16x64_bf16 v[48:51], v[100:103], a[40:47], v3
    v_smfmac_f32_16x16x64_bf16 v[52:55], v[100:103], a[168:175], v3
    v_smfmac_f32_16x16x64_bf16 v[60:63], v[100:103], v[120:127], v3
    s_waitcnt vmcnt(4)
mega_kernel_ch_f1_tc2:
    v_max_u32 v40, v104, v106
    v_cmp_eq_u32 vcc, -1, v40
    s_cbranch_vccnz mega_kernel_ch_f1_tc2_f
mega_kernel_ch_f1_tc2_ok:
    ds_write_b128 v2, v[104:107] offset:6144
    v_smfmac_f32_16x16x64_bf16 v[48:51], v[104:107], a[48:55], v3
    v_smfmac_f32_16x16x64_bf16 v[52:55], v[104:107], a[176:183], v3
    s_waitcnt vmcnt(3)
mega_kernel_ch_f1_tc3:
    v_max_u32 v40, v108, v110
    v_cmp_eq_u32 vcc, -1, v40
    s_cbranch_vccnz mega_kernel_ch_f1_tc3_f
mega_kernel_ch_f1_tc3_ok:
    ds_write_b128 v2, v[108:111] offset:7168
    v_smfmac_f32_16x16x64_bf16 v[48:51], v[108:111], a[56:63], v3
    v_smfmac_f32_16x16x64_bf16 v[52:55], v[108:111], a[184:191], v3
    s_waitcnt lgkmcnt(0)
    s_barrier
    ds_read_b128 v[64:67], v2 offset:8192
    ds_read_b128 v[68:71], v2 offset:12288
    ds_read_b128 v[72:75], v2 offset:0
    ds_read_b128 v[76:79], v2 offset:9216
    ds_read_b128 v[80:83], v2 offset:13312
    ds_read_b128 v[84:87], v2 offset:1024
    ds_read_b128 v[88:91], v2 offset:10240
    ds_read_b128 v[92:95], v2 offset:14336
    ds_read_b128 v[112:115], v2 offset:2048
    ds_read_b128 v[116:119], v2 offset:11264
    ds_read_b128 v[120:123], v2 offset:15360
    ds_read_b128 v[124:127], v2 offset:3072
    s_waitcnt lgkmcnt(11)
    v_smfmac_f32_16x16x64_bf16 v[48:51], v[64:67], a[64:71], v3
    v_smfmac_f32_16x16x64_bf16 v[52:55], v[64:67], a[192:199], v3
    s_waitcnt lgkmcnt(10)
    v_smfmac_f32_16x16x64_bf16 v[48:51], v[68:71], a[96:103], v3
    v_smfmac_f32_16x16x64_bf16 v[52:55], v[68:71], a[224:231], v3
    s_waitcnt lgkmcnt(9)
    v_smfmac_f32_16x16x64_bf16 v[48:51], v[72:75], a[0:7], v3
    v_smfmac_f32_16x16x64_bf16 v[52:55], v[72:75], a[128:135], v3
    s_waitcnt lgkmcnt(8)
    v_smfmac_f32_16x16x64_bf16 v[48:51], v[76:79], a[72:79], v3
    v_smfmac_f32_16x16x64_bf16 v[52:55], v[76:79], a[200:207], v3
    s_waitcnt lgkmcnt(7)
    v_smfmac_f32_16x16x64_bf16 v[48:51], v[80:83], a[104:111], v3
    v_smfmac_f32_16x16x64_bf16 v[52:55], v[80:83], a[232:239], v3
    s_waitcnt lgkmcnt(6)
    v_smfmac_f32_16x16x64_bf16 v[48:51], v[84:87], a[8:15], v3
    v_smfmac_f32_16x16x64_bf16 v[52:55], v[84:87], a[136:143], v3
    s_waitcnt lgkmcnt(5)
    v_smfmac_f32_16x16x64_bf16 v[48:51], v[88:91], a[80:87], v3
    v_smfmac_f32_16x16x64_bf16 v[52:55], v[88:91], a[208:215], v3
    s_waitcnt lgkmcnt(4)
    v_smfmac_f32_16x16x64_bf16 v[48:51], v[92:95], a[112:119], v3
    v_smfmac_f32_16x16x64_bf16 v[52:55], v[92:95], a[240:247], v3
    s_waitcnt lgkmcnt(3)
    v_smfmac_f32_16x16x64_bf16 v[48:51], v[112:115], a[16:23], v3
    v_smfmac_f32_16x16x64_bf16 v[52:55], v[112:115], a[144:151], v3
    s_waitcnt lgkmcnt(2)
    v_smfmac_f32_16x16x64_bf16 v[48:51], v[116:119], a[88:95], v3
    v_smfmac_f32_16x16x64_bf16 v[52:55], v[116:119], a[216:223], v3
    s_waitcnt lgkmcnt(1)
    v_smfmac_f32_16x16x64_bf16 v[48:51], v[120:123], a[120:127], v3
    v_smfmac_f32_16x16x64_bf16 v[52:55], v[120:123], a[248:255], v3
    s_waitcnt lgkmcnt(0)
    v_smfmac_f32_16x16x64_bf16 v[48:51], v[124:127], a[24:31], v3
    v_smfmac_f32_16x16x64_bf16 v[52:55], v[124:127], a[152:159], v3
    s_nop 7
    v_permlane32_swap_b32 v48, v52
    v_permlane32_swap_b32 v49, v53
    v_permlane32_swap_b32 v50, v54
    v_permlane32_swap_b32 v51, v55
    v_add_f32 v48, v48, v52
    v_add_f32 v49, v49, v53
    v_add_f32 v50, v50, v54
    v_add_f32 v51, v51, v55
    v_cvt_pk_bf16_f32 v52, v48, v49
    v_cvt_pk_bf16_f32 v53, v50, v51
    ds_write_b64 v6, v[52:53]
    s_waitcnt lgkmcnt(0)
    s_barrier
    ds_read_b64_tr_b16 v[48:49], v7 offset:0
    ds_read_b64_tr_b16 v[50:51], v7 offset:256
    ds_read_b64_tr_b16 v[52:53], v7 offset:1024
    ds_read_b64_tr_b16 v[54:55], v7 offset:1280
    ds_read_b128 v[24:27], v11 offset:49152
    ds_read_b128 v[28:31], v11 offset:50176
    ds_read_b128 v[96:99], v11 offset:57344
    ds_read_b128 v[100:103], v11 offset:58368
    s_waitcnt lgkmcnt(4)
    s_waitcnt vmcnt(1)
    v_mfma_f32_16x16x32_bf16 v[40:43], v[32:35], v[48:51], 0
    v_mfma_f32_16x16x32_bf16 v[40:43], v[36:39], v[52:55], v[40:43]
    s_nop 7
    buffer_store_dwordx4 v[40:43], v8, s[20:23], s40 offen
    s_waitcnt lgkmcnt(2)
    v_smfmac_f32_16x16x64_bf16 v[60:63], v[104:107], v[24:31], v3
    ds_read_b128 v[24:27], v12 offset:0
    ds_read_b128 v[28:31], v12 offset:1024
    s_waitcnt lgkmcnt(2)
    v_smfmac_f32_16x16x64_bf16 v[60:63], v[108:111], v[96:103], v3
    ds_read_b128 v[96:99], v12 offset:32768
    ds_read_b128 v[100:103], v12 offset:33792
    ds_read_b128 v[104:107], v11 offset:0
    ds_read_b128 v[108:111], v11 offset:1024
    s_waitcnt lgkmcnt(4)
    v_smfmac_f32_16x16x64_bf16 v[60:63], v[64:67], v[24:31], v3
    ds_read_b128 v[24:27], v12 offset:8192
    ds_read_b128 v[28:31], v12 offset:9216
    s_waitcnt lgkmcnt(4)
    v_smfmac_f32_16x16x64_bf16 v[60:63], v[68:71], v[96:103], v3
    ds_read_b128 v[96:99], v12 offset:40960
    ds_read_b128 v[100:103], v12 offset:41984
    ds_read_b128 v[64:67], v11 offset:8192
    ds_read_b128 v[68:71], v11 offset:9216
    s_waitcnt lgkmcnt(6)
    v_smfmac_f32_16x16x64_bf16 v[60:63], v[72:75], v[104:111], v3
    ds_read_b128 v[104:107], v12 offset:16384
    ds_read_b128 v[108:111], v12 offset:17408
    s_waitcnt lgkmcnt(6)
    v_smfmac_f32_16x16x64_bf16 v[60:63], v[76:79], v[24:31], v3
    ds_read_b128 v[24:27], v12 offset:49152
    ds_read_b128 v[28:31], v12 offset:50176
    ds_read_b128 v[72:75], v11 offset:16384
    ds_read_b128 v[76:79], v11 offset:17408
    s_waitcnt lgkmcnt(8)
    v_smfmac_f32_16x16x64_bf16 v[60:63], v[80:83], v[96:103], v3
    ds_read_b128 v[96:99], v12 offset:24576
    ds_read_b128 v[100:103], v12 offset:25600
    s_waitcnt lgkmcnt(8)
    v_smfmac_f32_16x16x64_bf16 v[60:63], v[84:87], v[64:71], v3
    ds_read_b128 v[64:67], v12 offset:57344
    ds_read_b128 v[68:71], v12 offset:58368
    buffer_load_dwordx4 v[32:35], v9, s[20:23], s40 offen sc1
    buffer_load_dwordx4 v[36:39], v9, s[20:23], s40 offen offset:2048 sc1
    buffer_load_dwordx2 v[40:41], v10, s[20:23], s40 offen sc1
    buffer_load_dwordx2 v[42:43], v10, s[20:23], s40 offen offset:2048 sc1
    s_waitcnt lgkmcnt(8)
    v_smfmac_f32_16x16x64_bf16 v[60:63], v[88:91], v[104:111], v3
    ds_read_b128 v[80:83], v11 offset:24576
    ds_read_b128 v[84:87], v11 offset:25600
    s_waitcnt lgkmcnt(8)
    v_smfmac_f32_16x16x64_bf16 v[60:63], v[92:95], v[24:31], v3
    s_waitcnt lgkmcnt(6)
    v_smfmac_f32_16x16x64_bf16 v[60:63], v[112:115], v[72:79], v3
    s_waitcnt lgkmcnt(4)
    v_smfmac_f32_16x16x64_bf16 v[60:63], v[116:119], v[96:103], v3
    s_waitcnt lgkmcnt(2)
    v_smfmac_f32_16x16x64_bf16 v[60:63], v[120:123], v[64:71], v3
    s_waitcnt lgkmcnt(0)
    v_smfmac_f32_16x16x64_bf16 v[60:63], v[124:127], v[80:87], v3
    s_nop 7
    v_mov_b32 v24, v60
    v_mov_b32 v25, v61
    v_mov_b32 v26, v62
    v_mov_b32 v27, v63
    v_permlane32_swap_b32 v24, v60
    v_permlane32_swap_b32 v25, v61
    v_permlane32_swap_b32 v26, v62
    v_permlane32_swap_b32 v27, v63
    v_add_f32 v24, v24, v60
    v_add_f32 v25, v25, v61
    v_add_f32 v26, v26, v62
    v_add_f32 v27, v27, v63
    v_cvt_pk_bf16_f32 v22, v24, v25
    v_cvt_pk_bf16_f32 v23, v26, v27
    s_cmp_eq_u32 s39, 63
    s_cbranch_scc1 mega_kernel_ch_f1_last
    s_cmp_ge_u32 s39, 60
    s_cbranch_scc1 mega_kernel_ch_f1_e1
mega_kernel_ch_f1_e1r:
    s_waitcnt vmcnt(0)
mega_kernel_ch_f1_sp_c:
    v_max3_u32 v28, v32, v34, v36
    v_max3_u32 v28, v28, v38, v40
    v_max_u32 v28, v28, v42
    v_cmp_eq_u32 vcc, -1, v28
    s_cbranch_vccnz mega_kernel_ch_f1_sp_f
mega_kernel_ch_f1_sp_ok:
    v_add_f32 v64, v32, v36
    v_add_f32 v65, v33, v37
    v_add_f32 v66, v34, v38
    v_add_f32 v67, v35, v39
    v_add_f32 v68, v40, v42
    v_add_f32 v69, v41, v43
    v_max3_f32 v70, v64, v65, v66
    v_max3_f32 v70, v70, v67, v68
    v_max_f32 v70, v70, v69
    s_nop 1
    v_max_f32_dpp v70, v70, v70 row_ror:8 row_mask:0xf bank_mask:0xf
    v_mov_b32 v71, v70
    s_nop 1
    v_permlane16_swap_b32 v71, v70
    v_max_f32 v70, v70, v71
    v_mov_b32 v71, v70
    s_nop 1
    v_permlane32_swap_b32 v71, v70
    v_max_f32 v70, v70, v71
    v_mul_f32 v70, s52, v70
    v_fma_f32 v64, v64, s52, -v70
    v_fma_f32 v65, v65, s52, -v70
    v_fma_f32 v66, v66, s52, -v70
    v_fma_f32 v67, v67, s52, -v70
    v_fma_f32 v68, v68, s52, -v70
    v_fma_f32 v69, v69, s52, -v70
    v_exp_f32 v64, v64
    v_exp_f32 v65, v65
    v_exp_f32 v66, v66
    v_exp_f32 v67, v67
    v_exp_f32 v68, v68
    v_exp_f32 v69, v69
    v_cvt_pk_bf16_f32 v72, v64, v65
    v_cvt_pk_bf16_f32 v73, v66, v67
    v_cvt_pk_bf16_f32 v76, v68, v69
    v_mov_b32_dpp v74, v72 row_ror:8 row_mask:0xf bank_mask:0xf
    v_mov_b32_dpp v75, v73 row_ror:8 row_mask:0xf bank_mask:0xf
    v_mov_b32_dpp v77, v76 row_ror:8 row_mask:0xf bank_mask:0xf
    s_nop 0
    v_mfma_f32_16x16x32_bf16 v[80:83], v[44:47], v[72:75], 0
    s_nop 5
    v_mfma_f32_16x16x16bf16_1k v[80:83], v[22:23], v[76:77], v[80:83]
    v_add_f32 v70, v64, v65
    v_add_f32 v71, v66, v67
    v_add_f32 v70, v70, v68
    v_add_f32 v71, v71, v69
    v_add_f32 v70, v70, v71
    s_nop 1
    v_add_f32_dpp v70, v70, v70 row_ror:8 row_mask:0xf bank_mask:0xf
    v_mov_b32 v71, v70
    s_nop 1
    v_permlane16_swap_b32 v71, v70
    v_add_f32 v70, v70, v71
    v_mov_b32 v71, v70
    s_nop 1
    v_permlane32_swap_b32 v71, v70
    v_add_f32 v70, v70, v71
    v_rcp_f32 v70, v70
    s_nop 0
    v_mul_f32 v80, v80, v70
    v_mul_f32 v81, v81, v70
    v_mul_f32 v82, v82, v70
    v_mul_f32 v83, v83, v70
    v_cvt_pk_bf16_f32 v84, v80, v81
    v_cvt_pk_bf16_f32 v85, v82, v83
    buffer_store_dwordx2 v[84:85], v13, s[20:23], s40 offen
    ds_read_b128 v[24:27], v11 offset:32768
    ds_read_b128 v[28:31], v11 offset:33792
    ds_read_b128 v[120:123], v11 offset:40960
    ds_read_b128 v[124:127], v11 offset:41984
    s_add_u32 s44, s41, s92
    s_add_u32 s45, s41, s93
    s_add_u32 s47, s47, 262144
    s_xor_b32 s42, s41, 524288
    s_add_u32 s56, s39, 2
    s_lshr_b32 s56, s56, 2
    s_lshl_b32 s56, s56, 10
    s_add_u32 s32, s56, s91
    s_lshl_b32 s56, s39, 13
    s_add_u32 s33, s56, s94
    v_mov_b32 v32, 0
    v_mov_b32 v33, 0
    v_mov_b32 v34, 0
    v_mov_b32 v35, 0
    v_mov_b32 v36, 0
    v_mov_b32 v37, 0
    v_mov_b32 v38, 0
    v_mov_b32 v39, 0
    v_mov_b32 v112, 0
    v_mov_b32 v113, 0
    v_mov_b32 v114, 0
    v_mov_b32 v115, 0
    v_mov_b32 v116, 0
    v_mov_b32 v117, 0
    v_mov_b32 v118, 0
    v_mov_b32 v119, 0
    s_sleep 6
    buffer_load_dwordx4 v[96:99], v14, s[20:23], s40 offen offset:0 sc1
    buffer_load_dwordx4 v[100:103], v14, s[20:23], s40 offen offset:1024 sc1
    buffer_load_dwordx4 v[104:107], v14, s[20:23], s40 offen offset:2048 sc1
    buffer_load_dwordx4 v[108:111], v14, s[20:23], s40 offen offset:3072 sc1
    s_waitcnt vmcnt(3)
mega_kernel_ch_f1_oc0:
    v_max_u32 v40, v96, v98
    v_cmp_eq_u32 vcc, -1, v40
    s_cbranch_vccnz mega_kernel_ch_f1_oc0_f
mega_kernel_ch_f1_oc0_ok:
    v_smfmac_f32_16x16x64_bf16 v[32:35], v[96:99], v[128:135], v3
    v_smfmac_f32_16x16x64_bf16 v[36:39], v[96:99], v[136:143], v3
    v_smfmac_f32_16x16x64_bf16 v[112:115], v[96:99], v[144:151], v3
    v_smfmac_f32_16x16x64_bf16 v[116:119], v[96:99], v[152:159], v3
    s_waitcnt vmcnt(2)
mega_kernel_ch_f1_oc1:
    v_max_u32 v40, v100, v102
    v_cmp_eq_u32 vcc, -1, v40
    s_cbranch_vccnz mega_kernel_ch_f1_oc1_f
mega_kernel_ch_f1_oc1_ok:
    v_smfmac_f32_16x16x64_bf16 v[32:35], v[100:103], v[160:167], v3
    v_smfmac_f32_16x16x64_bf16 v[36:39], v[100:103], v[168:175], v3
    v_smfmac_f32_16x16x64_bf16 v[112:115], v[100:103], v[176:183], v3
    v_smfmac_f32_16x16x64_bf16 v[116:119], v[100:103], v[184:191], v3
    s_waitcnt vmcnt(1)
mega_kernel_ch_f1_oc2:
    v_max_u32 v40, v104, v106
    v_cmp_eq_u32 vcc, -1, v40
    s_cbranch_vccnz mega_kernel_ch_f1_oc2_f
mega_kernel_ch_f1_oc2_ok:
    v_smfmac_f32_16x16x64_bf16 v[32:35], v[104:107], v[192:199], v3
    v_smfmac_f32_16x16x64_bf16 v[36:39], v[104:107], v[200:207], v3
    v_smfmac_f32_16x16x64_bf16 v[112:115], v[104:107], v[208:215], v3
    v_smfmac_f32_16x16x64_bf16 v[116:119], v[104:107], v[216:223], v3
    s_waitcnt vmcnt(0)
mega_kernel_ch_f1_oc3:
    v_max_u32 v40, v108, v110
    v_cmp_eq_u32 vcc, -1, v40
    s_cbranch_vccnz mega_kernel_ch_f1_oc3_f
mega_kernel_ch_f1_oc3_ok:
    v_smfmac_f32_16x16x64_bf16 v[32:35], v[108:111], v[224:231], v3
    v_smfmac_f32_16x16x64_bf16 v[36:39], v[108:111], v[232:239], v3
    v_smfmac_f32_16x16x64_bf16 v[112:115], v[108:111], v[240:247], v3
    v_smfmac_f32_16x16x64_bf16 v[116:119], v[108:111], v[248:255], v3
    s_nop 5
    v_permlane32_swap_b32 v32, v36
    v_permlane32_swap_b32 v33, v37
    v_permlane32_swap_b32 v34, v38
    v_permlane32_swap_b32 v35, v39
    v_add_f32 v32, v32, v36
    v_add_f32 v33, v33, v37
    v_add_f32 v34, v34, v38
    v_add_f32 v35, v35, v39
    ds_write_b128 v15, v[32:35]
    v_permlane32_swap_b32 v112, v116
    v_permlane32_swap_b32 v113, v117
    v_permlane32_swap_b32 v114, v118
    v_permlane32_swap_b32 v115, v119
    v_add_f32 v112, v112, v116
    v_add_f32 v113, v113, v117
    v_add_f32 v114, v114, v118
    v_add_f32 v115, v115, v119
    ds_write_b128 v15, v[112:115] offset:1024
    s_waitcnt lgkmcnt(0)
    s_barrier
    s_bfe_u32 s59, s39, 0x10001
    ds_read_b128 v[96:99], v16 offset:0
    ds_read_b128 v[100:103], v16 offset:2048
    ds_read_b128 v[104:107], v16 offset:4096
    ds_read_b128 v[108:111], v16 offset:6144
    buffer_store_dwordx2 v[22:23], v20, s[28:31], s48 offen sc1
    v_xor_b32 v116, 139264, v19
    s_waitcnt lgkmcnt(2)
    v_add_f32 v96, v96, v100
    v_add_f32 v97, v97, v101
    v_add_f32 v98, v98, v102
    v_add_f32 v99, v99, v103
    s_waitcnt lgkmcnt(0)
    v_add_f32 v104, v104, v108
    v_add_f32 v105, v105, v109
    v_add_f32 v106, v106, v110
    v_add_f32 v107, v107, v111
    v_add_f32 v96, v96, v104
    v_add_f32 v97, v97, v105
    v_add_f32 v98, v98, v106
    v_add_f32 v99, v99, v107
    v_bfi_b32 v96, 1, s59, v96
    v_bfi_b32 v98, 1, s59, v98
    buffer_store_dwordx4 v[96:99], v19, s[20:23], s49 offen sc1
    buffer_store_dwordx4 v[96:99], v116, s[20:23], s49 offen
    s_sleep 6
    buffer_load_dwordx4 v[72:75], v1, s[20:23], s49 offen sc1
    s_sleep 3
    buffer_load_dwordx4 v[76:79], v1, s[20:23], s49 offen sc1
    s_sleep 3
    buffer_load_dwordx4 v[80:83], v1, s[20:23], s49 offen sc1
    s_waitcnt vmcnt(2)
    v_bitop3_b32 v112, v72, v74, s59 bitop3:0x7e
    v_and_b32 v112, 1, v112
    v_cmp_ne_u32 vcc, 0, v112
    s_cbranch_vccnz mega_kernel_ch_f1_xf0
    v_permlane32_swap_b32 v72, v73
    v_permlane32_swap_b32 v74, v75
    v_add_f32 v114, v72, v73
    v_add_f32 v115, v74, v75
mega_kernel_ch_f1_xok:
    s_nop 1
    v_permlane16_swap_b32 v114, v115
    v_add_f32 v114, v114, v115
    s_nop 1
    v_mov_b32_dpp v115, v114 quad_perm:[1,1,3,3] row_mask:0xf bank_mask:0xf
    v_cvt_pk_bf16_f32 v112, v114, v115
    s_nop 1
    v_mov_b32_dpp v113, v112 quad_perm:[2,2,2,2] row_mask:0xf bank_mask:0xf
    buffer_store_dwordx2 v[112:113], v17, s[20:23], s41 offen
    s_branch mega_kernel_ch_f1_top
mega_kernel_ch_f1_last:
    buffer_store_dwordx2 v[22:23], v20, s[28:31], s48 offen sc1
    s_waitcnt vmcnt(0)
    s_barrier
    s_branch mega_kernel_ch_fin
mega_kernel_ch_f1_tc0_f:
    s_cmp_eq_u32 s43, 0
    s_cbranch_scc1 mega_kernel_ch_f1_tc0_ok
    s_mov_b32 s90, 0
    s_branch mega_kernel_ch_f1_tretry
mega_kernel_ch_f1_tc1_f:
    s_cmp_eq_u32 s43, 0
    s_cbranch_scc1 mega_kernel_ch_f1_tc1_ok
    s_mov_b32 s90, 1
    s_branch mega_kernel_ch_f1_tretry
mega_kernel_ch_f1_tc2_f:
    s_cmp_eq_u32 s43, 0
    s_cbranch_scc1 mega_kernel_ch_f1_tc2_ok
    s_mov_b32 s90, 2
    s_branch mega_kernel_ch_f1_tretry
mega_kernel_ch_f1_tc3_f:
    s_cmp_eq_u32 s43, 0
    s_cbranch_scc1 mega_kernel_ch_f1_tc3_ok
    s_mov_b32 s90, 3
    s_branch mega_kernel_ch_f1_tretry
mega_kernel_ch_f1_tretry:
    s_sub_u32 s43, s43, 1
    s_waitcnt vmcnt(0)
    v_max_u32 v40, v96, v98
    v_cmp_eq_u32 vcc, -1, v40
    s_cbranch_vccz mega_kernel_ch_f1_tr_L0
    buffer_load_dwordx4 v[96:99], v2, s[20:23], s44 offen offset:0 sc1
mega_kernel_ch_f1_tr_L0:
    v_max_u32 v40, v100, v102
    v_cmp_eq_u32 vcc, -1, v40
    s_cbranch_vccz mega_kernel_ch_f1_tr_L1
    buffer_load_dwordx4 v[100:103], v2, s[20:23], s44 offen offset:1024 sc1
mega_kernel_ch_f1_tr_L1:
    v_max_u32 v40, v104, v106
    v_cmp_eq_u32 vcc, -1, v40
    s_cbranch_vccz mega_kernel_ch_f1_tr_L2
    buffer_load_dwordx4 v[104:107], v2, s[20:23], s44 offen offset:2048 sc1
mega_kernel_ch_f1_tr_L2:
    v_max_u32 v40, v108, v110
    v_cmp_eq_u32 vcc, -1, v40
    s_cbranch_vccz mega_kernel_ch_f1_tr_L3
    buffer_load_dwordx4 v[108:111], v2, s[20:23], s44 offen offset:3072 sc1
mega_kernel_ch_f1_tr_L3:
    s_waitcnt vmcnt(0)
    s_cmp_eq_u32 s90, 0
    s_cbranch_scc1 mega_kernel_ch_f1_tc0
    s_cmp_eq_u32 s90, 1
    s_cbranch_scc1 mega_kernel_ch_f1_tc1
    s_cmp_eq_u32 s90, 2
    s_cbranch_scc1 mega_kernel_ch_f1_tc2
    s_branch mega_kernel_ch_f1_tc3
mega_kernel_ch_f1_e1:
    buffer_store_dwordx2 v[22:23], v20, s[28:31], s48 offen sc1
    s_branch mega_kernel_ch_f1_e1r
mega_kernel_ch_f1_sp_f:
    s_cmp_eq_u32 s43, 0
    s_cbranch_scc1 mega_kernel_ch_f1_sp_ok
    s_sub_u32 s43, s43, 1
    buffer_load_dwordx4 v[32:35], v9, s[20:23], s40 offen sc1
    buffer_load_dwordx4 v[36:39], v9, s[20:23], s40 offen offset:2048 sc1
    buffer_load_dwordx2 v[40:41], v10, s[20:23], s40 offen sc1
    buffer_load_dwordx2 v[42:43], v10, s[20:23], s40 offen offset:2048 sc1
    s_waitcnt vmcnt(0)
    s_branch mega_kernel_ch_f1_sp_c
mega_kernel_ch_f1_oc0_f:
    s_cmp_eq_u32 s43, 0
    s_cbranch_scc1 mega_kernel_ch_f1_oc0_ok
    s_mov_b32 s90, 0
    s_branch mega_kernel_ch_f1_oretry
mega_kernel_ch_f1_oc1_f:
    s_cmp_eq_u32 s43, 0
    s_cbranch_scc1 mega_kernel_ch_f1_oc1_ok
    s_mov_b32 s90, 1
    s_branch mega_kernel_ch_f1_oretry
mega_kernel_ch_f1_oc2_f:
    s_cmp_eq_u32 s43, 0
    s_cbranch_scc1 mega_kernel_ch_f1_oc2_ok
    s_mov_b32 s90, 2
    s_branch mega_kernel_ch_f1_oretry
mega_kernel_ch_f1_oc3_f:
    s_cmp_eq_u32 s43, 0
    s_cbranch_scc1 mega_kernel_ch_f1_oc3_ok
    s_mov_b32 s90, 3
    s_branch mega_kernel_ch_f1_oretry
mega_kernel_ch_f1_oretry:
    s_sub_u32 s43, s43, 1
    s_waitcnt vmcnt(0)
    v_max_u32 v40, v96, v98
    v_cmp_eq_u32 vcc, -1, v40
    s_cbranch_vccz mega_kernel_ch_f1_or_0
    buffer_load_dwordx4 v[96:99], v14, s[20:23], s40 offen offset:0 sc1
mega_kernel_ch_f1_or_0:
    v_max_u32 v40, v100, v102
    v_cmp_eq_u32 vcc, -1, v40
    s_cbranch_vccz mega_kernel_ch_f1_or_1
    buffer_load_dwordx4 v[100:103], v14, s[20:23], s40 offen offset:1024 sc1
mega_kernel_ch_f1_or_1:
    v_max_u32 v40, v104, v106
    v_cmp_eq_u32 vcc, -1, v40
    s_cbranch_vccz mega_kernel_ch_f1_or_2
    buffer_load_dwordx4 v[104:107], v14, s[20:23], s40 offen offset:2048 sc1
mega_kernel_ch_f1_or_2:
    v_max_u32 v40, v108, v110
    v_cmp_eq_u32 vcc, -1, v40
    s_cbranch_vccz mega_kernel_ch_f1_or_3
    buffer_load_dwordx4 v[108:111], v14, s[20:23], s40 offen offset:3072 sc1
mega_kernel_ch_f1_or_3:
    s_waitcnt vmcnt(0)
    s_cmp_eq_u32 s90, 0
    s_cbranch_scc1 mega_kernel_ch_f1_oc0
    s_cmp_eq_u32 s90, 1
    s_cbranch_scc1 mega_kernel_ch_f1_oc1
    s_cmp_eq_u32 s90, 2
    s_cbranch_scc1 mega_kernel_ch_f1_oc2
    s_branch mega_kernel_ch_f1_oc3
mega_kernel_ch_f1_xf0:
    s_cmp_eq_u32 s43, 0
    s_cbranch_scc1 mega_kernel_ch_f1_xok
    s_sub_u32 s43, s43, 1
    buffer_load_dwordx4 v[72:75], v1, s[20:23], s49 offen sc1
    s_waitcnt vmcnt(2)
    v_bitop3_b32 v112, v76, v78, s59 bitop3:0x7e
    v_and_b32 v112, 1, v112
    v_cmp_ne_u32 vcc, 0, v112
    s_cbranch_vccnz mega_kernel_ch_f1_xg1
    v_permlane32_swap_b32 v76, v77
    v_permlane32_swap_b32 v78, v79
    v_add_f32 v114, v76, v77
    v_add_f32 v115, v78, v79
    s_branch mega_kernel_ch_f1_xok
mega_kernel_ch_f1_xg1:
    buffer_load_dwordx4 v[76:79], v1, s[20:23], s49 offen sc1
    s_waitcnt vmcnt(2)
    v_bitop3_b32 v112, v80, v82, s59 bitop3:0x7e
    v_and_b32 v112, 1, v112
    v_cmp_ne_u32 vcc, 0, v112
    s_cbranch_vccnz mega_kernel_ch_f1_xg2
    v_permlane32_swap_b32 v80, v81
    v_permlane32_swap_b32 v82, v83
    v_add_f32 v114, v80, v81
    v_add_f32 v115, v82, v83
    s_branch mega_kernel_ch_f1_xok
mega_kernel_ch_f1_xg2:
    buffer_load_dwordx4 v[80:83], v1, s[20:23], s49 offen sc1
    s_waitcnt vmcnt(2)
    v_bitop3_b32 v112, v72, v74, s59 bitop3:0x7e
    v_and_b32 v112, 1, v112
    v_cmp_ne_u32 vcc, 0, v112
    s_cbranch_vccnz mega_kernel_ch_f1_xf0
    v_permlane32_swap_b32 v72, v73
    v_permlane32_swap_b32 v74, v75
    v_add_f32 v114, v72, v73
    v_add_f32 v115, v74, v75
    s_branch mega_kernel_ch_f1_xok
mega_kernel_ch_f2_top:
    s_sleep 4
    buffer_load_dwordx4 v[96:99], v2, s[20:23], s44 offen offset:0 sc1
    buffer_load_dwordx4 v[100:103], v2, s[20:23], s44 offen offset:1024 sc1
    buffer_load_dwordx4 v[104:107], v2, s[20:23], s44 offen offset:2048 sc1
    buffer_load_dwordx4 v[108:111], v2, s[20:23], s44 offen offset:3072 sc1
    buffer_load_dwordx4 v[44:47], v5, s[24:27], s47 offen sc1
    s_add_u32 s39, s39, 1
    s_mov_b32 s40, s41
    s_add_u32 s46, s40, 4096
    s_add_u32 s41, s40, 262144
    s_and_b32 s41, s41, 1048575
    s_and_b32 s49, s41, 262144
    s_add_u32 s49, s49, 1048576
    s_add_u32 s48, s48, 65536
    v_mov_b32 v48, 0
    v_mov_b32 v49, 0
    v_mov_b32 v50, 0
    v_mov_b32 v51, 0
    v_mov_b32 v52, 0
    v_mov_b32 v53, 0
    v_mov_b32 v54, 0
    v_mov_b32 v55, 0
    v_mov_b32 v60, 0
    v_mov_b32 v61, 0
    v_mov_b32 v62, 0
    v_mov_b32 v63, 0
    s_waitcnt vmcnt(4)
mega_kernel_ch_f2_tc0:
    v_max_u32 v40, v96, v98
    v_cmp_eq_u32 vcc, -1, v40
    s_cbranch_vccnz mega_kernel_ch_f2_tc0_f
mega_kernel_ch_f2_tc0_ok:
    ds_write_b128 v2, v[96:99] offset:8192
    v_smfmac_f32_16x16x64_bf16 v[48:51], v[96:99], a[64:71], v3
    v_smfmac_f32_16x16x64_bf16 v[52:55], v[96:99], a[192:199], v3
    v_smfmac_f32_16x16x64_bf16 v[60:63], v[96:99], v[24:31], v3
    s_waitcnt vmcnt(3)
mega_kernel_ch_f2_tc1:
    v_max_u32 v40, v100, v102
    v_cmp_eq_u32 vcc, -1, v40
    s_cbranch_vccnz mega_kernel_ch_f2_tc1_f
mega_kernel_ch_f2_tc1_ok:
    ds_write_b128 v2, v[100:103] offset:9216
    v_smfmac_f32_16x16x64_bf16 v[48:51], v[100:103], a[72:79], v3
    v_smfmac_f32_16x16x64_bf16 v[52:55], v[100:103], a[200:207], v3
    v_smfmac_f32_16x16x64_bf16 v[60:63], v[100:103], v[120:127], v3
    s_waitcnt vmcnt(2)
mega_kernel_ch_f2_tc2:
    v_max_u32 v40, v104, v106
    v_cmp_eq_u32 vcc, -1, v40
    s_cbranch_vccnz mega_kernel_ch_f2_tc2_f
mega_kernel_ch_f2_tc2_ok:
    ds_write_b128 v2, v[104:107] offset:10240
    v_smfmac_f32_16x16x64_bf16 v[48:51], v[104:107], a[80:87], v3
    v_smfmac_f32_16x16x64_bf16 v[52:55], v[104:107], a[208:215], v3
    s_waitcnt vmcnt(1)
mega_kernel_ch_f2_tc3:
    v_max_u32 v40, v108, v110
    v_cmp_eq_u32 vcc, -1, v40
    s_cbranch_vccnz mega_kernel_ch_f2_tc3_f
mega_kernel_ch_f2_tc3_ok:
    ds_write_b128 v2, v[108:111] offset:11264
    v_smfmac_f32_16x16x64_bf16 v[48:51], v[108:111], a[88:95], v3
    v_smfmac_f32_16x16x64_bf16 v[52:55], v[108:111], a[216:223], v3
    s_waitcnt lgkmcnt(0)
    s_barrier
    ds_read_b128 v[64:67], v2 offset:12288
    ds_read_b128 v[68:71], v2 offset:0
    ds_read_b128 v[72:75], v2 offset:4096
    ds_read_b128 v[76:79], v2 offset:13312
    ds_read_b128 v[80:83], v2 offset:1024
    ds_read_b128 v[84:87], v2 offset:5120
    ds_read_b128 v[88:91], v2 offset:14336
    ds_read_b128 v[92:95], v2 offset:2048
    ds_read_b128 v[112:115], v2 offset:6144
    ds_read_b128 v[116:119], v2 offset:15360
    ds_read_b128 v[120:123], v2 offset:3072
    ds_read_b128 v[124:127], v2 offset:7168
    buffer_store_dwordx4 v[56:59], v18, s[20:23], s42 offen
    s_cmp_eq_u32 s39, 0
    s_cbranch_scc1 mega_kernel_ch_f2_nocp
    s_mov_b64 exec, 1
    buffer_store_dword v56, off, s[16:19], s33 sc1
    s_mov_b64 exec, -1
mega_kernel_ch_f2_nocp:
    s_waitcnt lgkmcnt(11)
    s_nop 2
    v_smfmac_f32_16x16x64_bf16 v[48:51], v[64:67], a[96:103], v3
    v_smfmac_f32_16x16x64_bf16 v[52:55], v[64:67], a[224:231], v3
    s_waitcnt lgkmcnt(10)
    v_smfmac_f32_16x16x64_bf16 v[48:51], v[68:71], a[0:7], v3
    v_smfmac_f32_16x16x64_bf16 v[52:55], v[68:71], a[128:135], v3
    s_waitcnt lgkmcnt(9)
    v_smfmac_f32_16x16x64_bf16 v[48:51], v[72:75], a[32:39], v3
    v_smfmac_f32_16x16x64_bf16 v[52:55], v[72:75], a[160:167], v3
    s_waitcnt lgkmcnt(8)
    v_smfmac_f32_16x16x64_bf16 v[48:51], v[76:79], a[104:111], v3
    v_smfmac_f32_16x16x64_bf16 v[52:55], v[76:79], a[232:239], v3
    s_waitcnt lgkmcnt(7)
    v_smfmac_f32_16x16x64_bf16 v[48:51], v[80:83], a[8:15], v3
    v_smfmac_f32_16x16x64_bf16 v[52:55], v[80:83], a[136:143], v3
    s_waitcnt lgkmcnt(6)
    v_smfmac_f32_16x16x64_bf16 v[48:51], v[84:87], a[40:47], v3
    v_smfmac_f32_16x16x64_bf16 v[52:55], v[84:87], a[168:175], v3
    s_waitcnt lgkmcnt(5)
    v_smfmac_f32_16x16x64_bf16 v[48:51], v[88:91], a[112:119], v3
    v_smfmac_f32_16x16x64_bf16 v[52:55], v[88:91], a[240:247], v3
    s_waitcnt lgkmcnt(4)
    v_smfmac_f32_16x16x64_bf16 v[48:51], v[92:95], a[16:23], v3
    v_smfmac_f32_16x16x64_bf16 v[52:55], v[92:95], a[144:151], v3
    s_waitcnt lgkmcnt(3)
    v_smfmac_f32_16x16x64_bf16 v[48:51], v[112:115], a[48:55], v3
    v_smfmac_f32_16x16x64_bf16 v[52:55], v[112:115], a[176:183], v3
    s_waitcnt lgkmcnt(2)
    v_smfmac_f32_16x16x64_bf16 v[48:51], v[116:119], a[120:127], v3
    v_smfmac_f32_16x16x64_bf16 v[52:55], v[116:119], a[248:255], v3
    s_waitcnt lgkmcnt(1)
    v_smfmac_f32_16x16x64_bf16 v[48:51], v[120:123], a[24:31], v3
    v_smfmac_f32_16x16x64_bf16 v[52:55], v[120:123], a[152:159], v3
    s_waitcnt lgkmcnt(0)
    v_smfmac_f32_16x16x64_bf16 v[48:51], v[124:127], a[56:63], v3
    v_smfmac_f32_16x16x64_bf16 v[52:55], v[124:127], a[184:191], v3
    s_nop 7
    v_permlane32_swap_b32 v48, v52
    v_permlane32_swap_b32 v49, v53
    v_permlane32_swap_b32 v50, v54
    v_permlane32_swap_b32 v51, v55
    v_add_f32 v48, v48, v52
    v_add_f32 v49, v49, v53
    v_add_f32 v50, v50, v54
    v_add_f32 v51, v51, v55
    v_cvt_pk_bf16_f32 v52, v48, v49
    v_cvt_pk_bf16_f32 v53, v50, v51
    ds_write_b64 v6, v[52:53]
    s_waitcnt lgkmcnt(0)
    s_barrier
    ds_read_b64_tr_b16 v[48:49], v7 offset:0
    ds_read_b64_tr_b16 v[50:51], v7 offset:256
    ds_read_b64_tr_b16 v[52:53], v7 offset:1024
    ds_read_b64_tr_b16 v[54:55], v7 offset:1280
    ds_read_b128 v[24:27], v12 offset:16384
    ds_read_b128 v[28:31], v12 offset:17408
    ds_read_b128 v[96:99], v12 offset:24576
    ds_read_b128 v[100:103], v12 offset:25600
    s_waitcnt lgkmcnt(4)
    v_mfma_f32_16x16x32_bf16 v[40:43], v[48:51], v[48:51], 0
    v_mfma_f32_16x16x32_bf16 v[40:43], v[52:55], v[52:55], v[40:43]
    s_nop 7
    buffer_store_dwordx4 v[40:43], v8, s[20:23], s40 offen
    s_waitcnt lgkmcnt(2)
    v_smfmac_f32_16x16x64_bf16 v[60:63], v[104:107], v[24:31], v3
    ds_read_b128 v[24:27], v12 offset:32768
    ds_read_b128 v[28:31], v12 offset:33792
    s_waitcnt lgkmcnt(2)
    v_smfmac_f32_16x16x64_bf16 v[60:63], v[108:111], v[96:103], v3
    ds_read_b128 v[96:99], v11 offset:0
    ds_read_b128 v[100:103], v11 offset:1024
    ds_read_b128 v[104:107], v11 offset:32768
    ds_read_b128 v[108:111], v11 offset:33792
    s_waitcnt lgkmcnt(4)
    v_smfmac_f32_16x16x64_bf16 v[60:63], v[64:67], v[24:31], v3
    ds_read_b128 v[24:27], v12 offset:40960
    ds_read_b128 v[28:31], v12 offset:41984
    s_waitcnt lgkmcnt(4)
    v_smfmac_f32_16x16x64_bf16 v[60:63], v[68:71], v[96:103], v3
    ds_read_b128 v[96:99], v11 offset:8192
    ds_read_b128 v[100:103], v11 offset:9216
    ds_read_b128 v[64:67], v11 offset:40960
    ds_read_b128 v[68:71], v11 offset:41984
    s_waitcnt lgkmcnt(6)
    v_smfmac_f32_16x16x64_bf16 v[60:63], v[72:75], v[104:111], v3
    ds_read_b128 v[104:107], v12 offset:49152
    ds_read_b128 v[108:111], v12 offset:50176
    s_waitcnt lgkmcnt(6)
    v_smfmac_f32_16x16x64_bf16 v[60:63], v[76:79], v[24:31], v3
    ds_read_b128 v[24:27], v11 offset:16384
    ds_read_b128 v[28:31], v11 offset:17408
    ds_read_b128 v[72:75], v11 offset:49152
    ds_read_b128 v[76:79], v11 offset:50176
    s_waitcnt lgkmcnt(8)
    v_smfmac_f32_16x16x64_bf16 v[60:63], v[80:83], v[96:103], v3
    ds_read_b128 v[96:99], v12 offset:57344
    ds_read_b128 v[100:103], v12 offset:58368
    s_waitcnt lgkmcnt(8)
    v_smfmac_f32_16x16x64_bf16 v[60:63], v[84:87], v[64:71], v3
    ds_read_b128 v[64:67], v11 offset:24576
    ds_read_b128 v[68:71], v11 offset:25600
    buffer_load_dwordx4 v[32:35], v9, s[20:23], s40 offen sc1
    buffer_load_dwordx4 v[36:39], v9, s[20:23], s40 offen offset:2048 sc1
    buffer_load_dwordx2 v[40:41], v10, s[20:23], s40 offen sc1
    buffer_load_dwordx2 v[42:43], v10, s[20:23], s40 offen offset:2048 sc1
    s_waitcnt lgkmcnt(8)
    v_smfmac_f32_16x16x64_bf16 v[60:63], v[88:91], v[104:111], v3
    ds_read_b128 v[80:83], v11 offset:57344
    ds_read_b128 v[84:87], v11 offset:58368
    s_waitcnt lgkmcnt(8)
    v_smfmac_f32_16x16x64_bf16 v[60:63], v[92:95], v[24:31], v3
    s_waitcnt lgkmcnt(6)
    v_smfmac_f32_16x16x64_bf16 v[60:63], v[112:115], v[72:79], v3
    s_waitcnt lgkmcnt(4)
    v_smfmac_f32_16x16x64_bf16 v[60:63], v[116:119], v[96:103], v3
    s_waitcnt lgkmcnt(2)
    v_smfmac_f32_16x16x64_bf16 v[60:63], v[120:123], v[64:71], v3
    s_waitcnt lgkmcnt(0)
    v_smfmac_f32_16x16x64_bf16 v[60:63], v[124:127], v[80:87], v3
    s_nop 7
    v_mov_b32 v24, v60
    v_mov_b32 v25, v61
    v_mov_b32 v26, v62
    v_mov_b32 v27, v63
    v_permlane32_swap_b32 v24, v60
    v_permlane32_swap_b32 v25, v61
    v_permlane32_swap_b32 v26, v62
    v_permlane32_swap_b32 v27, v63
    v_add_f32 v24, v24, v60
    v_add_f32 v25, v25, v61
    v_add_f32 v26, v26, v62
    v_add_f32 v27, v27, v63
    v_cvt_pk_bf16_f32 v22, v24, v25
    v_cvt_pk_bf16_f32 v23, v26, v27
    s_cmp_eq_u32 s39, 63
    s_cbranch_scc1 mega_kernel_ch_f2_last
    s_cmp_ge_u32 s39, 60
    s_cbranch_scc1 mega_kernel_ch_f2_e1
mega_kernel_ch_f2_e1r:
    s_waitcnt vmcnt(0)
mega_kernel_ch_f2_sp_c:
    v_max3_u32 v28, v32, v34, v36
    v_max3_u32 v28, v28, v38, v40
    v_max_u32 v28, v28, v42
    v_cmp_eq_u32 vcc, -1, v28
    s_cbranch_vccnz mega_kernel_ch_f2_sp_f
mega_kernel_ch_f2_sp_ok:
    v_add_f32 v64, v32, v36
    v_add_f32 v65, v33, v37
    v_add_f32 v66, v34, v38
    v_add_f32 v67, v35, v39
    v_add_f32 v68, v40, v42
    v_add_f32 v69, v41, v43
    v_max3_f32 v70, v64, v65, v66
    v_max3_f32 v70, v70, v67, v68
    v_max_f32 v70, v70, v69
    s_nop 1
    v_max_f32_dpp v70, v70, v70 row_ror:8 row_mask:0xf bank_mask:0xf
    v_mov_b32 v71, v70
    s_nop 1
    v_permlane16_swap_b32 v71, v70
    v_max_f32 v70, v70, v71
    v_mov_b32 v71, v70
    s_nop 1
    v_permlane32_swap_b32 v71, v70
    v_max_f32 v70, v70, v71
    v_mul_f32 v70, s52, v70
    v_fma_f32 v64, v64, s52, -v70
    v_fma_f32 v65, v65, s52, -v70
    v_fma_f32 v66, v66, s52, -v70
    v_fma_f32 v67, v67, s52, -v70
    v_fma_f32 v68, v68, s52, -v70
    v_fma_f32 v69, v69, s52, -v70
    v_exp_f32 v64, v64
    v_exp_f32 v65, v65
    v_exp_f32 v66, v66
    v_exp_f32 v67, v67
    v_exp_f32 v68, v68
    v_exp_f32 v69, v69
    v_cvt_pk_bf16_f32 v72, v64, v65
    v_cvt_pk_bf16_f32 v73, v66, v67
    v_cvt_pk_bf16_f32 v76, v68, v69
    v_mov_b32_dpp v74, v72 row_ror:8 row_mask:0xf bank_mask:0xf
    v_mov_b32_dpp v75, v73 row_ror:8 row_mask:0xf bank_mask:0xf
    v_mov_b32_dpp v77, v76 row_ror:8 row_mask:0xf bank_mask:0xf
    s_nop 0
    v_mfma_f32_16x16x32_bf16 v[80:83], v[44:47], v[72:75], 0
    s_nop 5
    v_mfma_f32_16x16x16bf16_1k v[80:83], v[22:23], v[76:77], v[80:83]
    v_add_f32 v70, v64, v65
    v_add_f32 v71, v66, v67
    v_add_f32 v70, v70, v68
    v_add_f32 v71, v71, v69
    v_add_f32 v70, v70, v71
    s_nop 1
    v_add_f32_dpp v70, v70, v70 row_ror:8 row_mask:0xf bank_mask:0xf
    v_mov_b32 v71, v70
    s_nop 1
    v_permlane16_swap_b32 v71, v70
    v_add_f32 v70, v70, v71
    v_mov_b32 v71, v70
    s_nop 1
    v_permlane32_swap_b32 v71, v70
    v_add_f32 v70, v70, v71
    v_rcp_f32 v70, v70
    s_nop 0
    v_mul_f32 v80, v80, v70
    v_mul_f32 v81, v81, v70
    v_mul_f32 v82, v82, v70
    v_mul_f32 v83, v83, v70
    v_cvt_pk_bf16_f32 v84, v80, v81
    v_cvt_pk_bf16_f32 v85, v82, v83
    buffer_store_dwordx2 v[84:85], v13, s[20:23], s40 offen
    ds_read_b128 v[24:27], v12 offset:0
    ds_read_b128 v[28:31], v12 offset:1024
    ds_read_b128 v[120:123], v12 offset:8192
    ds_read_b128 v[124:127], v12 offset:9216
    s_add_u32 s44, s41, s92
    s_add_u32 s45, s41, s93
    s_add_u32 s47, s47, 262144
    s_xor_b32 s42, s41, 524288
    s_add_u32 s56, s39, 2
    s_lshr_b32 s56, s56, 2
    s_lshl_b32 s56, s56, 10
    s_add_u32 s32, s56, s91
    s_lshl_b32 s56, s39, 13
    s_add_u32 s33, s56, s94
    v_mov_b32 v32, 0
    v_mov_b32 v33, 0
    v_mov_b32 v34, 0
    v_mov_b32 v35, 0
    v_mov_b32 v36, 0
    v_mov_b32 v37, 0
    v_mov_b32 v38, 0
    v_mov_b32 v39, 0
    v_mov_b32 v112, 0
    v_mov_b32 v113, 0
    v_mov_b32 v114, 0
    v_mov_b32 v115, 0
    v_mov_b32 v116, 0
    v_mov_b32 v117, 0
    v_mov_b32 v118, 0
    v_mov_b32 v119, 0
    s_sleep 6
    buffer_load_dwordx4 v[96:99], v14, s[20:23], s40 offen offset:0 sc1
    buffer_load_dwordx4 v[100:103], v14, s[20:23], s40 offen offset:1024 sc1
    buffer_load_dwordx4 v[104:107], v14, s[20:23], s40 offen offset:2048 sc1
    buffer_load_dwordx4 v[108:111], v14, s[20:23], s40 offen offset:3072 sc1
    s_waitcnt vmcnt(3)
mega_kernel_ch_f2_oc0:
    v_max_u32 v40, v96, v98
    v_cmp_eq_u32 vcc, -1, v40
    s_cbranch_vccnz mega_kernel_ch_f2_oc0_f
mega_kernel_ch_f2_oc0_ok:
    v_smfmac_f32_16x16x64_bf16 v[32:35], v[96:99], v[128:135], v3
    v_smfmac_f32_16x16x64_bf16 v[36:39], v[96:99], v[136:143], v3
    v_smfmac_f32_16x16x64_bf16 v[112:115], v[96:99], v[144:151], v3
    v_smfmac_f32_16x16x64_bf16 v[116:119], v[96:99], v[152:159], v3
    s_waitcnt vmcnt(2)
mega_kernel_ch_f2_oc1:
    v_max_u32 v40, v100, v102
    v_cmp_eq_u32 vcc, -1, v40
    s_cbranch_vccnz mega_kernel_ch_f2_oc1_f
mega_kernel_ch_f2_oc1_ok:
    v_smfmac_f32_16x16x64_bf16 v[32:35], v[100:103], v[160:167], v3
    v_smfmac_f32_16x16x64_bf16 v[36:39], v[100:103], v[168:175], v3
    v_smfmac_f32_16x16x64_bf16 v[112:115], v[100:103], v[176:183], v3
    v_smfmac_f32_16x16x64_bf16 v[116:119], v[100:103], v[184:191], v3
    s_waitcnt vmcnt(1)
mega_kernel_ch_f2_oc2:
    v_max_u32 v40, v104, v106
    v_cmp_eq_u32 vcc, -1, v40
    s_cbranch_vccnz mega_kernel_ch_f2_oc2_f
mega_kernel_ch_f2_oc2_ok:
    v_smfmac_f32_16x16x64_bf16 v[32:35], v[104:107], v[192:199], v3
    v_smfmac_f32_16x16x64_bf16 v[36:39], v[104:107], v[200:207], v3
    v_smfmac_f32_16x16x64_bf16 v[112:115], v[104:107], v[208:215], v3
    v_smfmac_f32_16x16x64_bf16 v[116:119], v[104:107], v[216:223], v3
    s_waitcnt vmcnt(0)
mega_kernel_ch_f2_oc3:
    v_max_u32 v40, v108, v110
    v_cmp_eq_u32 vcc, -1, v40
    s_cbranch_vccnz mega_kernel_ch_f2_oc3_f
mega_kernel_ch_f2_oc3_ok:
    v_smfmac_f32_16x16x64_bf16 v[32:35], v[108:111], v[224:231], v3
    v_smfmac_f32_16x16x64_bf16 v[36:39], v[108:111], v[232:239], v3
    v_smfmac_f32_16x16x64_bf16 v[112:115], v[108:111], v[240:247], v3
    v_smfmac_f32_16x16x64_bf16 v[116:119], v[108:111], v[248:255], v3
    s_nop 5
    v_permlane32_swap_b32 v32, v36
    v_permlane32_swap_b32 v33, v37
    v_permlane32_swap_b32 v34, v38
    v_permlane32_swap_b32 v35, v39
    v_add_f32 v32, v32, v36
    v_add_f32 v33, v33, v37
    v_add_f32 v34, v34, v38
    v_add_f32 v35, v35, v39
    ds_write_b128 v15, v[32:35]
    v_permlane32_swap_b32 v112, v116
    v_permlane32_swap_b32 v113, v117
    v_permlane32_swap_b32 v114, v118
    v_permlane32_swap_b32 v115, v119
    v_add_f32 v112, v112, v116
    v_add_f32 v113, v113, v117
    v_add_f32 v114, v114, v118
    v_add_f32 v115, v115, v119
    ds_write_b128 v15, v[112:115] offset:1024
    s_waitcnt lgkmcnt(0)
    s_barrier
    s_cmp_ge_u32 s39, 60
    s_cbranch_scc1 mega_kernel_ch_f2_e2
mega_kernel_ch_f2_e2r:
    s_bfe_u32 s59, s39, 0x10001
    ds_read_b128 v[96:99], v16 offset:0
    ds_read_b128 v[100:103], v16 offset:2048
    ds_read_b128 v[104:107], v16 offset:4096
    ds_read_b128 v[108:111], v16 offset:6144
    buffer_store_dwordx2 v[22:23], v20, s[28:31], s48 offen sc1
    v_xor_b32 v116, 139264, v19
    s_waitcnt lgkmcnt(2)
    v_add_f32 v96, v96, v100
    v_add_f32 v97, v97, v101
    v_add_f32 v98, v98, v102
    v_add_f32 v99, v99, v103
    s_waitcnt lgkmcnt(0)
    v_add_f32 v104, v104, v108
    v_add_f32 v105, v105, v109
    v_add_f32 v106, v106, v110
    v_add_f32 v107, v107, v111
    v_add_f32 v96, v96, v104
    v_add_f32 v97, v97, v105
    v_add_f32 v98, v98, v106
    v_add_f32 v99, v99, v107
    v_bfi_b32 v96, 1, s59, v96
    v_bfi_b32 v98, 1, s59, v98
    buffer_store_dwordx4 v[96:99], v19, s[20:23], s49 offen sc1
    buffer_store_dwordx4 v[96:99], v116, s[20:23], s49 offen
    s_sleep 6
    buffer_load_dwordx4 v[72:75], v1, s[20:23], s49 offen sc1
    s_sleep 3
    buffer_load_dwordx4 v[76:79], v1, s[20:23], s49 offen sc1
    s_sleep 3
    buffer_load_dwordx4 v[80:83], v1, s[20:23], s49 offen sc1
    s_waitcnt vmcnt(2)
    v_bitop3_b32 v112, v72, v74, s59 bitop3:0x7e
    v_and_b32 v112, 1, v112
    v_cmp_ne_u32 vcc, 0, v112
    s_cbranch_vccnz mega_kernel_ch_f2_xf0
    v_permlane32_swap_b32 v72, v73
    v_permlane32_swap_b32 v74, v75
    v_add_f32 v114, v72, v73
    v_add_f32 v115, v74, v75
mega_kernel_ch_f2_xok:
    s_nop 1
    v_permlane16_swap_b32 v114, v115
    v_add_f32 v114, v114, v115
    s_nop 1
    v_mov_b32_dpp v115, v114 quad_perm:[1,1,3,3] row_mask:0xf bank_mask:0xf
    v_cvt_pk_bf16_f32 v112, v114, v115
    s_nop 1
    v_mov_b32_dpp v113, v112 quad_perm:[2,2,2,2] row_mask:0xf bank_mask:0xf
    buffer_store_dwordx2 v[112:113], v17, s[20:23], s41 offen
    s_branch mega_kernel_ch_f2_top
mega_kernel_ch_f2_last:
    buffer_store_dwordx2 v[22:23], v20, s[28:31], s48 offen sc1
    s_waitcnt vmcnt(0)
    s_barrier
    s_add_u32 s33, s33, 8192
    s_mov_b64 exec, 1
    buffer_store_dword v56, off, s[16:19], s33 sc1
    s_mov_b64 exec, -1
    s_waitcnt vmcnt(0)
    s_branch mega_kernel_ch_fin
mega_kernel_ch_f2_tc0_f:
    s_cmp_eq_u32 s43, 0
    s_cbranch_scc1 mega_kernel_ch_f2_tc0_ok
    s_mov_b32 s90, 0
    s_branch mega_kernel_ch_f2_tretry
mega_kernel_ch_f2_tc1_f:
    s_cmp_eq_u32 s43, 0
    s_cbranch_scc1 mega_kernel_ch_f2_tc1_ok
    s_mov_b32 s90, 1
    s_branch mega_kernel_ch_f2_tretry
mega_kernel_ch_f2_tc2_f:
    s_cmp_eq_u32 s43, 0
    s_cbranch_scc1 mega_kernel_ch_f2_tc2_ok
    s_mov_b32 s90, 2
    s_branch mega_kernel_ch_f2_tretry
mega_kernel_ch_f2_tc3_f:
    s_cmp_eq_u32 s43, 0
    s_cbranch_scc1 mega_kernel_ch_f2_tc3_ok
    s_mov_b32 s90, 3
    s_branch mega_kernel_ch_f2_tretry
mega_kernel_ch_f2_tretry:
    s_sub_u32 s43, s43, 1
    s_waitcnt vmcnt(0)
    v_max_u32 v40, v96, v98
    v_cmp_eq_u32 vcc, -1, v40
    s_cbranch_vccz mega_kernel_ch_f2_tr_L0
    buffer_load_dwordx4 v[96:99], v2, s[20:23], s44 offen offset:0 sc1
mega_kernel_ch_f2_tr_L0:
    v_max_u32 v40, v100, v102
    v_cmp_eq_u32 vcc, -1, v40
    s_cbranch_vccz mega_kernel_ch_f2_tr_L1
    buffer_load_dwordx4 v[100:103], v2, s[20:23], s44 offen offset:1024 sc1
mega_kernel_ch_f2_tr_L1:
    v_max_u32 v40, v104, v106
    v_cmp_eq_u32 vcc, -1, v40
    s_cbranch_vccz mega_kernel_ch_f2_tr_L2
    buffer_load_dwordx4 v[104:107], v2, s[20:23], s44 offen offset:2048 sc1
mega_kernel_ch_f2_tr_L2:
    v_max_u32 v40, v108, v110
    v_cmp_eq_u32 vcc, -1, v40
    s_cbranch_vccz mega_kernel_ch_f2_tr_L3
    buffer_load_dwordx4 v[108:111], v2, s[20:23], s44 offen offset:3072 sc1
mega_kernel_ch_f2_tr_L3:
    s_waitcnt vmcnt(0)
    s_cmp_eq_u32 s90, 0
    s_cbranch_scc1 mega_kernel_ch_f2_tc0
    s_cmp_eq_u32 s90, 1
    s_cbranch_scc1 mega_kernel_ch_f2_tc1
    s_cmp_eq_u32 s90, 2
    s_cbranch_scc1 mega_kernel_ch_f2_tc2
    s_branch mega_kernel_ch_f2_tc3
mega_kernel_ch_f2_e1:
    buffer_store_dwordx2 v[22:23], v20, s[28:31], s48 offen sc1
    s_branch mega_kernel_ch_f2_e1r
mega_kernel_ch_f2_sp_f:
    s_cmp_eq_u32 s43, 0
    s_cbranch_scc1 mega_kernel_ch_f2_sp_ok
    s_sub_u32 s43, s43, 1
    buffer_load_dwordx4 v[32:35], v9, s[20:23], s40 offen sc1
    buffer_load_dwordx4 v[36:39], v9, s[20:23], s40 offen offset:2048 sc1
    buffer_load_dwordx2 v[40:41], v10, s[20:23], s40 offen sc1
    buffer_load_dwordx2 v[42:43], v10, s[20:23], s40 offen offset:2048 sc1
    s_waitcnt vmcnt(0)
    s_branch mega_kernel_ch_f2_sp_c
mega_kernel_ch_f2_oc0_f:
    s_cmp_eq_u32 s43, 0
    s_cbranch_scc1 mega_kernel_ch_f2_oc0_ok
    s_mov_b32 s90, 0
    s_branch mega_kernel_ch_f2_oretry
mega_kernel_ch_f2_oc1_f:
    s_cmp_eq_u32 s43, 0
    s_cbranch_scc1 mega_kernel_ch_f2_oc1_ok
    s_mov_b32 s90, 1
    s_branch mega_kernel_ch_f2_oretry
mega_kernel_ch_f2_oc2_f:
    s_cmp_eq_u32 s43, 0
    s_cbranch_scc1 mega_kernel_ch_f2_oc2_ok
    s_mov_b32 s90, 2
    s_branch mega_kernel_ch_f2_oretry
mega_kernel_ch_f2_oc3_f:
    s_cmp_eq_u32 s43, 0
    s_cbranch_scc1 mega_kernel_ch_f2_oc3_ok
    s_mov_b32 s90, 3
    s_branch mega_kernel_ch_f2_oretry
mega_kernel_ch_f2_oretry:
    s_sub_u32 s43, s43, 1
    s_waitcnt vmcnt(0)
    v_max_u32 v40, v96, v98
    v_cmp_eq_u32 vcc, -1, v40
    s_cbranch_vccz mega_kernel_ch_f2_or_0
    buffer_load_dwordx4 v[96:99], v14, s[20:23], s40 offen offset:0 sc1
mega_kernel_ch_f2_or_0:
    v_max_u32 v40, v100, v102
    v_cmp_eq_u32 vcc, -1, v40
    s_cbranch_vccz mega_kernel_ch_f2_or_1
    buffer_load_dwordx4 v[100:103], v14, s[20:23], s40 offen offset:1024 sc1
mega_kernel_ch_f2_or_1:
    v_max_u32 v40, v104, v106
    v_cmp_eq_u32 vcc, -1, v40
    s_cbranch_vccz mega_kernel_ch_f2_or_2
    buffer_load_dwordx4 v[104:107], v14, s[20:23], s40 offen offset:2048 sc1
mega_kernel_ch_f2_or_2:
    v_max_u32 v40, v108, v110
    v_cmp_eq_u32 vcc, -1, v40
    s_cbranch_vccz mega_kernel_ch_f2_or_3
    buffer_load_dwordx4 v[108:111], v14, s[20:23], s40 offen offset:3072 sc1
mega_kernel_ch_f2_or_3:
    s_waitcnt vmcnt(0)
    s_cmp_eq_u32 s90, 0
    s_cbranch_scc1 mega_kernel_ch_f2_oc0
    s_cmp_eq_u32 s90, 1
    s_cbranch_scc1 mega_kernel_ch_f2_oc1
    s_cmp_eq_u32 s90, 2
    s_cbranch_scc1 mega_kernel_ch_f2_oc2
    s_branch mega_kernel_ch_f2_oc3
mega_kernel_ch_f2_e2:
    s_mov_b64 exec, 1
    buffer_store_dword v56, off, s[16:19], s33 sc1
    s_mov_b64 exec, -1
    s_branch mega_kernel_ch_f2_e2r
mega_kernel_ch_f2_xf0:
    s_cmp_eq_u32 s43, 0
    s_cbranch_scc1 mega_kernel_ch_f2_xok
    s_sub_u32 s43, s43, 1
    buffer_load_dwordx4 v[72:75], v1, s[20:23], s49 offen sc1
    s_waitcnt vmcnt(2)
    v_bitop3_b32 v112, v76, v78, s59 bitop3:0x7e
    v_and_b32 v112, 1, v112
    v_cmp_ne_u32 vcc, 0, v112
    s_cbranch_vccnz mega_kernel_ch_f2_xg1
    v_permlane32_swap_b32 v76, v77
    v_permlane32_swap_b32 v78, v79
    v_add_f32 v114, v76, v77
    v_add_f32 v115, v78, v79
    s_branch mega_kernel_ch_f2_xok
mega_kernel_ch_f2_xg1:
    buffer_load_dwordx4 v[76:79], v1, s[20:23], s49 offen sc1
    s_waitcnt vmcnt(2)
    v_bitop3_b32 v112, v80, v82, s59 bitop3:0x7e
    v_and_b32 v112, 1, v112
    v_cmp_ne_u32 vcc, 0, v112
    s_cbranch_vccnz mega_kernel_ch_f2_xg2
    v_permlane32_swap_b32 v80, v81
    v_permlane32_swap_b32 v82, v83
    v_add_f32 v114, v80, v81
    v_add_f32 v115, v82, v83
    s_branch mega_kernel_ch_f2_xok
mega_kernel_ch_f2_xg2:
    buffer_load_dwordx4 v[80:83], v1, s[20:23], s49 offen sc1
    s_waitcnt vmcnt(2)
    v_bitop3_b32 v112, v72, v74, s59 bitop3:0x7e
    v_and_b32 v112, 1, v112
    v_cmp_ne_u32 vcc, 0, v112
    s_cbranch_vccnz mega_kernel_ch_f2_xf0
    v_permlane32_swap_b32 v72, v73
    v_permlane32_swap_b32 v74, v75
    v_add_f32 v114, v72, v73
    v_add_f32 v115, v74, v75
    s_branch mega_kernel_ch_f2_xok
mega_kernel_ch_f3_top:
    s_sleep 4
    buffer_load_dwordx4 v[96:99], v2, s[20:23], s44 offen offset:0 sc1
    buffer_load_dwordx4 v[100:103], v2, s[20:23], s44 offen offset:1024 sc1
    buffer_load_dwordx4 v[104:107], v2, s[20:23], s44 offen offset:2048 sc1
    buffer_load_dwordx4 v[108:111], v2, s[20:23], s44 offen offset:3072 sc1
    buffer_load_dwordx4 v[44:47], v5, s[24:27], s47 offen sc1
    s_add_u32 s39, s39, 1
    s_mov_b32 s40, s41
    s_add_u32 s46, s40, 4096
    s_add_u32 s41, s40, 262144
    s_and_b32 s41, s41, 1048575
    s_and_b32 s49, s41, 262144
    s_add_u32 s49, s49, 1048576
    s_add_u32 s48, s48, 65536
    v_mov_b32 v48, 0
    v_mov_b32 v49, 0
    v_mov_b32 v50, 0
    v_mov_b32 v51, 0
    v_mov_b32 v52, 0
    v_mov_b32 v53, 0
    v_mov_b32 v54, 0
    v_mov_b32 v55, 0
    v_mov_b32 v60, 0
    v_mov_b32 v61, 0
    v_mov_b32 v62, 0
    v_mov_b32 v63, 0
    s_waitcnt vmcnt(4)
mega_kernel_ch_f3_tc0:
    v_max_u32 v40, v96, v98
    v_cmp_eq_u32 vcc, -1, v40
    s_cbranch_vccnz mega_kernel_ch_f3_tc0_f
mega_kernel_ch_f3_tc0_ok:
    ds_write_b128 v2, v[96:99] offset:12288
    v_smfmac_f32_16x16x64_bf16 v[48:51], v[96:99], a[96:103], v3
    v_smfmac_f32_16x16x64_bf16 v[52:55], v[96:99], a[224:231], v3
    v_smfmac_f32_16x16x64_bf16 v[60:63], v[96:99], v[24:31], v3
    s_waitcnt vmcnt(3)
mega_kernel_ch_f3_tc1:
    v_max_u32 v40, v100, v102
    v_cmp_eq_u32 vcc, -1, v40
    s_cbranch_vccnz mega_kernel_ch_f3_tc1_f
mega_kernel_ch_f3_tc1_ok:
    ds_write_b128 v2, v[100:103] offset:13312
    v_smfmac_f32_16x16x64_bf16 v[48:51], v[100:103], a[104:111], v3
    v_smfmac_f32_16x16x64_bf16 v[52:55], v[100:103], a[232:239], v3
    v_smfmac_f32_16x16x64_bf16 v[60:63], v[100:103], v[120:127], v3
    s_waitcnt vmcnt(2)
mega_kernel_ch_f3_tc2:
    v_max_u32 v40, v104, v106
    v_cmp_eq_u32 vcc, -1, v40
    s_cbranch_vccnz mega_kernel_ch_f3_tc2_f
mega_kernel_ch_f3_tc2_ok:
    ds_write_b128 v2, v[104:107] offset:14336
    v_smfmac_f32_16x16x64_bf16 v[48:51], v[104:107], a[112:119], v3
    v_smfmac_f32_16x16x64_bf16 v[52:55], v[104:107], a[240:247], v3
    s_waitcnt vmcnt(1)
mega_kernel_ch_f3_tc3:
    v_max_u32 v40, v108, v110
    v_cmp_eq_u32 vcc, -1, v40
    s_cbranch_vccnz mega_kernel_ch_f3_tc3_f
mega_kernel_ch_f3_tc3_ok:
    ds_write_b128 v2, v[108:111] offset:15360
    v_smfmac_f32_16x16x64_bf16 v[48:51], v[108:111], a[120:127], v3
    v_smfmac_f32_16x16x64_bf16 v[52:55], v[108:111], a[248:255], v3
    s_waitcnt lgkmcnt(0)
    s_barrier
    ds_read_b128 v[64:67], v2 offset:0
    ds_read_b128 v[68:71], v2 offset:4096
    ds_read_b128 v[72:75], v2 offset:8192
    ds_read_b128 v[76:79], v2 offset:1024
    ds_read_b128 v[80:83], v2 offset:5120
    ds_read_b128 v[84:87], v2 offset:9216
    ds_read_b128 v[88:91], v2 offset:2048
    ds_read_b128 v[92:95], v2 offset:6144
    ds_read_b128 v[112:115], v2 offset:10240
    ds_read_b128 v[116:119], v2 offset:3072
    ds_read_b128 v[120:123], v2 offset:7168
    ds_read_b128 v[124:127], v2 offset:11264
    buffer_store_dwordx4 v[56:59], v18, s[20:23], s42 offen
    s_add_u32 s56, s47, 262144
    buffer_load_dword v0, v21, s[24:27], s56 offen sc1
    buffer_load_dword v0, v8, s[16:19], s32 offen sc1
    s_waitcnt lgkmcnt(11)
    v_smfmac_f32_16x16x64_bf16 v[48:51], v[64:67], a[0:7], v3
    v_smfmac_f32_16x16x64_bf16 v[52:55], v[64:67], a[128:135], v3
    s_waitcnt lgkmcnt(10)
    v_smfmac_f32_16x16x64_bf16 v[48:51], v[68:71], a[32:39], v3
    v_smfmac_f32_16x16x64_bf16 v[52:55], v[68:71], a[160:167], v3
    s_waitcnt lgkmcnt(9)
    v_smfmac_f32_16x16x64_bf16 v[48:51], v[72:75], a[64:71], v3
    v_smfmac_f32_16x16x64_bf16 v[52:55], v[72:75], a[192:199], v3
    s_waitcnt lgkmcnt(8)
    v_smfmac_f32_16x16x64_bf16 v[48:51], v[76:79], a[8:15], v3
    v_smfmac_f32_16x16x64_bf16 v[52:55], v[76:79], a[136:143], v3
    s_waitcnt lgkmcnt(7)
    v_smfmac_f32_16x16x64_bf16 v[48:51], v[80:83], a[40:47], v3
    v_smfmac_f32_16x16x64_bf16 v[52:55], v[80:83], a[168:175], v3
    s_waitcnt lgkmcnt(6)
    v_smfmac_f32_16x16x64_bf16 v[48:51], v[84:87], a[72:79], v3
    v_smfmac_f32_16x16x64_bf16 v[52:55], v[84:87], a[200:207], v3
    s_waitcnt lgkmcnt(5)
    v_smfmac_f32_16x16x64_bf16 v[48:51], v[88:91], a[16:23], v3
    v_smfmac_f32_16x16x64_bf16 v[52:55], v[88:91], a[144:151], v3
    s_waitcnt lgkmcnt(4)
    v_smfmac_f32_16x16x64_bf16 v[48:51], v[92:95], a[48:55], v3
    v_smfmac_f32_16x16x64_bf16 v[52:55], v[92:95], a[176:183], v3
    s_waitcnt lgkmcnt(3)
    v_smfmac_f32_16x16x64_bf16 v[48:51], v[112:115], a[80:87], v3
    v_smfmac_f32_16x16x64_bf16 v[52:55], v[112:115], a[208:215], v3
    s_waitcnt lgkmcnt(2)
    v_smfmac_f32_16x16x64_bf16 v[48:51], v[116:119], a[24:31], v3
    v_smfmac_f32_16x16x64_bf16 v[52:55], v[116:119], a[152:159], v3
    s_waitcnt lgkmcnt(1)
    v_smfmac_f32_16x16x64_bf16 v[48:51], v[120:123], a[56:63], v3
    v_smfmac_f32_16x16x64_bf16 v[52:55], v[120:123], a[184:191], v3
    s_waitcnt lgkmcnt(0)
    v_smfmac_f32_16x16x64_bf16 v[48:51], v[124:127], a[88:95], v3
    v_smfmac_f32_16x16x64_bf16 v[52:55], v[124:127], a[216:223], v3
    s_nop 7
    v_permlane32_swap_b32 v48, v52
    v_permlane32_swap_b32 v49, v53
    v_permlane32_swap_b32 v50, v54
    v_permlane32_swap_b32 v51, v55
    v_add_f32 v48, v48, v52
    v_add_f32 v49, v49, v53
    v_add_f32 v50, v50, v54
    v_add_f32 v51, v51, v55
    v_cvt_pk_bf16_f32 v52, v48, v49
    v_cvt_pk_bf16_f32 v53, v50, v51
    ds_write_b64 v6, v[52:53]
    s_waitcnt lgkmcnt(0)
    s_barrier
    ds_read_b128 v[24:27], v12 offset:49152
    ds_read_b128 v[28:31], v12 offset:50176
    ds_read_b128 v[96:99], v12 offset:57344
    ds_read_b128 v[100:103], v12 offset:58368
    s_waitcnt lgkmcnt(2)
    v_smfmac_f32_16x16x64_bf16 v[60:63], v[104:107], v[24:31], v3
    ds_read_b128 v[24:27], v11 offset:0
    ds_read_b128 v[28:31], v11 offset:1024
    s_waitcnt lgkmcnt(2)
    v_smfmac_f32_16x16x64_bf16 v[60:63], v[108:111], v[96:103], v3
    ds_read_b128 v[96:99], v11 offset:32768
    ds_read_b128 v[100:103], v11 offset:33792
    ds_read_b128 v[104:107], v12 offset:0
    ds_read_b128 v[108:111], v12 offset:1024
    s_waitcnt lgkmcnt(4)
    v_smfmac_f32_16x16x64_bf16 v[60:63], v[64:67], v[24:31], v3
    ds_read_b128 v[24:27], v11 offset:8192
    ds_read_b128 v[28:31], v11 offset:9216
    s_waitcnt lgkmcnt(4)
    v_smfmac_f32_16x16x64_bf16 v[60:63], v[68:71], v[96:103], v3
    ds_read_b128 v[96:99], v11 offset:40960
    ds_read_b128 v[100:103], v11 offset:41984
    ds_read_b128 v[64:67], v12 offset:8192
    ds_read_b128 v[68:71], v12 offset:9216
    s_waitcnt lgkmcnt(6)
    v_smfmac_f32_16x16x64_bf16 v[60:63], v[72:75], v[104:111], v3
    ds_read_b128 v[104:107], v11 offset:16384
    ds_read_b128 v[108:111], v11 offset:17408
    s_waitcnt lgkmcnt(6)
    v_smfmac_f32_16x16x64_bf16 v[60:63], v[76:79], v[24:31], v3
    ds_read_b128 v[24:27], v11 offset:49152
    ds_read_b128 v[28:31], v11 offset:50176
    ds_read_b128 v[72:75], v12 offset:16384
    ds_read_b128 v[76:79], v12 offset:17408
    s_waitcnt lgkmcnt(8)
    v_smfmac_f32_16x16x64_bf16 v[60:63], v[80:83], v[96:103], v3
    ds_read_b128 v[96:99], v11 offset:24576
    ds_read_b128 v[100:103], v11 offset:25600
    s_waitcnt lgkmcnt(8)
    v_smfmac_f32_16x16x64_bf16 v[60:63], v[84:87], v[64:71], v3
    ds_read_b128 v[64:67], v11 offset:57344
    ds_read_b128 v[68:71], v11 offset:58368
    buffer_load_dwordx4 v[32:35], v9, s[20:23], s40 offen sc1
    buffer_load_dwordx4 v[36:39], v9, s[20:23], s40 offen offset:2048 sc1
    buffer_load_dwordx2 v[40:41], v10, s[20:23], s40 offen sc1
    buffer_load_dwordx2 v[42:43], v10, s[20:23], s40 offen offset:2048 sc1
    s_waitcnt lgkmcnt(8)
    v_smfmac_f32_16x16x64_bf16 v[60:63], v[88:91], v[104:111], v3
    ds_read_b128 v[80:83], v12 offset:24576
    ds_read_b128 v[84:87], v12 offset:25600
    s_waitcnt lgkmcnt(8)
    v_smfmac_f32_16x16x64_bf16 v[60:63], v[92:95], v[24:31], v3
    s_waitcnt lgkmcnt(6)
    v_smfmac_f32_16x16x64_bf16 v[60:63], v[112:115], v[72:79], v3
    s_waitcnt lgkmcnt(4)
    v_smfmac_f32_16x16x64_bf16 v[60:63], v[116:119], v[96:103], v3
    s_waitcnt lgkmcnt(2)
    v_smfmac_f32_16x16x64_bf16 v[60:63], v[120:123], v[64:71], v3
    s_waitcnt lgkmcnt(0)
    v_smfmac_f32_16x16x64_bf16 v[60:63], v[124:127], v[80:87], v3
    s_nop 7
    v_mov_b32 v24, v60
    v_mov_b32 v25, v61
    v_mov_b32 v26, v62
    v_mov_b32 v27, v63
    v_permlane32_swap_b32 v24, v60
    v_permlane32_swap_b32 v25, v61
    v_permlane32_swap_b32 v26, v62
    v_permlane32_swap_b32 v27, v63
    v_add_f32 v24, v24, v60
    v_add_f32 v25, v25, v61
    v_add_f32 v26, v26, v62
    v_add_f32 v27, v27, v63
    v_cvt_pk_bf16_f32 v22, v24, v25
    v_cvt_pk_bf16_f32 v23, v26, v27
    s_cmp_eq_u32 s39, 63
    s_cbranch_scc1 mega_kernel_ch_f3_last
    s_cmp_ge_u32 s39, 60
    s_cbranch_scc1 mega_kernel_ch_f3_e1
mega_kernel_ch_f3_e1r:
    s_waitcnt vmcnt(0)
mega_kernel_ch_f3_sp_c:
    v_max3_u32 v28, v32, v34, v36
    v_max3_u32 v28, v28, v38, v40
    v_max_u32 v28, v28, v42
    v_cmp_eq_u32 vcc, -1, v28
    s_cbranch_vccnz mega_kernel_ch_f3_sp_f
mega_kernel_ch_f3_sp_ok:
mega_kernel_ch_f3_tf:
    v_cmp_gt_u32 vcc, 4, v0
    s_cbranch_vccnz mega_kernel_ch_f3_tf_f
mega_kernel_ch_f3_tf_ok:
    v_add_f32 v64, v32, v36
    v_add_f32 v65, v33, v37
    v_add_f32 v66, v34, v38
    v_add_f32 v67, v35, v39
    v_add_f32 v68, v40, v42
    v_add_f32 v69, v41, v43
    v_max3_f32 v70, v64, v65, v66
    v_max3_f32 v70, v70, v67, v68
    v_max_f32 v70, v70, v69
    s_nop 1
    v_max_f32_dpp v70, v70, v70 row_ror:8 row_mask:0xf bank_mask:0xf
    v_mov_b32 v71, v70
    s_nop 1
    v_permlane16_swap_b32 v71, v70
    v_max_f32 v70, v70, v71
    v_mov_b32 v71, v70
    s_nop 1
    v_permlane32_swap_b32 v71, v70
    v_max_f32 v70, v70, v71
    v_mul_f32 v70, s52, v70
    v_fma_f32 v64, v64, s52, -v70
    v_fma_f32 v65, v65, s52, -v70
    v_fma_f32 v66, v66, s52, -v70
    v_fma_f32 v67, v67, s52, -v70
    v_fma_f32 v68, v68, s52, -v70
    v_fma_f32 v69, v69, s52, -v70
    v_exp_f32 v64, v64
    v_exp_f32 v65, v65
    v_exp_f32 v66, v66
    v_exp_f32 v67, v67
    v_exp_f32 v68, v68
    v_exp_f32 v69, v69
    v_cvt_pk_bf16_f32 v72, v64, v65
    v_cvt_pk_bf16_f32 v73, v66, v67
    v_cvt_pk_bf16_f32 v76, v68, v69
    v_mov_b32_dpp v74, v72 row_ror:8 row_mask:0xf bank_mask:0xf
    v_mov_b32_dpp v75, v73 row_ror:8 row_mask:0xf bank_mask:0xf
    v_mov_b32_dpp v77, v76 row_ror:8 row_mask:0xf bank_mask:0xf
    s_nop 0
    v_mfma_f32_16x16x32_bf16 v[80:83], v[44:47], v[72:75], 0
    s_nop 5
    v_mfma_f32_16x16x16bf16_1k v[80:83], v[22:23], v[76:77], v[80:83]
    v_add_f32 v70, v64, v65
    v_add_f32 v71, v66, v67
    v_add_f32 v70, v70, v68
    v_add_f32 v71, v71, v69
    v_add_f32 v70, v70, v71
    s_nop 1
    v_add_f32_dpp v70, v70, v70 row_ror:8 row_mask:0xf bank_mask:0xf
    v_mov_b32 v71, v70
    s_nop 1
    v_permlane16_swap_b32 v71, v70
    v_add_f32 v70, v70, v71
    v_mov_b32 v71, v70
    s_nop 1
    v_permlane32_swap_b32 v71, v70
    v_add_f32 v70, v70, v71
    v_rcp_f32 v70, v70
    s_nop 0
    v_mul_f32 v80, v80, v70
    v_mul_f32 v81, v81, v70
    v_mul_f32 v82, v82, v70
    v_mul_f32 v83, v83, v70
    v_cvt_pk_bf16_f32 v84, v80, v81
    v_cvt_pk_bf16_f32 v85, v82, v83
    buffer_store_dwordx2 v[84:85], v13, s[20:23], s40 offen
    ds_read_b128 v[24:27], v12 offset:32768
    ds_read_b128 v[28:31], v12 offset:33792
    ds_read_b128 v[120:123], v12 offset:40960
    ds_read_b128 v[124:127], v12 offset:41984
    s_add_u32 s44, s41, s92
    s_add_u32 s45, s41, s93
    s_add_u32 s47, s47, 262144
    s_xor_b32 s42, s41, 524288
    s_add_u32 s56, s39, 2
    s_lshr_b32 s56, s56, 2
    s_lshl_b32 s56, s56, 10
    s_add_u32 s32, s56, s91
    s_lshl_b32 s56, s39, 13
    s_add_u32 s33, s56, s94
    v_mov_b32 v32, 0
    v_mov_b32 v33, 0
    v_mov_b32 v34, 0
    v_mov_b32 v35, 0
    v_mov_b32 v36, 0
    v_mov_b32 v37, 0
    v_mov_b32 v38, 0
    v_mov_b32 v39, 0
    v_mov_b32 v112, 0
    v_mov_b32 v113, 0
    v_mov_b32 v114, 0
    v_mov_b32 v115, 0
    v_mov_b32 v116, 0
    v_mov_b32 v117, 0
    v_mov_b32 v118, 0
    v_mov_b32 v119, 0
    s_sleep 6
    buffer_load_dwordx4 v[96:99], v14, s[20:23], s40 offen offset:0 sc1
    buffer_load_dwordx4 v[100:103], v14, s[20:23], s40 offen offset:1024 sc1
    buffer_load_dwordx4 v[104:107], v14, s[20:23], s40 offen offset:2048 sc1
    buffer_load_dwordx4 v[108:111], v14, s[20:23], s40 offen offset:3072 sc1
    ds_read_b64_tr_b16 v[48:49], v7 offset:0
    ds_read_b64_tr_b16 v[50:51], v7 offset:256
    ds_read_b64_tr_b16 v[52:53], v7 offset:1024
    ds_read_b64_tr_b16 v[54:55], v7 offset:1280
    s_waitcnt vmcnt(3)
mega_kernel_ch_f3_oc0:
    v_max_u32 v40, v96, v98
    v_cmp_eq_u32 vcc, -1, v40
    s_cbranch_vccnz mega_kernel_ch_f3_oc0_f
mega_kernel_ch_f3_oc0_ok:
    v_smfmac_f32_16x16x64_bf16 v[32:35], v[96:99], v[128:135], v3
    v_smfmac_f32_16x16x64_bf16 v[36:39], v[96:99], v[136:143], v3
    v_smfmac_f32_16x16x64_bf16 v[112:115], v[96:99], v[144:151], v3
    v_smfmac_f32_16x16x64_bf16 v[116:119], v[96:99], v[152:159], v3
    s_waitcnt vmcnt(2)
mega_kernel_ch_f3_oc1:
    v_max_u32 v40, v100, v102
    v_cmp_eq_u32 vcc, -1, v40
    s_cbranch_vccnz mega_kernel_ch_f3_oc1_f
mega_kernel_ch_f3_oc1_ok:
    v_smfmac_f32_16x16x64_bf16 v[32:35], v[100:103], v[160:167], v3
    v_smfmac_f32_16x16x64_bf16 v[36:39], v[100:103], v[168:175], v3
    v_smfmac_f32_16x16x64_bf16 v[112:115], v[100:103], v[176:183], v3
    v_smfmac_f32_16x16x64_bf16 v[116:119], v[100:103], v[184:191], v3
    s_waitcnt vmcnt(1)
mega_kernel_ch_f3_oc2:
    v_max_u32 v40, v104, v106
    v_cmp_eq_u32 vcc, -1, v40
    s_cbranch_vccnz mega_kernel_ch_f3_oc2_f
mega_kernel_ch_f3_oc2_ok:
    v_smfmac_f32_16x16x64_bf16 v[32:35], v[104:107], v[192:199], v3
    v_smfmac_f32_16x16x64_bf16 v[36:39], v[104:107], v[200:207], v3
    v_smfmac_f32_16x16x64_bf16 v[112:115], v[104:107], v[208:215], v3
    v_smfmac_f32_16x16x64_bf16 v[116:119], v[104:107], v[216:223], v3
    s_waitcnt vmcnt(0)
mega_kernel_ch_f3_oc3:
    v_max_u32 v40, v108, v110
    v_cmp_eq_u32 vcc, -1, v40
    s_cbranch_vccnz mega_kernel_ch_f3_oc3_f
mega_kernel_ch_f3_oc3_ok:
    v_smfmac_f32_16x16x64_bf16 v[32:35], v[108:111], v[224:231], v3
    v_smfmac_f32_16x16x64_bf16 v[36:39], v[108:111], v[232:239], v3
    v_smfmac_f32_16x16x64_bf16 v[112:115], v[108:111], v[240:247], v3
    v_smfmac_f32_16x16x64_bf16 v[116:119], v[108:111], v[248:255], v3
    s_nop 5
    v_permlane32_swap_b32 v32, v36
    v_permlane32_swap_b32 v33, v37
    v_permlane32_swap_b32 v34, v38
    v_permlane32_swap_b32 v35, v39
    v_add_f32 v32, v32, v36
    v_add_f32 v33, v33, v37
    v_add_f32 v34, v34, v38
    v_add_f32 v35, v35, v39
    ds_write_b128 v15, v[32:35]
    v_permlane32_swap_b32 v112, v116
    v_permlane32_swap_b32 v113, v117
    v_permlane32_swap_b32 v114, v118
    v_permlane32_swap_b32 v115, v119
    v_add_f32 v112, v112, v116
    v_add_f32 v113, v113, v117
    v_add_f32 v114, v114, v118
    v_add_f32 v115, v115, v119
    ds_write_b128 v15, v[112:115] offset:1024
    s_waitcnt lgkmcnt(0)
    s_barrier
    s_bfe_u32 s59, s39, 0x10001
    ds_read_b128 v[96:99], v16 offset:0
    ds_read_b128 v[100:103], v16 offset:2048
    ds_read_b128 v[104:107], v16 offset:4096
    ds_read_b128 v[108:111], v16 offset:6144
    buffer_store_dwordx2 v[22:23], v20, s[28:31], s48 offen sc1
    buffer_store_dwordx4 v[48:51], v19, s[28:31], s48 offen offset:0 sc1
    buffer_store_dwordx4 v[52:55], v19, s[28:31], s48 offen offset:512 sc1
    v_xor_b32 v116, 139264, v4
    s_waitcnt lgkmcnt(2)
    v_add_f32 v96, v96, v100
    v_add_f32 v97, v97, v101
    v_add_f32 v98, v98, v102
    v_add_f32 v99, v99, v103
    s_waitcnt lgkmcnt(0)
    v_add_f32 v104, v104, v108
    v_add_f32 v105, v105, v109
    v_add_f32 v106, v106, v110
    v_add_f32 v107, v107, v111
    v_add_f32 v96, v96, v104
    v_add_f32 v97, v97, v105
    v_add_f32 v98, v98, v106
    v_add_f32 v99, v99, v107
    v_bfi_b32 v96, 1, s59, v96
    v_bfi_b32 v98, 1, s59, v98
    buffer_store_dwordx4 v[96:99], v4, s[20:23], s49 offen sc1
    buffer_store_dwordx4 v[96:99], v116, s[20:23], s49 offen
    s_sleep 6
    buffer_load_dwordx4 v[72:75], v1, s[20:23], s49 offen sc1
    s_sleep 3
    buffer_load_dwordx4 v[76:79], v1, s[20:23], s49 offen sc1
    s_sleep 3
    buffer_load_dwordx4 v[80:83], v1, s[20:23], s49 offen sc1
    s_waitcnt vmcnt(2)
    v_bitop3_b32 v112, v72, v74, s59 bitop3:0x7e
    v_and_b32 v112, 1, v112
    v_cmp_ne_u32 vcc, 0, v112
    s_cbranch_vccnz mega_kernel_ch_f3_xf0
    v_permlane32_swap_b32 v72, v73
    v_permlane32_swap_b32 v74, v75
    v_add_f32 v114, v72, v73
    v_add_f32 v115, v74, v75
mega_kernel_ch_f3_xok:
    s_nop 1
    v_permlane16_swap_b32 v114, v115
    v_add_f32 v114, v114, v115
    s_nop 1
    v_mov_b32_dpp v115, v114 quad_perm:[1,1,3,3] row_mask:0xf bank_mask:0xf
    v_cvt_pk_bf16_f32 v112, v114, v115
    s_nop 1
    v_mov_b32_dpp v113, v112 quad_perm:[2,2,2,2] row_mask:0xf bank_mask:0xf
    buffer_store_dwordx2 v[112:113], v17, s[20:23], s41 offen
    s_branch mega_kernel_ch_f3_top
mega_kernel_ch_f3_last:
    buffer_store_dwordx2 v[22:23], v20, s[28:31], s48 offen sc1
    ds_read_b64_tr_b16 v[48:49], v7 offset:0
    ds_read_b64_tr_b16 v[50:51], v7 offset:256
    ds_read_b64_tr_b16 v[52:53], v7 offset:1024
    ds_read_b64_tr_b16 v[54:55], v7 offset:1280
    s_waitcnt lgkmcnt(0)
    buffer_store_dwordx4 v[48:51], v19, s[28:31], s48 offen offset:0 sc1
    buffer_store_dwordx4 v[52:55], v19, s[28:31], s48 offen offset:512 sc1
    s_waitcnt vmcnt(0)
    s_barrier
    s_branch mega_kernel_ch_fin
mega_kernel_ch_f3_tc0_f:
    s_cmp_eq_u32 s43, 0
    s_cbranch_scc1 mega_kernel_ch_f3_tc0_ok
    s_mov_b32 s90, 0
    s_branch mega_kernel_ch_f3_tretry
mega_kernel_ch_f3_tc1_f:
    s_cmp_eq_u32 s43, 0
    s_cbranch_scc1 mega_kernel_ch_f3_tc1_ok
    s_mov_b32 s90, 1
    s_branch mega_kernel_ch_f3_tretry
mega_kernel_ch_f3_tc2_f:
    s_cmp_eq_u32 s43, 0
    s_cbranch_scc1 mega_kernel_ch_f3_tc2_ok
    s_mov_b32 s90, 2
    s_branch mega_kernel_ch_f3_tretry
mega_kernel_ch_f3_tc3_f:
    s_cmp_eq_u32 s43, 0
    s_cbranch_scc1 mega_kernel_ch_f3_tc3_ok
    s_mov_b32 s90, 3
    s_branch mega_kernel_ch_f3_tretry
mega_kernel_ch_f3_tretry:
    s_sub_u32 s43, s43, 1
    s_waitcnt vmcnt(0)
    v_max_u32 v40, v96, v98
    v_cmp_eq_u32 vcc, -1, v40
    s_cbranch_vccz mega_kernel_ch_f3_tr_L0
    buffer_load_dwordx4 v[96:99], v2, s[20:23], s44 offen offset:0 sc1
mega_kernel_ch_f3_tr_L0:
    v_max_u32 v40, v100, v102
    v_cmp_eq_u32 vcc, -1, v40
    s_cbranch_vccz mega_kernel_ch_f3_tr_L1
    buffer_load_dwordx4 v[100:103], v2, s[20:23], s44 offen offset:1024 sc1
mega_kernel_ch_f3_tr_L1:
    v_max_u32 v40, v104, v106
    v_cmp_eq_u32 vcc, -1, v40
    s_cbranch_vccz mega_kernel_ch_f3_tr_L2
    buffer_load_dwordx4 v[104:107], v2, s[20:23], s44 offen offset:2048 sc1
mega_kernel_ch_f3_tr_L2:
    v_max_u32 v40, v108, v110
    v_cmp_eq_u32 vcc, -1, v40
    s_cbranch_vccz mega_kernel_ch_f3_tr_L3
    buffer_load_dwordx4 v[108:111], v2, s[20:23], s44 offen offset:3072 sc1
mega_kernel_ch_f3_tr_L3:
    s_waitcnt vmcnt(0)
    s_cmp_eq_u32 s90, 0
    s_cbranch_scc1 mega_kernel_ch_f3_tc0
    s_cmp_eq_u32 s90, 1
    s_cbranch_scc1 mega_kernel_ch_f3_tc1
    s_cmp_eq_u32 s90, 2
    s_cbranch_scc1 mega_kernel_ch_f3_tc2
    s_branch mega_kernel_ch_f3_tc3
mega_kernel_ch_f3_e1:
    buffer_store_dwordx2 v[22:23], v20, s[28:31], s48 offen sc1
    ds_read_b64_tr_b16 v[48:49], v7 offset:0
    ds_read_b64_tr_b16 v[50:51], v7 offset:256
    ds_read_b64_tr_b16 v[52:53], v7 offset:1024
    ds_read_b64_tr_b16 v[54:55], v7 offset:1280
    s_waitcnt lgkmcnt(0)
    buffer_store_dwordx4 v[48:51], v19, s[28:31], s48 offen offset:0 sc1
    buffer_store_dwordx4 v[52:55], v19, s[28:31], s48 offen offset:512 sc1
    s_branch mega_kernel_ch_f3_e1r
mega_kernel_ch_f3_sp_f:
    s_cmp_eq_u32 s43, 0
    s_cbranch_scc1 mega_kernel_ch_f3_sp_ok
    s_sub_u32 s43, s43, 1
    buffer_load_dwordx4 v[32:35], v9, s[20:23], s40 offen sc1
    buffer_load_dwordx4 v[36:39], v9, s[20:23], s40 offen offset:2048 sc1
    buffer_load_dwordx2 v[40:41], v10, s[20:23], s40 offen sc1
    buffer_load_dwordx2 v[42:43], v10, s[20:23], s40 offen offset:2048 sc1
    s_waitcnt vmcnt(0)
    s_branch mega_kernel_ch_f3_sp_c
mega_kernel_ch_f3_tf_f:
    s_cmp_eq_u32 s43, 0
    s_cbranch_scc1 mega_kernel_ch_f3_tf_ok
    s_sub_u32 s43, s43, 1
    buffer_load_dword v0, v8, s[16:19], s32 offen sc1
    s_waitcnt vmcnt(0)
    s_branch mega_kernel_ch_f3_tf
mega_kernel_ch_f3_oc0_f:
    s_cmp_eq_u32 s43, 0
    s_cbranch_scc1 mega_kernel_ch_f3_oc0_ok
    s_mov_b32 s90, 0
    s_branch mega_kernel_ch_f3_oretry
mega_kernel_ch_f3_oc1_f:
    s_cmp_eq_u32 s43, 0
    s_cbranch_scc1 mega_kernel_ch_f3_oc1_ok
    s_mov_b32 s90, 1
    s_branch mega_kernel_ch_f3_oretry
mega_kernel_ch_f3_oc2_f:
    s_cmp_eq_u32 s43, 0
    s_cbranch_scc1 mega_kernel_ch_f3_oc2_ok
    s_mov_b32 s90, 2
    s_branch mega_kernel_ch_f3_oretry
mega_kernel_ch_f3_oc3_f:
    s_cmp_eq_u32 s43, 0
    s_cbranch_scc1 mega_kernel_ch_f3_oc3_ok
    s_mov_b32 s90, 3
    s_branch mega_kernel_ch_f3_oretry
mega_kernel_ch_f3_oretry:
    s_sub_u32 s43, s43, 1
    s_waitcnt vmcnt(0)
    v_max_u32 v40, v96, v98
    v_cmp_eq_u32 vcc, -1, v40
    s_cbranch_vccz mega_kernel_ch_f3_or_0
    buffer_load_dwordx4 v[96:99], v14, s[20:23], s40 offen offset:0 sc1
mega_kernel_ch_f3_or_0:
    v_max_u32 v40, v100, v102
    v_cmp_eq_u32 vcc, -1, v40
    s_cbranch_vccz mega_kernel_ch_f3_or_1
    buffer_load_dwordx4 v[100:103], v14, s[20:23], s40 offen offset:1024 sc1
mega_kernel_ch_f3_or_1:
    v_max_u32 v40, v104, v106
    v_cmp_eq_u32 vcc, -1, v40
    s_cbranch_vccz mega_kernel_ch_f3_or_2
    buffer_load_dwordx4 v[104:107], v14, s[20:23], s40 offen offset:2048 sc1
mega_kernel_ch_f3_or_2:
    v_max_u32 v40, v108, v110
    v_cmp_eq_u32 vcc, -1, v40
    s_cbranch_vccz mega_kernel_ch_f3_or_3
    buffer_load_dwordx4 v[108:111], v14, s[20:23], s40 offen offset:3072 sc1
mega_kernel_ch_f3_or_3:
    s_waitcnt vmcnt(0)
    s_cmp_eq_u32 s90, 0
    s_cbranch_scc1 mega_kernel_ch_f3_oc0
    s_cmp_eq_u32 s90, 1
    s_cbranch_scc1 mega_kernel_ch_f3_oc1
    s_cmp_eq_u32 s90, 2
    s_cbranch_scc1 mega_kernel_ch_f3_oc2
    s_branch mega_kernel_ch_f3_oc3
mega_kernel_ch_f3_xf0:
    s_cmp_eq_u32 s43, 0
    s_cbranch_scc1 mega_kernel_ch_f3_xok
    s_sub_u32 s43, s43, 1
    buffer_load_dwordx4 v[72:75], v1, s[20:23], s49 offen sc1
    s_waitcnt vmcnt(2)
    v_bitop3_b32 v112, v76, v78, s59 bitop3:0x7e
    v_and_b32 v112, 1, v112
    v_cmp_ne_u32 vcc, 0, v112
    s_cbranch_vccnz mega_kernel_ch_f3_xg1
    v_permlane32_swap_b32 v76, v77
    v_permlane32_swap_b32 v78, v79
    v_add_f32 v114, v76, v77
    v_add_f32 v115, v78, v79
    s_branch mega_kernel_ch_f3_xok
mega_kernel_ch_f3_xg1:
    buffer_load_dwordx4 v[76:79], v1, s[20:23], s49 offen sc1
    s_waitcnt vmcnt(2)
    v_bitop3_b32 v112, v80, v82, s59 bitop3:0x7e
    v_and_b32 v112, 1, v112
    v_cmp_ne_u32 vcc, 0, v112
    s_cbranch_vccnz mega_kernel_ch_f3_xg2
    v_permlane32_swap_b32 v80, v81
    v_permlane32_swap_b32 v82, v83
    v_add_f32 v114, v80, v81
    v_add_f32 v115, v82, v83
    s_branch mega_kernel_ch_f3_xok
mega_kernel_ch_f3_xg2:
    buffer_load_dwordx4 v[80:83], v1, s[20:23], s49 offen sc1
    s_waitcnt vmcnt(2)
    v_bitop3_b32 v112, v72, v74, s59 bitop3:0x7e
    v_and_b32 v112, 1, v112
    v_cmp_ne_u32 vcc, 0, v112
    s_cbranch_vccnz mega_kernel_ch_f3_xf0
    v_permlane32_swap_b32 v72, v73
    v_permlane32_swap_b32 v74, v75
    v_add_f32 v114, v72, v73
    v_add_f32 v115, v74, v75
    s_branch mega_kernel_ch_f3_xok
mega_kernel_ch_s0_top:
    s_sleep 4
    buffer_load_dwordx4 v[96:99], v2, s[20:23], s44 offen offset:0 sc1
    buffer_load_dwordx4 v[100:103], v2, s[20:23], s44 offen offset:1024 sc1
    buffer_load_dwordx4 v[104:107], v2, s[20:23], s44 offen offset:2048 sc1
    buffer_load_dwordx4 v[108:111], v2, s[20:23], s44 offen offset:3072 sc1
    buffer_load_dwordx4 v[32:35], v4, s[24:27], s47 offen offset:0 sc1
    buffer_load_dwordx4 v[36:39], v4, s[24:27], s47 offen offset:2048 sc1
    buffer_load_dwordx4 v[44:47], v5, s[24:27], s47 offen sc1
    s_add_u32 s39, s39, 1
    s_mov_b32 s40, s41
    s_add_u32 s46, s40, 4096
    s_add_u32 s41, s40, 262144
    s_and_b32 s41, s41, 1048575
    s_and_b32 s49, s41, 262144
    s_add_u32 s49, s49, 1048576
    s_add_u32 s48, s48, 65536
    v_mov_b32 v48, 0
    v_mov_b32 v49, 0
    v_mov_b32 v50, 0
    v_mov_b32 v51, 0
    v_mov_b32 v52, 0
    v_mov_b32 v53, 0
    v_mov_b32 v54, 0
    v_mov_b32 v55, 0
    v_mov_b32 v60, 0
    v_mov_b32 v61, 0
    v_mov_b32 v62, 0
    v_mov_b32 v63, 0
    s_waitcnt vmcnt(6)
mega_kernel_ch_s0_tc0:
    v_max_u32 v40, v96, v98
    v_cmp_eq_u32 vcc, -1, v40
    s_cbranch_vccnz mega_kernel_ch_s0_tc0_f
mega_kernel_ch_s0_tc0_ok:
    ds_write_b128 v2, v[96:99] offset:0
    v_smfmac_f32_16x16x64_bf16 v[48:51], v[96:99], a[0:7], v3
    v_smfmac_f32_16x16x64_bf16 v[52:55], v[96:99], a[128:135], v3
    v_smfmac_f32_16x16x64_bf16 v[60:63], v[96:99], v[24:31], v3
    s_waitcnt vmcnt(5)
mega_kernel_ch_s0_tc1:
    v_max_u32 v40, v100, v102
    v_cmp_eq_u32 vcc, -1, v40
    s_cbranch_vccnz mega_kernel_ch_s0_tc1_f
mega_kernel_ch_s0_tc1_ok:
    ds_write_b128 v2, v[100:103] offset:1024
    v_smfmac_f32_16x16x64_bf16 v[48:51], v[100:103], a[8:15], v3
    v_smfmac_f32_16x16x64_bf16 v[52:55], v[100:103], a[136:143], v3
    v_smfmac_f32_16x16x64_bf16 v[60:63], v[100:103], v[120:127], v3
    s_waitcnt vmcnt(4)
mega_kernel_ch_s0_tc2:
    v_max_u32 v40, v104, v106
    v_cmp_eq_u32 vcc, -1, v40
    s_cbranch_vccnz mega_kernel_ch_s0_tc2_f
mega_kernel_ch_s0_tc2_ok:
    ds_write_b128 v2, v[104:107] offset:2048
    v_smfmac_f32_16x16x64_bf16 v[48:51], v[104:107], a[16:23], v3
    v_smfmac_f32_16x16x64_bf16 v[52:55], v[104:107], a[144:151], v3
    s_waitcnt vmcnt(3)
mega_kernel_ch_s0_tc3:
    v_max_u32 v40, v108, v110
    v_cmp_eq_u32 vcc, -1, v40
    s_cbranch_vccnz mega_kernel_ch_s0_tc3_f
mega_kernel_ch_s0_tc3_ok:
    ds_write_b128 v2, v[108:111] offset:3072
    v_smfmac_f32_16x16x64_bf16 v[48:51], v[108:111], a[24:31], v3
    v_smfmac_f32_16x16x64_bf16 v[52:55], v[108:111], a[152:159], v3
    s_waitcnt lgkmcnt(0)
    s_barrier
    ds_read_b128 v[64:67], v2 offset:4096
    ds_read_b128 v[68:71], v2 offset:8192
    ds_read_b128 v[72:75], v2 offset:12288
    ds_read_b128 v[76:79], v2 offset:5120
    ds_read_b128 v[80:83], v2 offset:9216
    ds_read_b128 v[84:87], v2 offset:13312
    ds_read_b128 v[88:91], v2 offset:6144
    ds_read_b128 v[92:95], v2 offset:10240
    ds_read_b128 v[112:115], v2 offset:14336
    ds_read_b128 v[116:119], v2 offset:7168
    ds_read_b128 v[120:123], v2 offset:11264
    ds_read_b128 v[124:127], v2 offset:15360
    buffer_store_dwordx4 v[56:59], v18, s[20:23], s42 offen sc1
    s_waitcnt lgkmcnt(11)
    v_smfmac_f32_16x16x64_bf16 v[48:51], v[64:67], a[32:39], v3
    v_smfmac_f32_16x16x64_bf16 v[52:55], v[64:67], a[160:167], v3
    s_waitcnt lgkmcnt(10)
    v_smfmac_f32_16x16x64_bf16 v[48:51], v[68:71], a[64:71], v3
    v_smfmac_f32_16x16x64_bf16 v[52:55], v[68:71], a[192:199], v3
    s_waitcnt lgkmcnt(9)
    v_smfmac_f32_16x16x64_bf16 v[48:51], v[72:75], a[96:103], v3
    v_smfmac_f32_16x16x64_bf16 v[52:55], v[72:75], a[224:231], v3
    s_waitcnt lgkmcnt(8)
    v_smfmac_f32_16x16x64_bf16 v[48:51], v[76:79], a[40:47], v3
    v_smfmac_f32_16x16x64_bf16 v[52:55], v[76:79], a[168:175], v3
    s_waitcnt lgkmcnt(7)
    v_smfmac_f32_16x16x64_bf16 v[48:51], v[80:83], a[72:79], v3
    v_smfmac_f32_16x16x64_bf16 v[52:55], v[80:83], a[200:207], v3
    s_waitcnt lgkmcnt(6)
    v_smfmac_f32_16x16x64_bf16 v[48:51], v[84:87], a[104:111], v3
    v_smfmac_f32_16x16x64_bf16 v[52:55], v[84:87], a[232:239], v3
    s_waitcnt lgkmcnt(5)
    v_smfmac_f32_16x16x64_bf16 v[48:51], v[88:91], a[48:55], v3
    v_smfmac_f32_16x16x64_bf16 v[52:55], v[88:91], a[176:183], v3
    s_waitcnt lgkmcnt(4)
    v_smfmac_f32_16x16x64_bf16 v[48:51], v[92:95], a[80:87], v3
    v_smfmac_f32_16x16x64_bf16 v[52:55], v[92:95], a[208:215], v3
    s_waitcnt lgkmcnt(3)
    v_smfmac_f32_16x16x64_bf16 v[48:51], v[112:115], a[112:119], v3
    v_smfmac_f32_16x16x64_bf16 v[52:55], v[112:115], a[240:247], v3
    s_waitcnt lgkmcnt(2)
    v_smfmac_f32_16x16x64_bf16 v[48:51], v[116:119], a[56:63], v3
    v_smfmac_f32_16x16x64_bf16 v[52:55], v[116:119], a[184:191], v3
    s_waitcnt lgkmcnt(1)
    v_smfmac_f32_16x16x64_bf16 v[48:51], v[120:123], a[88:95], v3
    v_smfmac_f32_16x16x64_bf16 v[52:55], v[120:123], a[216:223], v3
    s_waitcnt lgkmcnt(0)
    v_smfmac_f32_16x16x64_bf16 v[48:51], v[124:127], a[120:127], v3
    v_smfmac_f32_16x16x64_bf16 v[52:55], v[124:127], a[248:255], v3
    s_nop 7
    v_permlane32_swap_b32 v48, v52
    v_permlane32_swap_b32 v49, v53
    v_permlane32_swap_b32 v50, v54
    v_permlane32_swap_b32 v51, v55
    v_add_f32 v48, v48, v52
    v_add_f32 v49, v49, v53
    v_add_f32 v50, v50, v54
    v_add_f32 v51, v51, v55
    v_cvt_pk_bf16_f32 v52, v48, v49
    v_cvt_pk_bf16_f32 v53, v50, v51
    ds_write_b64 v6, v[52:53]
    s_waitcnt lgkmcnt(0)
    s_barrier
    ds_read_b64_tr_b16 v[48:49], v7 offset:0
    ds_read_b64_tr_b16 v[50:51], v7 offset:256
    ds_read_b64_tr_b16 v[52:53], v7 offset:1024
    ds_read_b64_tr_b16 v[54:55], v7 offset:1280
    ds_read_b128 v[24:27], v11 offset:16384
    ds_read_b128 v[28:31], v11 offset:17408
    ds_read_b128 v[96:99], v11 offset:24576
    ds_read_b128 v[100:103], v11 offset:25600
    s_waitcnt lgkmcnt(4)
    s_waitcnt vmcnt(2)
    v_mfma_f32_16x16x32_bf16 v[40:43], v[32:35], v[48:51], 0
    v_mfma_f32_16x16x32_bf16 v[40:43], v[36:39], v[52:55], v[40:43]
    s_nop 7
    buffer_store_dwordx4 v[40:43], v8, s[20:23], s40 offen sc1
    s_waitcnt lgkmcnt(2)
    v_smfmac_f32_16x16x64_bf16 v[60:63], v[104:107], v[24:31], v3
    ds_read_b128 v[24:27], v11 offset:32768
    ds_read_b128 v[28:31], v11 offset:33792
    s_waitcnt lgkmcnt(2)
    v_smfmac_f32_16x16x64_bf16 v[60:63], v[108:111], v[96:103], v3
    ds_read_b128 v[96:99], v12 offset:0
    ds_read_b128 v[100:103], v12 offset:1024
    ds_read_b128 v[104:107], v12 offset:32768
    ds_read_b128 v[108:111], v12 offset:33792
    s_waitcnt lgkmcnt(4)
    v_smfmac_f32_16x16x64_bf16 v[60:63], v[64:67], v[24:31], v3
    ds_read_b128 v[24:27], v11 offset:40960
    ds_read_b128 v[28:31], v11 offset:41984
    s_waitcnt lgkmcnt(4)
    v_smfmac_f32_16x16x64_bf16 v[60:63], v[68:71], v[96:103], v3
    ds_read_b128 v[96:99], v12 offset:8192
    ds_read_b128 v[100:103], v12 offset:9216
    ds_read_b128 v[64:67], v12 offset:40960
    ds_read_b128 v[68:71], v12 offset:41984
    s_waitcnt lgkmcnt(6)
    v_smfmac_f32_16x16x64_bf16 v[60:63], v[72:75], v[104:111], v3
    ds_read_b128 v[104:107], v11 offset:49152
    ds_read_b128 v[108:111], v11 offset:50176
    s_waitcnt lgkmcnt(6)
    v_smfmac_f32_16x16x64_bf16 v[60:63], v[76:79], v[24:31], v3
    ds_read_b128 v[24:27], v12 offset:16384
    ds_read_b128 v[28:31], v12 offset:17408
    ds_read_b128 v[72:75], v12 offset:49152
    ds_read_b128 v[76:79], v12 offset:50176
    s_waitcnt lgkmcnt(8)
    v_smfmac_f32_16x16x64_bf16 v[60:63], v[80:83], v[96:103], v3
    ds_read_b128 v[96:99], v11 offset:57344
    ds_read_b128 v[100:103], v11 offset:58368
    s_waitcnt lgkmcnt(8)
    v_smfmac_f32_16x16x64_bf16 v[60:63], v[84:87], v[64:71], v3
    ds_read_b128 v[64:67], v12 offset:24576
    ds_read_b128 v[68:71], v12 offset:25600
    buffer_load_dwordx4 v[32:35], v9, s[20:23], s40 offen sc1
    buffer_load_dwordx4 v[36:39], v9, s[20:23], s40 offen offset:2048 sc1
    buffer_load_dwordx2 v[40:41], v10, s[20:23], s40 offen sc1
    buffer_load_dwordx2 v[42:43], v10, s[20:23], s40 offen offset:2048 sc1
    s_waitcnt lgkmcnt(8)
    v_smfmac_f32_16x16x64_bf16 v[60:63], v[88:91], v[104:111], v3
    ds_read_b128 v[80:83], v12 offset:57344
    ds_read_b128 v[84:87], v12 offset:58368
    s_waitcnt lgkmcnt(8)
    v_smfmac_f32_16x16x64_bf16 v[60:63], v[92:95], v[24:31], v3
    s_waitcnt lgkmcnt(6)
    v_smfmac_f32_16x16x64_bf16 v[60:63], v[112:115], v[72:79], v3
    s_waitcnt lgkmcnt(4)
    v_smfmac_f32_16x16x64_bf16 v[60:63], v[116:119], v[96:103], v3
    s_waitcnt lgkmcnt(2)
    v_smfmac_f32_16x16x64_bf16 v[60:63], v[120:123], v[64:71], v3
    s_waitcnt lgkmcnt(0)
    v_smfmac_f32_16x16x64_bf16 v[60:63], v[124:127], v[80:87], v3
    s_nop 7
    v_mov_b32 v24, v60
    v_mov_b32 v25, v61
    v_mov_b32 v26, v62
    v_mov_b32 v27, v63
    v_permlane32_swap_b32 v24, v60
    v_permlane32_swap_b32 v25, v61
    v_permlane32_swap_b32 v26, v62
    v_permlane32_swap_b32 v27, v63
    v_add_f32 v24, v24, v60
    v_add_f32 v25, v25, v61
    v_add_f32 v26, v26, v62
    v_add_f32 v27, v27, v63
    v_cvt_pk_bf16_f32 v22, v24, v25
    v_cvt_pk_bf16_f32 v23, v26, v27
    s_cmp_eq_u32 s39, 63
    s_cbranch_scc1 mega_kernel_ch_s0_last
    s_cmp_ge_u32 s39, 60
    s_cbranch_scc1 mega_kernel_ch_s0_e1
mega_kernel_ch_s0_e1r:
    s_waitcnt vmcnt(0)
mega_kernel_ch_s0_sp_c:
    v_max3_u32 v28, v32, v34, v36
    v_max3_u32 v28, v28, v38, v40
    v_max_u32 v28, v28, v42
    v_cmp_eq_u32 vcc, -1, v28
    s_cbranch_vccnz mega_kernel_ch_s0_sp_f
mega_kernel_ch_s0_sp_ok:
    v_add_f32 v64, v32, v36
    v_add_f32 v65, v33, v37
    v_add_f32 v66, v34, v38
    v_add_f32 v67, v35, v39
    v_add_f32 v68, v40, v42
    v_add_f32 v69, v41, v43
    v_max3_f32 v70, v64, v65, v66
    v_max3_f32 v70, v70, v67, v68
    v_max_f32 v70, v70, v69
    s_nop 1
    v_max_f32_dpp v70, v70, v70 row_ror:8 row_mask:0xf bank_mask:0xf
    v_mov_b32 v71, v70
    s_nop 1
    v_permlane16_swap_b32 v71, v70
    v_max_f32 v70, v70, v71
    v_mov_b32 v71, v70
    s_nop 1
    v_permlane32_swap_b32 v71, v70
    v_max_f32 v70, v70, v71
    v_mul_f32 v70, s52, v70
    v_fma_f32 v64, v64, s52, -v70
    v_fma_f32 v65, v65, s52, -v70
    v_fma_f32 v66, v66, s52, -v70
    v_fma_f32 v67, v67, s52, -v70
    v_fma_f32 v68, v68, s52, -v70
    v_fma_f32 v69, v69, s52, -v70
    v_exp_f32 v64, v64
    v_exp_f32 v65, v65
    v_exp_f32 v66, v66
    v_exp_f32 v67, v67
    v_exp_f32 v68, v68
    v_exp_f32 v69, v69
    v_cvt_pk_bf16_f32 v72, v64, v65
    v_cvt_pk_bf16_f32 v73, v66, v67
    v_cvt_pk_bf16_f32 v76, v68, v69
    v_mov_b32_dpp v74, v72 row_ror:8 row_mask:0xf bank_mask:0xf
    v_mov_b32_dpp v75, v73 row_ror:8 row_mask:0xf bank_mask:0xf
    v_mov_b32_dpp v77, v76 row_ror:8 row_mask:0xf bank_mask:0xf
    s_nop 0
    v_mfma_f32_16x16x32_bf16 v[80:83], v[44:47], v[72:75], 0
    s_nop 5
    v_mfma_f32_16x16x16bf16_1k v[80:83], v[22:23], v[76:77], v[80:83]
    v_add_f32 v70, v64, v65
    v_add_f32 v71, v66, v67
    v_add_f32 v70, v70, v68
    v_add_f32 v71, v71, v69
    v_add_f32 v70, v70, v71
    s_nop 1
    v_add_f32_dpp v70, v70, v70 row_ror:8 row_mask:0xf bank_mask:0xf
    v_mov_b32 v71, v70
    s_nop 1
    v_permlane16_swap_b32 v71, v70
    v_add_f32 v70, v70, v71
    v_mov_b32 v71, v70
    s_nop 1
    v_permlane32_swap_b32 v71, v70
    v_add_f32 v70, v70, v71
    v_rcp_f32 v70, v70
    s_nop 0
    v_mul_f32 v80, v80, v70
    v_mul_f32 v81, v81, v70
    v_mul_f32 v82, v82, v70
    v_mul_f32 v83, v83, v70
    v_cvt_pk_bf16_f32 v84, v80, v81
    v_cvt_pk_bf16_f32 v85, v82, v83
    buffer_store_dwordx2 v[84:85], v13, s[20:23], s40 offen sc1
    ds_read_b128 v[24:27], v11 offset:0
    ds_read_b128 v[28:31], v11 offset:1024
    ds_read_b128 v[120:123], v11 offset:8192
    ds_read_b128 v[124:127], v11 offset:9216
    s_add_u32 s44, s41, s92
    s_add_u32 s45, s41, s93
    s_add_u32 s47, s47, 262144
    s_xor_b32 s42, s41, 524288
    s_add_u32 s56, s39, 2
    s_lshr_b32 s56, s56, 2
    s_lshl_b32 s56, s56, 10
    s_add_u32 s32, s56, s91
    s_lshl_b32 s56, s39, 13
    s_add_u32 s33, s56, s94
    v_mov_b32 v32, 0
    v_mov_b32 v33, 0
    v_mov_b32 v34, 0
    v_mov_b32 v35, 0
    v_mov_b32 v36, 0
    v_mov_b32 v37, 0
    v_mov_b32 v38, 0
    v_mov_b32 v39, 0
    v_mov_b32 v112, 0
    v_mov_b32 v113, 0
    v_mov_b32 v114, 0
    v_mov_b32 v115, 0
    v_mov_b32 v116, 0
    v_mov_b32 v117, 0
    v_mov_b32 v118, 0
    v_mov_b32 v119, 0
    s_sleep 6
    buffer_load_dwordx4 v[96:99], v14, s[20:23], s40 offen offset:0 sc1
    buffer_load_dwordx4 v[100:103], v14, s[20:23], s40 offen offset:1024 sc1
    buffer_load_dwordx4 v[104:107], v14, s[20:23], s40 offen offset:2048 sc1
    buffer_load_dwordx4 v[108:111], v14, s[20:23], s40 offen offset:3072 sc1
    s_waitcnt vmcnt(3)
mega_kernel_ch_s0_oc0:
    v_max_u32 v40, v96, v98
    v_cmp_eq_u32 vcc, -1, v40
    s_cbranch_vccnz mega_kernel_ch_s0_oc0_f
mega_kernel_ch_s0_oc0_ok:
    v_smfmac_f32_16x16x64_bf16 v[32:35], v[96:99], v[128:135], v3
    v_smfmac_f32_16x16x64_bf16 v[36:39], v[96:99], v[136:143], v3
    v_smfmac_f32_16x16x64_bf16 v[112:115], v[96:99], v[144:151], v3
    v_smfmac_f32_16x16x64_bf16 v[116:119], v[96:99], v[152:159], v3
    s_waitcnt vmcnt(2)
mega_kernel_ch_s0_oc1:
    v_max_u32 v40, v100, v102
    v_cmp_eq_u32 vcc, -1, v40
    s_cbranch_vccnz mega_kernel_ch_s0_oc1_f
mega_kernel_ch_s0_oc1_ok:
    v_smfmac_f32_16x16x64_bf16 v[32:35], v[100:103], v[160:167], v3
    v_smfmac_f32_16x16x64_bf16 v[36:39], v[100:103], v[168:175], v3
    v_smfmac_f32_16x16x64_bf16 v[112:115], v[100:103], v[176:183], v3
    v_smfmac_f32_16x16x64_bf16 v[116:119], v[100:103], v[184:191], v3
    s_waitcnt vmcnt(1)
mega_kernel_ch_s0_oc2:
    v_max_u32 v40, v104, v106
    v_cmp_eq_u32 vcc, -1, v40
    s_cbranch_vccnz mega_kernel_ch_s0_oc2_f
mega_kernel_ch_s0_oc2_ok:
    v_smfmac_f32_16x16x64_bf16 v[32:35], v[104:107], v[192:199], v3
    v_smfmac_f32_16x16x64_bf16 v[36:39], v[104:107], v[200:207], v3
    v_smfmac_f32_16x16x64_bf16 v[112:115], v[104:107], v[208:215], v3
    v_smfmac_f32_16x16x64_bf16 v[116:119], v[104:107], v[216:223], v3
    s_waitcnt vmcnt(0)
mega_kernel_ch_s0_oc3:
    v_max_u32 v40, v108, v110
    v_cmp_eq_u32 vcc, -1, v40
    s_cbranch_vccnz mega_kernel_ch_s0_oc3_f
mega_kernel_ch_s0_oc3_ok:
    v_smfmac_f32_16x16x64_bf16 v[32:35], v[108:111], v[224:231], v3
    v_smfmac_f32_16x16x64_bf16 v[36:39], v[108:111], v[232:239], v3
    v_smfmac_f32_16x16x64_bf16 v[112:115], v[108:111], v[240:247], v3
    v_smfmac_f32_16x16x64_bf16 v[116:119], v[108:111], v[248:255], v3
    s_nop 5
    v_permlane32_swap_b32 v32, v36
    v_permlane32_swap_b32 v33, v37
    v_permlane32_swap_b32 v34, v38
    v_permlane32_swap_b32 v35, v39
    v_add_f32 v32, v32, v36
    v_add_f32 v33, v33, v37
    v_add_f32 v34, v34, v38
    v_add_f32 v35, v35, v39
    ds_write_b128 v15, v[32:35]
    v_permlane32_swap_b32 v112, v116
    v_permlane32_swap_b32 v113, v117
    v_permlane32_swap_b32 v114, v118
    v_permlane32_swap_b32 v115, v119
    v_add_f32 v112, v112, v116
    v_add_f32 v113, v113, v117
    v_add_f32 v114, v114, v118
    v_add_f32 v115, v115, v119
    ds_write_b128 v15, v[112:115] offset:1024
    s_waitcnt lgkmcnt(0)
    s_barrier
    s_bfe_u32 s59, s39, 0x10001
    ds_read_b128 v[96:99], v16 offset:0
    ds_read_b128 v[100:103], v16 offset:2048
    ds_read_b128 v[104:107], v16 offset:4096
    ds_read_b128 v[108:111], v16 offset:6144
    buffer_store_dwordx2 v[22:23], v20, s[28:31], s48 offen sc1
    v_xor_b32 v116, 139264, v19
    s_waitcnt lgkmcnt(2)
    v_add_f32 v96, v96, v100
    v_add_f32 v97, v97, v101
    v_add_f32 v98, v98, v102
    v_add_f32 v99, v99, v103
    s_waitcnt lgkmcnt(0)
    v_add_f32 v104, v104, v108
    v_add_f32 v105, v105, v109
    v_add_f32 v106, v106, v110
    v_add_f32 v107, v107, v111
    v_add_f32 v96, v96, v104
    v_add_f32 v97, v97, v105
    v_add_f32 v98, v98, v106
    v_add_f32 v99, v99, v107
    v_bfi_b32 v96, 1, s59, v96
    v_bfi_b32 v98, 1, s59, v98
    buffer_store_dwordx4 v[96:99], v19, s[20:23], s49 offen sc1
    buffer_store_dwordx4 v[96:99], v116, s[20:23], s49 offen sc1
    s_sleep 6
    buffer_load_dwordx4 v[72:75], v1, s[20:23], s49 offen sc1
    s_sleep 3
    buffer_load_dwordx4 v[76:79], v1, s[20:23], s49 offen sc1
    s_sleep 3
    buffer_load_dwordx4 v[80:83], v1, s[20:23], s49 offen sc1
    s_waitcnt vmcnt(2)
    v_bitop3_b32 v112, v72, v74, s59 bitop3:0x7e
    v_and_b32 v112, 1, v112
    v_cmp_ne_u32 vcc, 0, v112
    s_cbranch_vccnz mega_kernel_ch_s0_xf0
    v_permlane32_swap_b32 v72, v73
    v_permlane32_swap_b32 v74, v75
    v_add_f32 v114, v72, v73
    v_add_f32 v115, v74, v75
mega_kernel_ch_s0_xok:
    s_nop 1
    v_permlane16_swap_b32 v114, v115
    v_add_f32 v114, v114, v115
    s_nop 1
    v_mov_b32_dpp v115, v114 quad_perm:[1,1,3,3] row_mask:0xf bank_mask:0xf
    v_cvt_pk_bf16_f32 v112, v114, v115
    s_nop 1
    v_mov_b32_dpp v113, v112 quad_perm:[2,2,2,2] row_mask:0xf bank_mask:0xf
    buffer_store_dwordx2 v[112:113], v17, s[20:23], s41 offen sc1
    s_branch mega_kernel_ch_s0_top
mega_kernel_ch_s0_last:
    buffer_store_dwordx2 v[22:23], v20, s[28:31], s48 offen sc1
    s_waitcnt vmcnt(0)
    s_barrier
    s_branch mega_kernel_ch_fin
mega_kernel_ch_s0_tc0_f:
    s_cmp_eq_u32 s43, 0
    s_cbranch_scc1 mega_kernel_ch_s0_tc0_ok
    s_mov_b32 s90, 0
    s_branch mega_kernel_ch_s0_tretry
mega_kernel_ch_s0_tc1_f:
    s_cmp_eq_u32 s43, 0
    s_cbranch_scc1 mega_kernel_ch_s0_tc1_ok
    s_mov_b32 s90, 1
    s_branch mega_kernel_ch_s0_tretry
mega_kernel_ch_s0_tc2_f:
    s_cmp_eq_u32 s43, 0
    s_cbranch_scc1 mega_kernel_ch_s0_tc2_ok
    s_mov_b32 s90, 2
    s_branch mega_kernel_ch_s0_tretry
mega_kernel_ch_s0_tc3_f:
    s_cmp_eq_u32 s43, 0
    s_cbranch_scc1 mega_kernel_ch_s0_tc3_ok
    s_mov_b32 s90, 3
    s_branch mega_kernel_ch_s0_tretry
mega_kernel_ch_s0_tretry:
    s_sub_u32 s43, s43, 1
    s_waitcnt vmcnt(0)
    v_max_u32 v40, v96, v98
    v_cmp_eq_u32 vcc, -1, v40
    s_cbranch_vccz mega_kernel_ch_s0_tr_L0
    buffer_load_dwordx4 v[96:99], v2, s[20:23], s44 offen offset:0 sc1
mega_kernel_ch_s0_tr_L0:
    v_max_u32 v40, v100, v102
    v_cmp_eq_u32 vcc, -1, v40
    s_cbranch_vccz mega_kernel_ch_s0_tr_L1
    buffer_load_dwordx4 v[100:103], v2, s[20:23], s44 offen offset:1024 sc1
mega_kernel_ch_s0_tr_L1:
    v_max_u32 v40, v104, v106
    v_cmp_eq_u32 vcc, -1, v40
    s_cbranch_vccz mega_kernel_ch_s0_tr_L2
    buffer_load_dwordx4 v[104:107], v2, s[20:23], s44 offen offset:2048 sc1
mega_kernel_ch_s0_tr_L2:
    v_max_u32 v40, v108, v110
    v_cmp_eq_u32 vcc, -1, v40
    s_cbranch_vccz mega_kernel_ch_s0_tr_L3
    buffer_load_dwordx4 v[108:111], v2, s[20:23], s44 offen offset:3072 sc1
mega_kernel_ch_s0_tr_L3:
    s_waitcnt vmcnt(0)
    s_cmp_eq_u32 s90, 0
    s_cbranch_scc1 mega_kernel_ch_s0_tc0
    s_cmp_eq_u32 s90, 1
    s_cbranch_scc1 mega_kernel_ch_s0_tc1
    s_cmp_eq_u32 s90, 2
    s_cbranch_scc1 mega_kernel_ch_s0_tc2
    s_branch mega_kernel_ch_s0_tc3
mega_kernel_ch_s0_e1:
    buffer_store_dwordx2 v[22:23], v20, s[28:31], s48 offen sc1
    s_branch mega_kernel_ch_s0_e1r
mega_kernel_ch_s0_sp_f:
    s_cmp_eq_u32 s43, 0
    s_cbranch_scc1 mega_kernel_ch_s0_sp_ok
    s_sub_u32 s43, s43, 1
    buffer_load_dwordx4 v[32:35], v9, s[20:23], s40 offen sc1
    buffer_load_dwordx4 v[36:39], v9, s[20:23], s40 offen offset:2048 sc1
    buffer_load_dwordx2 v[40:41], v10, s[20:23], s40 offen sc1
    buffer_load_dwordx2 v[42:43], v10, s[20:23], s40 offen offset:2048 sc1
    s_waitcnt vmcnt(0)
    s_branch mega_kernel_ch_s0_sp_c
mega_kernel_ch_s0_oc0_f:
    s_cmp_eq_u32 s43, 0
    s_cbranch_scc1 mega_kernel_ch_s0_oc0_ok
    s_mov_b32 s90, 0
    s_branch mega_kernel_ch_s0_oretry
mega_kernel_ch_s0_oc1_f:
    s_cmp_eq_u32 s43, 0
    s_cbranch_scc1 mega_kernel_ch_s0_oc1_ok
    s_mov_b32 s90, 1
    s_branch mega_kernel_ch_s0_oretry
mega_kernel_ch_s0_oc2_f:
    s_cmp_eq_u32 s43, 0
    s_cbranch_scc1 mega_kernel_ch_s0_oc2_ok
    s_mov_b32 s90, 2
    s_branch mega_kernel_ch_s0_oretry
mega_kernel_ch_s0_oc3_f:
    s_cmp_eq_u32 s43, 0
    s_cbranch_scc1 mega_kernel_ch_s0_oc3_ok
    s_mov_b32 s90, 3
    s_branch mega_kernel_ch_s0_oretry
mega_kernel_ch_s0_oretry:
    s_sub_u32 s43, s43, 1
    s_waitcnt vmcnt(0)
    v_max_u32 v40, v96, v98
    v_cmp_eq_u32 vcc, -1, v40
    s_cbranch_vccz mega_kernel_ch_s0_or_0
    buffer_load_dwordx4 v[96:99], v14, s[20:23], s40 offen offset:0 sc1
mega_kernel_ch_s0_or_0:
    v_max_u32 v40, v100, v102
    v_cmp_eq_u32 vcc, -1, v40
    s_cbranch_vccz mega_kernel_ch_s0_or_1
    buffer_load_dwordx4 v[100:103], v14, s[20:23], s40 offen offset:1024 sc1
mega_kernel_ch_s0_or_1:
    v_max_u32 v40, v104, v106
    v_cmp_eq_u32 vcc, -1, v40
    s_cbranch_vccz mega_kernel_ch_s0_or_2
    buffer_load_dwordx4 v[104:107], v14, s[20:23], s40 offen offset:2048 sc1
mega_kernel_ch_s0_or_2:
    v_max_u32 v40, v108, v110
    v_cmp_eq_u32 vcc, -1, v40
    s_cbranch_vccz mega_kernel_ch_s0_or_3
    buffer_load_dwordx4 v[108:111], v14, s[20:23], s40 offen offset:3072 sc1
mega_kernel_ch_s0_or_3:
    s_waitcnt vmcnt(0)
    s_cmp_eq_u32 s90, 0
    s_cbranch_scc1 mega_kernel_ch_s0_oc0
    s_cmp_eq_u32 s90, 1
    s_cbranch_scc1 mega_kernel_ch_s0_oc1
    s_cmp_eq_u32 s90, 2
    s_cbranch_scc1 mega_kernel_ch_s0_oc2
    s_branch mega_kernel_ch_s0_oc3
mega_kernel_ch_s0_xf0:
    s_cmp_eq_u32 s43, 0
    s_cbranch_scc1 mega_kernel_ch_s0_xok
    s_sub_u32 s43, s43, 1
    buffer_load_dwordx4 v[72:75], v1, s[20:23], s49 offen sc1
    s_waitcnt vmcnt(2)
    v_bitop3_b32 v112, v76, v78, s59 bitop3:0x7e
    v_and_b32 v112, 1, v112
    v_cmp_ne_u32 vcc, 0, v112
    s_cbranch_vccnz mega_kernel_ch_s0_xg1
    v_permlane32_swap_b32 v76, v77
    v_permlane32_swap_b32 v78, v79
    v_add_f32 v114, v76, v77
    v_add_f32 v115, v78, v79
    s_branch mega_kernel_ch_s0_xok
mega_kernel_ch_s0_xg1:
    buffer_load_dwordx4 v[76:79], v1, s[20:23], s49 offen sc1
    s_waitcnt vmcnt(2)
    v_bitop3_b32 v112, v80, v82, s59 bitop3:0x7e
    v_and_b32 v112, 1, v112
    v_cmp_ne_u32 vcc, 0, v112
    s_cbranch_vccnz mega_kernel_ch_s0_xg2
    v_permlane32_swap_b32 v80, v81
    v_permlane32_swap_b32 v82, v83
    v_add_f32 v114, v80, v81
    v_add_f32 v115, v82, v83
    s_branch mega_kernel_ch_s0_xok
mega_kernel_ch_s0_xg2:
    buffer_load_dwordx4 v[80:83], v1, s[20:23], s49 offen sc1
    s_waitcnt vmcnt(2)
    v_bitop3_b32 v112, v72, v74, s59 bitop3:0x7e
    v_and_b32 v112, 1, v112
    v_cmp_ne_u32 vcc, 0, v112
    s_cbranch_vccnz mega_kernel_ch_s0_xf0
    v_permlane32_swap_b32 v72, v73
    v_permlane32_swap_b32 v74, v75
    v_add_f32 v114, v72, v73
    v_add_f32 v115, v74, v75
    s_branch mega_kernel_ch_s0_xok
mega_kernel_ch_s1_top:
    s_sleep 4
    buffer_load_dwordx4 v[96:99], v2, s[20:23], s44 offen offset:0 sc1
    buffer_load_dwordx4 v[100:103], v2, s[20:23], s44 offen offset:1024 sc1
    buffer_load_dwordx4 v[104:107], v2, s[20:23], s44 offen offset:2048 sc1
    buffer_load_dwordx4 v[108:111], v2, s[20:23], s44 offen offset:3072 sc1
    buffer_load_dwordx4 v[32:35], v4, s[24:27], s47 offen offset:0 sc1
    buffer_load_dwordx4 v[36:39], v4, s[24:27], s47 offen offset:2048 sc1
    buffer_load_dwordx4 v[44:47], v5, s[24:27], s47 offen sc1
    s_add_u32 s39, s39, 1
    s_mov_b32 s40, s41
    s_add_u32 s46, s40, 4096
    s_add_u32 s41, s40, 262144
    s_and_b32 s41, s41, 1048575
    s_and_b32 s49, s41, 262144
    s_add_u32 s49, s49, 1048576
    s_add_u32 s48, s48, 65536
    v_mov_b32 v48, 0
    v_mov_b32 v49, 0
    v_mov_b32 v50, 0
    v_mov_b32 v51, 0
    v_mov_b32 v52, 0
    v_mov_b32 v53, 0
    v_mov_b32 v54, 0
    v_mov_b32 v55, 0
    v_mov_b32 v60, 0
    v_mov_b32 v61, 0
    v_mov_b32 v62, 0
    v_mov_b32 v63, 0
    s_waitcnt vmcnt(6)
mega_kernel_ch_s1_tc0:
    v_max_u32 v40, v96, v98
    v_cmp_eq_u32 vcc, -1, v40
    s_cbranch_vccnz mega_kernel_ch_s1_tc0_f
mega_kernel_ch_s1_tc0_ok:
    ds_write_b128 v2, v[96:99] offset:4096
    v_smfmac_f32_16x16x64_bf16 v[48:51], v[96:99], a[32:39], v3
    v_smfmac_f32_16x16x64_bf16 v[52:55], v[96:99], a[160:167], v3
    v_smfmac_f32_16x16x64_bf16 v[60:63], v[96:99], v[24:31], v3
    s_waitcnt vmcnt(5)
mega_kernel_ch_s1_tc1:
    v_max_u32 v40, v100, v102
    v_cmp_eq_u32 vcc, -1, v40
    s_cbranch_vccnz mega_kernel_ch_s1_tc1_f
mega_kernel_ch_s1_tc1_ok:
    ds_write_b128 v2, v[100:103] offset:5120
    v_smfmac_f32_16x16x64_bf16 v[48:51], v[100:103], a[40:47], v3
    v_smfmac_f32_16x16x64_bf16 v[52:55], v[100:103], a[168:175], v3
    v_smfmac_f32_16x16x64_bf16 v[60:63], v[100:103], v[120:127], v3
    s_waitcnt vmcnt(4)
mega_kernel_ch_s1_tc2:
    v_max_u32 v40, v104, v106
    v_cmp_eq_u32 vcc, -1, v40
    s_cbranch_vccnz mega_kernel_ch_s1_tc2_f
mega_kernel_ch_s1_tc2_ok:
    ds_write_b128 v2, v[104:107] offset:6144
    v_smfmac_f32_16x16x64_bf16 v[48:51], v[104:107], a[48:55], v3
    v_smfmac_f32_16x16x64_bf16 v[52:55], v[104:107], a[176:183], v3
    s_waitcnt vmcnt(3)
mega_kernel_ch_s1_tc3:
    v_max_u32 v40, v108, v110
    v_cmp_eq_u32 vcc, -1, v40
    s_cbranch_vccnz mega_kernel_ch_s1_tc3_f
mega_kernel_ch_s1_tc3_ok:
    ds_write_b128 v2, v[108:111] offset:7168
    v_smfmac_f32_16x16x64_bf16 v[48:51], v[108:111], a[56:63], v3
    v_smfmac_f32_16x16x64_bf16 v[52:55], v[108:111], a[184:191], v3
    s_waitcnt lgkmcnt(0)
    s_barrier
    ds_read_b128 v[64:67], v2 offset:8192
    ds_read_b128 v[68:71], v2 offset:12288
    ds_read_b128 v[72:75], v2 offset:0
    ds_read_b128 v[76:79], v2 offset:9216
    ds_read_b128 v[80:83], v2 offset:13312
    ds_read_b128 v[84:87], v2 offset:1024
    ds_read_b128 v[88:91], v2 offset:10240
    ds_read_b128 v[92:95], v2 offset:14336
    ds_read_b128 v[112:115], v2 offset:2048
    ds_read_b128 v[116:119], v2 offset:11264
    ds_read_b128 v[120:123], v2 offset:15360
    ds_read_b128 v[124:127], v2 offset:3072
    s_waitcnt lgkmcnt(11)
    v_smfmac_f32_16x16x64_bf16 v[48:51], v[64:67], a[64:71], v3
    v_smfmac_f32_16x16x64_bf16 v[52:55], v[64:67], a[192:199], v3
    s_waitcnt lgkmcnt(10)
    v_smfmac_f32_16x16x64_bf16 v[48:51], v[68:71], a[96:103], v3
    v_smfmac_f32_16x16x64_bf16 v[52:55], v[68:71], a[224:231], v3
    s_waitcnt lgkmcnt(9)
    v_smfmac_f32_16x16x64_bf16 v[48:51], v[72:75], a[0:7], v3
    v_smfmac_f32_16x16x64_bf16 v[52:55], v[72:75], a[128:135], v3
    s_waitcnt lgkmcnt(8)
    v_smfmac_f32_16x16x64_bf16 v[48:51], v[76:79], a[72:79], v3
    v_smfmac_f32_16x16x64_bf16 v[52:55], v[76:79], a[200:207], v3
    s_waitcnt lgkmcnt(7)
    v_smfmac_f32_16x16x64_bf16 v[48:51], v[80:83], a[104:111], v3
    v_smfmac_f32_16x16x64_bf16 v[52:55], v[80:83], a[232:239], v3
    s_waitcnt lgkmcnt(6)
    v_smfmac_f32_16x16x64_bf16 v[48:51], v[84:87], a[8:15], v3
    v_smfmac_f32_16x16x64_bf16 v[52:55], v[84:87], a[136:143], v3
    s_waitcnt lgkmcnt(5)
    v_smfmac_f32_16x16x64_bf16 v[48:51], v[88:91], a[80:87], v3
    v_smfmac_f32_16x16x64_bf16 v[52:55], v[88:91], a[208:215], v3
    s_waitcnt lgkmcnt(4)
    v_smfmac_f32_16x16x64_bf16 v[48:51], v[92:95], a[112:119], v3
    v_smfmac_f32_16x16x64_bf16 v[52:55], v[92:95], a[240:247], v3
    s_waitcnt lgkmcnt(3)
    v_smfmac_f32_16x16x64_bf16 v[48:51], v[112:115], a[16:23], v3
    v_smfmac_f32_16x16x64_bf16 v[52:55], v[112:115], a[144:151], v3
    s_waitcnt lgkmcnt(2)
    v_smfmac_f32_16x16x64_bf16 v[48:51], v[116:119], a[88:95], v3
    v_smfmac_f32_16x16x64_bf16 v[52:55], v[116:119], a[216:223], v3
    s_waitcnt lgkmcnt(1)
    v_smfmac_f32_16x16x64_bf16 v[48:51], v[120:123], a[120:127], v3
    v_smfmac_f32_16x16x64_bf16 v[52:55], v[120:123], a[248:255], v3
    s_waitcnt lgkmcnt(0)
    v_smfmac_f32_16x16x64_bf16 v[48:51], v[124:127], a[24:31], v3
    v_smfmac_f32_16x16x64_bf16 v[52:55], v[124:127], a[152:159], v3
    s_nop 7
    v_permlane32_swap_b32 v48, v52
    v_permlane32_swap_b32 v49, v53
    v_permlane32_swap_b32 v50, v54
    v_permlane32_swap_b32 v51, v55
    v_add_f32 v48, v48, v52
    v_add_f32 v49, v49, v53
    v_add_f32 v50, v50, v54
    v_add_f32 v51, v51, v55
    v_cvt_pk_bf16_f32 v52, v48, v49
    v_cvt_pk_bf16_f32 v53, v50, v51
    ds_write_b64 v6, v[52:53]
    s_waitcnt lgkmcnt(0)
    s_barrier
    ds_read_b64_tr_b16 v[48:49], v7 offset:0
    ds_read_b64_tr_b16 v[50:51], v7 offset:256
    ds_read_b64_tr_b16 v[52:53], v7 offset:1024
    ds_read_b64_tr_b16 v[54:55], v7 offset:1280
    ds_read_b128 v[24:27], v11 offset:49152
    ds_read_b128 v[28:31], v11 offset:50176
    ds_read_b128 v[96:99], v11 offset:57344
    ds_read_b128 v[100:103], v11 offset:58368
    s_waitcnt lgkmcnt(4)
    s_waitcnt vmcnt(1)
    v_mfma_f32_16x16x32_bf16 v[40:43], v[32:35], v[48:51], 0
    v_mfma_f32_16x16x32_bf16 v[40:43], v[36:39], v[52:55], v[40:43]
    s_nop 7
    buffer_store_dwordx4 v[40:43], v8, s[20:23], s40 offen sc1
    s_waitcnt lgkmcnt(2)
    v_smfmac_f32_16x16x64_bf16 v[60:63], v[104:107], v[24:31], v3
    ds_read_b128 v[24:27], v12 offset:0
    ds_read_b128 v[28:31], v12 offset:1024
    s_waitcnt lgkmcnt(2)
    v_smfmac_f32_16x16x64_bf16 v[60:63], v[108:111], v[96:103], v3
    ds_read_b128 v[96:99], v12 offset:32768
    ds_read_b128 v[100:103], v12 offset:33792
    ds_read_b128 v[104:107], v11 offset:0
    ds_read_b128 v[108:111], v11 offset:1024
    s_waitcnt lgkmcnt(4)
    v_smfmac_f32_16x16x64_bf16 v[60:63], v[64:67], v[24:31], v3
    ds_read_b128 v[24:27], v12 offset:8192
    ds_read_b128 v[28:31], v12 offset:9216
    s_waitcnt lgkmcnt(4)
    v_smfmac_f32_16x16x64_bf16 v[60:63], v[68:71], v[96:103], v3
    ds_read_b128 v[96:99], v12 offset:40960
    ds_read_b128 v[100:103], v12 offset:41984
    ds_read_b128 v[64:67], v11 offset:8192
    ds_read_b128 v[68:71], v11 offset:9216
    s_waitcnt lgkmcnt(6)
    v_smfmac_f32_16x16x64_bf16 v[60:63], v[72:75], v[104:111], v3
    ds_read_b128 v[104:107], v12 offset:16384
    ds_read_b128 v[108:111], v12 offset:17408
    s_waitcnt lgkmcnt(6)
    v_smfmac_f32_16x16x64_bf16 v[60:63], v[76:79], v[24:31], v3
    ds_read_b128 v[24:27], v12 offset:49152
    ds_read_b128 v[28:31], v12 offset:50176
    ds_read_b128 v[72:75], v11 offset:16384
    ds_read_b128 v[76:79], v11 offset:17408
    s_waitcnt lgkmcnt(8)
    v_smfmac_f32_16x16x64_bf16 v[60:63], v[80:83], v[96:103], v3
    ds_read_b128 v[96:99], v12 offset:24576
    ds_read_b128 v[100:103], v12 offset:25600
    s_waitcnt lgkmcnt(8)
    v_smfmac_f32_16x16x64_bf16 v[60:63], v[84:87], v[64:71], v3
    ds_read_b128 v[64:67], v12 offset:57344
    ds_read_b128 v[68:71], v12 offset:58368
    buffer_load_dwordx4 v[32:35], v9, s[20:23], s40 offen sc1
    buffer_load_dwordx4 v[36:39], v9, s[20:23], s40 offen offset:2048 sc1
    buffer_load_dwordx2 v[40:41], v10, s[20:23], s40 offen sc1
    buffer_load_dwordx2 v[42:43], v10, s[20:23], s40 offen offset:2048 sc1
    s_waitcnt lgkmcnt(8)
    v_smfmac_f32_16x16x64_bf16 v[60:63], v[88:91], v[104:111], v3
    ds_read_b128 v[80:83], v11 offset:24576
    ds_read_b128 v[84:87], v11 offset:25600
    s_waitcnt lgkmcnt(8)
    v_smfmac_f32_16x16x64_bf16 v[60:63], v[92:95], v[24:31], v3
    s_waitcnt lgkmcnt(6)
    v_smfmac_f32_16x16x64_bf16 v[60:63], v[112:115], v[72:79], v3
    s_waitcnt lgkmcnt(4)
    v_smfmac_f32_16x16x64_bf16 v[60:63], v[116:119], v[96:103], v3
    s_waitcnt lgkmcnt(2)
    v_smfmac_f32_16x16x64_bf16 v[60:63], v[120:123], v[64:71], v3
    s_waitcnt lgkmcnt(0)
    v_smfmac_f32_16x16x64_bf16 v[60:63], v[124:127], v[80:87], v3
    s_nop 7
    v_mov_b32 v24, v60
    v_mov_b32 v25, v61
    v_mov_b32 v26, v62
    v_mov_b32 v27, v63
    v_permlane32_swap_b32 v24, v60
    v_permlane32_swap_b32 v25, v61
    v_permlane32_swap_b32 v26, v62
    v_permlane32_swap_b32 v27, v63
    v_add_f32 v24, v24, v60
    v_add_f32 v25, v25, v61
    v_add_f32 v26, v26, v62
    v_add_f32 v27, v27, v63
    v_cvt_pk_bf16_f32 v22, v24, v25
    v_cvt_pk_bf16_f32 v23, v26, v27
    s_cmp_eq_u32 s39, 63
    s_cbranch_scc1 mega_kernel_ch_s1_last
    s_cmp_ge_u32 s39, 60
    s_cbranch_scc1 mega_kernel_ch_s1_e1
mega_kernel_ch_s1_e1r:
    s_waitcnt vmcnt(0)
mega_kernel_ch_s1_sp_c:
    v_max3_u32 v28, v32, v34, v36
    v_max3_u32 v28, v28, v38, v40
    v_max_u32 v28, v28, v42
    v_cmp_eq_u32 vcc, -1, v28
    s_cbranch_vccnz mega_kernel_ch_s1_sp_f
mega_kernel_ch_s1_sp_ok:
    v_add_f32 v64, v32, v36
    v_add_f32 v65, v33, v37
    v_add_f32 v66, v34, v38
    v_add_f32 v67, v35, v39
    v_add_f32 v68, v40, v42
    v_add_f32 v69, v41, v43
    v_max3_f32 v70, v64, v65, v66
    v_max3_f32 v70, v70, v67, v68
    v_max_f32 v70, v70, v69
    s_nop 1
    v_max_f32_dpp v70, v70, v70 row_ror:8 row_mask:0xf bank_mask:0xf
    v_mov_b32 v71, v70
    s_nop 1
    v_permlane16_swap_b32 v71, v70
    v_max_f32 v70, v70, v71
    v_mov_b32 v71, v70
    s_nop 1
    v_permlane32_swap_b32 v71, v70
    v_max_f32 v70, v70, v71
    v_mul_f32 v70, s52, v70
    v_fma_f32 v64, v64, s52, -v70
    v_fma_f32 v65, v65, s52, -v70
    v_fma_f32 v66, v66, s52, -v70
    v_fma_f32 v67, v67, s52, -v70
    v_fma_f32 v68, v68, s52, -v70
    v_fma_f32 v69, v69, s52, -v70
    v_exp_f32 v64, v64
    v_exp_f32 v65, v65
    v_exp_f32 v66, v66
    v_exp_f32 v67, v67
    v_exp_f32 v68, v68
    v_exp_f32 v69, v69
    v_cvt_pk_bf16_f32 v72, v64, v65
    v_cvt_pk_bf16_f32 v73, v66, v67
    v_cvt_pk_bf16_f32 v76, v68, v69
    v_mov_b32_dpp v74, v72 row_ror:8 row_mask:0xf bank_mask:0xf
    v_mov_b32_dpp v75, v73 row_ror:8 row_mask:0xf bank_mask:0xf
    v_mov_b32_dpp v77, v76 row_ror:8 row_mask:0xf bank_mask:0xf
    s_nop 0
    v_mfma_f32_16x16x32_bf16 v[80:83], v[44:47], v[72:75], 0
    s_nop 5
    v_mfma_f32_16x16x16bf16_1k v[80:83], v[22:23], v[76:77], v[80:83]
    v_add_f32 v70, v64, v65
    v_add_f32 v71, v66, v67
    v_add_f32 v70, v70, v68
    v_add_f32 v71, v71, v69
    v_add_f32 v70, v70, v71
    s_nop 1
    v_add_f32_dpp v70, v70, v70 row_ror:8 row_mask:0xf bank_mask:0xf
    v_mov_b32 v71, v70
    s_nop 1
    v_permlane16_swap_b32 v71, v70
    v_add_f32 v70, v70, v71
    v_mov_b32 v71, v70
    s_nop 1
    v_permlane32_swap_b32 v71, v70
    v_add_f32 v70, v70, v71
    v_rcp_f32 v70, v70
    s_nop 0
    v_mul_f32 v80, v80, v70
    v_mul_f32 v81, v81, v70
    v_mul_f32 v82, v82, v70
    v_mul_f32 v83, v83, v70
    v_cvt_pk_bf16_f32 v84, v80, v81
    v_cvt_pk_bf16_f32 v85, v82, v83
    buffer_store_dwordx2 v[84:85], v13, s[20:23], s40 offen sc1
    ds_read_b128 v[24:27], v11 offset:32768
    ds_read_b128 v[28:31], v11 offset:33792
    ds_read_b128 v[120:123], v11 offset:40960
    ds_read_b128 v[124:127], v11 offset:41984
    s_add_u32 s44, s41, s92
    s_add_u32 s45, s41, s93
    s_add_u32 s47, s47, 262144
    s_xor_b32 s42, s41, 524288
    s_add_u32 s56, s39, 2
    s_lshr_b32 s56, s56, 2
    s_lshl_b32 s56, s56, 10
    s_add_u32 s32, s56, s91
    s_lshl_b32 s56, s39, 13
    s_add_u32 s33, s56, s94
    v_mov_b32 v32, 0
    v_mov_b32 v33, 0
    v_mov_b32 v34, 0
    v_mov_b32 v35, 0
    v_mov_b32 v36, 0
    v_mov_b32 v37, 0
    v_mov_b32 v38, 0
    v_mov_b32 v39, 0
    v_mov_b32 v112, 0
    v_mov_b32 v113, 0
    v_mov_b32 v114, 0
    v_mov_b32 v115, 0
    v_mov_b32 v116, 0
    v_mov_b32 v117, 0
    v_mov_b32 v118, 0
    v_mov_b32 v119, 0
    s_sleep 6
    buffer_load_dwordx4 v[96:99], v14, s[20:23], s40 offen offset:0 sc1
    buffer_load_dwordx4 v[100:103], v14, s[20:23], s40 offen offset:1024 sc1
    buffer_load_dwordx4 v[104:107], v14, s[20:23], s40 offen offset:2048 sc1
    buffer_load_dwordx4 v[108:111], v14, s[20:23], s40 offen offset:3072 sc1
    s_waitcnt vmcnt(3)
mega_kernel_ch_s1_oc0:
    v_max_u32 v40, v96, v98
    v_cmp_eq_u32 vcc, -1, v40
    s_cbranch_vccnz mega_kernel_ch_s1_oc0_f
mega_kernel_ch_s1_oc0_ok:
    v_smfmac_f32_16x16x64_bf16 v[32:35], v[96:99], v[128:135], v3
    v_smfmac_f32_16x16x64_bf16 v[36:39], v[96:99], v[136:143], v3
    v_smfmac_f32_16x16x64_bf16 v[112:115], v[96:99], v[144:151], v3
    v_smfmac_f32_16x16x64_bf16 v[116:119], v[96:99], v[152:159], v3
    s_waitcnt vmcnt(2)
mega_kernel_ch_s1_oc1:
    v_max_u32 v40, v100, v102
    v_cmp_eq_u32 vcc, -1, v40
    s_cbranch_vccnz mega_kernel_ch_s1_oc1_f
mega_kernel_ch_s1_oc1_ok:
    v_smfmac_f32_16x16x64_bf16 v[32:35], v[100:103], v[160:167], v3
    v_smfmac_f32_16x16x64_bf16 v[36:39], v[100:103], v[168:175], v3
    v_smfmac_f32_16x16x64_bf16 v[112:115], v[100:103], v[176:183], v3
    v_smfmac_f32_16x16x64_bf16 v[116:119], v[100:103], v[184:191], v3
    s_waitcnt vmcnt(1)
mega_kernel_ch_s1_oc2:
    v_max_u32 v40, v104, v106
    v_cmp_eq_u32 vcc, -1, v40
    s_cbranch_vccnz mega_kernel_ch_s1_oc2_f
mega_kernel_ch_s1_oc2_ok:
    v_smfmac_f32_16x16x64_bf16 v[32:35], v[104:107], v[192:199], v3
    v_smfmac_f32_16x16x64_bf16 v[36:39], v[104:107], v[200:207], v3
    v_smfmac_f32_16x16x64_bf16 v[112:115], v[104:107], v[208:215], v3
    v_smfmac_f32_16x16x64_bf16 v[116:119], v[104:107], v[216:223], v3
    s_waitcnt vmcnt(0)
mega_kernel_ch_s1_oc3:
    v_max_u32 v40, v108, v110
    v_cmp_eq_u32 vcc, -1, v40
    s_cbranch_vccnz mega_kernel_ch_s1_oc3_f
mega_kernel_ch_s1_oc3_ok:
    v_smfmac_f32_16x16x64_bf16 v[32:35], v[108:111], v[224:231], v3
    v_smfmac_f32_16x16x64_bf16 v[36:39], v[108:111], v[232:239], v3
    v_smfmac_f32_16x16x64_bf16 v[112:115], v[108:111], v[240:247], v3
    v_smfmac_f32_16x16x64_bf16 v[116:119], v[108:111], v[248:255], v3
    s_nop 5
    v_permlane32_swap_b32 v32, v36
    v_permlane32_swap_b32 v33, v37
    v_permlane32_swap_b32 v34, v38
    v_permlane32_swap_b32 v35, v39
    v_add_f32 v32, v32, v36
    v_add_f32 v33, v33, v37
    v_add_f32 v34, v34, v38
    v_add_f32 v35, v35, v39
    ds_write_b128 v15, v[32:35]
    v_permlane32_swap_b32 v112, v116
    v_permlane32_swap_b32 v113, v117
    v_permlane32_swap_b32 v114, v118
    v_permlane32_swap_b32 v115, v119
    v_add_f32 v112, v112, v116
    v_add_f32 v113, v113, v117
    v_add_f32 v114, v114, v118
    v_add_f32 v115, v115, v119
    ds_write_b128 v15, v[112:115] offset:1024
    s_waitcnt lgkmcnt(0)
    s_barrier
    s_bfe_u32 s59, s39, 0x10001
    ds_read_b128 v[96:99], v16 offset:0
    ds_read_b128 v[100:103], v16 offset:2048
    ds_read_b128 v[104:107], v16 offset:4096
    ds_read_b128 v[108:111], v16 offset:6144
    buffer_store_dwordx2 v[22:23], v20, s[28:31], s48 offen sc1
    v_xor_b32 v116, 139264, v19
    s_waitcnt lgkmcnt(2)
    v_add_f32 v96, v96, v100
    v_add_f32 v97, v97, v101
    v_add_f32 v98, v98, v102
    v_add_f32 v99, v99, v103
    s_waitcnt lgkmcnt(0)
    v_add_f32 v104, v104, v108
    v_add_f32 v105, v105, v109
    v_add_f32 v106, v106, v110
    v_add_f32 v107, v107, v111
    v_add_f32 v96, v96, v104
    v_add_f32 v97, v97, v105
    v_add_f32 v98, v98, v106
    v_add_f32 v99, v99, v107
    v_bfi_b32 v96, 1, s59, v96
    v_bfi_b32 v98, 1, s59, v98
    buffer_store_dwordx4 v[96:99], v19, s[20:23], s49 offen sc1
    buffer_store_dwordx4 v[96:99], v116, s[20:23], s49 offen sc1
    s_sleep 6
    buffer_load_dwordx4 v[72:75], v1, s[20:23], s49 offen sc1
    s_sleep 3
    buffer_load_dwordx4 v[76:79], v1, s[20:23], s49 offen sc1
    s_sleep 3
    buffer_load_dwordx4 v[80:83], v1, s[20:23], s49 offen sc1
    s_waitcnt vmcnt(2)
    v_bitop3_b32 v112, v72, v74, s59 bitop3:0x7e
    v_and_b32 v112, 1, v112
    v_cmp_ne_u32 vcc, 0, v112
    s_cbranch_vccnz mega_kernel_ch_s1_xf0
    v_permlane32_swap_b32 v72, v73
    v_permlane32_swap_b32 v74, v75
    v_add_f32 v114, v72, v73
    v_add_f32 v115, v74, v75
mega_kernel_ch_s1_xok:
    s_nop 1
    v_permlane16_swap_b32 v114, v115
    v_add_f32 v114, v114, v115
    s_nop 1
    v_mov_b32_dpp v115, v114 quad_perm:[1,1,3,3] row_mask:0xf bank_mask:0xf
    v_cvt_pk_bf16_f32 v112, v114, v115
    s_nop 1
    v_mov_b32_dpp v113, v112 quad_perm:[2,2,2,2] row_mask:0xf bank_mask:0xf
    buffer_store_dwordx2 v[112:113], v17, s[20:23], s41 offen sc1
    s_branch mega_kernel_ch_s1_top
mega_kernel_ch_s1_last:
    buffer_store_dwordx2 v[22:23], v20, s[28:31], s48 offen sc1
    s_waitcnt vmcnt(0)
    s_barrier
    s_branch mega_kernel_ch_fin
mega_kernel_ch_s1_tc0_f:
    s_cmp_eq_u32 s43, 0
    s_cbranch_scc1 mega_kernel_ch_s1_tc0_ok
    s_mov_b32 s90, 0
    s_branch mega_kernel_ch_s1_tretry
mega_kernel_ch_s1_tc1_f:
    s_cmp_eq_u32 s43, 0
    s_cbranch_scc1 mega_kernel_ch_s1_tc1_ok
    s_mov_b32 s90, 1
    s_branch mega_kernel_ch_s1_tretry
mega_kernel_ch_s1_tc2_f:
    s_cmp_eq_u32 s43, 0
    s_cbranch_scc1 mega_kernel_ch_s1_tc2_ok
    s_mov_b32 s90, 2
    s_branch mega_kernel_ch_s1_tretry
mega_kernel_ch_s1_tc3_f:
    s_cmp_eq_u32 s43, 0
    s_cbranch_scc1 mega_kernel_ch_s1_tc3_ok
    s_mov_b32 s90, 3
    s_branch mega_kernel_ch_s1_tretry
mega_kernel_ch_s1_tretry:
    s_sub_u32 s43, s43, 1
    s_waitcnt vmcnt(0)
    v_max_u32 v40, v96, v98
    v_cmp_eq_u32 vcc, -1, v40
    s_cbranch_vccz mega_kernel_ch_s1_tr_L0
    buffer_load_dwordx4 v[96:99], v2, s[20:23], s44 offen offset:0 sc1
mega_kernel_ch_s1_tr_L0:
    v_max_u32 v40, v100, v102
    v_cmp_eq_u32 vcc, -1, v40
    s_cbranch_vccz mega_kernel_ch_s1_tr_L1
    buffer_load_dwordx4 v[100:103], v2, s[20:23], s44 offen offset:1024 sc1
mega_kernel_ch_s1_tr_L1:
    v_max_u32 v40, v104, v106
    v_cmp_eq_u32 vcc, -1, v40
    s_cbranch_vccz mega_kernel_ch_s1_tr_L2
    buffer_load_dwordx4 v[104:107], v2, s[20:23], s44 offen offset:2048 sc1
mega_kernel_ch_s1_tr_L2:
    v_max_u32 v40, v108, v110
    v_cmp_eq_u32 vcc, -1, v40
    s_cbranch_vccz mega_kernel_ch_s1_tr_L3
    buffer_load_dwordx4 v[108:111], v2, s[20:23], s44 offen offset:3072 sc1
mega_kernel_ch_s1_tr_L3:
    s_waitcnt vmcnt(0)
    s_cmp_eq_u32 s90, 0
    s_cbranch_scc1 mega_kernel_ch_s1_tc0
    s_cmp_eq_u32 s90, 1
    s_cbranch_scc1 mega_kernel_ch_s1_tc1
    s_cmp_eq_u32 s90, 2
    s_cbranch_scc1 mega_kernel_ch_s1_tc2
    s_branch mega_kernel_ch_s1_tc3
mega_kernel_ch_s1_e1:
    buffer_store_dwordx2 v[22:23], v20, s[28:31], s48 offen sc1
    s_branch mega_kernel_ch_s1_e1r
mega_kernel_ch_s1_sp_f:
    s_cmp_eq_u32 s43, 0
    s_cbranch_scc1 mega_kernel_ch_s1_sp_ok
    s_sub_u32 s43, s43, 1
    buffer_load_dwordx4 v[32:35], v9, s[20:23], s40 offen sc1
    buffer_load_dwordx4 v[36:39], v9, s[20:23], s40 offen offset:2048 sc1
    buffer_load_dwordx2 v[40:41], v10, s[20:23], s40 offen sc1
    buffer_load_dwordx2 v[42:43], v10, s[20:23], s40 offen offset:2048 sc1
    s_waitcnt vmcnt(0)
    s_branch mega_kernel_ch_s1_sp_c
mega_kernel_ch_s1_oc0_f:
    s_cmp_eq_u32 s43, 0
    s_cbranch_scc1 mega_kernel_ch_s1_oc0_ok
    s_mov_b32 s90, 0
    s_branch mega_kernel_ch_s1_oretry
mega_kernel_ch_s1_oc1_f:
    s_cmp_eq_u32 s43, 0
    s_cbranch_scc1 mega_kernel_ch_s1_oc1_ok
    s_mov_b32 s90, 1
    s_branch mega_kernel_ch_s1_oretry
mega_kernel_ch_s1_oc2_f:
    s_cmp_eq_u32 s43, 0
    s_cbranch_scc1 mega_kernel_ch_s1_oc2_ok
    s_mov_b32 s90, 2
    s_branch mega_kernel_ch_s1_oretry
mega_kernel_ch_s1_oc3_f:
    s_cmp_eq_u32 s43, 0
    s_cbranch_scc1 mega_kernel_ch_s1_oc3_ok
    s_mov_b32 s90, 3
    s_branch mega_kernel_ch_s1_oretry
mega_kernel_ch_s1_oretry:
    s_sub_u32 s43, s43, 1
    s_waitcnt vmcnt(0)
    v_max_u32 v40, v96, v98
    v_cmp_eq_u32 vcc, -1, v40
    s_cbranch_vccz mega_kernel_ch_s1_or_0
    buffer_load_dwordx4 v[96:99], v14, s[20:23], s40 offen offset:0 sc1
mega_kernel_ch_s1_or_0:
    v_max_u32 v40, v100, v102
    v_cmp_eq_u32 vcc, -1, v40
    s_cbranch_vccz mega_kernel_ch_s1_or_1
    buffer_load_dwordx4 v[100:103], v14, s[20:23], s40 offen offset:1024 sc1
mega_kernel_ch_s1_or_1:
    v_max_u32 v40, v104, v106
    v_cmp_eq_u32 vcc, -1, v40
    s_cbranch_vccz mega_kernel_ch_s1_or_2
    buffer_load_dwordx4 v[104:107], v14, s[20:23], s40 offen offset:2048 sc1
mega_kernel_ch_s1_or_2:
    v_max_u32 v40, v108, v110
    v_cmp_eq_u32 vcc, -1, v40
    s_cbranch_vccz mega_kernel_ch_s1_or_3
    buffer_load_dwordx4 v[108:111], v14, s[20:23], s40 offen offset:3072 sc1
mega_kernel_ch_s1_or_3:
    s_waitcnt vmcnt(0)
    s_cmp_eq_u32 s90, 0
    s_cbranch_scc1 mega_kernel_ch_s1_oc0
    s_cmp_eq_u32 s90, 1
    s_cbranch_scc1 mega_kernel_ch_s1_oc1
    s_cmp_eq_u32 s90, 2
    s_cbranch_scc1 mega_kernel_ch_s1_oc2
    s_branch mega_kernel_ch_s1_oc3
mega_kernel_ch_s1_xf0:
    s_cmp_eq_u32 s43, 0
    s_cbranch_scc1 mega_kernel_ch_s1_xok
    s_sub_u32 s43, s43, 1
    buffer_load_dwordx4 v[72:75], v1, s[20:23], s49 offen sc1
    s_waitcnt vmcnt(2)
    v_bitop3_b32 v112, v76, v78, s59 bitop3:0x7e
    v_and_b32 v112, 1, v112
    v_cmp_ne_u32 vcc, 0, v112
    s_cbranch_vccnz mega_kernel_ch_s1_xg1
    v_permlane32_swap_b32 v76, v77
    v_permlane32_swap_b32 v78, v79
    v_add_f32 v114, v76, v77
    v_add_f32 v115, v78, v79
    s_branch mega_kernel_ch_s1_xok
mega_kernel_ch_s1_xg1:
    buffer_load_dwordx4 v[76:79], v1, s[20:23], s49 offen sc1
    s_waitcnt vmcnt(2)
    v_bitop3_b32 v112, v80, v82, s59 bitop3:0x7e
    v_and_b32 v112, 1, v112
    v_cmp_ne_u32 vcc, 0, v112
    s_cbranch_vccnz mega_kernel_ch_s1_xg2
    v_permlane32_swap_b32 v80, v81
    v_permlane32_swap_b32 v82, v83
    v_add_f32 v114, v80, v81
    v_add_f32 v115, v82, v83
    s_branch mega_kernel_ch_s1_xok
mega_kernel_ch_s1_xg2:
    buffer_load_dwordx4 v[80:83], v1, s[20:23], s49 offen sc1
    s_waitcnt vmcnt(2)
    v_bitop3_b32 v112, v72, v74, s59 bitop3:0x7e
    v_and_b32 v112, 1, v112
    v_cmp_ne_u32 vcc, 0, v112
    s_cbranch_vccnz mega_kernel_ch_s1_xf0
    v_permlane32_swap_b32 v72, v73
    v_permlane32_swap_b32 v74, v75
    v_add_f32 v114, v72, v73
    v_add_f32 v115, v74, v75
    s_branch mega_kernel_ch_s1_xok
mega_kernel_ch_s2_top:
    s_sleep 4
    buffer_load_dwordx4 v[96:99], v2, s[20:23], s44 offen offset:0 sc1
    buffer_load_dwordx4 v[100:103], v2, s[20:23], s44 offen offset:1024 sc1
    buffer_load_dwordx4 v[104:107], v2, s[20:23], s44 offen offset:2048 sc1
    buffer_load_dwordx4 v[108:111], v2, s[20:23], s44 offen offset:3072 sc1
    buffer_load_dwordx4 v[44:47], v5, s[24:27], s47 offen sc1
    s_add_u32 s39, s39, 1
    s_mov_b32 s40, s41
    s_add_u32 s46, s40, 4096
    s_add_u32 s41, s40, 262144
    s_and_b32 s41, s41, 1048575
    s_and_b32 s49, s41, 262144
    s_add_u32 s49, s49, 1048576
    s_add_u32 s48, s48, 65536
    v_mov_b32 v48, 0
    v_mov_b32 v49, 0
    v_mov_b32 v50, 0
    v_mov_b32 v51, 0
    v_mov_b32 v52, 0
    v_mov_b32 v53, 0
    v_mov_b32 v54, 0
    v_mov_b32 v55, 0
    v_mov_b32 v60, 0
    v_mov_b32 v61, 0
    v_mov_b32 v62, 0
    v_mov_b32 v63, 0
    s_waitcnt vmcnt(4)
mega_kernel_ch_s2_tc0:
    v_max_u32 v40, v96, v98
    v_cmp_eq_u32 vcc, -1, v40
    s_cbranch_vccnz mega_kernel_ch_s2_tc0_f
mega_kernel_ch_s2_tc0_ok:
    ds_write_b128 v2, v[96:99] offset:8192
    v_smfmac_f32_16x16x64_bf16 v[48:51], v[96:99], a[64:71], v3
    v_smfmac_f32_16x16x64_bf16 v[52:55], v[96:99], a[192:199], v3
    v_smfmac_f32_16x16x64_bf16 v[60:63], v[96:99], v[24:31], v3
    s_waitcnt vmcnt(3)
mega_kernel_ch_s2_tc1:
    v_max_u32 v40, v100, v102
    v_cmp_eq_u32 vcc, -1, v40
    s_cbranch_vccnz mega_kernel_ch_s2_tc1_f
mega_kernel_ch_s2_tc1_ok:
    ds_write_b128 v2, v[100:103] offset:9216
    v_smfmac_f32_16x16x64_bf16 v[48:51], v[100:103], a[72:79], v3
    v_smfmac_f32_16x16x64_bf16 v[52:55], v[100:103], a[200:207], v3
    v_smfmac_f32_16x16x64_bf16 v[60:63], v[100:103], v[120:127], v3
    s_waitcnt vmcnt(2)
mega_kernel_ch_s2_tc2:
    v_max_u32 v40, v104, v106
    v_cmp_eq_u32 vcc, -1, v40
    s_cbranch_vccnz mega_kernel_ch_s2_tc2_f
mega_kernel_ch_s2_tc2_ok:
    ds_write_b128 v2, v[104:107] offset:10240
    v_smfmac_f32_16x16x64_bf16 v[48:51], v[104:107], a[80:87], v3
    v_smfmac_f32_16x16x64_bf16 v[52:55], v[104:107], a[208:215], v3
    s_waitcnt vmcnt(1)
mega_kernel_ch_s2_tc3:
    v_max_u32 v40, v108, v110
    v_cmp_eq_u32 vcc, -1, v40
    s_cbranch_vccnz mega_kernel_ch_s2_tc3_f
mega_kernel_ch_s2_tc3_ok:
    ds_write_b128 v2, v[108:111] offset:11264
    v_smfmac_f32_16x16x64_bf16 v[48:51], v[108:111], a[88:95], v3
    v_smfmac_f32_16x16x64_bf16 v[52:55], v[108:111], a[216:223], v3
    s_waitcnt lgkmcnt(0)
    s_barrier
    ds_read_b128 v[64:67], v2 offset:12288
    ds_read_b128 v[68:71], v2 offset:0
    ds_read_b128 v[72:75], v2 offset:4096
    ds_read_b128 v[76:79], v2 offset:13312
    ds_read_b128 v[80:83], v2 offset:1024
    ds_read_b128 v[84:87], v2 offset:5120
    ds_read_b128 v[88:91], v2 offset:14336
    ds_read_b128 v[92:95], v2 offset:2048
    ds_read_b128 v[112:115], v2 offset:6144
    ds_read_b128 v[116:119], v2 offset:15360
    ds_read_b128 v[120:123], v2 offset:3072
    ds_read_b128 v[124:127], v2 offset:7168
    buffer_store_dwordx4 v[56:59], v18, s[20:23], s42 offen sc1
    s_cmp_eq_u32 s39, 0
    s_cbranch_scc1 mega_kernel_ch_s2_nocp
    s_mov_b64 exec, 1
    buffer_store_dword v56, off, s[16:19], s33 sc1
    s_mov_b64 exec, -1
mega_kernel_ch_s2_nocp:
    s_waitcnt lgkmcnt(11)
    s_nop 2
    v_smfmac_f32_16x16x64_bf16 v[48:51], v[64:67], a[96:103], v3
    v_smfmac_f32_16x16x64_bf16 v[52:55], v[64:67], a[224:231], v3
    s_waitcnt lgkmcnt(10)
    v_smfmac_f32_16x16x64_bf16 v[48:51], v[68:71], a[0:7], v3
    v_smfmac_f32_16x16x64_bf16 v[52:55], v[68:71], a[128:135], v3
    s_waitcnt lgkmcnt(9)
    v_smfmac_f32_16x16x64_bf16 v[48:51], v[72:75], a[32:39], v3
    v_smfmac_f32_16x16x64_bf16 v[52:55], v[72:75], a[160:167], v3
    s_waitcnt lgkmcnt(8)
    v_smfmac_f32_16x16x64_bf16 v[48:51], v[76:79], a[104:111], v3
    v_smfmac_f32_16x16x64_bf16 v[52:55], v[76:79], a[232:239], v3
    s_waitcnt lgkmcnt(7)
    v_smfmac_f32_16x16x64_bf16 v[48:51], v[80:83], a[8:15], v3
    v_smfmac_f32_16x16x64_bf16 v[52:55], v[80:83], a[136:143], v3
    s_waitcnt lgkmcnt(6)
    v_smfmac_f32_16x16x64_bf16 v[48:51], v[84:87], a[40:47], v3
    v_smfmac_f32_16x16x64_bf16 v[52:55], v[84:87], a[168:175], v3
    s_waitcnt lgkmcnt(5)
    v_smfmac_f32_16x16x64_bf16 v[48:51], v[88:91], a[112:119], v3
    v_smfmac_f32_16x16x64_bf16 v[52:55], v[88:91], a[240:247], v3
    s_waitcnt lgkmcnt(4)
    v_smfmac_f32_16x16x64_bf16 v[48:51], v[92:95], a[16:23], v3
    v_smfmac_f32_16x16x64_bf16 v[52:55], v[92:95], a[144:151], v3
    s_waitcnt lgkmcnt(3)
    v_smfmac_f32_16x16x64_bf16 v[48:51], v[112:115], a[48:55], v3
    v_smfmac_f32_16x16x64_bf16 v[52:55], v[112:115], a[176:183], v3
    s_waitcnt lgkmcnt(2)
    v_smfmac_f32_16x16x64_bf16 v[48:51], v[116:119], a[120:127], v3
    v_smfmac_f32_16x16x64_bf16 v[52:55], v[116:119], a[248:255], v3
    s_waitcnt lgkmcnt(1)
    v_smfmac_f32_16x16x64_bf16 v[48:51], v[120:123], a[24:31], v3
    v_smfmac_f32_16x16x64_bf16 v[52:55], v[120:123], a[152:159], v3
    s_waitcnt lgkmcnt(0)
    v_smfmac_f32_16x16x64_bf16 v[48:51], v[124:127], a[56:63], v3
    v_smfmac_f32_16x16x64_bf16 v[52:55], v[124:127], a[184:191], v3
    s_nop 7
    v_permlane32_swap_b32 v48, v52
    v_permlane32_swap_b32 v49, v53
    v_permlane32_swap_b32 v50, v54
    v_permlane32_swap_b32 v51, v55
    v_add_f32 v48, v48, v52
    v_add_f32 v49, v49, v53
    v_add_f32 v50, v50, v54
    v_add_f32 v51, v51, v55
    v_cvt_pk_bf16_f32 v52, v48, v49
    v_cvt_pk_bf16_f32 v53, v50, v51
    ds_write_b64 v6, v[52:53]
    s_waitcnt lgkmcnt(0)
    s_barrier
    ds_read_b64_tr_b16 v[48:49], v7 offset:0
    ds_read_b64_tr_b16 v[50:51], v7 offset:256
    ds_read_b64_tr_b16 v[52:53], v7 offset:1024
    ds_read_b64_tr_b16 v[54:55], v7 offset:1280
    ds_read_b128 v[24:27], v12 offset:16384
    ds_read_b128 v[28:31], v12 offset:17408
    ds_read_b128 v[96:99], v12 offset:24576
    ds_read_b128 v[100:103], v12 offset:25600
    s_waitcnt lgkmcnt(4)
    v_mfma_f32_16x16x32_bf16 v[40:43], v[48:51], v[48:51], 0
    v_mfma_f32_16x16x32_bf16 v[40:43], v[52:55], v[52:55], v[40:43]
    s_nop 7
    buffer_store_dwordx4 v[40:43], v8, s[20:23], s40 offen sc1
    s_waitcnt lgkmcnt(2)
    v_smfmac_f32_16x16x64_bf16 v[60:63], v[104:107], v[24:31], v3
    ds_read_b128 v[24:27], v12 offset:32768
    ds_read_b128 v[28:31], v12 offset:33792
    s_waitcnt lgkmcnt(2)
    v_smfmac_f32_16x16x64_bf16 v[60:63], v[108:111], v[96:103], v3
    ds_read_b128 v[96:99], v11 offset:0
    ds_read_b128 v[100:103], v11 offset:1024
    ds_read_b128 v[104:107], v11 offset:32768
    ds_read_b128 v[108:111], v11 offset:33792
    s_waitcnt lgkmcnt(4)
    v_smfmac_f32_16x16x64_bf16 v[60:63], v[64:67], v[24:31], v3
    ds_read_b128 v[24:27], v12 offset:40960
    ds_read_b128 v[28:31], v12 offset:41984
    s_waitcnt lgkmcnt(4)
    v_smfmac_f32_16x16x64_bf16 v[60:63], v[68:71], v[96:103], v3
    ds_read_b128 v[96:99], v11 offset:8192
    ds_read_b128 v[100:103], v11 offset:9216
    ds_read_b128 v[64:67], v11 offset:40960
    ds_read_b128 v[68:71], v11 offset:41984
    s_waitcnt lgkmcnt(6)
    v_smfmac_f32_16x16x64_bf16 v[60:63], v[72:75], v[104:111], v3
    ds_read_b128 v[104:107], v12 offset:49152
    ds_read_b128 v[108:111], v12 offset:50176
    s_waitcnt lgkmcnt(6)
    v_smfmac_f32_16x16x64_bf16 v[60:63], v[76:79], v[24:31], v3
    ds_read_b128 v[24:27], v11 offset:16384
    ds_read_b128 v[28:31], v11 offset:17408
    ds_read_b128 v[72:75], v11 offset:49152
    ds_read_b128 v[76:79], v11 offset:50176
    s_waitcnt lgkmcnt(8)
    v_smfmac_f32_16x16x64_bf16 v[60:63], v[80:83], v[96:103], v3
    ds_read_b128 v[96:99], v12 offset:57344
    ds_read_b128 v[100:103], v12 offset:58368
    s_waitcnt lgkmcnt(8)
    v_smfmac_f32_16x16x64_bf16 v[60:63], v[84:87], v[64:71], v3
    ds_read_b128 v[64:67], v11 offset:24576
    ds_read_b128 v[68:71], v11 offset:25600
    buffer_load_dwordx4 v[32:35], v9, s[20:23], s40 offen sc1
    buffer_load_dwordx4 v[36:39], v9, s[20:23], s40 offen offset:2048 sc1
    buffer_load_dwordx2 v[40:41], v10, s[20:23], s40 offen sc1
    buffer_load_dwordx2 v[42:43], v10, s[20:23], s40 offen offset:2048 sc1
    s_waitcnt lgkmcnt(8)
    v_smfmac_f32_16x16x64_bf16 v[60:63], v[88:91], v[104:111], v3
    ds_read_b128 v[80:83], v11 offset:57344
    ds_read_b128 v[84:87], v11 offset:58368
    s_waitcnt lgkmcnt(8)
    v_smfmac_f32_16x16x64_bf16 v[60:63], v[92:95], v[24:31], v3
    s_waitcnt lgkmcnt(6)
    v_smfmac_f32_16x16x64_bf16 v[60:63], v[112:115], v[72:79], v3
    s_waitcnt lgkmcnt(4)
    v_smfmac_f32_16x16x64_bf16 v[60:63], v[116:119], v[96:103], v3
    s_waitcnt lgkmcnt(2)
    v_smfmac_f32_16x16x64_bf16 v[60:63], v[120:123], v[64:71], v3
    s_waitcnt lgkmcnt(0)
    v_smfmac_f32_16x16x64_bf16 v[60:63], v[124:127], v[80:87], v3
    s_nop 7
    v_mov_b32 v24, v60
    v_mov_b32 v25, v61
    v_mov_b32 v26, v62
    v_mov_b32 v27, v63
    v_permlane32_swap_b32 v24, v60
    v_permlane32_swap_b32 v25, v61
    v_permlane32_swap_b32 v26, v62
    v_permlane32_swap_b32 v27, v63
    v_add_f32 v24, v24, v60
    v_add_f32 v25, v25, v61
    v_add_f32 v26, v26, v62
    v_add_f32 v27, v27, v63
    v_cvt_pk_bf16_f32 v22, v24, v25
    v_cvt_pk_bf16_f32 v23, v26, v27
    s_cmp_eq_u32 s39, 63
    s_cbranch_scc1 mega_kernel_ch_s2_last
    s_cmp_ge_u32 s39, 60
    s_cbranch_scc1 mega_kernel_ch_s2_e1
mega_kernel_ch_s2_e1r:
    s_waitcnt vmcnt(0)
mega_kernel_ch_s2_sp_c:
    v_max3_u32 v28, v32, v34, v36
    v_max3_u32 v28, v28, v38, v40
    v_max_u32 v28, v28, v42
    v_cmp_eq_u32 vcc, -1, v28
    s_cbranch_vccnz mega_kernel_ch_s2_sp_f
mega_kernel_ch_s2_sp_ok:
    v_add_f32 v64, v32, v36
    v_add_f32 v65, v33, v37
    v_add_f32 v66, v34, v38
    v_add_f32 v67, v35, v39
    v_add_f32 v68, v40, v42
    v_add_f32 v69, v41, v43
    v_max3_f32 v70, v64, v65, v66
    v_max3_f32 v70, v70, v67, v68
    v_max_f32 v70, v70, v69
    s_nop 1
    v_max_f32_dpp v70, v70, v70 row_ror:8 row_mask:0xf bank_mask:0xf
    v_mov_b32 v71, v70
    s_nop 1
    v_permlane16_swap_b32 v71, v70
    v_max_f32 v70, v70, v71
    v_mov_b32 v71, v70
    s_nop 1
    v_permlane32_swap_b32 v71, v70
    v_max_f32 v70, v70, v71
    v_mul_f32 v70, s52, v70
    v_fma_f32 v64, v64, s52, -v70
    v_fma_f32 v65, v65, s52, -v70
    v_fma_f32 v66, v66, s52, -v70
    v_fma_f32 v67, v67, s52, -v70
    v_fma_f32 v68, v68, s52, -v70
    v_fma_f32 v69, v69, s52, -v70
    v_exp_f32 v64, v64
    v_exp_f32 v65, v65
    v_exp_f32 v66, v66
    v_exp_f32 v67, v67
    v_exp_f32 v68, v68
    v_exp_f32 v69, v69
    v_cvt_pk_bf16_f32 v72, v64, v65
    v_cvt_pk_bf16_f32 v73, v66, v67
    v_cvt_pk_bf16_f32 v76, v68, v69
    v_mov_b32_dpp v74, v72 row_ror:8 row_mask:0xf bank_mask:0xf
    v_mov_b32_dpp v75, v73 row_ror:8 row_mask:0xf bank_mask:0xf
    v_mov_b32_dpp v77, v76 row_ror:8 row_mask:0xf bank_mask:0xf
    s_nop 0
    v_mfma_f32_16x16x32_bf16 v[80:83], v[44:47], v[72:75], 0
    s_nop 5
    v_mfma_f32_16x16x16bf16_1k v[80:83], v[22:23], v[76:77], v[80:83]
    v_add_f32 v70, v64, v65
    v_add_f32 v71, v66, v67
    v_add_f32 v70, v70, v68
    v_add_f32 v71, v71, v69
    v_add_f32 v70, v70, v71
    s_nop 1
    v_add_f32_dpp v70, v70, v70 row_ror:8 row_mask:0xf bank_mask:0xf
    v_mov_b32 v71, v70
    s_nop 1
    v_permlane16_swap_b32 v71, v70
    v_add_f32 v70, v70, v71
    v_mov_b32 v71, v70
    s_nop 1
    v_permlane32_swap_b32 v71, v70
    v_add_f32 v70, v70, v71
    v_rcp_f32 v70, v70
    s_nop 0
    v_mul_f32 v80, v80, v70
    v_mul_f32 v81, v81, v70
    v_mul_f32 v82, v82, v70
    v_mul_f32 v83, v83, v70
    v_cvt_pk_bf16_f32 v84, v80, v81
    v_cvt_pk_bf16_f32 v85, v82, v83
    buffer_store_dwordx2 v[84:85], v13, s[20:23], s40 offen sc1
    ds_read_b128 v[24:27], v12 offset:0
    ds_read_b128 v[28:31], v12 offset:1024
    ds_read_b128 v[120:123], v12 offset:8192
    ds_read_b128 v[124:127], v12 offset:9216
    s_add_u32 s44, s41, s92
    s_add_u32 s45, s41, s93
    s_add_u32 s47, s47, 262144
    s_xor_b32 s42, s41, 524288
    s_add_u32 s56, s39, 2
    s_lshr_b32 s56, s56, 2
    s_lshl_b32 s56, s56, 10
    s_add_u32 s32, s56, s91
    s_lshl_b32 s56, s39, 13
    s_add_u32 s33, s56, s94
    v_mov_b32 v32, 0
    v_mov_b32 v33, 0
    v_mov_b32 v34, 0
    v_mov_b32 v35, 0
    v_mov_b32 v36, 0
    v_mov_b32 v37, 0
    v_mov_b32 v38, 0
    v_mov_b32 v39, 0
    v_mov_b32 v112, 0
    v_mov_b32 v113, 0
    v_mov_b32 v114, 0
    v_mov_b32 v115, 0
    v_mov_b32 v116, 0
    v_mov_b32 v117, 0
    v_mov_b32 v118, 0
    v_mov_b32 v119, 0
    s_sleep 6
    buffer_load_dwordx4 v[96:99], v14, s[20:23], s40 offen offset:0 sc1
    buffer_load_dwordx4 v[100:103], v14, s[20:23], s40 offen offset:1024 sc1
    buffer_load_dwordx4 v[104:107], v14, s[20:23], s40 offen offset:2048 sc1
    buffer_load_dwordx4 v[108:111], v14, s[20:23], s40 offen offset:3072 sc1
    s_waitcnt vmcnt(3)
mega_kernel_ch_s2_oc0:
    v_max_u32 v40, v96, v98
    v_cmp_eq_u32 vcc, -1, v40
    s_cbranch_vccnz mega_kernel_ch_s2_oc0_f
mega_kernel_ch_s2_oc0_ok:
    v_smfmac_f32_16x16x64_bf16 v[32:35], v[96:99], v[128:135], v3
    v_smfmac_f32_16x16x64_bf16 v[36:39], v[96:99], v[136:143], v3
    v_smfmac_f32_16x16x64_bf16 v[112:115], v[96:99], v[144:151], v3
    v_smfmac_f32_16x16x64_bf16 v[116:119], v[96:99], v[152:159], v3
    s_waitcnt vmcnt(2)
mega_kernel_ch_s2_oc1:
    v_max_u32 v40, v100, v102
    v_cmp_eq_u32 vcc, -1, v40
    s_cbranch_vccnz mega_kernel_ch_s2_oc1_f
mega_kernel_ch_s2_oc1_ok:
    v_smfmac_f32_16x16x64_bf16 v[32:35], v[100:103], v[160:167], v3
    v_smfmac_f32_16x16x64_bf16 v[36:39], v[100:103], v[168:175], v3
    v_smfmac_f32_16x16x64_bf16 v[112:115], v[100:103], v[176:183], v3
    v_smfmac_f32_16x16x64_bf16 v[116:119], v[100:103], v[184:191], v3
    s_waitcnt vmcnt(1)
mega_kernel_ch_s2_oc2:
    v_max_u32 v40, v104, v106
    v_cmp_eq_u32 vcc, -1, v40
    s_cbranch_vccnz mega_kernel_ch_s2_oc2_f
mega_kernel_ch_s2_oc2_ok:
    v_smfmac_f32_16x16x64_bf16 v[32:35], v[104:107], v[192:199], v3
    v_smfmac_f32_16x16x64_bf16 v[36:39], v[104:107], v[200:207], v3
    v_smfmac_f32_16x16x64_bf16 v[112:115], v[104:107], v[208:215], v3
    v_smfmac_f32_16x16x64_bf16 v[116:119], v[104:107], v[216:223], v3
    s_waitcnt vmcnt(0)
mega_kernel_ch_s2_oc3:
    v_max_u32 v40, v108, v110
    v_cmp_eq_u32 vcc, -1, v40
    s_cbranch_vccnz mega_kernel_ch_s2_oc3_f
mega_kernel_ch_s2_oc3_ok:
    v_smfmac_f32_16x16x64_bf16 v[32:35], v[108:111], v[224:231], v3
    v_smfmac_f32_16x16x64_bf16 v[36:39], v[108:111], v[232:239], v3
    v_smfmac_f32_16x16x64_bf16 v[112:115], v[108:111], v[240:247], v3
    v_smfmac_f32_16x16x64_bf16 v[116:119], v[108:111], v[248:255], v3
    s_nop 5
    v_permlane32_swap_b32 v32, v36
    v_permlane32_swap_b32 v33, v37
    v_permlane32_swap_b32 v34, v38
    v_permlane32_swap_b32 v35, v39
    v_add_f32 v32, v32, v36
    v_add_f32 v33, v33, v37
    v_add_f32 v34, v34, v38
    v_add_f32 v35, v35, v39
    ds_write_b128 v15, v[32:35]
    v_permlane32_swap_b32 v112, v116
    v_permlane32_swap_b32 v113, v117
    v_permlane32_swap_b32 v114, v118
    v_permlane32_swap_b32 v115, v119
    v_add_f32 v112, v112, v116
    v_add_f32 v113, v113, v117
    v_add_f32 v114, v114, v118
    v_add_f32 v115, v115, v119
    ds_write_b128 v15, v[112:115] offset:1024
    s_waitcnt lgkmcnt(0)
    s_barrier
    s_cmp_ge_u32 s39, 60
    s_cbranch_scc1 mega_kernel_ch_s2_e2
mega_kernel_ch_s2_e2r:
    s_bfe_u32 s59, s39, 0x10001
    ds_read_b128 v[96:99], v16 offset:0
    ds_read_b128 v[100:103], v16 offset:2048
    ds_read_b128 v[104:107], v16 offset:4096
    ds_read_b128 v[108:111], v16 offset:6144
    buffer_store_dwordx2 v[22:23], v20, s[28:31], s48 offen sc1
    v_xor_b32 v116, 139264, v19
    s_waitcnt lgkmcnt(2)
    v_add_f32 v96, v96, v100
    v_add_f32 v97, v97, v101
    v_add_f32 v98, v98, v102
    v_add_f32 v99, v99, v103
    s_waitcnt lgkmcnt(0)
    v_add_f32 v104, v104, v108
    v_add_f32 v105, v105, v109
    v_add_f32 v106, v106, v110
    v_add_f32 v107, v107, v111
    v_add_f32 v96, v96, v104
    v_add_f32 v97, v97, v105
    v_add_f32 v98, v98, v106
    v_add_f32 v99, v99, v107
    v_bfi_b32 v96, 1, s59, v96
    v_bfi_b32 v98, 1, s59, v98
    buffer_store_dwordx4 v[96:99], v19, s[20:23], s49 offen sc1
    buffer_store_dwordx4 v[96:99], v116, s[20:23], s49 offen sc1
    s_sleep 6
    buffer_load_dwordx4 v[72:75], v1, s[20:23], s49 offen sc1
    s_sleep 3
    buffer_load_dwordx4 v[76:79], v1, s[20:23], s49 offen sc1
    s_sleep 3
    buffer_load_dwordx4 v[80:83], v1, s[20:23], s49 offen sc1
    s_waitcnt vmcnt(2)
    v_bitop3_b32 v112, v72, v74, s59 bitop3:0x7e
    v_and_b32 v112, 1, v112
    v_cmp_ne_u32 vcc, 0, v112
    s_cbranch_vccnz mega_kernel_ch_s2_xf0
    v_permlane32_swap_b32 v72, v73
    v_permlane32_swap_b32 v74, v75
    v_add_f32 v114, v72, v73
    v_add_f32 v115, v74, v75
mega_kernel_ch_s2_xok:
    s_nop 1
    v_permlane16_swap_b32 v114, v115
    v_add_f32 v114, v114, v115
    s_nop 1
    v_mov_b32_dpp v115, v114 quad_perm:[1,1,3,3] row_mask:0xf bank_mask:0xf
    v_cvt_pk_bf16_f32 v112, v114, v115
    s_nop 1
    v_mov_b32_dpp v113, v112 quad_perm:[2,2,2,2] row_mask:0xf bank_mask:0xf
    buffer_store_dwordx2 v[112:113], v17, s[20:23], s41 offen sc1
    s_branch mega_kernel_ch_s2_top
mega_kernel_ch_s2_last:
    buffer_store_dwordx2 v[22:23], v20, s[28:31], s48 offen sc1
    s_waitcnt vmcnt(0)
    s_barrier
    s_add_u32 s33, s33, 8192
    s_mov_b64 exec, 1
    buffer_store_dword v56, off, s[16:19], s33 sc1
    s_mov_b64 exec, -1
    s_waitcnt vmcnt(0)
    s_branch mega_kernel_ch_fin
mega_kernel_ch_s2_tc0_f:
    s_cmp_eq_u32 s43, 0
    s_cbranch_scc1 mega_kernel_ch_s2_tc0_ok
    s_mov_b32 s90, 0
    s_branch mega_kernel_ch_s2_tretry
mega_kernel_ch_s2_tc1_f:
    s_cmp_eq_u32 s43, 0
    s_cbranch_scc1 mega_kernel_ch_s2_tc1_ok
    s_mov_b32 s90, 1
    s_branch mega_kernel_ch_s2_tretry
mega_kernel_ch_s2_tc2_f:
    s_cmp_eq_u32 s43, 0
    s_cbranch_scc1 mega_kernel_ch_s2_tc2_ok
    s_mov_b32 s90, 2
    s_branch mega_kernel_ch_s2_tretry
mega_kernel_ch_s2_tc3_f:
    s_cmp_eq_u32 s43, 0
    s_cbranch_scc1 mega_kernel_ch_s2_tc3_ok
    s_mov_b32 s90, 3
    s_branch mega_kernel_ch_s2_tretry
mega_kernel_ch_s2_tretry:
    s_sub_u32 s43, s43, 1
    s_waitcnt vmcnt(0)
    v_max_u32 v40, v96, v98
    v_cmp_eq_u32 vcc, -1, v40
    s_cbranch_vccz mega_kernel_ch_s2_tr_L0
    buffer_load_dwordx4 v[96:99], v2, s[20:23], s44 offen offset:0 sc1
mega_kernel_ch_s2_tr_L0:
    v_max_u32 v40, v100, v102
    v_cmp_eq_u32 vcc, -1, v40
    s_cbranch_vccz mega_kernel_ch_s2_tr_L1
    buffer_load_dwordx4 v[100:103], v2, s[20:23], s44 offen offset:1024 sc1
mega_kernel_ch_s2_tr_L1:
    v_max_u32 v40, v104, v106
    v_cmp_eq_u32 vcc, -1, v40
    s_cbranch_vccz mega_kernel_ch_s2_tr_L2
    buffer_load_dwordx4 v[104:107], v2, s[20:23], s44 offen offset:2048 sc1
mega_kernel_ch_s2_tr_L2:
    v_max_u32 v40, v108, v110
    v_cmp_eq_u32 vcc, -1, v40
    s_cbranch_vccz mega_kernel_ch_s2_tr_L3
    buffer_load_dwordx4 v[108:111], v2, s[20:23], s44 offen offset:3072 sc1
mega_kernel_ch_s2_tr_L3:
    s_waitcnt vmcnt(0)
    s_cmp_eq_u32 s90, 0
    s_cbranch_scc1 mega_kernel_ch_s2_tc0
    s_cmp_eq_u32 s90, 1
    s_cbranch_scc1 mega_kernel_ch_s2_tc1
    s_cmp_eq_u32 s90, 2
    s_cbranch_scc1 mega_kernel_ch_s2_tc2
    s_branch mega_kernel_ch_s2_tc3
mega_kernel_ch_s2_e1:
    buffer_store_dwordx2 v[22:23], v20, s[28:31], s48 offen sc1
    s_branch mega_kernel_ch_s2_e1r
mega_kernel_ch_s2_sp_f:
    s_cmp_eq_u32 s43, 0
    s_cbranch_scc1 mega_kernel_ch_s2_sp_ok
    s_sub_u32 s43, s43, 1
    buffer_load_dwordx4 v[32:35], v9, s[20:23], s40 offen sc1
    buffer_load_dwordx4 v[36:39], v9, s[20:23], s40 offen offset:2048 sc1
    buffer_load_dwordx2 v[40:41], v10, s[20:23], s40 offen sc1
    buffer_load_dwordx2 v[42:43], v10, s[20:23], s40 offen offset:2048 sc1
    s_waitcnt vmcnt(0)
    s_branch mega_kernel_ch_s2_sp_c
mega_kernel_ch_s2_oc0_f:
    s_cmp_eq_u32 s43, 0
    s_cbranch_scc1 mega_kernel_ch_s2_oc0_ok
    s_mov_b32 s90, 0
    s_branch mega_kernel_ch_s2_oretry
mega_kernel_ch_s2_oc1_f:
    s_cmp_eq_u32 s43, 0
    s_cbranch_scc1 mega_kernel_ch_s2_oc1_ok
    s_mov_b32 s90, 1
    s_branch mega_kernel_ch_s2_oretry
mega_kernel_ch_s2_oc2_f:
    s_cmp_eq_u32 s43, 0
    s_cbranch_scc1 mega_kernel_ch_s2_oc2_ok
    s_mov_b32 s90, 2
    s_branch mega_kernel_ch_s2_oretry
mega_kernel_ch_s2_oc3_f:
    s_cmp_eq_u32 s43, 0
    s_cbranch_scc1 mega_kernel_ch_s2_oc3_ok
    s_mov_b32 s90, 3
    s_branch mega_kernel_ch_s2_oretry
mega_kernel_ch_s2_oretry:
    s_sub_u32 s43, s43, 1
    s_waitcnt vmcnt(0)
    v_max_u32 v40, v96, v98
    v_cmp_eq_u32 vcc, -1, v40
    s_cbranch_vccz mega_kernel_ch_s2_or_0
    buffer_load_dwordx4 v[96:99], v14, s[20:23], s40 offen offset:0 sc1
mega_kernel_ch_s2_or_0:
    v_max_u32 v40, v100, v102
    v_cmp_eq_u32 vcc, -1, v40
    s_cbranch_vccz mega_kernel_ch_s2_or_1
    buffer_load_dwordx4 v[100:103], v14, s[20:23], s40 offen offset:1024 sc1
mega_kernel_ch_s2_or_1:
    v_max_u32 v40, v104, v106
    v_cmp_eq_u32 vcc, -1, v40
    s_cbranch_vccz mega_kernel_ch_s2_or_2
    buffer_load_dwordx4 v[104:107], v14, s[20:23], s40 offen offset:2048 sc1
mega_kernel_ch_s2_or_2:
    v_max_u32 v40, v108, v110
    v_cmp_eq_u32 vcc, -1, v40
    s_cbranch_vccz mega_kernel_ch_s2_or_3
    buffer_load_dwordx4 v[108:111], v14, s[20:23], s40 offen offset:3072 sc1
mega_kernel_ch_s2_or_3:
    s_waitcnt vmcnt(0)
    s_cmp_eq_u32 s90, 0
    s_cbranch_scc1 mega_kernel_ch_s2_oc0
    s_cmp_eq_u32 s90, 1
    s_cbranch_scc1 mega_kernel_ch_s2_oc1
    s_cmp_eq_u32 s90, 2
    s_cbranch_scc1 mega_kernel_ch_s2_oc2
    s_branch mega_kernel_ch_s2_oc3
mega_kernel_ch_s2_e2:
    s_mov_b64 exec, 1
    buffer_store_dword v56, off, s[16:19], s33 sc1
    s_mov_b64 exec, -1
    s_branch mega_kernel_ch_s2_e2r
mega_kernel_ch_s2_xf0:
    s_cmp_eq_u32 s43, 0
    s_cbranch_scc1 mega_kernel_ch_s2_xok
    s_sub_u32 s43, s43, 1
    buffer_load_dwordx4 v[72:75], v1, s[20:23], s49 offen sc1
    s_waitcnt vmcnt(2)
    v_bitop3_b32 v112, v76, v78, s59 bitop3:0x7e
    v_and_b32 v112, 1, v112
    v_cmp_ne_u32 vcc, 0, v112
    s_cbranch_vccnz mega_kernel_ch_s2_xg1
    v_permlane32_swap_b32 v76, v77
    v_permlane32_swap_b32 v78, v79
    v_add_f32 v114, v76, v77
    v_add_f32 v115, v78, v79
    s_branch mega_kernel_ch_s2_xok
mega_kernel_ch_s2_xg1:
    buffer_load_dwordx4 v[76:79], v1, s[20:23], s49 offen sc1
    s_waitcnt vmcnt(2)
    v_bitop3_b32 v112, v80, v82, s59 bitop3:0x7e
    v_and_b32 v112, 1, v112
    v_cmp_ne_u32 vcc, 0, v112
    s_cbranch_vccnz mega_kernel_ch_s2_xg2
    v_permlane32_swap_b32 v80, v81
    v_permlane32_swap_b32 v82, v83
    v_add_f32 v114, v80, v81
    v_add_f32 v115, v82, v83
    s_branch mega_kernel_ch_s2_xok
mega_kernel_ch_s2_xg2:
    buffer_load_dwordx4 v[80:83], v1, s[20:23], s49 offen sc1
    s_waitcnt vmcnt(2)
    v_bitop3_b32 v112, v72, v74, s59 bitop3:0x7e
    v_and_b32 v112, 1, v112
    v_cmp_ne_u32 vcc, 0, v112
    s_cbranch_vccnz mega_kernel_ch_s2_xf0
    v_permlane32_swap_b32 v72, v73
    v_permlane32_swap_b32 v74, v75
    v_add_f32 v114, v72, v73
    v_add_f32 v115, v74, v75
    s_branch mega_kernel_ch_s2_xok
mega_kernel_ch_s3_top:
    s_sleep 4
    buffer_load_dwordx4 v[96:99], v2, s[20:23], s44 offen offset:0 sc1
    buffer_load_dwordx4 v[100:103], v2, s[20:23], s44 offen offset:1024 sc1
    buffer_load_dwordx4 v[104:107], v2, s[20:23], s44 offen offset:2048 sc1
    buffer_load_dwordx4 v[108:111], v2, s[20:23], s44 offen offset:3072 sc1
    buffer_load_dwordx4 v[44:47], v5, s[24:27], s47 offen sc1
    s_add_u32 s39, s39, 1
    s_mov_b32 s40, s41
    s_add_u32 s46, s40, 4096
    s_add_u32 s41, s40, 262144
    s_and_b32 s41, s41, 1048575
    s_and_b32 s49, s41, 262144
    s_add_u32 s49, s49, 1048576
    s_add_u32 s48, s48, 65536
    v_mov_b32 v48, 0
    v_mov_b32 v49, 0
    v_mov_b32 v50, 0
    v_mov_b32 v51, 0
    v_mov_b32 v52, 0
    v_mov_b32 v53, 0
    v_mov_b32 v54, 0
    v_mov_b32 v55, 0
    v_mov_b32 v60, 0
    v_mov_b32 v61, 0
    v_mov_b32 v62, 0
    v_mov_b32 v63, 0
    s_waitcnt vmcnt(4)
mega_kernel_ch_s3_tc0:
    v_max_u32 v40, v96, v98
    v_cmp_eq_u32 vcc, -1, v40
    s_cbranch_vccnz mega_kernel_ch_s3_tc0_f
mega_kernel_ch_s3_tc0_ok:
    ds_write_b128 v2, v[96:99] offset:12288
    v_smfmac_f32_16x16x64_bf16 v[48:51], v[96:99], a[96:103], v3
    v_smfmac_f32_16x16x64_bf16 v[52:55], v[96:99], a[224:231], v3
    v_smfmac_f32_16x16x64_bf16 v[60:63], v[96:99], v[24:31], v3
    s_waitcnt vmcnt(3)
mega_kernel_ch_s3_tc1:
    v_max_u32 v40, v100, v102
    v_cmp_eq_u32 vcc, -1, v40
    s_cbranch_vccnz mega_kernel_ch_s3_tc1_f
mega_kernel_ch_s3_tc1_ok:
    ds_write_b128 v2, v[100:103] offset:13312
    v_smfmac_f32_16x16x64_bf16 v[48:51], v[100:103], a[104:111], v3
    v_smfmac_f32_16x16x64_bf16 v[52:55], v[100:103], a[232:239], v3
    v_smfmac_f32_16x16x64_bf16 v[60:63], v[100:103], v[120:127], v3
    s_waitcnt vmcnt(2)
mega_kernel_ch_s3_tc2:
    v_max_u32 v40, v104, v106
    v_cmp_eq_u32 vcc, -1, v40
    s_cbranch_vccnz mega_kernel_ch_s3_tc2_f
mega_kernel_ch_s3_tc2_ok:
    ds_write_b128 v2, v[104:107] offset:14336
    v_smfmac_f32_16x16x64_bf16 v[48:51], v[104:107], a[112:119], v3
    v_smfmac_f32_16x16x64_bf16 v[52:55], v[104:107], a[240:247], v3
    s_waitcnt vmcnt(1)
mega_kernel_ch_s3_tc3:
    v_max_u32 v40, v108, v110
    v_cmp_eq_u32 vcc, -1, v40
    s_cbranch_vccnz mega_kernel_ch_s3_tc3_f
mega_kernel_ch_s3_tc3_ok:
    ds_write_b128 v2, v[108:111] offset:15360
    v_smfmac_f32_16x16x64_bf16 v[48:51], v[108:111], a[120:127], v3
    v_smfmac_f32_16x16x64_bf16 v[52:55], v[108:111], a[248:255], v3
    s_waitcnt lgkmcnt(0)
    s_barrier
    ds_read_b128 v[64:67], v2 offset:0
    ds_read_b128 v[68:71], v2 offset:4096
    ds_read_b128 v[72:75], v2 offset:8192
    ds_read_b128 v[76:79], v2 offset:1024
    ds_read_b128 v[80:83], v2 offset:5120
    ds_read_b128 v[84:87], v2 offset:9216
    ds_read_b128 v[88:91], v2 offset:2048
    ds_read_b128 v[92:95], v2 offset:6144
    ds_read_b128 v[112:115], v2 offset:10240
    ds_read_b128 v[116:119], v2 offset:3072
    ds_read_b128 v[120:123], v2 offset:7168
    ds_read_b128 v[124:127], v2 offset:11264
    buffer_store_dwordx4 v[56:59], v18, s[20:23], s42 offen sc1
    s_add_u32 s56, s47, 262144
    buffer_load_dword v0, v21, s[24:27], s56 offen sc1
    buffer_load_dword v0, v8, s[16:19], s32 offen sc1
    s_waitcnt lgkmcnt(11)
    v_smfmac_f32_16x16x64_bf16 v[48:51], v[64:67], a[0:7], v3
    v_smfmac_f32_16x16x64_bf16 v[52:55], v[64:67], a[128:135], v3
    s_waitcnt lgkmcnt(10)
    v_smfmac_f32_16x16x64_bf16 v[48:51], v[68:71], a[32:39], v3
    v_smfmac_f32_16x16x64_bf16 v[52:55], v[68:71], a[160:167], v3
    s_waitcnt lgkmcnt(9)
    v_smfmac_f32_16x16x64_bf16 v[48:51], v[72:75], a[64:71], v3
    v_smfmac_f32_16x16x64_bf16 v[52:55], v[72:75], a[192:199], v3
    s_waitcnt lgkmcnt(8)
    v_smfmac_f32_16x16x64_bf16 v[48:51], v[76:79], a[8:15], v3
    v_smfmac_f32_16x16x64_bf16 v[52:55], v[76:79], a[136:143], v3
    s_waitcnt lgkmcnt(7)
    v_smfmac_f32_16x16x64_bf16 v[48:51], v[80:83], a[40:47], v3
    v_smfmac_f32_16x16x64_bf16 v[52:55], v[80:83], a[168:175], v3
    s_waitcnt lgkmcnt(6)
    v_smfmac_f32_16x16x64_bf16 v[48:51], v[84:87], a[72:79], v3
    v_smfmac_f32_16x16x64_bf16 v[52:55], v[84:87], a[200:207], v3
    s_waitcnt lgkmcnt(5)
    v_smfmac_f32_16x16x64_bf16 v[48:51], v[88:91], a[16:23], v3
    v_smfmac_f32_16x16x64_bf16 v[52:55], v[88:91], a[144:151], v3
    s_waitcnt lgkmcnt(4)
    v_smfmac_f32_16x16x64_bf16 v[48:51], v[92:95], a[48:55], v3
    v_smfmac_f32_16x16x64_bf16 v[52:55], v[92:95], a[176:183], v3
    s_waitcnt lgkmcnt(3)
    v_smfmac_f32_16x16x64_bf16 v[48:51], v[112:115], a[80:87], v3
    v_smfmac_f32_16x16x64_bf16 v[52:55], v[112:115], a[208:215], v3
    s_waitcnt lgkmcnt(2)
    v_smfmac_f32_16x16x64_bf16 v[48:51], v[116:119], a[24:31], v3
    v_smfmac_f32_16x16x64_bf16 v[52:55], v[116:119], a[152:159], v3
    s_waitcnt lgkmcnt(1)
    v_smfmac_f32_16x16x64_bf16 v[48:51], v[120:123], a[56:63], v3
    v_smfmac_f32_16x16x64_bf16 v[52:55], v[120:123], a[184:191], v3
    s_waitcnt lgkmcnt(0)
    v_smfmac_f32_16x16x64_bf16 v[48:51], v[124:127], a[88:95], v3
    v_smfmac_f32_16x16x64_bf16 v[52:55], v[124:127], a[216:223], v3
    s_nop 7
    v_permlane32_swap_b32 v48, v52
    v_permlane32_swap_b32 v49, v53
    v_permlane32_swap_b32 v50, v54
    v_permlane32_swap_b32 v51, v55
    v_add_f32 v48, v48, v52
    v_add_f32 v49, v49, v53
    v_add_f32 v50, v50, v54
    v_add_f32 v51, v51, v55
    v_cvt_pk_bf16_f32 v52, v48, v49
    v_cvt_pk_bf16_f32 v53, v50, v51
    ds_write_b64 v6, v[52:53]
    s_waitcnt lgkmcnt(0)
    s_barrier
    ds_read_b128 v[24:27], v12 offset:49152
    ds_read_b128 v[28:31], v12 offset:50176
    ds_read_b128 v[96:99], v12 offset:57344
    ds_read_b128 v[100:103], v12 offset:58368
    s_waitcnt lgkmcnt(2)
    v_smfmac_f32_16x16x64_bf16 v[60:63], v[104:107], v[24:31], v3
    ds_read_b128 v[24:27], v11 offset:0
    ds_read_b128 v[28:31], v11 offset:1024
    s_waitcnt lgkmcnt(2)
    v_smfmac_f32_16x16x64_bf16 v[60:63], v[108:111], v[96:103], v3
    ds_read_b128 v[96:99], v11 offset:32768
    ds_read_b128 v[100:103], v11 offset:33792
    ds_read_b128 v[104:107], v12 offset:0
    ds_read_b128 v[108:111], v12 offset:1024
    s_waitcnt lgkmcnt(4)
    v_smfmac_f32_16x16x64_bf16 v[60:63], v[64:67], v[24:31], v3
    ds_read_b128 v[24:27], v11 offset:8192
    ds_read_b128 v[28:31], v11 offset:9216
    s_waitcnt lgkmcnt(4)
    v_smfmac_f32_16x16x64_bf16 v[60:63], v[68:71], v[96:103], v3
    ds_read_b128 v[96:99], v11 offset:40960
    ds_read_b128 v[100:103], v11 offset:41984
    ds_read_b128 v[64:67], v12 offset:8192
    ds_read_b128 v[68:71], v12 offset:9216
    s_waitcnt lgkmcnt(6)
    v_smfmac_f32_16x16x64_bf16 v[60:63], v[72:75], v[104:111], v3
    ds_read_b128 v[104:107], v11 offset:16384
    ds_read_b128 v[108:111], v11 offset:17408
    s_waitcnt lgkmcnt(6)
    v_smfmac_f32_16x16x64_bf16 v[60:63], v[76:79], v[24:31], v3
    ds_read_b128 v[24:27], v11 offset:49152
    ds_read_b128 v[28:31], v11 offset:50176
    ds_read_b128 v[72:75], v12 offset:16384
    ds_read_b128 v[76:79], v12 offset:17408
    s_waitcnt lgkmcnt(8)
    v_smfmac_f32_16x16x64_bf16 v[60:63], v[80:83], v[96:103], v3
    ds_read_b128 v[96:99], v11 offset:24576
    ds_read_b128 v[100:103], v11 offset:25600
    s_waitcnt lgkmcnt(8)
    v_smfmac_f32_16x16x64_bf16 v[60:63], v[84:87], v[64:71], v3
    ds_read_b128 v[64:67], v11 offset:57344
    ds_read_b128 v[68:71], v11 offset:58368
    buffer_load_dwordx4 v[32:35], v9, s[20:23], s40 offen sc1
    buffer_load_dwordx4 v[36:39], v9, s[20:23], s40 offen offset:2048 sc1
    buffer_load_dwordx2 v[40:41], v10, s[20:23], s40 offen sc1
    buffer_load_dwordx2 v[42:43], v10, s[20:23], s40 offen offset:2048 sc1
    s_waitcnt lgkmcnt(8)
    v_smfmac_f32_16x16x64_bf16 v[60:63], v[88:91], v[104:111], v3
    ds_read_b128 v[80:83], v12 offset:24576
    ds_read_b128 v[84:87], v12 offset:25600
    s_waitcnt lgkmcnt(8)
    v_smfmac_f32_16x16x64_bf16 v[60:63], v[92:95], v[24:31], v3
    s_waitcnt lgkmcnt(6)
    v_smfmac_f32_16x16x64_bf16 v[60:63], v[112:115], v[72:79], v3
    s_waitcnt lgkmcnt(4)
    v_smfmac_f32_16x16x64_bf16 v[60:63], v[116:119], v[96:103], v3
    s_waitcnt lgkmcnt(2)
    v_smfmac_f32_16x16x64_bf16 v[60:63], v[120:123], v[64:71], v3
    s_waitcnt lgkmcnt(0)
    v_smfmac_f32_16x16x64_bf16 v[60:63], v[124:127], v[80:87], v3
    s_nop 7
    v_mov_b32 v24, v60
    v_mov_b32 v25, v61
    v_mov_b32 v26, v62
    v_mov_b32 v27, v63
    v_permlane32_swap_b32 v24, v60
    v_permlane32_swap_b32 v25, v61
    v_permlane32_swap_b32 v26, v62
    v_permlane32_swap_b32 v27, v63
    v_add_f32 v24, v24, v60
    v_add_f32 v25, v25, v61
    v_add_f32 v26, v26, v62
    v_add_f32 v27, v27, v63
    v_cvt_pk_bf16_f32 v22, v24, v25
    v_cvt_pk_bf16_f32 v23, v26, v27
    s_cmp_eq_u32 s39, 63
    s_cbranch_scc1 mega_kernel_ch_s3_last
    s_cmp_ge_u32 s39, 60
    s_cbranch_scc1 mega_kernel_ch_s3_e1
mega_kernel_ch_s3_e1r:
    s_waitcnt vmcnt(0)
mega_kernel_ch_s3_sp_c:
    v_max3_u32 v28, v32, v34, v36
    v_max3_u32 v28, v28, v38, v40
    v_max_u32 v28, v28, v42
    v_cmp_eq_u32 vcc, -1, v28
    s_cbranch_vccnz mega_kernel_ch_s3_sp_f
mega_kernel_ch_s3_sp_ok:
mega_kernel_ch_s3_tf:
    v_cmp_gt_u32 vcc, 4, v0
    s_cbranch_vccnz mega_kernel_ch_s3_tf_f
mega_kernel_ch_s3_tf_ok:
    v_add_f32 v64, v32, v36
    v_add_f32 v65, v33, v37
    v_add_f32 v66, v34, v38
    v_add_f32 v67, v35, v39
    v_add_f32 v68, v40, v42
    v_add_f32 v69, v41, v43
    v_max3_f32 v70, v64, v65, v66
    v_max3_f32 v70, v70, v67, v68
    v_max_f32 v70, v70, v69
    s_nop 1
    v_max_f32_dpp v70, v70, v70 row_ror:8 row_mask:0xf bank_mask:0xf
    v_mov_b32 v71, v70
    s_nop 1
    v_permlane16_swap_b32 v71, v70
    v_max_f32 v70, v70, v71
    v_mov_b32 v71, v70
    s_nop 1
    v_permlane32_swap_b32 v71, v70
    v_max_f32 v70, v70, v71
    v_mul_f32 v70, s52, v70
    v_fma_f32 v64, v64, s52, -v70
    v_fma_f32 v65, v65, s52, -v70
    v_fma_f32 v66, v66, s52, -v70
    v_fma_f32 v67, v67, s52, -v70
    v_fma_f32 v68, v68, s52, -v70
    v_fma_f32 v69, v69, s52, -v70
    v_exp_f32 v64, v64
    v_exp_f32 v65, v65
    v_exp_f32 v66, v66
    v_exp_f32 v67, v67
    v_exp_f32 v68, v68
    v_exp_f32 v69, v69
    v_cvt_pk_bf16_f32 v72, v64, v65
    v_cvt_pk_bf16_f32 v73, v66, v67
    v_cvt_pk_bf16_f32 v76, v68, v69
    v_mov_b32_dpp v74, v72 row_ror:8 row_mask:0xf bank_mask:0xf
    v_mov_b32_dpp v75, v73 row_ror:8 row_mask:0xf bank_mask:0xf
    v_mov_b32_dpp v77, v76 row_ror:8 row_mask:0xf bank_mask:0xf
    s_nop 0
    v_mfma_f32_16x16x32_bf16 v[80:83], v[44:47], v[72:75], 0
    s_nop 5
    v_mfma_f32_16x16x16bf16_1k v[80:83], v[22:23], v[76:77], v[80:83]
    v_add_f32 v70, v64, v65
    v_add_f32 v71, v66, v67
    v_add_f32 v70, v70, v68
    v_add_f32 v71, v71, v69
    v_add_f32 v70, v70, v71
    s_nop 1
    v_add_f32_dpp v70, v70, v70 row_ror:8 row_mask:0xf bank_mask:0xf
    v_mov_b32 v71, v70
    s_nop 1
    v_permlane16_swap_b32 v71, v70
    v_add_f32 v70, v70, v71
    v_mov_b32 v71, v70
    s_nop 1
    v_permlane32_swap_b32 v71, v70
    v_add_f32 v70, v70, v71
    v_rcp_f32 v70, v70
    s_nop 0
    v_mul_f32 v80, v80, v70
    v_mul_f32 v81, v81, v70
    v_mul_f32 v82, v82, v70
    v_mul_f32 v83, v83, v70
    v_cvt_pk_bf16_f32 v84, v80, v81
    v_cvt_pk_bf16_f32 v85, v82, v83
    buffer_store_dwordx2 v[84:85], v13, s[20:23], s40 offen sc1
    ds_read_b128 v[24:27], v12 offset:32768
    ds_read_b128 v[28:31], v12 offset:33792
    ds_read_b128 v[120:123], v12 offset:40960
    ds_read_b128 v[124:127], v12 offset:41984
    s_add_u32 s44, s41, s92
    s_add_u32 s45, s41, s93
    s_add_u32 s47, s47, 262144
    s_xor_b32 s42, s41, 524288
    s_add_u32 s56, s39, 2
    s_lshr_b32 s56, s56, 2
    s_lshl_b32 s56, s56, 10
    s_add_u32 s32, s56, s91
    s_lshl_b32 s56, s39, 13
    s_add_u32 s33, s56, s94
    v_mov_b32 v32, 0
    v_mov_b32 v33, 0
    v_mov_b32 v34, 0
    v_mov_b32 v35, 0
    v_mov_b32 v36, 0
    v_mov_b32 v37, 0
    v_mov_b32 v38, 0
    v_mov_b32 v39, 0
    v_mov_b32 v112, 0
    v_mov_b32 v113, 0
    v_mov_b32 v114, 0
    v_mov_b32 v115, 0
    v_mov_b32 v116, 0
    v_mov_b32 v117, 0
    v_mov_b32 v118, 0
    v_mov_b32 v119, 0
    s_sleep 6
    buffer_load_dwordx4 v[96:99], v14, s[20:23], s40 offen offset:0 sc1
    buffer_load_dwordx4 v[100:103], v14, s[20:23], s40 offen offset:1024 sc1
    buffer_load_dwordx4 v[104:107], v14, s[20:23], s40 offen offset:2048 sc1
    buffer_load_dwordx4 v[108:111], v14, s[20:23], s40 offen offset:3072 sc1
    ds_read_b64_tr_b16 v[48:49], v7 offset:0
    ds_read_b64_tr_b16 v[50:51], v7 offset:256
    ds_read_b64_tr_b16 v[52:53], v7 offset:1024
    ds_read_b64_tr_b16 v[54:55], v7 offset:1280
    s_waitcnt vmcnt(3)
mega_kernel_ch_s3_oc0:
    v_max_u32 v40, v96, v98
    v_cmp_eq_u32 vcc, -1, v40
    s_cbranch_vccnz mega_kernel_ch_s3_oc0_f
mega_kernel_ch_s3_oc0_ok:
    v_smfmac_f32_16x16x64_bf16 v[32:35], v[96:99], v[128:135], v3
    v_smfmac_f32_16x16x64_bf16 v[36:39], v[96:99], v[136:143], v3
    v_smfmac_f32_16x16x64_bf16 v[112:115], v[96:99], v[144:151], v3
    v_smfmac_f32_16x16x64_bf16 v[116:119], v[96:99], v[152:159], v3
    s_waitcnt vmcnt(2)
mega_kernel_ch_s3_oc1:
    v_max_u32 v40, v100, v102
    v_cmp_eq_u32 vcc, -1, v40
    s_cbranch_vccnz mega_kernel_ch_s3_oc1_f
mega_kernel_ch_s3_oc1_ok:
    v_smfmac_f32_16x16x64_bf16 v[32:35], v[100:103], v[160:167], v3
    v_smfmac_f32_16x16x64_bf16 v[36:39], v[100:103], v[168:175], v3
    v_smfmac_f32_16x16x64_bf16 v[112:115], v[100:103], v[176:183], v3
    v_smfmac_f32_16x16x64_bf16 v[116:119], v[100:103], v[184:191], v3
    s_waitcnt vmcnt(1)
mega_kernel_ch_s3_oc2:
    v_max_u32 v40, v104, v106
    v_cmp_eq_u32 vcc, -1, v40
    s_cbranch_vccnz mega_kernel_ch_s3_oc2_f
mega_kernel_ch_s3_oc2_ok:
    v_smfmac_f32_16x16x64_bf16 v[32:35], v[104:107], v[192:199], v3
    v_smfmac_f32_16x16x64_bf16 v[36:39], v[104:107], v[200:207], v3
    v_smfmac_f32_16x16x64_bf16 v[112:115], v[104:107], v[208:215], v3
    v_smfmac_f32_16x16x64_bf16 v[116:119], v[104:107], v[216:223], v3
    s_waitcnt vmcnt(0)
mega_kernel_ch_s3_oc3:
    v_max_u32 v40, v108, v110
    v_cmp_eq_u32 vcc, -1, v40
    s_cbranch_vccnz mega_kernel_ch_s3_oc3_f
mega_kernel_ch_s3_oc3_ok:
    v_smfmac_f32_16x16x64_bf16 v[32:35], v[108:111], v[224:231], v3
    v_smfmac_f32_16x16x64_bf16 v[36:39], v[108:111], v[232:239], v3
    v_smfmac_f32_16x16x64_bf16 v[112:115], v[108:111], v[240:247], v3
    v_smfmac_f32_16x16x64_bf16 v[116:119], v[108:111], v[248:255], v3
    s_nop 5
    v_permlane32_swap_b32 v32, v36
    v_permlane32_swap_b32 v33, v37
    v_permlane32_swap_b32 v34, v38
    v_permlane32_swap_b32 v35, v39
    v_add_f32 v32, v32, v36
    v_add_f32 v33, v33, v37
    v_add_f32 v34, v34, v38
    v_add_f32 v35, v35, v39
    ds_write_b128 v15, v[32:35]
    v_permlane32_swap_b32 v112, v116
    v_permlane32_swap_b32 v113, v117
    v_permlane32_swap_b32 v114, v118
    v_permlane32_swap_b32 v115, v119
    v_add_f32 v112, v112, v116
    v_add_f32 v113, v113, v117
    v_add_f32 v114, v114, v118
    v_add_f32 v115, v115, v119
    ds_write_b128 v15, v[112:115] offset:1024
    s_waitcnt lgkmcnt(0)
    s_barrier
    s_bfe_u32 s59, s39, 0x10001
    ds_read_b128 v[96:99], v16 offset:0
    ds_read_b128 v[100:103], v16 offset:2048
    ds_read_b128 v[104:107], v16 offset:4096
    ds_read_b128 v[108:111], v16 offset:6144
    buffer_store_dwordx2 v[22:23], v20, s[28:31], s48 offen sc1
    buffer_store_dwordx4 v[48:51], v19, s[28:31], s48 offen offset:0 sc1
    buffer_store_dwordx4 v[52:55], v19, s[28:31], s48 offen offset:512 sc1
    v_xor_b32 v116, 139264, v4
    s_waitcnt lgkmcnt(2)
    v_add_f32 v96, v96, v100
    v_add_f32 v97, v97, v101
    v_add_f32 v98, v98, v102
    v_add_f32 v99, v99, v103
    s_waitcnt lgkmcnt(0)
    v_add_f32 v104, v104, v108
    v_add_f32 v105, v105, v109
    v_add_f32 v106, v106, v110
    v_add_f32 v107, v107, v111
    v_add_f32 v96, v96, v104
    v_add_f32 v97, v97, v105
    v_add_f32 v98, v98, v106
    v_add_f32 v99, v99, v107
    v_bfi_b32 v96, 1, s59, v96
    v_bfi_b32 v98, 1, s59, v98
    buffer_store_dwordx4 v[96:99], v4, s[20:23], s49 offen sc1
    buffer_store_dwordx4 v[96:99], v116, s[20:23], s49 offen sc1
    s_sleep 6
    buffer_load_dwordx4 v[72:75], v1, s[20:23], s49 offen sc1
    s_sleep 3
    buffer_load_dwordx4 v[76:79], v1, s[20:23], s49 offen sc1
    s_sleep 3
    buffer_load_dwordx4 v[80:83], v1, s[20:23], s49 offen sc1
    s_waitcnt vmcnt(2)
    v_bitop3_b32 v112, v72, v74, s59 bitop3:0x7e
    v_and_b32 v112, 1, v112
    v_cmp_ne_u32 vcc, 0, v112
    s_cbranch_vccnz mega_kernel_ch_s3_xf0
    v_permlane32_swap_b32 v72, v73
    v_permlane32_swap_b32 v74, v75
    v_add_f32 v114, v72, v73
    v_add_f32 v115, v74, v75
mega_kernel_ch_s3_xok:
    s_nop 1
    v_permlane16_swap_b32 v114, v115
    v_add_f32 v114, v114, v115
    s_nop 1
    v_mov_b32_dpp v115, v114 quad_perm:[1,1,3,3] row_mask:0xf bank_mask:0xf
    v_cvt_pk_bf16_f32 v112, v114, v115
    s_nop 1
    v_mov_b32_dpp v113, v112 quad_perm:[2,2,2,2] row_mask:0xf bank_mask:0xf
    buffer_store_dwordx2 v[112:113], v17, s[20:23], s41 offen sc1
    s_branch mega_kernel_ch_s3_top
mega_kernel_ch_s3_last:
    buffer_store_dwordx2 v[22:23], v20, s[28:31], s48 offen sc1
    ds_read_b64_tr_b16 v[48:49], v7 offset:0
    ds_read_b64_tr_b16 v[50:51], v7 offset:256
    ds_read_b64_tr_b16 v[52:53], v7 offset:1024
    ds_read_b64_tr_b16 v[54:55], v7 offset:1280
    s_waitcnt lgkmcnt(0)
    buffer_store_dwordx4 v[48:51], v19, s[28:31], s48 offen offset:0 sc1
    buffer_store_dwordx4 v[52:55], v19, s[28:31], s48 offen offset:512 sc1
    s_waitcnt vmcnt(0)
    s_barrier
    s_branch mega_kernel_ch_fin
mega_kernel_ch_s3_tc0_f:
    s_cmp_eq_u32 s43, 0
    s_cbranch_scc1 mega_kernel_ch_s3_tc0_ok
    s_mov_b32 s90, 0
    s_branch mega_kernel_ch_s3_tretry
mega_kernel_ch_s3_tc1_f:
    s_cmp_eq_u32 s43, 0
    s_cbranch_scc1 mega_kernel_ch_s3_tc1_ok
    s_mov_b32 s90, 1
    s_branch mega_kernel_ch_s3_tretry
mega_kernel_ch_s3_tc2_f:
    s_cmp_eq_u32 s43, 0
    s_cbranch_scc1 mega_kernel_ch_s3_tc2_ok
    s_mov_b32 s90, 2
    s_branch mega_kernel_ch_s3_tretry
mega_kernel_ch_s3_tc3_f:
    s_cmp_eq_u32 s43, 0
    s_cbranch_scc1 mega_kernel_ch_s3_tc3_ok
    s_mov_b32 s90, 3
    s_branch mega_kernel_ch_s3_tretry
mega_kernel_ch_s3_tretry:
    s_sub_u32 s43, s43, 1
    s_waitcnt vmcnt(0)
    v_max_u32 v40, v96, v98
    v_cmp_eq_u32 vcc, -1, v40
    s_cbranch_vccz mega_kernel_ch_s3_tr_L0
    buffer_load_dwordx4 v[96:99], v2, s[20:23], s44 offen offset:0 sc1
mega_kernel_ch_s3_tr_L0:
    v_max_u32 v40, v100, v102
    v_cmp_eq_u32 vcc, -1, v40
    s_cbranch_vccz mega_kernel_ch_s3_tr_L1
    buffer_load_dwordx4 v[100:103], v2, s[20:23], s44 offen offset:1024 sc1
mega_kernel_ch_s3_tr_L1:
    v_max_u32 v40, v104, v106
    v_cmp_eq_u32 vcc, -1, v40
    s_cbranch_vccz mega_kernel_ch_s3_tr_L2
    buffer_load_dwordx4 v[104:107], v2, s[20:23], s44 offen offset:2048 sc1
mega_kernel_ch_s3_tr_L2:
    v_max_u32 v40, v108, v110
    v_cmp_eq_u32 vcc, -1, v40
    s_cbranch_vccz mega_kernel_ch_s3_tr_L3
    buffer_load_dwordx4 v[108:111], v2, s[20:23], s44 offen offset:3072 sc1
mega_kernel_ch_s3_tr_L3:
    s_waitcnt vmcnt(0)
    s_cmp_eq_u32 s90, 0
    s_cbranch_scc1 mega_kernel_ch_s3_tc0
    s_cmp_eq_u32 s90, 1
    s_cbranch_scc1 mega_kernel_ch_s3_tc1
    s_cmp_eq_u32 s90, 2
    s_cbranch_scc1 mega_kernel_ch_s3_tc2
    s_branch mega_kernel_ch_s3_tc3
mega_kernel_ch_s3_e1:
    buffer_store_dwordx2 v[22:23], v20, s[28:31], s48 offen sc1
    ds_read_b64_tr_b16 v[48:49], v7 offset:0
    ds_read_b64_tr_b16 v[50:51], v7 offset:256
    ds_read_b64_tr_b16 v[52:53], v7 offset:1024
    ds_read_b64_tr_b16 v[54:55], v7 offset:1280
    s_waitcnt lgkmcnt(0)
    buffer_store_dwordx4 v[48:51], v19, s[28:31], s48 offen offset:0 sc1
    buffer_store_dwordx4 v[52:55], v19, s[28:31], s48 offen offset:512 sc1
    s_branch mega_kernel_ch_s3_e1r
mega_kernel_ch_s3_sp_f:
    s_cmp_eq_u32 s43, 0
    s_cbranch_scc1 mega_kernel_ch_s3_sp_ok
    s_sub_u32 s43, s43, 1
    buffer_load_dwordx4 v[32:35], v9, s[20:23], s40 offen sc1
    buffer_load_dwordx4 v[36:39], v9, s[20:23], s40 offen offset:2048 sc1
    buffer_load_dwordx2 v[40:41], v10, s[20:23], s40 offen sc1
    buffer_load_dwordx2 v[42:43], v10, s[20:23], s40 offen offset:2048 sc1
    s_waitcnt vmcnt(0)
    s_branch mega_kernel_ch_s3_sp_c
mega_kernel_ch_s3_tf_f:
    s_cmp_eq_u32 s43, 0
    s_cbranch_scc1 mega_kernel_ch_s3_tf_ok
    s_sub_u32 s43, s43, 1
    buffer_load_dword v0, v8, s[16:19], s32 offen sc1
    s_waitcnt vmcnt(0)
    s_branch mega_kernel_ch_s3_tf
mega_kernel_ch_s3_oc0_f:
    s_cmp_eq_u32 s43, 0
    s_cbranch_scc1 mega_kernel_ch_s3_oc0_ok
    s_mov_b32 s90, 0
    s_branch mega_kernel_ch_s3_oretry
mega_kernel_ch_s3_oc1_f:
    s_cmp_eq_u32 s43, 0
    s_cbranch_scc1 mega_kernel_ch_s3_oc1_ok
    s_mov_b32 s90, 1
    s_branch mega_kernel_ch_s3_oretry
mega_kernel_ch_s3_oc2_f:
    s_cmp_eq_u32 s43, 0
    s_cbranch_scc1 mega_kernel_ch_s3_oc2_ok
    s_mov_b32 s90, 2
    s_branch mega_kernel_ch_s3_oretry
mega_kernel_ch_s3_oc3_f:
    s_cmp_eq_u32 s43, 0
    s_cbranch_scc1 mega_kernel_ch_s3_oc3_ok
    s_mov_b32 s90, 3
    s_branch mega_kernel_ch_s3_oretry
mega_kernel_ch_s3_oretry:
    s_sub_u32 s43, s43, 1
    s_waitcnt vmcnt(0)
    v_max_u32 v40, v96, v98
    v_cmp_eq_u32 vcc, -1, v40
    s_cbranch_vccz mega_kernel_ch_s3_or_0
    buffer_load_dwordx4 v[96:99], v14, s[20:23], s40 offen offset:0 sc1
mega_kernel_ch_s3_or_0:
    v_max_u32 v40, v100, v102
    v_cmp_eq_u32 vcc, -1, v40
    s_cbranch_vccz mega_kernel_ch_s3_or_1
    buffer_load_dwordx4 v[100:103], v14, s[20:23], s40 offen offset:1024 sc1
mega_kernel_ch_s3_or_1:
    v_max_u32 v40, v104, v106
    v_cmp_eq_u32 vcc, -1, v40
    s_cbranch_vccz mega_kernel_ch_s3_or_2
    buffer_load_dwordx4 v[104:107], v14, s[20:23], s40 offen offset:2048 sc1
mega_kernel_ch_s3_or_2:
    v_max_u32 v40, v108, v110
    v_cmp_eq_u32 vcc, -1, v40
    s_cbranch_vccz mega_kernel_ch_s3_or_3
    buffer_load_dwordx4 v[108:111], v14, s[20:23], s40 offen offset:3072 sc1
mega_kernel_ch_s3_or_3:
    s_waitcnt vmcnt(0)
    s_cmp_eq_u32 s90, 0
    s_cbranch_scc1 mega_kernel_ch_s3_oc0
    s_cmp_eq_u32 s90, 1
    s_cbranch_scc1 mega_kernel_ch_s3_oc1
    s_cmp_eq_u32 s90, 2
    s_cbranch_scc1 mega_kernel_ch_s3_oc2
    s_branch mega_kernel_ch_s3_oc3
mega_kernel_ch_s3_xf0:
    s_cmp_eq_u32 s43, 0
    s_cbranch_scc1 mega_kernel_ch_s3_xok
    s_sub_u32 s43, s43, 1
    buffer_load_dwordx4 v[72:75], v1, s[20:23], s49 offen sc1
    s_waitcnt vmcnt(2)
    v_bitop3_b32 v112, v76, v78, s59 bitop3:0x7e
    v_and_b32 v112, 1, v112
    v_cmp_ne_u32 vcc, 0, v112
    s_cbranch_vccnz mega_kernel_ch_s3_xg1
    v_permlane32_swap_b32 v76, v77
    v_permlane32_swap_b32 v78, v79
    v_add_f32 v114, v76, v77
    v_add_f32 v115, v78, v79
    s_branch mega_kernel_ch_s3_xok
mega_kernel_ch_s3_xg1:
    buffer_load_dwordx4 v[76:79], v1, s[20:23], s49 offen sc1
    s_waitcnt vmcnt(2)
    v_bitop3_b32 v112, v80, v82, s59 bitop3:0x7e
    v_and_b32 v112, 1, v112
    v_cmp_ne_u32 vcc, 0, v112
    s_cbranch_vccnz mega_kernel_ch_s3_xg2
    v_permlane32_swap_b32 v80, v81
    v_permlane32_swap_b32 v82, v83
    v_add_f32 v114, v80, v81
    v_add_f32 v115, v82, v83
    s_branch mega_kernel_ch_s3_xok
mega_kernel_ch_s3_xg2:
    buffer_load_dwordx4 v[80:83], v1, s[20:23], s49 offen sc1
    s_waitcnt vmcnt(2)
    v_bitop3_b32 v112, v72, v74, s59 bitop3:0x7e
    v_and_b32 v112, 1, v112
    v_cmp_ne_u32 vcc, 0, v112
    s_cbranch_vccnz mega_kernel_ch_s3_xf0
    v_permlane32_swap_b32 v72, v73
    v_permlane32_swap_b32 v74, v75
    v_add_f32 v114, v72, v73
    v_add_f32 v115, v74, v75
    s_branch mega_kernel_ch_s3_xok
mega_kernel_ch_fin:
    s_branch mega_kernel_exit
mega_kernel_notchain:
    s_load_dwordx2 s[4:5], s[0:1], 104
    s_load_dwordx2 s[6:7], s[0:1], 24
    s_load_dwordx2 s[8:9], s[0:1], 32
    s_load_dwordx2 s[10:11], s[0:1], 16
    s_load_dwordx2 s[66:67], s[0:1], 0
    s_load_dwordx2 s[68:69], s[0:1], 8
    s_load_dwordx2 s[70:71], s[0:1], 96
    s_sub_u32 s64, s61, 64
    v_lshrrev_b32 v26, 6, v0
    v_and_b32 v1, 63, v0
    v_readfirstlane_b32 s46, v26
    s_lshl_b32 s84, s64, 2
    s_add_u32 s84, s84, s46
    s_lshl_b32 s84, s84, 11
    v_lshlrev_b32 v100, 4, v1
    v_add_u32 v100, s84, v100
    v_add_u32 v101, 1310720, v100
    v_add_u32 v102, 2621440, v100
    v_lshlrev_b32 v103, 4, v0
    s_waitcnt lgkmcnt(0)
    s_mov_b32 s72, s66
    s_mov_b32 s73, s67
    s_mov_b32 s74, 4194304
    s_mov_b32 s75, 0x20000
    s_mov_b32 s76, s4
    s_mov_b32 s77, s5
    s_mov_b32 s78, 4194304
    s_mov_b32 s79, 0x20000
    s_mov_b32 s20, s4
    s_mov_b32 s21, s5
    s_mov_b32 s22, 4194304
    s_mov_b32 s23, 0x20000
    s_add_u32 s32, s4, 4194304
    s_addc_u32 s33, s5, 0
    s_mov_b32 s34, 50331648
    s_mov_b32 s35, 0x20000
    s_add_u32 s56, s4, 169607168
    s_addc_u32 s57, s5, 0
    s_mov_b32 s58, 548864
    s_mov_b32 s59, 0x20000
    s_cmp_lt_u32 s64, 32
    s_cbranch_scc0 mega_kernel_ln3
    buffer_load_dwordx4 v[104:107], v100, s[72:75], 0 offen
    buffer_load_dwordx4 v[108:111], v100, s[72:75], 0 offen offset:1024
    s_waitcnt vmcnt(0)
    v_lshlrev_b32 v140, 16, v104
    v_and_b32 v141, 0xffff0000, v104
    v_lshlrev_b32 v142, 16, v105
    v_and_b32 v143, 0xffff0000, v105
    v_lshlrev_b32 v144, 16, v106
    v_and_b32 v145, 0xffff0000, v106
    v_lshlrev_b32 v146, 16, v107
    v_and_b32 v147, 0xffff0000, v107
    v_lshlrev_b32 v148, 16, v108
    v_and_b32 v149, 0xffff0000, v108
    v_lshlrev_b32 v150, 16, v109
    v_and_b32 v151, 0xffff0000, v109
    v_lshlrev_b32 v152, 16, v110
    v_and_b32 v153, 0xffff0000, v110
    v_lshlrev_b32 v154, 16, v111
    v_and_b32 v155, 0xffff0000, v111
    v_add_f32 v156, v140, v141
    v_add_f32 v156, v156, v142
    v_add_f32 v156, v156, v143
    v_add_f32 v156, v156, v144
    v_add_f32 v156, v156, v145
    v_add_f32 v156, v156, v146
    v_add_f32 v156, v156, v147
    v_add_f32 v156, v156, v148
    v_add_f32 v156, v156, v149
    v_add_f32 v156, v156, v150
    v_add_f32 v156, v156, v151
    v_add_f32 v156, v156, v152
    v_add_f32 v156, v156, v153
    v_add_f32 v156, v156, v154
    v_add_f32 v156, v156, v155
    s_nop 1
    v_add_f32_dpp v156, v156, v156 quad_perm:[1,0,3,2] row_mask:0xf bank_mask:0xf
    s_nop 1
    v_add_f32_dpp v156, v156, v156 quad_perm:[2,3,0,1] row_mask:0xf bank_mask:0xf
    s_nop 1
    v_add_f32_dpp v156, v156, v156 row_half_mirror row_mask:0xf bank_mask:0xf
    s_nop 1
    v_add_f32_dpp v156, v156, v156 row_mirror row_mask:0xf bank_mask:0xf
    v_mov_b32 v157, v156
    s_nop 1
    v_permlane16_swap_b32 v157, v156
    v_add_f32 v156, v156, v157
    v_mov_b32 v157, v156
    s_nop 1
    v_permlane32_swap_b32 v157, v156
    v_add_f32 v156, v156, v157
    v_mul_f32 v156, 0x3a800000, v156
    v_sub_f32 v140, v140, v156
    v_sub_f32 v141, v141, v156
    v_sub_f32 v142, v142, v156
    v_sub_f32 v143, v143, v156
    v_sub_f32 v144, v144, v156
    v_sub_f32 v145, v145, v156
    v_sub_f32 v146, v146, v156
    v_sub_f32 v147, v147, v156
    v_sub_f32 v148, v148, v156
    v_sub_f32 v149, v149, v156
    v_sub_f32 v150, v150, v156
    v_sub_f32 v151, v151, v156
    v_sub_f32 v152, v152, v156
    v_sub_f32 v153, v153, v156
    v_sub_f32 v154, v154, v156
    v_sub_f32 v155, v155, v156
    v_mul_f32 v156, v140, v140
    v_fmac_f32 v156, v141, v141
    v_fmac_f32 v156, v142, v142
    v_fmac_f32 v156, v143, v143
    v_fmac_f32 v156, v144, v144
    v_fmac_f32 v156, v145, v145
    v_fmac_f32 v156, v146, v146
    v_fmac_f32 v156, v147, v147
    v_fmac_f32 v156, v148, v148
    v_fmac_f32 v156, v149, v149
    v_fmac_f32 v156, v150, v150
    v_fmac_f32 v156, v151, v151
    v_fmac_f32 v156, v152, v152
    v_fmac_f32 v156, v153, v153
    v_fmac_f32 v156, v154, v154
    v_fmac_f32 v156, v155, v155
    s_nop 1
    v_add_f32_dpp v156, v156, v156 quad_perm:[1,0,3,2] row_mask:0xf bank_mask:0xf
    s_nop 1
    v_add_f32_dpp v156, v156, v156 quad_perm:[2,3,0,1] row_mask:0xf bank_mask:0xf
    s_nop 1
    v_add_f32_dpp v156, v156, v156 row_half_mirror row_mask:0xf bank_mask:0xf
    s_nop 1
    v_add_f32_dpp v156, v156, v156 row_mirror row_mask:0xf bank_mask:0xf
    v_mov_b32 v157, v156
    s_nop 1
    v_permlane16_swap_b32 v157, v156
    v_add_f32 v156, v156, v157
    v_mov_b32 v157, v156
    s_nop 1
    v_permlane32_swap_b32 v157, v156
    v_add_f32 v156, v156, v157
    v_mov_b32 v157, 0x3727c5ac
    v_fmac_f32 v157, 0x3a800000, v156
    v_rsq_f32 v157, v157
    s_nop 0
    v_mul_f32 v140, v140, v157
    v_mul_f32 v141, v141, v157
    v_mul_f32 v142, v142, v157
    v_mul_f32 v143, v143, v157
    v_mul_f32 v144, v144, v157
    v_mul_f32 v145, v145, v157
    v_mul_f32 v146, v146, v157
    v_mul_f32 v147, v147, v157
    v_mul_f32 v148, v148, v157
    v_mul_f32 v149, v149, v157
    v_mul_f32 v150, v150, v157
    v_mul_f32 v151, v151, v157
    v_mul_f32 v152, v152, v157
    v_mul_f32 v153, v153, v157
    v_mul_f32 v154, v154, v157
    v_mul_f32 v155, v155, v157
    v_cvt_pk_bf16_f32 v158, v140, v141
    v_cvt_pk_bf16_f32 v159, v142, v143
    v_cvt_pk_bf16_f32 v160, v144, v145
    v_cvt_pk_bf16_f32 v161, v146, v147
    v_cvt_pk_bf16_f32 v162, v148, v149
    v_cvt_pk_bf16_f32 v163, v150, v151
    v_cvt_pk_bf16_f32 v164, v152, v153
    v_cvt_pk_bf16_f32 v165, v154, v155
    buffer_store_dwordx4 v[158:161], v100, s[76:79], 0 offen sc1
    buffer_store_dwordx4 v[162:165], v100, s[76:79], 0 offen offset:1024 sc1
    s_branch mega_kernel_lnpub
mega_kernel_ln3:
    s_sub_u32 s84, s64, 96
    s_cmp_lt_u32 s84, 3
    s_cbranch_scc0 mega_kernel_noia
    s_lshl_b32 s85, s84, 13
    s_cmp_eq_u32 s84, 2
    s_cselect_b32 s85, 540672, s85
    v_mov_b32 v170, 0
    v_mov_b32 v171, 0
    v_mov_b32 v172, 0
    v_mov_b32 v173, 0
    v_add_u32 v174, 4096, v103
    buffer_store_dwordx4 v[170:173], v103, s[56:59], s85 offen sc1
    buffer_store_dwordx4 v[170:173], v174, s[56:59], s85 offen sc1
    s_waitcnt vmcnt(0)
    s_barrier
    s_cmp_lg_u32 s46, 0
    s_cbranch_scc1 mega_kernel_noia
    s_mov_b64 exec, 1
    v_mov_b32 v170, 72
    v_mov_b32 v171, 1
    global_atomic_add v170, v171, s[70:71] sc1
    s_waitcnt vmcnt(0)
    s_mov_b64 exec, -1
mega_kernel_noia:
    buffer_load_dwordx4 v[104:107], v100, s[72:75], 0 offen
    buffer_load_dwordx4 v[108:111], v100, s[72:75], 0 offen offset:1024
    buffer_load_dwordx4 v[112:115], v101, s[72:75], 0 offen
    buffer_load_dwordx4 v[116:119], v101, s[72:75], 0 offen offset:1024
    buffer_load_dwordx4 v[120:123], v102, s[72:75], 0 offen
    buffer_load_dwordx4 v[124:127], v102, s[72:75], 0 offen offset:1024
    s_waitcnt vmcnt(4)
    v_lshlrev_b32 v140, 16, v104
    v_and_b32 v141, 0xffff0000, v104
    v_lshlrev_b32 v142, 16, v105
    v_and_b32 v143, 0xffff0000, v105
    v_lshlrev_b32 v144, 16, v106
    v_and_b32 v145, 0xffff0000, v106
    v_lshlrev_b32 v146, 16, v107
    v_and_b32 v147, 0xffff0000, v107
    v_lshlrev_b32 v148, 16, v108
    v_and_b32 v149, 0xffff0000, v108
    v_lshlrev_b32 v150, 16, v109
    v_and_b32 v151, 0xffff0000, v109
    v_lshlrev_b32 v152, 16, v110
    v_and_b32 v153, 0xffff0000, v110
    v_lshlrev_b32 v154, 16, v111
    v_and_b32 v155, 0xffff0000, v111
    v_add_f32 v156, v140, v141
    v_add_f32 v156, v156, v142
    v_add_f32 v156, v156, v143
    v_add_f32 v156, v156, v144
    v_add_f32 v156, v156, v145
    v_add_f32 v156, v156, v146
    v_add_f32 v156, v156, v147
    v_add_f32 v156, v156, v148
    v_add_f32 v156, v156, v149
    v_add_f32 v156, v156, v150
    v_add_f32 v156, v156, v151
    v_add_f32 v156, v156, v152
    v_add_f32 v156, v156, v153
    v_add_f32 v156, v156, v154
    v_add_f32 v156, v156, v155
    s_nop 1
    v_add_f32_dpp v156, v156, v156 quad_perm:[1,0,3,2] row_mask:0xf bank_mask:0xf
    s_nop 1
    v_add_f32_dpp v156, v156, v156 quad_perm:[2,3,0,1] row_mask:0xf bank_mask:0xf
    s_nop 1
    v_add_f32_dpp v156, v156, v156 row_half_mirror row_mask:0xf bank_mask:0xf
    s_nop 1
    v_add_f32_dpp v156, v156, v156 row_mirror row_mask:0xf bank_mask:0xf
    v_mov_b32 v157, v156
    s_nop 1
    v_permlane16_swap_b32 v157, v156
    v_add_f32 v156, v156, v157
    v_mov_b32 v157, v156
    s_nop 1
    v_permlane32_swap_b32 v157, v156
    v_add_f32 v156, v156, v157
    v_mul_f32 v156, 0x3a800000, v156
    v_sub_f32 v140, v140, v156
    v_sub_f32 v141, v141, v156
    v_sub_f32 v142, v142, v156
    v_sub_f32 v143, v143, v156
    v_sub_f32 v144, v144, v156
    v_sub_f32 v145, v145, v156
    v_sub_f32 v146, v146, v156
    v_sub_f32 v147, v147, v156
    v_sub_f32 v148, v148, v156
    v_sub_f32 v149, v149, v156
    v_sub_f32 v150, v150, v156
    v_sub_f32 v151, v151, v156
    v_sub_f32 v152, v152, v156
    v_sub_f32 v153, v153, v156
    v_sub_f32 v154, v154, v156
    v_sub_f32 v155, v155, v156
    v_mul_f32 v156, v140, v140
    v_fmac_f32 v156, v141, v141
    v_fmac_f32 v156, v142, v142
    v_fmac_f32 v156, v143, v143
    v_fmac_f32 v156, v144, v144
    v_fmac_f32 v156, v145, v145
    v_fmac_f32 v156, v146, v146
    v_fmac_f32 v156, v147, v147
    v_fmac_f32 v156, v148, v148
    v_fmac_f32 v156, v149, v149
    v_fmac_f32 v156, v150, v150
    v_fmac_f32 v156, v151, v151
    v_fmac_f32 v156, v152, v152
    v_fmac_f32 v156, v153, v153
    v_fmac_f32 v156, v154, v154
    v_fmac_f32 v156, v155, v155
    s_nop 1
    v_add_f32_dpp v156, v156, v156 quad_perm:[1,0,3,2] row_mask:0xf bank_mask:0xf
    s_nop 1
    v_add_f32_dpp v156, v156, v156 quad_perm:[2,3,0,1] row_mask:0xf bank_mask:0xf
    s_nop 1
    v_add_f32_dpp v156, v156, v156 row_half_mirror row_mask:0xf bank_mask:0xf
    s_nop 1
    v_add_f32_dpp v156, v156, v156 row_mirror row_mask:0xf bank_mask:0xf
    v_mov_b32 v157, v156
    s_nop 1
    v_permlane16_swap_b32 v157, v156
    v_add_f32 v156, v156, v157
    v_mov_b32 v157, v156
    s_nop 1
    v_permlane32_swap_b32 v157, v156
    v_add_f32 v156, v156, v157
    v_mov_b32 v157, 0x3727c5ac
    v_fmac_f32 v157, 0x3a800000, v156
    v_rsq_f32 v157, v157
    s_nop 0
    v_mul_f32 v140, v140, v157
    v_mul_f32 v141, v141, v157
    v_mul_f32 v142, v142, v157
    v_mul_f32 v143, v143, v157
    v_mul_f32 v144, v144, v157
    v_mul_f32 v145, v145, v157
    v_mul_f32 v146, v146, v157
    v_mul_f32 v147, v147, v157
    v_mul_f32 v148, v148, v157
    v_mul_f32 v149, v149, v157
    v_mul_f32 v150, v150, v157
    v_mul_f32 v151, v151, v157
    v_mul_f32 v152, v152, v157
    v_mul_f32 v153, v153, v157
    v_mul_f32 v154, v154, v157
    v_mul_f32 v155, v155, v157
    v_cvt_pk_bf16_f32 v158, v140, v141
    v_cvt_pk_bf16_f32 v159, v142, v143
    v_cvt_pk_bf16_f32 v160, v144, v145
    v_cvt_pk_bf16_f32 v161, v146, v147
    v_cvt_pk_bf16_f32 v162, v148, v149
    v_cvt_pk_bf16_f32 v163, v150, v151
    v_cvt_pk_bf16_f32 v164, v152, v153
    v_cvt_pk_bf16_f32 v165, v154, v155
    buffer_store_dwordx4 v[158:161], v100, s[76:79], 0 offen sc1
    buffer_store_dwordx4 v[162:165], v100, s[76:79], 0 offen offset:1024 sc1
    s_waitcnt vmcnt(4)
    v_lshlrev_b32 v140, 16, v112
    v_and_b32 v141, 0xffff0000, v112
    v_lshlrev_b32 v142, 16, v113
    v_and_b32 v143, 0xffff0000, v113
    v_lshlrev_b32 v144, 16, v114
    v_and_b32 v145, 0xffff0000, v114
    v_lshlrev_b32 v146, 16, v115
    v_and_b32 v147, 0xffff0000, v115
    v_lshlrev_b32 v148, 16, v116
    v_and_b32 v149, 0xffff0000, v116
    v_lshlrev_b32 v150, 16, v117
    v_and_b32 v151, 0xffff0000, v117
    v_lshlrev_b32 v152, 16, v118
    v_and_b32 v153, 0xffff0000, v118
    v_lshlrev_b32 v154, 16, v119
    v_and_b32 v155, 0xffff0000, v119
    v_add_f32 v156, v140, v141
    v_add_f32 v156, v156, v142
    v_add_f32 v156, v156, v143
    v_add_f32 v156, v156, v144
    v_add_f32 v156, v156, v145
    v_add_f32 v156, v156, v146
    v_add_f32 v156, v156, v147
    v_add_f32 v156, v156, v148
    v_add_f32 v156, v156, v149
    v_add_f32 v156, v156, v150
    v_add_f32 v156, v156, v151
    v_add_f32 v156, v156, v152
    v_add_f32 v156, v156, v153
    v_add_f32 v156, v156, v154
    v_add_f32 v156, v156, v155
    s_nop 1
    v_add_f32_dpp v156, v156, v156 quad_perm:[1,0,3,2] row_mask:0xf bank_mask:0xf
    s_nop 1
    v_add_f32_dpp v156, v156, v156 quad_perm:[2,3,0,1] row_mask:0xf bank_mask:0xf
    s_nop 1
    v_add_f32_dpp v156, v156, v156 row_half_mirror row_mask:0xf bank_mask:0xf
    s_nop 1
    v_add_f32_dpp v156, v156, v156 row_mirror row_mask:0xf bank_mask:0xf
    v_mov_b32 v157, v156
    s_nop 1
    v_permlane16_swap_b32 v157, v156
    v_add_f32 v156, v156, v157
    v_mov_b32 v157, v156
    s_nop 1
    v_permlane32_swap_b32 v157, v156
    v_add_f32 v156, v156, v157
    v_mul_f32 v156, 0x3a800000, v156
    v_sub_f32 v140, v140, v156
    v_sub_f32 v141, v141, v156
    v_sub_f32 v142, v142, v156
    v_sub_f32 v143, v143, v156
    v_sub_f32 v144, v144, v156
    v_sub_f32 v145, v145, v156
    v_sub_f32 v146, v146, v156
    v_sub_f32 v147, v147, v156
    v_sub_f32 v148, v148, v156
    v_sub_f32 v149, v149, v156
    v_sub_f32 v150, v150, v156
    v_sub_f32 v151, v151, v156
    v_sub_f32 v152, v152, v156
    v_sub_f32 v153, v153, v156
    v_sub_f32 v154, v154, v156
    v_sub_f32 v155, v155, v156
    v_mul_f32 v156, v140, v140
    v_fmac_f32 v156, v141, v141
    v_fmac_f32 v156, v142, v142
    v_fmac_f32 v156, v143, v143
    v_fmac_f32 v156, v144, v144
    v_fmac_f32 v156, v145, v145
    v_fmac_f32 v156, v146, v146
    v_fmac_f32 v156, v147, v147
    v_fmac_f32 v156, v148, v148
    v_fmac_f32 v156, v149, v149
    v_fmac_f32 v156, v150, v150
    v_fmac_f32 v156, v151, v151
    v_fmac_f32 v156, v152, v152
    v_fmac_f32 v156, v153, v153
    v_fmac_f32 v156, v154, v154
    v_fmac_f32 v156, v155, v155
    s_nop 1
    v_add_f32_dpp v156, v156, v156 quad_perm:[1,0,3,2] row_mask:0xf bank_mask:0xf
    s_nop 1
    v_add_f32_dpp v156, v156, v156 quad_perm:[2,3,0,1] row_mask:0xf bank_mask:0xf
    s_nop 1
    v_add_f32_dpp v156, v156, v156 row_half_mirror row_mask:0xf bank_mask:0xf
    s_nop 1
    v_add_f32_dpp v156, v156, v156 row_mirror row_mask:0xf bank_mask:0xf
    v_mov_b32 v157, v156
    s_nop 1
    v_permlane16_swap_b32 v157, v156
    v_add_f32 v156, v156, v157
    v_mov_b32 v157, v156
    s_nop 1
    v_permlane32_swap_b32 v157, v156
    v_add_f32 v156, v156, v157
    v_mov_b32 v157, 0x3727c5ac
    v_fmac_f32 v157, 0x3a800000, v156
    v_rsq_f32 v157, v157
    s_nop 0
    v_mul_f32 v140, v140, v157
    v_mul_f32 v141, v141, v157
    v_mul_f32 v142, v142, v157
    v_mul_f32 v143, v143, v157
    v_mul_f32 v144, v144, v157
    v_mul_f32 v145, v145, v157
    v_mul_f32 v146, v146, v157
    v_mul_f32 v147, v147, v157
    v_mul_f32 v148, v148, v157
    v_mul_f32 v149, v149, v157
    v_mul_f32 v150, v150, v157
    v_mul_f32 v151, v151, v157
    v_mul_f32 v152, v152, v157
    v_mul_f32 v153, v153, v157
    v_mul_f32 v154, v154, v157
    v_mul_f32 v155, v155, v157
    v_cvt_pk_bf16_f32 v158, v140, v141
    v_cvt_pk_bf16_f32 v159, v142, v143
    v_cvt_pk_bf16_f32 v160, v144, v145
    v_cvt_pk_bf16_f32 v161, v146, v147
    v_cvt_pk_bf16_f32 v162, v148, v149
    v_cvt_pk_bf16_f32 v163, v150, v151
    v_cvt_pk_bf16_f32 v164, v152, v153
    v_cvt_pk_bf16_f32 v165, v154, v155
    buffer_store_dwordx4 v[158:161], v101, s[76:79], 0 offen sc1
    buffer_store_dwordx4 v[162:165], v101, s[76:79], 0 offen offset:1024 sc1
    s_waitcnt vmcnt(4)
    v_lshlrev_b32 v140, 16, v120
    v_and_b32 v141, 0xffff0000, v120
    v_lshlrev_b32 v142, 16, v121
    v_and_b32 v143, 0xffff0000, v121
    v_lshlrev_b32 v144, 16, v122
    v_and_b32 v145, 0xffff0000, v122
    v_lshlrev_b32 v146, 16, v123
    v_and_b32 v147, 0xffff0000, v123
    v_lshlrev_b32 v148, 16, v124
    v_and_b32 v149, 0xffff0000, v124
    v_lshlrev_b32 v150, 16, v125
    v_and_b32 v151, 0xffff0000, v125
    v_lshlrev_b32 v152, 16, v126
    v_and_b32 v153, 0xffff0000, v126
    v_lshlrev_b32 v154, 16, v127
    v_and_b32 v155, 0xffff0000, v127
    v_add_f32 v156, v140, v141
    v_add_f32 v156, v156, v142
    v_add_f32 v156, v156, v143
    v_add_f32 v156, v156, v144
    v_add_f32 v156, v156, v145
    v_add_f32 v156, v156, v146
    v_add_f32 v156, v156, v147
    v_add_f32 v156, v156, v148
    v_add_f32 v156, v156, v149
    v_add_f32 v156, v156, v150
    v_add_f32 v156, v156, v151
    v_add_f32 v156, v156, v152
    v_add_f32 v156, v156, v153
    v_add_f32 v156, v156, v154
    v_add_f32 v156, v156, v155
    s_nop 1
    v_add_f32_dpp v156, v156, v156 quad_perm:[1,0,3,2] row_mask:0xf bank_mask:0xf
    s_nop 1
    v_add_f32_dpp v156, v156, v156 quad_perm:[2,3,0,1] row_mask:0xf bank_mask:0xf
    s_nop 1
    v_add_f32_dpp v156, v156, v156 row_half_mirror row_mask:0xf bank_mask:0xf
    s_nop 1
    v_add_f32_dpp v156, v156, v156 row_mirror row_mask:0xf bank_mask:0xf
    v_mov_b32 v157, v156
    s_nop 1
    v_permlane16_swap_b32 v157, v156
    v_add_f32 v156, v156, v157
    v_mov_b32 v157, v156
    s_nop 1
    v_permlane32_swap_b32 v157, v156
    v_add_f32 v156, v156, v157
    v_mul_f32 v156, 0x3a800000, v156
    v_sub_f32 v140, v140, v156
    v_sub_f32 v141, v141, v156
    v_sub_f32 v142, v142, v156
    v_sub_f32 v143, v143, v156
    v_sub_f32 v144, v144, v156
    v_sub_f32 v145, v145, v156
    v_sub_f32 v146, v146, v156
    v_sub_f32 v147, v147, v156
    v_sub_f32 v148, v148, v156
    v_sub_f32 v149, v149, v156
    v_sub_f32 v150, v150, v156
    v_sub_f32 v151, v151, v156
    v_sub_f32 v152, v152, v156
    v_sub_f32 v153, v153, v156
    v_sub_f32 v154, v154, v156
    v_sub_f32 v155, v155, v156
    v_mul_f32 v156, v140, v140
    v_fmac_f32 v156, v141, v141
    v_fmac_f32 v156, v142, v142
    v_fmac_f32 v156, v143, v143
    v_fmac_f32 v156, v144, v144
    v_fmac_f32 v156, v145, v145
    v_fmac_f32 v156, v146, v146
    v_fmac_f32 v156, v147, v147
    v_fmac_f32 v156, v148, v148
    v_fmac_f32 v156, v149, v149
    v_fmac_f32 v156, v150, v150
    v_fmac_f32 v156, v151, v151
    v_fmac_f32 v156, v152, v152
    v_fmac_f32 v156, v153, v153
    v_fmac_f32 v156, v154, v154
    v_fmac_f32 v156, v155, v155
    s_nop 1
    v_add_f32_dpp v156, v156, v156 quad_perm:[1,0,3,2] row_mask:0xf bank_mask:0xf
    s_nop 1
    v_add_f32_dpp v156, v156, v156 quad_perm:[2,3,0,1] row_mask:0xf bank_mask:0xf
    s_nop 1
    v_add_f32_dpp v156, v156, v156 row_half_mirror row_mask:0xf bank_mask:0xf
    s_nop 1
    v_add_f32_dpp v156, v156, v156 row_mirror row_mask:0xf bank_mask:0xf
    v_mov_b32 v157, v156
    s_nop 1
    v_permlane16_swap_b32 v157, v156
    v_add_f32 v156, v156, v157
    v_mov_b32 v157, v156
    s_nop 1
    v_permlane32_swap_b32 v157, v156
    v_add_f32 v156, v156, v157
    v_mov_b32 v157, 0x3727c5ac
    v_fmac_f32 v157, 0x3a800000, v156
    v_rsq_f32 v157, v157
    s_nop 0
    v_mul_f32 v140, v140, v157
    v_mul_f32 v141, v141, v157
    v_mul_f32 v142, v142, v157
    v_mul_f32 v143, v143, v157
    v_mul_f32 v144, v144, v157
    v_mul_f32 v145, v145, v157
    v_mul_f32 v146, v146, v157
    v_mul_f32 v147, v147, v157
    v_mul_f32 v148, v148, v157
    v_mul_f32 v149, v149, v157
    v_mul_f32 v150, v150, v157
    v_mul_f32 v151, v151, v157
    v_mul_f32 v152, v152, v157
    v_mul_f32 v153, v153, v157
    v_mul_f32 v154, v154, v157
    v_mul_f32 v155, v155, v157
    v_cvt_pk_bf16_f32 v158, v140, v141
    v_cvt_pk_bf16_f32 v159, v142, v143
    v_cvt_pk_bf16_f32 v160, v144, v145
    v_cvt_pk_bf16_f32 v161, v146, v147
    v_cvt_pk_bf16_f32 v162, v148, v149
    v_cvt_pk_bf16_f32 v163, v150, v151
    v_cvt_pk_bf16_f32 v164, v152, v153
    v_cvt_pk_bf16_f32 v165, v154, v155
    buffer_store_dwordx4 v[158:161], v102, s[76:79], 0 offen sc1
    buffer_store_dwordx4 v[162:165], v102, s[76:79], 0 offen offset:1024 sc1
mega_kernel_lnpub:
    s_cmp_lg_u32 s46, 0
    s_cbranch_scc1 mega_kernel_lnw
    s_mov_b32 s84, 131072
    v_mov_b32 v170, 72
mega_kernel_iap:
    global_load_dword v171, v170, s[70:71] sc1
    s_waitcnt vmcnt(0)
    v_readfirstlane_b32 s85, v171
    s_cmp_eq_u32 s85, 3
    s_cbranch_scc1 mega_kernel_lnw
    s_cmp_eq_u32 s84, 0
    s_cbranch_scc1 mega_kernel_lnw
    s_sub_u32 s84, s84, 1
    s_branch mega_kernel_iap
mega_kernel_lnw:
    s_waitcnt vmcnt(0)
    s_barrier
    s_cmp_lg_u32 s46, 0
    s_cbranch_scc1 mega_kernel_lnf
    v_mul_u32_u24 v170, 160, v1
    v_add_u32 v170, s64, v170
    v_lshlrev_b32 v170, 4, v170
    v_add_u32 v170, 540672, v170
    v_mov_b32 v171, 1
    s_cmp_lt_u32 s64, 32
    s_cselect_b32 s84, 1, 7
    s_mov_b32 exec_lo, s84
    s_mov_b32 exec_hi, 0
    buffer_store_dword v171, v170, s[56:59], 0 offen sc1
    s_mov_b64 exec, -1
mega_kernel_lnf:
    s_cmp_lt_u32 s64, 128
    s_cbranch_scc0 mega_kernel_fb
    s_and_b32 s84, s64, 1
    s_mov_b32 s85, 0
    s_lshr_b32 s86, s64, 1
    s_lshr_b32 s47, s46, 1
    s_and_b32 s48, s46, 1
    v_and_b32 v26, 31, v1
    s_mul_i32 s49, s47, 32
    v_add_u32 v26, s49, v26
    v_lshrrev_b32 v27, 1, v26
    v_and_b32 v27, 7, v27
    v_lshrrev_b32 v28, 5, v1
    v_lshlrev_b32 v29, 7, v26
    v_add_u32 v30, 0, v28
    v_xor_b32 v30, v30, v27
    v_lshl_add_u32 v2, v30, 4, v29
    v_add_u32 v30, 2, v28
    v_xor_b32 v30, v30, v27
    v_lshl_add_u32 v3, v30, 4, v29
    v_add_u32 v30, 4, v28
    v_xor_b32 v30, v30, v27
    v_lshl_add_u32 v4, v30, 4, v29
    v_add_u32 v30, 6, v28
    v_xor_b32 v30, v30, v27
    v_lshl_add_u32 v5, v30, 4, v29
    v_lshrrev_b32 v26, 2, v1
    v_and_b32 v26, 3, v26
    v_lshrrev_b32 v27, 5, v1
    v_lshl_add_u32 v27, v27, 3, v26
    v_mul_u32_u24 v27, 256, v27
    v_lshrrev_b32 v28, 4, v1
    v_and_b32 v28, 1, v28
    v_lshlrev_b32 v28, 5, v28
    v_and_b32 v29, 3, v1
    v_lshl_add_u32 v28, v29, 3, v28
    v_add_u32 v27, v27, v28
    s_mul_i32 s49, s48, 2
    s_add_u32 s49, s49, 0
    v_xor_b32 v29, s49, v26
    v_lshlrev_b32 v29, 6, v29
    v_add_u32 v29, v29, v27
    v_add_u32 v6, 8192, v29
    s_mul_i32 s49, s48, 2
    s_add_u32 s49, s49, 1
    v_xor_b32 v29, s49, v26
    v_lshlrev_b32 v29, 6, v29
    v_add_u32 v29, v29, v27
    v_add_u32 v7, 8192, v29
    v_lshrrev_b32 v26, 3, v1
    s_mul_i32 s49, s46, 16
    v_add_u32 v26, s49, v26
    v_and_b32 v27, 7, v1
    s_mov_b32 s50, 2048
    v_add_u32 v28, 0, v26
    v_lshrrev_b32 v29, 1, v28
    v_and_b32 v29, 7, v29
    v_xor_b32 v29, v29, v27
    v_lshlrev_b32 v29, 4, v29
    v_mul_lo_u32 v28, v28, s50
    v_add_u32 v10, v28, v29
    v_add_u32 v28, 8, v26
    v_lshrrev_b32 v29, 1, v28
    v_and_b32 v29, 7, v29
    v_xor_b32 v29, v29, v27
    v_lshlrev_b32 v29, 4, v29
    v_mul_lo_u32 v28, v28, s50
    v_add_u32 v11, v28, v29
    v_lshrrev_b32 v26, 4, v1
    s_mul_i32 s49, s46, 16
    v_add_u32 v26, s49, v26
    v_and_b32 v27, 15, v1
    s_mov_b32 s50, 8192
    v_add_u32 v28, 0, v26
    v_and_b32 v29, 3, v28
    v_lshlrev_b32 v29, 2, v29
    v_xor_b32 v29, v29, v27
    v_lshlrev_b32 v29, 4, v29
    v_mul_lo_u32 v28, v28, s50
    v_add_u32 v18, v28, v29
    v_add_u32 v28, 4, v26
    v_and_b32 v29, 3, v28
    v_lshlrev_b32 v29, 2, v29
    v_xor_b32 v29, v29, v27
    v_lshlrev_b32 v29, 4, v29
    v_mul_lo_u32 v28, v28, s50
    v_add_u32 v19, v28, v29
    v_add_u32 v28, 8, v26
    v_and_b32 v29, 3, v28
    v_lshlrev_b32 v29, 2, v29
    v_xor_b32 v29, v29, v27
    v_lshlrev_b32 v29, 4, v29
    v_mul_lo_u32 v28, v28, s50
    v_add_u32 v20, v28, v29
    v_add_u32 v28, 12, v26
    v_and_b32 v29, 3, v28
    v_lshlrev_b32 v29, 2, v29
    v_xor_b32 v29, v29, v27
    v_lshlrev_b32 v29, 4, v29
    v_mul_lo_u32 v28, v28, s50
    v_add_u32 v21, v28, v29
    s_lshr_b32 s16, s86, 5
    s_and_b32 s17, s86, 31
    s_cmp_eq_u32 s16, 1
    s_cselect_b32 s12, s8, s6
    s_cselect_b32 s13, s9, s7
    s_mov_b32 s24, s12
    s_mov_b32 s25, s13
    s_mov_b32 s26, 8388608
    s_mov_b32 s27, 0x20000
    s_lshl_b32 s18, s85, 1
    s_add_u32 s18, s18, s84
    s_mul_i32 s40, s18, 131072
    s_lshl_b32 s41, s17, 8
    s_mul_i32 s54, s16, 16777216
    s_mul_i32 s19, s18, 524288
    s_add_u32 s54, s54, s19
    s_lshl_b32 s19, s17, 13
    s_add_u32 s54, s54, s19
    s_lshl_b32 s19, s18, 4
    v_and_b32 v26, 15, v1
    v_add_u32 v26, s19, v26
    v_lshlrev_b32 v26, 4, v26
    v_add_u32 v26, 540672, v26
    s_mov_b32 s12, 131072
mega_kernel_qfa_lw:
    buffer_load_dword v27, v26, s[56:59], 0 offen sc1
    s_waitcnt vmcnt(0)
    v_cmp_eq_u32 vcc, 0, v27
    s_cbranch_vccz mega_kernel_qfa_lw_ok
    s_cmp_eq_u32 s12, 0
    s_cbranch_scc1 mega_kernel_qfa_lw_ok
    s_sub_u32 s12, s12, 1
    s_sleep 1
    s_branch mega_kernel_qfa_lw
mega_kernel_qfa_lw_ok:
    s_mul_i32 s42, s46, 2048
    s_mul_i32 s43, s46, 4096
    s_add_u32 s43, s43, 8192
    s_add_u32 m0, s42, 0
    s_nop 0
    buffer_load_dwordx4 v10, s[20:23], s40 offen lds
    s_add_u32 m0, s42, 1024
    s_nop 0
    buffer_load_dwordx4 v11, s[20:23], s40 offen lds
    s_add_u32 m0, s43, 0
    s_nop 0
    buffer_load_dwordx4 v18, s[24:27], s41 offen lds
    s_add_u32 m0, s43, 1024
    s_nop 0
    buffer_load_dwordx4 v19, s[24:27], s41 offen lds
    s_add_u32 m0, s43, 2048
    s_nop 0
    buffer_load_dwordx4 v20, s[24:27], s41 offen lds
    s_add_u32 m0, s43, 3072
    s_nop 0
    buffer_load_dwordx4 v21, s[24:27], s41 offen lds
    s_add_u32 s40, s40, 128
    s_add_u32 s41, s41, 524288
    s_add_u32 s42, s42, 24576
    s_add_u32 s43, s43, 24576
    s_add_u32 m0, s42, 0
    s_nop 0
    buffer_load_dwordx4 v10, s[20:23], s40 offen lds
    s_add_u32 m0, s42, 1024
    s_nop 0
    buffer_load_dwordx4 v11, s[20:23], s40 offen lds
    s_add_u32 m0, s43, 0
    s_nop 0
    buffer_load_dwordx4 v18, s[24:27], s41 offen lds
    s_add_u32 m0, s43, 1024
    s_nop 0
    buffer_load_dwordx4 v19, s[24:27], s41 offen lds
    s_add_u32 m0, s43, 2048
    s_nop 0
    buffer_load_dwordx4 v20, s[24:27], s41 offen lds
    s_add_u32 m0, s43, 3072
    s_nop 0
    buffer_load_dwordx4 v21, s[24:27], s41 offen lds
    s_add_u32 s40, s40, 128
    s_add_u32 s41, s41, 524288
    s_add_u32 s42, s42, 24576
    s_add_u32 s43, s43, 24576
    s_add_u32 m0, s42, 0
    s_nop 0
    buffer_load_dwordx4 v10, s[20:23], s40 offen lds
    s_add_u32 m0, s42, 1024
    s_nop 0
    buffer_load_dwordx4 v11, s[20:23], s40 offen lds
    s_add_u32 m0, s43, 0
    s_nop 0
    buffer_load_dwordx4 v18, s[24:27], s41 offen lds
    s_add_u32 m0, s43, 1024
    s_nop 0
    buffer_load_dwordx4 v19, s[24:27], s41 offen lds
    s_add_u32 m0, s43, 2048
    s_nop 0
    buffer_load_dwordx4 v20, s[24:27], s41 offen lds
    s_add_u32 m0, s43, 3072
    s_nop 0
    buffer_load_dwordx4 v21, s[24:27], s41 offen lds
    s_add_u32 s40, s40, 128
    s_add_u32 s41, s41, 524288
    s_add_u32 s42, s42, 24576
    s_add_u32 s43, s43, 24576
    s_add_u32 m0, s42, 0
    s_nop 0
    buffer_load_dwordx4 v10, s[20:23], s40 offen lds
    s_add_u32 m0, s42, 1024
    s_nop 0
    buffer_load_dwordx4 v11, s[20:23], s40 offen lds
    s_add_u32 m0, s43, 0
    s_nop 0
    buffer_load_dwordx4 v18, s[24:27], s41 offen lds
    s_add_u32 m0, s43, 1024
    s_nop 0
    buffer_load_dwordx4 v19, s[24:27], s41 offen lds
    s_add_u32 m0, s43, 2048
    s_nop 0
    buffer_load_dwordx4 v20, s[24:27], s41 offen lds
    s_add_u32 m0, s43, 3072
    s_nop 0
    buffer_load_dwordx4 v21, s[24:27], s41 offen lds
    s_add_u32 s40, s40, 128
    s_add_u32 s41, s41, 524288
    s_add_u32 s42, s42, 24576
    s_add_u32 s43, s43, 24576
    s_add_u32 m0, s42, 0
    s_nop 0
    buffer_load_dwordx4 v10, s[20:23], s40 offen lds
    s_add_u32 m0, s42, 1024
    s_nop 0
    buffer_load_dwordx4 v11, s[20:23], s40 offen lds
    s_add_u32 m0, s43, 0
    s_nop 0
    buffer_load_dwordx4 v18, s[24:27], s41 offen lds
    s_add_u32 m0, s43, 1024
    s_nop 0
    buffer_load_dwordx4 v19, s[24:27], s41 offen lds
    s_add_u32 m0, s43, 2048
    s_nop 0
    buffer_load_dwordx4 v20, s[24:27], s41 offen lds
    s_add_u32 m0, s43, 3072
    s_nop 0
    buffer_load_dwordx4 v21, s[24:27], s41 offen lds
    s_add_u32 s40, s40, 128
    s_add_u32 s41, s41, 524288
    s_add_u32 s42, s42, 24576
    s_add_u32 s43, s43, 24576
    s_add_u32 m0, s42, 0
    s_nop 0
    buffer_load_dwordx4 v10, s[20:23], s40 offen lds
    s_add_u32 m0, s42, 1024
    s_nop 0
    buffer_load_dwordx4 v11, s[20:23], s40 offen lds
    s_add_u32 m0, s43, 0
    s_nop 0
    buffer_load_dwordx4 v18, s[24:27], s41 offen lds
    s_add_u32 m0, s43, 1024
    s_nop 0
    buffer_load_dwordx4 v19, s[24:27], s41 offen lds
    s_add_u32 m0, s43, 2048
    s_nop 0
    buffer_load_dwordx4 v20, s[24:27], s41 offen lds
    s_add_u32 m0, s43, 3072
    s_nop 0
    buffer_load_dwordx4 v21, s[24:27], s41 offen lds
    s_add_u32 s40, s40, 128
    s_add_u32 s41, s41, 524288
    s_sub_u32 s42, s42, 122880
    s_sub_u32 s43, s43, 122880
    s_waitcnt vmcnt(30)
    s_barrier
    ds_read_b64_tr_b16 v[36:37], v6 offset:0
    ds_read_b64_tr_b16 v[38:39], v6 offset:1024
    ds_read_b64_tr_b16 v[40:41], v7 offset:0
    ds_read_b64_tr_b16 v[42:43], v7 offset:1024
    ds_read_b128 v[32:35], v2 offset:0
    ds_read_b64_tr_b16 v[48:49], v6 offset:4096
    ds_read_b64_tr_b16 v[50:51], v6 offset:5120
    ds_read_b64_tr_b16 v[52:53], v7 offset:4096
    ds_read_b64_tr_b16 v[54:55], v7 offset:5120
    ds_read_b128 v[44:47], v3 offset:0
    ds_read_b64_tr_b16 v[60:61], v6 offset:8192
    ds_read_b64_tr_b16 v[62:63], v6 offset:9216
    ds_read_b64_tr_b16 v[64:65], v7 offset:8192
    ds_read_b64_tr_b16 v[66:67], v7 offset:9216
    ds_read_b128 v[56:59], v4 offset:0
    ds_read_b64_tr_b16 v[72:73], v6 offset:12288
    ds_read_b64_tr_b16 v[74:75], v6 offset:13312
    ds_read_b64_tr_b16 v[76:77], v7 offset:12288
    ds_read_b64_tr_b16 v[78:79], v7 offset:13312
    ds_read_b128 v[68:71], v5 offset:0
    s_waitcnt lgkmcnt(0)
    s_mov_b32 s52, 24576
    v_add_u32 v2, s52, v2
    v_add_u32 v3, s52, v3
    v_add_u32 v4, s52, v4
    v_add_u32 v5, s52, v5
    v_add_u32 v6, s52, v6
    v_add_u32 v7, s52, v7
    s_waitcnt vmcnt(24)
    s_barrier
    ds_read_b64_tr_b16 v[84:85], v6 offset:0
    ds_read_b64_tr_b16 v[86:87], v6 offset:1024
    ds_read_b64_tr_b16 v[88:89], v7 offset:0
    ds_read_b64_tr_b16 v[90:91], v7 offset:1024
    ds_read_b128 v[80:83], v2 offset:0
    ds_read_b64_tr_b16 v[96:97], v6 offset:4096
    ds_read_b64_tr_b16 v[98:99], v6 offset:5120
    ds_read_b64_tr_b16 v[100:101], v7 offset:4096
    ds_read_b64_tr_b16 v[102:103], v7 offset:5120
    ds_read_b128 v[92:95], v3 offset:0
    ds_read_b64_tr_b16 v[108:109], v6 offset:8192
    ds_read_b64_tr_b16 v[110:111], v6 offset:9216
    ds_read_b64_tr_b16 v[112:113], v7 offset:8192
    ds_read_b64_tr_b16 v[114:115], v7 offset:9216
    ds_read_b128 v[104:107], v4 offset:0
    ds_read_b64_tr_b16 v[120:121], v6 offset:12288
    ds_read_b64_tr_b16 v[122:123], v6 offset:13312
    ds_read_b64_tr_b16 v[124:125], v7 offset:12288
    ds_read_b64_tr_b16 v[126:127], v7 offset:13312
    ds_read_b128 v[116:119], v5 offset:0
    s_add_u32 m0, s42, 0
    s_nop 0
    buffer_load_dwordx4 v10, s[20:23], s40 offen lds
    s_add_u32 m0, s42, 1024
    s_nop 0
    buffer_load_dwordx4 v11, s[20:23], s40 offen lds
    s_add_u32 m0, s43, 0
    s_nop 0
    buffer_load_dwordx4 v18, s[24:27], s41 offen lds
    s_add_u32 m0, s43, 1024
    s_nop 0
    buffer_load_dwordx4 v19, s[24:27], s41 offen lds
    s_add_u32 m0, s43, 2048
    s_nop 0
    buffer_load_dwordx4 v20, s[24:27], s41 offen lds
    s_add_u32 m0, s43, 3072
    s_nop 0
    buffer_load_dwordx4 v21, s[24:27], s41 offen lds
    s_add_u32 s40, s40, 128
    s_add_u32 s41, s41, 524288
    s_add_u32 s42, s42, 24576
    s_add_u32 s43, s43, 24576
    s_cmp_eq_u32 s16, 1
    s_cbranch_scc1 mega_kernel_qfad_sw0
    v_mfma_f32_32x32x16_bf16 a[0:15], v[36:39], v[32:35], 0
    v_mfma_f32_32x32x16_bf16 a[16:31], v[40:43], v[32:35], 0
    v_mfma_f32_32x32x16_bf16 a[0:15], v[48:51], v[44:47], a[0:15]
    v_mfma_f32_32x32x16_bf16 a[16:31], v[52:55], v[44:47], a[16:31]
    v_mfma_f32_32x32x16_bf16 a[0:15], v[60:63], v[56:59], a[0:15]
    v_mfma_f32_32x32x16_bf16 a[16:31], v[64:67], v[56:59], a[16:31]
    v_mfma_f32_32x32x16_bf16 a[0:15], v[72:75], v[68:71], a[0:15]
    v_mfma_f32_32x32x16_bf16 a[16:31], v[76:79], v[68:71], a[16:31]
mega_kernel_qfad_swr0:
    s_waitcnt lgkmcnt(0)
    s_mov_b32 s52, 24576
    v_add_u32 v2, s52, v2
    v_add_u32 v3, s52, v3
    v_add_u32 v4, s52, v4
    v_add_u32 v5, s52, v5
    v_add_u32 v6, s52, v6
    v_add_u32 v7, s52, v7
    s_waitcnt vmcnt(24)
    s_barrier
    ds_read_b64_tr_b16 v[36:37], v6 offset:0
    ds_read_b64_tr_b16 v[38:39], v6 offset:1024
    ds_read_b64_tr_b16 v[40:41], v7 offset:0
    ds_read_b64_tr_b16 v[42:43], v7 offset:1024
    ds_read_b128 v[32:35], v2 offset:0
    ds_read_b64_tr_b16 v[48:49], v6 offset:4096
    ds_read_b64_tr_b16 v[50:51], v6 offset:5120
    ds_read_b64_tr_b16 v[52:53], v7 offset:4096
    ds_read_b64_tr_b16 v[54:55], v7 offset:5120
    ds_read_b128 v[44:47], v3 offset:0
    ds_read_b64_tr_b16 v[60:61], v6 offset:8192
    ds_read_b64_tr_b16 v[62:63], v6 offset:9216
    ds_read_b64_tr_b16 v[64:65], v7 offset:8192
    ds_read_b64_tr_b16 v[66:67], v7 offset:9216
    ds_read_b128 v[56:59], v4 offset:0
    ds_read_b64_tr_b16 v[72:73], v6 offset:12288
    ds_read_b64_tr_b16 v[74:75], v6 offset:13312
    ds_read_b64_tr_b16 v[76:77], v7 offset:12288
    ds_read_b64_tr_b16 v[78:79], v7 offset:13312
    ds_read_b128 v[68:71], v5 offset:0
    s_add_u32 m0, s42, 0
    s_nop 0
    buffer_load_dwordx4 v10, s[20:23], s40 offen lds
    s_add_u32 m0, s42, 1024
    s_nop 0
    buffer_load_dwordx4 v11, s[20:23], s40 offen lds
    s_add_u32 m0, s43, 0
    s_nop 0
    buffer_load_dwordx4 v18, s[24:27], s41 offen lds
    s_add_u32 m0, s43, 1024
    s_nop 0
    buffer_load_dwordx4 v19, s[24:27], s41 offen lds
    s_add_u32 m0, s43, 2048
    s_nop 0
    buffer_load_dwordx4 v20, s[24:27], s41 offen lds
    s_add_u32 m0, s43, 3072
    s_nop 0
    buffer_load_dwordx4 v21, s[24:27], s41 offen lds
    s_add_u32 s40, s40, 128
    s_add_u32 s41, s41, 524288
    s_add_u32 s42, s42, 24576
    s_add_u32 s43, s43, 24576
    s_cmp_eq_u32 s16, 1
    s_cbranch_scc1 mega_kernel_qfad_sw1
    v_mfma_f32_32x32x16_bf16 a[0:15], v[84:87], v[80:83], a[0:15]
    v_mfma_f32_32x32x16_bf16 a[16:31], v[88:91], v[80:83], a[16:31]
    v_mfma_f32_32x32x16_bf16 a[0:15], v[96:99], v[92:95], a[0:15]
    v_mfma_f32_32x32x16_bf16 a[16:31], v[100:103], v[92:95], a[16:31]
    v_mfma_f32_32x32x16_bf16 a[0:15], v[108:111], v[104:107], a[0:15]
    v_mfma_f32_32x32x16_bf16 a[16:31], v[112:115], v[104:107], a[16:31]
    v_mfma_f32_32x32x16_bf16 a[0:15], v[120:123], v[116:119], a[0:15]
    v_mfma_f32_32x32x16_bf16 a[16:31], v[124:127], v[116:119], a[16:31]
mega_kernel_qfad_swr1:
    s_waitcnt lgkmcnt(0)
    s_mov_b32 s52, 24576
    v_add_u32 v2, s52, v2
    v_add_u32 v3, s52, v3
    v_add_u32 v4, s52, v4
    v_add_u32 v5, s52, v5
    v_add_u32 v6, s52, v6
    v_add_u32 v7, s52, v7
    s_waitcnt vmcnt(24)
    s_barrier
    ds_read_b64_tr_b16 v[84:85], v6 offset:0
    ds_read_b64_tr_b16 v[86:87], v6 offset:1024
    ds_read_b64_tr_b16 v[88:89], v7 offset:0
    ds_read_b64_tr_b16 v[90:91], v7 offset:1024
    ds_read_b128 v[80:83], v2 offset:0
    ds_read_b64_tr_b16 v[96:97], v6 offset:4096
    ds_read_b64_tr_b16 v[98:99], v6 offset:5120
    ds_read_b64_tr_b16 v[100:101], v7 offset:4096
    ds_read_b64_tr_b16 v[102:103], v7 offset:5120
    ds_read_b128 v[92:95], v3 offset:0
    ds_read_b64_tr_b16 v[108:109], v6 offset:8192
    ds_read_b64_tr_b16 v[110:111], v6 offset:9216
    ds_read_b64_tr_b16 v[112:113], v7 offset:8192
    ds_read_b64_tr_b16 v[114:115], v7 offset:9216
    ds_read_b128 v[104:107], v4 offset:0
    ds_read_b64_tr_b16 v[120:121], v6 offset:12288
    ds_read_b64_tr_b16 v[122:123], v6 offset:13312
    ds_read_b64_tr_b16 v[124:125], v7 offset:12288
    ds_read_b64_tr_b16 v[126:127], v7 offset:13312
    ds_read_b128 v[116:119], v5 offset:0
    s_add_u32 m0, s42, 0
    s_nop 0
    buffer_load_dwordx4 v10, s[20:23], s40 offen lds
    s_add_u32 m0, s42, 1024
    s_nop 0
    buffer_load_dwordx4 v11, s[20:23], s40 offen lds
    s_add_u32 m0, s43, 0
    s_nop 0
    buffer_load_dwordx4 v18, s[24:27], s41 offen lds
    s_add_u32 m0, s43, 1024
    s_nop 0
    buffer_load_dwordx4 v19, s[24:27], s41 offen lds
    s_add_u32 m0, s43, 2048
    s_nop 0
    buffer_load_dwordx4 v20, s[24:27], s41 offen lds
    s_add_u32 m0, s43, 3072
    s_nop 0
    buffer_load_dwordx4 v21, s[24:27], s41 offen lds
    s_add_u32 s40, s40, 128
    s_add_u32 s41, s41, 524288
    s_add_u32 s42, s42, 24576
    s_add_u32 s43, s43, 24576
    s_cmp_eq_u32 s16, 1
    s_cbranch_scc1 mega_kernel_qfad_sw2
    v_mfma_f32_32x32x16_bf16 a[0:15], v[36:39], v[32:35], a[0:15]
    v_mfma_f32_32x32x16_bf16 a[16:31], v[40:43], v[32:35], a[16:31]
    v_mfma_f32_32x32x16_bf16 a[0:15], v[48:51], v[44:47], a[0:15]
    v_mfma_f32_32x32x16_bf16 a[16:31], v[52:55], v[44:47], a[16:31]
    v_mfma_f32_32x32x16_bf16 a[0:15], v[60:63], v[56:59], a[0:15]
    v_mfma_f32_32x32x16_bf16 a[16:31], v[64:67], v[56:59], a[16:31]
    v_mfma_f32_32x32x16_bf16 a[0:15], v[72:75], v[68:71], a[0:15]
    v_mfma_f32_32x32x16_bf16 a[16:31], v[76:79], v[68:71], a[16:31]
mega_kernel_qfad_swr2:
    s_waitcnt lgkmcnt(0)
    s_mov_b32 s52, 24576
    v_add_u32 v2, s52, v2
    v_add_u32 v3, s52, v3
    v_add_u32 v4, s52, v4
    v_add_u32 v5, s52, v5
    v_add_u32 v6, s52, v6
    v_add_u32 v7, s52, v7
    s_waitcnt vmcnt(24)
    s_barrier
    ds_read_b64_tr_b16 v[36:37], v6 offset:0
    ds_read_b64_tr_b16 v[38:39], v6 offset:1024
    ds_read_b64_tr_b16 v[40:41], v7 offset:0
    ds_read_b64_tr_b16 v[42:43], v7 offset:1024
    ds_read_b128 v[32:35], v2 offset:0
    ds_read_b64_tr_b16 v[48:49], v6 offset:4096
    ds_read_b64_tr_b16 v[50:51], v6 offset:5120
    ds_read_b64_tr_b16 v[52:53], v7 offset:4096
    ds_read_b64_tr_b16 v[54:55], v7 offset:5120
    ds_read_b128 v[44:47], v3 offset:0
    ds_read_b64_tr_b16 v[60:61], v6 offset:8192
    ds_read_b64_tr_b16 v[62:63], v6 offset:9216
    ds_read_b64_tr_b16 v[64:65], v7 offset:8192
    ds_read_b64_tr_b16 v[66:67], v7 offset:9216
    ds_read_b128 v[56:59], v4 offset:0
    ds_read_b64_tr_b16 v[72:73], v6 offset:12288
    ds_read_b64_tr_b16 v[74:75], v6 offset:13312
    ds_read_b64_tr_b16 v[76:77], v7 offset:12288
    ds_read_b64_tr_b16 v[78:79], v7 offset:13312
    ds_read_b128 v[68:71], v5 offset:0
    s_add_u32 m0, s42, 0
    s_nop 0
    buffer_load_dwordx4 v10, s[20:23], s40 offen lds
    s_add_u32 m0, s42, 1024
    s_nop 0
    buffer_load_dwordx4 v11, s[20:23], s40 offen lds
    s_add_u32 m0, s43, 0
    s_nop 0
    buffer_load_dwordx4 v18, s[24:27], s41 offen lds
    s_add_u32 m0, s43, 1024
    s_nop 0
    buffer_load_dwordx4 v19, s[24:27], s41 offen lds
    s_add_u32 m0, s43, 2048
    s_nop 0
    buffer_load_dwordx4 v20, s[24:27], s41 offen lds
    s_add_u32 m0, s43, 3072
    s_nop 0
    buffer_load_dwordx4 v21, s[24:27], s41 offen lds
    s_add_u32 s40, s40, 128
    s_add_u32 s41, s41, 524288
    s_add_u32 s42, s42, 24576
    s_add_u32 s43, s43, 24576
    s_cmp_eq_u32 s16, 1
    s_cbranch_scc1 mega_kernel_qfad_sw3
    v_mfma_f32_32x32x16_bf16 a[0:15], v[84:87], v[80:83], a[0:15]
    v_mfma_f32_32x32x16_bf16 a[16:31], v[88:91], v[80:83], a[16:31]
    v_mfma_f32_32x32x16_bf16 a[0:15], v[96:99], v[92:95], a[0:15]
    v_mfma_f32_32x32x16_bf16 a[16:31], v[100:103], v[92:95], a[16:31]
    v_mfma_f32_32x32x16_bf16 a[0:15], v[108:111], v[104:107], a[0:15]
    v_mfma_f32_32x32x16_bf16 a[16:31], v[112:115], v[104:107], a[16:31]
    v_mfma_f32_32x32x16_bf16 a[0:15], v[120:123], v[116:119], a[0:15]
    v_mfma_f32_32x32x16_bf16 a[16:31], v[124:127], v[116:119], a[16:31]
mega_kernel_qfad_swr3:
    s_waitcnt lgkmcnt(0)
    s_mov_b32 s52, 24576
    v_add_u32 v2, s52, v2
    v_add_u32 v3, s52, v3
    v_add_u32 v4, s52, v4
    v_add_u32 v5, s52, v5
    v_add_u32 v6, s52, v6
    v_add_u32 v7, s52, v7
    s_waitcnt vmcnt(24)
    s_barrier
    ds_read_b64_tr_b16 v[84:85], v6 offset:0
    ds_read_b64_tr_b16 v[86:87], v6 offset:1024
    ds_read_b64_tr_b16 v[88:89], v7 offset:0
    ds_read_b64_tr_b16 v[90:91], v7 offset:1024
    ds_read_b128 v[80:83], v2 offset:0
    ds_read_b64_tr_b16 v[96:97], v6 offset:4096
    ds_read_b64_tr_b16 v[98:99], v6 offset:5120
    ds_read_b64_tr_b16 v[100:101], v7 offset:4096
    ds_read_b64_tr_b16 v[102:103], v7 offset:5120
    ds_read_b128 v[92:95], v3 offset:0
    ds_read_b64_tr_b16 v[108:109], v6 offset:8192
    ds_read_b64_tr_b16 v[110:111], v6 offset:9216
    ds_read_b64_tr_b16 v[112:113], v7 offset:8192
    ds_read_b64_tr_b16 v[114:115], v7 offset:9216
    ds_read_b128 v[104:107], v4 offset:0
    ds_read_b64_tr_b16 v[120:121], v6 offset:12288
    ds_read_b64_tr_b16 v[122:123], v6 offset:13312
    ds_read_b64_tr_b16 v[124:125], v7 offset:12288
    ds_read_b64_tr_b16 v[126:127], v7 offset:13312
    ds_read_b128 v[116:119], v5 offset:0
    s_add_u32 m0, s42, 0
    s_nop 0
    buffer_load_dwordx4 v10, s[20:23], s40 offen lds
    s_add_u32 m0, s42, 1024
    s_nop 0
    buffer_load_dwordx4 v11, s[20:23], s40 offen lds
    s_add_u32 m0, s43, 0
    s_nop 0
    buffer_load_dwordx4 v18, s[24:27], s41 offen lds
    s_add_u32 m0, s43, 1024
    s_nop 0
    buffer_load_dwordx4 v19, s[24:27], s41 offen lds
    s_add_u32 m0, s43, 2048
    s_nop 0
    buffer_load_dwordx4 v20, s[24:27], s41 offen lds
    s_add_u32 m0, s43, 3072
    s_nop 0
    buffer_load_dwordx4 v21, s[24:27], s41 offen lds
    s_add_u32 s40, s40, 128
    s_add_u32 s41, s41, 524288
    s_add_u32 s42, s42, 24576
    s_add_u32 s43, s43, 24576
    s_cmp_eq_u32 s16, 1
    s_cbranch_scc1 mega_kernel_qfad_sw4
    v_mfma_f32_32x32x16_bf16 a[0:15], v[36:39], v[32:35], a[0:15]
    v_mfma_f32_32x32x16_bf16 a[16:31], v[40:43], v[32:35], a[16:31]
    v_mfma_f32_32x32x16_bf16 a[0:15], v[48:51], v[44:47], a[0:15]
    v_mfma_f32_32x32x16_bf16 a[16:31], v[52:55], v[44:47], a[16:31]
    v_mfma_f32_32x32x16_bf16 a[0:15], v[60:63], v[56:59], a[0:15]
    v_mfma_f32_32x32x16_bf16 a[16:31], v[64:67], v[56:59], a[16:31]
    v_mfma_f32_32x32x16_bf16 a[0:15], v[72:75], v[68:71], a[0:15]
    v_mfma_f32_32x32x16_bf16 a[16:31], v[76:79], v[68:71], a[16:31]
mega_kernel_qfad_swr4:
    s_waitcnt lgkmcnt(0)
    s_mov_b32 s52, 4294844416
    v_add_u32 v2, s52, v2
    v_add_u32 v3, s52, v3
    v_add_u32 v4, s52, v4
    v_add_u32 v5, s52, v5
    v_add_u32 v6, s52, v6
    v_add_u32 v7, s52, v7
    s_waitcnt vmcnt(24)
    s_barrier
    ds_read_b64_tr_b16 v[36:37], v6 offset:0
    ds_read_b64_tr_b16 v[38:39], v6 offset:1024
    ds_read_b64_tr_b16 v[40:41], v7 offset:0
    ds_read_b64_tr_b16 v[42:43], v7 offset:1024
    ds_read_b128 v[32:35], v2 offset:0
    ds_read_b64_tr_b16 v[48:49], v6 offset:4096
    ds_read_b64_tr_b16 v[50:51], v6 offset:5120
    ds_read_b64_tr_b16 v[52:53], v7 offset:4096
    ds_read_b64_tr_b16 v[54:55], v7 offset:5120
    ds_read_b128 v[44:47], v3 offset:0
    ds_read_b64_tr_b16 v[60:61], v6 offset:8192
    ds_read_b64_tr_b16 v[62:63], v6 offset:9216
    ds_read_b64_tr_b16 v[64:65], v7 offset:8192
    ds_read_b64_tr_b16 v[66:67], v7 offset:9216
    ds_read_b128 v[56:59], v4 offset:0
    ds_read_b64_tr_b16 v[72:73], v6 offset:12288
    ds_read_b64_tr_b16 v[74:75], v6 offset:13312
    ds_read_b64_tr_b16 v[76:77], v7 offset:12288
    ds_read_b64_tr_b16 v[78:79], v7 offset:13312
    ds_read_b128 v[68:71], v5 offset:0
    s_add_u32 m0, s42, 0
    s_nop 0
    buffer_load_dwordx4 v10, s[20:23], s40 offen lds
    s_add_u32 m0, s42, 1024
    s_nop 0
    buffer_load_dwordx4 v11, s[20:23], s40 offen lds
    s_add_u32 m0, s43, 0
    s_nop 0
    buffer_load_dwordx4 v18, s[24:27], s41 offen lds
    s_add_u32 m0, s43, 1024
    s_nop 0
    buffer_load_dwordx4 v19, s[24:27], s41 offen lds
    s_add_u32 m0, s43, 2048
    s_nop 0
    buffer_load_dwordx4 v20, s[24:27], s41 offen lds
    s_add_u32 m0, s43, 3072
    s_nop 0
    buffer_load_dwordx4 v21, s[24:27], s41 offen lds
    s_add_u32 s40, s40, 128
    s_add_u32 s41, s41, 524288
    s_sub_u32 s42, s42, 122880
    s_sub_u32 s43, s43, 122880
    s_cmp_eq_u32 s16, 1
    s_cbranch_scc1 mega_kernel_qfad_sw5
    v_mfma_f32_32x32x16_bf16 a[0:15], v[84:87], v[80:83], a[0:15]
    v_mfma_f32_32x32x16_bf16 a[16:31], v[88:91], v[80:83], a[16:31]
    v_mfma_f32_32x32x16_bf16 a[0:15], v[96:99], v[92:95], a[0:15]
    v_mfma_f32_32x32x16_bf16 a[16:31], v[100:103], v[92:95], a[16:31]
    v_mfma_f32_32x32x16_bf16 a[0:15], v[108:111], v[104:107], a[0:15]
    v_mfma_f32_32x32x16_bf16 a[16:31], v[112:115], v[104:107], a[16:31]
    v_mfma_f32_32x32x16_bf16 a[0:15], v[120:123], v[116:119], a[0:15]
    v_mfma_f32_32x32x16_bf16 a[16:31], v[124:127], v[116:119], a[16:31]
mega_kernel_qfad_swr5:
    s_waitcnt lgkmcnt(0)
    s_mov_b32 s52, 24576
    v_add_u32 v2, s52, v2
    v_add_u32 v3, s52, v3
    v_add_u32 v4, s52, v4
    v_add_u32 v5, s52, v5
    v_add_u32 v6, s52, v6
    v_add_u32 v7, s52, v7
    s_waitcnt vmcnt(24)
    s_barrier
    ds_read_b64_tr_b16 v[84:85], v6 offset:0
    ds_read_b64_tr_b16 v[86:87], v6 offset:1024
    ds_read_b64_tr_b16 v[88:89], v7 offset:0
    ds_read_b64_tr_b16 v[90:91], v7 offset:1024
    ds_read_b128 v[80:83], v2 offset:0
    ds_read_b64_tr_b16 v[96:97], v6 offset:4096
    ds_read_b64_tr_b16 v[98:99], v6 offset:5120
    ds_read_b64_tr_b16 v[100:101], v7 offset:4096
    ds_read_b64_tr_b16 v[102:103], v7 offset:5120
    ds_read_b128 v[92:95], v3 offset:0
    ds_read_b64_tr_b16 v[108:109], v6 offset:8192
    ds_read_b64_tr_b16 v[110:111], v6 offset:9216
    ds_read_b64_tr_b16 v[112:113], v7 offset:8192
    ds_read_b64_tr_b16 v[114:115], v7 offset:9216
    ds_read_b128 v[104:107], v4 offset:0
    ds_read_b64_tr_b16 v[120:121], v6 offset:12288
    ds_read_b64_tr_b16 v[122:123], v6 offset:13312
    ds_read_b64_tr_b16 v[124:125], v7 offset:12288
    ds_read_b64_tr_b16 v[126:127], v7 offset:13312
    ds_read_b128 v[116:119], v5 offset:0
    s_add_u32 m0, s42, 0
    s_nop 0
    buffer_load_dwordx4 v10, s[20:23], s40 offen lds
    s_add_u32 m0, s42, 1024
    s_nop 0
    buffer_load_dwordx4 v11, s[20:23], s40 offen lds
    s_add_u32 m0, s43, 0
    s_nop 0
    buffer_load_dwordx4 v18, s[24:27], s41 offen lds
    s_add_u32 m0, s43, 1024
    s_nop 0
    buffer_load_dwordx4 v19, s[24:27], s41 offen lds
    s_add_u32 m0, s43, 2048
    s_nop 0
    buffer_load_dwordx4 v20, s[24:27], s41 offen lds
    s_add_u32 m0, s43, 3072
    s_nop 0
    buffer_load_dwordx4 v21, s[24:27], s41 offen lds
    s_add_u32 s40, s40, 128
    s_add_u32 s41, s41, 524288
    s_add_u32 s42, s42, 24576
    s_add_u32 s43, s43, 24576
    s_cmp_eq_u32 s16, 1
    s_cbranch_scc1 mega_kernel_qfad_sw6
    v_mfma_f32_32x32x16_bf16 a[0:15], v[36:39], v[32:35], a[0:15]
    v_mfma_f32_32x32x16_bf16 a[16:31], v[40:43], v[32:35], a[16:31]
    v_mfma_f32_32x32x16_bf16 a[0:15], v[48:51], v[44:47], a[0:15]
    v_mfma_f32_32x32x16_bf16 a[16:31], v[52:55], v[44:47], a[16:31]
    v_mfma_f32_32x32x16_bf16 a[0:15], v[60:63], v[56:59], a[0:15]
    v_mfma_f32_32x32x16_bf16 a[16:31], v[64:67], v[56:59], a[16:31]
    v_mfma_f32_32x32x16_bf16 a[0:15], v[72:75], v[68:71], a[0:15]
    v_mfma_f32_32x32x16_bf16 a[16:31], v[76:79], v[68:71], a[16:31]
mega_kernel_qfad_swr6:
    s_waitcnt lgkmcnt(0)
    s_mov_b32 s52, 24576
    v_add_u32 v2, s52, v2
    v_add_u32 v3, s52, v3
    v_add_u32 v4, s52, v4
    v_add_u32 v5, s52, v5
    v_add_u32 v6, s52, v6
    v_add_u32 v7, s52, v7
    s_waitcnt vmcnt(24)
    s_barrier
    ds_read_b64_tr_b16 v[36:37], v6 offset:0
    ds_read_b64_tr_b16 v[38:39], v6 offset:1024
    ds_read_b64_tr_b16 v[40:41], v7 offset:0
    ds_read_b64_tr_b16 v[42:43], v7 offset:1024
    ds_read_b128 v[32:35], v2 offset:0
    ds_read_b64_tr_b16 v[48:49], v6 offset:4096
    ds_read_b64_tr_b16 v[50:51], v6 offset:5120
    ds_read_b64_tr_b16 v[52:53], v7 offset:4096
    ds_read_b64_tr_b16 v[54:55], v7 offset:5120
    ds_read_b128 v[44:47], v3 offset:0
    ds_read_b64_tr_b16 v[60:61], v6 offset:8192
    ds_read_b64_tr_b16 v[62:63], v6 offset:9216
    ds_read_b64_tr_b16 v[64:65], v7 offset:8192
    ds_read_b64_tr_b16 v[66:67], v7 offset:9216
    ds_read_b128 v[56:59], v4 offset:0
    ds_read_b64_tr_b16 v[72:73], v6 offset:12288
    ds_read_b64_tr_b16 v[74:75], v6 offset:13312
    ds_read_b64_tr_b16 v[76:77], v7 offset:12288
    ds_read_b64_tr_b16 v[78:79], v7 offset:13312
    ds_read_b128 v[68:71], v5 offset:0
    s_add_u32 m0, s42, 0
    s_nop 0
    buffer_load_dwordx4 v10, s[20:23], s40 offen lds
    s_add_u32 m0, s42, 1024
    s_nop 0
    buffer_load_dwordx4 v11, s[20:23], s40 offen lds
    s_add_u32 m0, s43, 0
    s_nop 0
    buffer_load_dwordx4 v18, s[24:27], s41 offen lds
    s_add_u32 m0, s43, 1024
    s_nop 0
    buffer_load_dwordx4 v19, s[24:27], s41 offen lds
    s_add_u32 m0, s43, 2048
    s_nop 0
    buffer_load_dwordx4 v20, s[24:27], s41 offen lds
    s_add_u32 m0, s43, 3072
    s_nop 0
    buffer_load_dwordx4 v21, s[24:27], s41 offen lds
    s_add_u32 s40, s40, 128
    s_add_u32 s41, s41, 524288
    s_add_u32 s42, s42, 24576
    s_add_u32 s43, s43, 24576
    s_cmp_eq_u32 s16, 1
    s_cbranch_scc1 mega_kernel_qfad_sw7
    v_mfma_f32_32x32x16_bf16 a[0:15], v[84:87], v[80:83], a[0:15]
    v_mfma_f32_32x32x16_bf16 a[16:31], v[88:91], v[80:83], a[16:31]
    v_mfma_f32_32x32x16_bf16 a[0:15], v[96:99], v[92:95], a[0:15]
    v_mfma_f32_32x32x16_bf16 a[16:31], v[100:103], v[92:95], a[16:31]
    v_mfma_f32_32x32x16_bf16 a[0:15], v[108:111], v[104:107], a[0:15]
    v_mfma_f32_32x32x16_bf16 a[16:31], v[112:115], v[104:107], a[16:31]
    v_mfma_f32_32x32x16_bf16 a[0:15], v[120:123], v[116:119], a[0:15]
    v_mfma_f32_32x32x16_bf16 a[16:31], v[124:127], v[116:119], a[16:31]
mega_kernel_qfad_swr7:
    s_waitcnt lgkmcnt(0)
    s_mov_b32 s52, 24576
    v_add_u32 v2, s52, v2
    v_add_u32 v3, s52, v3
    v_add_u32 v4, s52, v4
    v_add_u32 v5, s52, v5
    v_add_u32 v6, s52, v6
    v_add_u32 v7, s52, v7
    s_waitcnt vmcnt(24)
    s_barrier
    ds_read_b64_tr_b16 v[84:85], v6 offset:0
    ds_read_b64_tr_b16 v[86:87], v6 offset:1024
    ds_read_b64_tr_b16 v[88:89], v7 offset:0
    ds_read_b64_tr_b16 v[90:91], v7 offset:1024
    ds_read_b128 v[80:83], v2 offset:0
    ds_read_b64_tr_b16 v[96:97], v6 offset:4096
    ds_read_b64_tr_b16 v[98:99], v6 offset:5120
    ds_read_b64_tr_b16 v[100:101], v7 offset:4096
    ds_read_b64_tr_b16 v[102:103], v7 offset:5120
    ds_read_b128 v[92:95], v3 offset:0
    ds_read_b64_tr_b16 v[108:109], v6 offset:8192
    ds_read_b64_tr_b16 v[110:111], v6 offset:9216
    ds_read_b64_tr_b16 v[112:113], v7 offset:8192
    ds_read_b64_tr_b16 v[114:115], v7 offset:9216
    ds_read_b128 v[104:107], v4 offset:0
    ds_read_b64_tr_b16 v[120:121], v6 offset:12288
    ds_read_b64_tr_b16 v[122:123], v6 offset:13312
    ds_read_b64_tr_b16 v[124:125], v7 offset:12288
    ds_read_b64_tr_b16 v[126:127], v7 offset:13312
    ds_read_b128 v[116:119], v5 offset:0
    s_add_u32 m0, s42, 0
    s_nop 0
    buffer_load_dwordx4 v10, s[20:23], s40 offen lds
    s_add_u32 m0, s42, 1024
    s_nop 0
    buffer_load_dwordx4 v11, s[20:23], s40 offen lds
    s_add_u32 m0, s43, 0
    s_nop 0
    buffer_load_dwordx4 v18, s[24:27], s41 offen lds
    s_add_u32 m0, s43, 1024
    s_nop 0
    buffer_load_dwordx4 v19, s[24:27], s41 offen lds
    s_add_u32 m0, s43, 2048
    s_nop 0
    buffer_load_dwordx4 v20, s[24:27], s41 offen lds
    s_add_u32 m0, s43, 3072
    s_nop 0
    buffer_load_dwordx4 v21, s[24:27], s41 offen lds
    s_add_u32 s40, s40, 128
    s_add_u32 s41, s41, 524288
    s_add_u32 s42, s42, 24576
    s_add_u32 s43, s43, 24576
    s_cmp_eq_u32 s16, 1
    s_cbranch_scc1 mega_kernel_qfad_sw8
    v_mfma_f32_32x32x16_bf16 a[0:15], v[36:39], v[32:35], a[0:15]
    v_mfma_f32_32x32x16_bf16 a[16:31], v[40:43], v[32:35], a[16:31]
    v_mfma_f32_32x32x16_bf16 a[0:15], v[48:51], v[44:47], a[0:15]
    v_mfma_f32_32x32x16_bf16 a[16:31], v[52:55], v[44:47], a[16:31]
    v_mfma_f32_32x32x16_bf16 a[0:15], v[60:63], v[56:59], a[0:15]
    v_mfma_f32_32x32x16_bf16 a[16:31], v[64:67], v[56:59], a[16:31]
    v_mfma_f32_32x32x16_bf16 a[0:15], v[72:75], v[68:71], a[0:15]
    v_mfma_f32_32x32x16_bf16 a[16:31], v[76:79], v[68:71], a[16:31]
mega_kernel_qfad_swr8:
    s_waitcnt lgkmcnt(0)
    s_mov_b32 s52, 24576
    v_add_u32 v2, s52, v2
    v_add_u32 v3, s52, v3
    v_add_u32 v4, s52, v4
    v_add_u32 v5, s52, v5
    v_add_u32 v6, s52, v6
    v_add_u32 v7, s52, v7
    s_waitcnt vmcnt(24)
    s_barrier
    ds_read_b64_tr_b16 v[36:37], v6 offset:0
    ds_read_b64_tr_b16 v[38:39], v6 offset:1024
    ds_read_b64_tr_b16 v[40:41], v7 offset:0
    ds_read_b64_tr_b16 v[42:43], v7 offset:1024
    ds_read_b128 v[32:35], v2 offset:0
    ds_read_b64_tr_b16 v[48:49], v6 offset:4096
    ds_read_b64_tr_b16 v[50:51], v6 offset:5120
    ds_read_b64_tr_b16 v[52:53], v7 offset:4096
    ds_read_b64_tr_b16 v[54:55], v7 offset:5120
    ds_read_b128 v[44:47], v3 offset:0
    ds_read_b64_tr_b16 v[60:61], v6 offset:8192
    ds_read_b64_tr_b16 v[62:63], v6 offset:9216
    ds_read_b64_tr_b16 v[64:65], v7 offset:8192
    ds_read_b64_tr_b16 v[66:67], v7 offset:9216
    ds_read_b128 v[56:59], v4 offset:0
    ds_read_b64_tr_b16 v[72:73], v6 offset:12288
    ds_read_b64_tr_b16 v[74:75], v6 offset:13312
    ds_read_b64_tr_b16 v[76:77], v7 offset:12288
    ds_read_b64_tr_b16 v[78:79], v7 offset:13312
    ds_read_b128 v[68:71], v5 offset:0
    s_add_u32 m0, s42, 0
    s_nop 0
    buffer_load_dwordx4 v10, s[20:23], s40 offen lds
    s_add_u32 m0, s42, 1024
    s_nop 0
    buffer_load_dwordx4 v11, s[20:23], s40 offen lds
    s_add_u32 m0, s43, 0
    s_nop 0
    buffer_load_dwordx4 v18, s[24:27], s41 offen lds
    s_add_u32 m0, s43, 1024
    s_nop 0
    buffer_load_dwordx4 v19, s[24:27], s41 offen lds
    s_add_u32 m0, s43, 2048
    s_nop 0
    buffer_load_dwordx4 v20, s[24:27], s41 offen lds
    s_add_u32 m0, s43, 3072
    s_nop 0
    buffer_load_dwordx4 v21, s[24:27], s41 offen lds
    s_add_u32 s40, s40, 128
    s_add_u32 s41, s41, 524288
    s_add_u32 s42, s42, 24576
    s_add_u32 s43, s43, 24576
    s_cmp_eq_u32 s16, 1
    s_cbranch_scc1 mega_kernel_qfad_sw9
    v_mfma_f32_32x32x16_bf16 a[0:15], v[84:87], v[80:83], a[0:15]
    v_mfma_f32_32x32x16_bf16 a[16:31], v[88:91], v[80:83], a[16:31]
    v_mfma_f32_32x32x16_bf16 a[0:15], v[96:99], v[92:95], a[0:15]
    v_mfma_f32_32x32x16_bf16 a[16:31], v[100:103], v[92:95], a[16:31]
    v_mfma_f32_32x32x16_bf16 a[0:15], v[108:111], v[104:107], a[0:15]
    v_mfma_f32_32x32x16_bf16 a[16:31], v[112:115], v[104:107], a[16:31]
    v_mfma_f32_32x32x16_bf16 a[0:15], v[120:123], v[116:119], a[0:15]
    v_mfma_f32_32x32x16_bf16 a[16:31], v[124:127], v[116:119], a[16:31]
mega_kernel_qfad_swr9:
    s_waitcnt lgkmcnt(0)
    s_mov_b32 s52, 24576
    v_add_u32 v2, s52, v2
    v_add_u32 v3, s52, v3
    v_add_u32 v4, s52, v4
    v_add_u32 v5, s52, v5
    v_add_u32 v6, s52, v6
    v_add_u32 v7, s52, v7
    s_waitcnt vmcnt(24)
    s_barrier
    ds_read_b64_tr_b16 v[84:85], v6 offset:0
    ds_read_b64_tr_b16 v[86:87], v6 offset:1024
    ds_read_b64_tr_b16 v[88:89], v7 offset:0
    ds_read_b64_tr_b16 v[90:91], v7 offset:1024
    ds_read_b128 v[80:83], v2 offset:0
    ds_read_b64_tr_b16 v[96:97], v6 offset:4096
    ds_read_b64_tr_b16 v[98:99], v6 offset:5120
    ds_read_b64_tr_b16 v[100:101], v7 offset:4096
    ds_read_b64_tr_b16 v[102:103], v7 offset:5120
    ds_read_b128 v[92:95], v3 offset:0
    ds_read_b64_tr_b16 v[108:109], v6 offset:8192
    ds_read_b64_tr_b16 v[110:111], v6 offset:9216
    ds_read_b64_tr_b16 v[112:113], v7 offset:8192
    ds_read_b64_tr_b16 v[114:115], v7 offset:9216
    ds_read_b128 v[104:107], v4 offset:0
    ds_read_b64_tr_b16 v[120:121], v6 offset:12288
    ds_read_b64_tr_b16 v[122:123], v6 offset:13312
    ds_read_b64_tr_b16 v[124:125], v7 offset:12288
    ds_read_b64_tr_b16 v[126:127], v7 offset:13312
    ds_read_b128 v[116:119], v5 offset:0
    s_cmp_eq_u32 s16, 1
    s_cbranch_scc1 mega_kernel_qfad_sw10
    v_mfma_f32_32x32x16_bf16 a[0:15], v[36:39], v[32:35], a[0:15]
    v_mfma_f32_32x32x16_bf16 a[16:31], v[40:43], v[32:35], a[16:31]
    v_mfma_f32_32x32x16_bf16 a[0:15], v[48:51], v[44:47], a[0:15]
    v_mfma_f32_32x32x16_bf16 a[16:31], v[52:55], v[44:47], a[16:31]
    v_mfma_f32_32x32x16_bf16 a[0:15], v[60:63], v[56:59], a[0:15]
    v_mfma_f32_32x32x16_bf16 a[16:31], v[64:67], v[56:59], a[16:31]
    v_mfma_f32_32x32x16_bf16 a[0:15], v[72:75], v[68:71], a[0:15]
    v_mfma_f32_32x32x16_bf16 a[16:31], v[76:79], v[68:71], a[16:31]
mega_kernel_qfad_swr10:
    s_waitcnt lgkmcnt(0)
    s_mov_b32 s52, 4294844416
    v_add_u32 v2, s52, v2
    v_add_u32 v3, s52, v3
    v_add_u32 v4, s52, v4
    v_add_u32 v5, s52, v5
    v_add_u32 v6, s52, v6
    v_add_u32 v7, s52, v7
    s_waitcnt vmcnt(18)
    s_barrier
    ds_read_b64_tr_b16 v[36:37], v6 offset:0
    ds_read_b64_tr_b16 v[38:39], v6 offset:1024
    ds_read_b64_tr_b16 v[40:41], v7 offset:0
    ds_read_b64_tr_b16 v[42:43], v7 offset:1024
    ds_read_b128 v[32:35], v2 offset:0
    ds_read_b64_tr_b16 v[48:49], v6 offset:4096
    ds_read_b64_tr_b16 v[50:51], v6 offset:5120
    ds_read_b64_tr_b16 v[52:53], v7 offset:4096
    ds_read_b64_tr_b16 v[54:55], v7 offset:5120
    ds_read_b128 v[44:47], v3 offset:0
    ds_read_b64_tr_b16 v[60:61], v6 offset:8192
    ds_read_b64_tr_b16 v[62:63], v6 offset:9216
    ds_read_b64_tr_b16 v[64:65], v7 offset:8192
    ds_read_b64_tr_b16 v[66:67], v7 offset:9216
    ds_read_b128 v[56:59], v4 offset:0
    ds_read_b64_tr_b16 v[72:73], v6 offset:12288
    ds_read_b64_tr_b16 v[74:75], v6 offset:13312
    ds_read_b64_tr_b16 v[76:77], v7 offset:12288
    ds_read_b64_tr_b16 v[78:79], v7 offset:13312
    ds_read_b128 v[68:71], v5 offset:0
    s_cmp_eq_u32 s16, 1
    s_cbranch_scc1 mega_kernel_qfad_sw11
    v_mfma_f32_32x32x16_bf16 a[0:15], v[84:87], v[80:83], a[0:15]
    v_mfma_f32_32x32x16_bf16 a[16:31], v[88:91], v[80:83], a[16:31]
    v_mfma_f32_32x32x16_bf16 a[0:15], v[96:99], v[92:95], a[0:15]
    v_mfma_f32_32x32x16_bf16 a[16:31], v[100:103], v[92:95], a[16:31]
    v_mfma_f32_32x32x16_bf16 a[0:15], v[108:111], v[104:107], a[0:15]
    v_mfma_f32_32x32x16_bf16 a[16:31], v[112:115], v[104:107], a[16:31]
    v_mfma_f32_32x32x16_bf16 a[0:15], v[120:123], v[116:119], a[0:15]
    v_mfma_f32_32x32x16_bf16 a[16:31], v[124:127], v[116:119], a[16:31]
mega_kernel_qfad_swr11:
    s_waitcnt lgkmcnt(0)
    s_mov_b32 s52, 24576
    v_add_u32 v2, s52, v2
    v_add_u32 v3, s52, v3
    v_add_u32 v4, s52, v4
    v_add_u32 v5, s52, v5
    v_add_u32 v6, s52, v6
    v_add_u32 v7, s52, v7
    s_waitcnt vmcnt(12)
    s_barrier
    ds_read_b64_tr_b16 v[84:85], v6 offset:0
    ds_read_b64_tr_b16 v[86:87], v6 offset:1024
    ds_read_b64_tr_b16 v[88:89], v7 offset:0
    ds_read_b64_tr_b16 v[90:91], v7 offset:1024
    ds_read_b128 v[80:83], v2 offset:0
    ds_read_b64_tr_b16 v[96:97], v6 offset:4096
    ds_read_b64_tr_b16 v[98:99], v6 offset:5120
    ds_read_b64_tr_b16 v[100:101], v7 offset:4096
    ds_read_b64_tr_b16 v[102:103], v7 offset:5120
    ds_read_b128 v[92:95], v3 offset:0
    ds_read_b64_tr_b16 v[108:109], v6 offset:8192
    ds_read_b64_tr_b16 v[110:111], v6 offset:9216
    ds_read_b64_tr_b16 v[112:113], v7 offset:8192
    ds_read_b64_tr_b16 v[114:115], v7 offset:9216
    ds_read_b128 v[104:107], v4 offset:0
    ds_read_b64_tr_b16 v[120:121], v6 offset:12288
    ds_read_b64_tr_b16 v[122:123], v6 offset:13312
    ds_read_b64_tr_b16 v[124:125], v7 offset:12288
    ds_read_b64_tr_b16 v[126:127], v7 offset:13312
    ds_read_b128 v[116:119], v5 offset:0
    s_cmp_eq_u32 s16, 1
    s_cbranch_scc1 mega_kernel_qfad_sw12
    v_mfma_f32_32x32x16_bf16 a[0:15], v[36:39], v[32:35], a[0:15]
    v_mfma_f32_32x32x16_bf16 a[16:31], v[40:43], v[32:35], a[16:31]
    v_mfma_f32_32x32x16_bf16 a[0:15], v[48:51], v[44:47], a[0:15]
    v_mfma_f32_32x32x16_bf16 a[16:31], v[52:55], v[44:47], a[16:31]
    v_mfma_f32_32x32x16_bf16 a[0:15], v[60:63], v[56:59], a[0:15]
    v_mfma_f32_32x32x16_bf16 a[16:31], v[64:67], v[56:59], a[16:31]
    v_mfma_f32_32x32x16_bf16 a[0:15], v[72:75], v[68:71], a[0:15]
    v_mfma_f32_32x32x16_bf16 a[16:31], v[76:79], v[68:71], a[16:31]
mega_kernel_qfad_swr12:
    s_waitcnt lgkmcnt(0)
    s_mov_b32 s52, 24576
    v_add_u32 v2, s52, v2
    v_add_u32 v3, s52, v3
    v_add_u32 v4, s52, v4
    v_add_u32 v5, s52, v5
    v_add_u32 v6, s52, v6
    v_add_u32 v7, s52, v7
    s_waitcnt vmcnt(6)
    s_barrier
    ds_read_b64_tr_b16 v[36:37], v6 offset:0
    ds_read_b64_tr_b16 v[38:39], v6 offset:1024
    ds_read_b64_tr_b16 v[40:41], v7 offset:0
    ds_read_b64_tr_b16 v[42:43], v7 offset:1024
    ds_read_b128 v[32:35], v2 offset:0
    ds_read_b64_tr_b16 v[48:49], v6 offset:4096
    ds_read_b64_tr_b16 v[50:51], v6 offset:5120
    ds_read_b64_tr_b16 v[52:53], v7 offset:4096
    ds_read_b64_tr_b16 v[54:55], v7 offset:5120
    ds_read_b128 v[44:47], v3 offset:0
    ds_read_b64_tr_b16 v[60:61], v6 offset:8192
    ds_read_b64_tr_b16 v[62:63], v6 offset:9216
    ds_read_b64_tr_b16 v[64:65], v7 offset:8192
    ds_read_b64_tr_b16 v[66:67], v7 offset:9216
    ds_read_b128 v[56:59], v4 offset:0
    ds_read_b64_tr_b16 v[72:73], v6 offset:12288
    ds_read_b64_tr_b16 v[74:75], v6 offset:13312
    ds_read_b64_tr_b16 v[76:77], v7 offset:12288
    ds_read_b64_tr_b16 v[78:79], v7 offset:13312
    ds_read_b128 v[68:71], v5 offset:0
    s_cmp_eq_u32 s16, 1
    s_cbranch_scc1 mega_kernel_qfad_sw13
    v_mfma_f32_32x32x16_bf16 a[0:15], v[84:87], v[80:83], a[0:15]
    v_mfma_f32_32x32x16_bf16 a[16:31], v[88:91], v[80:83], a[16:31]
    v_mfma_f32_32x32x16_bf16 a[0:15], v[96:99], v[92:95], a[0:15]
    v_mfma_f32_32x32x16_bf16 a[16:31], v[100:103], v[92:95], a[16:31]
    v_mfma_f32_32x32x16_bf16 a[0:15], v[108:111], v[104:107], a[0:15]
    v_mfma_f32_32x32x16_bf16 a[16:31], v[112:115], v[104:107], a[16:31]
    v_mfma_f32_32x32x16_bf16 a[0:15], v[120:123], v[116:119], a[0:15]
    v_mfma_f32_32x32x16_bf16 a[16:31], v[124:127], v[116:119], a[16:31]
mega_kernel_qfad_swr13:
    s_waitcnt lgkmcnt(0)
    s_mov_b32 s52, 24576
    v_add_u32 v2, s52, v2
    v_add_u32 v3, s52, v3
    v_add_u32 v4, s52, v4
    v_add_u32 v5, s52, v5
    v_add_u32 v6, s52, v6
    v_add_u32 v7, s52, v7
    s_waitcnt vmcnt(0)
    s_barrier
    ds_read_b64_tr_b16 v[84:85], v6 offset:0
    ds_read_b64_tr_b16 v[86:87], v6 offset:1024
    ds_read_b64_tr_b16 v[88:89], v7 offset:0
    ds_read_b64_tr_b16 v[90:91], v7 offset:1024
    ds_read_b128 v[80:83], v2 offset:0
    ds_read_b64_tr_b16 v[96:97], v6 offset:4096
    ds_read_b64_tr_b16 v[98:99], v6 offset:5120
    ds_read_b64_tr_b16 v[100:101], v7 offset:4096
    ds_read_b64_tr_b16 v[102:103], v7 offset:5120
    ds_read_b128 v[92:95], v3 offset:0
    ds_read_b64_tr_b16 v[108:109], v6 offset:8192
    ds_read_b64_tr_b16 v[110:111], v6 offset:9216
    ds_read_b64_tr_b16 v[112:113], v7 offset:8192
    ds_read_b64_tr_b16 v[114:115], v7 offset:9216
    ds_read_b128 v[104:107], v4 offset:0
    ds_read_b64_tr_b16 v[120:121], v6 offset:12288
    ds_read_b64_tr_b16 v[122:123], v6 offset:13312
    ds_read_b64_tr_b16 v[124:125], v7 offset:12288
    ds_read_b64_tr_b16 v[126:127], v7 offset:13312
    ds_read_b128 v[116:119], v5 offset:0
    s_cmp_eq_u32 s16, 1
    s_cbranch_scc1 mega_kernel_qfad_sw14
    v_mfma_f32_32x32x16_bf16 a[0:15], v[36:39], v[32:35], a[0:15]
    v_mfma_f32_32x32x16_bf16 a[16:31], v[40:43], v[32:35], a[16:31]
    v_mfma_f32_32x32x16_bf16 a[0:15], v[48:51], v[44:47], a[0:15]
    v_mfma_f32_32x32x16_bf16 a[16:31], v[52:55], v[44:47], a[16:31]
    v_mfma_f32_32x32x16_bf16 a[0:15], v[60:63], v[56:59], a[0:15]
    v_mfma_f32_32x32x16_bf16 a[16:31], v[64:67], v[56:59], a[16:31]
    v_mfma_f32_32x32x16_bf16 a[0:15], v[72:75], v[68:71], a[0:15]
    v_mfma_f32_32x32x16_bf16 a[16:31], v[76:79], v[68:71], a[16:31]
mega_kernel_qfad_swr14:
    s_waitcnt lgkmcnt(0)
    s_cmp_eq_u32 s16, 1
    s_cbranch_scc1 mega_kernel_qfad_sw15
    v_mfma_f32_32x32x16_bf16 a[0:15], v[84:87], v[80:83], a[0:15]
    v_mfma_f32_32x32x16_bf16 a[16:31], v[88:91], v[80:83], a[16:31]
    v_mfma_f32_32x32x16_bf16 a[0:15], v[96:99], v[92:95], a[0:15]
    v_mfma_f32_32x32x16_bf16 a[16:31], v[100:103], v[92:95], a[16:31]
    v_mfma_f32_32x32x16_bf16 a[0:15], v[108:111], v[104:107], a[0:15]
    v_mfma_f32_32x32x16_bf16 a[16:31], v[112:115], v[104:107], a[16:31]
    v_mfma_f32_32x32x16_bf16 a[0:15], v[120:123], v[116:119], a[0:15]
    v_mfma_f32_32x32x16_bf16 a[16:31], v[124:127], v[116:119], a[16:31]
mega_kernel_qfad_swr15:
    s_branch mega_kernel_qfad_done
mega_kernel_qfad_sw0:
    s_nop 7
    v_mfma_f32_32x32x16_bf16 a[0:15], v[32:35], v[36:39], 0
    v_mfma_f32_32x32x16_bf16 a[16:31], v[32:35], v[40:43], 0
    v_mfma_f32_32x32x16_bf16 a[0:15], v[44:47], v[48:51], a[0:15]
    v_mfma_f32_32x32x16_bf16 a[16:31], v[44:47], v[52:55], a[16:31]
    v_mfma_f32_32x32x16_bf16 a[0:15], v[56:59], v[60:63], a[0:15]
    v_mfma_f32_32x32x16_bf16 a[16:31], v[56:59], v[64:67], a[16:31]
    v_mfma_f32_32x32x16_bf16 a[0:15], v[68:71], v[72:75], a[0:15]
    v_mfma_f32_32x32x16_bf16 a[16:31], v[68:71], v[76:79], a[16:31]
    s_branch mega_kernel_qfad_swr0
mega_kernel_qfad_sw1:
    v_mfma_f32_32x32x16_bf16 a[0:15], v[80:83], v[84:87], a[0:15]
    v_mfma_f32_32x32x16_bf16 a[16:31], v[80:83], v[88:91], a[16:31]
    v_mfma_f32_32x32x16_bf16 a[0:15], v[92:95], v[96:99], a[0:15]
    v_mfma_f32_32x32x16_bf16 a[16:31], v[92:95], v[100:103], a[16:31]
    v_mfma_f32_32x32x16_bf16 a[0:15], v[104:107], v[108:111], a[0:15]
    v_mfma_f32_32x32x16_bf16 a[16:31], v[104:107], v[112:115], a[16:31]
    v_mfma_f32_32x32x16_bf16 a[0:15], v[116:119], v[120:123], a[0:15]
    v_mfma_f32_32x32x16_bf16 a[16:31], v[116:119], v[124:127], a[16:31]
    s_branch mega_kernel_qfad_swr1
mega_kernel_qfad_sw2:
    v_mfma_f32_32x32x16_bf16 a[0:15], v[32:35], v[36:39], a[0:15]
    v_mfma_f32_32x32x16_bf16 a[16:31], v[32:35], v[40:43], a[16:31]
    v_mfma_f32_32x32x16_bf16 a[0:15], v[44:47], v[48:51], a[0:15]
    v_mfma_f32_32x32x16_bf16 a[16:31], v[44:47], v[52:55], a[16:31]
    v_mfma_f32_32x32x16_bf16 a[0:15], v[56:59], v[60:63], a[0:15]
    v_mfma_f32_32x32x16_bf16 a[16:31], v[56:59], v[64:67], a[16:31]
    v_mfma_f32_32x32x16_bf16 a[0:15], v[68:71], v[72:75], a[0:15]
    v_mfma_f32_32x32x16_bf16 a[16:31], v[68:71], v[76:79], a[16:31]
    s_branch mega_kernel_qfad_swr2
mega_kernel_qfad_sw3:
    v_mfma_f32_32x32x16_bf16 a[0:15], v[80:83], v[84:87], a[0:15]
    v_mfma_f32_32x32x16_bf16 a[16:31], v[80:83], v[88:91], a[16:31]
    v_mfma_f32_32x32x16_bf16 a[0:15], v[92:95], v[96:99], a[0:15]
    v_mfma_f32_32x32x16_bf16 a[16:31], v[92:95], v[100:103], a[16:31]
    v_mfma_f32_32x32x16_bf16 a[0:15], v[104:107], v[108:111], a[0:15]
    v_mfma_f32_32x32x16_bf16 a[16:31], v[104:107], v[112:115], a[16:31]
    v_mfma_f32_32x32x16_bf16 a[0:15], v[116:119], v[120:123], a[0:15]
    v_mfma_f32_32x32x16_bf16 a[16:31], v[116:119], v[124:127], a[16:31]
    s_branch mega_kernel_qfad_swr3
mega_kernel_qfad_sw4:
    v_mfma_f32_32x32x16_bf16 a[0:15], v[32:35], v[36:39], a[0:15]
    v_mfma_f32_32x32x16_bf16 a[16:31], v[32:35], v[40:43], a[16:31]
    v_mfma_f32_32x32x16_bf16 a[0:15], v[44:47], v[48:51], a[0:15]
    v_mfma_f32_32x32x16_bf16 a[16:31], v[44:47], v[52:55], a[16:31]
    v_mfma_f32_32x32x16_bf16 a[0:15], v[56:59], v[60:63], a[0:15]
    v_mfma_f32_32x32x16_bf16 a[16:31], v[56:59], v[64:67], a[16:31]
    v_mfma_f32_32x32x16_bf16 a[0:15], v[68:71], v[72:75], a[0:15]
    v_mfma_f32_32x32x16_bf16 a[16:31], v[68:71], v[76:79], a[16:31]
    s_branch mega_kernel_qfad_swr4
mega_kernel_qfad_sw5:
    v_mfma_f32_32x32x16_bf16 a[0:15], v[80:83], v[84:87], a[0:15]
    v_mfma_f32_32x32x16_bf16 a[16:31], v[80:83], v[88:91], a[16:31]
    v_mfma_f32_32x32x16_bf16 a[0:15], v[92:95], v[96:99], a[0:15]
    v_mfma_f32_32x32x16_bf16 a[16:31], v[92:95], v[100:103], a[16:31]
    v_mfma_f32_32x32x16_bf16 a[0:15], v[104:107], v[108:111], a[0:15]
    v_mfma_f32_32x32x16_bf16 a[16:31], v[104:107], v[112:115], a[16:31]
    v_mfma_f32_32x32x16_bf16 a[0:15], v[116:119], v[120:123], a[0:15]
    v_mfma_f32_32x32x16_bf16 a[16:31], v[116:119], v[124:127], a[16:31]
    s_branch mega_kernel_qfad_swr5
mega_kernel_qfad_sw6:
    v_mfma_f32_32x32x16_bf16 a[0:15], v[32:35], v[36:39], a[0:15]
    v_mfma_f32_32x32x16_bf16 a[16:31], v[32:35], v[40:43], a[16:31]
    v_mfma_f32_32x32x16_bf16 a[0:15], v[44:47], v[48:51], a[0:15]
    v_mfma_f32_32x32x16_bf16 a[16:31], v[44:47], v[52:55], a[16:31]
    v_mfma_f32_32x32x16_bf16 a[0:15], v[56:59], v[60:63], a[0:15]
    v_mfma_f32_32x32x16_bf16 a[16:31], v[56:59], v[64:67], a[16:31]
    v_mfma_f32_32x32x16_bf16 a[0:15], v[68:71], v[72:75], a[0:15]
    v_mfma_f32_32x32x16_bf16 a[16:31], v[68:71], v[76:79], a[16:31]
    s_branch mega_kernel_qfad_swr6
mega_kernel_qfad_sw7:
    v_mfma_f32_32x32x16_bf16 a[0:15], v[80:83], v[84:87], a[0:15]
    v_mfma_f32_32x32x16_bf16 a[16:31], v[80:83], v[88:91], a[16:31]
    v_mfma_f32_32x32x16_bf16 a[0:15], v[92:95], v[96:99], a[0:15]
    v_mfma_f32_32x32x16_bf16 a[16:31], v[92:95], v[100:103], a[16:31]
    v_mfma_f32_32x32x16_bf16 a[0:15], v[104:107], v[108:111], a[0:15]
    v_mfma_f32_32x32x16_bf16 a[16:31], v[104:107], v[112:115], a[16:31]
    v_mfma_f32_32x32x16_bf16 a[0:15], v[116:119], v[120:123], a[0:15]
    v_mfma_f32_32x32x16_bf16 a[16:31], v[116:119], v[124:127], a[16:31]
    s_branch mega_kernel_qfad_swr7
mega_kernel_qfad_sw8:
    v_mfma_f32_32x32x16_bf16 a[0:15], v[32:35], v[36:39], a[0:15]
    v_mfma_f32_32x32x16_bf16 a[16:31], v[32:35], v[40:43], a[16:31]
    v_mfma_f32_32x32x16_bf16 a[0:15], v[44:47], v[48:51], a[0:15]
    v_mfma_f32_32x32x16_bf16 a[16:31], v[44:47], v[52:55], a[16:31]
    v_mfma_f32_32x32x16_bf16 a[0:15], v[56:59], v[60:63], a[0:15]
    v_mfma_f32_32x32x16_bf16 a[16:31], v[56:59], v[64:67], a[16:31]
    v_mfma_f32_32x32x16_bf16 a[0:15], v[68:71], v[72:75], a[0:15]
    v_mfma_f32_32x32x16_bf16 a[16:31], v[68:71], v[76:79], a[16:31]
    s_branch mega_kernel_qfad_swr8
mega_kernel_qfad_sw9:
    v_mfma_f32_32x32x16_bf16 a[0:15], v[80:83], v[84:87], a[0:15]
    v_mfma_f32_32x32x16_bf16 a[16:31], v[80:83], v[88:91], a[16:31]
    v_mfma_f32_32x32x16_bf16 a[0:15], v[92:95], v[96:99], a[0:15]
    v_mfma_f32_32x32x16_bf16 a[16:31], v[92:95], v[100:103], a[16:31]
    v_mfma_f32_32x32x16_bf16 a[0:15], v[104:107], v[108:111], a[0:15]
    v_mfma_f32_32x32x16_bf16 a[16:31], v[104:107], v[112:115], a[16:31]
    v_mfma_f32_32x32x16_bf16 a[0:15], v[116:119], v[120:123], a[0:15]
    v_mfma_f32_32x32x16_bf16 a[16:31], v[116:119], v[124:127], a[16:31]
    s_branch mega_kernel_qfad_swr9
mega_kernel_qfad_sw10:
    v_mfma_f32_32x32x16_bf16 a[0:15], v[32:35], v[36:39], a[0:15]
    v_mfma_f32_32x32x16_bf16 a[16:31], v[32:35], v[40:43], a[16:31]
    v_mfma_f32_32x32x16_bf16 a[0:15], v[44:47], v[48:51], a[0:15]
    v_mfma_f32_32x32x16_bf16 a[16:31], v[44:47], v[52:55], a[16:31]
    v_mfma_f32_32x32x16_bf16 a[0:15], v[56:59], v[60:63], a[0:15]
    v_mfma_f32_32x32x16_bf16 a[16:31], v[56:59], v[64:67], a[16:31]
    v_mfma_f32_32x32x16_bf16 a[0:15], v[68:71], v[72:75], a[0:15]
    v_mfma_f32_32x32x16_bf16 a[16:31], v[68:71], v[76:79], a[16:31]
    s_branch mega_kernel_qfad_swr10
mega_kernel_qfad_sw11:
    v_mfma_f32_32x32x16_bf16 a[0:15], v[80:83], v[84:87], a[0:15]
    v_mfma_f32_32x32x16_bf16 a[16:31], v[80:83], v[88:91], a[16:31]
    v_mfma_f32_32x32x16_bf16 a[0:15], v[92:95], v[96:99], a[0:15]
    v_mfma_f32_32x32x16_bf16 a[16:31], v[92:95], v[100:103], a[16:31]
    v_mfma_f32_32x32x16_bf16 a[0:15], v[104:107], v[108:111], a[0:15]
    v_mfma_f32_32x32x16_bf16 a[16:31], v[104:107], v[112:115], a[16:31]
    v_mfma_f32_32x32x16_bf16 a[0:15], v[116:119], v[120:123], a[0:15]
    v_mfma_f32_32x32x16_bf16 a[16:31], v[116:119], v[124:127], a[16:31]
    s_branch mega_kernel_qfad_swr11
mega_kernel_qfad_sw12:
    v_mfma_f32_32x32x16_bf16 a[0:15], v[32:35], v[36:39], a[0:15]
    v_mfma_f32_32x32x16_bf16 a[16:31], v[32:35], v[40:43], a[16:31]
    v_mfma_f32_32x32x16_bf16 a[0:15], v[44:47], v[48:51], a[0:15]
    v_mfma_f32_32x32x16_bf16 a[16:31], v[44:47], v[52:55], a[16:31]
    v_mfma_f32_32x32x16_bf16 a[0:15], v[56:59], v[60:63], a[0:15]
    v_mfma_f32_32x32x16_bf16 a[16:31], v[56:59], v[64:67], a[16:31]
    v_mfma_f32_32x32x16_bf16 a[0:15], v[68:71], v[72:75], a[0:15]
    v_mfma_f32_32x32x16_bf16 a[16:31], v[68:71], v[76:79], a[16:31]
    s_branch mega_kernel_qfad_swr12
mega_kernel_qfad_sw13:
    v_mfma_f32_32x32x16_bf16 a[0:15], v[80:83], v[84:87], a[0:15]
    v_mfma_f32_32x32x16_bf16 a[16:31], v[80:83], v[88:91], a[16:31]
    v_mfma_f32_32x32x16_bf16 a[0:15], v[92:95], v[96:99], a[0:15]
    v_mfma_f32_32x32x16_bf16 a[16:31], v[92:95], v[100:103], a[16:31]
    v_mfma_f32_32x32x16_bf16 a[0:15], v[104:107], v[108:111], a[0:15]
    v_mfma_f32_32x32x16_bf16 a[16:31], v[104:107], v[112:115], a[16:31]
    v_mfma_f32_32x32x16_bf16 a[0:15], v[116:119], v[120:123], a[0:15]
    v_mfma_f32_32x32x16_bf16 a[16:31], v[116:119], v[124:127], a[16:31]
    s_branch mega_kernel_qfad_swr13
mega_kernel_qfad_sw14:
    v_mfma_f32_32x32x16_bf16 a[0:15], v[32:35], v[36:39], a[0:15]
    v_mfma_f32_32x32x16_bf16 a[16:31], v[32:35], v[40:43], a[16:31]
    v_mfma_f32_32x32x16_bf16 a[0:15], v[44:47], v[48:51], a[0:15]
    v_mfma_f32_32x32x16_bf16 a[16:31], v[44:47], v[52:55], a[16:31]
    v_mfma_f32_32x32x16_bf16 a[0:15], v[56:59], v[60:63], a[0:15]
    v_mfma_f32_32x32x16_bf16 a[16:31], v[56:59], v[64:67], a[16:31]
    v_mfma_f32_32x32x16_bf16 a[0:15], v[68:71], v[72:75], a[0:15]
    v_mfma_f32_32x32x16_bf16 a[16:31], v[68:71], v[76:79], a[16:31]
    s_branch mega_kernel_qfad_swr14
mega_kernel_qfad_sw15:
    v_mfma_f32_32x32x16_bf16 a[0:15], v[80:83], v[84:87], a[0:15]
    v_mfma_f32_32x32x16_bf16 a[16:31], v[80:83], v[88:91], a[16:31]
    v_mfma_f32_32x32x16_bf16 a[0:15], v[92:95], v[96:99], a[0:15]
    v_mfma_f32_32x32x16_bf16 a[16:31], v[92:95], v[100:103], a[16:31]
    v_mfma_f32_32x32x16_bf16 a[0:15], v[104:107], v[108:111], a[0:15]
    v_mfma_f32_32x32x16_bf16 a[16:31], v[104:107], v[112:115], a[16:31]
    v_mfma_f32_32x32x16_bf16 a[0:15], v[116:119], v[120:123], a[0:15]
    v_mfma_f32_32x32x16_bf16 a[16:31], v[116:119], v[124:127], a[16:31]
    s_branch mega_kernel_qfad_swr15
mega_kernel_qfad_done:
mega_kernel_qfa_epi:
    s_lshr_b32 s47, s46, 1
    s_and_b32 s48, s46, 1
    s_mul_i32 s47, s47, 262144
    s_mul_i32 s48, s48, 4096
    s_add_u32 s47, s47, s48
    s_add_u32 s47, s47, s54
    v_lshlrev_b32 v96, 4, v1
    s_add_u32 s50, s47, 0
    s_nop 1
    v_accvgpr_read_b32 v98, a0
    v_accvgpr_read_b32 v99, a1
    v_accvgpr_read_b32 v100, a2
    v_accvgpr_read_b32 v101, a3
    v_accvgpr_read_b32 v102, a4
    v_accvgpr_read_b32 v103, a5
    v_accvgpr_read_b32 v104, a6
    v_accvgpr_read_b32 v105, a7
    v_accvgpr_read_b32 v106, a8
    v_accvgpr_read_b32 v107, a9
    v_accvgpr_read_b32 v108, a10
    v_accvgpr_read_b32 v109, a11
    v_accvgpr_read_b32 v110, a12
    v_accvgpr_read_b32 v111, a13
    v_accvgpr_read_b32 v112, a14
    v_accvgpr_read_b32 v113, a15
    v_cvt_pk_bf16_f32 v114, v98, v99
    v_cvt_pk_bf16_f32 v115, v100, v101
    v_cvt_pk_bf16_f32 v116, v102, v103
    v_cvt_pk_bf16_f32 v117, v104, v105
    v_cvt_pk_bf16_f32 v118, v106, v107
    v_cvt_pk_bf16_f32 v119, v108, v109
    v_cvt_pk_bf16_f32 v120, v110, v111
    v_cvt_pk_bf16_f32 v121, v112, v113
    buffer_store_dwordx4 v[114:117], v96, s[32:35], s50 offen offset:0 sc1
    buffer_store_dwordx4 v[118:121], v96, s[32:35], s50 offen offset:1024 sc1
    s_add_u32 s50, s47, 2048
    v_accvgpr_read_b32 v122, a16
    v_accvgpr_read_b32 v123, a17
    v_accvgpr_read_b32 v124, a18
    v_accvgpr_read_b32 v125, a19
    v_accvgpr_read_b32 v126, a20
    v_accvgpr_read_b32 v127, a21
    v_accvgpr_read_b32 v128, a22
    v_accvgpr_read_b32 v129, a23
    v_accvgpr_read_b32 v130, a24
    v_accvgpr_read_b32 v131, a25
    v_accvgpr_read_b32 v132, a26
    v_accvgpr_read_b32 v133, a27
    v_accvgpr_read_b32 v134, a28
    v_accvgpr_read_b32 v135, a29
    v_accvgpr_read_b32 v136, a30
    v_accvgpr_read_b32 v137, a31
    v_cvt_pk_bf16_f32 v138, v122, v123
    v_cvt_pk_bf16_f32 v139, v124, v125
    v_cvt_pk_bf16_f32 v140, v126, v127
    v_cvt_pk_bf16_f32 v141, v128, v129
    v_cvt_pk_bf16_f32 v142, v130, v131
    v_cvt_pk_bf16_f32 v143, v132, v133
    v_cvt_pk_bf16_f32 v144, v134, v135
    v_cvt_pk_bf16_f32 v145, v136, v137
    buffer_store_dwordx4 v[138:141], v96, s[32:35], s50 offen offset:0 sc1
    buffer_store_dwordx4 v[142:145], v96, s[32:35], s50 offen offset:1024 sc1
    s_waitcnt vmcnt(0)
    s_barrier
    s_cmp_lg_u32 s46, 0
    s_cbranch_scc1 mega_kernel_qfa_nf
    s_lshl_b32 s18, s85, 10
    s_lshr_b32 s19, s17, 1
    s_lshl_b32 s19, s19, 6
    s_add_u32 s18, s18, s19
    s_lshl_b32 s19, s16, 2
    s_add_u32 s18, s18, s19
    v_mov_b32 v26, 1
    v_mov_b32 v27, 0
    s_mov_b64 exec, 1
    buffer_atomic_add v26, v27, s[56:59], s18 offen sc1
    s_mov_b64 exec, -1
mega_kernel_qfa_nf:
    s_branch mega_kernel_fdone
mega_kernel_fb:
    s_sub_u32 s87, s64, 128
    s_add_u32 s80, s4, 167772160
    s_addc_u32 s81, s5, 0
    s_mov_b32 s82, 1572864
    s_mov_b32 s83, 0x20000
    s_lshl_b32 s84, s87, 12
    v_add_u32 v104, s84, v103
    v_mov_b32 v108, -1
    v_mov_b32 v109, -1
    v_mov_b32 v110, -1
    v_mov_b32 v111, -1
    v_mov_b32 v170, 0
    v_mov_b32 v171, 0
    v_mov_b32 v172, 0
    v_mov_b32 v173, 0
    s_lshl_b32 s84, s87, 13
    s_add_u32 s85, s84, 1048576
    v_add_u32 v174, 4096, v103
    buffer_store_dwordx4 v[108:111], v103, s[80:83], s85 offen sc1
    buffer_store_dwordx4 v[108:111], v174, s[80:83], s85 offen sc1
    s_add_u32 s85, s84, 16384
    buffer_store_dwordx4 v[170:173], v103, s[56:59], s85 offen sc1
    buffer_store_dwordx4 v[170:173], v174, s[56:59], s85 offen sc1
    v_and_b32 v105, 2047, v104
    v_mov_b32 v106, 1280
    v_cmp_eq_u32 vcc, v105, v106
    s_cmp_ge_u32 s87, 16
    s_cselect_b64 s[88:89], -1, 0
    s_and_b64 vcc, vcc, s[88:89]
    s_cmp_lt_u32 s87, 48
    s_cselect_b64 s[88:89], -1, 0
    s_and_b64 vcc, vcc, s[88:89]
    v_mov_b32 v106, 0xff800000
    v_cndmask_b32 v112, v108, v106, vcc
    v_cndmask_b32 v113, v109, v106, vcc
    v_cndmask_b32 v114, v110, v106, vcc
    v_cndmask_b32 v115, v111, v106, vcc
    s_mov_b32 s84, 262144
    buffer_store_dwordx4 v[112:115], v104, s[80:83], s84 offen sc1
    s_mov_b32 s84, 524288
    buffer_store_dwordx4 v[112:115], v104, s[80:83], s84 offen sc1
    s_mov_b32 s84, 786432
    buffer_store_dwordx4 v[112:115], v104, s[80:83], s84 offen sc1
    s_cmp_ge_u32 s87, 16
    s_cbranch_scc1 mega_kernel_ib0
    s_mov_b32 s72, s68
    s_mov_b32 s73, s69
    s_mov_b32 s74, 16384
    s_mov_b32 s75, 0x20000
    v_and_b32 v105, 16383, v104
    v_lshrrev_b32 v105, 4, v105
    v_and_b32 v106, 7, v105
    v_lshlrev_b32 v106, 11, v106
    v_lshrrev_b32 v105, 3, v105
    v_lshl_add_u32 v105, v105, 4, v106
    buffer_load_dwordx4 v[116:119], v105, s[72:75], 0 offen
    s_waitcnt vmcnt(0)
    v_mov_b32 v120, v116
    v_mov_b32 v121, v117
    v_mov_b32 v122, v118
    v_mov_b32 v123, v119
    buffer_store_dwordx4 v[120:123], v104, s[80:83], 0 offen sc1
    s_branch mega_kernel_ib1
mega_kernel_ib0:
    buffer_store_dwordx4 v[112:115], v104, s[80:83], 0 offen sc1
mega_kernel_ib1:
    s_waitcnt vmcnt(0)
    s_barrier
    s_cmp_lg_u32 s46, 0
    s_cbranch_scc1 mega_kernel_ib2
    s_mov_b64 exec, 1
    v_mov_b32 v170, 76
    v_mov_b32 v171, 1
    global_atomic_add v170, v171, s[70:71] sc1
    s_mov_b64 exec, -1
mega_kernel_ib2:
    s_mov_b32 s85, 1
    s_lshr_b32 s47, s46, 1
    s_and_b32 s48, s46, 1
    v_and_b32 v26, 31, v1
    s_mul_i32 s49, s47, 64
    v_add_u32 v26, s49, v26
    v_lshrrev_b32 v27, 1, v26
    v_and_b32 v27, 7, v27
    v_lshrrev_b32 v28, 5, v1
    v_lshlrev_b32 v29, 7, v26
    v_add_u32 v30, 0, v28
    v_xor_b32 v30, v30, v27
    v_lshl_add_u32 v2, v30, 4, v29
    v_add_u32 v30, 2, v28
    v_xor_b32 v30, v30, v27
    v_lshl_add_u32 v3, v30, 4, v29
    v_add_u32 v30, 4, v28
    v_xor_b32 v30, v30, v27
    v_lshl_add_u32 v4, v30, 4, v29
    v_add_u32 v30, 6, v28
    v_xor_b32 v30, v30, v27
    v_lshl_add_u32 v5, v30, 4, v29
    v_lshrrev_b32 v26, 2, v1
    v_and_b32 v26, 3, v26
    v_lshrrev_b32 v27, 5, v1
    v_lshl_add_u32 v27, v27, 3, v26
    v_mul_u32_u24 v27, 256, v27
    v_lshrrev_b32 v28, 4, v1
    v_and_b32 v28, 1, v28
    v_lshlrev_b32 v28, 5, v28
    v_and_b32 v29, 3, v1
    v_lshl_add_u32 v28, v29, 3, v28
    v_add_u32 v27, v27, v28
    s_mul_i32 s49, s48, 2
    s_add_u32 s49, s49, 0
    v_xor_b32 v29, s49, v26
    v_lshlrev_b32 v29, 6, v29
    v_add_u32 v29, v29, v27
    v_add_u32 v6, 16384, v29
    s_mul_i32 s49, s48, 2
    s_add_u32 s49, s49, 1
    v_xor_b32 v29, s49, v26
    v_lshlrev_b32 v29, 6, v29
    v_add_u32 v29, v29, v27
    v_add_u32 v7, 16384, v29
    v_lshrrev_b32 v26, 3, v1
    s_mul_i32 s49, s46, 32
    v_add_u32 v26, s49, v26
    v_and_b32 v27, 7, v1
    s_mov_b32 s50, 2048
    v_add_u32 v28, 0, v26
    v_lshrrev_b32 v29, 1, v28
    v_and_b32 v29, 7, v29
    v_xor_b32 v29, v29, v27
    v_lshlrev_b32 v29, 4, v29
    v_mul_lo_u32 v28, v28, s50
    v_add_u32 v10, v28, v29
    v_add_u32 v28, 8, v26
    v_lshrrev_b32 v29, 1, v28
    v_and_b32 v29, 7, v29
    v_xor_b32 v29, v29, v27
    v_lshlrev_b32 v29, 4, v29
    v_mul_lo_u32 v28, v28, s50
    v_add_u32 v11, v28, v29
    v_add_u32 v28, 16, v26
    v_lshrrev_b32 v29, 1, v28
    v_and_b32 v29, 7, v29
    v_xor_b32 v29, v29, v27
    v_lshlrev_b32 v29, 4, v29
    v_mul_lo_u32 v28, v28, s50
    v_add_u32 v12, v28, v29
    v_add_u32 v28, 24, v26
    v_lshrrev_b32 v29, 1, v28
    v_and_b32 v29, 7, v29
    v_xor_b32 v29, v29, v27
    v_lshlrev_b32 v29, 4, v29
    v_mul_lo_u32 v28, v28, s50
    v_add_u32 v13, v28, v29
    v_lshrrev_b32 v26, 4, v1
    s_mul_i32 s49, s46, 16
    v_add_u32 v26, s49, v26
    v_and_b32 v27, 15, v1
    s_mov_b32 s50, 8192
    v_add_u32 v28, 0, v26
    v_and_b32 v29, 3, v28
    v_lshlrev_b32 v29, 2, v29
    v_xor_b32 v29, v29, v27
    v_lshlrev_b32 v29, 4, v29
    v_mul_lo_u32 v28, v28, s50
    v_add_u32 v18, v28, v29
    v_add_u32 v28, 4, v26
    v_and_b32 v29, 3, v28
    v_lshlrev_b32 v29, 2, v29
    v_xor_b32 v29, v29, v27
    v_lshlrev_b32 v29, 4, v29
    v_mul_lo_u32 v28, v28, s50
    v_add_u32 v19, v28, v29
    v_add_u32 v28, 8, v26
    v_and_b32 v29, 3, v28
    v_lshlrev_b32 v29, 2, v29
    v_xor_b32 v29, v29, v27
    v_lshlrev_b32 v29, 4, v29
    v_mul_lo_u32 v28, v28, s50
    v_add_u32 v20, v28, v29
    v_add_u32 v28, 12, v26
    v_and_b32 v29, 3, v28
    v_lshlrev_b32 v29, 2, v29
    v_xor_b32 v29, v29, v27
    v_lshlrev_b32 v29, 4, v29
    v_mul_lo_u32 v28, v28, s50
    v_add_u32 v21, v28, v29
    s_lshr_b32 s16, s87, 5
    s_and_b32 s17, s87, 31
    s_cmp_eq_u32 s16, 1
    s_cselect_b32 s12, s8, s6
    s_cselect_b32 s13, s9, s7
    s_mov_b32 s24, s12
    s_mov_b32 s25, s13
    s_mov_b32 s26, 8388608
    s_mov_b32 s27, 0x20000
    s_lshl_b32 s18, s85, 1
    s_mul_i32 s40, s18, 131072
    s_lshl_b32 s41, s17, 8
    s_mul_i32 s54, s16, 16777216
    s_mul_i32 s19, s18, 524288
    s_add_u32 s54, s54, s19
    s_lshl_b32 s19, s17, 13
    s_add_u32 s54, s54, s19
    s_lshl_b32 s19, s18, 4
    v_and_b32 v26, 31, v1
    v_add_u32 v26, s19, v26
    v_lshlrev_b32 v26, 4, v26
    v_add_u32 v26, 540672, v26
    s_mov_b32 s12, 131072
mega_kernel_qfb_lw:
    buffer_load_dword v27, v26, s[56:59], 0 offen sc1
    s_waitcnt vmcnt(0)
    v_cmp_eq_u32 vcc, 0, v27
    s_cbranch_vccz mega_kernel_qfb_lw_ok
    s_cmp_eq_u32 s12, 0
    s_cbranch_scc1 mega_kernel_qfb_lw_ok
    s_sub_u32 s12, s12, 1
    s_sleep 1
    s_branch mega_kernel_qfb_lw
mega_kernel_qfb_lw_ok:
    s_mul_i32 s42, s46, 4096
    s_mul_i32 s43, s46, 4096
    s_add_u32 s43, s43, 16384
    s_add_u32 m0, s42, 0
    s_nop 0
    buffer_load_dwordx4 v10, s[20:23], s40 offen lds
    s_add_u32 m0, s42, 1024
    s_nop 0
    buffer_load_dwordx4 v11, s[20:23], s40 offen lds
    s_add_u32 m0, s42, 2048
    s_nop 0
    buffer_load_dwordx4 v12, s[20:23], s40 offen lds
    s_add_u32 m0, s42, 3072
    s_nop 0
    buffer_load_dwordx4 v13, s[20:23], s40 offen lds
    s_add_u32 m0, s43, 0
    s_nop 0
    buffer_load_dwordx4 v18, s[24:27], s41 offen lds
    s_add_u32 m0, s43, 1024
    s_nop 0
    buffer_load_dwordx4 v19, s[24:27], s41 offen lds
    s_add_u32 m0, s43, 2048
    s_nop 0
    buffer_load_dwordx4 v20, s[24:27], s41 offen lds
    s_add_u32 m0, s43, 3072
    s_nop 0
    buffer_load_dwordx4 v21, s[24:27], s41 offen lds
    s_add_u32 s40, s40, 128
    s_add_u32 s41, s41, 524288
    s_add_u32 s42, s42, 32768
    s_add_u32 s43, s43, 32768
    s_add_u32 m0, s42, 0
    s_nop 0
    buffer_load_dwordx4 v10, s[20:23], s40 offen lds
    s_add_u32 m0, s42, 1024
    s_nop 0
    buffer_load_dwordx4 v11, s[20:23], s40 offen lds
    s_add_u32 m0, s42, 2048
    s_nop 0
    buffer_load_dwordx4 v12, s[20:23], s40 offen lds
    s_add_u32 m0, s42, 3072
    s_nop 0
    buffer_load_dwordx4 v13, s[20:23], s40 offen lds
    s_add_u32 m0, s43, 0
    s_nop 0
    buffer_load_dwordx4 v18, s[24:27], s41 offen lds
    s_add_u32 m0, s43, 1024
    s_nop 0
    buffer_load_dwordx4 v19, s[24:27], s41 offen lds
    s_add_u32 m0, s43, 2048
    s_nop 0
    buffer_load_dwordx4 v20, s[24:27], s41 offen lds
    s_add_u32 m0, s43, 3072
    s_nop 0
    buffer_load_dwordx4 v21, s[24:27], s41 offen lds
    s_add_u32 s40, s40, 128
    s_add_u32 s41, s41, 524288
    s_add_u32 s42, s42, 32768
    s_add_u32 s43, s43, 32768
    s_add_u32 m0, s42, 0
    s_nop 0
    buffer_load_dwordx4 v10, s[20:23], s40 offen lds
    s_add_u32 m0, s42, 1024
    s_nop 0
    buffer_load_dwordx4 v11, s[20:23], s40 offen lds
    s_add_u32 m0, s42, 2048
    s_nop 0
    buffer_load_dwordx4 v12, s[20:23], s40 offen lds
    s_add_u32 m0, s42, 3072
    s_nop 0
    buffer_load_dwordx4 v13, s[20:23], s40 offen lds
    s_add_u32 m0, s43, 0
    s_nop 0
    buffer_load_dwordx4 v18, s[24:27], s41 offen lds
    s_add_u32 m0, s43, 1024
    s_nop 0
    buffer_load_dwordx4 v19, s[24:27], s41 offen lds
    s_add_u32 m0, s43, 2048
    s_nop 0
    buffer_load_dwordx4 v20, s[24:27], s41 offen lds
    s_add_u32 m0, s43, 3072
    s_nop 0
    buffer_load_dwordx4 v21, s[24:27], s41 offen lds
    s_add_u32 s40, s40, 128
    s_add_u32 s41, s41, 524288
    s_add_u32 s42, s42, 32768
    s_add_u32 s43, s43, 32768
    s_add_u32 m0, s42, 0
    s_nop 0
    buffer_load_dwordx4 v10, s[20:23], s40 offen lds
    s_add_u32 m0, s42, 1024
    s_nop 0
    buffer_load_dwordx4 v11, s[20:23], s40 offen lds
    s_add_u32 m0, s42, 2048
    s_nop 0
    buffer_load_dwordx4 v12, s[20:23], s40 offen lds
    s_add_u32 m0, s42, 3072
    s_nop 0
    buffer_load_dwordx4 v13, s[20:23], s40 offen lds
    s_add_u32 m0, s43, 0
    s_nop 0
    buffer_load_dwordx4 v18, s[24:27], s41 offen lds
    s_add_u32 m0, s43, 1024
    s_nop 0
    buffer_load_dwordx4 v19, s[24:27], s41 offen lds
    s_add_u32 m0, s43, 2048
    s_nop 0
    buffer_load_dwordx4 v20, s[24:27], s41 offen lds
    s_add_u32 m0, s43, 3072
    s_nop 0
    buffer_load_dwordx4 v21, s[24:27], s41 offen lds
    s_add_u32 s40, s40, 128
    s_add_u32 s41, s41, 524288
    s_add_u32 s42, s42, 32768
    s_add_u32 s43, s43, 32768
    s_add_u32 m0, s42, 0
    s_nop 0
    buffer_load_dwordx4 v10, s[20:23], s40 offen lds
    s_add_u32 m0, s42, 1024
    s_nop 0
    buffer_load_dwordx4 v11, s[20:23], s40 offen lds
    s_add_u32 m0, s42, 2048
    s_nop 0
    buffer_load_dwordx4 v12, s[20:23], s40 offen lds
    s_add_u32 m0, s42, 3072
    s_nop 0
    buffer_load_dwordx4 v13, s[20:23], s40 offen lds
    s_add_u32 m0, s43, 0
    s_nop 0
    buffer_load_dwordx4 v18, s[24:27], s41 offen lds
    s_add_u32 m0, s43, 1024
    s_nop 0
    buffer_load_dwordx4 v19, s[24:27], s41 offen lds
    s_add_u32 m0, s43, 2048
    s_nop 0
    buffer_load_dwordx4 v20, s[24:27], s41 offen lds
    s_add_u32 m0, s43, 3072
    s_nop 0
    buffer_load_dwordx4 v21, s[24:27], s41 offen lds
    s_add_u32 s40, s40, 128
    s_add_u32 s41, s41, 524288
    s_sub_u32 s42, s42, 131072
    s_sub_u32 s43, s43, 131072
    s_waitcnt vmcnt(32)
    s_barrier
    ds_read_b64_tr_b16 v[40:41], v6 offset:0
    ds_read_b64_tr_b16 v[42:43], v6 offset:1024
    ds_read_b64_tr_b16 v[44:45], v7 offset:0
    ds_read_b64_tr_b16 v[46:47], v7 offset:1024
    ds_read_b128 v[32:35], v2 offset:0
    ds_read_b128 v[36:39], v2 offset:4096
    ds_read_b64_tr_b16 v[56:57], v6 offset:4096
    ds_read_b64_tr_b16 v[58:59], v6 offset:5120
    ds_read_b64_tr_b16 v[60:61], v7 offset:4096
    ds_read_b64_tr_b16 v[62:63], v7 offset:5120
    ds_read_b128 v[48:51], v3 offset:0
    ds_read_b128 v[52:55], v3 offset:4096
    ds_read_b64_tr_b16 v[72:73], v6 offset:8192
    ds_read_b64_tr_b16 v[74:75], v6 offset:9216
    ds_read_b64_tr_b16 v[76:77], v7 offset:8192
    ds_read_b64_tr_b16 v[78:79], v7 offset:9216
    ds_read_b128 v[64:67], v4 offset:0
    ds_read_b128 v[68:71], v4 offset:4096
    ds_read_b64_tr_b16 v[88:89], v6 offset:12288
    ds_read_b64_tr_b16 v[90:91], v6 offset:13312
    ds_read_b64_tr_b16 v[92:93], v7 offset:12288
    ds_read_b64_tr_b16 v[94:95], v7 offset:13312
    ds_read_b128 v[80:83], v5 offset:0
    ds_read_b128 v[84:87], v5 offset:4096
    s_waitcnt lgkmcnt(0)
    s_mov_b32 s52, 32768
    v_add_u32 v2, s52, v2
    v_add_u32 v3, s52, v3
    v_add_u32 v4, s52, v4
    v_add_u32 v5, s52, v5
    v_add_u32 v6, s52, v6
    v_add_u32 v7, s52, v7
    s_waitcnt vmcnt(24)
    s_barrier
    ds_read_b64_tr_b16 v[104:105], v6 offset:0
    ds_read_b64_tr_b16 v[106:107], v6 offset:1024
    ds_read_b64_tr_b16 v[108:109], v7 offset:0
    ds_read_b64_tr_b16 v[110:111], v7 offset:1024
    ds_read_b128 v[96:99], v2 offset:0
    ds_read_b128 v[100:103], v2 offset:4096
    ds_read_b64_tr_b16 v[120:121], v6 offset:4096
    ds_read_b64_tr_b16 v[122:123], v6 offset:5120
    ds_read_b64_tr_b16 v[124:125], v7 offset:4096
    ds_read_b64_tr_b16 v[126:127], v7 offset:5120
    ds_read_b128 v[112:115], v3 offset:0
    ds_read_b128 v[116:119], v3 offset:4096
    ds_read_b64_tr_b16 v[136:137], v6 offset:8192
    ds_read_b64_tr_b16 v[138:139], v6 offset:9216
    ds_read_b64_tr_b16 v[140:141], v7 offset:8192
    ds_read_b64_tr_b16 v[142:143], v7 offset:9216
    ds_read_b128 v[128:131], v4 offset:0
    ds_read_b128 v[132:135], v4 offset:4096
    ds_read_b64_tr_b16 v[152:153], v6 offset:12288
    ds_read_b64_tr_b16 v[154:155], v6 offset:13312
    ds_read_b64_tr_b16 v[156:157], v7 offset:12288
    ds_read_b64_tr_b16 v[158:159], v7 offset:13312
    ds_read_b128 v[144:147], v5 offset:0
    ds_read_b128 v[148:151], v5 offset:4096
    s_add_u32 m0, s42, 0
    s_nop 0
    buffer_load_dwordx4 v10, s[20:23], s40 offen lds
    s_add_u32 m0, s42, 1024
    s_nop 0
    buffer_load_dwordx4 v11, s[20:23], s40 offen lds
    s_add_u32 m0, s42, 2048
    s_nop 0
    buffer_load_dwordx4 v12, s[20:23], s40 offen lds
    s_add_u32 m0, s42, 3072
    s_nop 0
    buffer_load_dwordx4 v13, s[20:23], s40 offen lds
    s_add_u32 m0, s43, 0
    s_nop 0
    buffer_load_dwordx4 v18, s[24:27], s41 offen lds
    s_add_u32 m0, s43, 1024
    s_nop 0
    buffer_load_dwordx4 v19, s[24:27], s41 offen lds
    s_add_u32 m0, s43, 2048
    s_nop 0
    buffer_load_dwordx4 v20, s[24:27], s41 offen lds
    s_add_u32 m0, s43, 3072
    s_nop 0
    buffer_load_dwordx4 v21, s[24:27], s41 offen lds
    s_add_u32 s40, s40, 128
    s_add_u32 s41, s41, 524288
    s_add_u32 s42, s42, 32768
    s_add_u32 s43, s43, 32768
    s_cmp_eq_u32 s16, 1
    s_cbranch_scc1 mega_kernel_qfbd_sw0
    v_mfma_f32_32x32x16_bf16 a[0:15], v[40:43], v[32:35], 0
    v_mfma_f32_32x32x16_bf16 a[16:31], v[40:43], v[36:39], 0
    v_mfma_f32_32x32x16_bf16 a[32:47], v[44:47], v[32:35], 0
    v_mfma_f32_32x32x16_bf16 a[48:63], v[44:47], v[36:39], 0
    v_mfma_f32_32x32x16_bf16 a[0:15], v[56:59], v[48:51], a[0:15]
    v_mfma_f32_32x32x16_bf16 a[16:31], v[56:59], v[52:55], a[16:31]
    v_mfma_f32_32x32x16_bf16 a[32:47], v[60:63], v[48:51], a[32:47]
    v_mfma_f32_32x32x16_bf16 a[48:63], v[60:63], v[52:55], a[48:63]
    v_mfma_f32_32x32x16_bf16 a[0:15], v[72:75], v[64:67], a[0:15]
    v_mfma_f32_32x32x16_bf16 a[16:31], v[72:75], v[68:71], a[16:31]
    v_mfma_f32_32x32x16_bf16 a[32:47], v[76:79], v[64:67], a[32:47]
    v_mfma_f32_32x32x16_bf16 a[48:63], v[76:79], v[68:71], a[48:63]
    v_mfma_f32_32x32x16_bf16 a[0:15], v[88:91], v[80:83], a[0:15]
    v_mfma_f32_32x32x16_bf16 a[16:31], v[88:91], v[84:87], a[16:31]
    v_mfma_f32_32x32x16_bf16 a[32:47], v[92:95], v[80:83], a[32:47]
    v_mfma_f32_32x32x16_bf16 a[48:63], v[92:95], v[84:87], a[48:63]
mega_kernel_qfbd_swr0:
    s_waitcnt lgkmcnt(0)
    s_mov_b32 s52, 32768
    v_add_u32 v2, s52, v2
    v_add_u32 v3, s52, v3
    v_add_u32 v4, s52, v4
    v_add_u32 v5, s52, v5
    v_add_u32 v6, s52, v6
    v_add_u32 v7, s52, v7
    s_waitcnt vmcnt(24)
    s_barrier
    ds_read_b64_tr_b16 v[40:41], v6 offset:0
    ds_read_b64_tr_b16 v[42:43], v6 offset:1024
    ds_read_b64_tr_b16 v[44:45], v7 offset:0
    ds_read_b64_tr_b16 v[46:47], v7 offset:1024
    ds_read_b128 v[32:35], v2 offset:0
    ds_read_b128 v[36:39], v2 offset:4096
    ds_read_b64_tr_b16 v[56:57], v6 offset:4096
    ds_read_b64_tr_b16 v[58:59], v6 offset:5120
    ds_read_b64_tr_b16 v[60:61], v7 offset:4096
    ds_read_b64_tr_b16 v[62:63], v7 offset:5120
    ds_read_b128 v[48:51], v3 offset:0
    ds_read_b128 v[52:55], v3 offset:4096
    ds_read_b64_tr_b16 v[72:73], v6 offset:8192
    ds_read_b64_tr_b16 v[74:75], v6 offset:9216
    ds_read_b64_tr_b16 v[76:77], v7 offset:8192
    ds_read_b64_tr_b16 v[78:79], v7 offset:9216
    ds_read_b128 v[64:67], v4 offset:0
    ds_read_b128 v[68:71], v4 offset:4096
    ds_read_b64_tr_b16 v[88:89], v6 offset:12288
    ds_read_b64_tr_b16 v[90:91], v6 offset:13312
    ds_read_b64_tr_b16 v[92:93], v7 offset:12288
    ds_read_b64_tr_b16 v[94:95], v7 offset:13312
    ds_read_b128 v[80:83], v5 offset:0
    ds_read_b128 v[84:87], v5 offset:4096
    s_add_u32 m0, s42, 0
    s_nop 0
    buffer_load_dwordx4 v10, s[20:23], s40 offen lds
    s_add_u32 m0, s42, 1024
    s_nop 0
    buffer_load_dwordx4 v11, s[20:23], s40 offen lds
    s_add_u32 m0, s42, 2048
    s_nop 0
    buffer_load_dwordx4 v12, s[20:23], s40 offen lds
    s_add_u32 m0, s42, 3072
    s_nop 0
    buffer_load_dwordx4 v13, s[20:23], s40 offen lds
    s_add_u32 m0, s43, 0
    s_nop 0
    buffer_load_dwordx4 v18, s[24:27], s41 offen lds
    s_add_u32 m0, s43, 1024
    s_nop 0
    buffer_load_dwordx4 v19, s[24:27], s41 offen lds
    s_add_u32 m0, s43, 2048
    s_nop 0
    buffer_load_dwordx4 v20, s[24:27], s41 offen lds
    s_add_u32 m0, s43, 3072
    s_nop 0
    buffer_load_dwordx4 v21, s[24:27], s41 offen lds
    s_add_u32 s40, s40, 128
    s_add_u32 s41, s41, 524288
    s_add_u32 s42, s42, 32768
    s_add_u32 s43, s43, 32768
    s_cmp_eq_u32 s16, 1
    s_cbranch_scc1 mega_kernel_qfbd_sw1
    v_mfma_f32_32x32x16_bf16 a[0:15], v[104:107], v[96:99], a[0:15]
    v_mfma_f32_32x32x16_bf16 a[16:31], v[104:107], v[100:103], a[16:31]
    v_mfma_f32_32x32x16_bf16 a[32:47], v[108:111], v[96:99], a[32:47]
    v_mfma_f32_32x32x16_bf16 a[48:63], v[108:111], v[100:103], a[48:63]
    v_mfma_f32_32x32x16_bf16 a[0:15], v[120:123], v[112:115], a[0:15]
    v_mfma_f32_32x32x16_bf16 a[16:31], v[120:123], v[116:119], a[16:31]
    v_mfma_f32_32x32x16_bf16 a[32:47], v[124:127], v[112:115], a[32:47]
    v_mfma_f32_32x32x16_bf16 a[48:63], v[124:127], v[116:119], a[48:63]
    v_mfma_f32_32x32x16_bf16 a[0:15], v[136:139], v[128:131], a[0:15]
    v_mfma_f32_32x32x16_bf16 a[16:31], v[136:139], v[132:135], a[16:31]
    v_mfma_f32_32x32x16_bf16 a[32:47], v[140:143], v[128:131], a[32:47]
    v_mfma_f32_32x32x16_bf16 a[48:63], v[140:143], v[132:135], a[48:63]
    v_mfma_f32_32x32x16_bf16 a[0:15], v[152:155], v[144:147], a[0:15]
    v_mfma_f32_32x32x16_bf16 a[16:31], v[152:155], v[148:151], a[16:31]
    v_mfma_f32_32x32x16_bf16 a[32:47], v[156:159], v[144:147], a[32:47]
    v_mfma_f32_32x32x16_bf16 a[48:63], v[156:159], v[148:151], a[48:63]
mega_kernel_qfbd_swr1:
    s_waitcnt lgkmcnt(0)
    s_mov_b32 s52, 32768
    v_add_u32 v2, s52, v2
    v_add_u32 v3, s52, v3
    v_add_u32 v4, s52, v4
    v_add_u32 v5, s52, v5
    v_add_u32 v6, s52, v6
    v_add_u32 v7, s52, v7
    s_waitcnt vmcnt(24)
    s_barrier
    ds_read_b64_tr_b16 v[104:105], v6 offset:0
    ds_read_b64_tr_b16 v[106:107], v6 offset:1024
    ds_read_b64_tr_b16 v[108:109], v7 offset:0
    ds_read_b64_tr_b16 v[110:111], v7 offset:1024
    ds_read_b128 v[96:99], v2 offset:0
    ds_read_b128 v[100:103], v2 offset:4096
    ds_read_b64_tr_b16 v[120:121], v6 offset:4096
    ds_read_b64_tr_b16 v[122:123], v6 offset:5120
    ds_read_b64_tr_b16 v[124:125], v7 offset:4096
    ds_read_b64_tr_b16 v[126:127], v7 offset:5120
    ds_read_b128 v[112:115], v3 offset:0
    ds_read_b128 v[116:119], v3 offset:4096
    ds_read_b64_tr_b16 v[136:137], v6 offset:8192
    ds_read_b64_tr_b16 v[138:139], v6 offset:9216
    ds_read_b64_tr_b16 v[140:141], v7 offset:8192
    ds_read_b64_tr_b16 v[142:143], v7 offset:9216
    ds_read_b128 v[128:131], v4 offset:0
    ds_read_b128 v[132:135], v4 offset:4096
    ds_read_b64_tr_b16 v[152:153], v6 offset:12288
    ds_read_b64_tr_b16 v[154:155], v6 offset:13312
    ds_read_b64_tr_b16 v[156:157], v7 offset:12288
    ds_read_b64_tr_b16 v[158:159], v7 offset:13312
    ds_read_b128 v[144:147], v5 offset:0
    ds_read_b128 v[148:151], v5 offset:4096
    s_add_u32 m0, s42, 0
    s_nop 0
    buffer_load_dwordx4 v10, s[20:23], s40 offen lds
    s_add_u32 m0, s42, 1024
    s_nop 0
    buffer_load_dwordx4 v11, s[20:23], s40 offen lds
    s_add_u32 m0, s42, 2048
    s_nop 0
    buffer_load_dwordx4 v12, s[20:23], s40 offen lds
    s_add_u32 m0, s42, 3072
    s_nop 0
    buffer_load_dwordx4 v13, s[20:23], s40 offen lds
    s_add_u32 m0, s43, 0
    s_nop 0
    buffer_load_dwordx4 v18, s[24:27], s41 offen lds
    s_add_u32 m0, s43, 1024
    s_nop 0
    buffer_load_dwordx4 v19, s[24:27], s41 offen lds
    s_add_u32 m0, s43, 2048
    s_nop 0
    buffer_load_dwordx4 v20, s[24:27], s41 offen lds
    s_add_u32 m0, s43, 3072
    s_nop 0
    buffer_load_dwordx4 v21, s[24:27], s41 offen lds
    s_add_u32 s40, s40, 128
    s_add_u32 s41, s41, 524288
    s_add_u32 s42, s42, 32768
    s_add_u32 s43, s43, 32768
    s_cmp_eq_u32 s16, 1
    s_cbranch_scc1 mega_kernel_qfbd_sw2
    v_mfma_f32_32x32x16_bf16 a[0:15], v[40:43], v[32:35], a[0:15]
    v_mfma_f32_32x32x16_bf16 a[16:31], v[40:43], v[36:39], a[16:31]
    v_mfma_f32_32x32x16_bf16 a[32:47], v[44:47], v[32:35], a[32:47]
    v_mfma_f32_32x32x16_bf16 a[48:63], v[44:47], v[36:39], a[48:63]
    v_mfma_f32_32x32x16_bf16 a[0:15], v[56:59], v[48:51], a[0:15]
    v_mfma_f32_32x32x16_bf16 a[16:31], v[56:59], v[52:55], a[16:31]
    v_mfma_f32_32x32x16_bf16 a[32:47], v[60:63], v[48:51], a[32:47]
    v_mfma_f32_32x32x16_bf16 a[48:63], v[60:63], v[52:55], a[48:63]
    v_mfma_f32_32x32x16_bf16 a[0:15], v[72:75], v[64:67], a[0:15]
    v_mfma_f32_32x32x16_bf16 a[16:31], v[72:75], v[68:71], a[16:31]
    v_mfma_f32_32x32x16_bf16 a[32:47], v[76:79], v[64:67], a[32:47]
    v_mfma_f32_32x32x16_bf16 a[48:63], v[76:79], v[68:71], a[48:63]
    v_mfma_f32_32x32x16_bf16 a[0:15], v[88:91], v[80:83], a[0:15]
    v_mfma_f32_32x32x16_bf16 a[16:31], v[88:91], v[84:87], a[16:31]
    v_mfma_f32_32x32x16_bf16 a[32:47], v[92:95], v[80:83], a[32:47]
    v_mfma_f32_32x32x16_bf16 a[48:63], v[92:95], v[84:87], a[48:63]
mega_kernel_qfbd_swr2:
    s_waitcnt lgkmcnt(0)
    s_mov_b32 s52, 32768
    v_add_u32 v2, s52, v2
    v_add_u32 v3, s52, v3
    v_add_u32 v4, s52, v4
    v_add_u32 v5, s52, v5
    v_add_u32 v6, s52, v6
    v_add_u32 v7, s52, v7
    s_waitcnt vmcnt(24)
    s_barrier
    ds_read_b64_tr_b16 v[40:41], v6 offset:0
    ds_read_b64_tr_b16 v[42:43], v6 offset:1024
    ds_read_b64_tr_b16 v[44:45], v7 offset:0
    ds_read_b64_tr_b16 v[46:47], v7 offset:1024
    ds_read_b128 v[32:35], v2 offset:0
    ds_read_b128 v[36:39], v2 offset:4096
    ds_read_b64_tr_b16 v[56:57], v6 offset:4096
    ds_read_b64_tr_b16 v[58:59], v6 offset:5120
    ds_read_b64_tr_b16 v[60:61], v7 offset:4096
    ds_read_b64_tr_b16 v[62:63], v7 offset:5120
    ds_read_b128 v[48:51], v3 offset:0
    ds_read_b128 v[52:55], v3 offset:4096
    ds_read_b64_tr_b16 v[72:73], v6 offset:8192
    ds_read_b64_tr_b16 v[74:75], v6 offset:9216
    ds_read_b64_tr_b16 v[76:77], v7 offset:8192
    ds_read_b64_tr_b16 v[78:79], v7 offset:9216
    ds_read_b128 v[64:67], v4 offset:0
    ds_read_b128 v[68:71], v4 offset:4096
    ds_read_b64_tr_b16 v[88:89], v6 offset:12288
    ds_read_b64_tr_b16 v[90:91], v6 offset:13312
    ds_read_b64_tr_b16 v[92:93], v7 offset:12288
    ds_read_b64_tr_b16 v[94:95], v7 offset:13312
    ds_read_b128 v[80:83], v5 offset:0
    ds_read_b128 v[84:87], v5 offset:4096
    s_add_u32 m0, s42, 0
    s_nop 0
    buffer_load_dwordx4 v10, s[20:23], s40 offen lds
    s_add_u32 m0, s42, 1024
    s_nop 0
    buffer_load_dwordx4 v11, s[20:23], s40 offen lds
    s_add_u32 m0, s42, 2048
    s_nop 0
    buffer_load_dwordx4 v12, s[20:23], s40 offen lds
    s_add_u32 m0, s42, 3072
    s_nop 0
    buffer_load_dwordx4 v13, s[20:23], s40 offen lds
    s_add_u32 m0, s43, 0
    s_nop 0
    buffer_load_dwordx4 v18, s[24:27], s41 offen lds
    s_add_u32 m0, s43, 1024
    s_nop 0
    buffer_load_dwordx4 v19, s[24:27], s41 offen lds
    s_add_u32 m0, s43, 2048
    s_nop 0
    buffer_load_dwordx4 v20, s[24:27], s41 offen lds
    s_add_u32 m0, s43, 3072
    s_nop 0
    buffer_load_dwordx4 v21, s[24:27], s41 offen lds
    s_add_u32 s40, s40, 128
    s_add_u32 s41, s41, 524288
    s_add_u32 s42, s42, 32768
    s_add_u32 s43, s43, 32768
    s_cmp_eq_u32 s16, 1
    s_cbranch_scc1 mega_kernel_qfbd_sw3
    v_mfma_f32_32x32x16_bf16 a[0:15], v[104:107], v[96:99], a[0:15]
    v_mfma_f32_32x32x16_bf16 a[16:31], v[104:107], v[100:103], a[16:31]
    v_mfma_f32_32x32x16_bf16 a[32:47], v[108:111], v[96:99], a[32:47]
    v_mfma_f32_32x32x16_bf16 a[48:63], v[108:111], v[100:103], a[48:63]
    v_mfma_f32_32x32x16_bf16 a[0:15], v[120:123], v[112:115], a[0:15]
    v_mfma_f32_32x32x16_bf16 a[16:31], v[120:123], v[116:119], a[16:31]
    v_mfma_f32_32x32x16_bf16 a[32:47], v[124:127], v[112:115], a[32:47]
    v_mfma_f32_32x32x16_bf16 a[48:63], v[124:127], v[116:119], a[48:63]
    v_mfma_f32_32x32x16_bf16 a[0:15], v[136:139], v[128:131], a[0:15]
    v_mfma_f32_32x32x16_bf16 a[16:31], v[136:139], v[132:135], a[16:31]
    v_mfma_f32_32x32x16_bf16 a[32:47], v[140:143], v[128:131], a[32:47]
    v_mfma_f32_32x32x16_bf16 a[48:63], v[140:143], v[132:135], a[48:63]
    v_mfma_f32_32x32x16_bf16 a[0:15], v[152:155], v[144:147], a[0:15]
    v_mfma_f32_32x32x16_bf16 a[16:31], v[152:155], v[148:151], a[16:31]
    v_mfma_f32_32x32x16_bf16 a[32:47], v[156:159], v[144:147], a[32:47]
    v_mfma_f32_32x32x16_bf16 a[48:63], v[156:159], v[148:151], a[48:63]
mega_kernel_qfbd_swr3:
    s_waitcnt lgkmcnt(0)
    s_mov_b32 s52, 4294836224
    v_add_u32 v2, s52, v2
    v_add_u32 v3, s52, v3
    v_add_u32 v4, s52, v4
    v_add_u32 v5, s52, v5
    v_add_u32 v6, s52, v6
    v_add_u32 v7, s52, v7
    s_waitcnt vmcnt(24)
    s_barrier
    ds_read_b64_tr_b16 v[104:105], v6 offset:0
    ds_read_b64_tr_b16 v[106:107], v6 offset:1024
    ds_read_b64_tr_b16 v[108:109], v7 offset:0
    ds_read_b64_tr_b16 v[110:111], v7 offset:1024
    ds_read_b128 v[96:99], v2 offset:0
    ds_read_b128 v[100:103], v2 offset:4096
    ds_read_b64_tr_b16 v[120:121], v6 offset:4096
    ds_read_b64_tr_b16 v[122:123], v6 offset:5120
    ds_read_b64_tr_b16 v[124:125], v7 offset:4096
    ds_read_b64_tr_b16 v[126:127], v7 offset:5120
    ds_read_b128 v[112:115], v3 offset:0
    ds_read_b128 v[116:119], v3 offset:4096
    ds_read_b64_tr_b16 v[136:137], v6 offset:8192
    ds_read_b64_tr_b16 v[138:139], v6 offset:9216
    ds_read_b64_tr_b16 v[140:141], v7 offset:8192
    ds_read_b64_tr_b16 v[142:143], v7 offset:9216
    ds_read_b128 v[128:131], v4 offset:0
    ds_read_b128 v[132:135], v4 offset:4096
    ds_read_b64_tr_b16 v[152:153], v6 offset:12288
    ds_read_b64_tr_b16 v[154:155], v6 offset:13312
    ds_read_b64_tr_b16 v[156:157], v7 offset:12288
    ds_read_b64_tr_b16 v[158:159], v7 offset:13312
    ds_read_b128 v[144:147], v5 offset:0
    ds_read_b128 v[148:151], v5 offset:4096
    s_add_u32 m0, s42, 0
    s_nop 0
    buffer_load_dwordx4 v10, s[20:23], s40 offen lds
    s_add_u32 m0, s42, 1024
    s_nop 0
    buffer_load_dwordx4 v11, s[20:23], s40 offen lds
    s_add_u32 m0, s42, 2048
    s_nop 0
    buffer_load_dwordx4 v12, s[20:23], s40 offen lds
    s_add_u32 m0, s42, 3072
    s_nop 0
    buffer_load_dwordx4 v13, s[20:23], s40 offen lds
    s_add_u32 m0, s43, 0
    s_nop 0
    buffer_load_dwordx4 v18, s[24:27], s41 offen lds
    s_add_u32 m0, s43, 1024
    s_nop 0
    buffer_load_dwordx4 v19, s[24:27], s41 offen lds
    s_add_u32 m0, s43, 2048
    s_nop 0
    buffer_load_dwordx4 v20, s[24:27], s41 offen lds
    s_add_u32 m0, s43, 3072
    s_nop 0
    buffer_load_dwordx4 v21, s[24:27], s41 offen lds
    s_add_u32 s40, s40, 128
    s_add_u32 s41, s41, 524288
    s_sub_u32 s42, s42, 131072
    s_sub_u32 s43, s43, 131072
    s_cmp_eq_u32 s16, 1
    s_cbranch_scc1 mega_kernel_qfbd_sw4
    v_mfma_f32_32x32x16_bf16 a[0:15], v[40:43], v[32:35], a[0:15]
    v_mfma_f32_32x32x16_bf16 a[16:31], v[40:43], v[36:39], a[16:31]
    v_mfma_f32_32x32x16_bf16 a[32:47], v[44:47], v[32:35], a[32:47]
    v_mfma_f32_32x32x16_bf16 a[48:63], v[44:47], v[36:39], a[48:63]
    v_mfma_f32_32x32x16_bf16 a[0:15], v[56:59], v[48:51], a[0:15]
    v_mfma_f32_32x32x16_bf16 a[16:31], v[56:59], v[52:55], a[16:31]
    v_mfma_f32_32x32x16_bf16 a[32:47], v[60:63], v[48:51], a[32:47]
    v_mfma_f32_32x32x16_bf16 a[48:63], v[60:63], v[52:55], a[48:63]
    v_mfma_f32_32x32x16_bf16 a[0:15], v[72:75], v[64:67], a[0:15]
    v_mfma_f32_32x32x16_bf16 a[16:31], v[72:75], v[68:71], a[16:31]
    v_mfma_f32_32x32x16_bf16 a[32:47], v[76:79], v[64:67], a[32:47]
    v_mfma_f32_32x32x16_bf16 a[48:63], v[76:79], v[68:71], a[48:63]
    v_mfma_f32_32x32x16_bf16 a[0:15], v[88:91], v[80:83], a[0:15]
    v_mfma_f32_32x32x16_bf16 a[16:31], v[88:91], v[84:87], a[16:31]
    v_mfma_f32_32x32x16_bf16 a[32:47], v[92:95], v[80:83], a[32:47]
    v_mfma_f32_32x32x16_bf16 a[48:63], v[92:95], v[84:87], a[48:63]
mega_kernel_qfbd_swr4:
    s_waitcnt lgkmcnt(0)
    s_mov_b32 s52, 32768
    v_add_u32 v2, s52, v2
    v_add_u32 v3, s52, v3
    v_add_u32 v4, s52, v4
    v_add_u32 v5, s52, v5
    v_add_u32 v6, s52, v6
    v_add_u32 v7, s52, v7
    s_waitcnt vmcnt(24)
    s_barrier
    ds_read_b64_tr_b16 v[40:41], v6 offset:0
    ds_read_b64_tr_b16 v[42:43], v6 offset:1024
    ds_read_b64_tr_b16 v[44:45], v7 offset:0
    ds_read_b64_tr_b16 v[46:47], v7 offset:1024
    ds_read_b128 v[32:35], v2 offset:0
    ds_read_b128 v[36:39], v2 offset:4096
    ds_read_b64_tr_b16 v[56:57], v6 offset:4096
    ds_read_b64_tr_b16 v[58:59], v6 offset:5120
    ds_read_b64_tr_b16 v[60:61], v7 offset:4096
    ds_read_b64_tr_b16 v[62:63], v7 offset:5120
    ds_read_b128 v[48:51], v3 offset:0
    ds_read_b128 v[52:55], v3 offset:4096
    ds_read_b64_tr_b16 v[72:73], v6 offset:8192
    ds_read_b64_tr_b16 v[74:75], v6 offset:9216
    ds_read_b64_tr_b16 v[76:77], v7 offset:8192
    ds_read_b64_tr_b16 v[78:79], v7 offset:9216
    ds_read_b128 v[64:67], v4 offset:0
    ds_read_b128 v[68:71], v4 offset:4096
    ds_read_b64_tr_b16 v[88:89], v6 offset:12288
    ds_read_b64_tr_b16 v[90:91], v6 offset:13312
    ds_read_b64_tr_b16 v[92:93], v7 offset:12288
    ds_read_b64_tr_b16 v[94:95], v7 offset:13312
    ds_read_b128 v[80:83], v5 offset:0
    ds_read_b128 v[84:87], v5 offset:4096
    s_add_u32 m0, s42, 0
    s_nop 0
    buffer_load_dwordx4 v10, s[20:23], s40 offen lds
    s_add_u32 m0, s42, 1024
    s_nop 0
    buffer_load_dwordx4 v11, s[20:23], s40 offen lds
    s_add_u32 m0, s42, 2048
    s_nop 0
    buffer_load_dwordx4 v12, s[20:23], s40 offen lds
    s_add_u32 m0, s42, 3072
    s_nop 0
    buffer_load_dwordx4 v13, s[20:23], s40 offen lds
    s_add_u32 m0, s43, 0
    s_nop 0
    buffer_load_dwordx4 v18, s[24:27], s41 offen lds
    s_add_u32 m0, s43, 1024
    s_nop 0
    buffer_load_dwordx4 v19, s[24:27], s41 offen lds
    s_add_u32 m0, s43, 2048
    s_nop 0
    buffer_load_dwordx4 v20, s[24:27], s41 offen lds
    s_add_u32 m0, s43, 3072
    s_nop 0
    buffer_load_dwordx4 v21, s[24:27], s41 offen lds
    s_add_u32 s40, s40, 128
    s_add_u32 s41, s41, 524288
    s_add_u32 s42, s42, 32768
    s_add_u32 s43, s43, 32768
    s_cmp_eq_u32 s16, 1
    s_cbranch_scc1 mega_kernel_qfbd_sw5
    v_mfma_f32_32x32x16_bf16 a[0:15], v[104:107], v[96:99], a[0:15]
    v_mfma_f32_32x32x16_bf16 a[16:31], v[104:107], v[100:103], a[16:31]
    v_mfma_f32_32x32x16_bf16 a[32:47], v[108:111], v[96:99], a[32:47]
    v_mfma_f32_32x32x16_bf16 a[48:63], v[108:111], v[100:103], a[48:63]
    v_mfma_f32_32x32x16_bf16 a[0:15], v[120:123], v[112:115], a[0:15]
    v_mfma_f32_32x32x16_bf16 a[16:31], v[120:123], v[116:119], a[16:31]
    v_mfma_f32_32x32x16_bf16 a[32:47], v[124:127], v[112:115], a[32:47]
    v_mfma_f32_32x32x16_bf16 a[48:63], v[124:127], v[116:119], a[48:63]
    v_mfma_f32_32x32x16_bf16 a[0:15], v[136:139], v[128:131], a[0:15]
    v_mfma_f32_32x32x16_bf16 a[16:31], v[136:139], v[132:135], a[16:31]
    v_mfma_f32_32x32x16_bf16 a[32:47], v[140:143], v[128:131], a[32:47]
    v_mfma_f32_32x32x16_bf16 a[48:63], v[140:143], v[132:135], a[48:63]
    v_mfma_f32_32x32x16_bf16 a[0:15], v[152:155], v[144:147], a[0:15]
    v_mfma_f32_32x32x16_bf16 a[16:31], v[152:155], v[148:151], a[16:31]
    v_mfma_f32_32x32x16_bf16 a[32:47], v[156:159], v[144:147], a[32:47]
    v_mfma_f32_32x32x16_bf16 a[48:63], v[156:159], v[148:151], a[48:63]
mega_kernel_qfbd_swr5:
    s_waitcnt lgkmcnt(0)
    s_mov_b32 s52, 32768
    v_add_u32 v2, s52, v2
    v_add_u32 v3, s52, v3
    v_add_u32 v4, s52, v4
    v_add_u32 v5, s52, v5
    v_add_u32 v6, s52, v6
    v_add_u32 v7, s52, v7
    s_waitcnt vmcnt(24)
    s_barrier
    ds_read_b64_tr_b16 v[104:105], v6 offset:0
    ds_read_b64_tr_b16 v[106:107], v6 offset:1024
    ds_read_b64_tr_b16 v[108:109], v7 offset:0
    ds_read_b64_tr_b16 v[110:111], v7 offset:1024
    ds_read_b128 v[96:99], v2 offset:0
    ds_read_b128 v[100:103], v2 offset:4096
    ds_read_b64_tr_b16 v[120:121], v6 offset:4096
    ds_read_b64_tr_b16 v[122:123], v6 offset:5120
    ds_read_b64_tr_b16 v[124:125], v7 offset:4096
    ds_read_b64_tr_b16 v[126:127], v7 offset:5120
    ds_read_b128 v[112:115], v3 offset:0
    ds_read_b128 v[116:119], v3 offset:4096
    ds_read_b64_tr_b16 v[136:137], v6 offset:8192
    ds_read_b64_tr_b16 v[138:139], v6 offset:9216
    ds_read_b64_tr_b16 v[140:141], v7 offset:8192
    ds_read_b64_tr_b16 v[142:143], v7 offset:9216
    ds_read_b128 v[128:131], v4 offset:0
    ds_read_b128 v[132:135], v4 offset:4096
    ds_read_b64_tr_b16 v[152:153], v6 offset:12288
    ds_read_b64_tr_b16 v[154:155], v6 offset:13312
    ds_read_b64_tr_b16 v[156:157], v7 offset:12288
    ds_read_b64_tr_b16 v[158:159], v7 offset:13312
    ds_read_b128 v[144:147], v5 offset:0
    ds_read_b128 v[148:151], v5 offset:4096
    s_add_u32 m0, s42, 0
    s_nop 0
    buffer_load_dwordx4 v10, s[20:23], s40 offen lds
    s_add_u32 m0, s42, 1024
    s_nop 0
    buffer_load_dwordx4 v11, s[20:23], s40 offen lds
    s_add_u32 m0, s42, 2048
    s_nop 0
    buffer_load_dwordx4 v12, s[20:23], s40 offen lds
    s_add_u32 m0, s42, 3072
    s_nop 0
    buffer_load_dwordx4 v13, s[20:23], s40 offen lds
    s_add_u32 m0, s43, 0
    s_nop 0
    buffer_load_dwordx4 v18, s[24:27], s41 offen lds
    s_add_u32 m0, s43, 1024
    s_nop 0
    buffer_load_dwordx4 v19, s[24:27], s41 offen lds
    s_add_u32 m0, s43, 2048
    s_nop 0
    buffer_load_dwordx4 v20, s[24:27], s41 offen lds
    s_add_u32 m0, s43, 3072
    s_nop 0
    buffer_load_dwordx4 v21, s[24:27], s41 offen lds
    s_add_u32 s40, s40, 128
    s_add_u32 s41, s41, 524288
    s_add_u32 s42, s42, 32768
    s_add_u32 s43, s43, 32768
    s_cmp_eq_u32 s16, 1
    s_cbranch_scc1 mega_kernel_qfbd_sw6
    v_mfma_f32_32x32x16_bf16 a[0:15], v[40:43], v[32:35], a[0:15]
    v_mfma_f32_32x32x16_bf16 a[16:31], v[40:43], v[36:39], a[16:31]
    v_mfma_f32_32x32x16_bf16 a[32:47], v[44:47], v[32:35], a[32:47]
    v_mfma_f32_32x32x16_bf16 a[48:63], v[44:47], v[36:39], a[48:63]
    v_mfma_f32_32x32x16_bf16 a[0:15], v[56:59], v[48:51], a[0:15]
    v_mfma_f32_32x32x16_bf16 a[16:31], v[56:59], v[52:55], a[16:31]
    v_mfma_f32_32x32x16_bf16 a[32:47], v[60:63], v[48:51], a[32:47]
    v_mfma_f32_32x32x16_bf16 a[48:63], v[60:63], v[52:55], a[48:63]
    v_mfma_f32_32x32x16_bf16 a[0:15], v[72:75], v[64:67], a[0:15]
    v_mfma_f32_32x32x16_bf16 a[16:31], v[72:75], v[68:71], a[16:31]
    v_mfma_f32_32x32x16_bf16 a[32:47], v[76:79], v[64:67], a[32:47]
    v_mfma_f32_32x32x16_bf16 a[48:63], v[76:79], v[68:71], a[48:63]
    v_mfma_f32_32x32x16_bf16 a[0:15], v[88:91], v[80:83], a[0:15]
    v_mfma_f32_32x32x16_bf16 a[16:31], v[88:91], v[84:87], a[16:31]
    v_mfma_f32_32x32x16_bf16 a[32:47], v[92:95], v[80:83], a[32:47]
    v_mfma_f32_32x32x16_bf16 a[48:63], v[92:95], v[84:87], a[48:63]
mega_kernel_qfbd_swr6:
    s_waitcnt lgkmcnt(0)
    s_mov_b32 s52, 32768
    v_add_u32 v2, s52, v2
    v_add_u32 v3, s52, v3
    v_add_u32 v4, s52, v4
    v_add_u32 v5, s52, v5
    v_add_u32 v6, s52, v6
    v_add_u32 v7, s52, v7
    s_waitcnt vmcnt(24)
    s_barrier
    ds_read_b64_tr_b16 v[40:41], v6 offset:0
    ds_read_b64_tr_b16 v[42:43], v6 offset:1024
    ds_read_b64_tr_b16 v[44:45], v7 offset:0
    ds_read_b64_tr_b16 v[46:47], v7 offset:1024
    ds_read_b128 v[32:35], v2 offset:0
    ds_read_b128 v[36:39], v2 offset:4096
    ds_read_b64_tr_b16 v[56:57], v6 offset:4096
    ds_read_b64_tr_b16 v[58:59], v6 offset:5120
    ds_read_b64_tr_b16 v[60:61], v7 offset:4096
    ds_read_b64_tr_b16 v[62:63], v7 offset:5120
    ds_read_b128 v[48:51], v3 offset:0
    ds_read_b128 v[52:55], v3 offset:4096
    ds_read_b64_tr_b16 v[72:73], v6 offset:8192
    ds_read_b64_tr_b16 v[74:75], v6 offset:9216
    ds_read_b64_tr_b16 v[76:77], v7 offset:8192
    ds_read_b64_tr_b16 v[78:79], v7 offset:9216
    ds_read_b128 v[64:67], v4 offset:0
    ds_read_b128 v[68:71], v4 offset:4096
    ds_read_b64_tr_b16 v[88:89], v6 offset:12288
    ds_read_b64_tr_b16 v[90:91], v6 offset:13312
    ds_read_b64_tr_b16 v[92:93], v7 offset:12288
    ds_read_b64_tr_b16 v[94:95], v7 offset:13312
    ds_read_b128 v[80:83], v5 offset:0
    ds_read_b128 v[84:87], v5 offset:4096
    s_add_u32 m0, s42, 0
    s_nop 0
    buffer_load_dwordx4 v10, s[20:23], s40 offen lds
    s_add_u32 m0, s42, 1024
    s_nop 0
    buffer_load_dwordx4 v11, s[20:23], s40 offen lds
    s_add_u32 m0, s42, 2048
    s_nop 0
    buffer_load_dwordx4 v12, s[20:23], s40 offen lds
    s_add_u32 m0, s42, 3072
    s_nop 0
    buffer_load_dwordx4 v13, s[20:23], s40 offen lds
    s_add_u32 m0, s43, 0
    s_nop 0
    buffer_load_dwordx4 v18, s[24:27], s41 offen lds
    s_add_u32 m0, s43, 1024
    s_nop 0
    buffer_load_dwordx4 v19, s[24:27], s41 offen lds
    s_add_u32 m0, s43, 2048
    s_nop 0
    buffer_load_dwordx4 v20, s[24:27], s41 offen lds
    s_add_u32 m0, s43, 3072
    s_nop 0
    buffer_load_dwordx4 v21, s[24:27], s41 offen lds
    s_add_u32 s40, s40, 128
    s_add_u32 s41, s41, 524288
    s_add_u32 s42, s42, 32768
    s_add_u32 s43, s43, 32768
    s_cmp_eq_u32 s16, 1
    s_cbranch_scc1 mega_kernel_qfbd_sw7
    v_mfma_f32_32x32x16_bf16 a[0:15], v[104:107], v[96:99], a[0:15]
    v_mfma_f32_32x32x16_bf16 a[16:31], v[104:107], v[100:103], a[16:31]
    v_mfma_f32_32x32x16_bf16 a[32:47], v[108:111], v[96:99], a[32:47]
    v_mfma_f32_32x32x16_bf16 a[48:63], v[108:111], v[100:103], a[48:63]
    v_mfma_f32_32x32x16_bf16 a[0:15], v[120:123], v[112:115], a[0:15]
    v_mfma_f32_32x32x16_bf16 a[16:31], v[120:123], v[116:119], a[16:31]
    v_mfma_f32_32x32x16_bf16 a[32:47], v[124:127], v[112:115], a[32:47]
    v_mfma_f32_32x32x16_bf16 a[48:63], v[124:127], v[116:119], a[48:63]
    v_mfma_f32_32x32x16_bf16 a[0:15], v[136:139], v[128:131], a[0:15]
    v_mfma_f32_32x32x16_bf16 a[16:31], v[136:139], v[132:135], a[16:31]
    v_mfma_f32_32x32x16_bf16 a[32:47], v[140:143], v[128:131], a[32:47]
    v_mfma_f32_32x32x16_bf16 a[48:63], v[140:143], v[132:135], a[48:63]
    v_mfma_f32_32x32x16_bf16 a[0:15], v[152:155], v[144:147], a[0:15]
    v_mfma_f32_32x32x16_bf16 a[16:31], v[152:155], v[148:151], a[16:31]
    v_mfma_f32_32x32x16_bf16 a[32:47], v[156:159], v[144:147], a[32:47]
    v_mfma_f32_32x32x16_bf16 a[48:63], v[156:159], v[148:151], a[48:63]
mega_kernel_qfbd_swr7:
    s_waitcnt lgkmcnt(0)
    s_mov_b32 s52, 32768
    v_add_u32 v2, s52, v2
    v_add_u32 v3, s52, v3
    v_add_u32 v4, s52, v4
    v_add_u32 v5, s52, v5
    v_add_u32 v6, s52, v6
    v_add_u32 v7, s52, v7
    s_waitcnt vmcnt(24)
    s_barrier
    ds_read_b64_tr_b16 v[104:105], v6 offset:0
    ds_read_b64_tr_b16 v[106:107], v6 offset:1024
    ds_read_b64_tr_b16 v[108:109], v7 offset:0
    ds_read_b64_tr_b16 v[110:111], v7 offset:1024
    ds_read_b128 v[96:99], v2 offset:0
    ds_read_b128 v[100:103], v2 offset:4096
    ds_read_b64_tr_b16 v[120:121], v6 offset:4096
    ds_read_b64_tr_b16 v[122:123], v6 offset:5120
    ds_read_b64_tr_b16 v[124:125], v7 offset:4096
    ds_read_b64_tr_b16 v[126:127], v7 offset:5120
    ds_read_b128 v[112:115], v3 offset:0
    ds_read_b128 v[116:119], v3 offset:4096
    ds_read_b64_tr_b16 v[136:137], v6 offset:8192
    ds_read_b64_tr_b16 v[138:139], v6 offset:9216
    ds_read_b64_tr_b16 v[140:141], v7 offset:8192
    ds_read_b64_tr_b16 v[142:143], v7 offset:9216
    ds_read_b128 v[128:131], v4 offset:0
    ds_read_b128 v[132:135], v4 offset:4096
    ds_read_b64_tr_b16 v[152:153], v6 offset:12288
    ds_read_b64_tr_b16 v[154:155], v6 offset:13312
    ds_read_b64_tr_b16 v[156:157], v7 offset:12288
    ds_read_b64_tr_b16 v[158:159], v7 offset:13312
    ds_read_b128 v[144:147], v5 offset:0
    ds_read_b128 v[148:151], v5 offset:4096
    s_add_u32 m0, s42, 0
    s_nop 0
    buffer_load_dwordx4 v10, s[20:23], s40 offen lds
    s_add_u32 m0, s42, 1024
    s_nop 0
    buffer_load_dwordx4 v11, s[20:23], s40 offen lds
    s_add_u32 m0, s42, 2048
    s_nop 0
    buffer_load_dwordx4 v12, s[20:23], s40 offen lds
    s_add_u32 m0, s42, 3072
    s_nop 0
    buffer_load_dwordx4 v13, s[20:23], s40 offen lds
    s_add_u32 m0, s43, 0
    s_nop 0
    buffer_load_dwordx4 v18, s[24:27], s41 offen lds
    s_add_u32 m0, s43, 1024
    s_nop 0
    buffer_load_dwordx4 v19, s[24:27], s41 offen lds
    s_add_u32 m0, s43, 2048
    s_nop 0
    buffer_load_dwordx4 v20, s[24:27], s41 offen lds
    s_add_u32 m0, s43, 3072
    s_nop 0
    buffer_load_dwordx4 v21, s[24:27], s41 offen lds
    s_add_u32 s40, s40, 128
    s_add_u32 s41, s41, 524288
    s_add_u32 s42, s42, 32768
    s_add_u32 s43, s43, 32768
    s_cmp_eq_u32 s16, 1
    s_cbranch_scc1 mega_kernel_qfbd_sw8
    v_mfma_f32_32x32x16_bf16 a[0:15], v[40:43], v[32:35], a[0:15]
    v_mfma_f32_32x32x16_bf16 a[16:31], v[40:43], v[36:39], a[16:31]
    v_mfma_f32_32x32x16_bf16 a[32:47], v[44:47], v[32:35], a[32:47]
    v_mfma_f32_32x32x16_bf16 a[48:63], v[44:47], v[36:39], a[48:63]
    v_mfma_f32_32x32x16_bf16 a[0:15], v[56:59], v[48:51], a[0:15]
    v_mfma_f32_32x32x16_bf16 a[16:31], v[56:59], v[52:55], a[16:31]
    v_mfma_f32_32x32x16_bf16 a[32:47], v[60:63], v[48:51], a[32:47]
    v_mfma_f32_32x32x16_bf16 a[48:63], v[60:63], v[52:55], a[48:63]
    v_mfma_f32_32x32x16_bf16 a[0:15], v[72:75], v[64:67], a[0:15]
    v_mfma_f32_32x32x16_bf16 a[16:31], v[72:75], v[68:71], a[16:31]
    v_mfma_f32_32x32x16_bf16 a[32:47], v[76:79], v[64:67], a[32:47]
    v_mfma_f32_32x32x16_bf16 a[48:63], v[76:79], v[68:71], a[48:63]
    v_mfma_f32_32x32x16_bf16 a[0:15], v[88:91], v[80:83], a[0:15]
    v_mfma_f32_32x32x16_bf16 a[16:31], v[88:91], v[84:87], a[16:31]
    v_mfma_f32_32x32x16_bf16 a[32:47], v[92:95], v[80:83], a[32:47]
    v_mfma_f32_32x32x16_bf16 a[48:63], v[92:95], v[84:87], a[48:63]
mega_kernel_qfbd_swr8:
    s_waitcnt lgkmcnt(0)
    s_mov_b32 s52, 4294836224
    v_add_u32 v2, s52, v2
    v_add_u32 v3, s52, v3
    v_add_u32 v4, s52, v4
    v_add_u32 v5, s52, v5
    v_add_u32 v6, s52, v6
    v_add_u32 v7, s52, v7
    s_waitcnt vmcnt(24)
    s_barrier
    ds_read_b64_tr_b16 v[40:41], v6 offset:0
    ds_read_b64_tr_b16 v[42:43], v6 offset:1024
    ds_read_b64_tr_b16 v[44:45], v7 offset:0
    ds_read_b64_tr_b16 v[46:47], v7 offset:1024
    ds_read_b128 v[32:35], v2 offset:0
    ds_read_b128 v[36:39], v2 offset:4096
    ds_read_b64_tr_b16 v[56:57], v6 offset:4096
    ds_read_b64_tr_b16 v[58:59], v6 offset:5120
    ds_read_b64_tr_b16 v[60:61], v7 offset:4096
    ds_read_b64_tr_b16 v[62:63], v7 offset:5120
    ds_read_b128 v[48:51], v3 offset:0
    ds_read_b128 v[52:55], v3 offset:4096
    ds_read_b64_tr_b16 v[72:73], v6 offset:8192
    ds_read_b64_tr_b16 v[74:75], v6 offset:9216
    ds_read_b64_tr_b16 v[76:77], v7 offset:8192
    ds_read_b64_tr_b16 v[78:79], v7 offset:9216
    ds_read_b128 v[64:67], v4 offset:0
    ds_read_b128 v[68:71], v4 offset:4096
    ds_read_b64_tr_b16 v[88:89], v6 offset:12288
    ds_read_b64_tr_b16 v[90:91], v6 offset:13312
    ds_read_b64_tr_b16 v[92:93], v7 offset:12288
    ds_read_b64_tr_b16 v[94:95], v7 offset:13312
    ds_read_b128 v[80:83], v5 offset:0
    ds_read_b128 v[84:87], v5 offset:4096
    s_add_u32 m0, s42, 0
    s_nop 0
    buffer_load_dwordx4 v10, s[20:23], s40 offen lds
    s_add_u32 m0, s42, 1024
    s_nop 0
    buffer_load_dwordx4 v11, s[20:23], s40 offen lds
    s_add_u32 m0, s42, 2048
    s_nop 0
    buffer_load_dwordx4 v12, s[20:23], s40 offen lds
    s_add_u32 m0, s42, 3072
    s_nop 0
    buffer_load_dwordx4 v13, s[20:23], s40 offen lds
    s_add_u32 m0, s43, 0
    s_nop 0
    buffer_load_dwordx4 v18, s[24:27], s41 offen lds
    s_add_u32 m0, s43, 1024
    s_nop 0
    buffer_load_dwordx4 v19, s[24:27], s41 offen lds
    s_add_u32 m0, s43, 2048
    s_nop 0
    buffer_load_dwordx4 v20, s[24:27], s41 offen lds
    s_add_u32 m0, s43, 3072
    s_nop 0
    buffer_load_dwordx4 v21, s[24:27], s41 offen lds
    s_add_u32 s40, s40, 128
    s_add_u32 s41, s41, 524288
    s_sub_u32 s42, s42, 131072
    s_sub_u32 s43, s43, 131072
    s_cmp_eq_u32 s16, 1
    s_cbranch_scc1 mega_kernel_qfbd_sw9
    v_mfma_f32_32x32x16_bf16 a[0:15], v[104:107], v[96:99], a[0:15]
    v_mfma_f32_32x32x16_bf16 a[16:31], v[104:107], v[100:103], a[16:31]
    v_mfma_f32_32x32x16_bf16 a[32:47], v[108:111], v[96:99], a[32:47]
    v_mfma_f32_32x32x16_bf16 a[48:63], v[108:111], v[100:103], a[48:63]
    v_mfma_f32_32x32x16_bf16 a[0:15], v[120:123], v[112:115], a[0:15]
    v_mfma_f32_32x32x16_bf16 a[16:31], v[120:123], v[116:119], a[16:31]
    v_mfma_f32_32x32x16_bf16 a[32:47], v[124:127], v[112:115], a[32:47]
    v_mfma_f32_32x32x16_bf16 a[48:63], v[124:127], v[116:119], a[48:63]
    v_mfma_f32_32x32x16_bf16 a[0:15], v[136:139], v[128:131], a[0:15]
    v_mfma_f32_32x32x16_bf16 a[16:31], v[136:139], v[132:135], a[16:31]
    v_mfma_f32_32x32x16_bf16 a[32:47], v[140:143], v[128:131], a[32:47]
    v_mfma_f32_32x32x16_bf16 a[48:63], v[140:143], v[132:135], a[48:63]
    v_mfma_f32_32x32x16_bf16 a[0:15], v[152:155], v[144:147], a[0:15]
    v_mfma_f32_32x32x16_bf16 a[16:31], v[152:155], v[148:151], a[16:31]
    v_mfma_f32_32x32x16_bf16 a[32:47], v[156:159], v[144:147], a[32:47]
    v_mfma_f32_32x32x16_bf16 a[48:63], v[156:159], v[148:151], a[48:63]
mega_kernel_qfbd_swr9:
    s_waitcnt lgkmcnt(0)
    s_mov_b32 s52, 32768
    v_add_u32 v2, s52, v2
    v_add_u32 v3, s52, v3
    v_add_u32 v4, s52, v4
    v_add_u32 v5, s52, v5
    v_add_u32 v6, s52, v6
    v_add_u32 v7, s52, v7
    s_waitcnt vmcnt(24)
    s_barrier
    ds_read_b64_tr_b16 v[104:105], v6 offset:0
    ds_read_b64_tr_b16 v[106:107], v6 offset:1024
    ds_read_b64_tr_b16 v[108:109], v7 offset:0
    ds_read_b64_tr_b16 v[110:111], v7 offset:1024
    ds_read_b128 v[96:99], v2 offset:0
    ds_read_b128 v[100:103], v2 offset:4096
    ds_read_b64_tr_b16 v[120:121], v6 offset:4096
    ds_read_b64_tr_b16 v[122:123], v6 offset:5120
    ds_read_b64_tr_b16 v[124:125], v7 offset:4096
    ds_read_b64_tr_b16 v[126:127], v7 offset:5120
    ds_read_b128 v[112:115], v3 offset:0
    ds_read_b128 v[116:119], v3 offset:4096
    ds_read_b64_tr_b16 v[136:137], v6 offset:8192
    ds_read_b64_tr_b16 v[138:139], v6 offset:9216
    ds_read_b64_tr_b16 v[140:141], v7 offset:8192
    ds_read_b64_tr_b16 v[142:143], v7 offset:9216
    ds_read_b128 v[128:131], v4 offset:0
    ds_read_b128 v[132:135], v4 offset:4096
    ds_read_b64_tr_b16 v[152:153], v6 offset:12288
    ds_read_b64_tr_b16 v[154:155], v6 offset:13312
    ds_read_b64_tr_b16 v[156:157], v7 offset:12288
    ds_read_b64_tr_b16 v[158:159], v7 offset:13312
    ds_read_b128 v[144:147], v5 offset:0
    ds_read_b128 v[148:151], v5 offset:4096
    s_add_u32 m0, s42, 0
    s_nop 0
    buffer_load_dwordx4 v10, s[20:23], s40 offen lds
    s_add_u32 m0, s42, 1024
    s_nop 0
    buffer_load_dwordx4 v11, s[20:23], s40 offen lds
    s_add_u32 m0, s42, 2048
    s_nop 0
    buffer_load_dwordx4 v12, s[20:23], s40 offen lds
    s_add_u32 m0, s42, 3072
    s_nop 0
    buffer_load_dwordx4 v13, s[20:23], s40 offen lds
    s_add_u32 m0, s43, 0
    s_nop 0
    buffer_load_dwordx4 v18, s[24:27], s41 offen lds
    s_add_u32 m0, s43, 1024
    s_nop 0
    buffer_load_dwordx4 v19, s[24:27], s41 offen lds
    s_add_u32 m0, s43, 2048
    s_nop 0
    buffer_load_dwordx4 v20, s[24:27], s41 offen lds
    s_add_u32 m0, s43, 3072
    s_nop 0
    buffer_load_dwordx4 v21, s[24:27], s41 offen lds
    s_add_u32 s40, s40, 128
    s_add_u32 s41, s41, 524288
    s_add_u32 s42, s42, 32768
    s_add_u32 s43, s43, 32768
    s_cmp_eq_u32 s16, 1
    s_cbranch_scc1 mega_kernel_qfbd_sw10
    v_mfma_f32_32x32x16_bf16 a[0:15], v[40:43], v[32:35], a[0:15]
    v_mfma_f32_32x32x16_bf16 a[16:31], v[40:43], v[36:39], a[16:31]
    v_mfma_f32_32x32x16_bf16 a[32:47], v[44:47], v[32:35], a[32:47]
    v_mfma_f32_32x32x16_bf16 a[48:63], v[44:47], v[36:39], a[48:63]
    v_mfma_f32_32x32x16_bf16 a[0:15], v[56:59], v[48:51], a[0:15]
    v_mfma_f32_32x32x16_bf16 a[16:31], v[56:59], v[52:55], a[16:31]
    v_mfma_f32_32x32x16_bf16 a[32:47], v[60:63], v[48:51], a[32:47]
    v_mfma_f32_32x32x16_bf16 a[48:63], v[60:63], v[52:55], a[48:63]
    v_mfma_f32_32x32x16_bf16 a[0:15], v[72:75], v[64:67], a[0:15]
    v_mfma_f32_32x32x16_bf16 a[16:31], v[72:75], v[68:71], a[16:31]
    v_mfma_f32_32x32x16_bf16 a[32:47], v[76:79], v[64:67], a[32:47]
    v_mfma_f32_32x32x16_bf16 a[48:63], v[76:79], v[68:71], a[48:63]
    v_mfma_f32_32x32x16_bf16 a[0:15], v[88:91], v[80:83], a[0:15]
    v_mfma_f32_32x32x16_bf16 a[16:31], v[88:91], v[84:87], a[16:31]
    v_mfma_f32_32x32x16_bf16 a[32:47], v[92:95], v[80:83], a[32:47]
    v_mfma_f32_32x32x16_bf16 a[48:63], v[92:95], v[84:87], a[48:63]
mega_kernel_qfbd_swr10:
    s_waitcnt lgkmcnt(0)
    s_mov_b32 s52, 32768
    v_add_u32 v2, s52, v2
    v_add_u32 v3, s52, v3
    v_add_u32 v4, s52, v4
    v_add_u32 v5, s52, v5
    v_add_u32 v6, s52, v6
    v_add_u32 v7, s52, v7
    s_waitcnt vmcnt(24)
    s_barrier
    ds_read_b64_tr_b16 v[40:41], v6 offset:0
    ds_read_b64_tr_b16 v[42:43], v6 offset:1024
    ds_read_b64_tr_b16 v[44:45], v7 offset:0
    ds_read_b64_tr_b16 v[46:47], v7 offset:1024
    ds_read_b128 v[32:35], v2 offset:0
    ds_read_b128 v[36:39], v2 offset:4096
    ds_read_b64_tr_b16 v[56:57], v6 offset:4096
    ds_read_b64_tr_b16 v[58:59], v6 offset:5120
    ds_read_b64_tr_b16 v[60:61], v7 offset:4096
    ds_read_b64_tr_b16 v[62:63], v7 offset:5120
    ds_read_b128 v[48:51], v3 offset:0
    ds_read_b128 v[52:55], v3 offset:4096
    ds_read_b64_tr_b16 v[72:73], v6 offset:8192
    ds_read_b64_tr_b16 v[74:75], v6 offset:9216
    ds_read_b64_tr_b16 v[76:77], v7 offset:8192
    ds_read_b64_tr_b16 v[78:79], v7 offset:9216
    ds_read_b128 v[64:67], v4 offset:0
    ds_read_b128 v[68:71], v4 offset:4096
    ds_read_b64_tr_b16 v[88:89], v6 offset:12288
    ds_read_b64_tr_b16 v[90:91], v6 offset:13312
    ds_read_b64_tr_b16 v[92:93], v7 offset:12288
    ds_read_b64_tr_b16 v[94:95], v7 offset:13312
    ds_read_b128 v[80:83], v5 offset:0
    ds_read_b128 v[84:87], v5 offset:4096
    s_cmp_eq_u32 s16, 1
    s_cbranch_scc1 mega_kernel_qfbd_sw11
    v_mfma_f32_32x32x16_bf16 a[0:15], v[104:107], v[96:99], a[0:15]
    v_mfma_f32_32x32x16_bf16 a[16:31], v[104:107], v[100:103], a[16:31]
    v_mfma_f32_32x32x16_bf16 a[32:47], v[108:111], v[96:99], a[32:47]
    v_mfma_f32_32x32x16_bf16 a[48:63], v[108:111], v[100:103], a[48:63]
    v_mfma_f32_32x32x16_bf16 a[0:15], v[120:123], v[112:115], a[0:15]
    v_mfma_f32_32x32x16_bf16 a[16:31], v[120:123], v[116:119], a[16:31]
    v_mfma_f32_32x32x16_bf16 a[32:47], v[124:127], v[112:115], a[32:47]
    v_mfma_f32_32x32x16_bf16 a[48:63], v[124:127], v[116:119], a[48:63]
    v_mfma_f32_32x32x16_bf16 a[0:15], v[136:139], v[128:131], a[0:15]
    v_mfma_f32_32x32x16_bf16 a[16:31], v[136:139], v[132:135], a[16:31]
    v_mfma_f32_32x32x16_bf16 a[32:47], v[140:143], v[128:131], a[32:47]
    v_mfma_f32_32x32x16_bf16 a[48:63], v[140:143], v[132:135], a[48:63]
    v_mfma_f32_32x32x16_bf16 a[0:15], v[152:155], v[144:147], a[0:15]
    v_mfma_f32_32x32x16_bf16 a[16:31], v[152:155], v[148:151], a[16:31]
    v_mfma_f32_32x32x16_bf16 a[32:47], v[156:159], v[144:147], a[32:47]
    v_mfma_f32_32x32x16_bf16 a[48:63], v[156:159], v[148:151], a[48:63]
mega_kernel_qfbd_swr11:
    s_waitcnt lgkmcnt(0)
    s_mov_b32 s52, 32768
    v_add_u32 v2, s52, v2
    v_add_u32 v3, s52, v3
    v_add_u32 v4, s52, v4
    v_add_u32 v5, s52, v5
    v_add_u32 v6, s52, v6
    v_add_u32 v7, s52, v7
    s_waitcnt vmcnt(16)
    s_barrier
    ds_read_b64_tr_b16 v[104:105], v6 offset:0
    ds_read_b64_tr_b16 v[106:107], v6 offset:1024
    ds_read_b64_tr_b16 v[108:109], v7 offset:0
    ds_read_b64_tr_b16 v[110:111], v7 offset:1024
    ds_read_b128 v[96:99], v2 offset:0
    ds_read_b128 v[100:103], v2 offset:4096
    ds_read_b64_tr_b16 v[120:121], v6 offset:4096
    ds_read_b64_tr_b16 v[122:123], v6 offset:5120
    ds_read_b64_tr_b16 v[124:125], v7 offset:4096
    ds_read_b64_tr_b16 v[126:127], v7 offset:5120
    ds_read_b128 v[112:115], v3 offset:0
    ds_read_b128 v[116:119], v3 offset:4096
    ds_read_b64_tr_b16 v[136:137], v6 offset:8192
    ds_read_b64_tr_b16 v[138:139], v6 offset:9216
    ds_read_b64_tr_b16 v[140:141], v7 offset:8192
    ds_read_b64_tr_b16 v[142:143], v7 offset:9216
    ds_read_b128 v[128:131], v4 offset:0
    ds_read_b128 v[132:135], v4 offset:4096
    ds_read_b64_tr_b16 v[152:153], v6 offset:12288
    ds_read_b64_tr_b16 v[154:155], v6 offset:13312
    ds_read_b64_tr_b16 v[156:157], v7 offset:12288
    ds_read_b64_tr_b16 v[158:159], v7 offset:13312
    ds_read_b128 v[144:147], v5 offset:0
    ds_read_b128 v[148:151], v5 offset:4096
    s_cmp_eq_u32 s16, 1
    s_cbranch_scc1 mega_kernel_qfbd_sw12
    v_mfma_f32_32x32x16_bf16 a[0:15], v[40:43], v[32:35], a[0:15]
    v_mfma_f32_32x32x16_bf16 a[16:31], v[40:43], v[36:39], a[16:31]
    v_mfma_f32_32x32x16_bf16 a[32:47], v[44:47], v[32:35], a[32:47]
    v_mfma_f32_32x32x16_bf16 a[48:63], v[44:47], v[36:39], a[48:63]
    v_mfma_f32_32x32x16_bf16 a[0:15], v[56:59], v[48:51], a[0:15]
    v_mfma_f32_32x32x16_bf16 a[16:31], v[56:59], v[52:55], a[16:31]
    v_mfma_f32_32x32x16_bf16 a[32:47], v[60:63], v[48:51], a[32:47]
    v_mfma_f32_32x32x16_bf16 a[48:63], v[60:63], v[52:55], a[48:63]
    v_mfma_f32_32x32x16_bf16 a[0:15], v[72:75], v[64:67], a[0:15]
    v_mfma_f32_32x32x16_bf16 a[16:31], v[72:75], v[68:71], a[16:31]
    v_mfma_f32_32x32x16_bf16 a[32:47], v[76:79], v[64:67], a[32:47]
    v_mfma_f32_32x32x16_bf16 a[48:63], v[76:79], v[68:71], a[48:63]
    v_mfma_f32_32x32x16_bf16 a[0:15], v[88:91], v[80:83], a[0:15]
    v_mfma_f32_32x32x16_bf16 a[16:31], v[88:91], v[84:87], a[16:31]
    v_mfma_f32_32x32x16_bf16 a[32:47], v[92:95], v[80:83], a[32:47]
    v_mfma_f32_32x32x16_bf16 a[48:63], v[92:95], v[84:87], a[48:63]
mega_kernel_qfbd_swr12:
    s_waitcnt lgkmcnt(0)
    s_mov_b32 s52, 32768
    v_add_u32 v2, s52, v2
    v_add_u32 v3, s52, v3
    v_add_u32 v4, s52, v4
    v_add_u32 v5, s52, v5
    v_add_u32 v6, s52, v6
    v_add_u32 v7, s52, v7
    s_waitcnt vmcnt(8)
    s_barrier
    ds_read_b64_tr_b16 v[40:41], v6 offset:0
    ds_read_b64_tr_b16 v[42:43], v6 offset:1024
    ds_read_b64_tr_b16 v[44:45], v7 offset:0
    ds_read_b64_tr_b16 v[46:47], v7 offset:1024
    ds_read_b128 v[32:35], v2 offset:0
    ds_read_b128 v[36:39], v2 offset:4096
    ds_read_b64_tr_b16 v[56:57], v6 offset:4096
    ds_read_b64_tr_b16 v[58:59], v6 offset:5120
    ds_read_b64_tr_b16 v[60:61], v7 offset:4096
    ds_read_b64_tr_b16 v[62:63], v7 offset:5120
    ds_read_b128 v[48:51], v3 offset:0
    ds_read_b128 v[52:55], v3 offset:4096
    ds_read_b64_tr_b16 v[72:73], v6 offset:8192
    ds_read_b64_tr_b16 v[74:75], v6 offset:9216
    ds_read_b64_tr_b16 v[76:77], v7 offset:8192
    ds_read_b64_tr_b16 v[78:79], v7 offset:9216
    ds_read_b128 v[64:67], v4 offset:0
    ds_read_b128 v[68:71], v4 offset:4096
    ds_read_b64_tr_b16 v[88:89], v6 offset:12288
    ds_read_b64_tr_b16 v[90:91], v6 offset:13312
    ds_read_b64_tr_b16 v[92:93], v7 offset:12288
    ds_read_b64_tr_b16 v[94:95], v7 offset:13312
    ds_read_b128 v[80:83], v5 offset:0
    ds_read_b128 v[84:87], v5 offset:4096
    s_cmp_eq_u32 s16, 1
    s_cbranch_scc1 mega_kernel_qfbd_sw13
    v_mfma_f32_32x32x16_bf16 a[0:15], v[104:107], v[96:99], a[0:15]
    v_mfma_f32_32x32x16_bf16 a[16:31], v[104:107], v[100:103], a[16:31]
    v_mfma_f32_32x32x16_bf16 a[32:47], v[108:111], v[96:99], a[32:47]
    v_mfma_f32_32x32x16_bf16 a[48:63], v[108:111], v[100:103], a[48:63]
    v_mfma_f32_32x32x16_bf16 a[0:15], v[120:123], v[112:115], a[0:15]
    v_mfma_f32_32x32x16_bf16 a[16:31], v[120:123], v[116:119], a[16:31]
    v_mfma_f32_32x32x16_bf16 a[32:47], v[124:127], v[112:115], a[32:47]
    v_mfma_f32_32x32x16_bf16 a[48:63], v[124:127], v[116:119], a[48:63]
    v_mfma_f32_32x32x16_bf16 a[0:15], v[136:139], v[128:131], a[0:15]
    v_mfma_f32_32x32x16_bf16 a[16:31], v[136:139], v[132:135], a[16:31]
    v_mfma_f32_32x32x16_bf16 a[32:47], v[140:143], v[128:131], a[32:47]
    v_mfma_f32_32x32x16_bf16 a[48:63], v[140:143], v[132:135], a[48:63]
    v_mfma_f32_32x32x16_bf16 a[0:15], v[152:155], v[144:147], a[0:15]
    v_mfma_f32_32x32x16_bf16 a[16:31], v[152:155], v[148:151], a[16:31]
    v_mfma_f32_32x32x16_bf16 a[32:47], v[156:159], v[144:147], a[32:47]
    v_mfma_f32_32x32x16_bf16 a[48:63], v[156:159], v[148:151], a[48:63]
mega_kernel_qfbd_swr13:
    s_waitcnt lgkmcnt(0)
    s_mov_b32 s52, 4294836224
    v_add_u32 v2, s52, v2
    v_add_u32 v3, s52, v3
    v_add_u32 v4, s52, v4
    v_add_u32 v5, s52, v5
    v_add_u32 v6, s52, v6
    v_add_u32 v7, s52, v7
    s_waitcnt vmcnt(0)
    s_barrier
    ds_read_b64_tr_b16 v[104:105], v6 offset:0
    ds_read_b64_tr_b16 v[106:107], v6 offset:1024
    ds_read_b64_tr_b16 v[108:109], v7 offset:0
    ds_read_b64_tr_b16 v[110:111], v7 offset:1024
    ds_read_b128 v[96:99], v2 offset:0
    ds_read_b128 v[100:103], v2 offset:4096
    ds_read_b64_tr_b16 v[120:121], v6 offset:4096
    ds_read_b64_tr_b16 v[122:123], v6 offset:5120
    ds_read_b64_tr_b16 v[124:125], v7 offset:4096
    ds_read_b64_tr_b16 v[126:127], v7 offset:5120
    ds_read_b128 v[112:115], v3 offset:0
    ds_read_b128 v[116:119], v3 offset:4096
    ds_read_b64_tr_b16 v[136:137], v6 offset:8192
    ds_read_b64_tr_b16 v[138:139], v6 offset:9216
    ds_read_b64_tr_b16 v[140:141], v7 offset:8192
    ds_read_b64_tr_b16 v[142:143], v7 offset:9216
    ds_read_b128 v[128:131], v4 offset:0
    ds_read_b128 v[132:135], v4 offset:4096
    ds_read_b64_tr_b16 v[152:153], v6 offset:12288
    ds_read_b64_tr_b16 v[154:155], v6 offset:13312
    ds_read_b64_tr_b16 v[156:157], v7 offset:12288
    ds_read_b64_tr_b16 v[158:159], v7 offset:13312
    ds_read_b128 v[144:147], v5 offset:0
    ds_read_b128 v[148:151], v5 offset:4096
    s_cmp_eq_u32 s16, 1
    s_cbranch_scc1 mega_kernel_qfbd_sw14
    v_mfma_f32_32x32x16_bf16 a[0:15], v[40:43], v[32:35], a[0:15]
    v_mfma_f32_32x32x16_bf16 a[16:31], v[40:43], v[36:39], a[16:31]
    v_mfma_f32_32x32x16_bf16 a[32:47], v[44:47], v[32:35], a[32:47]
    v_mfma_f32_32x32x16_bf16 a[48:63], v[44:47], v[36:39], a[48:63]
    v_mfma_f32_32x32x16_bf16 a[0:15], v[56:59], v[48:51], a[0:15]
    v_mfma_f32_32x32x16_bf16 a[16:31], v[56:59], v[52:55], a[16:31]
    v_mfma_f32_32x32x16_bf16 a[32:47], v[60:63], v[48:51], a[32:47]
    v_mfma_f32_32x32x16_bf16 a[48:63], v[60:63], v[52:55], a[48:63]
    v_mfma_f32_32x32x16_bf16 a[0:15], v[72:75], v[64:67], a[0:15]
    v_mfma_f32_32x32x16_bf16 a[16:31], v[72:75], v[68:71], a[16:31]
    v_mfma_f32_32x32x16_bf16 a[32:47], v[76:79], v[64:67], a[32:47]
    v_mfma_f32_32x32x16_bf16 a[48:63], v[76:79], v[68:71], a[48:63]
    v_mfma_f32_32x32x16_bf16 a[0:15], v[88:91], v[80:83], a[0:15]
    v_mfma_f32_32x32x16_bf16 a[16:31], v[88:91], v[84:87], a[16:31]
    v_mfma_f32_32x32x16_bf16 a[32:47], v[92:95], v[80:83], a[32:47]
    v_mfma_f32_32x32x16_bf16 a[48:63], v[92:95], v[84:87], a[48:63]
mega_kernel_qfbd_swr14:
    s_waitcnt lgkmcnt(0)
    s_cmp_eq_u32 s16, 1
    s_cbranch_scc1 mega_kernel_qfbd_sw15
    v_mfma_f32_32x32x16_bf16 a[0:15], v[104:107], v[96:99], a[0:15]
    v_mfma_f32_32x32x16_bf16 a[16:31], v[104:107], v[100:103], a[16:31]
    v_mfma_f32_32x32x16_bf16 a[32:47], v[108:111], v[96:99], a[32:47]
    v_mfma_f32_32x32x16_bf16 a[48:63], v[108:111], v[100:103], a[48:63]
    v_mfma_f32_32x32x16_bf16 a[0:15], v[120:123], v[112:115], a[0:15]
    v_mfma_f32_32x32x16_bf16 a[16:31], v[120:123], v[116:119], a[16:31]
    v_mfma_f32_32x32x16_bf16 a[32:47], v[124:127], v[112:115], a[32:47]
    v_mfma_f32_32x32x16_bf16 a[48:63], v[124:127], v[116:119], a[48:63]
    v_mfma_f32_32x32x16_bf16 a[0:15], v[136:139], v[128:131], a[0:15]
    v_mfma_f32_32x32x16_bf16 a[16:31], v[136:139], v[132:135], a[16:31]
    v_mfma_f32_32x32x16_bf16 a[32:47], v[140:143], v[128:131], a[32:47]
    v_mfma_f32_32x32x16_bf16 a[48:63], v[140:143], v[132:135], a[48:63]
    v_mfma_f32_32x32x16_bf16 a[0:15], v[152:155], v[144:147], a[0:15]
    v_mfma_f32_32x32x16_bf16 a[16:31], v[152:155], v[148:151], a[16:31]
    v_mfma_f32_32x32x16_bf16 a[32:47], v[156:159], v[144:147], a[32:47]
    v_mfma_f32_32x32x16_bf16 a[48:63], v[156:159], v[148:151], a[48:63]
mega_kernel_qfbd_swr15:
    s_branch mega_kernel_qfbd_done
mega_kernel_qfbd_sw0:
    s_nop 5
    v_mfma_f32_32x32x16_bf16 a[0:15], v[32:35], v[40:43], 0
    v_mfma_f32_32x32x16_bf16 a[16:31], v[36:39], v[40:43], 0
    v_mfma_f32_32x32x16_bf16 a[32:47], v[32:35], v[44:47], 0
    v_mfma_f32_32x32x16_bf16 a[48:63], v[36:39], v[44:47], 0
    v_mfma_f32_32x32x16_bf16 a[0:15], v[48:51], v[56:59], a[0:15]
    v_mfma_f32_32x32x16_bf16 a[16:31], v[52:55], v[56:59], a[16:31]
    v_mfma_f32_32x32x16_bf16 a[32:47], v[48:51], v[60:63], a[32:47]
    v_mfma_f32_32x32x16_bf16 a[48:63], v[52:55], v[60:63], a[48:63]
    v_mfma_f32_32x32x16_bf16 a[0:15], v[64:67], v[72:75], a[0:15]
    v_mfma_f32_32x32x16_bf16 a[16:31], v[68:71], v[72:75], a[16:31]
    v_mfma_f32_32x32x16_bf16 a[32:47], v[64:67], v[76:79], a[32:47]
    v_mfma_f32_32x32x16_bf16 a[48:63], v[68:71], v[76:79], a[48:63]
    v_mfma_f32_32x32x16_bf16 a[0:15], v[80:83], v[88:91], a[0:15]
    v_mfma_f32_32x32x16_bf16 a[16:31], v[84:87], v[88:91], a[16:31]
    v_mfma_f32_32x32x16_bf16 a[32:47], v[80:83], v[92:95], a[32:47]
    v_mfma_f32_32x32x16_bf16 a[48:63], v[84:87], v[92:95], a[48:63]
    s_branch mega_kernel_qfbd_swr0
mega_kernel_qfbd_sw1:
    v_mfma_f32_32x32x16_bf16 a[0:15], v[96:99], v[104:107], a[0:15]
    v_mfma_f32_32x32x16_bf16 a[16:31], v[100:103], v[104:107], a[16:31]
    v_mfma_f32_32x32x16_bf16 a[32:47], v[96:99], v[108:111], a[32:47]
    v_mfma_f32_32x32x16_bf16 a[48:63], v[100:103], v[108:111], a[48:63]
    v_mfma_f32_32x32x16_bf16 a[0:15], v[112:115], v[120:123], a[0:15]
    v_mfma_f32_32x32x16_bf16 a[16:31], v[116:119], v[120:123], a[16:31]
    v_mfma_f32_32x32x16_bf16 a[32:47], v[112:115], v[124:127], a[32:47]
    v_mfma_f32_32x32x16_bf16 a[48:63], v[116:119], v[124:127], a[48:63]
    v_mfma_f32_32x32x16_bf16 a[0:15], v[128:131], v[136:139], a[0:15]
    v_mfma_f32_32x32x16_bf16 a[16:31], v[132:135], v[136:139], a[16:31]
    v_mfma_f32_32x32x16_bf16 a[32:47], v[128:131], v[140:143], a[32:47]
    v_mfma_f32_32x32x16_bf16 a[48:63], v[132:135], v[140:143], a[48:63]
    v_mfma_f32_32x32x16_bf16 a[0:15], v[144:147], v[152:155], a[0:15]
    v_mfma_f32_32x32x16_bf16 a[16:31], v[148:151], v[152:155], a[16:31]
    v_mfma_f32_32x32x16_bf16 a[32:47], v[144:147], v[156:159], a[32:47]
    v_mfma_f32_32x32x16_bf16 a[48:63], v[148:151], v[156:159], a[48:63]
    s_branch mega_kernel_qfbd_swr1
mega_kernel_qfbd_sw2:
    v_mfma_f32_32x32x16_bf16 a[0:15], v[32:35], v[40:43], a[0:15]
    v_mfma_f32_32x32x16_bf16 a[16:31], v[36:39], v[40:43], a[16:31]
    v_mfma_f32_32x32x16_bf16 a[32:47], v[32:35], v[44:47], a[32:47]
    v_mfma_f32_32x32x16_bf16 a[48:63], v[36:39], v[44:47], a[48:63]
    v_mfma_f32_32x32x16_bf16 a[0:15], v[48:51], v[56:59], a[0:15]
    v_mfma_f32_32x32x16_bf16 a[16:31], v[52:55], v[56:59], a[16:31]
    v_mfma_f32_32x32x16_bf16 a[32:47], v[48:51], v[60:63], a[32:47]
    v_mfma_f32_32x32x16_bf16 a[48:63], v[52:55], v[60:63], a[48:63]
    v_mfma_f32_32x32x16_bf16 a[0:15], v[64:67], v[72:75], a[0:15]
    v_mfma_f32_32x32x16_bf16 a[16:31], v[68:71], v[72:75], a[16:31]
    v_mfma_f32_32x32x16_bf16 a[32:47], v[64:67], v[76:79], a[32:47]
    v_mfma_f32_32x32x16_bf16 a[48:63], v[68:71], v[76:79], a[48:63]
    v_mfma_f32_32x32x16_bf16 a[0:15], v[80:83], v[88:91], a[0:15]
    v_mfma_f32_32x32x16_bf16 a[16:31], v[84:87], v[88:91], a[16:31]
    v_mfma_f32_32x32x16_bf16 a[32:47], v[80:83], v[92:95], a[32:47]
    v_mfma_f32_32x32x16_bf16 a[48:63], v[84:87], v[92:95], a[48:63]
    s_branch mega_kernel_qfbd_swr2
mega_kernel_qfbd_sw3:
    v_mfma_f32_32x32x16_bf16 a[0:15], v[96:99], v[104:107], a[0:15]
    v_mfma_f32_32x32x16_bf16 a[16:31], v[100:103], v[104:107], a[16:31]
    v_mfma_f32_32x32x16_bf16 a[32:47], v[96:99], v[108:111], a[32:47]
    v_mfma_f32_32x32x16_bf16 a[48:63], v[100:103], v[108:111], a[48:63]
    v_mfma_f32_32x32x16_bf16 a[0:15], v[112:115], v[120:123], a[0:15]
    v_mfma_f32_32x32x16_bf16 a[16:31], v[116:119], v[120:123], a[16:31]
    v_mfma_f32_32x32x16_bf16 a[32:47], v[112:115], v[124:127], a[32:47]
    v_mfma_f32_32x32x16_bf16 a[48:63], v[116:119], v[124:127], a[48:63]
    v_mfma_f32_32x32x16_bf16 a[0:15], v[128:131], v[136:139], a[0:15]
    v_mfma_f32_32x32x16_bf16 a[16:31], v[132:135], v[136:139], a[16:31]
    v_mfma_f32_32x32x16_bf16 a[32:47], v[128:131], v[140:143], a[32:47]
    v_mfma_f32_32x32x16_bf16 a[48:63], v[132:135], v[140:143], a[48:63]
    v_mfma_f32_32x32x16_bf16 a[0:15], v[144:147], v[152:155], a[0:15]
    v_mfma_f32_32x32x16_bf16 a[16:31], v[148:151], v[152:155], a[16:31]
    v_mfma_f32_32x32x16_bf16 a[32:47], v[144:147], v[156:159], a[32:47]
    v_mfma_f32_32x32x16_bf16 a[48:63], v[148:151], v[156:159], a[48:63]
    s_branch mega_kernel_qfbd_swr3
mega_kernel_qfbd_sw4:
    v_mfma_f32_32x32x16_bf16 a[0:15], v[32:35], v[40:43], a[0:15]
    v_mfma_f32_32x32x16_bf16 a[16:31], v[36:39], v[40:43], a[16:31]
    v_mfma_f32_32x32x16_bf16 a[32:47], v[32:35], v[44:47], a[32:47]
    v_mfma_f32_32x32x16_bf16 a[48:63], v[36:39], v[44:47], a[48:63]
    v_mfma_f32_32x32x16_bf16 a[0:15], v[48:51], v[56:59], a[0:15]
    v_mfma_f32_32x32x16_bf16 a[16:31], v[52:55], v[56:59], a[16:31]
    v_mfma_f32_32x32x16_bf16 a[32:47], v[48:51], v[60:63], a[32:47]
    v_mfma_f32_32x32x16_bf16 a[48:63], v[52:55], v[60:63], a[48:63]
    v_mfma_f32_32x32x16_bf16 a[0:15], v[64:67], v[72:75], a[0:15]
    v_mfma_f32_32x32x16_bf16 a[16:31], v[68:71], v[72:75], a[16:31]
    v_mfma_f32_32x32x16_bf16 a[32:47], v[64:67], v[76:79], a[32:47]
    v_mfma_f32_32x32x16_bf16 a[48:63], v[68:71], v[76:79], a[48:63]
    v_mfma_f32_32x32x16_bf16 a[0:15], v[80:83], v[88:91], a[0:15]
    v_mfma_f32_32x32x16_bf16 a[16:31], v[84:87], v[88:91], a[16:31]
    v_mfma_f32_32x32x16_bf16 a[32:47], v[80:83], v[92:95], a[32:47]
    v_mfma_f32_32x32x16_bf16 a[48:63], v[84:87], v[92:95], a[48:63]
    s_branch mega_kernel_qfbd_swr4
mega_kernel_qfbd_sw5:
    v_mfma_f32_32x32x16_bf16 a[0:15], v[96:99], v[104:107], a[0:15]
    v_mfma_f32_32x32x16_bf16 a[16:31], v[100:103], v[104:107], a[16:31]
    v_mfma_f32_32x32x16_bf16 a[32:47], v[96:99], v[108:111], a[32:47]
    v_mfma_f32_32x32x16_bf16 a[48:63], v[100:103], v[108:111], a[48:63]
    v_mfma_f32_32x32x16_bf16 a[0:15], v[112:115], v[120:123], a[0:15]
    v_mfma_f32_32x32x16_bf16 a[16:31], v[116:119], v[120:123], a[16:31]
    v_mfma_f32_32x32x16_bf16 a[32:47], v[112:115], v[124:127], a[32:47]
    v_mfma_f32_32x32x16_bf16 a[48:63], v[116:119], v[124:127], a[48:63]
    v_mfma_f32_32x32x16_bf16 a[0:15], v[128:131], v[136:139], a[0:15]
    v_mfma_f32_32x32x16_bf16 a[16:31], v[132:135], v[136:139], a[16:31]
    v_mfma_f32_32x32x16_bf16 a[32:47], v[128:131], v[140:143], a[32:47]
    v_mfma_f32_32x32x16_bf16 a[48:63], v[132:135], v[140:143], a[48:63]
    v_mfma_f32_32x32x16_bf16 a[0:15], v[144:147], v[152:155], a[0:15]
    v_mfma_f32_32x32x16_bf16 a[16:31], v[148:151], v[152:155], a[16:31]
    v_mfma_f32_32x32x16_bf16 a[32:47], v[144:147], v[156:159], a[32:47]
    v_mfma_f32_32x32x16_bf16 a[48:63], v[148:151], v[156:159], a[48:63]
    s_branch mega_kernel_qfbd_swr5
mega_kernel_qfbd_sw6:
    v_mfma_f32_32x32x16_bf16 a[0:15], v[32:35], v[40:43], a[0:15]
    v_mfma_f32_32x32x16_bf16 a[16:31], v[36:39], v[40:43], a[16:31]
    v_mfma_f32_32x32x16_bf16 a[32:47], v[32:35], v[44:47], a[32:47]
    v_mfma_f32_32x32x16_bf16 a[48:63], v[36:39], v[44:47], a[48:63]
    v_mfma_f32_32x32x16_bf16 a[0:15], v[48:51], v[56:59], a[0:15]
    v_mfma_f32_32x32x16_bf16 a[16:31], v[52:55], v[56:59], a[16:31]
    v_mfma_f32_32x32x16_bf16 a[32:47], v[48:51], v[60:63], a[32:47]
    v_mfma_f32_32x32x16_bf16 a[48:63], v[52:55], v[60:63], a[48:63]
    v_mfma_f32_32x32x16_bf16 a[0:15], v[64:67], v[72:75], a[0:15]
    v_mfma_f32_32x32x16_bf16 a[16:31], v[68:71], v[72:75], a[16:31]
    v_mfma_f32_32x32x16_bf16 a[32:47], v[64:67], v[76:79], a[32:47]
    v_mfma_f32_32x32x16_bf16 a[48:63], v[68:71], v[76:79], a[48:63]
    v_mfma_f32_32x32x16_bf16 a[0:15], v[80:83], v[88:91], a[0:15]
    v_mfma_f32_32x32x16_bf16 a[16:31], v[84:87], v[88:91], a[16:31]
    v_mfma_f32_32x32x16_bf16 a[32:47], v[80:83], v[92:95], a[32:47]
    v_mfma_f32_32x32x16_bf16 a[48:63], v[84:87], v[92:95], a[48:63]
    s_branch mega_kernel_qfbd_swr6
mega_kernel_qfbd_sw7:
    v_mfma_f32_32x32x16_bf16 a[0:15], v[96:99], v[104:107], a[0:15]
    v_mfma_f32_32x32x16_bf16 a[16:31], v[100:103], v[104:107], a[16:31]
    v_mfma_f32_32x32x16_bf16 a[32:47], v[96:99], v[108:111], a[32:47]
    v_mfma_f32_32x32x16_bf16 a[48:63], v[100:103], v[108:111], a[48:63]
    v_mfma_f32_32x32x16_bf16 a[0:15], v[112:115], v[120:123], a[0:15]
    v_mfma_f32_32x32x16_bf16 a[16:31], v[116:119], v[120:123], a[16:31]
    v_mfma_f32_32x32x16_bf16 a[32:47], v[112:115], v[124:127], a[32:47]
    v_mfma_f32_32x32x16_bf16 a[48:63], v[116:119], v[124:127], a[48:63]
    v_mfma_f32_32x32x16_bf16 a[0:15], v[128:131], v[136:139], a[0:15]
    v_mfma_f32_32x32x16_bf16 a[16:31], v[132:135], v[136:139], a[16:31]
    v_mfma_f32_32x32x16_bf16 a[32:47], v[128:131], v[140:143], a[32:47]
    v_mfma_f32_32x32x16_bf16 a[48:63], v[132:135], v[140:143], a[48:63]
    v_mfma_f32_32x32x16_bf16 a[0:15], v[144:147], v[152:155], a[0:15]
    v_mfma_f32_32x32x16_bf16 a[16:31], v[148:151], v[152:155], a[16:31]
    v_mfma_f32_32x32x16_bf16 a[32:47], v[144:147], v[156:159], a[32:47]
    v_mfma_f32_32x32x16_bf16 a[48:63], v[148:151], v[156:159], a[48:63]
    s_branch mega_kernel_qfbd_swr7
mega_kernel_qfbd_sw8:
    v_mfma_f32_32x32x16_bf16 a[0:15], v[32:35], v[40:43], a[0:15]
    v_mfma_f32_32x32x16_bf16 a[16:31], v[36:39], v[40:43], a[16:31]
    v_mfma_f32_32x32x16_bf16 a[32:47], v[32:35], v[44:47], a[32:47]
    v_mfma_f32_32x32x16_bf16 a[48:63], v[36:39], v[44:47], a[48:63]
    v_mfma_f32_32x32x16_bf16 a[0:15], v[48:51], v[56:59], a[0:15]
    v_mfma_f32_32x32x16_bf16 a[16:31], v[52:55], v[56:59], a[16:31]
    v_mfma_f32_32x32x16_bf16 a[32:47], v[48:51], v[60:63], a[32:47]
    v_mfma_f32_32x32x16_bf16 a[48:63], v[52:55], v[60:63], a[48:63]
    v_mfma_f32_32x32x16_bf16 a[0:15], v[64:67], v[72:75], a[0:15]
    v_mfma_f32_32x32x16_bf16 a[16:31], v[68:71], v[72:75], a[16:31]
    v_mfma_f32_32x32x16_bf16 a[32:47], v[64:67], v[76:79], a[32:47]
    v_mfma_f32_32x32x16_bf16 a[48:63], v[68:71], v[76:79], a[48:63]
    v_mfma_f32_32x32x16_bf16 a[0:15], v[80:83], v[88:91], a[0:15]
    v_mfma_f32_32x32x16_bf16 a[16:31], v[84:87], v[88:91], a[16:31]
    v_mfma_f32_32x32x16_bf16 a[32:47], v[80:83], v[92:95], a[32:47]
    v_mfma_f32_32x32x16_bf16 a[48:63], v[84:87], v[92:95], a[48:63]
    s_branch mega_kernel_qfbd_swr8
mega_kernel_qfbd_sw9:
    v_mfma_f32_32x32x16_bf16 a[0:15], v[96:99], v[104:107], a[0:15]
    v_mfma_f32_32x32x16_bf16 a[16:31], v[100:103], v[104:107], a[16:31]
    v_mfma_f32_32x32x16_bf16 a[32:47], v[96:99], v[108:111], a[32:47]
    v_mfma_f32_32x32x16_bf16 a[48:63], v[100:103], v[108:111], a[48:63]
    v_mfma_f32_32x32x16_bf16 a[0:15], v[112:115], v[120:123], a[0:15]
    v_mfma_f32_32x32x16_bf16 a[16:31], v[116:119], v[120:123], a[16:31]
    v_mfma_f32_32x32x16_bf16 a[32:47], v[112:115], v[124:127], a[32:47]
    v_mfma_f32_32x32x16_bf16 a[48:63], v[116:119], v[124:127], a[48:63]
    v_mfma_f32_32x32x16_bf16 a[0:15], v[128:131], v[136:139], a[0:15]
    v_mfma_f32_32x32x16_bf16 a[16:31], v[132:135], v[136:139], a[16:31]
    v_mfma_f32_32x32x16_bf16 a[32:47], v[128:131], v[140:143], a[32:47]
    v_mfma_f32_32x32x16_bf16 a[48:63], v[132:135], v[140:143], a[48:63]
    v_mfma_f32_32x32x16_bf16 a[0:15], v[144:147], v[152:155], a[0:15]
    v_mfma_f32_32x32x16_bf16 a[16:31], v[148:151], v[152:155], a[16:31]
    v_mfma_f32_32x32x16_bf16 a[32:47], v[144:147], v[156:159], a[32:47]
    v_mfma_f32_32x32x16_bf16 a[48:63], v[148:151], v[156:159], a[48:63]
    s_branch mega_kernel_qfbd_swr9
mega_kernel_qfbd_sw10:
    v_mfma_f32_32x32x16_bf16 a[0:15], v[32:35], v[40:43], a[0:15]
    v_mfma_f32_32x32x16_bf16 a[16:31], v[36:39], v[40:43], a[16:31]
    v_mfma_f32_32x32x16_bf16 a[32:47], v[32:35], v[44:47], a[32:47]
    v_mfma_f32_32x32x16_bf16 a[48:63], v[36:39], v[44:47], a[48:63]
    v_mfma_f32_32x32x16_bf16 a[0:15], v[48:51], v[56:59], a[0:15]
    v_mfma_f32_32x32x16_bf16 a[16:31], v[52:55], v[56:59], a[16:31]
    v_mfma_f32_32x32x16_bf16 a[32:47], v[48:51], v[60:63], a[32:47]
    v_mfma_f32_32x32x16_bf16 a[48:63], v[52:55], v[60:63], a[48:63]
    v_mfma_f32_32x32x16_bf16 a[0:15], v[64:67], v[72:75], a[0:15]
    v_mfma_f32_32x32x16_bf16 a[16:31], v[68:71], v[72:75], a[16:31]
    v_mfma_f32_32x32x16_bf16 a[32:47], v[64:67], v[76:79], a[32:47]
    v_mfma_f32_32x32x16_bf16 a[48:63], v[68:71], v[76:79], a[48:63]
    v_mfma_f32_32x32x16_bf16 a[0:15], v[80:83], v[88:91], a[0:15]
    v_mfma_f32_32x32x16_bf16 a[16:31], v[84:87], v[88:91], a[16:31]
    v_mfma_f32_32x32x16_bf16 a[32:47], v[80:83], v[92:95], a[32:47]
    v_mfma_f32_32x32x16_bf16 a[48:63], v[84:87], v[92:95], a[48:63]
    s_branch mega_kernel_qfbd_swr10
mega_kernel_qfbd_sw11:
    v_mfma_f32_32x32x16_bf16 a[0:15], v[96:99], v[104:107], a[0:15]
    v_mfma_f32_32x32x16_bf16 a[16:31], v[100:103], v[104:107], a[16:31]
    v_mfma_f32_32x32x16_bf16 a[32:47], v[96:99], v[108:111], a[32:47]
    v_mfma_f32_32x32x16_bf16 a[48:63], v[100:103], v[108:111], a[48:63]
    v_mfma_f32_32x32x16_bf16 a[0:15], v[112:115], v[120:123], a[0:15]
    v_mfma_f32_32x32x16_bf16 a[16:31], v[116:119], v[120:123], a[16:31]
    v_mfma_f32_32x32x16_bf16 a[32:47], v[112:115], v[124:127], a[32:47]
    v_mfma_f32_32x32x16_bf16 a[48:63], v[116:119], v[124:127], a[48:63]
    v_mfma_f32_32x32x16_bf16 a[0:15], v[128:131], v[136:139], a[0:15]
    v_mfma_f32_32x32x16_bf16 a[16:31], v[132:135], v[136:139], a[16:31]
    v_mfma_f32_32x32x16_bf16 a[32:47], v[128:131], v[140:143], a[32:47]
    v_mfma_f32_32x32x16_bf16 a[48:63], v[132:135], v[140:143], a[48:63]
    v_mfma_f32_32x32x16_bf16 a[0:15], v[144:147], v[152:155], a[0:15]
    v_mfma_f32_32x32x16_bf16 a[16:31], v[148:151], v[152:155], a[16:31]
    v_mfma_f32_32x32x16_bf16 a[32:47], v[144:147], v[156:159], a[32:47]
    v_mfma_f32_32x32x16_bf16 a[48:63], v[148:151], v[156:159], a[48:63]
    s_branch mega_kernel_qfbd_swr11
mega_kernel_qfbd_sw12:
    v_mfma_f32_32x32x16_bf16 a[0:15], v[32:35], v[40:43], a[0:15]
    v_mfma_f32_32x32x16_bf16 a[16:31], v[36:39], v[40:43], a[16:31]
    v_mfma_f32_32x32x16_bf16 a[32:47], v[32:35], v[44:47], a[32:47]
    v_mfma_f32_32x32x16_bf16 a[48:63], v[36:39], v[44:47], a[48:63]
    v_mfma_f32_32x32x16_bf16 a[0:15], v[48:51], v[56:59], a[0:15]
    v_mfma_f32_32x32x16_bf16 a[16:31], v[52:55], v[56:59], a[16:31]
    v_mfma_f32_32x32x16_bf16 a[32:47], v[48:51], v[60:63], a[32:47]
    v_mfma_f32_32x32x16_bf16 a[48:63], v[52:55], v[60:63], a[48:63]
    v_mfma_f32_32x32x16_bf16 a[0:15], v[64:67], v[72:75], a[0:15]
    v_mfma_f32_32x32x16_bf16 a[16:31], v[68:71], v[72:75], a[16:31]
    v_mfma_f32_32x32x16_bf16 a[32:47], v[64:67], v[76:79], a[32:47]
    v_mfma_f32_32x32x16_bf16 a[48:63], v[68:71], v[76:79], a[48:63]
    v_mfma_f32_32x32x16_bf16 a[0:15], v[80:83], v[88:91], a[0:15]
    v_mfma_f32_32x32x16_bf16 a[16:31], v[84:87], v[88:91], a[16:31]
    v_mfma_f32_32x32x16_bf16 a[32:47], v[80:83], v[92:95], a[32:47]
    v_mfma_f32_32x32x16_bf16 a[48:63], v[84:87], v[92:95], a[48:63]
    s_branch mega_kernel_qfbd_swr12
mega_kernel_qfbd_sw13:
    v_mfma_f32_32x32x16_bf16 a[0:15], v[96:99], v[104:107], a[0:15]
    v_mfma_f32_32x32x16_bf16 a[16:31], v[100:103], v[104:107], a[16:31]
    v_mfma_f32_32x32x16_bf16 a[32:47], v[96:99], v[108:111], a[32:47]
    v_mfma_f32_32x32x16_bf16 a[48:63], v[100:103], v[108:111], a[48:63]
    v_mfma_f32_32x32x16_bf16 a[0:15], v[112:115], v[120:123], a[0:15]
    v_mfma_f32_32x32x16_bf16 a[16:31], v[116:119], v[120:123], a[16:31]
    v_mfma_f32_32x32x16_bf16 a[32:47], v[112:115], v[124:127], a[32:47]
    v_mfma_f32_32x32x16_bf16 a[48:63], v[116:119], v[124:127], a[48:63]
    v_mfma_f32_32x32x16_bf16 a[0:15], v[128:131], v[136:139], a[0:15]
    v_mfma_f32_32x32x16_bf16 a[16:31], v[132:135], v[136:139], a[16:31]
    v_mfma_f32_32x32x16_bf16 a[32:47], v[128:131], v[140:143], a[32:47]
    v_mfma_f32_32x32x16_bf16 a[48:63], v[132:135], v[140:143], a[48:63]
    v_mfma_f32_32x32x16_bf16 a[0:15], v[144:147], v[152:155], a[0:15]
    v_mfma_f32_32x32x16_bf16 a[16:31], v[148:151], v[152:155], a[16:31]
    v_mfma_f32_32x32x16_bf16 a[32:47], v[144:147], v[156:159], a[32:47]
    v_mfma_f32_32x32x16_bf16 a[48:63], v[148:151], v[156:159], a[48:63]
    s_branch mega_kernel_qfbd_swr13
mega_kernel_qfbd_sw14:
    v_mfma_f32_32x32x16_bf16 a[0:15], v[32:35], v[40:43], a[0:15]
    v_mfma_f32_32x32x16_bf16 a[16:31], v[36:39], v[40:43], a[16:31]
    v_mfma_f32_32x32x16_bf16 a[32:47], v[32:35], v[44:47], a[32:47]
    v_mfma_f32_32x32x16_bf16 a[48:63], v[36:39], v[44:47], a[48:63]
    v_mfma_f32_32x32x16_bf16 a[0:15], v[48:51], v[56:59], a[0:15]
    v_mfma_f32_32x32x16_bf16 a[16:31], v[52:55], v[56:59], a[16:31]
    v_mfma_f32_32x32x16_bf16 a[32:47], v[48:51], v[60:63], a[32:47]
    v_mfma_f32_32x32x16_bf16 a[48:63], v[52:55], v[60:63], a[48:63]
    v_mfma_f32_32x32x16_bf16 a[0:15], v[64:67], v[72:75], a[0:15]
    v_mfma_f32_32x32x16_bf16 a[16:31], v[68:71], v[72:75], a[16:31]
    v_mfma_f32_32x32x16_bf16 a[32:47], v[64:67], v[76:79], a[32:47]
    v_mfma_f32_32x32x16_bf16 a[48:63], v[68:71], v[76:79], a[48:63]
    v_mfma_f32_32x32x16_bf16 a[0:15], v[80:83], v[88:91], a[0:15]
    v_mfma_f32_32x32x16_bf16 a[16:31], v[84:87], v[88:91], a[16:31]
    v_mfma_f32_32x32x16_bf16 a[32:47], v[80:83], v[92:95], a[32:47]
    v_mfma_f32_32x32x16_bf16 a[48:63], v[84:87], v[92:95], a[48:63]
    s_branch mega_kernel_qfbd_swr14
mega_kernel_qfbd_sw15:
    v_mfma_f32_32x32x16_bf16 a[0:15], v[96:99], v[104:107], a[0:15]
    v_mfma_f32_32x32x16_bf16 a[16:31], v[100:103], v[104:107], a[16:31]
    v_mfma_f32_32x32x16_bf16 a[32:47], v[96:99], v[108:111], a[32:47]
    v_mfma_f32_32x32x16_bf16 a[48:63], v[100:103], v[108:111], a[48:63]
    v_mfma_f32_32x32x16_bf16 a[0:15], v[112:115], v[120:123], a[0:15]
    v_mfma_f32_32x32x16_bf16 a[16:31], v[116:119], v[120:123], a[16:31]
    v_mfma_f32_32x32x16_bf16 a[32:47], v[112:115], v[124:127], a[32:47]
    v_mfma_f32_32x32x16_bf16 a[48:63], v[116:119], v[124:127], a[48:63]
    v_mfma_f32_32x32x16_bf16 a[0:15], v[128:131], v[136:139], a[0:15]
    v_mfma_f32_32x32x16_bf16 a[16:31], v[132:135], v[136:139], a[16:31]
    v_mfma_f32_32x32x16_bf16 a[32:47], v[128:131], v[140:143], a[32:47]
    v_mfma_f32_32x32x16_bf16 a[48:63], v[132:135], v[140:143], a[48:63]
    v_mfma_f32_32x32x16_bf16 a[0:15], v[144:147], v[152:155], a[0:15]
    v_mfma_f32_32x32x16_bf16 a[16:31], v[148:151], v[152:155], a[16:31]
    v_mfma_f32_32x32x16_bf16 a[32:47], v[144:147], v[156:159], a[32:47]
    v_mfma_f32_32x32x16_bf16 a[48:63], v[148:151], v[156:159], a[48:63]
    s_branch mega_kernel_qfbd_swr15
mega_kernel_qfbd_done:
mega_kernel_qfb_epi:
    s_lshr_b32 s47, s46, 1
    s_and_b32 s48, s46, 1
    s_mul_i32 s47, s47, 524288
    s_mul_i32 s48, s48, 4096
    s_add_u32 s47, s47, s48
    s_add_u32 s47, s47, s54
    v_lshlrev_b32 v96, 4, v1
    s_add_u32 s50, s47, 0
    v_accvgpr_read_b32 v98, a0
    v_accvgpr_read_b32 v99, a1
    v_accvgpr_read_b32 v100, a2
    v_accvgpr_read_b32 v101, a3
    v_accvgpr_read_b32 v102, a4
    v_accvgpr_read_b32 v103, a5
    v_accvgpr_read_b32 v104, a6
    v_accvgpr_read_b32 v105, a7
    v_accvgpr_read_b32 v106, a8
    v_accvgpr_read_b32 v107, a9
    v_accvgpr_read_b32 v108, a10
    v_accvgpr_read_b32 v109, a11
    v_accvgpr_read_b32 v110, a12
    v_accvgpr_read_b32 v111, a13
    v_accvgpr_read_b32 v112, a14
    v_accvgpr_read_b32 v113, a15
    v_cvt_pk_bf16_f32 v114, v98, v99
    v_cvt_pk_bf16_f32 v115, v100, v101
    v_cvt_pk_bf16_f32 v116, v102, v103
    v_cvt_pk_bf16_f32 v117, v104, v105
    v_cvt_pk_bf16_f32 v118, v106, v107
    v_cvt_pk_bf16_f32 v119, v108, v109
    v_cvt_pk_bf16_f32 v120, v110, v111
    v_cvt_pk_bf16_f32 v121, v112, v113
    buffer_store_dwordx4 v[114:117], v96, s[32:35], s50 offen offset:0 sc1
    buffer_store_dwordx4 v[118:121], v96, s[32:35], s50 offen offset:1024 sc1
    s_add_u32 s50, s47, 2048
    v_accvgpr_read_b32 v122, a32
    v_accvgpr_read_b32 v123, a33
    v_accvgpr_read_b32 v124, a34
    v_accvgpr_read_b32 v125, a35
    v_accvgpr_read_b32 v126, a36
    v_accvgpr_read_b32 v127, a37
    v_accvgpr_read_b32 v128, a38
    v_accvgpr_read_b32 v129, a39
    v_accvgpr_read_b32 v130, a40
    v_accvgpr_read_b32 v131, a41
    v_accvgpr_read_b32 v132, a42
    v_accvgpr_read_b32 v133, a43
    v_accvgpr_read_b32 v134, a44
    v_accvgpr_read_b32 v135, a45
    v_accvgpr_read_b32 v136, a46
    v_accvgpr_read_b32 v137, a47
    v_cvt_pk_bf16_f32 v138, v122, v123
    v_cvt_pk_bf16_f32 v139, v124, v125
    v_cvt_pk_bf16_f32 v140, v126, v127
    v_cvt_pk_bf16_f32 v141, v128, v129
    v_cvt_pk_bf16_f32 v142, v130, v131
    v_cvt_pk_bf16_f32 v143, v132, v133
    v_cvt_pk_bf16_f32 v144, v134, v135
    v_cvt_pk_bf16_f32 v145, v136, v137
    buffer_store_dwordx4 v[138:141], v96, s[32:35], s50 offen offset:0 sc1
    buffer_store_dwordx4 v[142:145], v96, s[32:35], s50 offen offset:1024 sc1
    s_add_u32 s50, s47, 262144
    v_accvgpr_read_b32 v146, a16
    v_accvgpr_read_b32 v147, a17
    v_accvgpr_read_b32 v148, a18
    v_accvgpr_read_b32 v149, a19
    v_accvgpr_read_b32 v150, a20
    v_accvgpr_read_b32 v151, a21
    v_accvgpr_read_b32 v152, a22
    v_accvgpr_read_b32 v153, a23
    v_accvgpr_read_b32 v154, a24
    v_accvgpr_read_b32 v155, a25
    v_accvgpr_read_b32 v156, a26
    v_accvgpr_read_b32 v157, a27
    v_accvgpr_read_b32 v158, a28
    v_accvgpr_read_b32 v159, a29
    v_accvgpr_read_b32 v160, a30
    v_accvgpr_read_b32 v161, a31
    v_cvt_pk_bf16_f32 v162, v146, v147
    v_cvt_pk_bf16_f32 v163, v148, v149
    v_cvt_pk_bf16_f32 v164, v150, v151
    v_cvt_pk_bf16_f32 v165, v152, v153
    v_cvt_pk_bf16_f32 v166, v154, v155
    v_cvt_pk_bf16_f32 v167, v156, v157
    v_cvt_pk_bf16_f32 v168, v158, v159
    v_cvt_pk_bf16_f32 v169, v160, v161
    buffer_store_dwordx4 v[162:165], v96, s[32:35], s50 offen offset:0 sc1
    buffer_store_dwordx4 v[166:169], v96, s[32:35], s50 offen offset:1024 sc1
    s_add_u32 s50, s47, 264192
    v_accvgpr_read_b32 v98, a48
    v_accvgpr_read_b32 v99, a49
    v_accvgpr_read_b32 v100, a50
    v_accvgpr_read_b32 v101, a51
    v_accvgpr_read_b32 v102, a52
    v_accvgpr_read_b32 v103, a53
    v_accvgpr_read_b32 v104, a54
    v_accvgpr_read_b32 v105, a55
    v_accvgpr_read_b32 v106, a56
    v_accvgpr_read_b32 v107, a57
    v_accvgpr_read_b32 v108, a58
    v_accvgpr_read_b32 v109, a59
    v_accvgpr_read_b32 v110, a60
    v_accvgpr_read_b32 v111, a61
    v_accvgpr_read_b32 v112, a62
    v_accvgpr_read_b32 v113, a63
    v_cvt_pk_bf16_f32 v114, v98, v99
    v_cvt_pk_bf16_f32 v115, v100, v101
    v_cvt_pk_bf16_f32 v116, v102, v103
    v_cvt_pk_bf16_f32 v117, v104, v105
    v_cvt_pk_bf16_f32 v118, v106, v107
    v_cvt_pk_bf16_f32 v119, v108, v109
    v_cvt_pk_bf16_f32 v120, v110, v111
    v_cvt_pk_bf16_f32 v121, v112, v113
    buffer_store_dwordx4 v[114:117], v96, s[32:35], s50 offen offset:0 sc1
    buffer_store_dwordx4 v[118:121], v96, s[32:35], s50 offen offset:1024 sc1
    s_waitcnt vmcnt(0)
    s_barrier
    s_cmp_lg_u32 s46, 0
    s_cbranch_scc1 mega_kernel_qfb_nf
    s_lshl_b32 s18, s85, 10
    s_lshr_b32 s19, s17, 1
    s_lshl_b32 s19, s19, 6
    s_add_u32 s18, s18, s19
    s_lshl_b32 s19, s16, 2
    s_add_u32 s18, s18, s19
    v_mov_b32 v26, 2
    v_mov_b32 v27, 0
    s_mov_b64 exec, 1
    buffer_atomic_add v26, v27, s[56:59], s18 offen sc1
    s_mov_b64 exec, -1
mega_kernel_qfb_nf:
mega_kernel_fdone:
    s_lshr_b32 s47, s46, 1
    s_and_b32 s48, s46, 1
    v_and_b32 v26, 31, v1
    s_mul_i32 s49, s47, 64
    v_add_u32 v26, s49, v26
    v_lshrrev_b32 v27, 1, v26
    v_and_b32 v27, 7, v27
    v_lshrrev_b32 v28, 5, v1
    v_lshlrev_b32 v29, 7, v26
    v_add_u32 v30, 0, v28
    v_xor_b32 v30, v30, v27
    v_lshl_add_u32 v2, v30, 4, v29
    v_add_u32 v30, 2, v28
    v_xor_b32 v30, v30, v27
    v_lshl_add_u32 v3, v30, 4, v29
    v_add_u32 v30, 4, v28
    v_xor_b32 v30, v30, v27
    v_lshl_add_u32 v4, v30, 4, v29
    v_add_u32 v30, 6, v28
    v_xor_b32 v30, v30, v27
    v_lshl_add_u32 v5, v30, 4, v29
    v_lshrrev_b32 v26, 2, v1
    v_and_b32 v26, 3, v26
    v_lshrrev_b32 v27, 5, v1
    v_lshl_add_u32 v27, v27, 3, v26
    v_mul_u32_u24 v27, 512, v27
    v_lshrrev_b32 v28, 4, v1
    v_and_b32 v28, 1, v28
    v_lshlrev_b32 v28, 5, v28
    v_and_b32 v29, 3, v1
    v_lshl_add_u32 v28, v29, 3, v28
    v_add_u32 v27, v27, v28
    s_mul_i32 s49, s48, 4
    s_add_u32 s49, s49, 0
    v_xor_b32 v29, s49, v26
    v_lshlrev_b32 v29, 6, v29
    v_add_u32 v29, v29, v27
    v_add_u32 v6, 16384, v29
    s_mul_i32 s49, s48, 4
    s_add_u32 s49, s49, 1
    v_xor_b32 v29, s49, v26
    v_lshlrev_b32 v29, 6, v29
    v_add_u32 v29, v29, v27
    v_add_u32 v7, 16384, v29
    s_mul_i32 s49, s48, 4
    s_add_u32 s49, s49, 2
    v_xor_b32 v29, s49, v26
    v_lshlrev_b32 v29, 6, v29
    v_add_u32 v29, v29, v27
    v_add_u32 v8, 16384, v29
    s_mul_i32 s49, s48, 4
    s_add_u32 s49, s49, 3
    v_xor_b32 v29, s49, v26
    v_lshlrev_b32 v29, 6, v29
    v_add_u32 v29, v29, v27
    v_add_u32 v9, 16384, v29
    v_lshrrev_b32 v26, 3, v1
    s_mul_i32 s49, s46, 32
    v_add_u32 v26, s49, v26
    v_and_b32 v27, 7, v1
    s_mov_b32 s50, 2048
    v_add_u32 v28, 0, v26
    v_lshrrev_b32 v29, 1, v28
    v_and_b32 v29, 7, v29
    v_xor_b32 v29, v29, v27
    v_lshlrev_b32 v29, 4, v29
    v_mul_lo_u32 v28, v28, s50
    v_add_u32 v10, v28, v29
    v_add_u32 v28, 8, v26
    v_lshrrev_b32 v29, 1, v28
    v_and_b32 v29, 7, v29
    v_xor_b32 v29, v29, v27
    v_lshlrev_b32 v29, 4, v29
    v_mul_lo_u32 v28, v28, s50
    v_add_u32 v11, v28, v29
    v_add_u32 v28, 16, v26
    v_lshrrev_b32 v29, 1, v28
    v_and_b32 v29, 7, v29
    v_xor_b32 v29, v29, v27
    v_lshlrev_b32 v29, 4, v29
    v_mul_lo_u32 v28, v28, s50
    v_add_u32 v12, v28, v29
    v_add_u32 v28, 24, v26
    v_lshrrev_b32 v29, 1, v28
    v_and_b32 v29, 7, v29
    v_xor_b32 v29, v29, v27
    v_lshlrev_b32 v29, 4, v29
    v_mul_lo_u32 v28, v28, s50
    v_add_u32 v13, v28, v29
    v_lshrrev_b32 v26, 5, v1
    s_mul_i32 s49, s46, 16
    v_add_u32 v26, s49, v26
    v_and_b32 v27, 31, v1
    s_mov_b32 s50, 8192
    v_add_u32 v28, 0, v26
    v_and_b32 v29, 3, v28
    v_lshlrev_b32 v29, 2, v29
    v_xor_b32 v29, v29, v27
    v_lshlrev_b32 v29, 4, v29
    v_mul_lo_u32 v28, v28, s50
    v_add_u32 v18, v28, v29
    v_add_u32 v28, 2, v26
    v_and_b32 v29, 3, v28
    v_lshlrev_b32 v29, 2, v29
    v_xor_b32 v29, v29, v27
    v_lshlrev_b32 v29, 4, v29
    v_mul_lo_u32 v28, v28, s50
    v_add_u32 v19, v28, v29
    v_add_u32 v28, 4, v26
    v_and_b32 v29, 3, v28
    v_lshlrev_b32 v29, 2, v29
    v_xor_b32 v29, v29, v27
    v_lshlrev_b32 v29, 4, v29
    v_mul_lo_u32 v28, v28, s50
    v_add_u32 v20, v28, v29
    v_add_u32 v28, 6, v26
    v_and_b32 v29, 3, v28
    v_lshlrev_b32 v29, 2, v29
    v_xor_b32 v29, v29, v27
    v_lshlrev_b32 v29, 4, v29
    v_mul_lo_u32 v28, v28, s50
    v_add_u32 v21, v28, v29
    v_add_u32 v28, 8, v26
    v_and_b32 v29, 3, v28
    v_lshlrev_b32 v29, 2, v29
    v_xor_b32 v29, v29, v27
    v_lshlrev_b32 v29, 4, v29
    v_mul_lo_u32 v28, v28, s50
    v_add_u32 v22, v28, v29
    v_add_u32 v28, 10, v26
    v_and_b32 v29, 3, v28
    v_lshlrev_b32 v29, 2, v29
    v_xor_b32 v29, v29, v27
    v_lshlrev_b32 v29, 4, v29
    v_mul_lo_u32 v28, v28, s50
    v_add_u32 v23, v28, v29
    v_add_u32 v28, 12, v26
    v_and_b32 v29, 3, v28
    v_lshlrev_b32 v29, 2, v29
    v_xor_b32 v29, v29, v27
    v_lshlrev_b32 v29, 4, v29
    v_mul_lo_u32 v28, v28, s50
    v_add_u32 v24, v28, v29
    v_add_u32 v28, 14, v26
    v_and_b32 v29, 3, v28
    v_lshlrev_b32 v29, 2, v29
    v_xor_b32 v29, v29, v27
    v_lshlrev_b32 v29, 4, v29
    v_mul_lo_u32 v28, v28, s50
    v_add_u32 v25, v28, v29
    s_sub_u32 s17, s61, 64
    s_lshr_b32 s63, s17, 2
mega_kernel_qloop:
    s_and_b32 s19, s61, 3
    s_cmp_lt_u32 s63, 8
    s_cbranch_scc0 mega_kernel_qb
    s_lshl_b32 s18, s63, 1
    s_lshr_b32 s17, s19, 1
    s_add_u32 s18, s18, s17
    s_add_u32 s15, s18, 32
    s_and_b32 s14, s19, 1
    s_branch mega_kernel_qgo
mega_kernel_qb:
    s_cmp_lt_u32 s63, 104
    s_cbranch_scc0 mega_kernel_qc
    s_sub_u32 s17, s63, 8
    s_mul_i32 s18, s17, 1366
    s_lshr_b32 s18, s18, 16
    s_mul_i32 s13, s18, 48
    s_sub_u32 s15, s17, s13
    s_lshl_b32 s18, s18, 2
    s_add_u32 s18, s18, s19
    s_add_u32 s14, s18, 2
    s_branch mega_kernel_qgo
mega_kernel_qc:
    s_sub_u32 s17, s63, 104
    s_mul_i32 s13, s17, 2731
    s_lshr_b32 s13, s13, 16
    s_mul_i32 s18, s13, 24
    s_sub_u32 s17, s17, s18
    s_lshl_b32 s18, s17, 1
    s_lshr_b32 s17, s19, 1
    s_add_u32 s15, s18, s17
    s_and_b32 s19, s19, 1
    s_lshl_b32 s13, s13, 1
    s_add_u32 s19, s19, s13
    s_add_u32 s14, s19, 10
mega_kernel_qgo:
    s_lshr_b32 s16, s15, 4
    s_and_b32 s17, s15, 15
    s_cmp_eq_u32 s16, 1
    s_cselect_b32 s12, s8, s6
    s_cselect_b32 s13, s9, s7
    s_cmp_eq_u32 s16, 2
    s_cselect_b32 s12, s10, s12
    s_cselect_b32 s13, s11, s13
    s_mov_b32 s24, s12
    s_mov_b32 s25, s13
    s_mov_b32 s26, 8388608
    s_mov_b32 s27, 0x20000
    s_mul_i32 s40, s14, 262144
    s_mul_i32 s41, s17, 512
    s_mul_i32 s54, s16, 16777216
    s_mul_i32 s18, s14, 1048576
    s_add_u32 s54, s54, s18
    s_mul_i32 s18, s17, 16384
    s_add_u32 s54, s54, s18
    s_lshl_b32 s19, s14, 5
    v_and_b32 v26, 31, v1
    v_add_u32 v26, s19, v26
    v_lshlrev_b32 v26, 4, v26
    v_add_u32 v26, 540672, v26
    s_mov_b32 s12, 131072
mega_kernel_q0_lw:
    buffer_load_dword v27, v26, s[56:59], 0 offen sc1
    s_waitcnt vmcnt(0)
    v_cmp_eq_u32 vcc, 0, v27
    s_cbranch_vccz mega_kernel_q0_lw_ok
    s_cmp_eq_u32 s12, 0
    s_cbranch_scc1 mega_kernel_q0_lw_ok
    s_sub_u32 s12, s12, 1
    s_sleep 1
    s_branch mega_kernel_q0_lw
mega_kernel_q0_lw_ok:
    s_cmp_eq_u32 s16, 1
    s_cbranch_scc1 mega_kernel_q0_v
    s_mul_i32 s42, s46, 4096
    s_mul_i32 s43, s46, 8192
    s_add_u32 s43, s43, 16384
    s_mov_b32 s45, 49152
    s_mov_b32 s52, 49152
    s_add_u32 m0, s42, 0
    s_nop 0
    buffer_load_dwordx4 v10, s[20:23], s40 offen lds
    s_add_u32 m0, s42, 1024
    s_nop 0
    buffer_load_dwordx4 v11, s[20:23], s40 offen lds
    s_add_u32 m0, s42, 2048
    s_nop 0
    buffer_load_dwordx4 v12, s[20:23], s40 offen lds
    s_add_u32 m0, s42, 3072
    s_nop 0
    buffer_load_dwordx4 v13, s[20:23], s40 offen lds
    s_add_u32 m0, s43, 0
    s_nop 0
    buffer_load_dwordx4 v18, s[24:27], s41 offen lds
    s_add_u32 m0, s43, 1024
    s_nop 0
    buffer_load_dwordx4 v19, s[24:27], s41 offen lds
    s_add_u32 m0, s43, 2048
    s_nop 0
    buffer_load_dwordx4 v20, s[24:27], s41 offen lds
    s_add_u32 m0, s43, 3072
    s_nop 0
    buffer_load_dwordx4 v21, s[24:27], s41 offen lds
    s_add_u32 m0, s43, 4096
    s_nop 0
    buffer_load_dwordx4 v22, s[24:27], s41 offen lds
    s_add_u32 m0, s43, 5120
    s_nop 0
    buffer_load_dwordx4 v23, s[24:27], s41 offen lds
    s_add_u32 m0, s43, 6144
    s_nop 0
    buffer_load_dwordx4 v24, s[24:27], s41 offen lds
    s_add_u32 m0, s43, 7168
    s_nop 0
    buffer_load_dwordx4 v25, s[24:27], s41 offen lds
    s_add_u32 s40, s40, 128
    s_add_u32 s41, s41, 524288
    s_add_u32 s42, s42, s45
    s_add_u32 s43, s43, s45
    s_sub_u32 s45, 0, s45
    s_add_u32 m0, s42, 0
    s_nop 0
    buffer_load_dwordx4 v10, s[20:23], s40 offen lds
    s_add_u32 m0, s42, 1024
    s_nop 0
    buffer_load_dwordx4 v11, s[20:23], s40 offen lds
    s_add_u32 m0, s42, 2048
    s_nop 0
    buffer_load_dwordx4 v12, s[20:23], s40 offen lds
    s_add_u32 m0, s42, 3072
    s_nop 0
    buffer_load_dwordx4 v13, s[20:23], s40 offen lds
    s_add_u32 m0, s43, 0
    s_nop 0
    buffer_load_dwordx4 v18, s[24:27], s41 offen lds
    s_add_u32 m0, s43, 1024
    s_nop 0
    buffer_load_dwordx4 v19, s[24:27], s41 offen lds
    s_add_u32 m0, s43, 2048
    s_nop 0
    buffer_load_dwordx4 v20, s[24:27], s41 offen lds
    s_add_u32 m0, s43, 3072
    s_nop 0
    buffer_load_dwordx4 v21, s[24:27], s41 offen lds
    s_add_u32 m0, s43, 4096
    s_nop 0
    buffer_load_dwordx4 v22, s[24:27], s41 offen lds
    s_add_u32 m0, s43, 5120
    s_nop 0
    buffer_load_dwordx4 v23, s[24:27], s41 offen lds
    s_add_u32 m0, s43, 6144
    s_nop 0
    buffer_load_dwordx4 v24, s[24:27], s41 offen lds
    s_add_u32 m0, s43, 7168
    s_nop 0
    buffer_load_dwordx4 v25, s[24:27], s41 offen lds
    s_add_u32 s40, s40, 128
    s_add_u32 s41, s41, 524288
    s_add_u32 s42, s42, s45
    s_add_u32 s43, s43, s45
    s_sub_u32 s45, 0, s45
    s_waitcnt vmcnt(12)
    s_barrier
    ds_read_b64_tr_b16 v[64:65], v6 offset:0
    ds_read_b64_tr_b16 v[66:67], v6 offset:2048
    ds_read_b128 v[32:35], v2 offset:0
    ds_read_b128 v[36:39], v2 offset:4096
    ds_read_b64_tr_b16 v[68:69], v7 offset:0
    ds_read_b64_tr_b16 v[70:71], v7 offset:2048
    ds_read_b64_tr_b16 v[72:73], v8 offset:0
    ds_read_b64_tr_b16 v[74:75], v8 offset:2048
    ds_read_b64_tr_b16 v[76:77], v9 offset:0
    ds_read_b64_tr_b16 v[78:79], v9 offset:2048
    s_waitcnt lgkmcnt(0)
    v_mfma_f32_32x32x16_bf16 a[0:15], v[64:67], v[32:35], 0
    ds_read_b64_tr_b16 v[80:81], v6 offset:8192
    ds_read_b64_tr_b16 v[82:83], v6 offset:10240
    v_mfma_f32_32x32x16_bf16 a[16:31], v[64:67], v[36:39], 0
    ds_read_b128 v[48:51], v3 offset:0
    v_mfma_f32_32x32x16_bf16 a[32:47], v[68:71], v[32:35], 0
    ds_read_b128 v[52:55], v3 offset:4096
    v_mfma_f32_32x32x16_bf16 a[48:63], v[68:71], v[36:39], 0
    ds_read_b64_tr_b16 v[84:85], v7 offset:8192
    v_mfma_f32_32x32x16_bf16 a[64:79], v[72:75], v[32:35], 0
    ds_read_b64_tr_b16 v[86:87], v7 offset:10240
    ds_read_b64_tr_b16 v[88:89], v8 offset:8192
    v_mfma_f32_32x32x16_bf16 a[80:95], v[72:75], v[36:39], 0
    ds_read_b64_tr_b16 v[90:91], v8 offset:10240
    v_mfma_f32_32x32x16_bf16 a[96:111], v[76:79], v[32:35], 0
    ds_read_b64_tr_b16 v[92:93], v9 offset:8192
    v_mfma_f32_32x32x16_bf16 a[112:127], v[76:79], v[36:39], 0
    ds_read_b64_tr_b16 v[94:95], v9 offset:10240
    s_waitcnt lgkmcnt(0)
    v_mfma_f32_32x32x16_bf16 a[0:15], v[80:83], v[48:51], a[0:15]
    ds_read_b64_tr_b16 v[64:65], v6 offset:16384
    ds_read_b64_tr_b16 v[66:67], v6 offset:18432
    v_mfma_f32_32x32x16_bf16 a[16:31], v[80:83], v[52:55], a[16:31]
    ds_read_b128 v[32:35], v4 offset:0
    v_mfma_f32_32x32x16_bf16 a[32:47], v[84:87], v[48:51], a[32:47]
    ds_read_b128 v[36:39], v4 offset:4096
    v_mfma_f32_32x32x16_bf16 a[48:63], v[84:87], v[52:55], a[48:63]
    ds_read_b64_tr_b16 v[68:69], v7 offset:16384
    v_mfma_f32_32x32x16_bf16 a[64:79], v[88:91], v[48:51], a[64:79]
    ds_read_b64_tr_b16 v[70:71], v7 offset:18432
    ds_read_b64_tr_b16 v[72:73], v8 offset:16384
    v_mfma_f32_32x32x16_bf16 a[80:95], v[88:91], v[52:55], a[80:95]
    ds_read_b64_tr_b16 v[74:75], v8 offset:18432
    v_mfma_f32_32x32x16_bf16 a[96:111], v[92:95], v[48:51], a[96:111]
    ds_read_b64_tr_b16 v[76:77], v9 offset:16384
    v_mfma_f32_32x32x16_bf16 a[112:127], v[92:95], v[52:55], a[112:127]
    ds_read_b64_tr_b16 v[78:79], v9 offset:18432
    s_waitcnt lgkmcnt(0)
    v_mfma_f32_32x32x16_bf16 a[0:15], v[64:67], v[32:35], a[0:15]
    ds_read_b64_tr_b16 v[80:81], v6 offset:24576
    ds_read_b64_tr_b16 v[82:83], v6 offset:26624
    v_mfma_f32_32x32x16_bf16 a[16:31], v[64:67], v[36:39], a[16:31]
    ds_read_b128 v[48:51], v5 offset:0
    v_mfma_f32_32x32x16_bf16 a[32:47], v[68:71], v[32:35], a[32:47]
    ds_read_b128 v[52:55], v5 offset:4096
    ds_read_b64_tr_b16 v[84:85], v7 offset:24576
    v_mfma_f32_32x32x16_bf16 a[48:63], v[68:71], v[36:39], a[48:63]
    ds_read_b64_tr_b16 v[86:87], v7 offset:26624
    v_mfma_f32_32x32x16_bf16 a[64:79], v[72:75], v[32:35], a[64:79]
    ds_read_b64_tr_b16 v[88:89], v8 offset:24576
    v_mfma_f32_32x32x16_bf16 a[80:95], v[72:75], v[36:39], a[80:95]
    ds_read_b64_tr_b16 v[90:91], v8 offset:26624
    ds_read_b64_tr_b16 v[92:93], v9 offset:24576
    v_mfma_f32_32x32x16_bf16 a[96:111], v[76:79], v[32:35], a[96:111]
    ds_read_b64_tr_b16 v[94:95], v9 offset:26624
    v_mfma_f32_32x32x16_bf16 a[112:127], v[76:79], v[36:39], a[112:127]
    v_add_u32 v2, s52, v2
    v_add_u32 v3, s52, v3
    v_add_u32 v4, s52, v4
    v_add_u32 v5, s52, v5
    v_add_u32 v6, s52, v6
    v_add_u32 v7, s52, v7
    v_add_u32 v8, s52, v8
    v_add_u32 v9, s52, v9
    s_sub_u32 s52, 0, s52
    s_waitcnt vmcnt(0) lgkmcnt(0)
    v_mfma_f32_32x32x16_bf16 a[0:15], v[80:83], v[48:51], a[0:15]
    s_barrier
    v_mfma_f32_32x32x16_bf16 a[16:31], v[80:83], v[52:55], a[16:31]
    ds_read_b64_tr_b16 v[64:65], v6 offset:0
    s_add_u32 m0, s42, 0
    s_nop 0
    buffer_load_dwordx4 v10, s[20:23], s40 offen lds
    ds_read_b64_tr_b16 v[66:67], v6 offset:2048
    v_mfma_f32_32x32x16_bf16 a[32:47], v[84:87], v[48:51], a[32:47]
    s_add_u32 m0, s42, 1024
    s_nop 0
    buffer_load_dwordx4 v11, s[20:23], s40 offen lds
    ds_read_b128 v[32:35], v2 offset:0
    v_mfma_f32_32x32x16_bf16 a[48:63], v[84:87], v[52:55], a[48:63]
    ds_read_b128 v[36:39], v2 offset:4096
    s_add_u32 m0, s43, 0
    s_nop 0
    buffer_load_dwordx4 v18, s[24:27], s41 offen lds
    v_mfma_f32_32x32x16_bf16 a[64:79], v[88:91], v[48:51], a[64:79]
    ds_read_b64_tr_b16 v[68:69], v7 offset:0
    ds_read_b64_tr_b16 v[70:71], v7 offset:2048
    s_add_u32 m0, s43, 1024
    s_nop 0
    buffer_load_dwordx4 v19, s[24:27], s41 offen lds
    v_mfma_f32_32x32x16_bf16 a[80:95], v[88:91], v[52:55], a[80:95]
    ds_read_b64_tr_b16 v[72:73], v8 offset:0
    s_add_u32 m0, s43, 2048
    s_nop 0
    buffer_load_dwordx4 v20, s[24:27], s41 offen lds
    v_mfma_f32_32x32x16_bf16 a[96:111], v[92:95], v[48:51], a[96:111]
    ds_read_b64_tr_b16 v[74:75], v8 offset:2048
    ds_read_b64_tr_b16 v[76:77], v9 offset:0
    v_mfma_f32_32x32x16_bf16 a[112:127], v[92:95], v[52:55], a[112:127]
    s_add_u32 m0, s43, 3072
    s_nop 0
    buffer_load_dwordx4 v21, s[24:27], s41 offen lds
    ds_read_b64_tr_b16 v[78:79], v9 offset:2048
    s_mov_b32 s44, 13
mega_kernel_q0n_loop:
    s_waitcnt lgkmcnt(0)
    v_mfma_f32_32x32x16_bf16 a[0:15], v[64:67], v[32:35], a[0:15]
    ds_read_b64_tr_b16 v[80:81], v6 offset:8192
    s_add_u32 m0, s42, 2048
    s_nop 0
    buffer_load_dwordx4 v12, s[20:23], s40 offen lds
    ds_read_b64_tr_b16 v[82:83], v6 offset:10240
    v_mfma_f32_32x32x16_bf16 a[16:31], v[64:67], v[36:39], a[16:31]
    s_add_u32 m0, s42, 3072
    s_nop 0
    buffer_load_dwordx4 v13, s[20:23], s40 offen lds
    ds_read_b128 v[48:51], v3 offset:0
    v_mfma_f32_32x32x16_bf16 a[32:47], v[68:71], v[32:35], a[32:47]
    ds_read_b128 v[52:55], v3 offset:4096
    s_add_u32 m0, s43, 4096
    s_nop 0
    buffer_load_dwordx4 v22, s[24:27], s41 offen lds
    v_mfma_f32_32x32x16_bf16 a[48:63], v[68:71], v[36:39], a[48:63]
    ds_read_b64_tr_b16 v[84:85], v7 offset:8192
    ds_read_b64_tr_b16 v[86:87], v7 offset:10240
    v_mfma_f32_32x32x16_bf16 a[64:79], v[72:75], v[32:35], a[64:79]
    s_add_u32 m0, s43, 5120
    s_nop 0
    buffer_load_dwordx4 v23, s[24:27], s41 offen lds
    ds_read_b64_tr_b16 v[88:89], v8 offset:8192
    v_mfma_f32_32x32x16_bf16 a[80:95], v[72:75], v[36:39], a[80:95]
    s_add_u32 m0, s43, 6144
    s_nop 0
    buffer_load_dwordx4 v24, s[24:27], s41 offen lds
    ds_read_b64_tr_b16 v[90:91], v8 offset:10240
    v_mfma_f32_32x32x16_bf16 a[96:111], v[76:79], v[32:35], a[96:111]
    ds_read_b64_tr_b16 v[92:93], v9 offset:8192
    s_add_u32 m0, s43, 7168
    s_nop 0
    buffer_load_dwordx4 v25, s[24:27], s41 offen lds
    v_mfma_f32_32x32x16_bf16 a[112:127], v[76:79], v[36:39], a[112:127]
    ds_read_b64_tr_b16 v[94:95], v9 offset:10240
    s_add_u32 s40, s40, 128
    s_add_u32 s41, s41, 524288
    s_add_u32 s42, s42, s45
    s_add_u32 s43, s43, s45
    s_sub_u32 s45, 0, s45
    s_waitcnt lgkmcnt(0)
    v_mfma_f32_32x32x16_bf16 a[0:15], v[80:83], v[48:51], a[0:15]
    ds_read_b64_tr_b16 v[64:65], v6 offset:16384
    ds_read_b64_tr_b16 v[66:67], v6 offset:18432
    v_mfma_f32_32x32x16_bf16 a[16:31], v[80:83], v[52:55], a[16:31]
    ds_read_b128 v[32:35], v4 offset:0
    v_mfma_f32_32x32x16_bf16 a[32:47], v[84:87], v[48:51], a[32:47]
    ds_read_b128 v[36:39], v4 offset:4096
    v_mfma_f32_32x32x16_bf16 a[48:63], v[84:87], v[52:55], a[48:63]
    ds_read_b64_tr_b16 v[68:69], v7 offset:16384
    v_mfma_f32_32x32x16_bf16 a[64:79], v[88:91], v[48:51], a[64:79]
    ds_read_b64_tr_b16 v[70:71], v7 offset:18432
    ds_read_b64_tr_b16 v[72:73], v8 offset:16384
    v_mfma_f32_32x32x16_bf16 a[80:95], v[88:91], v[52:55], a[80:95]
    ds_read_b64_tr_b16 v[74:75], v8 offset:18432
    v_mfma_f32_32x32x16_bf16 a[96:111], v[92:95], v[48:51], a[96:111]
    ds_read_b64_tr_b16 v[76:77], v9 offset:16384
    v_mfma_f32_32x32x16_bf16 a[112:127], v[92:95], v[52:55], a[112:127]
    ds_read_b64_tr_b16 v[78:79], v9 offset:18432
    s_waitcnt lgkmcnt(0)
    v_mfma_f32_32x32x16_bf16 a[0:15], v[64:67], v[32:35], a[0:15]
    ds_read_b64_tr_b16 v[80:81], v6 offset:24576
    ds_read_b64_tr_b16 v[82:83], v6 offset:26624
    v_mfma_f32_32x32x16_bf16 a[16:31], v[64:67], v[36:39], a[16:31]
    ds_read_b128 v[48:51], v5 offset:0
    v_mfma_f32_32x32x16_bf16 a[32:47], v[68:71], v[32:35], a[32:47]
    ds_read_b128 v[52:55], v5 offset:4096
    ds_read_b64_tr_b16 v[84:85], v7 offset:24576
    v_mfma_f32_32x32x16_bf16 a[48:63], v[68:71], v[36:39], a[48:63]
    ds_read_b64_tr_b16 v[86:87], v7 offset:26624
    v_mfma_f32_32x32x16_bf16 a[64:79], v[72:75], v[32:35], a[64:79]
    ds_read_b64_tr_b16 v[88:89], v8 offset:24576
    v_mfma_f32_32x32x16_bf16 a[80:95], v[72:75], v[36:39], a[80:95]
    ds_read_b64_tr_b16 v[90:91], v8 offset:26624
    ds_read_b64_tr_b16 v[92:93], v9 offset:24576
    v_mfma_f32_32x32x16_bf16 a[96:111], v[76:79], v[32:35], a[96:111]
    ds_read_b64_tr_b16 v[94:95], v9 offset:26624
    v_mfma_f32_32x32x16_bf16 a[112:127], v[76:79], v[36:39], a[112:127]
    v_add_u32 v2, s52, v2
    v_add_u32 v3, s52, v3
    v_add_u32 v4, s52, v4
    v_add_u32 v5, s52, v5
    v_add_u32 v6, s52, v6
    v_add_u32 v7, s52, v7
    v_add_u32 v8, s52, v8
    v_add_u32 v9, s52, v9
    s_sub_u32 s52, 0, s52
    s_waitcnt vmcnt(0) lgkmcnt(0)
    v_mfma_f32_32x32x16_bf16 a[0:15], v[80:83], v[48:51], a[0:15]
    s_barrier
    v_mfma_f32_32x32x16_bf16 a[16:31], v[80:83], v[52:55], a[16:31]
    ds_read_b64_tr_b16 v[64:65], v6 offset:0
    s_add_u32 m0, s42, 0
    s_nop 0
    buffer_load_dwordx4 v10, s[20:23], s40 offen lds
    ds_read_b64_tr_b16 v[66:67], v6 offset:2048
    v_mfma_f32_32x32x16_bf16 a[32:47], v[84:87], v[48:51], a[32:47]
    s_add_u32 m0, s42, 1024
    s_nop 0
    buffer_load_dwordx4 v11, s[20:23], s40 offen lds
    ds_read_b128 v[32:35], v2 offset:0
    v_mfma_f32_32x32x16_bf16 a[48:63], v[84:87], v[52:55], a[48:63]
    ds_read_b128 v[36:39], v2 offset:4096
    s_add_u32 m0, s43, 0
    s_nop 0
    buffer_load_dwordx4 v18, s[24:27], s41 offen lds
    v_mfma_f32_32x32x16_bf16 a[64:79], v[88:91], v[48:51], a[64:79]
    ds_read_b64_tr_b16 v[68:69], v7 offset:0
    ds_read_b64_tr_b16 v[70:71], v7 offset:2048
    s_add_u32 m0, s43, 1024
    s_nop 0
    buffer_load_dwordx4 v19, s[24:27], s41 offen lds
    v_mfma_f32_32x32x16_bf16 a[80:95], v[88:91], v[52:55], a[80:95]
    ds_read_b64_tr_b16 v[72:73], v8 offset:0
    s_add_u32 m0, s43, 2048
    s_nop 0
    buffer_load_dwordx4 v20, s[24:27], s41 offen lds
    v_mfma_f32_32x32x16_bf16 a[96:111], v[92:95], v[48:51], a[96:111]
    ds_read_b64_tr_b16 v[74:75], v8 offset:2048
    ds_read_b64_tr_b16 v[76:77], v9 offset:0
    v_mfma_f32_32x32x16_bf16 a[112:127], v[92:95], v[52:55], a[112:127]
    s_add_u32 m0, s43, 3072
    s_nop 0
    buffer_load_dwordx4 v21, s[24:27], s41 offen lds
    ds_read_b64_tr_b16 v[78:79], v9 offset:2048
    s_sub_u32 s44, s44, 1
    s_cmp_lg_u32 s44, 0
    s_cbranch_scc1 mega_kernel_q0n_loop
    s_waitcnt lgkmcnt(0)
    v_mfma_f32_32x32x16_bf16 a[0:15], v[64:67], v[32:35], a[0:15]
    ds_read_b64_tr_b16 v[80:81], v6 offset:8192
    s_add_u32 m0, s42, 2048
    s_nop 0
    buffer_load_dwordx4 v12, s[20:23], s40 offen lds
    ds_read_b64_tr_b16 v[82:83], v6 offset:10240
    v_mfma_f32_32x32x16_bf16 a[16:31], v[64:67], v[36:39], a[16:31]
    s_add_u32 m0, s42, 3072
    s_nop 0
    buffer_load_dwordx4 v13, s[20:23], s40 offen lds
    ds_read_b128 v[48:51], v3 offset:0
    v_mfma_f32_32x32x16_bf16 a[32:47], v[68:71], v[32:35], a[32:47]
    ds_read_b128 v[52:55], v3 offset:4096
    s_add_u32 m0, s43, 4096
    s_nop 0
    buffer_load_dwordx4 v22, s[24:27], s41 offen lds
    v_mfma_f32_32x32x16_bf16 a[48:63], v[68:71], v[36:39], a[48:63]
    ds_read_b64_tr_b16 v[84:85], v7 offset:8192
    ds_read_b64_tr_b16 v[86:87], v7 offset:10240
    v_mfma_f32_32x32x16_bf16 a[64:79], v[72:75], v[32:35], a[64:79]
    s_add_u32 m0, s43, 5120
    s_nop 0
    buffer_load_dwordx4 v23, s[24:27], s41 offen lds
    ds_read_b64_tr_b16 v[88:89], v8 offset:8192
    v_mfma_f32_32x32x16_bf16 a[80:95], v[72:75], v[36:39], a[80:95]
    s_add_u32 m0, s43, 6144
    s_nop 0
    buffer_load_dwordx4 v24, s[24:27], s41 offen lds
    ds_read_b64_tr_b16 v[90:91], v8 offset:10240
    v_mfma_f32_32x32x16_bf16 a[96:111], v[76:79], v[32:35], a[96:111]
    ds_read_b64_tr_b16 v[92:93], v9 offset:8192
    s_add_u32 m0, s43, 7168
    s_nop 0
    buffer_load_dwordx4 v25, s[24:27], s41 offen lds
    v_mfma_f32_32x32x16_bf16 a[112:127], v[76:79], v[36:39], a[112:127]
    ds_read_b64_tr_b16 v[94:95], v9 offset:10240
    s_add_u32 s40, s40, 128
    s_add_u32 s41, s41, 524288
    s_add_u32 s42, s42, s45
    s_add_u32 s43, s43, s45
    s_sub_u32 s45, 0, s45
    s_waitcnt lgkmcnt(0)
    v_mfma_f32_32x32x16_bf16 a[0:15], v[80:83], v[48:51], a[0:15]
    ds_read_b64_tr_b16 v[64:65], v6 offset:16384
    ds_read_b64_tr_b16 v[66:67], v6 offset:18432
    v_mfma_f32_32x32x16_bf16 a[16:31], v[80:83], v[52:55], a[16:31]
    ds_read_b128 v[32:35], v4 offset:0
    v_mfma_f32_32x32x16_bf16 a[32:47], v[84:87], v[48:51], a[32:47]
    ds_read_b128 v[36:39], v4 offset:4096
    v_mfma_f32_32x32x16_bf16 a[48:63], v[84:87], v[52:55], a[48:63]
    ds_read_b64_tr_b16 v[68:69], v7 offset:16384
    v_mfma_f32_32x32x16_bf16 a[64:79], v[88:91], v[48:51], a[64:79]
    ds_read_b64_tr_b16 v[70:71], v7 offset:18432
    ds_read_b64_tr_b16 v[72:73], v8 offset:16384
    v_mfma_f32_32x32x16_bf16 a[80:95], v[88:91], v[52:55], a[80:95]
    ds_read_b64_tr_b16 v[74:75], v8 offset:18432
    v_mfma_f32_32x32x16_bf16 a[96:111], v[92:95], v[48:51], a[96:111]
    ds_read_b64_tr_b16 v[76:77], v9 offset:16384
    v_mfma_f32_32x32x16_bf16 a[112:127], v[92:95], v[52:55], a[112:127]
    ds_read_b64_tr_b16 v[78:79], v9 offset:18432
    s_waitcnt lgkmcnt(0)
    v_mfma_f32_32x32x16_bf16 a[0:15], v[64:67], v[32:35], a[0:15]
    ds_read_b64_tr_b16 v[80:81], v6 offset:24576
    ds_read_b64_tr_b16 v[82:83], v6 offset:26624
    v_mfma_f32_32x32x16_bf16 a[16:31], v[64:67], v[36:39], a[16:31]
    ds_read_b128 v[48:51], v5 offset:0
    v_mfma_f32_32x32x16_bf16 a[32:47], v[68:71], v[32:35], a[32:47]
    ds_read_b128 v[52:55], v5 offset:4096
    ds_read_b64_tr_b16 v[84:85], v7 offset:24576
    v_mfma_f32_32x32x16_bf16 a[48:63], v[68:71], v[36:39], a[48:63]
    ds_read_b64_tr_b16 v[86:87], v7 offset:26624
    v_mfma_f32_32x32x16_bf16 a[64:79], v[72:75], v[32:35], a[64:79]
    ds_read_b64_tr_b16 v[88:89], v8 offset:24576
    v_mfma_f32_32x32x16_bf16 a[80:95], v[72:75], v[36:39], a[80:95]
    ds_read_b64_tr_b16 v[90:91], v8 offset:26624
    ds_read_b64_tr_b16 v[92:93], v9 offset:24576
    v_mfma_f32_32x32x16_bf16 a[96:111], v[76:79], v[32:35], a[96:111]
    ds_read_b64_tr_b16 v[94:95], v9 offset:26624
    v_mfma_f32_32x32x16_bf16 a[112:127], v[76:79], v[36:39], a[112:127]
    v_add_u32 v2, s52, v2
    v_add_u32 v3, s52, v3
    v_add_u32 v4, s52, v4
    v_add_u32 v5, s52, v5
    v_add_u32 v6, s52, v6
    v_add_u32 v7, s52, v7
    v_add_u32 v8, s52, v8
    v_add_u32 v9, s52, v9
    s_sub_u32 s52, 0, s52
    s_waitcnt vmcnt(0) lgkmcnt(0)
    v_mfma_f32_32x32x16_bf16 a[0:15], v[80:83], v[48:51], a[0:15]
    s_barrier
    v_mfma_f32_32x32x16_bf16 a[16:31], v[80:83], v[52:55], a[16:31]
    ds_read_b64_tr_b16 v[64:65], v6 offset:0
    ds_read_b64_tr_b16 v[66:67], v6 offset:2048
    v_mfma_f32_32x32x16_bf16 a[32:47], v[84:87], v[48:51], a[32:47]
    ds_read_b128 v[32:35], v2 offset:0
    v_mfma_f32_32x32x16_bf16 a[48:63], v[84:87], v[52:55], a[48:63]
    ds_read_b128 v[36:39], v2 offset:4096
    ds_read_b64_tr_b16 v[68:69], v7 offset:0
    v_mfma_f32_32x32x16_bf16 a[64:79], v[88:91], v[48:51], a[64:79]
    ds_read_b64_tr_b16 v[70:71], v7 offset:2048
    v_mfma_f32_32x32x16_bf16 a[80:95], v[88:91], v[52:55], a[80:95]
    ds_read_b64_tr_b16 v[72:73], v8 offset:0
    ds_read_b64_tr_b16 v[74:75], v8 offset:2048
    v_mfma_f32_32x32x16_bf16 a[96:111], v[92:95], v[48:51], a[96:111]
    ds_read_b64_tr_b16 v[76:77], v9 offset:0
    v_mfma_f32_32x32x16_bf16 a[112:127], v[92:95], v[52:55], a[112:127]
    ds_read_b64_tr_b16 v[78:79], v9 offset:2048
    s_waitcnt lgkmcnt(0)
    v_mfma_f32_32x32x16_bf16 a[0:15], v[64:67], v[32:35], a[0:15]
    ds_read_b64_tr_b16 v[80:81], v6 offset:8192
    ds_read_b64_tr_b16 v[82:83], v6 offset:10240
    v_mfma_f32_32x32x16_bf16 a[16:31], v[64:67], v[36:39], a[16:31]
    ds_read_b128 v[48:51], v3 offset:0
    v_mfma_f32_32x32x16_bf16 a[32:47], v[68:71], v[32:35], a[32:47]
    ds_read_b128 v[52:55], v3 offset:4096
    v_mfma_f32_32x32x16_bf16 a[48:63], v[68:71], v[36:39], a[48:63]
    ds_read_b64_tr_b16 v[84:85], v7 offset:8192
    v_mfma_f32_32x32x16_bf16 a[64:79], v[72:75], v[32:35], a[64:79]
    ds_read_b64_tr_b16 v[86:87], v7 offset:10240
    ds_read_b64_tr_b16 v[88:89], v8 offset:8192
    v_mfma_f32_32x32x16_bf16 a[80:95], v[72:75], v[36:39], a[80:95]
    ds_read_b64_tr_b16 v[90:91], v8 offset:10240
    v_mfma_f32_32x32x16_bf16 a[96:111], v[76:79], v[32:35], a[96:111]
    ds_read_b64_tr_b16 v[92:93], v9 offset:8192
    v_mfma_f32_32x32x16_bf16 a[112:127], v[76:79], v[36:39], a[112:127]
    ds_read_b64_tr_b16 v[94:95], v9 offset:10240
    s_waitcnt lgkmcnt(0)
    v_mfma_f32_32x32x16_bf16 a[0:15], v[80:83], v[48:51], a[0:15]
    ds_read_b64_tr_b16 v[64:65], v6 offset:16384
    ds_read_b64_tr_b16 v[66:67], v6 offset:18432
    v_mfma_f32_32x32x16_bf16 a[16:31], v[80:83], v[52:55], a[16:31]
    ds_read_b128 v[32:35], v4 offset:0
    v_mfma_f32_32x32x16_bf16 a[32:47], v[84:87], v[48:51], a[32:47]
    ds_read_b128 v[36:39], v4 offset:4096
    v_mfma_f32_32x32x16_bf16 a[48:63], v[84:87], v[52:55], a[48:63]
    ds_read_b64_tr_b16 v[68:69], v7 offset:16384
    v_mfma_f32_32x32x16_bf16 a[64:79], v[88:91], v[48:51], a[64:79]
    ds_read_b64_tr_b16 v[70:71], v7 offset:18432
    ds_read_b64_tr_b16 v[72:73], v8 offset:16384
    v_mfma_f32_32x32x16_bf16 a[80:95], v[88:91], v[52:55], a[80:95]
    ds_read_b64_tr_b16 v[74:75], v8 offset:18432
    v_mfma_f32_32x32x16_bf16 a[96:111], v[92:95], v[48:51], a[96:111]
    ds_read_b64_tr_b16 v[76:77], v9 offset:16384
    v_mfma_f32_32x32x16_bf16 a[112:127], v[92:95], v[52:55], a[112:127]
    ds_read_b64_tr_b16 v[78:79], v9 offset:18432
    s_waitcnt lgkmcnt(0)
    v_mfma_f32_32x32x16_bf16 a[0:15], v[64:67], v[32:35], a[0:15]
    ds_read_b64_tr_b16 v[80:81], v6 offset:24576
    ds_read_b64_tr_b16 v[82:83], v6 offset:26624
    v_mfma_f32_32x32x16_bf16 a[16:31], v[64:67], v[36:39], a[16:31]
    ds_read_b128 v[48:51], v5 offset:0
    v_mfma_f32_32x32x16_bf16 a[32:47], v[68:71], v[32:35], a[32:47]
    ds_read_b128 v[52:55], v5 offset:4096
    v_mfma_f32_32x32x16_bf16 a[48:63], v[68:71], v[36:39], a[48:63]
    ds_read_b64_tr_b16 v[84:85], v7 offset:24576
    v_mfma_f32_32x32x16_bf16 a[64:79], v[72:75], v[32:35], a[64:79]
    ds_read_b64_tr_b16 v[86:87], v7 offset:26624
    ds_read_b64_tr_b16 v[88:89], v8 offset:24576
    v_mfma_f32_32x32x16_bf16 a[80:95], v[72:75], v[36:39], a[80:95]
    ds_read_b64_tr_b16 v[90:91], v8 offset:26624
    v_mfma_f32_32x32x16_bf16 a[96:111], v[76:79], v[32:35], a[96:111]
    ds_read_b64_tr_b16 v[92:93], v9 offset:24576
    v_mfma_f32_32x32x16_bf16 a[112:127], v[76:79], v[36:39], a[112:127]
    ds_read_b64_tr_b16 v[94:95], v9 offset:26624
    s_waitcnt lgkmcnt(0)
    v_mfma_f32_32x32x16_bf16 a[0:15], v[80:83], v[48:51], a[0:15]
    v_mfma_f32_32x32x16_bf16 a[16:31], v[80:83], v[52:55], a[16:31]
    v_mfma_f32_32x32x16_bf16 a[32:47], v[84:87], v[48:51], a[32:47]
    v_mfma_f32_32x32x16_bf16 a[48:63], v[84:87], v[52:55], a[48:63]
    v_mfma_f32_32x32x16_bf16 a[64:79], v[88:91], v[48:51], a[64:79]
    v_mfma_f32_32x32x16_bf16 a[80:95], v[88:91], v[52:55], a[80:95]
    v_mfma_f32_32x32x16_bf16 a[96:111], v[92:95], v[48:51], a[96:111]
    v_mfma_f32_32x32x16_bf16 a[112:127], v[92:95], v[52:55], a[112:127]
    v_add_u32 v2, s52, v2
    v_add_u32 v3, s52, v3
    v_add_u32 v4, s52, v4
    v_add_u32 v5, s52, v5
    v_add_u32 v6, s52, v6
    v_add_u32 v7, s52, v7
    v_add_u32 v8, s52, v8
    v_add_u32 v9, s52, v9
    s_sub_u32 s52, 0, s52
    s_branch mega_kernel_q0_epi
mega_kernel_q0_v:
    s_mul_i32 s42, s46, 4096
    s_mul_i32 s43, s46, 8192
    s_add_u32 s43, s43, 16384
    s_mov_b32 s45, 49152
    s_mov_b32 s52, 49152
    s_add_u32 m0, s42, 0
    s_nop 0
    buffer_load_dwordx4 v10, s[20:23], s40 offen lds
    s_add_u32 m0, s42, 1024
    s_nop 0
    buffer_load_dwordx4 v11, s[20:23], s40 offen lds
    s_add_u32 m0, s42, 2048
    s_nop 0
    buffer_load_dwordx4 v12, s[20:23], s40 offen lds
    s_add_u32 m0, s42, 3072
    s_nop 0
    buffer_load_dwordx4 v13, s[20:23], s40 offen lds
    s_add_u32 m0, s43, 0
    s_nop 0
    buffer_load_dwordx4 v18, s[24:27], s41 offen lds
    s_add_u32 m0, s43, 1024
    s_nop 0
    buffer_load_dwordx4 v19, s[24:27], s41 offen lds
    s_add_u32 m0, s43, 2048
    s_nop 0
    buffer_load_dwordx4 v20, s[24:27], s41 offen lds
    s_add_u32 m0, s43, 3072
    s_nop 0
    buffer_load_dwordx4 v21, s[24:27], s41 offen lds
    s_add_u32 m0, s43, 4096
    s_nop 0
    buffer_load_dwordx4 v22, s[24:27], s41 offen lds
    s_add_u32 m0, s43, 5120
    s_nop 0
    buffer_load_dwordx4 v23, s[24:27], s41 offen lds
    s_add_u32 m0, s43, 6144
    s_nop 0
    buffer_load_dwordx4 v24, s[24:27], s41 offen lds
    s_add_u32 m0, s43, 7168
    s_nop 0
    buffer_load_dwordx4 v25, s[24:27], s41 offen lds
    s_add_u32 s40, s40, 128
    s_add_u32 s41, s41, 524288
    s_add_u32 s42, s42, s45
    s_add_u32 s43, s43, s45
    s_sub_u32 s45, 0, s45
    s_add_u32 m0, s42, 0
    s_nop 0
    buffer_load_dwordx4 v10, s[20:23], s40 offen lds
    s_add_u32 m0, s42, 1024
    s_nop 0
    buffer_load_dwordx4 v11, s[20:23], s40 offen lds
    s_add_u32 m0, s42, 2048
    s_nop 0
    buffer_load_dwordx4 v12, s[20:23], s40 offen lds
    s_add_u32 m0, s42, 3072
    s_nop 0
    buffer_load_dwordx4 v13, s[20:23], s40 offen lds
    s_add_u32 m0, s43, 0
    s_nop 0
    buffer_load_dwordx4 v18, s[24:27], s41 offen lds
    s_add_u32 m0, s43, 1024
    s_nop 0
    buffer_load_dwordx4 v19, s[24:27], s41 offen lds
    s_add_u32 m0, s43, 2048
    s_nop 0
    buffer_load_dwordx4 v20, s[24:27], s41 offen lds
    s_add_u32 m0, s43, 3072
    s_nop 0
    buffer_load_dwordx4 v21, s[24:27], s41 offen lds
    s_add_u32 m0, s43, 4096
    s_nop 0
    buffer_load_dwordx4 v22, s[24:27], s41 offen lds
    s_add_u32 m0, s43, 5120
    s_nop 0
    buffer_load_dwordx4 v23, s[24:27], s41 offen lds
    s_add_u32 m0, s43, 6144
    s_nop 0
    buffer_load_dwordx4 v24, s[24:27], s41 offen lds
    s_add_u32 m0, s43, 7168
    s_nop 0
    buffer_load_dwordx4 v25, s[24:27], s41 offen lds
    s_add_u32 s40, s40, 128
    s_add_u32 s41, s41, 524288
    s_add_u32 s42, s42, s45
    s_add_u32 s43, s43, s45
    s_sub_u32 s45, 0, s45
    s_waitcnt vmcnt(12)
    s_barrier
    ds_read_b64_tr_b16 v[64:65], v6 offset:0
    ds_read_b64_tr_b16 v[66:67], v6 offset:2048
    ds_read_b128 v[32:35], v2 offset:0
    ds_read_b128 v[36:39], v2 offset:4096
    ds_read_b64_tr_b16 v[68:69], v7 offset:0
    ds_read_b64_tr_b16 v[70:71], v7 offset:2048
    ds_read_b64_tr_b16 v[72:73], v8 offset:0
    ds_read_b64_tr_b16 v[74:75], v8 offset:2048
    ds_read_b64_tr_b16 v[76:77], v9 offset:0
    ds_read_b64_tr_b16 v[78:79], v9 offset:2048
    s_waitcnt lgkmcnt(0)
    v_mfma_f32_32x32x16_bf16 a[0:15], v[32:35], v[64:67], 0
    ds_read_b64_tr_b16 v[80:81], v6 offset:8192
    ds_read_b64_tr_b16 v[82:83], v6 offset:10240
    v_mfma_f32_32x32x16_bf16 a[16:31], v[36:39], v[64:67], 0
    ds_read_b128 v[48:51], v3 offset:0
    v_mfma_f32_32x32x16_bf16 a[32:47], v[32:35], v[68:71], 0
    ds_read_b128 v[52:55], v3 offset:4096
    v_mfma_f32_32x32x16_bf16 a[48:63], v[36:39], v[68:71], 0
    ds_read_b64_tr_b16 v[84:85], v7 offset:8192
    v_mfma_f32_32x32x16_bf16 a[64:79], v[32:35], v[72:75], 0
    ds_read_b64_tr_b16 v[86:87], v7 offset:10240
    ds_read_b64_tr_b16 v[88:89], v8 offset:8192
    v_mfma_f32_32x32x16_bf16 a[80:95], v[36:39], v[72:75], 0
    ds_read_b64_tr_b16 v[90:91], v8 offset:10240
    v_mfma_f32_32x32x16_bf16 a[96:111], v[32:35], v[76:79], 0
    ds_read_b64_tr_b16 v[92:93], v9 offset:8192
    v_mfma_f32_32x32x16_bf16 a[112:127], v[36:39], v[76:79], 0
    ds_read_b64_tr_b16 v[94:95], v9 offset:10240
    s_waitcnt lgkmcnt(0)
    v_mfma_f32_32x32x16_bf16 a[0:15], v[48:51], v[80:83], a[0:15]
    ds_read_b64_tr_b16 v[64:65], v6 offset:16384
    ds_read_b64_tr_b16 v[66:67], v6 offset:18432
    v_mfma_f32_32x32x16_bf16 a[16:31], v[52:55], v[80:83], a[16:31]
    ds_read_b128 v[32:35], v4 offset:0
    v_mfma_f32_32x32x16_bf16 a[32:47], v[48:51], v[84:87], a[32:47]
    ds_read_b128 v[36:39], v4 offset:4096
    v_mfma_f32_32x32x16_bf16 a[48:63], v[52:55], v[84:87], a[48:63]
    ds_read_b64_tr_b16 v[68:69], v7 offset:16384
    v_mfma_f32_32x32x16_bf16 a[64:79], v[48:51], v[88:91], a[64:79]
    ds_read_b64_tr_b16 v[70:71], v7 offset:18432
    ds_read_b64_tr_b16 v[72:73], v8 offset:16384
    v_mfma_f32_32x32x16_bf16 a[80:95], v[52:55], v[88:91], a[80:95]
    ds_read_b64_tr_b16 v[74:75], v8 offset:18432
    v_mfma_f32_32x32x16_bf16 a[96:111], v[48:51], v[92:95], a[96:111]
    ds_read_b64_tr_b16 v[76:77], v9 offset:16384
    v_mfma_f32_32x32x16_bf16 a[112:127], v[52:55], v[92:95], a[112:127]
    ds_read_b64_tr_b16 v[78:79], v9 offset:18432
    s_waitcnt lgkmcnt(0)
    v_mfma_f32_32x32x16_bf16 a[0:15], v[32:35], v[64:67], a[0:15]
    ds_read_b64_tr_b16 v[80:81], v6 offset:24576
    ds_read_b64_tr_b16 v[82:83], v6 offset:26624
    v_mfma_f32_32x32x16_bf16 a[16:31], v[36:39], v[64:67], a[16:31]
    ds_read_b128 v[48:51], v5 offset:0
    v_mfma_f32_32x32x16_bf16 a[32:47], v[32:35], v[68:71], a[32:47]
    ds_read_b128 v[52:55], v5 offset:4096
    ds_read_b64_tr_b16 v[84:85], v7 offset:24576
    v_mfma_f32_32x32x16_bf16 a[48:63], v[36:39], v[68:71], a[48:63]
    ds_read_b64_tr_b16 v[86:87], v7 offset:26624
    v_mfma_f32_32x32x16_bf16 a[64:79], v[32:35], v[72:75], a[64:79]
    ds_read_b64_tr_b16 v[88:89], v8 offset:24576
    v_mfma_f32_32x32x16_bf16 a[80:95], v[36:39], v[72:75], a[80:95]
    ds_read_b64_tr_b16 v[90:91], v8 offset:26624
    ds_read_b64_tr_b16 v[92:93], v9 offset:24576
    v_mfma_f32_32x32x16_bf16 a[96:111], v[32:35], v[76:79], a[96:111]
    ds_read_b64_tr_b16 v[94:95], v9 offset:26624
    v_mfma_f32_32x32x16_bf16 a[112:127], v[36:39], v[76:79], a[112:127]
    v_add_u32 v2, s52, v2
    v_add_u32 v3, s52, v3
    v_add_u32 v4, s52, v4
    v_add_u32 v5, s52, v5
    v_add_u32 v6, s52, v6
    v_add_u32 v7, s52, v7
    v_add_u32 v8, s52, v8
    v_add_u32 v9, s52, v9
    s_sub_u32 s52, 0, s52
    s_waitcnt vmcnt(0) lgkmcnt(0)
    v_mfma_f32_32x32x16_bf16 a[0:15], v[48:51], v[80:83], a[0:15]
    s_barrier
    v_mfma_f32_32x32x16_bf16 a[16:31], v[52:55], v[80:83], a[16:31]
    ds_read_b64_tr_b16 v[64:65], v6 offset:0
    s_add_u32 m0, s42, 0
    s_nop 0
    buffer_load_dwordx4 v10, s[20:23], s40 offen lds
    ds_read_b64_tr_b16 v[66:67], v6 offset:2048
    v_mfma_f32_32x32x16_bf16 a[32:47], v[48:51], v[84:87], a[32:47]
    s_add_u32 m0, s42, 1024
    s_nop 0
    buffer_load_dwordx4 v11, s[20:23], s40 offen lds
    ds_read_b128 v[32:35], v2 offset:0
    v_mfma_f32_32x32x16_bf16 a[48:63], v[52:55], v[84:87], a[48:63]
    ds_read_b128 v[36:39], v2 offset:4096
    s_add_u32 m0, s43, 0
    s_nop 0
    buffer_load_dwordx4 v18, s[24:27], s41 offen lds
    v_mfma_f32_32x32x16_bf16 a[64:79], v[48:51], v[88:91], a[64:79]
    ds_read_b64_tr_b16 v[68:69], v7 offset:0
    ds_read_b64_tr_b16 v[70:71], v7 offset:2048
    s_add_u32 m0, s43, 1024
    s_nop 0
    buffer_load_dwordx4 v19, s[24:27], s41 offen lds
    v_mfma_f32_32x32x16_bf16 a[80:95], v[52:55], v[88:91], a[80:95]
    ds_read_b64_tr_b16 v[72:73], v8 offset:0
    s_add_u32 m0, s43, 2048
    s_nop 0
    buffer_load_dwordx4 v20, s[24:27], s41 offen lds
    v_mfma_f32_32x32x16_bf16 a[96:111], v[48:51], v[92:95], a[96:111]
    ds_read_b64_tr_b16 v[74:75], v8 offset:2048
    ds_read_b64_tr_b16 v[76:77], v9 offset:0
    v_mfma_f32_32x32x16_bf16 a[112:127], v[52:55], v[92:95], a[112:127]
    s_add_u32 m0, s43, 3072
    s_nop 0
    buffer_load_dwordx4 v21, s[24:27], s41 offen lds
    ds_read_b64_tr_b16 v[78:79], v9 offset:2048
    s_mov_b32 s44, 13
mega_kernel_q0v_loop:
    s_waitcnt lgkmcnt(0)
    v_mfma_f32_32x32x16_bf16 a[0:15], v[32:35], v[64:67], a[0:15]
    ds_read_b64_tr_b16 v[80:81], v6 offset:8192
    s_add_u32 m0, s42, 2048
    s_nop 0
    buffer_load_dwordx4 v12, s[20:23], s40 offen lds
    ds_read_b64_tr_b16 v[82:83], v6 offset:10240
    v_mfma_f32_32x32x16_bf16 a[16:31], v[36:39], v[64:67], a[16:31]
    s_add_u32 m0, s42, 3072
    s_nop 0
    buffer_load_dwordx4 v13, s[20:23], s40 offen lds
    ds_read_b128 v[48:51], v3 offset:0
    v_mfma_f32_32x32x16_bf16 a[32:47], v[32:35], v[68:71], a[32:47]
    ds_read_b128 v[52:55], v3 offset:4096
    s_add_u32 m0, s43, 4096
    s_nop 0
    buffer_load_dwordx4 v22, s[24:27], s41 offen lds
    v_mfma_f32_32x32x16_bf16 a[48:63], v[36:39], v[68:71], a[48:63]
    ds_read_b64_tr_b16 v[84:85], v7 offset:8192
    ds_read_b64_tr_b16 v[86:87], v7 offset:10240
    v_mfma_f32_32x32x16_bf16 a[64:79], v[32:35], v[72:75], a[64:79]
    s_add_u32 m0, s43, 5120
    s_nop 0
    buffer_load_dwordx4 v23, s[24:27], s41 offen lds
    ds_read_b64_tr_b16 v[88:89], v8 offset:8192
    v_mfma_f32_32x32x16_bf16 a[80:95], v[36:39], v[72:75], a[80:95]
    s_add_u32 m0, s43, 6144
    s_nop 0
    buffer_load_dwordx4 v24, s[24:27], s41 offen lds
    ds_read_b64_tr_b16 v[90:91], v8 offset:10240
    v_mfma_f32_32x32x16_bf16 a[96:111], v[32:35], v[76:79], a[96:111]
    ds_read_b64_tr_b16 v[92:93], v9 offset:8192
    s_add_u32 m0, s43, 7168
    s_nop 0
    buffer_load_dwordx4 v25, s[24:27], s41 offen lds
    v_mfma_f32_32x32x16_bf16 a[112:127], v[36:39], v[76:79], a[112:127]
    ds_read_b64_tr_b16 v[94:95], v9 offset:10240
    s_add_u32 s40, s40, 128
    s_add_u32 s41, s41, 524288
    s_add_u32 s42, s42, s45
    s_add_u32 s43, s43, s45
    s_sub_u32 s45, 0, s45
    s_waitcnt lgkmcnt(0)
    v_mfma_f32_32x32x16_bf16 a[0:15], v[48:51], v[80:83], a[0:15]
    ds_read_b64_tr_b16 v[64:65], v6 offset:16384
    ds_read_b64_tr_b16 v[66:67], v6 offset:18432
    v_mfma_f32_32x32x16_bf16 a[16:31], v[52:55], v[80:83], a[16:31]
    ds_read_b128 v[32:35], v4 offset:0
    v_mfma_f32_32x32x16_bf16 a[32:47], v[48:51], v[84:87], a[32:47]
    ds_read_b128 v[36:39], v4 offset:4096
    v_mfma_f32_32x32x16_bf16 a[48:63], v[52:55], v[84:87], a[48:63]
    ds_read_b64_tr_b16 v[68:69], v7 offset:16384
    v_mfma_f32_32x32x16_bf16 a[64:79], v[48:51], v[88:91], a[64:79]
    ds_read_b64_tr_b16 v[70:71], v7 offset:18432
    ds_read_b64_tr_b16 v[72:73], v8 offset:16384
    v_mfma_f32_32x32x16_bf16 a[80:95], v[52:55], v[88:91], a[80:95]
    ds_read_b64_tr_b16 v[74:75], v8 offset:18432
    v_mfma_f32_32x32x16_bf16 a[96:111], v[48:51], v[92:95], a[96:111]
    ds_read_b64_tr_b16 v[76:77], v9 offset:16384
    v_mfma_f32_32x32x16_bf16 a[112:127], v[52:55], v[92:95], a[112:127]
    ds_read_b64_tr_b16 v[78:79], v9 offset:18432
    s_waitcnt lgkmcnt(0)
    v_mfma_f32_32x32x16_bf16 a[0:15], v[32:35], v[64:67], a[0:15]
    ds_read_b64_tr_b16 v[80:81], v6 offset:24576
    ds_read_b64_tr_b16 v[82:83], v6 offset:26624
    v_mfma_f32_32x32x16_bf16 a[16:31], v[36:39], v[64:67], a[16:31]
    ds_read_b128 v[48:51], v5 offset:0
    v_mfma_f32_32x32x16_bf16 a[32:47], v[32:35], v[68:71], a[32:47]
    ds_read_b128 v[52:55], v5 offset:4096
    ds_read_b64_tr_b16 v[84:85], v7 offset:24576
    v_mfma_f32_32x32x16_bf16 a[48:63], v[36:39], v[68:71], a[48:63]
    ds_read_b64_tr_b16 v[86:87], v7 offset:26624
    v_mfma_f32_32x32x16_bf16 a[64:79], v[32:35], v[72:75], a[64:79]
    ds_read_b64_tr_b16 v[88:89], v8 offset:24576
    v_mfma_f32_32x32x16_bf16 a[80:95], v[36:39], v[72:75], a[80:95]
    ds_read_b64_tr_b16 v[90:91], v8 offset:26624
    ds_read_b64_tr_b16 v[92:93], v9 offset:24576
    v_mfma_f32_32x32x16_bf16 a[96:111], v[32:35], v[76:79], a[96:111]
    ds_read_b64_tr_b16 v[94:95], v9 offset:26624
    v_mfma_f32_32x32x16_bf16 a[112:127], v[36:39], v[76:79], a[112:127]
    v_add_u32 v2, s52, v2
    v_add_u32 v3, s52, v3
    v_add_u32 v4, s52, v4
    v_add_u32 v5, s52, v5
    v_add_u32 v6, s52, v6
    v_add_u32 v7, s52, v7
    v_add_u32 v8, s52, v8
    v_add_u32 v9, s52, v9
    s_sub_u32 s52, 0, s52
    s_waitcnt vmcnt(0) lgkmcnt(0)
    v_mfma_f32_32x32x16_bf16 a[0:15], v[48:51], v[80:83], a[0:15]
    s_barrier
    v_mfma_f32_32x32x16_bf16 a[16:31], v[52:55], v[80:83], a[16:31]
    ds_read_b64_tr_b16 v[64:65], v6 offset:0
    s_add_u32 m0, s42, 0
    s_nop 0
    buffer_load_dwordx4 v10, s[20:23], s40 offen lds
    ds_read_b64_tr_b16 v[66:67], v6 offset:2048
    v_mfma_f32_32x32x16_bf16 a[32:47], v[48:51], v[84:87], a[32:47]
    s_add_u32 m0, s42, 1024
    s_nop 0
    buffer_load_dwordx4 v11, s[20:23], s40 offen lds
    ds_read_b128 v[32:35], v2 offset:0
    v_mfma_f32_32x32x16_bf16 a[48:63], v[52:55], v[84:87], a[48:63]
    ds_read_b128 v[36:39], v2 offset:4096
    s_add_u32 m0, s43, 0
    s_nop 0
    buffer_load_dwordx4 v18, s[24:27], s41 offen lds
    v_mfma_f32_32x32x16_bf16 a[64:79], v[48:51], v[88:91], a[64:79]
    ds_read_b64_tr_b16 v[68:69], v7 offset:0
    ds_read_b64_tr_b16 v[70:71], v7 offset:2048
    s_add_u32 m0, s43, 1024
    s_nop 0
    buffer_load_dwordx4 v19, s[24:27], s41 offen lds
    v_mfma_f32_32x32x16_bf16 a[80:95], v[52:55], v[88:91], a[80:95]
    ds_read_b64_tr_b16 v[72:73], v8 offset:0
    s_add_u32 m0, s43, 2048
    s_nop 0
    buffer_load_dwordx4 v20, s[24:27], s41 offen lds
    v_mfma_f32_32x32x16_bf16 a[96:111], v[48:51], v[92:95], a[96:111]
    ds_read_b64_tr_b16 v[74:75], v8 offset:2048
    ds_read_b64_tr_b16 v[76:77], v9 offset:0
    v_mfma_f32_32x32x16_bf16 a[112:127], v[52:55], v[92:95], a[112:127]
    s_add_u32 m0, s43, 3072
    s_nop 0
    buffer_load_dwordx4 v21, s[24:27], s41 offen lds
    ds_read_b64_tr_b16 v[78:79], v9 offset:2048
    s_sub_u32 s44, s44, 1
    s_cmp_lg_u32 s44, 0
    s_cbranch_scc1 mega_kernel_q0v_loop
    s_waitcnt lgkmcnt(0)
    v_mfma_f32_32x32x16_bf16 a[0:15], v[32:35], v[64:67], a[0:15]
    ds_read_b64_tr_b16 v[80:81], v6 offset:8192
    s_add_u32 m0, s42, 2048
    s_nop 0
    buffer_load_dwordx4 v12, s[20:23], s40 offen lds
    ds_read_b64_tr_b16 v[82:83], v6 offset:10240
    v_mfma_f32_32x32x16_bf16 a[16:31], v[36:39], v[64:67], a[16:31]
    s_add_u32 m0, s42, 3072
    s_nop 0
    buffer_load_dwordx4 v13, s[20:23], s40 offen lds
    ds_read_b128 v[48:51], v3 offset:0
    v_mfma_f32_32x32x16_bf16 a[32:47], v[32:35], v[68:71], a[32:47]
    ds_read_b128 v[52:55], v3 offset:4096
    s_add_u32 m0, s43, 4096
    s_nop 0
    buffer_load_dwordx4 v22, s[24:27], s41 offen lds
    v_mfma_f32_32x32x16_bf16 a[48:63], v[36:39], v[68:71], a[48:63]
    ds_read_b64_tr_b16 v[84:85], v7 offset:8192
    ds_read_b64_tr_b16 v[86:87], v7 offset:10240
    v_mfma_f32_32x32x16_bf16 a[64:79], v[32:35], v[72:75], a[64:79]
    s_add_u32 m0, s43, 5120
    s_nop 0
    buffer_load_dwordx4 v23, s[24:27], s41 offen lds
    ds_read_b64_tr_b16 v[88:89], v8 offset:8192
    v_mfma_f32_32x32x16_bf16 a[80:95], v[36:39], v[72:75], a[80:95]
    s_add_u32 m0, s43, 6144
    s_nop 0
    buffer_load_dwordx4 v24, s[24:27], s41 offen lds
    ds_read_b64_tr_b16 v[90:91], v8 offset:10240
    v_mfma_f32_32x32x16_bf16 a[96:111], v[32:35], v[76:79], a[96:111]
    ds_read_b64_tr_b16 v[92:93], v9 offset:8192
    s_add_u32 m0, s43, 7168
    s_nop 0
    buffer_load_dwordx4 v25, s[24:27], s41 offen lds
    v_mfma_f32_32x32x16_bf16 a[112:127], v[36:39], v[76:79], a[112:127]
    ds_read_b64_tr_b16 v[94:95], v9 offset:10240
    s_add_u32 s40, s40, 128
    s_add_u32 s41, s41, 524288
    s_add_u32 s42, s42, s45
    s_add_u32 s43, s43, s45
    s_sub_u32 s45, 0, s45
    s_waitcnt lgkmcnt(0)
    v_mfma_f32_32x32x16_bf16 a[0:15], v[48:51], v[80:83], a[0:15]
    ds_read_b64_tr_b16 v[64:65], v6 offset:16384
    ds_read_b64_tr_b16 v[66:67], v6 offset:18432
    v_mfma_f32_32x32x16_bf16 a[16:31], v[52:55], v[80:83], a[16:31]
    ds_read_b128 v[32:35], v4 offset:0
    v_mfma_f32_32x32x16_bf16 a[32:47], v[48:51], v[84:87], a[32:47]
    ds_read_b128 v[36:39], v4 offset:4096
    v_mfma_f32_32x32x16_bf16 a[48:63], v[52:55], v[84:87], a[48:63]
    ds_read_b64_tr_b16 v[68:69], v7 offset:16384
    v_mfma_f32_32x32x16_bf16 a[64:79], v[48:51], v[88:91], a[64:79]
    ds_read_b64_tr_b16 v[70:71], v7 offset:18432
    ds_read_b64_tr_b16 v[72:73], v8 offset:16384
    v_mfma_f32_32x32x16_bf16 a[80:95], v[52:55], v[88:91], a[80:95]
    ds_read_b64_tr_b16 v[74:75], v8 offset:18432
    v_mfma_f32_32x32x16_bf16 a[96:111], v[48:51], v[92:95], a[96:111]
    ds_read_b64_tr_b16 v[76:77], v9 offset:16384
    v_mfma_f32_32x32x16_bf16 a[112:127], v[52:55], v[92:95], a[112:127]
    ds_read_b64_tr_b16 v[78:79], v9 offset:18432
    s_waitcnt lgkmcnt(0)
    v_mfma_f32_32x32x16_bf16 a[0:15], v[32:35], v[64:67], a[0:15]
    ds_read_b64_tr_b16 v[80:81], v6 offset:24576
    ds_read_b64_tr_b16 v[82:83], v6 offset:26624
    v_mfma_f32_32x32x16_bf16 a[16:31], v[36:39], v[64:67], a[16:31]
    ds_read_b128 v[48:51], v5 offset:0
    v_mfma_f32_32x32x16_bf16 a[32:47], v[32:35], v[68:71], a[32:47]
    ds_read_b128 v[52:55], v5 offset:4096
    ds_read_b64_tr_b16 v[84:85], v7 offset:24576
    v_mfma_f32_32x32x16_bf16 a[48:63], v[36:39], v[68:71], a[48:63]
    ds_read_b64_tr_b16 v[86:87], v7 offset:26624
    v_mfma_f32_32x32x16_bf16 a[64:79], v[32:35], v[72:75], a[64:79]
    ds_read_b64_tr_b16 v[88:89], v8 offset:24576
    v_mfma_f32_32x32x16_bf16 a[80:95], v[36:39], v[72:75], a[80:95]
    ds_read_b64_tr_b16 v[90:91], v8 offset:26624
    ds_read_b64_tr_b16 v[92:93], v9 offset:24576
    v_mfma_f32_32x32x16_bf16 a[96:111], v[32:35], v[76:79], a[96:111]
    ds_read_b64_tr_b16 v[94:95], v9 offset:26624
    v_mfma_f32_32x32x16_bf16 a[112:127], v[36:39], v[76:79], a[112:127]
    v_add_u32 v2, s52, v2
    v_add_u32 v3, s52, v3
    v_add_u32 v4, s52, v4
    v_add_u32 v5, s52, v5
    v_add_u32 v6, s52, v6
    v_add_u32 v7, s52, v7
    v_add_u32 v8, s52, v8
    v_add_u32 v9, s52, v9
    s_sub_u32 s52, 0, s52
    s_waitcnt vmcnt(0) lgkmcnt(0)
    v_mfma_f32_32x32x16_bf16 a[0:15], v[48:51], v[80:83], a[0:15]
    s_barrier
    v_mfma_f32_32x32x16_bf16 a[16:31], v[52:55], v[80:83], a[16:31]
    ds_read_b64_tr_b16 v[64:65], v6 offset:0
    ds_read_b64_tr_b16 v[66:67], v6 offset:2048
    v_mfma_f32_32x32x16_bf16 a[32:47], v[48:51], v[84:87], a[32:47]
    ds_read_b128 v[32:35], v2 offset:0
    v_mfma_f32_32x32x16_bf16 a[48:63], v[52:55], v[84:87], a[48:63]
    ds_read_b128 v[36:39], v2 offset:4096
    ds_read_b64_tr_b16 v[68:69], v7 offset:0
    v_mfma_f32_32x32x16_bf16 a[64:79], v[48:51], v[88:91], a[64:79]
    ds_read_b64_tr_b16 v[70:71], v7 offset:2048
    v_mfma_f32_32x32x16_bf16 a[80:95], v[52:55], v[88:91], a[80:95]
    ds_read_b64_tr_b16 v[72:73], v8 offset:0
    ds_read_b64_tr_b16 v[74:75], v8 offset:2048
    v_mfma_f32_32x32x16_bf16 a[96:111], v[48:51], v[92:95], a[96:111]
    ds_read_b64_tr_b16 v[76:77], v9 offset:0
    v_mfma_f32_32x32x16_bf16 a[112:127], v[52:55], v[92:95], a[112:127]
    ds_read_b64_tr_b16 v[78:79], v9 offset:2048
    s_waitcnt lgkmcnt(0)
    v_mfma_f32_32x32x16_bf16 a[0:15], v[32:35], v[64:67], a[0:15]
    ds_read_b64_tr_b16 v[80:81], v6 offset:8192
    ds_read_b64_tr_b16 v[82:83], v6 offset:10240
    v_mfma_f32_32x32x16_bf16 a[16:31], v[36:39], v[64:67], a[16:31]
    ds_read_b128 v[48:51], v3 offset:0
    v_mfma_f32_32x32x16_bf16 a[32:47], v[32:35], v[68:71], a[32:47]
    ds_read_b128 v[52:55], v3 offset:4096
    v_mfma_f32_32x32x16_bf16 a[48:63], v[36:39], v[68:71], a[48:63]
    ds_read_b64_tr_b16 v[84:85], v7 offset:8192
    v_mfma_f32_32x32x16_bf16 a[64:79], v[32:35], v[72:75], a[64:79]
    ds_read_b64_tr_b16 v[86:87], v7 offset:10240
    ds_read_b64_tr_b16 v[88:89], v8 offset:8192
    v_mfma_f32_32x32x16_bf16 a[80:95], v[36:39], v[72:75], a[80:95]
    ds_read_b64_tr_b16 v[90:91], v8 offset:10240
    v_mfma_f32_32x32x16_bf16 a[96:111], v[32:35], v[76:79], a[96:111]
    ds_read_b64_tr_b16 v[92:93], v9 offset:8192
    v_mfma_f32_32x32x16_bf16 a[112:127], v[36:39], v[76:79], a[112:127]
    ds_read_b64_tr_b16 v[94:95], v9 offset:10240
    s_waitcnt lgkmcnt(0)
    v_mfma_f32_32x32x16_bf16 a[0:15], v[48:51], v[80:83], a[0:15]
    ds_read_b64_tr_b16 v[64:65], v6 offset:16384
    ds_read_b64_tr_b16 v[66:67], v6 offset:18432
    v_mfma_f32_32x32x16_bf16 a[16:31], v[52:55], v[80:83], a[16:31]
    ds_read_b128 v[32:35], v4 offset:0
    v_mfma_f32_32x32x16_bf16 a[32:47], v[48:51], v[84:87], a[32:47]
    ds_read_b128 v[36:39], v4 offset:4096
    v_mfma_f32_32x32x16_bf16 a[48:63], v[52:55], v[84:87], a[48:63]
    ds_read_b64_tr_b16 v[68:69], v7 offset:16384
    v_mfma_f32_32x32x16_bf16 a[64:79], v[48:51], v[88:91], a[64:79]
    ds_read_b64_tr_b16 v[70:71], v7 offset:18432
    ds_read_b64_tr_b16 v[72:73], v8 offset:16384
    v_mfma_f32_32x32x16_bf16 a[80:95], v[52:55], v[88:91], a[80:95]
    ds_read_b64_tr_b16 v[74:75], v8 offset:18432
    v_mfma_f32_32x32x16_bf16 a[96:111], v[48:51], v[92:95], a[96:111]
    ds_read_b64_tr_b16 v[76:77], v9 offset:16384
    v_mfma_f32_32x32x16_bf16 a[112:127], v[52:55], v[92:95], a[112:127]
    ds_read_b64_tr_b16 v[78:79], v9 offset:18432
    s_waitcnt lgkmcnt(0)
    v_mfma_f32_32x32x16_bf16 a[0:15], v[32:35], v[64:67], a[0:15]
    ds_read_b64_tr_b16 v[80:81], v6 offset:24576
    ds_read_b64_tr_b16 v[82:83], v6 offset:26624
    v_mfma_f32_32x32x16_bf16 a[16:31], v[36:39], v[64:67], a[16:31]
    ds_read_b128 v[48:51], v5 offset:0
    v_mfma_f32_32x32x16_bf16 a[32:47], v[32:35], v[68:71], a[32:47]
    ds_read_b128 v[52:55], v5 offset:4096
    v_mfma_f32_32x32x16_bf16 a[48:63], v[36:39], v[68:71], a[48:63]
    ds_read_b64_tr_b16 v[84:85], v7 offset:24576
    v_mfma_f32_32x32x16_bf16 a[64:79], v[32:35], v[72:75], a[64:79]
    ds_read_b64_tr_b16 v[86:87], v7 offset:26624
    ds_read_b64_tr_b16 v[88:89], v8 offset:24576
    v_mfma_f32_32x32x16_bf16 a[80:95], v[36:39], v[72:75], a[80:95]
    ds_read_b64_tr_b16 v[90:91], v8 offset:26624
    v_mfma_f32_32x32x16_bf16 a[96:111], v[32:35], v[76:79], a[96:111]
    ds_read_b64_tr_b16 v[92:93], v9 offset:24576
    v_mfma_f32_32x32x16_bf16 a[112:127], v[36:39], v[76:79], a[112:127]
    ds_read_b64_tr_b16 v[94:95], v9 offset:26624
    s_waitcnt lgkmcnt(0)
    v_mfma_f32_32x32x16_bf16 a[0:15], v[48:51], v[80:83], a[0:15]
    v_mfma_f32_32x32x16_bf16 a[16:31], v[52:55], v[80:83], a[16:31]
    v_mfma_f32_32x32x16_bf16 a[32:47], v[48:51], v[84:87], a[32:47]
    v_mfma_f32_32x32x16_bf16 a[48:63], v[52:55], v[84:87], a[48:63]
    v_mfma_f32_32x32x16_bf16 a[64:79], v[48:51], v[88:91], a[64:79]
    v_mfma_f32_32x32x16_bf16 a[80:95], v[52:55], v[88:91], a[80:95]
    v_mfma_f32_32x32x16_bf16 a[96:111], v[48:51], v[92:95], a[96:111]
    v_mfma_f32_32x32x16_bf16 a[112:127], v[52:55], v[92:95], a[112:127]
    v_add_u32 v2, s52, v2
    v_add_u32 v3, s52, v3
    v_add_u32 v4, s52, v4
    v_add_u32 v5, s52, v5
    v_add_u32 v6, s52, v6
    v_add_u32 v7, s52, v7
    v_add_u32 v8, s52, v8
    v_add_u32 v9, s52, v9
    s_sub_u32 s52, 0, s52
mega_kernel_q0_epi:
    s_lshr_b32 s47, s46, 1
    s_and_b32 s48, s46, 1
    s_mul_i32 s47, s47, 524288
    s_mul_i32 s48, s48, 8192
    s_add_u32 s47, s47, s48
    s_add_u32 s47, s47, s54
    v_lshlrev_b32 v96, 4, v1
    s_add_u32 s50, s47, 0
    v_accvgpr_read_b32 v98, a0
    v_accvgpr_read_b32 v99, a1
    v_accvgpr_read_b32 v100, a2
    v_accvgpr_read_b32 v101, a3
    v_accvgpr_read_b32 v102, a4
    v_accvgpr_read_b32 v103, a5
    v_accvgpr_read_b32 v104, a6
    v_accvgpr_read_b32 v105, a7
    v_accvgpr_read_b32 v106, a8
    v_accvgpr_read_b32 v107, a9
    v_accvgpr_read_b32 v108, a10
    v_accvgpr_read_b32 v109, a11
    v_accvgpr_read_b32 v110, a12
    v_accvgpr_read_b32 v111, a13
    v_accvgpr_read_b32 v112, a14
    v_accvgpr_read_b32 v113, a15
    v_cvt_pk_bf16_f32 v114, v98, v99
    v_cvt_pk_bf16_f32 v115, v100, v101
    v_cvt_pk_bf16_f32 v116, v102, v103
    v_cvt_pk_bf16_f32 v117, v104, v105
    v_cvt_pk_bf16_f32 v118, v106, v107
    v_cvt_pk_bf16_f32 v119, v108, v109
    v_cvt_pk_bf16_f32 v120, v110, v111
    v_cvt_pk_bf16_f32 v121, v112, v113
    buffer_store_dwordx4 v[114:117], v96, s[32:35], s50 offen offset:0 sc1
    buffer_store_dwordx4 v[118:121], v96, s[32:35], s50 offen offset:1024 sc1
    s_add_u32 s50, s47, 2048
    v_accvgpr_read_b32 v122, a32
    v_accvgpr_read_b32 v123, a33
    v_accvgpr_read_b32 v124, a34
    v_accvgpr_read_b32 v125, a35
    v_accvgpr_read_b32 v126, a36
    v_accvgpr_read_b32 v127, a37
    v_accvgpr_read_b32 v128, a38
    v_accvgpr_read_b32 v129, a39
    v_accvgpr_read_b32 v130, a40
    v_accvgpr_read_b32 v131, a41
    v_accvgpr_read_b32 v132, a42
    v_accvgpr_read_b32 v133, a43
    v_accvgpr_read_b32 v134, a44
    v_accvgpr_read_b32 v135, a45
    v_accvgpr_read_b32 v136, a46
    v_accvgpr_read_b32 v137, a47
    v_cvt_pk_bf16_f32 v138, v122, v123
    v_cvt_pk_bf16_f32 v139, v124, v125
    v_cvt_pk_bf16_f32 v140, v126, v127
    v_cvt_pk_bf16_f32 v141, v128, v129
    v_cvt_pk_bf16_f32 v142, v130, v131
    v_cvt_pk_bf16_f32 v143, v132, v133
    v_cvt_pk_bf16_f32 v144, v134, v135
    v_cvt_pk_bf16_f32 v145, v136, v137
    buffer_store_dwordx4 v[138:141], v96, s[32:35], s50 offen offset:0 sc1
    buffer_store_dwordx4 v[142:145], v96, s[32:35], s50 offen offset:1024 sc1
    s_add_u32 s50, s47, 4096
    v_accvgpr_read_b32 v146, a64
    v_accvgpr_read_b32 v147, a65
    v_accvgpr_read_b32 v148, a66
    v_accvgpr_read_b32 v149, a67
    v_accvgpr_read_b32 v150, a68
    v_accvgpr_read_b32 v151, a69
    v_accvgpr_read_b32 v152, a70
    v_accvgpr_read_b32 v153, a71
    v_accvgpr_read_b32 v154, a72
    v_accvgpr_read_b32 v155, a73
    v_accvgpr_read_b32 v156, a74
    v_accvgpr_read_b32 v157, a75
    v_accvgpr_read_b32 v158, a76
    v_accvgpr_read_b32 v159, a77
    v_accvgpr_read_b32 v160, a78
    v_accvgpr_read_b32 v161, a79
    v_cvt_pk_bf16_f32 v162, v146, v147
    v_cvt_pk_bf16_f32 v163, v148, v149
    v_cvt_pk_bf16_f32 v164, v150, v151
    v_cvt_pk_bf16_f32 v165, v152, v153
    v_cvt_pk_bf16_f32 v166, v154, v155
    v_cvt_pk_bf16_f32 v167, v156, v157
    v_cvt_pk_bf16_f32 v168, v158, v159
    v_cvt_pk_bf16_f32 v169, v160, v161
    buffer_store_dwordx4 v[162:165], v96, s[32:35], s50 offen offset:0 sc1
    buffer_store_dwordx4 v[166:169], v96, s[32:35], s50 offen offset:1024 sc1
    s_add_u32 s50, s47, 6144
    v_accvgpr_read_b32 v98, a96
    v_accvgpr_read_b32 v99, a97
    v_accvgpr_read_b32 v100, a98
    v_accvgpr_read_b32 v101, a99
    v_accvgpr_read_b32 v102, a100
    v_accvgpr_read_b32 v103, a101
    v_accvgpr_read_b32 v104, a102
    v_accvgpr_read_b32 v105, a103
    v_accvgpr_read_b32 v106, a104
    v_accvgpr_read_b32 v107, a105
    v_accvgpr_read_b32 v108, a106
    v_accvgpr_read_b32 v109, a107
    v_accvgpr_read_b32 v110, a108
    v_accvgpr_read_b32 v111, a109
    v_accvgpr_read_b32 v112, a110
    v_accvgpr_read_b32 v113, a111
    v_cvt_pk_bf16_f32 v114, v98, v99
    v_cvt_pk_bf16_f32 v115, v100, v101
    v_cvt_pk_bf16_f32 v116, v102, v103
    v_cvt_pk_bf16_f32 v117, v104, v105
    v_cvt_pk_bf16_f32 v118, v106, v107
    v_cvt_pk_bf16_f32 v119, v108, v109
    v_cvt_pk_bf16_f32 v120, v110, v111
    v_cvt_pk_bf16_f32 v121, v112, v113
    buffer_store_dwordx4 v[114:117], v96, s[32:35], s50 offen offset:0 sc1
    buffer_store_dwordx4 v[118:121], v96, s[32:35], s50 offen offset:1024 sc1
    s_add_u32 s50, s47, 262144
    v_accvgpr_read_b32 v122, a16
    v_accvgpr_read_b32 v123, a17
    v_accvgpr_read_b32 v124, a18
    v_accvgpr_read_b32 v125, a19
    v_accvgpr_read_b32 v126, a20
    v_accvgpr_read_b32 v127, a21
    v_accvgpr_read_b32 v128, a22
    v_accvgpr_read_b32 v129, a23
    v_accvgpr_read_b32 v130, a24
    v_accvgpr_read_b32 v131, a25
    v_accvgpr_read_b32 v132, a26
    v_accvgpr_read_b32 v133, a27
    v_accvgpr_read_b32 v134, a28
    v_accvgpr_read_b32 v135, a29
    v_accvgpr_read_b32 v136, a30
    v_accvgpr_read_b32 v137, a31
    v_cvt_pk_bf16_f32 v138, v122, v123
    v_cvt_pk_bf16_f32 v139, v124, v125
    v_cvt_pk_bf16_f32 v140, v126, v127
    v_cvt_pk_bf16_f32 v141, v128, v129
    v_cvt_pk_bf16_f32 v142, v130, v131
    v_cvt_pk_bf16_f32 v143, v132, v133
    v_cvt_pk_bf16_f32 v144, v134, v135
    v_cvt_pk_bf16_f32 v145, v136, v137
    buffer_store_dwordx4 v[138:141], v96, s[32:35], s50 offen offset:0 sc1
    buffer_store_dwordx4 v[142:145], v96, s[32:35], s50 offen offset:1024 sc1
    s_add_u32 s50, s47, 264192
    v_accvgpr_read_b32 v146, a48
    v_accvgpr_read_b32 v147, a49
    v_accvgpr_read_b32 v148, a50
    v_accvgpr_read_b32 v149, a51
    v_accvgpr_read_b32 v150, a52
    v_accvgpr_read_b32 v151, a53
    v_accvgpr_read_b32 v152, a54
    v_accvgpr_read_b32 v153, a55
    v_accvgpr_read_b32 v154, a56
    v_accvgpr_read_b32 v155, a57
    v_accvgpr_read_b32 v156, a58
    v_accvgpr_read_b32 v157, a59
    v_accvgpr_read_b32 v158, a60
    v_accvgpr_read_b32 v159, a61
    v_accvgpr_read_b32 v160, a62
    v_accvgpr_read_b32 v161, a63
    v_cvt_pk_bf16_f32 v162, v146, v147
    v_cvt_pk_bf16_f32 v163, v148, v149
    v_cvt_pk_bf16_f32 v164, v150, v151
    v_cvt_pk_bf16_f32 v165, v152, v153
    v_cvt_pk_bf16_f32 v166, v154, v155
    v_cvt_pk_bf16_f32 v167, v156, v157
    v_cvt_pk_bf16_f32 v168, v158, v159
    v_cvt_pk_bf16_f32 v169, v160, v161
    buffer_store_dwordx4 v[162:165], v96, s[32:35], s50 offen offset:0 sc1
    buffer_store_dwordx4 v[166:169], v96, s[32:35], s50 offen offset:1024 sc1
    s_add_u32 s50, s47, 266240
    v_accvgpr_read_b32 v98, a80
    v_accvgpr_read_b32 v99, a81
    v_accvgpr_read_b32 v100, a82
    v_accvgpr_read_b32 v101, a83
    v_accvgpr_read_b32 v102, a84
    v_accvgpr_read_b32 v103, a85
    v_accvgpr_read_b32 v104, a86
    v_accvgpr_read_b32 v105, a87
    v_accvgpr_read_b32 v106, a88
    v_accvgpr_read_b32 v107, a89
    v_accvgpr_read_b32 v108, a90
    v_accvgpr_read_b32 v109, a91
    v_accvgpr_read_b32 v110, a92
    v_accvgpr_read_b32 v111, a93
    v_accvgpr_read_b32 v112, a94
    v_accvgpr_read_b32 v113, a95
    v_cvt_pk_bf16_f32 v114, v98, v99
    v_cvt_pk_bf16_f32 v115, v100, v101
    v_cvt_pk_bf16_f32 v116, v102, v103
    v_cvt_pk_bf16_f32 v117, v104, v105
    v_cvt_pk_bf16_f32 v118, v106, v107
    v_cvt_pk_bf16_f32 v119, v108, v109
    v_cvt_pk_bf16_f32 v120, v110, v111
    v_cvt_pk_bf16_f32 v121, v112, v113
    buffer_store_dwordx4 v[114:117], v96, s[32:35], s50 offen offset:0 sc1
    buffer_store_dwordx4 v[118:121], v96, s[32:35], s50 offen offset:1024 sc1
    s_add_u32 s50, s47, 268288
    v_accvgpr_read_b32 v122, a112
    v_accvgpr_read_b32 v123, a113
    v_accvgpr_read_b32 v124, a114
    v_accvgpr_read_b32 v125, a115
    v_accvgpr_read_b32 v126, a116
    v_accvgpr_read_b32 v127, a117
    v_accvgpr_read_b32 v128, a118
    v_accvgpr_read_b32 v129, a119
    v_accvgpr_read_b32 v130, a120
    v_accvgpr_read_b32 v131, a121
    v_accvgpr_read_b32 v132, a122
    v_accvgpr_read_b32 v133, a123
    v_accvgpr_read_b32 v134, a124
    v_accvgpr_read_b32 v135, a125
    v_accvgpr_read_b32 v136, a126
    v_accvgpr_read_b32 v137, a127
    v_cvt_pk_bf16_f32 v138, v122, v123
    v_cvt_pk_bf16_f32 v139, v124, v125
    v_cvt_pk_bf16_f32 v140, v126, v127
    v_cvt_pk_bf16_f32 v141, v128, v129
    v_cvt_pk_bf16_f32 v142, v130, v131
    v_cvt_pk_bf16_f32 v143, v132, v133
    v_cvt_pk_bf16_f32 v144, v134, v135
    v_cvt_pk_bf16_f32 v145, v136, v137
    buffer_store_dwordx4 v[138:141], v96, s[32:35], s50 offen offset:0 sc1
    buffer_store_dwordx4 v[142:145], v96, s[32:35], s50 offen offset:1024 sc1
    s_waitcnt vmcnt(0)
    s_barrier
    s_cmp_lg_u32 s46, 0
    s_cbranch_scc1 mega_kernel_q0_nf
    s_lshl_b32 s18, s14, 10
    s_lshl_b32 s19, s17, 6
    s_add_u32 s18, s18, s19
    s_lshl_b32 s19, s16, 2
    s_add_u32 s18, s18, s19
    v_mov_b32 v26, 4
    v_mov_b32 v27, 0
    s_mov_b64 exec, 1
    buffer_store_dword v26, v27, s[56:59], s18 offen sc1
    s_mov_b64 exec, -1
mega_kernel_q0_nf:
    s_cmp_lt_u32 s63, 48
    s_cbranch_scc0 mega_kernel_q2
    s_add_u32 s63, s63, 48
    s_branch mega_kernel_qloop
mega_kernel_q2:
    s_cmp_lt_u32 s61, 208
    s_cbranch_scc1 mega_kernel_qdone
    s_add_u32 s63, s63, 12
    s_cmp_lt_u32 s63, 176
    s_cbranch_scc1 mega_kernel_qloop
mega_kernel_qdone:
    s_load_dwordx2 s[70:71], s[0:1], 96
    v_mov_b32 v2, 76
    s_mov_b32 s64, 131072
    s_waitcnt lgkmcnt(0)
mega_kernel_ibp:
    global_load_dword v3, v2, s[70:71] sc1
    s_waitcnt vmcnt(0)
    v_readfirstlane_b32 s65, v3
    s_cmp_eq_u32 s65, 64
    s_cbranch_scc1 mega_kernel_ibok
    s_cmp_eq_u32 s64, 0
    s_cbranch_scc1 mega_kernel_ibok
    s_sub_u32 s64, s64, 1
    s_sleep 2
    s_branch mega_kernel_ibp
mega_kernel_ibok:
    s_cmp_lt_u32 s61, 96
    s_cbranch_scc1 mega_kernel_toW
    s_cmp_lt_u32 s61, 152
    s_cbranch_scc1 mega_kernel_toG
    s_cmp_lt_u32 s61, 160
    s_cbranch_scc1 mega_kernel_toX
    s_cmp_lt_u32 s61, 192
    s_cbranch_scc1 mega_kernel_toD
    s_cmp_lt_u32 s61, 208
    s_cbranch_scc1 mega_kernel_toR
    s_branch mega_kernel_exit
mega_kernel_toW:
    s_sub_u32 s63, s61, 64
    s_load_dwordx2 s[4:5], s[0:1], 104
    s_load_dwordx2 s[6:7], s[0:1], 40
    s_waitcnt lgkmcnt(0)
    s_mov_b32 s20, s6
    s_mov_b32 s21, s7
    s_mov_b32 s22, 8388608
    s_mov_b32 s23, 0x20000
    s_add_u32 s28, s4, 62914560
    s_addc_u32 s29, s5, 0
    s_mov_b32 s30, 16777216
    s_mov_b32 s31, 0x20000
    s_add_u32 s32, s4, 98828288
    s_addc_u32 s33, s5, 0
    s_mov_b32 s34, 33554432
    s_mov_b32 s35, 0x20000
    s_add_u32 s36, s4, 169607168
    s_addc_u32 s37, s5, 0
    s_mov_b32 s38, 548864
    s_mov_b32 s39, 0x20000
    s_and_b32 s56, s63, 7
    s_lshr_b32 s57, s63, 3
    s_mul_i32 s64, s57, 1024
    s_mul_i32 s58, s62, 256
    s_add_u32 s64, s64, s58
    s_lshl_b32 s65, s56, 8
    s_lshl_b32 s46, s64, 6
    s_lshl_b32 s68, s56, 16
    s_lshl_b32 s58, s62, 14
    s_add_u32 s68, s68, s58
    s_lshl_b32 s58, s57, 12
    s_add_u32 s68, s68, s58
    s_lshr_b32 s67, s68, 8
    s_add_u32 s67, s67, 18432
    s_lshr_b32 s66, s64, 3
    s_add_u32 s66, s66, 16384
    v_and_b32 v224, 63, v0
    v_lshlrev_b32 v1, 4, v224
    v_min_u32 v2, 1, v224
    v_lshlrev_b32 v2, 4, v2
    v_lshrrev_b32 v225, 3, v224
    v_lshrrev_b32 v226, 4, v224
    v_and_b32 v226, 1, v226
    v_lshlrev_b32 v226, 2, v226
    v_and_b32 v227, 7, v224
    v_xor_b32 v226, v226, v227
    v_mul_u32_u24 v225, 2048, v225
    v_lshl_add_u32 v6, v226, 4, v225
    v_lshrrev_b32 v225, 5, v224
    v_lshrrev_b32 v226, 2, v224
    v_and_b32 v226, 3, v226
    v_lshl_add_u32 v225, v225, 2, v226
    v_lshlrev_b32 v225, 7, v225
    v_lshrrev_b32 v227, 4, v224
    v_and_b32 v227, 1, v227
    v_lshl_add_u32 v225, v227, 5, v225
    v_and_b32 v227, 3, v224
    v_lshl_add_u32 v225, v227, 3, v225
    s_lshl_b32 s56, s62, 15
    v_add_u32 v225, s56, v225
    v_lshrrev_b32 v226, 1, v226
    v_lshl_add_u32 v4, v226, 6, v225
    v_xor_b32 v5, 64, v4
    s_lshl_b32 s56, s62, 14
    v_add_u32 v7, s56, v1
    v_add_u32 v8, 0x10000, v7
    s_lshl_b32 s56, s62, 12
    v_add_u32 v9, s56, v1
    v_add_u32 v10, 0x10000, v9
    v_lshrrev_b32 v225, 5, v224
    v_lshrrev_b32 v226, 2, v224
    v_and_b32 v226, 3, v226
    v_lshl_add_u32 v225, v225, 2, v226
    v_lshlrev_b32 v225, 7, v225
    v_lshrrev_b32 v227, 4, v224
    v_and_b32 v227, 1, v227
    v_lshl_add_u32 v225, v227, 5, v225
    v_and_b32 v227, 3, v224
    v_lshl_add_u32 v225, v227, 3, v225
    s_lshl_b32 s56, s62, 15
    v_add_u32 v225, s56, v225
    v_lshrrev_b32 v226, 1, v226
    v_lshlrev_b32 v226, 6, v226
    s_add_u32 s56, s62, 1
    s_and_b32 s56, s56, 3
    s_and_b32 s57, s56, 1
    s_lshl_b32 s57, s57, 6
    s_lshr_b32 s58, s56, 1
    s_lshl_b32 s58, s58, 13
    s_add_u32 s57, s57, s58
    v_xor_b32 v228, s57, v226
    v_add_u32 v228, v228, v225
    s_add_u32 s56, s62, 2
    s_and_b32 s56, s56, 3
    s_and_b32 s57, s56, 1
    s_lshl_b32 s57, s57, 6
    s_lshr_b32 s58, s56, 1
    s_lshl_b32 s58, s58, 13
    s_add_u32 s57, s57, s58
    v_xor_b32 v229, s57, v226
    v_add_u32 v229, v229, v225
    s_add_u32 s56, s62, 3
    s_and_b32 s56, s56, 3
    s_and_b32 s57, s56, 1
    s_lshl_b32 s57, s57, 6
    s_lshr_b32 s58, s56, 1
    s_lshl_b32 s58, s58, 13
    s_add_u32 s57, s57, s58
    v_xor_b32 v230, s57, v226
    v_add_u32 v230, v230, v225
    s_add_u32 s56, s62, 4
    s_and_b32 s56, s56, 3
    s_and_b32 s57, s56, 1
    s_lshl_b32 s57, s57, 6
    s_lshr_b32 s58, s56, 1
    s_lshl_b32 s58, s58, 13
    s_add_u32 s57, s57, s58
    v_xor_b32 v231, s57, v226
    v_add_u32 v231, v231, v225
    s_lshl_b32 s56, s62, 14
    v_add_u32 v7, s56, v1
    s_add_u32 s56, s62, 1
    s_and_b32 s56, s56, 3
    s_lshl_b32 s56, s56, 14
    s_add_u32 s56, s56, 8192
    v_add_u32 v8, s56, v1
    s_add_u32 s56, s62, 2
    s_and_b32 s56, s56, 3
    s_lshl_b32 s56, s56, 14
    s_add_u32 s56, s56, 4096
    v_add_u32 v9, s56, v1
    s_add_u32 s56, s62, 3
    s_and_b32 s56, s56, 3
    s_lshl_b32 s56, s56, 14
    s_add_u32 s56, s56, 0
    v_add_u32 v10, s56, v1
    v_mov_b32 v14, 1
    s_lshl_b32 s56, s62, 15
    s_add_u32 s56, s56, 0
    s_add_u32 s57, s64, 0
    s_mul_i32 s57, s57, 2048
    s_add_u32 s57, s57, s65
    s_add_u32 m0, s56, 0
    s_nop 0
    buffer_load_dwordx4 v6, s[20:23], s57 offen offset:0 lds
    s_add_u32 m0, s56, 8064
    s_nop 0
    buffer_load_dwordx4 v6, s[20:23], s57 offen offset:128 lds
    s_add_u32 s57, s57, 16384
    s_add_u32 m0, s56, 1024
    s_nop 0
    buffer_load_dwordx4 v6, s[20:23], s57 offen offset:0 lds
    s_add_u32 m0, s56, 9088
    s_nop 0
    buffer_load_dwordx4 v6, s[20:23], s57 offen offset:128 lds
    s_add_u32 s57, s57, 16384
    s_add_u32 m0, s56, 2048
    s_nop 0
    buffer_load_dwordx4 v6, s[20:23], s57 offen offset:0 lds
    s_add_u32 m0, s56, 10112
    s_nop 0
    buffer_load_dwordx4 v6, s[20:23], s57 offen offset:128 lds
    s_add_u32 s57, s57, 16384
    s_add_u32 m0, s56, 3072
    s_nop 0
    buffer_load_dwordx4 v6, s[20:23], s57 offen offset:0 lds
    s_add_u32 m0, s56, 11136
    s_nop 0
    buffer_load_dwordx4 v6, s[20:23], s57 offen offset:128 lds
    s_add_u32 s57, s57, 16384
    s_add_u32 m0, s56, 4096
    s_nop 0
    buffer_load_dwordx4 v6, s[20:23], s57 offen offset:0 lds
    s_add_u32 m0, s56, 12160
    s_nop 0
    buffer_load_dwordx4 v6, s[20:23], s57 offen offset:128 lds
    s_add_u32 s57, s57, 16384
    s_add_u32 m0, s56, 5120
    s_nop 0
    buffer_load_dwordx4 v6, s[20:23], s57 offen offset:0 lds
    s_add_u32 m0, s56, 13184
    s_nop 0
    buffer_load_dwordx4 v6, s[20:23], s57 offen offset:128 lds
    s_add_u32 s57, s57, 16384
    s_add_u32 m0, s56, 6144
    s_nop 0
    buffer_load_dwordx4 v6, s[20:23], s57 offen offset:0 lds
    s_add_u32 m0, s56, 14208
    s_nop 0
    buffer_load_dwordx4 v6, s[20:23], s57 offen offset:128 lds
    s_add_u32 s57, s57, 16384
    s_add_u32 m0, s56, 7168
    s_nop 0
    buffer_load_dwordx4 v6, s[20:23], s57 offen offset:0 lds
    s_add_u32 m0, s56, 15232
    s_nop 0
    buffer_load_dwordx4 v6, s[20:23], s57 offen offset:128 lds
    s_lshl_b32 s56, s62, 15
    s_add_u32 s56, s56, 16384
    s_add_u32 s57, s64, 64
    s_mul_i32 s57, s57, 2048
    s_add_u32 s57, s57, s65
    s_add_u32 m0, s56, 0
    s_nop 0
    buffer_load_dwordx4 v6, s[20:23], s57 offen offset:0 lds
    s_add_u32 m0, s56, 8064
    s_nop 0
    buffer_load_dwordx4 v6, s[20:23], s57 offen offset:128 lds
    s_add_u32 s57, s57, 16384
    s_add_u32 m0, s56, 1024
    s_nop 0
    buffer_load_dwordx4 v6, s[20:23], s57 offen offset:0 lds
    s_add_u32 m0, s56, 9088
    s_nop 0
    buffer_load_dwordx4 v6, s[20:23], s57 offen offset:128 lds
    s_add_u32 s57, s57, 16384
    s_add_u32 m0, s56, 2048
    s_nop 0
    buffer_load_dwordx4 v6, s[20:23], s57 offen offset:0 lds
    s_add_u32 m0, s56, 10112
    s_nop 0
    buffer_load_dwordx4 v6, s[20:23], s57 offen offset:128 lds
    s_add_u32 s57, s57, 16384
    s_add_u32 m0, s56, 3072
    s_nop 0
    buffer_load_dwordx4 v6, s[20:23], s57 offen offset:0 lds
    s_add_u32 m0, s56, 11136
    s_nop 0
    buffer_load_dwordx4 v6, s[20:23], s57 offen offset:128 lds
    s_add_u32 s57, s57, 16384
    s_add_u32 m0, s56, 4096
    s_nop 0
    buffer_load_dwordx4 v6, s[20:23], s57 offen offset:0 lds
    s_add_u32 m0, s56, 12160
    s_nop 0
    buffer_load_dwordx4 v6, s[20:23], s57 offen offset:128 lds
    s_add_u32 s57, s57, 16384
    s_add_u32 m0, s56, 5120
    s_nop 0
    buffer_load_dwordx4 v6, s[20:23], s57 offen offset:0 lds
    s_add_u32 m0, s56, 13184
    s_nop 0
    buffer_load_dwordx4 v6, s[20:23], s57 offen offset:128 lds
    s_add_u32 s57, s57, 16384
    s_add_u32 m0, s56, 6144
    s_nop 0
    buffer_load_dwordx4 v6, s[20:23], s57 offen offset:0 lds
    s_add_u32 m0, s56, 14208
    s_nop 0
    buffer_load_dwordx4 v6, s[20:23], s57 offen offset:128 lds
    s_add_u32 s57, s57, 16384
    s_add_u32 m0, s56, 7168
    s_nop 0
    buffer_load_dwordx4 v6, s[20:23], s57 offen offset:0 lds
    s_add_u32 m0, s56, 15232
    s_nop 0
    buffer_load_dwordx4 v6, s[20:23], s57 offen offset:128 lds
    s_waitcnt vmcnt(16)
    ds_read_b64_tr_b16 a[0:1], v228 offset:0
    ds_read_b64_tr_b16 a[2:3], v228 offset:1024
    ds_read_b64_tr_b16 a[4:5], v229 offset:0
    ds_read_b64_tr_b16 a[6:7], v229 offset:1024
    ds_read_b64_tr_b16 a[8:9], v230 offset:0
    ds_read_b64_tr_b16 a[10:11], v230 offset:1024
    ds_read_b64_tr_b16 a[12:13], v231 offset:0
    ds_read_b64_tr_b16 a[14:15], v231 offset:1024
    ds_read_b64_tr_b16 a[16:17], v228 offset:2048
    ds_read_b64_tr_b16 a[18:19], v228 offset:3072
    ds_read_b64_tr_b16 a[20:21], v229 offset:2048
    ds_read_b64_tr_b16 a[22:23], v229 offset:3072
    ds_read_b64_tr_b16 a[24:25], v230 offset:2048
    ds_read_b64_tr_b16 a[26:27], v230 offset:3072
    ds_read_b64_tr_b16 a[28:29], v231 offset:2048
    ds_read_b64_tr_b16 a[30:31], v231 offset:3072
    ds_read_b64_tr_b16 a[32:33], v228 offset:4096
    ds_read_b64_tr_b16 a[34:35], v228 offset:5120
    ds_read_b64_tr_b16 a[36:37], v229 offset:4096
    ds_read_b64_tr_b16 a[38:39], v229 offset:5120
    ds_read_b64_tr_b16 a[40:41], v230 offset:4096
    ds_read_b64_tr_b16 a[42:43], v230 offset:5120
    ds_read_b64_tr_b16 a[44:45], v231 offset:4096
    ds_read_b64_tr_b16 a[46:47], v231 offset:5120
    ds_read_b64_tr_b16 a[48:49], v228 offset:6144
    ds_read_b64_tr_b16 a[50:51], v228 offset:7168
    ds_read_b64_tr_b16 a[52:53], v229 offset:6144
    ds_read_b64_tr_b16 a[54:55], v229 offset:7168
    ds_read_b64_tr_b16 a[56:57], v230 offset:6144
    ds_read_b64_tr_b16 a[58:59], v230 offset:7168
    ds_read_b64_tr_b16 a[60:61], v231 offset:6144
    ds_read_b64_tr_b16 a[62:63], v231 offset:7168
    s_waitcnt lgkmcnt(0)
    s_lshl_b32 s56, s62, 15
    s_add_u32 s56, s56, 0
    s_add_u32 s57, s64, 128
    s_mul_i32 s57, s57, 2048
    s_add_u32 s57, s57, s65
    s_add_u32 m0, s56, 0
    s_nop 0
    buffer_load_dwordx4 v6, s[20:23], s57 offen offset:0 lds
    s_add_u32 m0, s56, 8064
    s_nop 0
    buffer_load_dwordx4 v6, s[20:23], s57 offen offset:128 lds
    s_add_u32 s57, s57, 16384
    s_add_u32 m0, s56, 1024
    s_nop 0
    buffer_load_dwordx4 v6, s[20:23], s57 offen offset:0 lds
    s_add_u32 m0, s56, 9088
    s_nop 0
    buffer_load_dwordx4 v6, s[20:23], s57 offen offset:128 lds
    s_add_u32 s57, s57, 16384
    s_add_u32 m0, s56, 2048
    s_nop 0
    buffer_load_dwordx4 v6, s[20:23], s57 offen offset:0 lds
    s_add_u32 m0, s56, 10112
    s_nop 0
    buffer_load_dwordx4 v6, s[20:23], s57 offen offset:128 lds
    s_add_u32 s57, s57, 16384
    s_add_u32 m0, s56, 3072
    s_nop 0
    buffer_load_dwordx4 v6, s[20:23], s57 offen offset:0 lds
    s_add_u32 m0, s56, 11136
    s_nop 0
    buffer_load_dwordx4 v6, s[20:23], s57 offen offset:128 lds
    s_add_u32 s57, s57, 16384
    s_add_u32 m0, s56, 4096
    s_nop 0
    buffer_load_dwordx4 v6, s[20:23], s57 offen offset:0 lds
    s_add_u32 m0, s56, 12160
    s_nop 0
    buffer_load_dwordx4 v6, s[20:23], s57 offen offset:128 lds
    s_add_u32 s57, s57, 16384
    s_add_u32 m0, s56, 5120
    s_nop 0
    buffer_load_dwordx4 v6, s[20:23], s57 offen offset:0 lds
    s_add_u32 m0, s56, 13184
    s_nop 0
    buffer_load_dwordx4 v6, s[20:23], s57 offen offset:128 lds
    s_add_u32 s57, s57, 16384
    s_add_u32 m0, s56, 6144
    s_nop 0
    buffer_load_dwordx4 v6, s[20:23], s57 offen offset:0 lds
    s_add_u32 m0, s56, 14208
    s_nop 0
    buffer_load_dwordx4 v6, s[20:23], s57 offen offset:128 lds
    s_add_u32 s57, s57, 16384
    s_add_u32 m0, s56, 7168
    s_nop 0
    buffer_load_dwordx4 v6, s[20:23], s57 offen offset:0 lds
    s_add_u32 m0, s56, 15232
    s_nop 0
    buffer_load_dwordx4 v6, s[20:23], s57 offen offset:128 lds
    s_waitcnt vmcnt(16)
    ds_read_b64_tr_b16 a[64:65], v228 offset:16384
    ds_read_b64_tr_b16 a[66:67], v228 offset:17408
    ds_read_b64_tr_b16 a[68:69], v229 offset:16384
    ds_read_b64_tr_b16 a[70:71], v229 offset:17408
    ds_read_b64_tr_b16 a[72:73], v230 offset:16384
    ds_read_b64_tr_b16 a[74:75], v230 offset:17408
    ds_read_b64_tr_b16 a[76:77], v231 offset:16384
    ds_read_b64_tr_b16 a[78:79], v231 offset:17408
    ds_read_b64_tr_b16 a[80:81], v228 offset:18432
    ds_read_b64_tr_b16 a[82:83], v228 offset:19456
    ds_read_b64_tr_b16 a[84:85], v229 offset:18432
    ds_read_b64_tr_b16 a[86:87], v229 offset:19456
    ds_read_b64_tr_b16 a[88:89], v230 offset:18432
    ds_read_b64_tr_b16 a[90:91], v230 offset:19456
    ds_read_b64_tr_b16 a[92:93], v231 offset:18432
    ds_read_b64_tr_b16 a[94:95], v231 offset:19456
    ds_read_b64_tr_b16 a[96:97], v228 offset:20480
    ds_read_b64_tr_b16 a[98:99], v228 offset:21504
    ds_read_b64_tr_b16 a[100:101], v229 offset:20480
    ds_read_b64_tr_b16 a[102:103], v229 offset:21504
    ds_read_b64_tr_b16 a[104:105], v230 offset:20480
    ds_read_b64_tr_b16 a[106:107], v230 offset:21504
    ds_read_b64_tr_b16 a[108:109], v231 offset:20480
    ds_read_b64_tr_b16 a[110:111], v231 offset:21504
    ds_read_b64_tr_b16 a[112:113], v228 offset:22528
    ds_read_b64_tr_b16 a[114:115], v228 offset:23552
    ds_read_b64_tr_b16 a[116:117], v229 offset:22528
    ds_read_b64_tr_b16 a[118:119], v229 offset:23552
    ds_read_b64_tr_b16 a[120:121], v230 offset:22528
    ds_read_b64_tr_b16 a[122:123], v230 offset:23552
    ds_read_b64_tr_b16 a[124:125], v231 offset:22528
    ds_read_b64_tr_b16 a[126:127], v231 offset:23552
    s_waitcnt lgkmcnt(0)
    s_lshl_b32 s56, s62, 15
    s_add_u32 s56, s56, 16384
    s_add_u32 s57, s64, 192
    s_mul_i32 s57, s57, 2048
    s_add_u32 s57, s57, s65
    s_add_u32 m0, s56, 0
    s_nop 0
    buffer_load_dwordx4 v6, s[20:23], s57 offen offset:0 lds
    s_add_u32 m0, s56, 8064
    s_nop 0
    buffer_load_dwordx4 v6, s[20:23], s57 offen offset:128 lds
    s_add_u32 s57, s57, 16384
    s_add_u32 m0, s56, 1024
    s_nop 0
    buffer_load_dwordx4 v6, s[20:23], s57 offen offset:0 lds
    s_add_u32 m0, s56, 9088
    s_nop 0
    buffer_load_dwordx4 v6, s[20:23], s57 offen offset:128 lds
    s_add_u32 s57, s57, 16384
    s_add_u32 m0, s56, 2048
    s_nop 0
    buffer_load_dwordx4 v6, s[20:23], s57 offen offset:0 lds
    s_add_u32 m0, s56, 10112
    s_nop 0
    buffer_load_dwordx4 v6, s[20:23], s57 offen offset:128 lds
    s_add_u32 s57, s57, 16384
    s_add_u32 m0, s56, 3072
    s_nop 0
    buffer_load_dwordx4 v6, s[20:23], s57 offen offset:0 lds
    s_add_u32 m0, s56, 11136
    s_nop 0
    buffer_load_dwordx4 v6, s[20:23], s57 offen offset:128 lds
    s_add_u32 s57, s57, 16384
    s_add_u32 m0, s56, 4096
    s_nop 0
    buffer_load_dwordx4 v6, s[20:23], s57 offen offset:0 lds
    s_add_u32 m0, s56, 12160
    s_nop 0
    buffer_load_dwordx4 v6, s[20:23], s57 offen offset:128 lds
    s_add_u32 s57, s57, 16384
    s_add_u32 m0, s56, 5120
    s_nop 0
    buffer_load_dwordx4 v6, s[20:23], s57 offen offset:0 lds
    s_add_u32 m0, s56, 13184
    s_nop 0
    buffer_load_dwordx4 v6, s[20:23], s57 offen offset:128 lds
    s_add_u32 s57, s57, 16384
    s_add_u32 m0, s56, 6144
    s_nop 0
    buffer_load_dwordx4 v6, s[20:23], s57 offen offset:0 lds
    s_add_u32 m0, s56, 14208
    s_nop 0
    buffer_load_dwordx4 v6, s[20:23], s57 offen offset:128 lds
    s_add_u32 s57, s57, 16384
    s_add_u32 m0, s56, 7168
    s_nop 0
    buffer_load_dwordx4 v6, s[20:23], s57 offen offset:0 lds
    s_add_u32 m0, s56, 15232
    s_nop 0
    buffer_load_dwordx4 v6, s[20:23], s57 offen offset:128 lds
    s_waitcnt vmcnt(16)
    ds_read_b64_tr_b16 a[128:129], v228 offset:0
    ds_read_b64_tr_b16 a[130:131], v228 offset:1024
    ds_read_b64_tr_b16 a[132:133], v229 offset:0
    ds_read_b64_tr_b16 a[134:135], v229 offset:1024
    ds_read_b64_tr_b16 a[136:137], v230 offset:0
    ds_read_b64_tr_b16 a[138:139], v230 offset:1024
    ds_read_b64_tr_b16 a[140:141], v231 offset:0
    ds_read_b64_tr_b16 a[142:143], v231 offset:1024
    ds_read_b64_tr_b16 a[144:145], v228 offset:2048
    ds_read_b64_tr_b16 a[146:147], v228 offset:3072
    ds_read_b64_tr_b16 a[148:149], v229 offset:2048
    ds_read_b64_tr_b16 a[150:151], v229 offset:3072
    ds_read_b64_tr_b16 a[152:153], v230 offset:2048
    ds_read_b64_tr_b16 a[154:155], v230 offset:3072
    ds_read_b64_tr_b16 a[156:157], v231 offset:2048
    ds_read_b64_tr_b16 a[158:159], v231 offset:3072
    ds_read_b64_tr_b16 a[160:161], v228 offset:4096
    ds_read_b64_tr_b16 a[162:163], v228 offset:5120
    ds_read_b64_tr_b16 a[164:165], v229 offset:4096
    ds_read_b64_tr_b16 a[166:167], v229 offset:5120
    ds_read_b64_tr_b16 a[168:169], v230 offset:4096
    ds_read_b64_tr_b16 a[170:171], v230 offset:5120
    ds_read_b64_tr_b16 a[172:173], v231 offset:4096
    ds_read_b64_tr_b16 a[174:175], v231 offset:5120
    ds_read_b64_tr_b16 a[176:177], v228 offset:6144
    ds_read_b64_tr_b16 a[178:179], v228 offset:7168
    ds_read_b64_tr_b16 a[180:181], v229 offset:6144
    ds_read_b64_tr_b16 a[182:183], v229 offset:7168
    ds_read_b64_tr_b16 a[184:185], v230 offset:6144
    ds_read_b64_tr_b16 a[186:187], v230 offset:7168
    ds_read_b64_tr_b16 a[188:189], v231 offset:6144
    ds_read_b64_tr_b16 a[190:191], v231 offset:7168
    s_waitcnt lgkmcnt(0)
    s_waitcnt vmcnt(0)
    ds_read_b64_tr_b16 a[192:193], v228 offset:16384
    ds_read_b64_tr_b16 a[194:195], v228 offset:17408
    ds_read_b64_tr_b16 a[196:197], v229 offset:16384
    ds_read_b64_tr_b16 a[198:199], v229 offset:17408
    ds_read_b64_tr_b16 a[200:201], v230 offset:16384
    ds_read_b64_tr_b16 a[202:203], v230 offset:17408
    ds_read_b64_tr_b16 a[204:205], v231 offset:16384
    ds_read_b64_tr_b16 a[206:207], v231 offset:17408
    ds_read_b64_tr_b16 a[208:209], v228 offset:18432
    ds_read_b64_tr_b16 a[210:211], v228 offset:19456
    ds_read_b64_tr_b16 a[212:213], v229 offset:18432
    ds_read_b64_tr_b16 a[214:215], v229 offset:19456
    ds_read_b64_tr_b16 a[216:217], v230 offset:18432
    ds_read_b64_tr_b16 a[218:219], v230 offset:19456
    ds_read_b64_tr_b16 a[220:221], v231 offset:18432
    ds_read_b64_tr_b16 a[222:223], v231 offset:19456
    ds_read_b64_tr_b16 a[224:225], v228 offset:20480
    ds_read_b64_tr_b16 a[226:227], v228 offset:21504
    ds_read_b64_tr_b16 a[228:229], v229 offset:20480
    ds_read_b64_tr_b16 a[230:231], v229 offset:21504
    ds_read_b64_tr_b16 a[232:233], v230 offset:20480
    ds_read_b64_tr_b16 a[234:235], v230 offset:21504
    ds_read_b64_tr_b16 a[236:237], v231 offset:20480
    ds_read_b64_tr_b16 a[238:239], v231 offset:21504
    ds_read_b64_tr_b16 a[240:241], v228 offset:22528
    ds_read_b64_tr_b16 a[242:243], v228 offset:23552
    ds_read_b64_tr_b16 a[244:245], v229 offset:22528
    ds_read_b64_tr_b16 a[246:247], v229 offset:23552
    ds_read_b64_tr_b16 a[248:249], v230 offset:22528
    ds_read_b64_tr_b16 a[250:251], v230 offset:23552
    ds_read_b64_tr_b16 a[252:253], v231 offset:22528
    ds_read_b64_tr_b16 a[254:255], v231 offset:23552
    s_waitcnt lgkmcnt(0)
    s_barrier
    s_mov_b32 s45, 262144
    s_mov_b32 s44, 0
    s_lshl_b32 s56, s44, 13
    s_add_u32 s52, s56, s66
    s_add_u32 s54, s56, s67
    s_mul_i32 s53, s44, 524288
    s_add_u32 s53, s53, s68
    s_mul_i32 s69, s44, 262144
    s_add_u32 s69, s69, s46
mega_kernel_W_p0:
    buffer_load_dword v3, v2, s[36:39], s52 offen sc1
    s_waitcnt vmcnt(0)
    v_cmp_eq_u32 vcc, 0, v3
    s_cbranch_vccz mega_kernel_W_p0_ok
    s_cmp_eq_u32 s45, 0
    s_cbranch_scc1 mega_kernel_W_p0_ok
    s_sub_u32 s45, s45, 1
    s_sleep 1
    s_branch mega_kernel_W_p0
mega_kernel_W_p0_ok:
    s_branch mega_kernel_W0_cold
mega_kernel_W0_deep:
    s_lshl_b32 s56, s44, 13
    s_add_u32 s52, s56, s66
    s_add_u32 s54, s56, s67
    s_mul_i32 s53, s44, 524288
    s_add_u32 s53, s53, s68
    s_mul_i32 s69, s44, 262144
    s_add_u32 s69, s69, s46
    s_waitcnt vmcnt(4)
    s_cmp_eq_u32 s44, 63
    s_cbranch_scc1 mega_kernel_W0_pre2
    v_cmp_eq_u32 vcc, 0, v3
    s_cbranch_vccnz mega_kernel_W0_pre2
    s_add_u32 s48, s69, 262144
    s_add_u32 s49, s69, 266240
    s_add_u32 s50, s69, 270336
    s_add_u32 s51, s69, 274432
    v_mfma_f32_32x32x16_bf16 v[160:175], a[0:3], v[32:35], 0
    buffer_load_dwordx4 v[96:99], v1, s[28:31], s48 offen offset:0 sc1
    v_mfma_f32_32x32x16_bf16 v[176:191], a[4:7], v[32:35], 0
    v_mfma_f32_32x32x16_bf16 v[192:207], a[8:11], v[32:35], 0
    v_mfma_f32_32x32x16_bf16 v[208:223], a[12:15], v[32:35], 0
    v_mfma_f32_32x32x16_bf16 v[160:175], a[16:19], v[36:39], v[160:175]
    buffer_load_dwordx4 v[100:103], v1, s[28:31], s48 offen offset:1024 sc1
    v_mfma_f32_32x32x16_bf16 v[176:191], a[20:23], v[36:39], v[176:191]
    v_mfma_f32_32x32x16_bf16 v[192:207], a[24:27], v[36:39], v[192:207]
    v_mfma_f32_32x32x16_bf16 v[208:223], a[28:31], v[36:39], v[208:223]
    v_mfma_f32_32x32x16_bf16 v[160:175], a[32:35], v[40:43], v[160:175]
    buffer_load_dwordx4 v[104:107], v1, s[28:31], s48 offen offset:2048 sc1
    v_mfma_f32_32x32x16_bf16 v[176:191], a[36:39], v[40:43], v[176:191]
    v_mfma_f32_32x32x16_bf16 v[192:207], a[40:43], v[40:43], v[192:207]
    v_mfma_f32_32x32x16_bf16 v[208:223], a[44:47], v[40:43], v[208:223]
    v_mfma_f32_32x32x16_bf16 v[160:175], a[48:51], v[44:47], v[160:175]
    buffer_load_dwordx4 v[108:111], v1, s[28:31], s48 offen offset:3072 sc1
    v_mfma_f32_32x32x16_bf16 v[176:191], a[52:55], v[44:47], v[176:191]
    v_mfma_f32_32x32x16_bf16 v[192:207], a[56:59], v[44:47], v[192:207]
    v_mfma_f32_32x32x16_bf16 v[208:223], a[60:63], v[44:47], v[208:223]
    v_mfma_f32_32x32x16_bf16 v[160:175], a[64:67], v[48:51], v[160:175]
    buffer_load_dwordx4 v[112:115], v1, s[28:31], s49 offen offset:0 sc1
    v_mfma_f32_32x32x16_bf16 v[176:191], a[68:71], v[48:51], v[176:191]
    v_mfma_f32_32x32x16_bf16 v[192:207], a[72:75], v[48:51], v[192:207]
    v_mfma_f32_32x32x16_bf16 v[208:223], a[76:79], v[48:51], v[208:223]
    v_mfma_f32_32x32x16_bf16 v[160:175], a[80:83], v[52:55], v[160:175]
    buffer_load_dwordx4 v[116:119], v1, s[28:31], s49 offen offset:1024 sc1
    v_mfma_f32_32x32x16_bf16 v[176:191], a[84:87], v[52:55], v[176:191]
    v_mfma_f32_32x32x16_bf16 v[192:207], a[88:91], v[52:55], v[192:207]
    v_mfma_f32_32x32x16_bf16 v[208:223], a[92:95], v[52:55], v[208:223]
    v_mfma_f32_32x32x16_bf16 v[160:175], a[96:99], v[56:59], v[160:175]
    buffer_load_dwordx4 v[120:123], v1, s[28:31], s49 offen offset:2048 sc1
    v_mfma_f32_32x32x16_bf16 v[176:191], a[100:103], v[56:59], v[176:191]
    v_mfma_f32_32x32x16_bf16 v[192:207], a[104:107], v[56:59], v[192:207]
    v_mfma_f32_32x32x16_bf16 v[208:223], a[108:111], v[56:59], v[208:223]
    v_mfma_f32_32x32x16_bf16 v[160:175], a[112:115], v[60:63], v[160:175]
    buffer_load_dwordx4 v[124:127], v1, s[28:31], s49 offen offset:3072 sc1
    v_mfma_f32_32x32x16_bf16 v[176:191], a[116:119], v[60:63], v[176:191]
    v_mfma_f32_32x32x16_bf16 v[192:207], a[120:123], v[60:63], v[192:207]
    v_mfma_f32_32x32x16_bf16 v[208:223], a[124:127], v[60:63], v[208:223]
    s_waitcnt vmcnt(8)
    s_mov_b64 exec, 1
    buffer_store_dword v14, off, s[36:39], s47 sc1
    s_mov_b64 exec, -1
    s_mov_b32 s55, 1
    s_nop 1
    s_branch mega_kernel_W0_p2d
mega_kernel_W0_pre:
    s_lshl_b32 s56, s44, 13
    s_add_u32 s52, s56, s66
    s_add_u32 s54, s56, s67
    s_mul_i32 s53, s44, 524288
    s_add_u32 s53, s53, s68
    s_mul_i32 s69, s44, 262144
    s_add_u32 s69, s69, s46
mega_kernel_W0_pre2:
    s_add_u32 s56, s52, 8192
    buffer_load_dword v3, v2, s[36:39], s56 offen sc1
    s_waitcnt vmcnt(5)
    v_mfma_f32_32x32x16_bf16 v[160:175], a[0:3], v[32:35], 0
    v_mfma_f32_32x32x16_bf16 v[176:191], a[4:7], v[32:35], 0
    v_mfma_f32_32x32x16_bf16 v[192:207], a[8:11], v[32:35], 0
    v_mfma_f32_32x32x16_bf16 v[208:223], a[12:15], v[32:35], 0
    v_mfma_f32_32x32x16_bf16 v[160:175], a[16:19], v[36:39], v[160:175]
    v_mfma_f32_32x32x16_bf16 v[176:191], a[20:23], v[36:39], v[176:191]
    v_mfma_f32_32x32x16_bf16 v[192:207], a[24:27], v[36:39], v[192:207]
    v_mfma_f32_32x32x16_bf16 v[208:223], a[28:31], v[36:39], v[208:223]
    v_mfma_f32_32x32x16_bf16 v[160:175], a[32:35], v[40:43], v[160:175]
    v_mfma_f32_32x32x16_bf16 v[176:191], a[36:39], v[40:43], v[176:191]
    v_mfma_f32_32x32x16_bf16 v[192:207], a[40:43], v[40:43], v[192:207]
    v_mfma_f32_32x32x16_bf16 v[208:223], a[44:47], v[40:43], v[208:223]
    v_mfma_f32_32x32x16_bf16 v[160:175], a[48:51], v[44:47], v[160:175]
    v_mfma_f32_32x32x16_bf16 v[176:191], a[52:55], v[44:47], v[176:191]
    v_mfma_f32_32x32x16_bf16 v[192:207], a[56:59], v[44:47], v[192:207]
    v_mfma_f32_32x32x16_bf16 v[208:223], a[60:63], v[44:47], v[208:223]
    v_mfma_f32_32x32x16_bf16 v[160:175], a[64:67], v[48:51], v[160:175]
    v_mfma_f32_32x32x16_bf16 v[176:191], a[68:71], v[48:51], v[176:191]
    v_mfma_f32_32x32x16_bf16 v[192:207], a[72:75], v[48:51], v[192:207]
    v_mfma_f32_32x32x16_bf16 v[208:223], a[76:79], v[48:51], v[208:223]
    v_mfma_f32_32x32x16_bf16 v[160:175], a[80:83], v[52:55], v[160:175]
    v_mfma_f32_32x32x16_bf16 v[176:191], a[84:87], v[52:55], v[176:191]
    v_mfma_f32_32x32x16_bf16 v[192:207], a[88:91], v[52:55], v[192:207]
    v_mfma_f32_32x32x16_bf16 v[208:223], a[92:95], v[52:55], v[208:223]
    v_mfma_f32_32x32x16_bf16 v[160:175], a[96:99], v[56:59], v[160:175]
    v_mfma_f32_32x32x16_bf16 v[176:191], a[100:103], v[56:59], v[176:191]
    v_mfma_f32_32x32x16_bf16 v[192:207], a[104:107], v[56:59], v[192:207]
    v_mfma_f32_32x32x16_bf16 v[208:223], a[108:111], v[56:59], v[208:223]
    v_mfma_f32_32x32x16_bf16 v[160:175], a[112:115], v[60:63], v[160:175]
    v_mfma_f32_32x32x16_bf16 v[176:191], a[116:119], v[60:63], v[176:191]
    v_mfma_f32_32x32x16_bf16 v[192:207], a[120:123], v[60:63], v[192:207]
    v_mfma_f32_32x32x16_bf16 v[208:223], a[124:127], v[60:63], v[208:223]
    s_waitcnt vmcnt(0)
    s_mov_b64 exec, 1
    buffer_store_dword v14, off, s[36:39], s47 sc1
    s_mov_b64 exec, -1
    s_branch mega_kernel_W0_mid
mega_kernel_W0_cold:
    s_add_u32 s48, s69, 0
    s_add_u32 s49, s69, 4096
    s_add_u32 s50, s69, 8192
    s_add_u32 s51, s69, 12288
    buffer_load_dwordx4 v[32:35], v1, s[28:31], s48 offen offset:0 sc1
    buffer_load_dwordx4 v[36:39], v1, s[28:31], s48 offen offset:1024 sc1
    buffer_load_dwordx4 v[40:43], v1, s[28:31], s48 offen offset:2048 sc1
    buffer_load_dwordx4 v[44:47], v1, s[28:31], s48 offen offset:3072 sc1
    buffer_load_dwordx4 v[48:51], v1, s[28:31], s49 offen offset:0 sc1
    buffer_load_dwordx4 v[52:55], v1, s[28:31], s49 offen offset:1024 sc1
    buffer_load_dwordx4 v[56:59], v1, s[28:31], s49 offen offset:2048 sc1
    buffer_load_dwordx4 v[60:63], v1, s[28:31], s49 offen offset:3072 sc1
    s_waitcnt vmcnt(7)
    v_mfma_f32_32x32x16_bf16 v[160:175], a[0:3], v[32:35], 0
    buffer_load_dwordx4 v[64:67], v1, s[28:31], s50 offen offset:0 sc1
    v_mfma_f32_32x32x16_bf16 v[176:191], a[4:7], v[32:35], 0
    v_mfma_f32_32x32x16_bf16 v[192:207], a[8:11], v[32:35], 0
    buffer_load_dwordx4 v[68:71], v1, s[28:31], s50 offen offset:1024 sc1
    v_mfma_f32_32x32x16_bf16 v[208:223], a[12:15], v[32:35], 0
    s_waitcnt vmcnt(8)
    v_mfma_f32_32x32x16_bf16 v[160:175], a[16:19], v[36:39], v[160:175]
    buffer_load_dwordx4 v[72:75], v1, s[28:31], s50 offen offset:2048 sc1
    v_mfma_f32_32x32x16_bf16 v[176:191], a[20:23], v[36:39], v[176:191]
    v_mfma_f32_32x32x16_bf16 v[192:207], a[24:27], v[36:39], v[192:207]
    buffer_load_dwordx4 v[76:79], v1, s[28:31], s50 offen offset:3072 sc1
    v_mfma_f32_32x32x16_bf16 v[208:223], a[28:31], v[36:39], v[208:223]
    s_waitcnt vmcnt(9)
    v_mfma_f32_32x32x16_bf16 v[160:175], a[32:35], v[40:43], v[160:175]
    buffer_load_dwordx4 v[80:83], v1, s[28:31], s51 offen offset:0 sc1
    v_mfma_f32_32x32x16_bf16 v[176:191], a[36:39], v[40:43], v[176:191]
    v_mfma_f32_32x32x16_bf16 v[192:207], a[40:43], v[40:43], v[192:207]
    buffer_load_dwordx4 v[84:87], v1, s[28:31], s51 offen offset:1024 sc1
    v_mfma_f32_32x32x16_bf16 v[208:223], a[44:47], v[40:43], v[208:223]
    s_waitcnt vmcnt(10)
    v_mfma_f32_32x32x16_bf16 v[160:175], a[48:51], v[44:47], v[160:175]
    buffer_load_dwordx4 v[88:91], v1, s[28:31], s51 offen offset:2048 sc1
    v_mfma_f32_32x32x16_bf16 v[176:191], a[52:55], v[44:47], v[176:191]
    v_mfma_f32_32x32x16_bf16 v[192:207], a[56:59], v[44:47], v[192:207]
    buffer_load_dwordx4 v[92:95], v1, s[28:31], s51 offen offset:3072 sc1
    s_add_u32 s56, s52, 8192
    buffer_load_dword v3, v2, s[36:39], s56 offen sc1
    v_mfma_f32_32x32x16_bf16 v[208:223], a[60:63], v[44:47], v[208:223]
    s_waitcnt vmcnt(12)
    v_mfma_f32_32x32x16_bf16 v[160:175], a[64:67], v[48:51], v[160:175]
    v_mfma_f32_32x32x16_bf16 v[176:191], a[68:71], v[48:51], v[176:191]
    v_mfma_f32_32x32x16_bf16 v[192:207], a[72:75], v[48:51], v[192:207]
    v_mfma_f32_32x32x16_bf16 v[208:223], a[76:79], v[48:51], v[208:223]
    s_waitcnt vmcnt(11)
    v_mfma_f32_32x32x16_bf16 v[160:175], a[80:83], v[52:55], v[160:175]
    v_mfma_f32_32x32x16_bf16 v[176:191], a[84:87], v[52:55], v[176:191]
    v_mfma_f32_32x32x16_bf16 v[192:207], a[88:91], v[52:55], v[192:207]
    v_mfma_f32_32x32x16_bf16 v[208:223], a[92:95], v[52:55], v[208:223]
    s_waitcnt vmcnt(10)
    v_mfma_f32_32x32x16_bf16 v[160:175], a[96:99], v[56:59], v[160:175]
    v_mfma_f32_32x32x16_bf16 v[176:191], a[100:103], v[56:59], v[176:191]
    v_mfma_f32_32x32x16_bf16 v[192:207], a[104:107], v[56:59], v[192:207]
    v_mfma_f32_32x32x16_bf16 v[208:223], a[108:111], v[56:59], v[208:223]
    s_waitcnt vmcnt(9)
    v_mfma_f32_32x32x16_bf16 v[160:175], a[112:115], v[60:63], v[160:175]
    v_mfma_f32_32x32x16_bf16 v[176:191], a[116:119], v[60:63], v[176:191]
    v_mfma_f32_32x32x16_bf16 v[192:207], a[120:123], v[60:63], v[192:207]
    v_mfma_f32_32x32x16_bf16 v[208:223], a[124:127], v[60:63], v[208:223]
    s_waitcnt vmcnt(0)
mega_kernel_W0_mid:
    s_mov_b32 s55, 0
    s_cmp_eq_u32 s44, 63
    s_cbranch_scc1 mega_kernel_W0_p2n
    v_cmp_eq_u32 vcc, 0, v3
    s_cbranch_vccnz mega_kernel_W0_p2n
    s_mov_b32 s55, 1
    s_add_u32 s48, s69, 262144
    s_add_u32 s49, s69, 266240
    s_add_u32 s50, s69, 270336
    s_add_u32 s51, s69, 274432
    s_add_u32 s56, s52, 16384
    v_mfma_f32_32x32x16_bf16 v[160:175], a[128:131], v[64:67], v[160:175]
    v_mfma_f32_32x32x16_bf16 v[160:175], a[144:147], v[68:71], v[160:175]
    buffer_load_dwordx4 v[96:99], v1, s[28:31], s48 offen offset:0 sc1
    v_mfma_f32_32x32x16_bf16 v[160:175], a[160:163], v[72:75], v[160:175]
    v_mfma_f32_32x32x16_bf16 v[160:175], a[176:179], v[76:79], v[160:175]
    v_mfma_f32_32x32x16_bf16 v[160:175], a[192:195], v[80:83], v[160:175]
    buffer_load_dwordx4 v[100:103], v1, s[28:31], s48 offen offset:1024 sc1
    v_mfma_f32_32x32x16_bf16 v[160:175], a[208:211], v[84:87], v[160:175]
    v_mfma_f32_32x32x16_bf16 v[160:175], a[224:227], v[88:91], v[160:175]
    v_mfma_f32_32x32x16_bf16 v[160:175], a[240:243], v[92:95], v[160:175]
    v_mfma_f32_32x32x16_bf16 v[176:191], a[132:135], v[64:67], v[176:191]
    v_mfma_f32_32x32x16_bf16 v[176:191], a[148:151], v[68:71], v[176:191]
    s_nop 9
    ds_write_b128 v7, v[160:163] offset:0
    v_mfma_f32_32x32x16_bf16 v[176:191], a[164:167], v[72:75], v[176:191]
    buffer_load_dwordx4 v[104:107], v1, s[28:31], s48 offen offset:2048 sc1
    v_mfma_f32_32x32x16_bf16 v[176:191], a[180:183], v[76:79], v[176:191]
    ds_write_b128 v7, v[164:167] offset:1024
    v_mfma_f32_32x32x16_bf16 v[176:191], a[196:199], v[80:83], v[176:191]
    buffer_load_dwordx4 v[108:111], v1, s[28:31], s48 offen offset:3072 sc1
    v_mfma_f32_32x32x16_bf16 v[176:191], a[212:215], v[84:87], v[176:191]
    ds_write_b128 v7, v[168:171] offset:2048
    v_mfma_f32_32x32x16_bf16 v[176:191], a[228:231], v[88:91], v[176:191]
    ds_write_b128 v7, v[172:175] offset:3072
    v_mfma_f32_32x32x16_bf16 v[176:191], a[244:247], v[92:95], v[176:191]
    v_mfma_f32_32x32x16_bf16 v[192:207], a[136:139], v[64:67], v[192:207]
    v_mfma_f32_32x32x16_bf16 v[192:207], a[152:155], v[68:71], v[192:207]
    s_nop 9
    ds_write_b128 v7, v[176:179] offset:4096
    v_mfma_f32_32x32x16_bf16 v[192:207], a[168:171], v[72:75], v[192:207]
    buffer_load_dwordx4 v[112:115], v1, s[28:31], s49 offen offset:0 sc1
    v_mfma_f32_32x32x16_bf16 v[192:207], a[184:187], v[76:79], v[192:207]
    ds_write_b128 v7, v[180:183] offset:5120
    v_mfma_f32_32x32x16_bf16 v[192:207], a[200:203], v[80:83], v[192:207]
    buffer_load_dwordx4 v[116:119], v1, s[28:31], s49 offen offset:1024 sc1
    v_mfma_f32_32x32x16_bf16 v[192:207], a[216:219], v[84:87], v[192:207]
    ds_write_b128 v7, v[184:187] offset:6144
    v_mfma_f32_32x32x16_bf16 v[192:207], a[232:235], v[88:91], v[192:207]
    ds_write_b128 v7, v[188:191] offset:7168
    v_mfma_f32_32x32x16_bf16 v[192:207], a[248:251], v[92:95], v[192:207]
    v_mfma_f32_32x32x16_bf16 v[208:223], a[140:143], v[64:67], v[208:223]
    v_mfma_f32_32x32x16_bf16 v[208:223], a[156:159], v[68:71], v[208:223]
    s_nop 9
    ds_write_b128 v7, v[192:195] offset:8192
    v_mfma_f32_32x32x16_bf16 v[208:223], a[172:175], v[72:75], v[208:223]
    buffer_load_dwordx4 v[120:123], v1, s[28:31], s49 offen offset:2048 sc1
    v_mfma_f32_32x32x16_bf16 v[208:223], a[188:191], v[76:79], v[208:223]
    ds_write_b128 v7, v[196:199] offset:9216
    v_mfma_f32_32x32x16_bf16 v[208:223], a[204:207], v[80:83], v[208:223]
    buffer_load_dwordx4 v[124:127], v1, s[28:31], s49 offen offset:3072 sc1
    v_mfma_f32_32x32x16_bf16 v[208:223], a[220:223], v[84:87], v[208:223]
    ds_write_b128 v7, v[200:203] offset:10240
    v_mfma_f32_32x32x16_bf16 v[208:223], a[236:239], v[88:91], v[208:223]
    ds_write_b128 v7, v[204:207] offset:11264
    v_mfma_f32_32x32x16_bf16 v[208:223], a[252:255], v[92:95], v[208:223]
    s_waitcnt lgkmcnt(0)
    s_barrier
    ds_read_b128 v[160:163], v8 offset:0
    ds_read_b128 v[164:167], v8 offset:1024
    ds_read_b128 v[168:171], v8 offset:2048
    ds_read_b128 v[172:175], v8 offset:3072
    ds_read_b128 v[176:179], v9 offset:0
    ds_read_b128 v[180:183], v9 offset:1024
    ds_read_b128 v[184:187], v9 offset:2048
    ds_read_b128 v[188:191], v9 offset:3072
    ds_read_b128 v[192:195], v10 offset:0
    ds_read_b128 v[196:199], v10 offset:1024
    ds_read_b128 v[200:203], v10 offset:2048
    ds_read_b128 v[204:207], v10 offset:3072
    buffer_load_dwordx4 v[128:131], v1, s[28:31], s50 offen offset:0 sc1
    buffer_load_dwordx4 v[132:135], v1, s[28:31], s50 offen offset:1024 sc1
    buffer_load_dwordx4 v[136:139], v1, s[28:31], s50 offen offset:2048 sc1
    buffer_load_dwordx4 v[140:143], v1, s[28:31], s50 offen offset:3072 sc1
    buffer_load_dwordx4 v[144:147], v1, s[28:31], s51 offen offset:0 sc1
    s_waitcnt lgkmcnt(8)
    buffer_load_dwordx4 v[148:151], v1, s[28:31], s51 offen offset:1024 sc1
    v_add_f32 v32, v208, v160
    v_add_f32 v33, v209, v161
    v_add_f32 v34, v210, v162
    v_add_f32 v35, v211, v163
    v_add_f32 v36, v212, v164
    v_add_f32 v37, v213, v165
    v_add_f32 v38, v214, v166
    v_add_f32 v39, v215, v167
    v_add_f32 v40, v216, v168
    v_add_f32 v41, v217, v169
    v_add_f32 v42, v218, v170
    v_add_f32 v43, v219, v171
    v_add_f32 v44, v220, v172
    buffer_load_dwordx4 v[152:155], v1, s[28:31], s51 offen offset:2048 sc1
    v_add_f32 v45, v221, v173
    v_add_f32 v46, v222, v174
    v_add_f32 v47, v223, v175
    s_waitcnt lgkmcnt(0)
    v_add_f32 v176, v176, v192
    v_add_f32 v177, v177, v193
    v_add_f32 v178, v178, v194
    v_add_f32 v179, v179, v195
    v_add_f32 v180, v180, v196
    v_add_f32 v181, v181, v197
    v_add_f32 v182, v182, v198
    v_add_f32 v183, v183, v199
    v_add_f32 v184, v184, v200
    v_add_f32 v185, v185, v201
    buffer_load_dwordx4 v[156:159], v1, s[28:31], s51 offen offset:3072 sc1
    v_add_f32 v186, v186, v202
    v_add_f32 v187, v187, v203
    v_add_f32 v188, v188, v204
    v_add_f32 v189, v189, v205
    v_add_f32 v190, v190, v206
    v_add_f32 v191, v191, v207
    v_add_f32 v32, v32, v176
    v_add_f32 v33, v33, v177
    v_add_f32 v34, v34, v178
    v_add_f32 v35, v35, v179
    v_add_f32 v36, v36, v180
    v_add_f32 v37, v37, v181
    v_add_f32 v38, v38, v182
    buffer_load_dword v3, v2, s[36:39], s56 offen sc1
    v_add_f32 v39, v39, v183
    v_add_f32 v40, v40, v184
    v_add_f32 v41, v41, v185
    v_add_f32 v42, v42, v186
    v_add_f32 v43, v43, v187
    v_add_f32 v44, v44, v188
    v_add_f32 v45, v45, v189
    v_add_f32 v46, v46, v190
    v_add_f32 v47, v47, v191
    v_xor_b32 v7, 0x10000, v7
    v_xor_b32 v8, 0x10000, v8
    v_xor_b32 v9, 0x10000, v9
    v_xor_b32 v10, 0x10000, v10
    buffer_store_dwordx4 v[32:35], v1, s[32:35], s53 offen offset:0 sc1
    buffer_store_dwordx4 v[36:39], v1, s[32:35], s53 offen offset:1024 sc1
    buffer_store_dwordx4 v[40:43], v1, s[32:35], s53 offen offset:2048 sc1
    buffer_store_dwordx4 v[44:47], v1, s[32:35], s53 offen offset:3072 sc1
    s_branch mega_kernel_W0_post
mega_kernel_W0_p2d:
    s_add_u32 s56, s52, 16384
    v_mfma_f32_32x32x16_bf16 v[160:175], a[128:131], v[64:67], v[160:175]
    v_mfma_f32_32x32x16_bf16 v[160:175], a[144:147], v[68:71], v[160:175]
    buffer_load_dwordx4 v[128:131], v1, s[28:31], s50 offen offset:0 sc1
    v_mfma_f32_32x32x16_bf16 v[160:175], a[160:163], v[72:75], v[160:175]
    v_mfma_f32_32x32x16_bf16 v[160:175], a[176:179], v[76:79], v[160:175]
    buffer_load_dwordx4 v[132:135], v1, s[28:31], s50 offen offset:1024 sc1
    v_mfma_f32_32x32x16_bf16 v[160:175], a[192:195], v[80:83], v[160:175]
    v_mfma_f32_32x32x16_bf16 v[160:175], a[208:211], v[84:87], v[160:175]
    buffer_load_dwordx4 v[136:139], v1, s[28:31], s50 offen offset:2048 sc1
    v_mfma_f32_32x32x16_bf16 v[160:175], a[224:227], v[88:91], v[160:175]
    v_mfma_f32_32x32x16_bf16 v[160:175], a[240:243], v[92:95], v[160:175]
    v_mfma_f32_32x32x16_bf16 v[176:191], a[132:135], v[64:67], v[176:191]
    v_mfma_f32_32x32x16_bf16 v[176:191], a[148:151], v[68:71], v[176:191]
    s_nop 9
    ds_write_b128 v7, v[160:163] offset:0
    v_mfma_f32_32x32x16_bf16 v[176:191], a[164:167], v[72:75], v[176:191]
    buffer_load_dwordx4 v[140:143], v1, s[28:31], s50 offen offset:3072 sc1
    v_mfma_f32_32x32x16_bf16 v[176:191], a[180:183], v[76:79], v[176:191]
    ds_write_b128 v7, v[164:167] offset:1024
    v_mfma_f32_32x32x16_bf16 v[176:191], a[196:199], v[80:83], v[176:191]
    buffer_load_dwordx4 v[144:147], v1, s[28:31], s51 offen offset:0 sc1
    v_mfma_f32_32x32x16_bf16 v[176:191], a[212:215], v[84:87], v[176:191]
    ds_write_b128 v7, v[168:171] offset:2048
    v_mfma_f32_32x32x16_bf16 v[176:191], a[228:231], v[88:91], v[176:191]
    buffer_load_dwordx4 v[148:151], v1, s[28:31], s51 offen offset:1024 sc1
    v_mfma_f32_32x32x16_bf16 v[176:191], a[244:247], v[92:95], v[176:191]
    ds_write_b128 v7, v[172:175] offset:3072
    v_mfma_f32_32x32x16_bf16 v[192:207], a[136:139], v[64:67], v[192:207]
    v_mfma_f32_32x32x16_bf16 v[192:207], a[152:155], v[68:71], v[192:207]
    s_nop 8
    ds_write_b128 v7, v[176:179] offset:4096
    v_mfma_f32_32x32x16_bf16 v[192:207], a[168:171], v[72:75], v[192:207]
    buffer_load_dwordx4 v[152:155], v1, s[28:31], s51 offen offset:2048 sc1
    v_mfma_f32_32x32x16_bf16 v[192:207], a[184:187], v[76:79], v[192:207]
    ds_write_b128 v7, v[180:183] offset:5120
    v_mfma_f32_32x32x16_bf16 v[192:207], a[200:203], v[80:83], v[192:207]
    buffer_load_dwordx4 v[156:159], v1, s[28:31], s51 offen offset:3072 sc1
    v_mfma_f32_32x32x16_bf16 v[192:207], a[216:219], v[84:87], v[192:207]
    ds_write_b128 v7, v[184:187] offset:6144
    v_mfma_f32_32x32x16_bf16 v[192:207], a[232:235], v[88:91], v[192:207]
    buffer_load_dword v3, v2, s[36:39], s56 offen sc1
    v_mfma_f32_32x32x16_bf16 v[192:207], a[248:251], v[92:95], v[192:207]
    ds_write_b128 v7, v[188:191] offset:7168
    v_mfma_f32_32x32x16_bf16 v[208:223], a[140:143], v[64:67], v[208:223]
    v_mfma_f32_32x32x16_bf16 v[208:223], a[156:159], v[68:71], v[208:223]
    s_nop 8
    ds_write_b128 v7, v[192:195] offset:8192
    v_mfma_f32_32x32x16_bf16 v[208:223], a[172:175], v[72:75], v[208:223]
    ds_write_b128 v7, v[196:199] offset:9216
    v_mfma_f32_32x32x16_bf16 v[208:223], a[188:191], v[76:79], v[208:223]
    v_mfma_f32_32x32x16_bf16 v[208:223], a[204:207], v[80:83], v[208:223]
    ds_write_b128 v7, v[200:203] offset:10240
    v_mfma_f32_32x32x16_bf16 v[208:223], a[220:223], v[84:87], v[208:223]
    v_mfma_f32_32x32x16_bf16 v[208:223], a[236:239], v[88:91], v[208:223]
    ds_write_b128 v7, v[204:207] offset:11264
    v_mfma_f32_32x32x16_bf16 v[208:223], a[252:255], v[92:95], v[208:223]
    s_branch mega_kernel_W0_red
mega_kernel_W0_p2n:
    v_mfma_f32_32x32x16_bf16 v[160:175], a[128:131], v[64:67], v[160:175]
    v_mfma_f32_32x32x16_bf16 v[160:175], a[144:147], v[68:71], v[160:175]
    v_mfma_f32_32x32x16_bf16 v[160:175], a[160:163], v[72:75], v[160:175]
    v_mfma_f32_32x32x16_bf16 v[160:175], a[176:179], v[76:79], v[160:175]
    v_mfma_f32_32x32x16_bf16 v[160:175], a[192:195], v[80:83], v[160:175]
    v_mfma_f32_32x32x16_bf16 v[160:175], a[208:211], v[84:87], v[160:175]
    v_mfma_f32_32x32x16_bf16 v[160:175], a[224:227], v[88:91], v[160:175]
    v_mfma_f32_32x32x16_bf16 v[160:175], a[240:243], v[92:95], v[160:175]
    s_add_u32 s56, s52, 8192
    buffer_load_dword v3, v2, s[36:39], s56 offen sc1
    v_mfma_f32_32x32x16_bf16 v[176:191], a[132:135], v[64:67], v[176:191]
    v_mfma_f32_32x32x16_bf16 v[176:191], a[148:151], v[68:71], v[176:191]
    s_nop 7
    ds_write_b128 v7, v[160:163] offset:0
    v_mfma_f32_32x32x16_bf16 v[176:191], a[164:167], v[72:75], v[176:191]
    ds_write_b128 v7, v[164:167] offset:1024
    v_mfma_f32_32x32x16_bf16 v[176:191], a[180:183], v[76:79], v[176:191]
    v_mfma_f32_32x32x16_bf16 v[176:191], a[196:199], v[80:83], v[176:191]
    ds_write_b128 v7, v[168:171] offset:2048
    v_mfma_f32_32x32x16_bf16 v[176:191], a[212:215], v[84:87], v[176:191]
    v_mfma_f32_32x32x16_bf16 v[176:191], a[228:231], v[88:91], v[176:191]
    ds_write_b128 v7, v[172:175] offset:3072
    v_mfma_f32_32x32x16_bf16 v[176:191], a[244:247], v[92:95], v[176:191]
    v_mfma_f32_32x32x16_bf16 v[192:207], a[136:139], v[64:67], v[192:207]
    v_mfma_f32_32x32x16_bf16 v[192:207], a[152:155], v[68:71], v[192:207]
    s_nop 9
    ds_write_b128 v7, v[176:179] offset:4096
    v_mfma_f32_32x32x16_bf16 v[192:207], a[168:171], v[72:75], v[192:207]
    ds_write_b128 v7, v[180:183] offset:5120
    v_mfma_f32_32x32x16_bf16 v[192:207], a[184:187], v[76:79], v[192:207]
    v_mfma_f32_32x32x16_bf16 v[192:207], a[200:203], v[80:83], v[192:207]
    ds_write_b128 v7, v[184:187] offset:6144
    v_mfma_f32_32x32x16_bf16 v[192:207], a[216:219], v[84:87], v[192:207]
    v_mfma_f32_32x32x16_bf16 v[192:207], a[232:235], v[88:91], v[192:207]
    ds_write_b128 v7, v[188:191] offset:7168
    v_mfma_f32_32x32x16_bf16 v[192:207], a[248:251], v[92:95], v[192:207]
    v_mfma_f32_32x32x16_bf16 v[208:223], a[140:143], v[64:67], v[208:223]
    v_mfma_f32_32x32x16_bf16 v[208:223], a[156:159], v[68:71], v[208:223]
    s_nop 9
    ds_write_b128 v7, v[192:195] offset:8192
    v_mfma_f32_32x32x16_bf16 v[208:223], a[172:175], v[72:75], v[208:223]
    ds_write_b128 v7, v[196:199] offset:9216
    v_mfma_f32_32x32x16_bf16 v[208:223], a[188:191], v[76:79], v[208:223]
    v_mfma_f32_32x32x16_bf16 v[208:223], a[204:207], v[80:83], v[208:223]
    ds_write_b128 v7, v[200:203] offset:10240
    v_mfma_f32_32x32x16_bf16 v[208:223], a[220:223], v[84:87], v[208:223]
    v_mfma_f32_32x32x16_bf16 v[208:223], a[236:239], v[88:91], v[208:223]
    ds_write_b128 v7, v[204:207] offset:11264
    v_mfma_f32_32x32x16_bf16 v[208:223], a[252:255], v[92:95], v[208:223]
    s_waitcnt lgkmcnt(0)
    s_barrier
    s_cmp_eq_u32 s44, 63
    s_cbranch_scc1 mega_kernel_W0_red2
    s_waitcnt vmcnt(0)
    v_cmp_eq_u32 vcc, 0, v3
    s_cbranch_vccnz mega_kernel_W0_red2
    s_mov_b32 s55, 1
    s_add_u32 s48, s69, 262144
    s_add_u32 s49, s69, 266240
    s_add_u32 s50, s69, 270336
    s_add_u32 s51, s69, 274432
    s_add_u32 s56, s52, 16384
    ds_read_b128 v[160:163], v8 offset:0
    ds_read_b128 v[164:167], v8 offset:1024
    ds_read_b128 v[168:171], v8 offset:2048
    ds_read_b128 v[172:175], v8 offset:3072
    ds_read_b128 v[176:179], v9 offset:0
    ds_read_b128 v[180:183], v9 offset:1024
    ds_read_b128 v[184:187], v9 offset:2048
    ds_read_b128 v[188:191], v9 offset:3072
    ds_read_b128 v[192:195], v10 offset:0
    ds_read_b128 v[196:199], v10 offset:1024
    ds_read_b128 v[200:203], v10 offset:2048
    ds_read_b128 v[204:207], v10 offset:3072
    buffer_load_dwordx4 v[96:99], v1, s[28:31], s48 offen offset:0 sc1
    buffer_load_dwordx4 v[100:103], v1, s[28:31], s48 offen offset:1024 sc1
    buffer_load_dwordx4 v[104:107], v1, s[28:31], s48 offen offset:2048 sc1
    buffer_load_dwordx4 v[108:111], v1, s[28:31], s48 offen offset:3072 sc1
    buffer_load_dwordx4 v[112:115], v1, s[28:31], s49 offen offset:0 sc1
    buffer_load_dwordx4 v[116:119], v1, s[28:31], s49 offen offset:1024 sc1
    buffer_load_dwordx4 v[120:123], v1, s[28:31], s49 offen offset:2048 sc1
    buffer_load_dwordx4 v[124:127], v1, s[28:31], s49 offen offset:3072 sc1
    s_waitcnt lgkmcnt(8)
    buffer_load_dwordx4 v[128:131], v1, s[28:31], s50 offen offset:0 sc1
    v_add_f32 v32, v208, v160
    v_add_f32 v33, v209, v161
    v_add_f32 v34, v210, v162
    v_add_f32 v35, v211, v163
    v_add_f32 v36, v212, v164
    v_add_f32 v37, v213, v165
    buffer_load_dwordx4 v[132:135], v1, s[28:31], s50 offen offset:1024 sc1
    v_add_f32 v38, v214, v166
    v_add_f32 v39, v215, v167
    v_add_f32 v40, v216, v168
    v_add_f32 v41, v217, v169
    v_add_f32 v42, v218, v170
    v_add_f32 v43, v219, v171
    buffer_load_dwordx4 v[136:139], v1, s[28:31], s50 offen offset:2048 sc1
    v_add_f32 v44, v220, v172
    v_add_f32 v45, v221, v173
    v_add_f32 v46, v222, v174
    v_add_f32 v47, v223, v175
    s_waitcnt lgkmcnt(0)
    v_add_f32 v176, v176, v192
    buffer_load_dwordx4 v[140:143], v1, s[28:31], s50 offen offset:3072 sc1
    v_add_f32 v177, v177, v193
    v_add_f32 v178, v178, v194
    v_add_f32 v179, v179, v195
    v_add_f32 v180, v180, v196
    v_add_f32 v181, v181, v197
    v_add_f32 v182, v182, v198
    buffer_load_dwordx4 v[144:147], v1, s[28:31], s51 offen offset:0 sc1
    v_add_f32 v183, v183, v199
    v_add_f32 v184, v184, v200
    v_add_f32 v185, v185, v201
    v_add_f32 v186, v186, v202
    v_add_f32 v187, v187, v203
    v_add_f32 v188, v188, v204
    buffer_load_dwordx4 v[148:151], v1, s[28:31], s51 offen offset:1024 sc1
    v_add_f32 v189, v189, v205
    v_add_f32 v190, v190, v206
    v_add_f32 v191, v191, v207
    v_add_f32 v32, v32, v176
    v_add_f32 v33, v33, v177
    v_add_f32 v34, v34, v178
    buffer_load_dwordx4 v[152:155], v1, s[28:31], s51 offen offset:2048 sc1
    v_add_f32 v35, v35, v179
    v_add_f32 v36, v36, v180
    v_add_f32 v37, v37, v181
    v_add_f32 v38, v38, v182
    v_add_f32 v39, v39, v183
    v_add_f32 v40, v40, v184
    buffer_load_dwordx4 v[156:159], v1, s[28:31], s51 offen offset:3072 sc1
    v_add_f32 v41, v41, v185
    v_add_f32 v42, v42, v186
    v_add_f32 v43, v43, v187
    v_add_f32 v44, v44, v188
    v_add_f32 v45, v45, v189
    v_add_f32 v46, v46, v190
    buffer_load_dword v3, v2, s[36:39], s56 offen sc1
    v_add_f32 v47, v47, v191
    v_xor_b32 v7, 0x10000, v7
    v_xor_b32 v8, 0x10000, v8
    v_xor_b32 v9, 0x10000, v9
    v_xor_b32 v10, 0x10000, v10
    buffer_store_dwordx4 v[32:35], v1, s[32:35], s53 offen offset:0 sc1
    buffer_store_dwordx4 v[36:39], v1, s[32:35], s53 offen offset:1024 sc1
    buffer_store_dwordx4 v[40:43], v1, s[32:35], s53 offen offset:2048 sc1
    buffer_store_dwordx4 v[44:47], v1, s[32:35], s53 offen offset:3072 sc1
    s_branch mega_kernel_W0_post
mega_kernel_W0_red:
    s_waitcnt lgkmcnt(0)
    s_barrier
mega_kernel_W0_red2:
    ds_read_b128 v[160:163], v8 offset:0
    ds_read_b128 v[164:167], v8 offset:1024
    ds_read_b128 v[168:171], v8 offset:2048
    ds_read_b128 v[172:175], v8 offset:3072
    ds_read_b128 v[176:179], v9 offset:0
    ds_read_b128 v[180:183], v9 offset:1024
    ds_read_b128 v[184:187], v9 offset:2048
    ds_read_b128 v[188:191], v9 offset:3072
    ds_read_b128 v[192:195], v10 offset:0
    ds_read_b128 v[196:199], v10 offset:1024
    ds_read_b128 v[200:203], v10 offset:2048
    ds_read_b128 v[204:207], v10 offset:3072
    s_waitcnt lgkmcnt(8)
    v_add_f32 v32, v208, v160
    v_add_f32 v33, v209, v161
    v_add_f32 v34, v210, v162
    v_add_f32 v35, v211, v163
    v_add_f32 v36, v212, v164
    v_add_f32 v37, v213, v165
    v_add_f32 v38, v214, v166
    v_add_f32 v39, v215, v167
    v_add_f32 v40, v216, v168
    v_add_f32 v41, v217, v169
    v_add_f32 v42, v218, v170
    v_add_f32 v43, v219, v171
    v_add_f32 v44, v220, v172
    v_add_f32 v45, v221, v173
    v_add_f32 v46, v222, v174
    v_add_f32 v47, v223, v175
    s_waitcnt lgkmcnt(0)
    v_add_f32 v176, v176, v192
    v_add_f32 v177, v177, v193
    v_add_f32 v178, v178, v194
    v_add_f32 v179, v179, v195
    v_add_f32 v180, v180, v196
    v_add_f32 v181, v181, v197
    v_add_f32 v182, v182, v198
    v_add_f32 v183, v183, v199
    v_add_f32 v184, v184, v200
    v_add_f32 v185, v185, v201
    v_add_f32 v186, v186, v202
    v_add_f32 v187, v187, v203
    v_add_f32 v188, v188, v204
    v_add_f32 v189, v189, v205
    v_add_f32 v190, v190, v206
    v_add_f32 v191, v191, v207
    v_add_f32 v32, v32, v176
    v_add_f32 v33, v33, v177
    v_add_f32 v34, v34, v178
    v_add_f32 v35, v35, v179
    v_add_f32 v36, v36, v180
    v_add_f32 v37, v37, v181
    v_add_f32 v38, v38, v182
    v_add_f32 v39, v39, v183
    v_add_f32 v40, v40, v184
    v_add_f32 v41, v41, v185
    v_add_f32 v42, v42, v186
    v_add_f32 v43, v43, v187
    v_add_f32 v44, v44, v188
    v_add_f32 v45, v45, v189
    v_add_f32 v46, v46, v190
    v_add_f32 v47, v47, v191
    v_xor_b32 v7, 0x10000, v7
    v_xor_b32 v8, 0x10000, v8
    v_xor_b32 v9, 0x10000, v9
    v_xor_b32 v10, 0x10000, v10
    buffer_store_dwordx4 v[32:35], v1, s[32:35], s53 offen offset:0 sc1
    buffer_store_dwordx4 v[36:39], v1, s[32:35], s53 offen offset:1024 sc1
    buffer_store_dwordx4 v[40:43], v1, s[32:35], s53 offen offset:2048 sc1
    buffer_store_dwordx4 v[44:47], v1, s[32:35], s53 offen offset:3072 sc1
mega_kernel_W0_post:
    s_cmp_eq_u32 s44, 63
    s_cbranch_scc1 mega_kernel_W0_last
    s_cmp_lg_u32 s55, 0
    s_cbranch_scc0 mega_kernel_W0_np
    s_mov_b32 s47, s54
    s_add_u32 s44, s44, 1
    s_branch mega_kernel_W1_deep
mega_kernel_W0_np:
    s_add_u32 s56, s52, 8192
    buffer_load_dword v3, v2, s[36:39], s56 offen sc1
    s_waitcnt vmcnt(0)
    s_mov_b64 exec, 1
    buffer_store_dword v14, off, s[36:39], s54 sc1
    s_mov_b64 exec, -1
    v_cmp_eq_u32 vcc, 0, v3
    s_cbranch_vccz mega_kernel_W0_p_ok
mega_kernel_W0_p:
    buffer_load_dword v3, v2, s[36:39], s56 offen sc1
    s_waitcnt vmcnt(0)
    v_cmp_eq_u32 vcc, 0, v3
    s_cbranch_vccz mega_kernel_W0_p_ok
    s_cmp_eq_u32 s45, 0
    s_cbranch_scc1 mega_kernel_W0_p_ok
    s_sub_u32 s45, s45, 1
    s_sleep 1
    s_branch mega_kernel_W0_p
mega_kernel_W0_p_ok:
    s_add_u32 s44, s44, 1
    s_lshl_b32 s56, s44, 13
    s_add_u32 s52, s56, s66
    s_add_u32 s54, s56, s67
    s_mul_i32 s53, s44, 524288
    s_add_u32 s53, s53, s68
    s_mul_i32 s69, s44, 262144
    s_add_u32 s69, s69, s46
    s_branch mega_kernel_W1_cold
mega_kernel_W0_last:
    s_waitcnt vmcnt(0)
    s_mov_b64 exec, 1
    buffer_store_dword v14, off, s[36:39], s54 sc1
    s_mov_b64 exec, -1
    s_branch mega_kernel_W_fin
mega_kernel_W1_deep:
    s_lshl_b32 s56, s44, 13
    s_add_u32 s52, s56, s66
    s_add_u32 s54, s56, s67
    s_mul_i32 s53, s44, 524288
    s_add_u32 s53, s53, s68
    s_mul_i32 s69, s44, 262144
    s_add_u32 s69, s69, s46
    s_waitcnt vmcnt(4)
    s_cmp_eq_u32 s44, 63
    s_cbranch_scc1 mega_kernel_W1_pre2
    v_cmp_eq_u32 vcc, 0, v3
    s_cbranch_vccnz mega_kernel_W1_pre2
    s_add_u32 s48, s69, 262144
    s_add_u32 s49, s69, 266240
    s_add_u32 s50, s69, 270336
    s_add_u32 s51, s69, 274432
    v_mfma_f32_32x32x16_bf16 v[160:175], a[0:3], v[96:99], 0
    buffer_load_dwordx4 v[32:35], v1, s[28:31], s48 offen offset:0 sc1
    v_mfma_f32_32x32x16_bf16 v[176:191], a[4:7], v[96:99], 0
    v_mfma_f32_32x32x16_bf16 v[192:207], a[8:11], v[96:99], 0
    v_mfma_f32_32x32x16_bf16 v[208:223], a[12:15], v[96:99], 0
    v_mfma_f32_32x32x16_bf16 v[160:175], a[16:19], v[100:103], v[160:175]
    buffer_load_dwordx4 v[36:39], v1, s[28:31], s48 offen offset:1024 sc1
    v_mfma_f32_32x32x16_bf16 v[176:191], a[20:23], v[100:103], v[176:191]
    v_mfma_f32_32x32x16_bf16 v[192:207], a[24:27], v[100:103], v[192:207]
    v_mfma_f32_32x32x16_bf16 v[208:223], a[28:31], v[100:103], v[208:223]
    v_mfma_f32_32x32x16_bf16 v[160:175], a[32:35], v[104:107], v[160:175]
    buffer_load_dwordx4 v[40:43], v1, s[28:31], s48 offen offset:2048 sc1
    v_mfma_f32_32x32x16_bf16 v[176:191], a[36:39], v[104:107], v[176:191]
    v_mfma_f32_32x32x16_bf16 v[192:207], a[40:43], v[104:107], v[192:207]
    v_mfma_f32_32x32x16_bf16 v[208:223], a[44:47], v[104:107], v[208:223]
    v_mfma_f32_32x32x16_bf16 v[160:175], a[48:51], v[108:111], v[160:175]
    buffer_load_dwordx4 v[44:47], v1, s[28:31], s48 offen offset:3072 sc1
    v_mfma_f32_32x32x16_bf16 v[176:191], a[52:55], v[108:111], v[176:191]
    v_mfma_f32_32x32x16_bf16 v[192:207], a[56:59], v[108:111], v[192:207]
    v_mfma_f32_32x32x16_bf16 v[208:223], a[60:63], v[108:111], v[208:223]
    v_mfma_f32_32x32x16_bf16 v[160:175], a[64:67], v[112:115], v[160:175]
    buffer_load_dwordx4 v[48:51], v1, s[28:31], s49 offen offset:0 sc1
    v_mfma_f32_32x32x16_bf16 v[176:191], a[68:71], v[112:115], v[176:191]
    v_mfma_f32_32x32x16_bf16 v[192:207], a[72:75], v[112:115], v[192:207]
    v_mfma_f32_32x32x16_bf16 v[208:223], a[76:79], v[112:115], v[208:223]
    v_mfma_f32_32x32x16_bf16 v[160:175], a[80:83], v[116:119], v[160:175]
    buffer_load_dwordx4 v[52:55], v1, s[28:31], s49 offen offset:1024 sc1
    v_mfma_f32_32x32x16_bf16 v[176:191], a[84:87], v[116:119], v[176:191]
    v_mfma_f32_32x32x16_bf16 v[192:207], a[88:91], v[116:119], v[192:207]
    v_mfma_f32_32x32x16_bf16 v[208:223], a[92:95], v[116:119], v[208:223]
    v_mfma_f32_32x32x16_bf16 v[160:175], a[96:99], v[120:123], v[160:175]
    buffer_load_dwordx4 v[56:59], v1, s[28:31], s49 offen offset:2048 sc1
    v_mfma_f32_32x32x16_bf16 v[176:191], a[100:103], v[120:123], v[176:191]
    v_mfma_f32_32x32x16_bf16 v[192:207], a[104:107], v[120:123], v[192:207]
    v_mfma_f32_32x32x16_bf16 v[208:223], a[108:111], v[120:123], v[208:223]
    v_mfma_f32_32x32x16_bf16 v[160:175], a[112:115], v[124:127], v[160:175]
    buffer_load_dwordx4 v[60:63], v1, s[28:31], s49 offen offset:3072 sc1
    v_mfma_f32_32x32x16_bf16 v[176:191], a[116:119], v[124:127], v[176:191]
    v_mfma_f32_32x32x16_bf16 v[192:207], a[120:123], v[124:127], v[192:207]
    v_mfma_f32_32x32x16_bf16 v[208:223], a[124:127], v[124:127], v[208:223]
    s_waitcnt vmcnt(8)
    s_mov_b64 exec, 1
    buffer_store_dword v14, off, s[36:39], s47 sc1
    s_mov_b64 exec, -1
    s_mov_b32 s55, 1
    s_nop 1
    s_branch mega_kernel_W1_p2d
mega_kernel_W1_pre:
    s_lshl_b32 s56, s44, 13
    s_add_u32 s52, s56, s66
    s_add_u32 s54, s56, s67
    s_mul_i32 s53, s44, 524288
    s_add_u32 s53, s53, s68
    s_mul_i32 s69, s44, 262144
    s_add_u32 s69, s69, s46
mega_kernel_W1_pre2:
    s_add_u32 s56, s52, 8192
    buffer_load_dword v3, v2, s[36:39], s56 offen sc1
    s_waitcnt vmcnt(5)
    v_mfma_f32_32x32x16_bf16 v[160:175], a[0:3], v[96:99], 0
    v_mfma_f32_32x32x16_bf16 v[176:191], a[4:7], v[96:99], 0
    v_mfma_f32_32x32x16_bf16 v[192:207], a[8:11], v[96:99], 0
    v_mfma_f32_32x32x16_bf16 v[208:223], a[12:15], v[96:99], 0
    v_mfma_f32_32x32x16_bf16 v[160:175], a[16:19], v[100:103], v[160:175]
    v_mfma_f32_32x32x16_bf16 v[176:191], a[20:23], v[100:103], v[176:191]
    v_mfma_f32_32x32x16_bf16 v[192:207], a[24:27], v[100:103], v[192:207]
    v_mfma_f32_32x32x16_bf16 v[208:223], a[28:31], v[100:103], v[208:223]
    v_mfma_f32_32x32x16_bf16 v[160:175], a[32:35], v[104:107], v[160:175]
    v_mfma_f32_32x32x16_bf16 v[176:191], a[36:39], v[104:107], v[176:191]
    v_mfma_f32_32x32x16_bf16 v[192:207], a[40:43], v[104:107], v[192:207]
    v_mfma_f32_32x32x16_bf16 v[208:223], a[44:47], v[104:107], v[208:223]
    v_mfma_f32_32x32x16_bf16 v[160:175], a[48:51], v[108:111], v[160:175]
    v_mfma_f32_32x32x16_bf16 v[176:191], a[52:55], v[108:111], v[176:191]
    v_mfma_f32_32x32x16_bf16 v[192:207], a[56:59], v[108:111], v[192:207]
    v_mfma_f32_32x32x16_bf16 v[208:223], a[60:63], v[108:111], v[208:223]
    v_mfma_f32_32x32x16_bf16 v[160:175], a[64:67], v[112:115], v[160:175]
    v_mfma_f32_32x32x16_bf16 v[176:191], a[68:71], v[112:115], v[176:191]
    v_mfma_f32_32x32x16_bf16 v[192:207], a[72:75], v[112:115], v[192:207]
    v_mfma_f32_32x32x16_bf16 v[208:223], a[76:79], v[112:115], v[208:223]
    v_mfma_f32_32x32x16_bf16 v[160:175], a[80:83], v[116:119], v[160:175]
    v_mfma_f32_32x32x16_bf16 v[176:191], a[84:87], v[116:119], v[176:191]
    v_mfma_f32_32x32x16_bf16 v[192:207], a[88:91], v[116:119], v[192:207]
    v_mfma_f32_32x32x16_bf16 v[208:223], a[92:95], v[116:119], v[208:223]
    v_mfma_f32_32x32x16_bf16 v[160:175], a[96:99], v[120:123], v[160:175]
    v_mfma_f32_32x32x16_bf16 v[176:191], a[100:103], v[120:123], v[176:191]
    v_mfma_f32_32x32x16_bf16 v[192:207], a[104:107], v[120:123], v[192:207]
    v_mfma_f32_32x32x16_bf16 v[208:223], a[108:111], v[120:123], v[208:223]
    v_mfma_f32_32x32x16_bf16 v[160:175], a[112:115], v[124:127], v[160:175]
    v_mfma_f32_32x32x16_bf16 v[176:191], a[116:119], v[124:127], v[176:191]
    v_mfma_f32_32x32x16_bf16 v[192:207], a[120:123], v[124:127], v[192:207]
    v_mfma_f32_32x32x16_bf16 v[208:223], a[124:127], v[124:127], v[208:223]
    s_waitcnt vmcnt(0)
    s_mov_b64 exec, 1
    buffer_store_dword v14, off, s[36:39], s47 sc1
    s_mov_b64 exec, -1
    s_branch mega_kernel_W1_mid
mega_kernel_W1_cold:
    s_add_u32 s48, s69, 0
    s_add_u32 s49, s69, 4096
    s_add_u32 s50, s69, 8192
    s_add_u32 s51, s69, 12288
    buffer_load_dwordx4 v[96:99], v1, s[28:31], s48 offen offset:0 sc1
    buffer_load_dwordx4 v[100:103], v1, s[28:31], s48 offen offset:1024 sc1
    buffer_load_dwordx4 v[104:107], v1, s[28:31], s48 offen offset:2048 sc1
    buffer_load_dwordx4 v[108:111], v1, s[28:31], s48 offen offset:3072 sc1
    buffer_load_dwordx4 v[112:115], v1, s[28:31], s49 offen offset:0 sc1
    buffer_load_dwordx4 v[116:119], v1, s[28:31], s49 offen offset:1024 sc1
    buffer_load_dwordx4 v[120:123], v1, s[28:31], s49 offen offset:2048 sc1
    buffer_load_dwordx4 v[124:127], v1, s[28:31], s49 offen offset:3072 sc1
    s_waitcnt vmcnt(7)
    v_mfma_f32_32x32x16_bf16 v[160:175], a[0:3], v[96:99], 0
    buffer_load_dwordx4 v[128:131], v1, s[28:31], s50 offen offset:0 sc1
    v_mfma_f32_32x32x16_bf16 v[176:191], a[4:7], v[96:99], 0
    v_mfma_f32_32x32x16_bf16 v[192:207], a[8:11], v[96:99], 0
    buffer_load_dwordx4 v[132:135], v1, s[28:31], s50 offen offset:1024 sc1
    v_mfma_f32_32x32x16_bf16 v[208:223], a[12:15], v[96:99], 0
    s_waitcnt vmcnt(8)
    v_mfma_f32_32x32x16_bf16 v[160:175], a[16:19], v[100:103], v[160:175]
    buffer_load_dwordx4 v[136:139], v1, s[28:31], s50 offen offset:2048 sc1
    v_mfma_f32_32x32x16_bf16 v[176:191], a[20:23], v[100:103], v[176:191]
    v_mfma_f32_32x32x16_bf16 v[192:207], a[24:27], v[100:103], v[192:207]
    buffer_load_dwordx4 v[140:143], v1, s[28:31], s50 offen offset:3072 sc1
    v_mfma_f32_32x32x16_bf16 v[208:223], a[28:31], v[100:103], v[208:223]
    s_waitcnt vmcnt(9)
    v_mfma_f32_32x32x16_bf16 v[160:175], a[32:35], v[104:107], v[160:175]
    buffer_load_dwordx4 v[144:147], v1, s[28:31], s51 offen offset:0 sc1
    v_mfma_f32_32x32x16_bf16 v[176:191], a[36:39], v[104:107], v[176:191]
    v_mfma_f32_32x32x16_bf16 v[192:207], a[40:43], v[104:107], v[192:207]
    buffer_load_dwordx4 v[148:151], v1, s[28:31], s51 offen offset:1024 sc1
    v_mfma_f32_32x32x16_bf16 v[208:223], a[44:47], v[104:107], v[208:223]
    s_waitcnt vmcnt(10)
    v_mfma_f32_32x32x16_bf16 v[160:175], a[48:51], v[108:111], v[160:175]
    buffer_load_dwordx4 v[152:155], v1, s[28:31], s51 offen offset:2048 sc1
    v_mfma_f32_32x32x16_bf16 v[176:191], a[52:55], v[108:111], v[176:191]
    v_mfma_f32_32x32x16_bf16 v[192:207], a[56:59], v[108:111], v[192:207]
    buffer_load_dwordx4 v[156:159], v1, s[28:31], s51 offen offset:3072 sc1
    s_add_u32 s56, s52, 8192
    buffer_load_dword v3, v2, s[36:39], s56 offen sc1
    v_mfma_f32_32x32x16_bf16 v[208:223], a[60:63], v[108:111], v[208:223]
    s_waitcnt vmcnt(12)
    v_mfma_f32_32x32x16_bf16 v[160:175], a[64:67], v[112:115], v[160:175]
    v_mfma_f32_32x32x16_bf16 v[176:191], a[68:71], v[112:115], v[176:191]
    v_mfma_f32_32x32x16_bf16 v[192:207], a[72:75], v[112:115], v[192:207]
    v_mfma_f32_32x32x16_bf16 v[208:223], a[76:79], v[112:115], v[208:223]
    s_waitcnt vmcnt(11)
    v_mfma_f32_32x32x16_bf16 v[160:175], a[80:83], v[116:119], v[160:175]
    v_mfma_f32_32x32x16_bf16 v[176:191], a[84:87], v[116:119], v[176:191]
    v_mfma_f32_32x32x16_bf16 v[192:207], a[88:91], v[116:119], v[192:207]
    v_mfma_f32_32x32x16_bf16 v[208:223], a[92:95], v[116:119], v[208:223]
    s_waitcnt vmcnt(10)
    v_mfma_f32_32x32x16_bf16 v[160:175], a[96:99], v[120:123], v[160:175]
    v_mfma_f32_32x32x16_bf16 v[176:191], a[100:103], v[120:123], v[176:191]
    v_mfma_f32_32x32x16_bf16 v[192:207], a[104:107], v[120:123], v[192:207]
    v_mfma_f32_32x32x16_bf16 v[208:223], a[108:111], v[120:123], v[208:223]
    s_waitcnt vmcnt(9)
    v_mfma_f32_32x32x16_bf16 v[160:175], a[112:115], v[124:127], v[160:175]
    v_mfma_f32_32x32x16_bf16 v[176:191], a[116:119], v[124:127], v[176:191]
    v_mfma_f32_32x32x16_bf16 v[192:207], a[120:123], v[124:127], v[192:207]
    v_mfma_f32_32x32x16_bf16 v[208:223], a[124:127], v[124:127], v[208:223]
    s_waitcnt vmcnt(0)
mega_kernel_W1_mid:
    s_mov_b32 s55, 0
    s_cmp_eq_u32 s44, 63
    s_cbranch_scc1 mega_kernel_W1_p2n
    v_cmp_eq_u32 vcc, 0, v3
    s_cbranch_vccnz mega_kernel_W1_p2n
    s_mov_b32 s55, 1
    s_add_u32 s48, s69, 262144
    s_add_u32 s49, s69, 266240
    s_add_u32 s50, s69, 270336
    s_add_u32 s51, s69, 274432
    s_add_u32 s56, s52, 16384
    v_mfma_f32_32x32x16_bf16 v[160:175], a[128:131], v[128:131], v[160:175]
    v_mfma_f32_32x32x16_bf16 v[160:175], a[144:147], v[132:135], v[160:175]
    buffer_load_dwordx4 v[32:35], v1, s[28:31], s48 offen offset:0 sc1
    v_mfma_f32_32x32x16_bf16 v[160:175], a[160:163], v[136:139], v[160:175]
    v_mfma_f32_32x32x16_bf16 v[160:175], a[176:179], v[140:143], v[160:175]
    v_mfma_f32_32x32x16_bf16 v[160:175], a[192:195], v[144:147], v[160:175]
    buffer_load_dwordx4 v[36:39], v1, s[28:31], s48 offen offset:1024 sc1
    v_mfma_f32_32x32x16_bf16 v[160:175], a[208:211], v[148:151], v[160:175]
    v_mfma_f32_32x32x16_bf16 v[160:175], a[224:227], v[152:155], v[160:175]
    v_mfma_f32_32x32x16_bf16 v[160:175], a[240:243], v[156:159], v[160:175]
    v_mfma_f32_32x32x16_bf16 v[176:191], a[132:135], v[128:131], v[176:191]
    v_mfma_f32_32x32x16_bf16 v[176:191], a[148:151], v[132:135], v[176:191]
    s_nop 9
    ds_write_b128 v7, v[160:163] offset:0
    v_mfma_f32_32x32x16_bf16 v[176:191], a[164:167], v[136:139], v[176:191]
    buffer_load_dwordx4 v[40:43], v1, s[28:31], s48 offen offset:2048 sc1
    v_mfma_f32_32x32x16_bf16 v[176:191], a[180:183], v[140:143], v[176:191]
    ds_write_b128 v7, v[164:167] offset:1024
    v_mfma_f32_32x32x16_bf16 v[176:191], a[196:199], v[144:147], v[176:191]
    buffer_load_dwordx4 v[44:47], v1, s[28:31], s48 offen offset:3072 sc1
    v_mfma_f32_32x32x16_bf16 v[176:191], a[212:215], v[148:151], v[176:191]
    ds_write_b128 v7, v[168:171] offset:2048
    v_mfma_f32_32x32x16_bf16 v[176:191], a[228:231], v[152:155], v[176:191]
    ds_write_b128 v7, v[172:175] offset:3072
    v_mfma_f32_32x32x16_bf16 v[176:191], a[244:247], v[156:159], v[176:191]
    v_mfma_f32_32x32x16_bf16 v[192:207], a[136:139], v[128:131], v[192:207]
    v_mfma_f32_32x32x16_bf16 v[192:207], a[152:155], v[132:135], v[192:207]
    s_nop 9
    ds_write_b128 v7, v[176:179] offset:4096
    v_mfma_f32_32x32x16_bf16 v[192:207], a[168:171], v[136:139], v[192:207]
    buffer_load_dwordx4 v[48:51], v1, s[28:31], s49 offen offset:0 sc1
    v_mfma_f32_32x32x16_bf16 v[192:207], a[184:187], v[140:143], v[192:207]
    ds_write_b128 v7, v[180:183] offset:5120
    v_mfma_f32_32x32x16_bf16 v[192:207], a[200:203], v[144:147], v[192:207]
    buffer_load_dwordx4 v[52:55], v1, s[28:31], s49 offen offset:1024 sc1
    v_mfma_f32_32x32x16_bf16 v[192:207], a[216:219], v[148:151], v[192:207]
    ds_write_b128 v7, v[184:187] offset:6144
    v_mfma_f32_32x32x16_bf16 v[192:207], a[232:235], v[152:155], v[192:207]
    ds_write_b128 v7, v[188:191] offset:7168
    v_mfma_f32_32x32x16_bf16 v[192:207], a[248:251], v[156:159], v[192:207]
    v_mfma_f32_32x32x16_bf16 v[208:223], a[140:143], v[128:131], v[208:223]
    v_mfma_f32_32x32x16_bf16 v[208:223], a[156:159], v[132:135], v[208:223]
    s_nop 9
    ds_write_b128 v7, v[192:195] offset:8192
    v_mfma_f32_32x32x16_bf16 v[208:223], a[172:175], v[136:139], v[208:223]
    buffer_load_dwordx4 v[56:59], v1, s[28:31], s49 offen offset:2048 sc1
    v_mfma_f32_32x32x16_bf16 v[208:223], a[188:191], v[140:143], v[208:223]
    ds_write_b128 v7, v[196:199] offset:9216
    v_mfma_f32_32x32x16_bf16 v[208:223], a[204:207], v[144:147], v[208:223]
    buffer_load_dwordx4 v[60:63], v1, s[28:31], s49 offen offset:3072 sc1
    v_mfma_f32_32x32x16_bf16 v[208:223], a[220:223], v[148:151], v[208:223]
    ds_write_b128 v7, v[200:203] offset:10240
    v_mfma_f32_32x32x16_bf16 v[208:223], a[236:239], v[152:155], v[208:223]
    ds_write_b128 v7, v[204:207] offset:11264
    v_mfma_f32_32x32x16_bf16 v[208:223], a[252:255], v[156:159], v[208:223]
    s_waitcnt lgkmcnt(0)
    s_barrier
    ds_read_b128 v[160:163], v8 offset:0
    ds_read_b128 v[164:167], v8 offset:1024
    ds_read_b128 v[168:171], v8 offset:2048
    ds_read_b128 v[172:175], v8 offset:3072
    ds_read_b128 v[176:179], v9 offset:0
    ds_read_b128 v[180:183], v9 offset:1024
    ds_read_b128 v[184:187], v9 offset:2048
    ds_read_b128 v[188:191], v9 offset:3072
    ds_read_b128 v[192:195], v10 offset:0
    ds_read_b128 v[196:199], v10 offset:1024
    ds_read_b128 v[200:203], v10 offset:2048
    ds_read_b128 v[204:207], v10 offset:3072
    buffer_load_dwordx4 v[64:67], v1, s[28:31], s50 offen offset:0 sc1
    buffer_load_dwordx4 v[68:71], v1, s[28:31], s50 offen offset:1024 sc1
    buffer_load_dwordx4 v[72:75], v1, s[28:31], s50 offen offset:2048 sc1
    buffer_load_dwordx4 v[76:79], v1, s[28:31], s50 offen offset:3072 sc1
    buffer_load_dwordx4 v[80:83], v1, s[28:31], s51 offen offset:0 sc1
    s_waitcnt lgkmcnt(8)
    buffer_load_dwordx4 v[84:87], v1, s[28:31], s51 offen offset:1024 sc1
    v_add_f32 v96, v208, v160
    v_add_f32 v97, v209, v161
    v_add_f32 v98, v210, v162
    v_add_f32 v99, v211, v163
    v_add_f32 v100, v212, v164
    v_add_f32 v101, v213, v165
    v_add_f32 v102, v214, v166
    v_add_f32 v103, v215, v167
    v_add_f32 v104, v216, v168
    v_add_f32 v105, v217, v169
    v_add_f32 v106, v218, v170
    v_add_f32 v107, v219, v171
    v_add_f32 v108, v220, v172
    buffer_load_dwordx4 v[88:91], v1, s[28:31], s51 offen offset:2048 sc1
    v_add_f32 v109, v221, v173
    v_add_f32 v110, v222, v174
    v_add_f32 v111, v223, v175
    s_waitcnt lgkmcnt(0)
    v_add_f32 v176, v176, v192
    v_add_f32 v177, v177, v193
    v_add_f32 v178, v178, v194
    v_add_f32 v179, v179, v195
    v_add_f32 v180, v180, v196
    v_add_f32 v181, v181, v197
    v_add_f32 v182, v182, v198
    v_add_f32 v183, v183, v199
    v_add_f32 v184, v184, v200
    v_add_f32 v185, v185, v201
    buffer_load_dwordx4 v[92:95], v1, s[28:31], s51 offen offset:3072 sc1
    v_add_f32 v186, v186, v202
    v_add_f32 v187, v187, v203
    v_add_f32 v188, v188, v204
    v_add_f32 v189, v189, v205
    v_add_f32 v190, v190, v206
    v_add_f32 v191, v191, v207
    v_add_f32 v96, v96, v176
    v_add_f32 v97, v97, v177
    v_add_f32 v98, v98, v178
    v_add_f32 v99, v99, v179
    v_add_f32 v100, v100, v180
    v_add_f32 v101, v101, v181
    v_add_f32 v102, v102, v182
    buffer_load_dword v3, v2, s[36:39], s56 offen sc1
    v_add_f32 v103, v103, v183
    v_add_f32 v104, v104, v184
    v_add_f32 v105, v105, v185
    v_add_f32 v106, v106, v186
    v_add_f32 v107, v107, v187
    v_add_f32 v108, v108, v188
    v_add_f32 v109, v109, v189
    v_add_f32 v110, v110, v190
    v_add_f32 v111, v111, v191
    v_xor_b32 v7, 0x10000, v7
    v_xor_b32 v8, 0x10000, v8
    v_xor_b32 v9, 0x10000, v9
    v_xor_b32 v10, 0x10000, v10
    buffer_store_dwordx4 v[96:99], v1, s[32:35], s53 offen offset:0 sc1
    buffer_store_dwordx4 v[100:103], v1, s[32:35], s53 offen offset:1024 sc1
    buffer_store_dwordx4 v[104:107], v1, s[32:35], s53 offen offset:2048 sc1
    buffer_store_dwordx4 v[108:111], v1, s[32:35], s53 offen offset:3072 sc1
    s_branch mega_kernel_W1_post
mega_kernel_W1_p2d:
    s_add_u32 s56, s52, 16384
    v_mfma_f32_32x32x16_bf16 v[160:175], a[128:131], v[128:131], v[160:175]
    v_mfma_f32_32x32x16_bf16 v[160:175], a[144:147], v[132:135], v[160:175]
    buffer_load_dwordx4 v[64:67], v1, s[28:31], s50 offen offset:0 sc1
    v_mfma_f32_32x32x16_bf16 v[160:175], a[160:163], v[136:139], v[160:175]
    v_mfma_f32_32x32x16_bf16 v[160:175], a[176:179], v[140:143], v[160:175]
    buffer_load_dwordx4 v[68:71], v1, s[28:31], s50 offen offset:1024 sc1
    v_mfma_f32_32x32x16_bf16 v[160:175], a[192:195], v[144:147], v[160:175]
    v_mfma_f32_32x32x16_bf16 v[160:175], a[208:211], v[148:151], v[160:175]
    buffer_load_dwordx4 v[72:75], v1, s[28:31], s50 offen offset:2048 sc1
    v_mfma_f32_32x32x16_bf16 v[160:175], a[224:227], v[152:155], v[160:175]
    v_mfma_f32_32x32x16_bf16 v[160:175], a[240:243], v[156:159], v[160:175]
    v_mfma_f32_32x32x16_bf16 v[176:191], a[132:135], v[128:131], v[176:191]
    v_mfma_f32_32x32x16_bf16 v[176:191], a[148:151], v[132:135], v[176:191]
    s_nop 9
    ds_write_b128 v7, v[160:163] offset:0
    v_mfma_f32_32x32x16_bf16 v[176:191], a[164:167], v[136:139], v[176:191]
    buffer_load_dwordx4 v[76:79], v1, s[28:31], s50 offen offset:3072 sc1
    v_mfma_f32_32x32x16_bf16 v[176:191], a[180:183], v[140:143], v[176:191]
    ds_write_b128 v7, v[164:167] offset:1024
    v_mfma_f32_32x32x16_bf16 v[176:191], a[196:199], v[144:147], v[176:191]
    buffer_load_dwordx4 v[80:83], v1, s[28:31], s51 offen offset:0 sc1
    v_mfma_f32_32x32x16_bf16 v[176:191], a[212:215], v[148:151], v[176:191]
    ds_write_b128 v7, v[168:171] offset:2048
    v_mfma_f32_32x32x16_bf16 v[176:191], a[228:231], v[152:155], v[176:191]
    buffer_load_dwordx4 v[84:87], v1, s[28:31], s51 offen offset:1024 sc1
    v_mfma_f32_32x32x16_bf16 v[176:191], a[244:247], v[156:159], v[176:191]
    ds_write_b128 v7, v[172:175] offset:3072
    v_mfma_f32_32x32x16_bf16 v[192:207], a[136:139], v[128:131], v[192:207]
    v_mfma_f32_32x32x16_bf16 v[192:207], a[152:155], v[132:135], v[192:207]
    s_nop 8
    ds_write_b128 v7, v[176:179] offset:4096
    v_mfma_f32_32x32x16_bf16 v[192:207], a[168:171], v[136:139], v[192:207]
    buffer_load_dwordx4 v[88:91], v1, s[28:31], s51 offen offset:2048 sc1
    v_mfma_f32_32x32x16_bf16 v[192:207], a[184:187], v[140:143], v[192:207]
    ds_write_b128 v7, v[180:183] offset:5120
    v_mfma_f32_32x32x16_bf16 v[192:207], a[200:203], v[144:147], v[192:207]
    buffer_load_dwordx4 v[92:95], v1, s[28:31], s51 offen offset:3072 sc1
    v_mfma_f32_32x32x16_bf16 v[192:207], a[216:219], v[148:151], v[192:207]
    ds_write_b128 v7, v[184:187] offset:6144
    v_mfma_f32_32x32x16_bf16 v[192:207], a[232:235], v[152:155], v[192:207]
    buffer_load_dword v3, v2, s[36:39], s56 offen sc1
    v_mfma_f32_32x32x16_bf16 v[192:207], a[248:251], v[156:159], v[192:207]
    ds_write_b128 v7, v[188:191] offset:7168
    v_mfma_f32_32x32x16_bf16 v[208:223], a[140:143], v[128:131], v[208:223]
    v_mfma_f32_32x32x16_bf16 v[208:223], a[156:159], v[132:135], v[208:223]
    s_nop 8
    ds_write_b128 v7, v[192:195] offset:8192
    v_mfma_f32_32x32x16_bf16 v[208:223], a[172:175], v[136:139], v[208:223]
    ds_write_b128 v7, v[196:199] offset:9216
    v_mfma_f32_32x32x16_bf16 v[208:223], a[188:191], v[140:143], v[208:223]
    v_mfma_f32_32x32x16_bf16 v[208:223], a[204:207], v[144:147], v[208:223]
    ds_write_b128 v7, v[200:203] offset:10240
    v_mfma_f32_32x32x16_bf16 v[208:223], a[220:223], v[148:151], v[208:223]
    v_mfma_f32_32x32x16_bf16 v[208:223], a[236:239], v[152:155], v[208:223]
    ds_write_b128 v7, v[204:207] offset:11264
    v_mfma_f32_32x32x16_bf16 v[208:223], a[252:255], v[156:159], v[208:223]
    s_branch mega_kernel_W1_red
mega_kernel_W1_p2n:
    v_mfma_f32_32x32x16_bf16 v[160:175], a[128:131], v[128:131], v[160:175]
    v_mfma_f32_32x32x16_bf16 v[160:175], a[144:147], v[132:135], v[160:175]
    v_mfma_f32_32x32x16_bf16 v[160:175], a[160:163], v[136:139], v[160:175]
    v_mfma_f32_32x32x16_bf16 v[160:175], a[176:179], v[140:143], v[160:175]
    v_mfma_f32_32x32x16_bf16 v[160:175], a[192:195], v[144:147], v[160:175]
    v_mfma_f32_32x32x16_bf16 v[160:175], a[208:211], v[148:151], v[160:175]
    v_mfma_f32_32x32x16_bf16 v[160:175], a[224:227], v[152:155], v[160:175]
    v_mfma_f32_32x32x16_bf16 v[160:175], a[240:243], v[156:159], v[160:175]
    s_add_u32 s56, s52, 8192
    buffer_load_dword v3, v2, s[36:39], s56 offen sc1
    v_mfma_f32_32x32x16_bf16 v[176:191], a[132:135], v[128:131], v[176:191]
    v_mfma_f32_32x32x16_bf16 v[176:191], a[148:151], v[132:135], v[176:191]
    s_nop 7
    ds_write_b128 v7, v[160:163] offset:0
    v_mfma_f32_32x32x16_bf16 v[176:191], a[164:167], v[136:139], v[176:191]
    ds_write_b128 v7, v[164:167] offset:1024
    v_mfma_f32_32x32x16_bf16 v[176:191], a[180:183], v[140:143], v[176:191]
    v_mfma_f32_32x32x16_bf16 v[176:191], a[196:199], v[144:147], v[176:191]
    ds_write_b128 v7, v[168:171] offset:2048
    v_mfma_f32_32x32x16_bf16 v[176:191], a[212:215], v[148:151], v[176:191]
    v_mfma_f32_32x32x16_bf16 v[176:191], a[228:231], v[152:155], v[176:191]
    ds_write_b128 v7, v[172:175] offset:3072
    v_mfma_f32_32x32x16_bf16 v[176:191], a[244:247], v[156:159], v[176:191]
    v_mfma_f32_32x32x16_bf16 v[192:207], a[136:139], v[128:131], v[192:207]
    v_mfma_f32_32x32x16_bf16 v[192:207], a[152:155], v[132:135], v[192:207]
    s_nop 9
    ds_write_b128 v7, v[176:179] offset:4096
    v_mfma_f32_32x32x16_bf16 v[192:207], a[168:171], v[136:139], v[192:207]
    ds_write_b128 v7, v[180:183] offset:5120
    v_mfma_f32_32x32x16_bf16 v[192:207], a[184:187], v[140:143], v[192:207]
    v_mfma_f32_32x32x16_bf16 v[192:207], a[200:203], v[144:147], v[192:207]
    ds_write_b128 v7, v[184:187] offset:6144
    v_mfma_f32_32x32x16_bf16 v[192:207], a[216:219], v[148:151], v[192:207]
    v_mfma_f32_32x32x16_bf16 v[192:207], a[232:235], v[152:155], v[192:207]
    ds_write_b128 v7, v[188:191] offset:7168
    v_mfma_f32_32x32x16_bf16 v[192:207], a[248:251], v[156:159], v[192:207]
    v_mfma_f32_32x32x16_bf16 v[208:223], a[140:143], v[128:131], v[208:223]
    v_mfma_f32_32x32x16_bf16 v[208:223], a[156:159], v[132:135], v[208:223]
    s_nop 9
    ds_write_b128 v7, v[192:195] offset:8192
    v_mfma_f32_32x32x16_bf16 v[208:223], a[172:175], v[136:139], v[208:223]
    ds_write_b128 v7, v[196:199] offset:9216
    v_mfma_f32_32x32x16_bf16 v[208:223], a[188:191], v[140:143], v[208:223]
    v_mfma_f32_32x32x16_bf16 v[208:223], a[204:207], v[144:147], v[208:223]
    ds_write_b128 v7, v[200:203] offset:10240
    v_mfma_f32_32x32x16_bf16 v[208:223], a[220:223], v[148:151], v[208:223]
    v_mfma_f32_32x32x16_bf16 v[208:223], a[236:239], v[152:155], v[208:223]
    ds_write_b128 v7, v[204:207] offset:11264
    v_mfma_f32_32x32x16_bf16 v[208:223], a[252:255], v[156:159], v[208:223]
    s_waitcnt lgkmcnt(0)
    s_barrier
    s_cmp_eq_u32 s44, 63
    s_cbranch_scc1 mega_kernel_W1_red2
    s_waitcnt vmcnt(0)
    v_cmp_eq_u32 vcc, 0, v3
    s_cbranch_vccnz mega_kernel_W1_red2
    s_mov_b32 s55, 1
    s_add_u32 s48, s69, 262144
    s_add_u32 s49, s69, 266240
    s_add_u32 s50, s69, 270336
    s_add_u32 s51, s69, 274432
    s_add_u32 s56, s52, 16384
    ds_read_b128 v[160:163], v8 offset:0
    ds_read_b128 v[164:167], v8 offset:1024
    ds_read_b128 v[168:171], v8 offset:2048
    ds_read_b128 v[172:175], v8 offset:3072
    ds_read_b128 v[176:179], v9 offset:0
    ds_read_b128 v[180:183], v9 offset:1024
    ds_read_b128 v[184:187], v9 offset:2048
    ds_read_b128 v[188:191], v9 offset:3072
    ds_read_b128 v[192:195], v10 offset:0
    ds_read_b128 v[196:199], v10 offset:1024
    ds_read_b128 v[200:203], v10 offset:2048
    ds_read_b128 v[204:207], v10 offset:3072
    buffer_load_dwordx4 v[32:35], v1, s[28:31], s48 offen offset:0 sc1
    buffer_load_dwordx4 v[36:39], v1, s[28:31], s48 offen offset:1024 sc1
    buffer_load_dwordx4 v[40:43], v1, s[28:31], s48 offen offset:2048 sc1
    buffer_load_dwordx4 v[44:47], v1, s[28:31], s48 offen offset:3072 sc1
    buffer_load_dwordx4 v[48:51], v1, s[28:31], s49 offen offset:0 sc1
    buffer_load_dwordx4 v[52:55], v1, s[28:31], s49 offen offset:1024 sc1
    buffer_load_dwordx4 v[56:59], v1, s[28:31], s49 offen offset:2048 sc1
    buffer_load_dwordx4 v[60:63], v1, s[28:31], s49 offen offset:3072 sc1
    s_waitcnt lgkmcnt(8)
    buffer_load_dwordx4 v[64:67], v1, s[28:31], s50 offen offset:0 sc1
    v_add_f32 v96, v208, v160
    v_add_f32 v97, v209, v161
    v_add_f32 v98, v210, v162
    v_add_f32 v99, v211, v163
    v_add_f32 v100, v212, v164
    v_add_f32 v101, v213, v165
    buffer_load_dwordx4 v[68:71], v1, s[28:31], s50 offen offset:1024 sc1
    v_add_f32 v102, v214, v166
    v_add_f32 v103, v215, v167
    v_add_f32 v104, v216, v168
    v_add_f32 v105, v217, v169
    v_add_f32 v106, v218, v170
    v_add_f32 v107, v219, v171
    buffer_load_dwordx4 v[72:75], v1, s[28:31], s50 offen offset:2048 sc1
    v_add_f32 v108, v220, v172
    v_add_f32 v109, v221, v173
    v_add_f32 v110, v222, v174
    v_add_f32 v111, v223, v175
    s_waitcnt lgkmcnt(0)
    v_add_f32 v176, v176, v192
    buffer_load_dwordx4 v[76:79], v1, s[28:31], s50 offen offset:3072 sc1
    v_add_f32 v177, v177, v193
    v_add_f32 v178, v178, v194
    v_add_f32 v179, v179, v195
    v_add_f32 v180, v180, v196
    v_add_f32 v181, v181, v197
    v_add_f32 v182, v182, v198
    buffer_load_dwordx4 v[80:83], v1, s[28:31], s51 offen offset:0 sc1
    v_add_f32 v183, v183, v199
    v_add_f32 v184, v184, v200
    v_add_f32 v185, v185, v201
    v_add_f32 v186, v186, v202
    v_add_f32 v187, v187, v203
    v_add_f32 v188, v188, v204
    buffer_load_dwordx4 v[84:87], v1, s[28:31], s51 offen offset:1024 sc1
    v_add_f32 v189, v189, v205
    v_add_f32 v190, v190, v206
    v_add_f32 v191, v191, v207
    v_add_f32 v96, v96, v176
    v_add_f32 v97, v97, v177
    v_add_f32 v98, v98, v178
    buffer_load_dwordx4 v[88:91], v1, s[28:31], s51 offen offset:2048 sc1
    v_add_f32 v99, v99, v179
    v_add_f32 v100, v100, v180
    v_add_f32 v101, v101, v181
    v_add_f32 v102, v102, v182
    v_add_f32 v103, v103, v183
    v_add_f32 v104, v104, v184
    buffer_load_dwordx4 v[92:95], v1, s[28:31], s51 offen offset:3072 sc1
    v_add_f32 v105, v105, v185
    v_add_f32 v106, v106, v186
    v_add_f32 v107, v107, v187
    v_add_f32 v108, v108, v188
    v_add_f32 v109, v109, v189
    v_add_f32 v110, v110, v190
    buffer_load_dword v3, v2, s[36:39], s56 offen sc1
    v_add_f32 v111, v111, v191
    v_xor_b32 v7, 0x10000, v7
    v_xor_b32 v8, 0x10000, v8
    v_xor_b32 v9, 0x10000, v9
    v_xor_b32 v10, 0x10000, v10
    buffer_store_dwordx4 v[96:99], v1, s[32:35], s53 offen offset:0 sc1
    buffer_store_dwordx4 v[100:103], v1, s[32:35], s53 offen offset:1024 sc1
    buffer_store_dwordx4 v[104:107], v1, s[32:35], s53 offen offset:2048 sc1
    buffer_store_dwordx4 v[108:111], v1, s[32:35], s53 offen offset:3072 sc1
    s_branch mega_kernel_W1_post
mega_kernel_W1_red:
    s_waitcnt lgkmcnt(0)
    s_barrier
mega_kernel_W1_red2:
    ds_read_b128 v[160:163], v8 offset:0
    ds_read_b128 v[164:167], v8 offset:1024
    ds_read_b128 v[168:171], v8 offset:2048
    ds_read_b128 v[172:175], v8 offset:3072
    ds_read_b128 v[176:179], v9 offset:0
    ds_read_b128 v[180:183], v9 offset:1024
    ds_read_b128 v[184:187], v9 offset:2048
    ds_read_b128 v[188:191], v9 offset:3072
    ds_read_b128 v[192:195], v10 offset:0
    ds_read_b128 v[196:199], v10 offset:1024
    ds_read_b128 v[200:203], v10 offset:2048
    ds_read_b128 v[204:207], v10 offset:3072
    s_waitcnt lgkmcnt(8)
    v_add_f32 v96, v208, v160
    v_add_f32 v97, v209, v161
    v_add_f32 v98, v210, v162
    v_add_f32 v99, v211, v163
    v_add_f32 v100, v212, v164
    v_add_f32 v101, v213, v165
    v_add_f32 v102, v214, v166
    v_add_f32 v103, v215, v167
    v_add_f32 v104, v216, v168
    v_add_f32 v105, v217, v169
    v_add_f32 v106, v218, v170
    v_add_f32 v107, v219, v171
    v_add_f32 v108, v220, v172
    v_add_f32 v109, v221, v173
    v_add_f32 v110, v222, v174
    v_add_f32 v111, v223, v175
    s_waitcnt lgkmcnt(0)
    v_add_f32 v176, v176, v192
    v_add_f32 v177, v177, v193
    v_add_f32 v178, v178, v194
    v_add_f32 v179, v179, v195
    v_add_f32 v180, v180, v196
    v_add_f32 v181, v181, v197
    v_add_f32 v182, v182, v198
    v_add_f32 v183, v183, v199
    v_add_f32 v184, v184, v200
    v_add_f32 v185, v185, v201
    v_add_f32 v186, v186, v202
    v_add_f32 v187, v187, v203
    v_add_f32 v188, v188, v204
    v_add_f32 v189, v189, v205
    v_add_f32 v190, v190, v206
    v_add_f32 v191, v191, v207
    v_add_f32 v96, v96, v176
    v_add_f32 v97, v97, v177
    v_add_f32 v98, v98, v178
    v_add_f32 v99, v99, v179
    v_add_f32 v100, v100, v180
    v_add_f32 v101, v101, v181
    v_add_f32 v102, v102, v182
    v_add_f32 v103, v103, v183
    v_add_f32 v104, v104, v184
    v_add_f32 v105, v105, v185
    v_add_f32 v106, v106, v186
    v_add_f32 v107, v107, v187
    v_add_f32 v108, v108, v188
    v_add_f32 v109, v109, v189
    v_add_f32 v110, v110, v190
    v_add_f32 v111, v111, v191
    v_xor_b32 v7, 0x10000, v7
    v_xor_b32 v8, 0x10000, v8
    v_xor_b32 v9, 0x10000, v9
    v_xor_b32 v10, 0x10000, v10
    buffer_store_dwordx4 v[96:99], v1, s[32:35], s53 offen offset:0 sc1
    buffer_store_dwordx4 v[100:103], v1, s[32:35], s53 offen offset:1024 sc1
    buffer_store_dwordx4 v[104:107], v1, s[32:35], s53 offen offset:2048 sc1
    buffer_store_dwordx4 v[108:111], v1, s[32:35], s53 offen offset:3072 sc1
mega_kernel_W1_post:
    s_cmp_eq_u32 s44, 63
    s_cbranch_scc1 mega_kernel_W1_last
    s_cmp_lg_u32 s55, 0
    s_cbranch_scc0 mega_kernel_W1_np
    s_mov_b32 s47, s54
    s_add_u32 s44, s44, 1
    s_branch mega_kernel_W0_deep
mega_kernel_W1_np:
    s_add_u32 s56, s52, 8192
    buffer_load_dword v3, v2, s[36:39], s56 offen sc1
    s_waitcnt vmcnt(0)
    s_mov_b64 exec, 1
    buffer_store_dword v14, off, s[36:39], s54 sc1
    s_mov_b64 exec, -1
    v_cmp_eq_u32 vcc, 0, v3
    s_cbranch_vccz mega_kernel_W1_p_ok
mega_kernel_W1_p:
    buffer_load_dword v3, v2, s[36:39], s56 offen sc1
    s_waitcnt vmcnt(0)
    v_cmp_eq_u32 vcc, 0, v3
    s_cbranch_vccz mega_kernel_W1_p_ok
    s_cmp_eq_u32 s45, 0
    s_cbranch_scc1 mega_kernel_W1_p_ok
    s_sub_u32 s45, s45, 1
    s_sleep 1
    s_branch mega_kernel_W1_p
mega_kernel_W1_p_ok:
    s_add_u32 s44, s44, 1
    s_lshl_b32 s56, s44, 13
    s_add_u32 s52, s56, s66
    s_add_u32 s54, s56, s67
    s_mul_i32 s53, s44, 524288
    s_add_u32 s53, s53, s68
    s_mul_i32 s69, s44, 262144
    s_add_u32 s69, s69, s46
    s_branch mega_kernel_W0_cold
mega_kernel_W1_last:
    s_waitcnt vmcnt(0)
    s_mov_b64 exec, 1
    buffer_store_dword v14, off, s[36:39], s54 sc1
    s_mov_b64 exec, -1
    s_branch mega_kernel_W_fin
mega_kernel_W_fin:
    s_waitcnt vmcnt(0)
    s_branch mega_kernel_exit
mega_kernel_toG:
    s_sub_u32 s63, s61, 96
    s_load_dwordx2 s[4:5], s[0:1], 104
    s_load_dwordx2 s[6:7], s[0:1], 64
    s_load_dwordx2 s[8:9], s[0:1], 72
    s_waitcnt lgkmcnt(0)
    s_mov_b32 s20, s6
    s_mov_b32 s21, s7
    s_mov_b32 s22, 7340032
    s_mov_b32 s23, 0x20000
    s_mov_b32 s24, s8
    s_mov_b32 s25, s9
    s_mov_b32 s26, 7340032
    s_mov_b32 s27, 0x20000
    s_add_u32 s28, s4, 79691776
    s_addc_u32 s29, s5, 0
    s_mov_b32 s30, 4194304
    s_mov_b32 s31, 0x20000
    s_add_u32 s32, s4, 83886080
    s_addc_u32 s33, s5, 0
    s_mov_b32 s34, 14680064
    s_mov_b32 s35, 0x20000
    s_add_u32 s36, s4, 169607168
    s_addc_u32 s37, s5, 0
    s_mov_b32 s38, 548864
    s_mov_b32 s39, 0x20000
    s_add_u32 s40, s4, 98566144
    s_addc_u32 s41, s5, 0
    s_mov_b32 s42, 262144
    s_mov_b32 s43, 0x20000
    s_lshl_b32 s64, s62, 8
    s_lshl_b32 s65, s63, 7
    s_lshl_b32 s46, s64, 6
    s_lshl_b32 s56, s63, 2
    s_add_u32 s56, s56, s62
    s_lshl_b32 s68, s56, 10
    s_lshl_b32 s67, s56, 3
    s_add_u32 s67, s67, 22528
    s_mov_b32 s66, 16896
    v_and_b32 v224, 63, v0
    v_lshlrev_b32 v1, 4, v224
    v_min_u32 v2, 15, v224
    v_lshlrev_b32 v2, 4, v2
    v_lshrrev_b32 v225, 3, v224
    v_lshrrev_b32 v226, 4, v224
    v_and_b32 v226, 1, v226
    v_lshlrev_b32 v226, 2, v226
    v_and_b32 v227, 7, v224
    v_xor_b32 v226, v226, v227
    v_mul_u32_u24 v225, 7168, v225
    v_lshl_add_u32 v6, v226, 4, v225
    v_lshrrev_b32 v225, 5, v224
    v_lshrrev_b32 v226, 2, v224
    v_and_b32 v226, 3, v226
    v_lshl_add_u32 v225, v225, 2, v226
    v_lshlrev_b32 v225, 7, v225
    v_lshrrev_b32 v227, 4, v224
    v_and_b32 v227, 1, v227
    v_lshl_add_u32 v225, v227, 5, v225
    v_and_b32 v227, 3, v224
    v_lshl_add_u32 v225, v227, 3, v225
    s_lshl_b32 s56, s62, 15
    v_add_u32 v225, s56, v225
    v_lshrrev_b32 v226, 1, v226
    v_lshl_add_u32 v4, v226, 6, v225
    v_xor_b32 v5, 64, v4
    s_lshl_b32 s56, s62, 14
    v_add_u32 v7, s56, v1
    v_add_u32 v8, 0x10000, v7
    s_lshr_b32 s56, s62, 1
    s_lshl_b32 s56, s56, 12
    s_and_b32 s57, s62, 1
    s_lshl_b32 s57, s57, 11
    s_add_u32 s56, s56, s57
    v_add_u32 v9, s56, v1
    v_add_u32 v10, 0x10000, v9
    v_lshrrev_b32 v225, 5, v224
    v_lshrrev_b32 v226, 2, v224
    v_and_b32 v226, 3, v226
    v_lshl_add_u32 v225, v225, 2, v226
    v_lshlrev_b32 v225, 7, v225
    v_lshrrev_b32 v227, 4, v224
    v_and_b32 v227, 1, v227
    v_lshl_add_u32 v225, v227, 13, v225
    v_and_b32 v227, 3, v224
    v_lshl_add_u32 v225, v227, 3, v225
    s_lshl_b32 s56, s62, 15
    v_add_u32 v225, s56, v225
    v_lshrrev_b32 v226, 1, v226
    v_lshlrev_b32 v226, 6, v226
    s_add_u32 s56, s62, 1
    s_and_b32 s56, s56, 3
    s_lshl_b32 s57, s56, 5
    v_xor_b32 v228, s57, v226
    v_add_u32 v228, v228, v225
    s_add_u32 s56, s62, 2
    s_and_b32 s56, s56, 3
    s_lshl_b32 s57, s56, 5
    v_xor_b32 v229, s57, v226
    v_add_u32 v229, v229, v225
    s_add_u32 s56, s62, 3
    s_and_b32 s56, s56, 3
    s_lshl_b32 s57, s56, 5
    v_xor_b32 v230, s57, v226
    v_add_u32 v230, v230, v225
    s_add_u32 s56, s62, 4
    s_and_b32 s56, s56, 3
    s_lshl_b32 s57, s56, 5
    v_xor_b32 v231, s57, v226
    v_add_u32 v231, v231, v225
    s_lshl_b32 s56, s62, 14
    v_add_u32 v7, s56, v1
    s_add_u32 s56, s62, 1
    s_and_b32 s56, s56, 3
    s_lshl_b32 s56, s56, 14
    s_add_u32 s56, s56, 8192
    v_add_u32 v8, s56, v1
    s_add_u32 s56, s62, 2
    s_and_b32 s56, s56, 3
    s_lshl_b32 s56, s56, 14
    s_add_u32 s56, s56, 4096
    v_add_u32 v9, s56, v1
    s_add_u32 s56, s62, 3
    s_and_b32 s56, s56, 3
    s_lshl_b32 s56, s56, 14
    s_add_u32 s56, s56, 0
    v_add_u32 v10, s56, v1
    v_and_b32 v225, 31, v224
    v_lshlrev_b32 v225, 7, v225
    v_lshrrev_b32 v226, 5, v224
    v_lshl_add_u32 v11, v226, 6, v225
    v_mov_b32 v14, 1
    s_lshl_b32 s56, s62, 15
    s_add_u32 s56, s56, 0
    s_add_u32 s57, s64, 0
    s_mul_i32 s57, s57, 7168
    s_add_u32 s57, s57, s65
    s_add_u32 m0, s56, 0
    s_nop 0
    buffer_load_dwordx4 v6, s[20:23], s57 offen lds
    s_add_u32 m0, s56, 8192
    s_nop 0
    buffer_load_dwordx4 v6, s[24:27], s57 offen lds
    s_add_u32 s57, s57, 57344
    s_add_u32 m0, s56, 1024
    s_nop 0
    buffer_load_dwordx4 v6, s[20:23], s57 offen lds
    s_add_u32 m0, s56, 9216
    s_nop 0
    buffer_load_dwordx4 v6, s[24:27], s57 offen lds
    s_add_u32 s57, s57, 57344
    s_add_u32 m0, s56, 2048
    s_nop 0
    buffer_load_dwordx4 v6, s[20:23], s57 offen lds
    s_add_u32 m0, s56, 10240
    s_nop 0
    buffer_load_dwordx4 v6, s[24:27], s57 offen lds
    s_add_u32 s57, s57, 57344
    s_add_u32 m0, s56, 3072
    s_nop 0
    buffer_load_dwordx4 v6, s[20:23], s57 offen lds
    s_add_u32 m0, s56, 11264
    s_nop 0
    buffer_load_dwordx4 v6, s[24:27], s57 offen lds
    s_add_u32 s57, s57, 57344
    s_add_u32 m0, s56, 4096
    s_nop 0
    buffer_load_dwordx4 v6, s[20:23], s57 offen lds
    s_add_u32 m0, s56, 12288
    s_nop 0
    buffer_load_dwordx4 v6, s[24:27], s57 offen lds
    s_add_u32 s57, s57, 57344
    s_add_u32 m0, s56, 5120
    s_nop 0
    buffer_load_dwordx4 v6, s[20:23], s57 offen lds
    s_add_u32 m0, s56, 13312
    s_nop 0
    buffer_load_dwordx4 v6, s[24:27], s57 offen lds
    s_add_u32 s57, s57, 57344
    s_add_u32 m0, s56, 6144
    s_nop 0
    buffer_load_dwordx4 v6, s[20:23], s57 offen lds
    s_add_u32 m0, s56, 14336
    s_nop 0
    buffer_load_dwordx4 v6, s[24:27], s57 offen lds
    s_add_u32 s57, s57, 57344
    s_add_u32 m0, s56, 7168
    s_nop 0
    buffer_load_dwordx4 v6, s[20:23], s57 offen lds
    s_add_u32 m0, s56, 15360
    s_nop 0
    buffer_load_dwordx4 v6, s[24:27], s57 offen lds
    s_lshl_b32 s56, s62, 15
    s_add_u32 s56, s56, 16384
    s_add_u32 s57, s64, 64
    s_mul_i32 s57, s57, 7168
    s_add_u32 s57, s57, s65
    s_add_u32 m0, s56, 0
    s_nop 0
    buffer_load_dwordx4 v6, s[20:23], s57 offen lds
    s_add_u32 m0, s56, 8192
    s_nop 0
    buffer_load_dwordx4 v6, s[24:27], s57 offen lds
    s_add_u32 s57, s57, 57344
    s_add_u32 m0, s56, 1024
    s_nop 0
    buffer_load_dwordx4 v6, s[20:23], s57 offen lds
    s_add_u32 m0, s56, 9216
    s_nop 0
    buffer_load_dwordx4 v6, s[24:27], s57 offen lds
    s_add_u32 s57, s57, 57344
    s_add_u32 m0, s56, 2048
    s_nop 0
    buffer_load_dwordx4 v6, s[20:23], s57 offen lds
    s_add_u32 m0, s56, 10240
    s_nop 0
    buffer_load_dwordx4 v6, s[24:27], s57 offen lds
    s_add_u32 s57, s57, 57344
    s_add_u32 m0, s56, 3072
    s_nop 0
    buffer_load_dwordx4 v6, s[20:23], s57 offen lds
    s_add_u32 m0, s56, 11264
    s_nop 0
    buffer_load_dwordx4 v6, s[24:27], s57 offen lds
    s_add_u32 s57, s57, 57344
    s_add_u32 m0, s56, 4096
    s_nop 0
    buffer_load_dwordx4 v6, s[20:23], s57 offen lds
    s_add_u32 m0, s56, 12288
    s_nop 0
    buffer_load_dwordx4 v6, s[24:27], s57 offen lds
    s_add_u32 s57, s57, 57344
    s_add_u32 m0, s56, 5120
    s_nop 0
    buffer_load_dwordx4 v6, s[20:23], s57 offen lds
    s_add_u32 m0, s56, 13312
    s_nop 0
    buffer_load_dwordx4 v6, s[24:27], s57 offen lds
    s_add_u32 s57, s57, 57344
    s_add_u32 m0, s56, 6144
    s_nop 0
    buffer_load_dwordx4 v6, s[20:23], s57 offen lds
    s_add_u32 m0, s56, 14336
    s_nop 0
    buffer_load_dwordx4 v6, s[24:27], s57 offen lds
    s_add_u32 s57, s57, 57344
    s_add_u32 m0, s56, 7168
    s_nop 0
    buffer_load_dwordx4 v6, s[20:23], s57 offen lds
    s_add_u32 m0, s56, 15360
    s_nop 0
    buffer_load_dwordx4 v6, s[24:27], s57 offen lds
    s_waitcnt vmcnt(16)
    ds_read_b64_tr_b16 a[0:1], v228 offset:0
    ds_read_b64_tr_b16 a[2:3], v228 offset:1024
    ds_read_b64_tr_b16 a[4:5], v229 offset:0
    ds_read_b64_tr_b16 a[6:7], v229 offset:1024
    ds_read_b64_tr_b16 a[8:9], v230 offset:0
    ds_read_b64_tr_b16 a[10:11], v230 offset:1024
    ds_read_b64_tr_b16 a[12:13], v231 offset:0
    ds_read_b64_tr_b16 a[14:15], v231 offset:1024
    ds_read_b64_tr_b16 a[16:17], v228 offset:2048
    ds_read_b64_tr_b16 a[18:19], v228 offset:3072
    ds_read_b64_tr_b16 a[20:21], v229 offset:2048
    ds_read_b64_tr_b16 a[22:23], v229 offset:3072
    ds_read_b64_tr_b16 a[24:25], v230 offset:2048
    ds_read_b64_tr_b16 a[26:27], v230 offset:3072
    ds_read_b64_tr_b16 a[28:29], v231 offset:2048
    ds_read_b64_tr_b16 a[30:31], v231 offset:3072
    ds_read_b64_tr_b16 a[32:33], v228 offset:4096
    ds_read_b64_tr_b16 a[34:35], v228 offset:5120
    ds_read_b64_tr_b16 a[36:37], v229 offset:4096
    ds_read_b64_tr_b16 a[38:39], v229 offset:5120
    ds_read_b64_tr_b16 a[40:41], v230 offset:4096
    ds_read_b64_tr_b16 a[42:43], v230 offset:5120
    ds_read_b64_tr_b16 a[44:45], v231 offset:4096
    ds_read_b64_tr_b16 a[46:47], v231 offset:5120
    ds_read_b64_tr_b16 a[48:49], v228 offset:6144
    ds_read_b64_tr_b16 a[50:51], v228 offset:7168
    ds_read_b64_tr_b16 a[52:53], v229 offset:6144
    ds_read_b64_tr_b16 a[54:55], v229 offset:7168
    ds_read_b64_tr_b16 a[56:57], v230 offset:6144
    ds_read_b64_tr_b16 a[58:59], v230 offset:7168
    ds_read_b64_tr_b16 a[60:61], v231 offset:6144
    ds_read_b64_tr_b16 a[62:63], v231 offset:7168
    s_waitcnt lgkmcnt(0)
    s_lshl_b32 s56, s62, 15
    s_add_u32 s56, s56, 0
    s_add_u32 s57, s64, 128
    s_mul_i32 s57, s57, 7168
    s_add_u32 s57, s57, s65
    s_add_u32 m0, s56, 0
    s_nop 0
    buffer_load_dwordx4 v6, s[20:23], s57 offen lds
    s_add_u32 m0, s56, 8192
    s_nop 0
    buffer_load_dwordx4 v6, s[24:27], s57 offen lds
    s_add_u32 s57, s57, 57344
    s_add_u32 m0, s56, 1024
    s_nop 0
    buffer_load_dwordx4 v6, s[20:23], s57 offen lds
    s_add_u32 m0, s56, 9216
    s_nop 0
    buffer_load_dwordx4 v6, s[24:27], s57 offen lds
    s_add_u32 s57, s57, 57344
    s_add_u32 m0, s56, 2048
    s_nop 0
    buffer_load_dwordx4 v6, s[20:23], s57 offen lds
    s_add_u32 m0, s56, 10240
    s_nop 0
    buffer_load_dwordx4 v6, s[24:27], s57 offen lds
    s_add_u32 s57, s57, 57344
    s_add_u32 m0, s56, 3072
    s_nop 0
    buffer_load_dwordx4 v6, s[20:23], s57 offen lds
    s_add_u32 m0, s56, 11264
    s_nop 0
    buffer_load_dwordx4 v6, s[24:27], s57 offen lds
    s_add_u32 s57, s57, 57344
    s_add_u32 m0, s56, 4096
    s_nop 0
    buffer_load_dwordx4 v6, s[20:23], s57 offen lds
    s_add_u32 m0, s56, 12288
    s_nop 0
    buffer_load_dwordx4 v6, s[24:27], s57 offen lds
    s_add_u32 s57, s57, 57344
    s_add_u32 m0, s56, 5120
    s_nop 0
    buffer_load_dwordx4 v6, s[20:23], s57 offen lds
    s_add_u32 m0, s56, 13312
    s_nop 0
    buffer_load_dwordx4 v6, s[24:27], s57 offen lds
    s_add_u32 s57, s57, 57344
    s_add_u32 m0, s56, 6144
    s_nop 0
    buffer_load_dwordx4 v6, s[20:23], s57 offen lds
    s_add_u32 m0, s56, 14336
    s_nop 0
    buffer_load_dwordx4 v6, s[24:27], s57 offen lds
    s_add_u32 s57, s57, 57344
    s_add_u32 m0, s56, 7168
    s_nop 0
    buffer_load_dwordx4 v6, s[20:23], s57 offen lds
    s_add_u32 m0, s56, 15360
    s_nop 0
    buffer_load_dwordx4 v6, s[24:27], s57 offen lds
    s_waitcnt vmcnt(16)
    ds_read_b64_tr_b16 a[64:65], v228 offset:16384
    ds_read_b64_tr_b16 a[66:67], v228 offset:17408
    ds_read_b64_tr_b16 a[68:69], v229 offset:16384
    ds_read_b64_tr_b16 a[70:71], v229 offset:17408
    ds_read_b64_tr_b16 a[72:73], v230 offset:16384
    ds_read_b64_tr_b16 a[74:75], v230 offset:17408
    ds_read_b64_tr_b16 a[76:77], v231 offset:16384
    ds_read_b64_tr_b16 a[78:79], v231 offset:17408
    ds_read_b64_tr_b16 a[80:81], v228 offset:18432
    ds_read_b64_tr_b16 a[82:83], v228 offset:19456
    ds_read_b64_tr_b16 a[84:85], v229 offset:18432
    ds_read_b64_tr_b16 a[86:87], v229 offset:19456
    ds_read_b64_tr_b16 a[88:89], v230 offset:18432
    ds_read_b64_tr_b16 a[90:91], v230 offset:19456
    ds_read_b64_tr_b16 a[92:93], v231 offset:18432
    ds_read_b64_tr_b16 a[94:95], v231 offset:19456
    ds_read_b64_tr_b16 a[96:97], v228 offset:20480
    ds_read_b64_tr_b16 a[98:99], v228 offset:21504
    ds_read_b64_tr_b16 a[100:101], v229 offset:20480
    ds_read_b64_tr_b16 a[102:103], v229 offset:21504
    ds_read_b64_tr_b16 a[104:105], v230 offset:20480
    ds_read_b64_tr_b16 a[106:107], v230 offset:21504
    ds_read_b64_tr_b16 a[108:109], v231 offset:20480
    ds_read_b64_tr_b16 a[110:111], v231 offset:21504
    ds_read_b64_tr_b16 a[112:113], v228 offset:22528
    ds_read_b64_tr_b16 a[114:115], v228 offset:23552
    ds_read_b64_tr_b16 a[116:117], v229 offset:22528
    ds_read_b64_tr_b16 a[118:119], v229 offset:23552
    ds_read_b64_tr_b16 a[120:121], v230 offset:22528
    ds_read_b64_tr_b16 a[122:123], v230 offset:23552
    ds_read_b64_tr_b16 a[124:125], v231 offset:22528
    ds_read_b64_tr_b16 a[126:127], v231 offset:23552
    s_waitcnt lgkmcnt(0)
    s_lshl_b32 s56, s62, 15
    s_add_u32 s56, s56, 16384
    s_add_u32 s57, s64, 192
    s_mul_i32 s57, s57, 7168
    s_add_u32 s57, s57, s65
    s_add_u32 m0, s56, 0
    s_nop 0
    buffer_load_dwordx4 v6, s[20:23], s57 offen lds
    s_add_u32 m0, s56, 8192
    s_nop 0
    buffer_load_dwordx4 v6, s[24:27], s57 offen lds
    s_add_u32 s57, s57, 57344
    s_add_u32 m0, s56, 1024
    s_nop 0
    buffer_load_dwordx4 v6, s[20:23], s57 offen lds
    s_add_u32 m0, s56, 9216
    s_nop 0
    buffer_load_dwordx4 v6, s[24:27], s57 offen lds
    s_add_u32 s57, s57, 57344
    s_add_u32 m0, s56, 2048
    s_nop 0
    buffer_load_dwordx4 v6, s[20:23], s57 offen lds
    s_add_u32 m0, s56, 10240
    s_nop 0
    buffer_load_dwordx4 v6, s[24:27], s57 offen lds
    s_add_u32 s57, s57, 57344
    s_add_u32 m0, s56, 3072
    s_nop 0
    buffer_load_dwordx4 v6, s[20:23], s57 offen lds
    s_add_u32 m0, s56, 11264
    s_nop 0
    buffer_load_dwordx4 v6, s[24:27], s57 offen lds
    s_add_u32 s57, s57, 57344
    s_add_u32 m0, s56, 4096
    s_nop 0
    buffer_load_dwordx4 v6, s[20:23], s57 offen lds
    s_add_u32 m0, s56, 12288
    s_nop 0
    buffer_load_dwordx4 v6, s[24:27], s57 offen lds
    s_add_u32 s57, s57, 57344
    s_add_u32 m0, s56, 5120
    s_nop 0
    buffer_load_dwordx4 v6, s[20:23], s57 offen lds
    s_add_u32 m0, s56, 13312
    s_nop 0
    buffer_load_dwordx4 v6, s[24:27], s57 offen lds
    s_add_u32 s57, s57, 57344
    s_add_u32 m0, s56, 6144
    s_nop 0
    buffer_load_dwordx4 v6, s[20:23], s57 offen lds
    s_add_u32 m0, s56, 14336
    s_nop 0
    buffer_load_dwordx4 v6, s[24:27], s57 offen lds
    s_add_u32 s57, s57, 57344
    s_add_u32 m0, s56, 7168
    s_nop 0
    buffer_load_dwordx4 v6, s[20:23], s57 offen lds
    s_add_u32 m0, s56, 15360
    s_nop 0
    buffer_load_dwordx4 v6, s[24:27], s57 offen lds
    s_waitcnt vmcnt(16)
    ds_read_b64_tr_b16 a[128:129], v228 offset:0
    ds_read_b64_tr_b16 a[130:131], v228 offset:1024
    ds_read_b64_tr_b16 a[132:133], v229 offset:0
    ds_read_b64_tr_b16 a[134:135], v229 offset:1024
    ds_read_b64_tr_b16 a[136:137], v230 offset:0
    ds_read_b64_tr_b16 a[138:139], v230 offset:1024
    ds_read_b64_tr_b16 a[140:141], v231 offset:0
    ds_read_b64_tr_b16 a[142:143], v231 offset:1024
    ds_read_b64_tr_b16 a[144:145], v228 offset:2048
    ds_read_b64_tr_b16 a[146:147], v228 offset:3072
    ds_read_b64_tr_b16 a[148:149], v229 offset:2048
    ds_read_b64_tr_b16 a[150:151], v229 offset:3072
    ds_read_b64_tr_b16 a[152:153], v230 offset:2048
    ds_read_b64_tr_b16 a[154:155], v230 offset:3072
    ds_read_b64_tr_b16 a[156:157], v231 offset:2048
    ds_read_b64_tr_b16 a[158:159], v231 offset:3072
    ds_read_b64_tr_b16 a[160:161], v228 offset:4096
    ds_read_b64_tr_b16 a[162:163], v228 offset:5120
    ds_read_b64_tr_b16 a[164:165], v229 offset:4096
    ds_read_b64_tr_b16 a[166:167], v229 offset:5120
    ds_read_b64_tr_b16 a[168:169], v230 offset:4096
    ds_read_b64_tr_b16 a[170:171], v230 offset:5120
    ds_read_b64_tr_b16 a[172:173], v231 offset:4096
    ds_read_b64_tr_b16 a[174:175], v231 offset:5120
    ds_read_b64_tr_b16 a[176:177], v228 offset:6144
    ds_read_b64_tr_b16 a[178:179], v228 offset:7168
    ds_read_b64_tr_b16 a[180:181], v229 offset:6144
    ds_read_b64_tr_b16 a[182:183], v229 offset:7168
    ds_read_b64_tr_b16 a[184:185], v230 offset:6144
    ds_read_b64_tr_b16 a[186:187], v230 offset:7168
    ds_read_b64_tr_b16 a[188:189], v231 offset:6144
    ds_read_b64_tr_b16 a[190:191], v231 offset:7168
    s_waitcnt lgkmcnt(0)
    s_waitcnt vmcnt(0)
    ds_read_b64_tr_b16 a[192:193], v228 offset:16384
    ds_read_b64_tr_b16 a[194:195], v228 offset:17408
    ds_read_b64_tr_b16 a[196:197], v229 offset:16384
    ds_read_b64_tr_b16 a[198:199], v229 offset:17408
    ds_read_b64_tr_b16 a[200:201], v230 offset:16384
    ds_read_b64_tr_b16 a[202:203], v230 offset:17408
    ds_read_b64_tr_b16 a[204:205], v231 offset:16384
    ds_read_b64_tr_b16 a[206:207], v231 offset:17408
    ds_read_b64_tr_b16 a[208:209], v228 offset:18432
    ds_read_b64_tr_b16 a[210:211], v228 offset:19456
    ds_read_b64_tr_b16 a[212:213], v229 offset:18432
    ds_read_b64_tr_b16 a[214:215], v229 offset:19456
    ds_read_b64_tr_b16 a[216:217], v230 offset:18432
    ds_read_b64_tr_b16 a[218:219], v230 offset:19456
    ds_read_b64_tr_b16 a[220:221], v231 offset:18432
    ds_read_b64_tr_b16 a[222:223], v231 offset:19456
    ds_read_b64_tr_b16 a[224:225], v228 offset:20480
    ds_read_b64_tr_b16 a[226:227], v228 offset:21504
    ds_read_b64_tr_b16 a[228:229], v229 offset:20480
    ds_read_b64_tr_b16 a[230:231], v229 offset:21504
    ds_read_b64_tr_b16 a[232:233], v230 offset:20480
    ds_read_b64_tr_b16 a[234:235], v230 offset:21504
    ds_read_b64_tr_b16 a[236:237], v231 offset:20480
    ds_read_b64_tr_b16 a[238:239], v231 offset:21504
    ds_read_b64_tr_b16 a[240:241], v228 offset:22528
    ds_read_b64_tr_b16 a[242:243], v228 offset:23552
    ds_read_b64_tr_b16 a[244:245], v229 offset:22528
    ds_read_b64_tr_b16 a[246:247], v229 offset:23552
    ds_read_b64_tr_b16 a[248:249], v230 offset:22528
    ds_read_b64_tr_b16 a[250:251], v230 offset:23552
    ds_read_b64_tr_b16 a[252:253], v231 offset:22528
    ds_read_b64_tr_b16 a[254:255], v231 offset:23552
    s_waitcnt lgkmcnt(0)
    s_barrier
    v_mov_b32 v96, 0x3f803f80
    v_mov_b32 v97, 0x3f803f80
    v_mov_b32 v98, 0x3f803f80
    v_mov_b32 v99, 0x3f803f80
    v_mov_b32 v100, 0x3f803f80
    v_mov_b32 v101, 0x3f803f80
    v_mov_b32 v102, 0x3f803f80
    v_mov_b32 v103, 0x3f803f80
    v_mov_b32 v104, 0x3f803f80
    v_mov_b32 v105, 0x3f803f80
    v_mov_b32 v106, 0x3f803f80
    v_mov_b32 v107, 0x3f803f80
    v_mov_b32 v108, 0x3f803f80
    v_mov_b32 v109, 0x3f803f80
    v_mov_b32 v110, 0x3f803f80
    v_mov_b32 v111, 0x3f803f80
    v_mov_b32 v112, 0x3f803f80
    v_mov_b32 v113, 0x3f803f80
    v_mov_b32 v114, 0x3f803f80
    v_mov_b32 v115, 0x3f803f80
    v_mov_b32 v116, 0x3f803f80
    v_mov_b32 v117, 0x3f803f80
    v_mov_b32 v118, 0x3f803f80
    v_mov_b32 v119, 0x3f803f80
    v_mov_b32 v120, 0x3f803f80
    v_mov_b32 v121, 0x3f803f80
    v_mov_b32 v122, 0x3f803f80
    v_mov_b32 v123, 0x3f803f80
    v_mov_b32 v124, 0x3f803f80
    v_mov_b32 v125, 0x3f803f80
    v_mov_b32 v126, 0x3f803f80
    v_mov_b32 v127, 0x3f803f80
    v_mov_b32 v128, 0x3f803f80
    v_mov_b32 v129, 0x3f803f80
    v_mov_b32 v130, 0x3f803f80
    v_mov_b32 v131, 0x3f803f80
    v_mov_b32 v132, 0x3f803f80
    v_mov_b32 v133, 0x3f803f80
    v_mov_b32 v134, 0x3f803f80
    v_mov_b32 v135, 0x3f803f80
    v_mov_b32 v136, 0x3f803f80
    v_mov_b32 v137, 0x3f803f80
    v_mov_b32 v138, 0x3f803f80
    v_mov_b32 v139, 0x3f803f80
    v_mov_b32 v140, 0x3f803f80
    v_mov_b32 v141, 0x3f803f80
    v_mov_b32 v142, 0x3f803f80
    v_mov_b32 v143, 0x3f803f80
    v_mov_b32 v144, 0x3f803f80
    v_mov_b32 v145, 0x3f803f80
    v_mov_b32 v146, 0x3f803f80
    v_mov_b32 v147, 0x3f803f80
    v_mov_b32 v148, 0x3f803f80
    v_mov_b32 v149, 0x3f803f80
    v_mov_b32 v150, 0x3f803f80
    v_mov_b32 v151, 0x3f803f80
    v_mov_b32 v152, 0x3f803f80
    v_mov_b32 v153, 0x3f803f80
    v_mov_b32 v154, 0x3f803f80
    v_mov_b32 v155, 0x3f803f80
    v_mov_b32 v156, 0x3f803f80
    v_mov_b32 v157, 0x3f803f80
    v_mov_b32 v158, 0x3f803f80
    v_mov_b32 v159, 0x3f803f80
    v_mfma_f32_32x32x16_bf16 v[160:175], a[0:3], v[96:99], 0
    v_mfma_f32_32x32x16_bf16 v[176:191], a[4:7], v[96:99], 0
    v_mfma_f32_32x32x16_bf16 v[192:207], a[8:11], v[96:99], 0
    v_mfma_f32_32x32x16_bf16 v[208:223], a[12:15], v[96:99], 0
    v_mfma_f32_32x32x16_bf16 v[160:175], a[16:19], v[100:103], v[160:175]
    v_mfma_f32_32x32x16_bf16 v[176:191], a[20:23], v[100:103], v[176:191]
    v_mfma_f32_32x32x16_bf16 v[192:207], a[24:27], v[100:103], v[192:207]
    v_mfma_f32_32x32x16_bf16 v[208:223], a[28:31], v[100:103], v[208:223]
    v_mfma_f32_32x32x16_bf16 v[160:175], a[32:35], v[104:107], v[160:175]
    v_mfma_f32_32x32x16_bf16 v[176:191], a[36:39], v[104:107], v[176:191]
    v_mfma_f32_32x32x16_bf16 v[192:207], a[40:43], v[104:107], v[192:207]
    v_mfma_f32_32x32x16_bf16 v[208:223], a[44:47], v[104:107], v[208:223]
    v_mfma_f32_32x32x16_bf16 v[160:175], a[48:51], v[108:111], v[160:175]
    v_mfma_f32_32x32x16_bf16 v[176:191], a[52:55], v[108:111], v[176:191]
    v_mfma_f32_32x32x16_bf16 v[192:207], a[56:59], v[108:111], v[192:207]
    v_mfma_f32_32x32x16_bf16 v[208:223], a[60:63], v[108:111], v[208:223]
    v_mfma_f32_32x32x16_bf16 v[160:175], a[64:67], v[112:115], v[160:175]
    v_mfma_f32_32x32x16_bf16 v[176:191], a[68:71], v[112:115], v[176:191]
    v_mfma_f32_32x32x16_bf16 v[192:207], a[72:75], v[112:115], v[192:207]
    v_mfma_f32_32x32x16_bf16 v[208:223], a[76:79], v[112:115], v[208:223]
    v_mfma_f32_32x32x16_bf16 v[160:175], a[80:83], v[116:119], v[160:175]
    v_mfma_f32_32x32x16_bf16 v[176:191], a[84:87], v[116:119], v[176:191]
    v_mfma_f32_32x32x16_bf16 v[192:207], a[88:91], v[116:119], v[192:207]
    v_mfma_f32_32x32x16_bf16 v[208:223], a[92:95], v[116:119], v[208:223]
    v_mfma_f32_32x32x16_bf16 v[160:175], a[96:99], v[120:123], v[160:175]
    v_mfma_f32_32x32x16_bf16 v[176:191], a[100:103], v[120:123], v[176:191]
    v_mfma_f32_32x32x16_bf16 v[192:207], a[104:107], v[120:123], v[192:207]
    v_mfma_f32_32x32x16_bf16 v[208:223], a[108:111], v[120:123], v[208:223]
    v_mfma_f32_32x32x16_bf16 v[160:175], a[112:115], v[124:127], v[160:175]
    v_mfma_f32_32x32x16_bf16 v[176:191], a[116:119], v[124:127], v[176:191]
    v_mfma_f32_32x32x16_bf16 v[192:207], a[120:123], v[124:127], v[192:207]
    v_mfma_f32_32x32x16_bf16 v[208:223], a[124:127], v[124:127], v[208:223]
    v_mfma_f32_32x32x16_bf16 v[160:175], a[128:131], v[128:131], v[160:175]
    v_mfma_f32_32x32x16_bf16 v[176:191], a[132:135], v[128:131], v[176:191]
    v_mfma_f32_32x32x16_bf16 v[192:207], a[136:139], v[128:131], v[192:207]
    v_mfma_f32_32x32x16_bf16 v[208:223], a[140:143], v[128:131], v[208:223]
    v_mfma_f32_32x32x16_bf16 v[160:175], a[144:147], v[132:135], v[160:175]
    v_mfma_f32_32x32x16_bf16 v[176:191], a[148:151], v[132:135], v[176:191]
    v_mfma_f32_32x32x16_bf16 v[192:207], a[152:155], v[132:135], v[192:207]
    v_mfma_f32_32x32x16_bf16 v[208:223], a[156:159], v[132:135], v[208:223]
    v_mfma_f32_32x32x16_bf16 v[160:175], a[160:163], v[136:139], v[160:175]
    v_mfma_f32_32x32x16_bf16 v[176:191], a[164:167], v[136:139], v[176:191]
    v_mfma_f32_32x32x16_bf16 v[192:207], a[168:171], v[136:139], v[192:207]
    v_mfma_f32_32x32x16_bf16 v[208:223], a[172:175], v[136:139], v[208:223]
    v_mfma_f32_32x32x16_bf16 v[160:175], a[176:179], v[140:143], v[160:175]
    v_mfma_f32_32x32x16_bf16 v[176:191], a[180:183], v[140:143], v[176:191]
    v_mfma_f32_32x32x16_bf16 v[192:207], a[184:187], v[140:143], v[192:207]
    v_mfma_f32_32x32x16_bf16 v[208:223], a[188:191], v[140:143], v[208:223]
    v_mfma_f32_32x32x16_bf16 v[160:175], a[192:195], v[144:147], v[160:175]
    v_mfma_f32_32x32x16_bf16 v[176:191], a[196:199], v[144:147], v[176:191]
    v_mfma_f32_32x32x16_bf16 v[192:207], a[200:203], v[144:147], v[192:207]
    v_mfma_f32_32x32x16_bf16 v[208:223], a[204:207], v[144:147], v[208:223]
    v_mfma_f32_32x32x16_bf16 v[160:175], a[208:211], v[148:151], v[160:175]
    v_mfma_f32_32x32x16_bf16 v[176:191], a[212:215], v[148:151], v[176:191]
    v_mfma_f32_32x32x16_bf16 v[192:207], a[216:219], v[148:151], v[192:207]
    v_mfma_f32_32x32x16_bf16 v[208:223], a[220:223], v[148:151], v[208:223]
    v_mfma_f32_32x32x16_bf16 v[160:175], a[224:227], v[152:155], v[160:175]
    v_mfma_f32_32x32x16_bf16 v[176:191], a[228:231], v[152:155], v[176:191]
    v_mfma_f32_32x32x16_bf16 v[192:207], a[232:235], v[152:155], v[192:207]
    v_mfma_f32_32x32x16_bf16 v[208:223], a[236:239], v[152:155], v[208:223]
    v_mfma_f32_32x32x16_bf16 v[160:175], a[240:243], v[156:159], v[160:175]
    v_mfma_f32_32x32x16_bf16 v[176:191], a[244:247], v[156:159], v[176:191]
    v_mfma_f32_32x32x16_bf16 v[192:207], a[248:251], v[156:159], v[192:207]
    v_mfma_f32_32x32x16_bf16 v[208:223], a[252:255], v[156:159], v[208:223]
    s_nop 8
    ds_write_b128 v7, v[160:163] offset:0
    ds_write_b128 v7, v[164:167] offset:1024
    ds_write_b128 v7, v[168:171] offset:2048
    ds_write_b128 v7, v[172:175] offset:3072
    ds_write_b128 v7, v[176:179] offset:4096
    ds_write_b128 v7, v[180:183] offset:5120
    ds_write_b128 v7, v[184:187] offset:6144
    ds_write_b128 v7, v[188:191] offset:7168
    ds_write_b128 v7, v[192:195] offset:8192
    ds_write_b128 v7, v[196:199] offset:9216
    ds_write_b128 v7, v[200:203] offset:10240
    ds_write_b128 v7, v[204:207] offset:11264
    s_waitcnt lgkmcnt(0)
    s_barrier
    ds_read_b128 v[160:163], v8 offset:0
    ds_read_b128 v[164:167], v8 offset:1024
    ds_read_b128 v[168:171], v8 offset:2048
    ds_read_b128 v[172:175], v8 offset:3072
    ds_read_b128 v[176:179], v9 offset:0
    ds_read_b128 v[180:183], v9 offset:1024
    ds_read_b128 v[184:187], v9 offset:2048
    ds_read_b128 v[188:191], v9 offset:3072
    ds_read_b128 v[192:195], v10 offset:0
    ds_read_b128 v[196:199], v10 offset:1024
    ds_read_b128 v[200:203], v10 offset:2048
    ds_read_b128 v[204:207], v10 offset:3072
    s_waitcnt lgkmcnt(8)
    v_add_f32 v16, v208, v160
    v_add_f32 v17, v209, v161
    v_add_f32 v18, v210, v162
    v_add_f32 v19, v211, v163
    v_add_f32 v20, v212, v164
    v_add_f32 v21, v213, v165
    v_add_f32 v22, v214, v166
    v_add_f32 v23, v215, v167
    v_add_f32 v24, v216, v168
    v_add_f32 v25, v217, v169
    v_add_f32 v26, v218, v170
    v_add_f32 v27, v219, v171
    v_add_f32 v28, v220, v172
    v_add_f32 v29, v221, v173
    v_add_f32 v30, v222, v174
    v_add_f32 v31, v223, v175
    s_waitcnt lgkmcnt(0)
    v_add_f32 v176, v176, v192
    v_add_f32 v177, v177, v193
    v_add_f32 v178, v178, v194
    v_add_f32 v179, v179, v195
    v_add_f32 v180, v180, v196
    v_add_f32 v181, v181, v197
    v_add_f32 v182, v182, v198
    v_add_f32 v183, v183, v199
    v_add_f32 v184, v184, v200
    v_add_f32 v185, v185, v201
    v_add_f32 v186, v186, v202
    v_add_f32 v187, v187, v203
    v_add_f32 v188, v188, v204
    v_add_f32 v189, v189, v205
    v_add_f32 v190, v190, v206
    v_add_f32 v191, v191, v207
    v_add_f32 v16, v16, v176
    v_add_f32 v17, v17, v177
    v_add_f32 v18, v18, v178
    v_add_f32 v19, v19, v179
    v_add_f32 v20, v20, v180
    v_add_f32 v21, v21, v181
    v_add_f32 v22, v22, v182
    v_add_f32 v23, v23, v183
    v_add_f32 v24, v24, v184
    v_add_f32 v25, v25, v185
    v_add_f32 v26, v26, v186
    v_add_f32 v27, v27, v187
    v_add_f32 v28, v28, v188
    v_add_f32 v29, v29, v189
    v_add_f32 v30, v30, v190
    v_add_f32 v31, v31, v191
    v_xor_b32 v7, 0x10000, v7
    v_xor_b32 v8, 0x10000, v8
    v_xor_b32 v9, 0x10000, v9
    v_xor_b32 v10, 0x10000, v10
    s_mov_b32 s45, 262144
    s_mov_b32 s44, 0
    s_lshl_b32 s56, s44, 13
    s_add_u32 s52, s56, s66
    s_add_u32 s54, s56, s67
    s_mul_i32 s53, s44, 229376
    s_add_u32 s53, s53, s68
    s_mul_i32 s69, s44, 65536
    s_add_u32 s69, s69, s46
mega_kernel_G_p0:
    buffer_load_dword v3, v2, s[36:39], s52 offen sc1
    s_waitcnt vmcnt(0)
    v_cmp_eq_u32 vcc, 0, v3
    s_cbranch_vccz mega_kernel_G_p0_ok
    s_cmp_eq_u32 s45, 0
    s_cbranch_scc1 mega_kernel_G_p0_ok
    s_sub_u32 s45, s45, 1
    s_sleep 1
    s_branch mega_kernel_G_p0
mega_kernel_G_p0_ok:
    s_branch mega_kernel_G0_cold
mega_kernel_G0_deep:
    s_lshl_b32 s56, s44, 13
    s_add_u32 s52, s56, s66
    s_add_u32 s54, s56, s67
    s_mul_i32 s53, s44, 229376
    s_add_u32 s53, s53, s68
    s_mul_i32 s69, s44, 65536
    s_add_u32 s69, s69, s46
    s_waitcnt vmcnt(1)
    s_cmp_eq_u32 s44, 63
    s_cbranch_scc1 mega_kernel_G0_pre2
    v_cmp_eq_u32 vcc, 0, v3
    s_cbranch_vccnz mega_kernel_G0_pre2
    s_add_u32 s48, s69, 65536
    s_add_u32 s49, s69, 69632
    s_add_u32 s50, s69, 73728
    s_add_u32 s51, s69, 77824
    v_mfma_f32_32x32x16_bf16 v[160:175], a[0:3], v[32:35], 0
    buffer_load_dwordx4 v[96:99], v1, s[28:31], s48 offen offset:0 sc1
    v_add_f32 v224, v224, v226
    v_mfma_f32_32x32x16_bf16 v[176:191], a[4:7], v[32:35], 0
    buffer_load_dwordx4 v[100:103], v1, s[28:31], s48 offen offset:1024 sc1
    v_mfma_f32_32x32x16_bf16 v[192:207], a[8:11], v[32:35], 0
    v_add_f32 v225, v225, v227
    v_mfma_f32_32x32x16_bf16 v[208:223], a[12:15], v[32:35], 0
    buffer_load_dwordx4 v[104:107], v1, s[28:31], s48 offen offset:2048 sc1
    v_mfma_f32_32x32x16_bf16 v[160:175], a[16:19], v[36:39], v[160:175]
    v_add_f32 v224, v224, v228
    v_mfma_f32_32x32x16_bf16 v[176:191], a[20:23], v[36:39], v[176:191]
    buffer_load_dwordx4 v[108:111], v1, s[28:31], s48 offen offset:3072 sc1
    v_mfma_f32_32x32x16_bf16 v[192:207], a[24:27], v[36:39], v[192:207]
    v_add_f32 v225, v225, v229
    v_mfma_f32_32x32x16_bf16 v[208:223], a[28:31], v[36:39], v[208:223]
    buffer_load_dwordx4 v[112:115], v1, s[28:31], s49 offen offset:0 sc1
    v_mfma_f32_32x32x16_bf16 v[160:175], a[32:35], v[40:43], v[160:175]
    v_add_f32 v224, v224, v230
    buffer_load_dwordx4 v[116:119], v1, s[28:31], s49 offen offset:1024 sc1
    v_mfma_f32_32x32x16_bf16 v[176:191], a[36:39], v[40:43], v[176:191]
    v_add_f32 v225, v225, v231
    v_mfma_f32_32x32x16_bf16 v[192:207], a[40:43], v[40:43], v[192:207]
    buffer_load_dwordx4 v[120:123], v1, s[28:31], s49 offen offset:2048 sc1
    v_mfma_f32_32x32x16_bf16 v[208:223], a[44:47], v[40:43], v[208:223]
    v_add_f32 v224, v224, v232
    v_mfma_f32_32x32x16_bf16 v[160:175], a[48:51], v[44:47], v[160:175]
    buffer_load_dwordx4 v[124:127], v1, s[28:31], s49 offen offset:3072 sc1
    v_mfma_f32_32x32x16_bf16 v[176:191], a[52:55], v[44:47], v[176:191]
    v_add_f32 v225, v225, v233
    v_mfma_f32_32x32x16_bf16 v[192:207], a[56:59], v[44:47], v[192:207]
    buffer_load_dwordx4 v[128:131], v1, s[28:31], s50 offen offset:0 sc1
    v_mfma_f32_32x32x16_bf16 v[208:223], a[60:63], v[44:47], v[208:223]
    v_add_f32 v224, v224, v234
    v_mfma_f32_32x32x16_bf16 v[160:175], a[64:67], v[48:51], v[160:175]
    buffer_load_dwordx4 v[132:135], v1, s[28:31], s50 offen offset:1024 sc1
    v_add_f32 v225, v225, v235
    v_mfma_f32_32x32x16_bf16 v[176:191], a[68:71], v[48:51], v[176:191]
    v_add_f32 v224, v224, v236
    v_mfma_f32_32x32x16_bf16 v[192:207], a[72:75], v[48:51], v[192:207]
    v_add_f32 v225, v225, v237
    v_mfma_f32_32x32x16_bf16 v[208:223], a[76:79], v[48:51], v[208:223]
    v_add_f32 v224, v224, v238
    v_mfma_f32_32x32x16_bf16 v[160:175], a[80:83], v[52:55], v[160:175]
    v_add_f32 v225, v225, v239
    v_mfma_f32_32x32x16_bf16 v[176:191], a[84:87], v[52:55], v[176:191]
    v_mov_b32 v226, v224
    v_mfma_f32_32x32x16_bf16 v[192:207], a[88:91], v[52:55], v[192:207]
    v_mov_b32 v227, v225
    v_mfma_f32_32x32x16_bf16 v[208:223], a[92:95], v[52:55], v[208:223]
    v_permlane32_swap_b32 v226, v224
    v_mfma_f32_32x32x16_bf16 v[160:175], a[96:99], v[56:59], v[160:175]
    v_permlane32_swap_b32 v227, v225
    v_add_f32 v224, v224, v226
    v_mfma_f32_32x32x16_bf16 v[176:191], a[100:103], v[56:59], v[176:191]
    v_add_f32 v225, v225, v227
    v_mfma_f32_32x32x16_bf16 v[192:207], a[104:107], v[56:59], v[192:207]
    v_mul_f32 v12, 0x3a800000, v224
    v_mfma_f32_32x32x16_bf16 v[208:223], a[108:111], v[56:59], v[208:223]
    v_mul_f32 v225, 0x3a800000, v225
    v_mfma_f32_32x32x16_bf16 v[160:175], a[112:115], v[60:63], v[160:175]
    v_fma_f32 v225, -v12, v12, v225
    v_mfma_f32_32x32x16_bf16 v[176:191], a[116:119], v[60:63], v[176:191]
    v_max_f32 v225, 0, v225
    v_mfma_f32_32x32x16_bf16 v[192:207], a[120:123], v[60:63], v[192:207]
    v_add_f32 v225, 0x3727c5ac, v225
    v_mfma_f32_32x32x16_bf16 v[208:223], a[124:127], v[60:63], v[208:223]
    v_rsq_f32 v13, v225
    s_waitcnt vmcnt(10)
    s_mov_b64 exec, 1
    buffer_store_byte v14, off, s[36:39], s47 sc1
    s_mov_b64 exec, -1
    s_mov_b32 s55, 1
    s_nop 1
    s_branch mega_kernel_G0_p2d
mega_kernel_G0_pre:
    s_lshl_b32 s56, s44, 13
    s_add_u32 s52, s56, s66
    s_add_u32 s54, s56, s67
    s_mul_i32 s53, s44, 229376
    s_add_u32 s53, s53, s68
    s_mul_i32 s69, s44, 65536
    s_add_u32 s69, s69, s46
mega_kernel_G0_pre2:
    s_add_u32 s56, s52, 8192
    buffer_load_dword v3, v2, s[36:39], s56 offen sc1
    s_waitcnt vmcnt(2)
    v_mfma_f32_32x32x16_bf16 v[160:175], a[0:3], v[32:35], 0
    v_add_f32 v224, v224, v226
    v_mfma_f32_32x32x16_bf16 v[176:191], a[4:7], v[32:35], 0
    v_add_f32 v225, v225, v227
    v_mfma_f32_32x32x16_bf16 v[192:207], a[8:11], v[32:35], 0
    v_add_f32 v224, v224, v228
    v_mfma_f32_32x32x16_bf16 v[208:223], a[12:15], v[32:35], 0
    v_add_f32 v225, v225, v229
    v_mfma_f32_32x32x16_bf16 v[160:175], a[16:19], v[36:39], v[160:175]
    v_add_f32 v224, v224, v230
    v_mfma_f32_32x32x16_bf16 v[176:191], a[20:23], v[36:39], v[176:191]
    v_mfma_f32_32x32x16_bf16 v[192:207], a[24:27], v[36:39], v[192:207]
    v_add_f32 v225, v225, v231
    v_mfma_f32_32x32x16_bf16 v[208:223], a[28:31], v[36:39], v[208:223]
    v_add_f32 v224, v224, v232
    v_mfma_f32_32x32x16_bf16 v[160:175], a[32:35], v[40:43], v[160:175]
    v_add_f32 v225, v225, v233
    v_mfma_f32_32x32x16_bf16 v[176:191], a[36:39], v[40:43], v[176:191]
    v_add_f32 v224, v224, v234
    v_mfma_f32_32x32x16_bf16 v[192:207], a[40:43], v[40:43], v[192:207]
    v_mfma_f32_32x32x16_bf16 v[208:223], a[44:47], v[40:43], v[208:223]
    v_add_f32 v225, v225, v235
    v_mfma_f32_32x32x16_bf16 v[160:175], a[48:51], v[44:47], v[160:175]
    v_add_f32 v224, v224, v236
    v_mfma_f32_32x32x16_bf16 v[176:191], a[52:55], v[44:47], v[176:191]
    v_add_f32 v225, v225, v237
    v_mfma_f32_32x32x16_bf16 v[192:207], a[56:59], v[44:47], v[192:207]
    v_add_f32 v224, v224, v238
    v_mfma_f32_32x32x16_bf16 v[208:223], a[60:63], v[44:47], v[208:223]
    v_mfma_f32_32x32x16_bf16 v[160:175], a[64:67], v[48:51], v[160:175]
    v_add_f32 v225, v225, v239
    v_mfma_f32_32x32x16_bf16 v[176:191], a[68:71], v[48:51], v[176:191]
    v_mov_b32 v226, v224
    v_mfma_f32_32x32x16_bf16 v[192:207], a[72:75], v[48:51], v[192:207]
    v_mov_b32 v227, v225
    v_mfma_f32_32x32x16_bf16 v[208:223], a[76:79], v[48:51], v[208:223]
    v_permlane32_swap_b32 v226, v224
    v_mfma_f32_32x32x16_bf16 v[160:175], a[80:83], v[52:55], v[160:175]
    v_permlane32_swap_b32 v227, v225
    v_mfma_f32_32x32x16_bf16 v[176:191], a[84:87], v[52:55], v[176:191]
    v_mfma_f32_32x32x16_bf16 v[192:207], a[88:91], v[52:55], v[192:207]
    v_add_f32 v224, v224, v226
    v_mfma_f32_32x32x16_bf16 v[208:223], a[92:95], v[52:55], v[208:223]
    v_add_f32 v225, v225, v227
    v_mfma_f32_32x32x16_bf16 v[160:175], a[96:99], v[56:59], v[160:175]
    v_mul_f32 v12, 0x3a800000, v224
    v_mfma_f32_32x32x16_bf16 v[176:191], a[100:103], v[56:59], v[176:191]
    v_mul_f32 v225, 0x3a800000, v225
    v_mfma_f32_32x32x16_bf16 v[192:207], a[104:107], v[56:59], v[192:207]
    v_mfma_f32_32x32x16_bf16 v[208:223], a[108:111], v[56:59], v[208:223]
    v_fma_f32 v225, -v12, v12, v225
    v_mfma_f32_32x32x16_bf16 v[160:175], a[112:115], v[60:63], v[160:175]
    v_max_f32 v225, 0, v225
    v_mfma_f32_32x32x16_bf16 v[176:191], a[116:119], v[60:63], v[176:191]
    v_add_f32 v225, 0x3727c5ac, v225
    v_mfma_f32_32x32x16_bf16 v[192:207], a[120:123], v[60:63], v[192:207]
    v_rsq_f32 v13, v225
    v_mfma_f32_32x32x16_bf16 v[208:223], a[124:127], v[60:63], v[208:223]
    s_waitcnt vmcnt(0)
    s_mov_b64 exec, 1
    buffer_store_byte v14, off, s[36:39], s47 sc1
    s_mov_b64 exec, -1
    s_branch mega_kernel_G0_mid
mega_kernel_G0_cold:
    s_add_u32 s48, s69, 0
    s_add_u32 s49, s69, 4096
    s_add_u32 s50, s69, 8192
    s_add_u32 s51, s69, 12288
    s_lshl_b32 s57, s44, 12
    buffer_load_dwordx4 v[224:227], v11, s[40:43], s57 offen offset:0 sc1
    buffer_load_dwordx4 v[228:231], v11, s[40:43], s57 offen offset:16 sc1
    buffer_load_dwordx4 v[232:235], v11, s[40:43], s57 offen offset:32 sc1
    buffer_load_dwordx4 v[236:239], v11, s[40:43], s57 offen offset:48 sc1
    buffer_load_dwordx4 v[32:35], v1, s[28:31], s48 offen offset:0 sc1
    buffer_load_dwordx4 v[36:39], v1, s[28:31], s48 offen offset:1024 sc1
    buffer_load_dwordx4 v[40:43], v1, s[28:31], s48 offen offset:2048 sc1
    buffer_load_dwordx4 v[44:47], v1, s[28:31], s48 offen offset:3072 sc1
    buffer_load_dwordx4 v[48:51], v1, s[28:31], s49 offen offset:0 sc1
    buffer_load_dwordx4 v[52:55], v1, s[28:31], s49 offen offset:1024 sc1
    buffer_load_dwordx4 v[56:59], v1, s[28:31], s49 offen offset:2048 sc1
    buffer_load_dwordx4 v[60:63], v1, s[28:31], s49 offen offset:3072 sc1
    s_waitcnt vmcnt(7)
    v_mfma_f32_32x32x16_bf16 v[160:175], a[0:3], v[32:35], 0
    buffer_load_dwordx4 v[64:67], v1, s[28:31], s50 offen offset:0 sc1
    v_mfma_f32_32x32x16_bf16 v[176:191], a[4:7], v[32:35], 0
    v_mfma_f32_32x32x16_bf16 v[192:207], a[8:11], v[32:35], 0
    buffer_load_dwordx4 v[68:71], v1, s[28:31], s50 offen offset:1024 sc1
    v_mfma_f32_32x32x16_bf16 v[208:223], a[12:15], v[32:35], 0
    s_waitcnt vmcnt(8)
    v_mfma_f32_32x32x16_bf16 v[160:175], a[16:19], v[36:39], v[160:175]
    buffer_load_dwordx4 v[72:75], v1, s[28:31], s50 offen offset:2048 sc1
    v_mfma_f32_32x32x16_bf16 v[176:191], a[20:23], v[36:39], v[176:191]
    v_mfma_f32_32x32x16_bf16 v[192:207], a[24:27], v[36:39], v[192:207]
    buffer_load_dwordx4 v[76:79], v1, s[28:31], s50 offen offset:3072 sc1
    v_mfma_f32_32x32x16_bf16 v[208:223], a[28:31], v[36:39], v[208:223]
    s_waitcnt vmcnt(9)
    v_mfma_f32_32x32x16_bf16 v[160:175], a[32:35], v[40:43], v[160:175]
    buffer_load_dwordx4 v[80:83], v1, s[28:31], s51 offen offset:0 sc1
    v_mfma_f32_32x32x16_bf16 v[176:191], a[36:39], v[40:43], v[176:191]
    v_mfma_f32_32x32x16_bf16 v[192:207], a[40:43], v[40:43], v[192:207]
    buffer_load_dwordx4 v[84:87], v1, s[28:31], s51 offen offset:1024 sc1
    v_mfma_f32_32x32x16_bf16 v[208:223], a[44:47], v[40:43], v[208:223]
    s_waitcnt vmcnt(10)
    v_mfma_f32_32x32x16_bf16 v[160:175], a[48:51], v[44:47], v[160:175]
    buffer_load_dwordx4 v[88:91], v1, s[28:31], s51 offen offset:2048 sc1
    v_mfma_f32_32x32x16_bf16 v[176:191], a[52:55], v[44:47], v[176:191]
    v_mfma_f32_32x32x16_bf16 v[192:207], a[56:59], v[44:47], v[192:207]
    buffer_load_dwordx4 v[92:95], v1, s[28:31], s51 offen offset:3072 sc1
    s_add_u32 s56, s52, 8192
    buffer_load_dword v3, v2, s[36:39], s56 offen sc1
    v_mfma_f32_32x32x16_bf16 v[208:223], a[60:63], v[44:47], v[208:223]
    s_waitcnt vmcnt(12)
    v_mfma_f32_32x32x16_bf16 v[160:175], a[64:67], v[48:51], v[160:175]
    v_add_f32 v224, v224, v226
    v_add_f32 v225, v225, v227
    v_mfma_f32_32x32x16_bf16 v[176:191], a[68:71], v[48:51], v[176:191]
    v_add_f32 v224, v224, v228
    v_add_f32 v225, v225, v229
    v_mfma_f32_32x32x16_bf16 v[192:207], a[72:75], v[48:51], v[192:207]
    v_add_f32 v224, v224, v230
    v_add_f32 v225, v225, v231
    v_mfma_f32_32x32x16_bf16 v[208:223], a[76:79], v[48:51], v[208:223]
    v_add_f32 v224, v224, v232
    v_add_f32 v225, v225, v233
    s_waitcnt vmcnt(11)
    v_mfma_f32_32x32x16_bf16 v[160:175], a[80:83], v[52:55], v[160:175]
    v_add_f32 v224, v224, v234
    v_add_f32 v225, v225, v235
    v_mfma_f32_32x32x16_bf16 v[176:191], a[84:87], v[52:55], v[176:191]
    v_add_f32 v224, v224, v236
    v_add_f32 v225, v225, v237
    v_mfma_f32_32x32x16_bf16 v[192:207], a[88:91], v[52:55], v[192:207]
    v_add_f32 v224, v224, v238
    v_add_f32 v225, v225, v239
    v_mfma_f32_32x32x16_bf16 v[208:223], a[92:95], v[52:55], v[208:223]
    v_mov_b32 v226, v224
    v_mov_b32 v227, v225
    s_waitcnt vmcnt(10)
    v_mfma_f32_32x32x16_bf16 v[160:175], a[96:99], v[56:59], v[160:175]
    v_permlane32_swap_b32 v226, v224
    v_permlane32_swap_b32 v227, v225
    v_mfma_f32_32x32x16_bf16 v[176:191], a[100:103], v[56:59], v[176:191]
    v_add_f32 v224, v224, v226
    v_add_f32 v225, v225, v227
    v_mfma_f32_32x32x16_bf16 v[192:207], a[104:107], v[56:59], v[192:207]
    v_mul_f32 v12, 0x3a800000, v224
    v_mul_f32 v225, 0x3a800000, v225
    v_mfma_f32_32x32x16_bf16 v[208:223], a[108:111], v[56:59], v[208:223]
    v_fma_f32 v225, -v12, v12, v225
    v_max_f32 v225, 0, v225
    s_waitcnt vmcnt(9)
    v_mfma_f32_32x32x16_bf16 v[160:175], a[112:115], v[60:63], v[160:175]
    v_add_f32 v225, 0x3727c5ac, v225
    v_rsq_f32 v13, v225
    v_mfma_f32_32x32x16_bf16 v[176:191], a[116:119], v[60:63], v[176:191]
    v_mfma_f32_32x32x16_bf16 v[192:207], a[120:123], v[60:63], v[192:207]
    v_mfma_f32_32x32x16_bf16 v[208:223], a[124:127], v[60:63], v[208:223]
    s_waitcnt vmcnt(0)
mega_kernel_G0_mid:
    s_mov_b32 s55, 0
    s_cmp_eq_u32 s44, 63
    s_cbranch_scc1 mega_kernel_G0_p2n
    v_cmp_eq_u32 vcc, 0, v3
    s_cbranch_vccnz mega_kernel_G0_p2n
    s_mov_b32 s55, 1
    s_add_u32 s48, s69, 65536
    s_add_u32 s49, s69, 69632
    s_add_u32 s50, s69, 73728
    s_add_u32 s51, s69, 77824
    s_lshl_b32 s57, s44, 12
    s_add_u32 s57, s57, 4096
    s_add_u32 s56, s52, 16384
    v_mfma_f32_32x32x16_bf16 v[160:175], a[128:131], v[64:67], v[160:175]
    v_mfma_f32_32x32x16_bf16 v[160:175], a[144:147], v[68:71], v[160:175]
    buffer_load_dwordx4 v[224:227], v11, s[40:43], s57 offen offset:0 sc1
    v_mfma_f32_32x32x16_bf16 v[160:175], a[160:163], v[72:75], v[160:175]
    v_mfma_f32_32x32x16_bf16 v[160:175], a[176:179], v[76:79], v[160:175]
    buffer_load_dwordx4 v[228:231], v11, s[40:43], s57 offen offset:16 sc1
    v_mfma_f32_32x32x16_bf16 v[160:175], a[192:195], v[80:83], v[160:175]
    v_mfma_f32_32x32x16_bf16 v[160:175], a[208:211], v[84:87], v[160:175]
    buffer_load_dwordx4 v[232:235], v11, s[40:43], s57 offen offset:32 sc1
    v_mfma_f32_32x32x16_bf16 v[160:175], a[224:227], v[88:91], v[160:175]
    v_mfma_f32_32x32x16_bf16 v[160:175], a[240:243], v[92:95], v[160:175]
    v_mfma_f32_32x32x16_bf16 v[176:191], a[132:135], v[64:67], v[176:191]
    v_mfma_f32_32x32x16_bf16 v[176:191], a[148:151], v[68:71], v[176:191]
    s_nop 9
    ds_write_b128 v7, v[160:163] offset:0
    v_mfma_f32_32x32x16_bf16 v[176:191], a[164:167], v[72:75], v[176:191]
    buffer_load_dwordx4 v[236:239], v11, s[40:43], s57 offen offset:48 sc1
    v_mfma_f32_32x32x16_bf16 v[176:191], a[180:183], v[76:79], v[176:191]
    ds_write_b128 v7, v[164:167] offset:1024
    v_mfma_f32_32x32x16_bf16 v[176:191], a[196:199], v[80:83], v[176:191]
    buffer_load_dwordx4 v[96:99], v1, s[28:31], s48 offen offset:0 sc1
    v_mfma_f32_32x32x16_bf16 v[176:191], a[212:215], v[84:87], v[176:191]
    ds_write_b128 v7, v[168:171] offset:2048
    v_mfma_f32_32x32x16_bf16 v[176:191], a[228:231], v[88:91], v[176:191]
    buffer_load_dwordx4 v[100:103], v1, s[28:31], s48 offen offset:1024 sc1
    v_mfma_f32_32x32x16_bf16 v[176:191], a[244:247], v[92:95], v[176:191]
    ds_write_b128 v7, v[172:175] offset:3072
    v_mfma_f32_32x32x16_bf16 v[192:207], a[136:139], v[64:67], v[192:207]
    v_mfma_f32_32x32x16_bf16 v[192:207], a[152:155], v[68:71], v[192:207]
    s_nop 8
    ds_write_b128 v7, v[176:179] offset:4096
    v_mfma_f32_32x32x16_bf16 v[192:207], a[168:171], v[72:75], v[192:207]
    buffer_load_dwordx4 v[104:107], v1, s[28:31], s48 offen offset:2048 sc1
    v_mfma_f32_32x32x16_bf16 v[192:207], a[184:187], v[76:79], v[192:207]
    ds_write_b128 v7, v[180:183] offset:5120
    v_mfma_f32_32x32x16_bf16 v[192:207], a[200:203], v[80:83], v[192:207]
    buffer_load_dwordx4 v[108:111], v1, s[28:31], s48 offen offset:3072 sc1
    v_mfma_f32_32x32x16_bf16 v[192:207], a[216:219], v[84:87], v[192:207]
    ds_write_b128 v7, v[184:187] offset:6144
    v_mfma_f32_32x32x16_bf16 v[192:207], a[232:235], v[88:91], v[192:207]
    buffer_load_dwordx4 v[112:115], v1, s[28:31], s49 offen offset:0 sc1
    v_mfma_f32_32x32x16_bf16 v[192:207], a[248:251], v[92:95], v[192:207]
    ds_write_b128 v7, v[188:191] offset:7168
    v_mfma_f32_32x32x16_bf16 v[208:223], a[140:143], v[64:67], v[208:223]
    v_mfma_f32_32x32x16_bf16 v[208:223], a[156:159], v[68:71], v[208:223]
    s_nop 8
    ds_write_b128 v7, v[192:195] offset:8192
    v_mfma_f32_32x32x16_bf16 v[208:223], a[172:175], v[72:75], v[208:223]
    buffer_load_dwordx4 v[116:119], v1, s[28:31], s49 offen offset:1024 sc1
    v_mfma_f32_32x32x16_bf16 v[208:223], a[188:191], v[76:79], v[208:223]
    ds_write_b128 v7, v[196:199] offset:9216
    v_mfma_f32_32x32x16_bf16 v[208:223], a[204:207], v[80:83], v[208:223]
    buffer_load_dwordx4 v[120:123], v1, s[28:31], s49 offen offset:2048 sc1
    v_mfma_f32_32x32x16_bf16 v[208:223], a[220:223], v[84:87], v[208:223]
    ds_write_b128 v7, v[200:203] offset:10240
    v_mfma_f32_32x32x16_bf16 v[208:223], a[236:239], v[88:91], v[208:223]
    ds_write_b128 v7, v[204:207] offset:11264
    v_mfma_f32_32x32x16_bf16 v[208:223], a[252:255], v[92:95], v[208:223]
    s_waitcnt lgkmcnt(0)
    s_barrier
    ds_read_b128 v[160:163], v8 offset:0
    ds_read_b128 v[164:167], v8 offset:1024
    ds_read_b128 v[168:171], v8 offset:2048
    ds_read_b128 v[172:175], v8 offset:3072
    ds_read_b128 v[176:179], v9 offset:0
    ds_read_b128 v[180:183], v9 offset:1024
    ds_read_b128 v[184:187], v9 offset:2048
    ds_read_b128 v[188:191], v9 offset:3072
    ds_read_b128 v[192:195], v10 offset:0
    ds_read_b128 v[196:199], v10 offset:1024
    ds_read_b128 v[200:203], v10 offset:2048
    ds_read_b128 v[204:207], v10 offset:3072
    buffer_load_dwordx4 v[124:127], v1, s[28:31], s49 offen offset:3072 sc1
    buffer_load_dwordx4 v[128:131], v1, s[28:31], s50 offen offset:0 sc1
    buffer_load_dwordx4 v[132:135], v1, s[28:31], s50 offen offset:1024 sc1
    buffer_load_dwordx4 v[136:139], v1, s[28:31], s50 offen offset:2048 sc1
    buffer_load_dwordx4 v[140:143], v1, s[28:31], s50 offen offset:3072 sc1
    s_waitcnt lgkmcnt(8)
    buffer_load_dwordx4 v[144:147], v1, s[28:31], s51 offen offset:0 sc1
    v_add_f32 v32, v208, v160
    v_add_f32 v33, v209, v161
    v_add_f32 v34, v210, v162
    v_add_f32 v35, v211, v163
    v_add_f32 v36, v212, v164
    v_add_f32 v37, v213, v165
    v_add_f32 v38, v214, v166
    v_add_f32 v39, v215, v167
    v_add_f32 v40, v216, v168
    v_add_f32 v41, v217, v169
    buffer_load_dwordx4 v[148:151], v1, s[28:31], s51 offen offset:1024 sc1
    v_add_f32 v42, v218, v170
    v_add_f32 v43, v219, v171
    v_add_f32 v44, v220, v172
    v_add_f32 v45, v221, v173
    v_add_f32 v46, v222, v174
    v_add_f32 v47, v223, v175
    s_waitcnt lgkmcnt(0)
    v_add_f32 v176, v176, v192
    v_add_f32 v177, v177, v193
    v_add_f32 v178, v178, v194
    v_add_f32 v179, v179, v195
    buffer_load_dwordx4 v[152:155], v1, s[28:31], s51 offen offset:2048 sc1
    v_add_f32 v180, v180, v196
    v_add_f32 v181, v181, v197
    v_add_f32 v182, v182, v198
    v_add_f32 v183, v183, v199
    v_add_f32 v184, v184, v200
    v_add_f32 v185, v185, v201
    v_add_f32 v186, v186, v202
    v_add_f32 v187, v187, v203
    v_add_f32 v188, v188, v204
    v_add_f32 v189, v189, v205
    v_add_f32 v190, v190, v206
    buffer_load_dwordx4 v[156:159], v1, s[28:31], s51 offen offset:3072 sc1
    v_add_f32 v191, v191, v207
    v_add_f32 v32, v32, v176
    v_add_f32 v33, v33, v177
    v_add_f32 v34, v34, v178
    v_add_f32 v35, v35, v179
    v_add_f32 v36, v36, v180
    v_add_f32 v37, v37, v181
    v_add_f32 v38, v38, v182
    v_add_f32 v39, v39, v183
    v_add_f32 v40, v40, v184
    v_add_f32 v41, v41, v185
    buffer_load_dword v3, v2, s[36:39], s56 offen sc1
    v_add_f32 v42, v42, v186
    v_add_f32 v43, v43, v187
    v_add_f32 v44, v44, v188
    v_add_f32 v45, v45, v189
    v_add_f32 v46, v46, v190
    v_add_f32 v47, v47, v191
    v_xor_b32 v7, 0x10000, v7
    v_xor_b32 v8, 0x10000, v8
    v_xor_b32 v9, 0x10000, v9
    v_xor_b32 v10, 0x10000, v10
    v_mul_f32 v15, 0xbfb8aa3b, v13
    v_fma_f32 v32, -v12, v16, v32
    v_fma_f32 v33, -v12, v17, v33
    v_fma_f32 v34, -v12, v18, v34
    v_fma_f32 v35, -v12, v19, v35
    v_fma_f32 v36, -v12, v20, v36
    v_fma_f32 v37, -v12, v21, v37
    v_fma_f32 v38, -v12, v22, v38
    v_fma_f32 v39, -v12, v23, v39
    v_fma_f32 v40, -v12, v24, v40
    v_fma_f32 v41, -v12, v25, v41
    v_fma_f32 v42, -v12, v26, v42
    v_fma_f32 v43, -v12, v27, v43
    v_fma_f32 v44, -v12, v28, v44
    v_fma_f32 v45, -v12, v29, v45
    v_fma_f32 v46, -v12, v30, v46
    v_fma_f32 v47, -v12, v31, v47
    v_mul_f32 v32, v32, v15
    v_mul_f32 v33, v33, v15
    v_mul_f32 v34, v34, v15
    v_mul_f32 v35, v35, v15
    v_mul_f32 v36, v36, v15
    v_mul_f32 v37, v37, v15
    v_mul_f32 v38, v38, v15
    v_mul_f32 v39, v39, v15
    v_exp_f32 v32, v32
    v_exp_f32 v33, v33
    v_exp_f32 v34, v34
    v_exp_f32 v35, v35
    v_exp_f32 v36, v36
    v_exp_f32 v37, v37
    v_exp_f32 v38, v38
    v_exp_f32 v39, v39
    v_mul_f32 v40, v40, v13
    v_mul_f32 v41, v41, v13
    v_mul_f32 v42, v42, v13
    v_mul_f32 v43, v43, v13
    v_mul_f32 v44, v44, v13
    v_mul_f32 v45, v45, v13
    v_mul_f32 v46, v46, v13
    v_mul_f32 v47, v47, v13
    v_add_f32 v32, 1.0, v32
    v_add_f32 v33, 1.0, v33
    v_add_f32 v34, 1.0, v34
    v_add_f32 v35, 1.0, v35
    v_add_f32 v36, 1.0, v36
    v_add_f32 v37, 1.0, v37
    v_add_f32 v38, 1.0, v38
    v_add_f32 v39, 1.0, v39
    v_rcp_f32 v32, v32
    v_rcp_f32 v33, v33
    v_rcp_f32 v34, v34
    v_rcp_f32 v35, v35
    v_rcp_f32 v36, v36
    v_rcp_f32 v37, v37
    v_rcp_f32 v38, v38
    v_rcp_f32 v39, v39
    v_mul_f32 v32, v32, v40
    v_mul_f32 v33, v33, v41
    v_mul_f32 v34, v34, v42
    v_mul_f32 v35, v35, v43
    v_mul_f32 v36, v36, v44
    v_mul_f32 v37, v37, v45
    v_mul_f32 v38, v38, v46
    v_mul_f32 v39, v39, v47
    v_cvt_pk_bf16_f32 v48, v32, v33
    v_cvt_pk_bf16_f32 v49, v34, v35
    v_cvt_pk_bf16_f32 v50, v36, v37
    v_cvt_pk_bf16_f32 v51, v38, v39
    buffer_store_dwordx4 v[48:51], v1, s[32:35], s53 offen sc1
    s_branch mega_kernel_G0_post
mega_kernel_G0_p2d:
    s_lshl_b32 s57, s44, 12
    s_add_u32 s57, s57, 4096
    s_add_u32 s56, s52, 16384
    v_mfma_f32_32x32x16_bf16 v[160:175], a[128:131], v[64:67], v[160:175]
    v_mfma_f32_32x32x16_bf16 v[160:175], a[144:147], v[68:71], v[160:175]
    buffer_load_dwordx4 v[136:139], v1, s[28:31], s50 offen offset:2048 sc1
    v_mfma_f32_32x32x16_bf16 v[160:175], a[160:163], v[72:75], v[160:175]
    v_mfma_f32_32x32x16_bf16 v[160:175], a[176:179], v[76:79], v[160:175]
    buffer_load_dwordx4 v[140:143], v1, s[28:31], s50 offen offset:3072 sc1
    v_mfma_f32_32x32x16_bf16 v[160:175], a[192:195], v[80:83], v[160:175]
    v_mfma_f32_32x32x16_bf16 v[160:175], a[208:211], v[84:87], v[160:175]
    buffer_load_dwordx4 v[224:227], v11, s[40:43], s57 offen offset:0 sc1
    v_mfma_f32_32x32x16_bf16 v[160:175], a[224:227], v[88:91], v[160:175]
    v_mfma_f32_32x32x16_bf16 v[160:175], a[240:243], v[92:95], v[160:175]
    v_mfma_f32_32x32x16_bf16 v[176:191], a[132:135], v[64:67], v[176:191]
    v_mfma_f32_32x32x16_bf16 v[176:191], a[148:151], v[68:71], v[176:191]
    s_nop 9
    ds_write_b128 v7, v[160:163] offset:0
    v_mfma_f32_32x32x16_bf16 v[176:191], a[164:167], v[72:75], v[176:191]
    buffer_load_dwordx4 v[228:231], v11, s[40:43], s57 offen offset:16 sc1
    v_mfma_f32_32x32x16_bf16 v[176:191], a[180:183], v[76:79], v[176:191]
    ds_write_b128 v7, v[164:167] offset:1024
    v_mfma_f32_32x32x16_bf16 v[176:191], a[196:199], v[80:83], v[176:191]
    buffer_load_dwordx4 v[232:235], v11, s[40:43], s57 offen offset:32 sc1
    v_mfma_f32_32x32x16_bf16 v[176:191], a[212:215], v[84:87], v[176:191]
    ds_write_b128 v7, v[168:171] offset:2048
    v_mfma_f32_32x32x16_bf16 v[176:191], a[228:231], v[88:91], v[176:191]
    buffer_load_dwordx4 v[236:239], v11, s[40:43], s57 offen offset:48 sc1
    v_mfma_f32_32x32x16_bf16 v[176:191], a[244:247], v[92:95], v[176:191]
    ds_write_b128 v7, v[172:175] offset:3072
    v_mfma_f32_32x32x16_bf16 v[192:207], a[136:139], v[64:67], v[192:207]
    v_mfma_f32_32x32x16_bf16 v[192:207], a[152:155], v[68:71], v[192:207]
    s_nop 8
    ds_write_b128 v7, v[176:179] offset:4096
    v_mfma_f32_32x32x16_bf16 v[192:207], a[168:171], v[72:75], v[192:207]
    buffer_load_dwordx4 v[144:147], v1, s[28:31], s51 offen offset:0 sc1
    v_mfma_f32_32x32x16_bf16 v[192:207], a[184:187], v[76:79], v[192:207]
    ds_write_b128 v7, v[180:183] offset:5120
    v_mfma_f32_32x32x16_bf16 v[192:207], a[200:203], v[80:83], v[192:207]
    buffer_load_dwordx4 v[148:151], v1, s[28:31], s51 offen offset:1024 sc1
    v_mfma_f32_32x32x16_bf16 v[192:207], a[216:219], v[84:87], v[192:207]
    ds_write_b128 v7, v[184:187] offset:6144
    v_mfma_f32_32x32x16_bf16 v[192:207], a[232:235], v[88:91], v[192:207]
    buffer_load_dwordx4 v[152:155], v1, s[28:31], s51 offen offset:2048 sc1
    v_mfma_f32_32x32x16_bf16 v[192:207], a[248:251], v[92:95], v[192:207]
    ds_write_b128 v7, v[188:191] offset:7168
    v_mfma_f32_32x32x16_bf16 v[208:223], a[140:143], v[64:67], v[208:223]
    v_mfma_f32_32x32x16_bf16 v[208:223], a[156:159], v[68:71], v[208:223]
    s_nop 8
    ds_write_b128 v7, v[192:195] offset:8192
    v_mfma_f32_32x32x16_bf16 v[208:223], a[172:175], v[72:75], v[208:223]
    buffer_load_dwordx4 v[156:159], v1, s[28:31], s51 offen offset:3072 sc1
    v_mfma_f32_32x32x16_bf16 v[208:223], a[188:191], v[76:79], v[208:223]
    ds_write_b128 v7, v[196:199] offset:9216
    v_mfma_f32_32x32x16_bf16 v[208:223], a[204:207], v[80:83], v[208:223]
    buffer_load_dword v3, v2, s[36:39], s56 offen sc1
    v_mfma_f32_32x32x16_bf16 v[208:223], a[220:223], v[84:87], v[208:223]
    ds_write_b128 v7, v[200:203] offset:10240
    v_mfma_f32_32x32x16_bf16 v[208:223], a[236:239], v[88:91], v[208:223]
    ds_write_b128 v7, v[204:207] offset:11264
    v_mfma_f32_32x32x16_bf16 v[208:223], a[252:255], v[92:95], v[208:223]
    s_branch mega_kernel_G0_red
mega_kernel_G0_p2n:
    v_mfma_f32_32x32x16_bf16 v[160:175], a[128:131], v[64:67], v[160:175]
    v_mfma_f32_32x32x16_bf16 v[160:175], a[144:147], v[68:71], v[160:175]
    v_mfma_f32_32x32x16_bf16 v[160:175], a[160:163], v[72:75], v[160:175]
    v_mfma_f32_32x32x16_bf16 v[160:175], a[176:179], v[76:79], v[160:175]
    v_mfma_f32_32x32x16_bf16 v[160:175], a[192:195], v[80:83], v[160:175]
    v_mfma_f32_32x32x16_bf16 v[160:175], a[208:211], v[84:87], v[160:175]
    v_mfma_f32_32x32x16_bf16 v[160:175], a[224:227], v[88:91], v[160:175]
    v_mfma_f32_32x32x16_bf16 v[160:175], a[240:243], v[92:95], v[160:175]
    s_add_u32 s56, s52, 8192
    buffer_load_dword v3, v2, s[36:39], s56 offen sc1
    v_mfma_f32_32x32x16_bf16 v[176:191], a[132:135], v[64:67], v[176:191]
    v_mfma_f32_32x32x16_bf16 v[176:191], a[148:151], v[68:71], v[176:191]
    s_nop 7
    ds_write_b128 v7, v[160:163] offset:0
    v_mfma_f32_32x32x16_bf16 v[176:191], a[164:167], v[72:75], v[176:191]
    ds_write_b128 v7, v[164:167] offset:1024
    v_mfma_f32_32x32x16_bf16 v[176:191], a[180:183], v[76:79], v[176:191]
    v_mfma_f32_32x32x16_bf16 v[176:191], a[196:199], v[80:83], v[176:191]
    ds_write_b128 v7, v[168:171] offset:2048
    v_mfma_f32_32x32x16_bf16 v[176:191], a[212:215], v[84:87], v[176:191]
    v_mfma_f32_32x32x16_bf16 v[176:191], a[228:231], v[88:91], v[176:191]
    ds_write_b128 v7, v[172:175] offset:3072
    v_mfma_f32_32x32x16_bf16 v[176:191], a[244:247], v[92:95], v[176:191]
    v_mfma_f32_32x32x16_bf16 v[192:207], a[136:139], v[64:67], v[192:207]
    v_mfma_f32_32x32x16_bf16 v[192:207], a[152:155], v[68:71], v[192:207]
    s_nop 9
    ds_write_b128 v7, v[176:179] offset:4096
    v_mfma_f32_32x32x16_bf16 v[192:207], a[168:171], v[72:75], v[192:207]
    ds_write_b128 v7, v[180:183] offset:5120
    v_mfma_f32_32x32x16_bf16 v[192:207], a[184:187], v[76:79], v[192:207]
    v_mfma_f32_32x32x16_bf16 v[192:207], a[200:203], v[80:83], v[192:207]
    ds_write_b128 v7, v[184:187] offset:6144
    v_mfma_f32_32x32x16_bf16 v[192:207], a[216:219], v[84:87], v[192:207]
    v_mfma_f32_32x32x16_bf16 v[192:207], a[232:235], v[88:91], v[192:207]
    ds_write_b128 v7, v[188:191] offset:7168
    v_mfma_f32_32x32x16_bf16 v[192:207], a[248:251], v[92:95], v[192:207]
    v_mfma_f32_32x32x16_bf16 v[208:223], a[140:143], v[64:67], v[208:223]
    v_mfma_f32_32x32x16_bf16 v[208:223], a[156:159], v[68:71], v[208:223]
    s_nop 9
    ds_write_b128 v7, v[192:195] offset:8192
    v_mfma_f32_32x32x16_bf16 v[208:223], a[172:175], v[72:75], v[208:223]
    ds_write_b128 v7, v[196:199] offset:9216
    v_mfma_f32_32x32x16_bf16 v[208:223], a[188:191], v[76:79], v[208:223]
    v_mfma_f32_32x32x16_bf16 v[208:223], a[204:207], v[80:83], v[208:223]
    ds_write_b128 v7, v[200:203] offset:10240
    v_mfma_f32_32x32x16_bf16 v[208:223], a[220:223], v[84:87], v[208:223]
    v_mfma_f32_32x32x16_bf16 v[208:223], a[236:239], v[88:91], v[208:223]
    ds_write_b128 v7, v[204:207] offset:11264
    v_mfma_f32_32x32x16_bf16 v[208:223], a[252:255], v[92:95], v[208:223]
    s_waitcnt lgkmcnt(0)
    s_barrier
    s_cmp_eq_u32 s44, 63
    s_cbranch_scc1 mega_kernel_G0_red2
    s_waitcnt vmcnt(0)
    v_cmp_eq_u32 vcc, 0, v3
    s_cbranch_vccnz mega_kernel_G0_red2
    s_mov_b32 s55, 1
    s_add_u32 s48, s69, 65536
    s_add_u32 s49, s69, 69632
    s_add_u32 s50, s69, 73728
    s_add_u32 s51, s69, 77824
    s_lshl_b32 s57, s44, 12
    s_add_u32 s57, s57, 4096
    s_add_u32 s56, s52, 16384
    ds_read_b128 v[160:163], v8 offset:0
    ds_read_b128 v[164:167], v8 offset:1024
    ds_read_b128 v[168:171], v8 offset:2048
    ds_read_b128 v[172:175], v8 offset:3072
    ds_read_b128 v[176:179], v9 offset:0
    ds_read_b128 v[180:183], v9 offset:1024
    ds_read_b128 v[184:187], v9 offset:2048
    ds_read_b128 v[188:191], v9 offset:3072
    ds_read_b128 v[192:195], v10 offset:0
    ds_read_b128 v[196:199], v10 offset:1024
    ds_read_b128 v[200:203], v10 offset:2048
    ds_read_b128 v[204:207], v10 offset:3072
    buffer_load_dwordx4 v[224:227], v11, s[40:43], s57 offen offset:0 sc1
    buffer_load_dwordx4 v[228:231], v11, s[40:43], s57 offen offset:16 sc1
    buffer_load_dwordx4 v[232:235], v11, s[40:43], s57 offen offset:32 sc1
    buffer_load_dwordx4 v[236:239], v11, s[40:43], s57 offen offset:48 sc1
    buffer_load_dwordx4 v[96:99], v1, s[28:31], s48 offen offset:0 sc1
    buffer_load_dwordx4 v[100:103], v1, s[28:31], s48 offen offset:1024 sc1
    buffer_load_dwordx4 v[104:107], v1, s[28:31], s48 offen offset:2048 sc1
    buffer_load_dwordx4 v[108:111], v1, s[28:31], s48 offen offset:3072 sc1
    s_waitcnt lgkmcnt(8)
    buffer_load_dwordx4 v[112:115], v1, s[28:31], s49 offen offset:0 sc1
    v_add_f32 v32, v208, v160
    v_add_f32 v33, v209, v161
    v_add_f32 v34, v210, v162
    v_add_f32 v35, v211, v163
    v_add_f32 v36, v212, v164
    v_add_f32 v37, v213, v165
    v_add_f32 v38, v214, v166
    v_add_f32 v39, v215, v167
    v_add_f32 v40, v216, v168
    buffer_load_dwordx4 v[116:119], v1, s[28:31], s49 offen offset:1024 sc1
    v_add_f32 v41, v217, v169
    v_add_f32 v42, v218, v170
    v_add_f32 v43, v219, v171
    v_add_f32 v44, v220, v172
    v_add_f32 v45, v221, v173
    v_add_f32 v46, v222, v174
    v_add_f32 v47, v223, v175
    s_waitcnt lgkmcnt(0)
    v_add_f32 v176, v176, v192
    buffer_load_dwordx4 v[120:123], v1, s[28:31], s49 offen offset:2048 sc1
    v_add_f32 v177, v177, v193
    v_add_f32 v178, v178, v194
    v_add_f32 v179, v179, v195
    v_add_f32 v180, v180, v196
    v_add_f32 v181, v181, v197
    v_add_f32 v182, v182, v198
    v_add_f32 v183, v183, v199
    v_add_f32 v184, v184, v200
    v_add_f32 v185, v185, v201
    buffer_load_dwordx4 v[124:127], v1, s[28:31], s49 offen offset:3072 sc1
    v_add_f32 v186, v186, v202
    v_add_f32 v187, v187, v203
    v_add_f32 v188, v188, v204
    v_add_f32 v189, v189, v205
    v_add_f32 v190, v190, v206
    v_add_f32 v191, v191, v207
    v_add_f32 v32, v32, v176
    v_add_f32 v33, v33, v177
    v_add_f32 v34, v34, v178
    buffer_load_dwordx4 v[128:131], v1, s[28:31], s50 offen offset:0 sc1
    v_add_f32 v35, v35, v179
    v_add_f32 v36, v36, v180
    v_add_f32 v37, v37, v181
    v_add_f32 v38, v38, v182
    v_add_f32 v39, v39, v183
    v_add_f32 v40, v40, v184
    v_add_f32 v41, v41, v185
    v_add_f32 v42, v42, v186
    v_add_f32 v43, v43, v187
    buffer_load_dwordx4 v[132:135], v1, s[28:31], s50 offen offset:1024 sc1
    v_add_f32 v44, v44, v188
    v_add_f32 v45, v45, v189
    v_add_f32 v46, v46, v190
    v_add_f32 v47, v47, v191
    v_xor_b32 v7, 0x10000, v7
    v_xor_b32 v8, 0x10000, v8
    v_xor_b32 v9, 0x10000, v9
    v_xor_b32 v10, 0x10000, v10
    v_mul_f32 v15, 0xbfb8aa3b, v13
    buffer_load_dwordx4 v[136:139], v1, s[28:31], s50 offen offset:2048 sc1
    v_fma_f32 v32, -v12, v16, v32
    v_fma_f32 v33, -v12, v17, v33
    v_fma_f32 v34, -v12, v18, v34
    v_fma_f32 v35, -v12, v19, v35
    v_fma_f32 v36, -v12, v20, v36
    v_fma_f32 v37, -v12, v21, v37
    v_fma_f32 v38, -v12, v22, v38
    v_fma_f32 v39, -v12, v23, v39
    v_fma_f32 v40, -v12, v24, v40
    buffer_load_dwordx4 v[140:143], v1, s[28:31], s50 offen offset:3072 sc1
    v_fma_f32 v41, -v12, v25, v41
    v_fma_f32 v42, -v12, v26, v42
    v_fma_f32 v43, -v12, v27, v43
    v_fma_f32 v44, -v12, v28, v44
    v_fma_f32 v45, -v12, v29, v45
    v_fma_f32 v46, -v12, v30, v46
    v_fma_f32 v47, -v12, v31, v47
    v_mul_f32 v32, v32, v15
    v_mul_f32 v33, v33, v15
    v_mul_f32 v34, v34, v15
    buffer_load_dwordx4 v[144:147], v1, s[28:31], s51 offen offset:0 sc1
    v_mul_f32 v35, v35, v15
    v_mul_f32 v36, v36, v15
    v_mul_f32 v37, v37, v15
    v_mul_f32 v38, v38, v15
    v_mul_f32 v39, v39, v15
    v_exp_f32 v32, v32
    v_exp_f32 v33, v33
    v_exp_f32 v34, v34
    v_exp_f32 v35, v35
    v_exp_f32 v36, v36
    buffer_load_dwordx4 v[148:151], v1, s[28:31], s51 offen offset:1024 sc1
    v_exp_f32 v37, v37
    v_exp_f32 v38, v38
    v_exp_f32 v39, v39
    v_mul_f32 v40, v40, v13
    v_mul_f32 v41, v41, v13
    v_mul_f32 v42, v42, v13
    v_mul_f32 v43, v43, v13
    v_mul_f32 v44, v44, v13
    v_mul_f32 v45, v45, v13
    v_mul_f32 v46, v46, v13
    buffer_load_dwordx4 v[152:155], v1, s[28:31], s51 offen offset:2048 sc1
    v_mul_f32 v47, v47, v13
    v_add_f32 v32, 1.0, v32
    v_add_f32 v33, 1.0, v33
    v_add_f32 v34, 1.0, v34
    v_add_f32 v35, 1.0, v35
    v_add_f32 v36, 1.0, v36
    v_add_f32 v37, 1.0, v37
    v_add_f32 v38, 1.0, v38
    v_add_f32 v39, 1.0, v39
    v_rcp_f32 v32, v32
    buffer_load_dwordx4 v[156:159], v1, s[28:31], s51 offen offset:3072 sc1
    v_rcp_f32 v33, v33
    v_rcp_f32 v34, v34
    v_rcp_f32 v35, v35
    v_rcp_f32 v36, v36
    v_rcp_f32 v37, v37
    v_rcp_f32 v38, v38
    v_rcp_f32 v39, v39
    v_mul_f32 v32, v32, v40
    v_mul_f32 v33, v33, v41
    v_mul_f32 v34, v34, v42
    buffer_load_dword v3, v2, s[36:39], s56 offen sc1
    v_mul_f32 v35, v35, v43
    v_mul_f32 v36, v36, v44
    v_mul_f32 v37, v37, v45
    v_mul_f32 v38, v38, v46
    v_mul_f32 v39, v39, v47
    v_cvt_pk_bf16_f32 v48, v32, v33
    v_cvt_pk_bf16_f32 v49, v34, v35
    v_cvt_pk_bf16_f32 v50, v36, v37
    v_cvt_pk_bf16_f32 v51, v38, v39
    buffer_store_dwordx4 v[48:51], v1, s[32:35], s53 offen sc1
    s_branch mega_kernel_G0_post
mega_kernel_G0_red:
    s_waitcnt lgkmcnt(0)
    s_barrier
mega_kernel_G0_red2:
    ds_read_b128 v[160:163], v8 offset:0
    ds_read_b128 v[164:167], v8 offset:1024
    ds_read_b128 v[168:171], v8 offset:2048
    ds_read_b128 v[172:175], v8 offset:3072
    ds_read_b128 v[176:179], v9 offset:0
    ds_read_b128 v[180:183], v9 offset:1024
    ds_read_b128 v[184:187], v9 offset:2048
    ds_read_b128 v[188:191], v9 offset:3072
    ds_read_b128 v[192:195], v10 offset:0
    ds_read_b128 v[196:199], v10 offset:1024
    ds_read_b128 v[200:203], v10 offset:2048
    ds_read_b128 v[204:207], v10 offset:3072
    s_waitcnt lgkmcnt(8)
    v_add_f32 v32, v208, v160
    v_add_f32 v33, v209, v161
    v_add_f32 v34, v210, v162
    v_add_f32 v35, v211, v163
    v_add_f32 v36, v212, v164
    v_add_f32 v37, v213, v165
    v_add_f32 v38, v214, v166
    v_add_f32 v39, v215, v167
    v_add_f32 v40, v216, v168
    v_add_f32 v41, v217, v169
    v_add_f32 v42, v218, v170
    v_add_f32 v43, v219, v171
    v_add_f32 v44, v220, v172
    v_add_f32 v45, v221, v173
    v_add_f32 v46, v222, v174
    v_add_f32 v47, v223, v175
    s_waitcnt lgkmcnt(0)
    v_add_f32 v176, v176, v192
    v_add_f32 v177, v177, v193
    v_add_f32 v178, v178, v194
    v_add_f32 v179, v179, v195
    v_add_f32 v180, v180, v196
    v_add_f32 v181, v181, v197
    v_add_f32 v182, v182, v198
    v_add_f32 v183, v183, v199
    v_add_f32 v184, v184, v200
    v_add_f32 v185, v185, v201
    v_add_f32 v186, v186, v202
    v_add_f32 v187, v187, v203
    v_add_f32 v188, v188, v204
    v_add_f32 v189, v189, v205
    v_add_f32 v190, v190, v206
    v_add_f32 v191, v191, v207
    v_add_f32 v32, v32, v176
    v_add_f32 v33, v33, v177
    v_add_f32 v34, v34, v178
    v_add_f32 v35, v35, v179
    v_add_f32 v36, v36, v180
    v_add_f32 v37, v37, v181
    v_add_f32 v38, v38, v182
    v_add_f32 v39, v39, v183
    v_add_f32 v40, v40, v184
    v_add_f32 v41, v41, v185
    v_add_f32 v42, v42, v186
    v_add_f32 v43, v43, v187
    v_add_f32 v44, v44, v188
    v_add_f32 v45, v45, v189
    v_add_f32 v46, v46, v190
    v_add_f32 v47, v47, v191
    v_xor_b32 v7, 0x10000, v7
    v_xor_b32 v8, 0x10000, v8
    v_xor_b32 v9, 0x10000, v9
    v_xor_b32 v10, 0x10000, v10
    v_mul_f32 v15, 0xbfb8aa3b, v13
    v_fma_f32 v32, -v12, v16, v32
    v_fma_f32 v33, -v12, v17, v33
    v_fma_f32 v34, -v12, v18, v34
    v_fma_f32 v35, -v12, v19, v35
    v_fma_f32 v36, -v12, v20, v36
    v_fma_f32 v37, -v12, v21, v37
    v_fma_f32 v38, -v12, v22, v38
    v_fma_f32 v39, -v12, v23, v39
    v_fma_f32 v40, -v12, v24, v40
    v_fma_f32 v41, -v12, v25, v41
    v_fma_f32 v42, -v12, v26, v42
    v_fma_f32 v43, -v12, v27, v43
    v_fma_f32 v44, -v12, v28, v44
    v_fma_f32 v45, -v12, v29, v45
    v_fma_f32 v46, -v12, v30, v46
    v_fma_f32 v47, -v12, v31, v47
    v_mul_f32 v32, v32, v15
    v_mul_f32 v33, v33, v15
    v_mul_f32 v34, v34, v15
    v_mul_f32 v35, v35, v15
    v_mul_f32 v36, v36, v15
    v_mul_f32 v37, v37, v15
    v_mul_f32 v38, v38, v15
    v_mul_f32 v39, v39, v15
    v_exp_f32 v32, v32
    v_exp_f32 v33, v33
    v_exp_f32 v34, v34
    v_exp_f32 v35, v35
    v_exp_f32 v36, v36
    v_exp_f32 v37, v37
    v_exp_f32 v38, v38
    v_exp_f32 v39, v39
    v_mul_f32 v40, v40, v13
    v_mul_f32 v41, v41, v13
    v_mul_f32 v42, v42, v13
    v_mul_f32 v43, v43, v13
    v_mul_f32 v44, v44, v13
    v_mul_f32 v45, v45, v13
    v_mul_f32 v46, v46, v13
    v_mul_f32 v47, v47, v13
    v_add_f32 v32, 1.0, v32
    v_add_f32 v33, 1.0, v33
    v_add_f32 v34, 1.0, v34
    v_add_f32 v35, 1.0, v35
    v_add_f32 v36, 1.0, v36
    v_add_f32 v37, 1.0, v37
    v_add_f32 v38, 1.0, v38
    v_add_f32 v39, 1.0, v39
    v_rcp_f32 v32, v32
    v_rcp_f32 v33, v33
    v_rcp_f32 v34, v34
    v_rcp_f32 v35, v35
    v_rcp_f32 v36, v36
    v_rcp_f32 v37, v37
    v_rcp_f32 v38, v38
    v_rcp_f32 v39, v39
    v_mul_f32 v32, v32, v40
    v_mul_f32 v33, v33, v41
    v_mul_f32 v34, v34, v42
    v_mul_f32 v35, v35, v43
    v_mul_f32 v36, v36, v44
    v_mul_f32 v37, v37, v45
    v_mul_f32 v38, v38, v46
    v_mul_f32 v39, v39, v47
    v_cvt_pk_bf16_f32 v48, v32, v33
    v_cvt_pk_bf16_f32 v49, v34, v35
    v_cvt_pk_bf16_f32 v50, v36, v37
    v_cvt_pk_bf16_f32 v51, v38, v39
    buffer_store_dwordx4 v[48:51], v1, s[32:35], s53 offen sc1
mega_kernel_G0_post:
    s_cmp_eq_u32 s44, 63
    s_cbranch_scc1 mega_kernel_G0_last
    s_cmp_lg_u32 s55, 0
    s_cbranch_scc0 mega_kernel_G0_np
    s_mov_b32 s47, s54
    s_add_u32 s44, s44, 1
    s_branch mega_kernel_G1_deep
mega_kernel_G0_np:
    s_add_u32 s56, s52, 8192
    buffer_load_dword v3, v2, s[36:39], s56 offen sc1
    s_waitcnt vmcnt(0)
    s_mov_b64 exec, 1
    buffer_store_byte v14, off, s[36:39], s54 sc1
    s_mov_b64 exec, -1
    v_cmp_eq_u32 vcc, 0, v3
    s_cbranch_vccz mega_kernel_G0_p_ok
mega_kernel_G0_p:
    buffer_load_dword v3, v2, s[36:39], s56 offen sc1
    s_waitcnt vmcnt(0)
    v_cmp_eq_u32 vcc, 0, v3
    s_cbranch_vccz mega_kernel_G0_p_ok
    s_cmp_eq_u32 s45, 0
    s_cbranch_scc1 mega_kernel_G0_p_ok
    s_sub_u32 s45, s45, 1
    s_sleep 1
    s_branch mega_kernel_G0_p
mega_kernel_G0_p_ok:
    s_add_u32 s44, s44, 1
    s_lshl_b32 s56, s44, 13
    s_add_u32 s52, s56, s66
    s_add_u32 s54, s56, s67
    s_mul_i32 s53, s44, 229376
    s_add_u32 s53, s53, s68
    s_mul_i32 s69, s44, 65536
    s_add_u32 s69, s69, s46
    s_branch mega_kernel_G1_cold
mega_kernel_G0_last:
    s_waitcnt vmcnt(0)
    s_mov_b64 exec, 1
    buffer_store_byte v14, off, s[36:39], s54 sc1
    s_mov_b64 exec, -1
    s_branch mega_kernel_G_fin
mega_kernel_G1_deep:
    s_lshl_b32 s56, s44, 13
    s_add_u32 s52, s56, s66
    s_add_u32 s54, s56, s67
    s_mul_i32 s53, s44, 229376
    s_add_u32 s53, s53, s68
    s_mul_i32 s69, s44, 65536
    s_add_u32 s69, s69, s46
    s_waitcnt vmcnt(1)
    s_cmp_eq_u32 s44, 63
    s_cbranch_scc1 mega_kernel_G1_pre2
    v_cmp_eq_u32 vcc, 0, v3
    s_cbranch_vccnz mega_kernel_G1_pre2
    s_add_u32 s48, s69, 65536
    s_add_u32 s49, s69, 69632
    s_add_u32 s50, s69, 73728
    s_add_u32 s51, s69, 77824
    v_mfma_f32_32x32x16_bf16 v[160:175], a[0:3], v[96:99], 0
    buffer_load_dwordx4 v[32:35], v1, s[28:31], s48 offen offset:0 sc1
    v_add_f32 v224, v224, v226
    v_mfma_f32_32x32x16_bf16 v[176:191], a[4:7], v[96:99], 0
    buffer_load_dwordx4 v[36:39], v1, s[28:31], s48 offen offset:1024 sc1
    v_mfma_f32_32x32x16_bf16 v[192:207], a[8:11], v[96:99], 0
    v_add_f32 v225, v225, v227
    v_mfma_f32_32x32x16_bf16 v[208:223], a[12:15], v[96:99], 0
    buffer_load_dwordx4 v[40:43], v1, s[28:31], s48 offen offset:2048 sc1
    v_mfma_f32_32x32x16_bf16 v[160:175], a[16:19], v[100:103], v[160:175]
    v_add_f32 v224, v224, v228
    v_mfma_f32_32x32x16_bf16 v[176:191], a[20:23], v[100:103], v[176:191]
    buffer_load_dwordx4 v[44:47], v1, s[28:31], s48 offen offset:3072 sc1
    v_mfma_f32_32x32x16_bf16 v[192:207], a[24:27], v[100:103], v[192:207]
    v_add_f32 v225, v225, v229
    v_mfma_f32_32x32x16_bf16 v[208:223], a[28:31], v[100:103], v[208:223]
    buffer_load_dwordx4 v[48:51], v1, s[28:31], s49 offen offset:0 sc1
    v_mfma_f32_32x32x16_bf16 v[160:175], a[32:35], v[104:107], v[160:175]
    v_add_f32 v224, v224, v230
    buffer_load_dwordx4 v[52:55], v1, s[28:31], s49 offen offset:1024 sc1
    v_mfma_f32_32x32x16_bf16 v[176:191], a[36:39], v[104:107], v[176:191]
    v_add_f32 v225, v225, v231
    v_mfma_f32_32x32x16_bf16 v[192:207], a[40:43], v[104:107], v[192:207]
    buffer_load_dwordx4 v[56:59], v1, s[28:31], s49 offen offset:2048 sc1
    v_mfma_f32_32x32x16_bf16 v[208:223], a[44:47], v[104:107], v[208:223]
    v_add_f32 v224, v224, v232
    v_mfma_f32_32x32x16_bf16 v[160:175], a[48:51], v[108:111], v[160:175]
    buffer_load_dwordx4 v[60:63], v1, s[28:31], s49 offen offset:3072 sc1
    v_mfma_f32_32x32x16_bf16 v[176:191], a[52:55], v[108:111], v[176:191]
    v_add_f32 v225, v225, v233
    v_mfma_f32_32x32x16_bf16 v[192:207], a[56:59], v[108:111], v[192:207]
    buffer_load_dwordx4 v[64:67], v1, s[28:31], s50 offen offset:0 sc1
    v_mfma_f32_32x32x16_bf16 v[208:223], a[60:63], v[108:111], v[208:223]
    v_add_f32 v224, v224, v234
    v_mfma_f32_32x32x16_bf16 v[160:175], a[64:67], v[112:115], v[160:175]
    buffer_load_dwordx4 v[68:71], v1, s[28:31], s50 offen offset:1024 sc1
    v_add_f32 v225, v225, v235
    v_mfma_f32_32x32x16_bf16 v[176:191], a[68:71], v[112:115], v[176:191]
    v_add_f32 v224, v224, v236
    v_mfma_f32_32x32x16_bf16 v[192:207], a[72:75], v[112:115], v[192:207]
    v_add_f32 v225, v225, v237
    v_mfma_f32_32x32x16_bf16 v[208:223], a[76:79], v[112:115], v[208:223]
    v_add_f32 v224, v224, v238
    v_mfma_f32_32x32x16_bf16 v[160:175], a[80:83], v[116:119], v[160:175]
    v_add_f32 v225, v225, v239
    v_mfma_f32_32x32x16_bf16 v[176:191], a[84:87], v[116:119], v[176:191]
    v_mov_b32 v226, v224
    v_mfma_f32_32x32x16_bf16 v[192:207], a[88:91], v[116:119], v[192:207]
    v_mov_b32 v227, v225
    v_mfma_f32_32x32x16_bf16 v[208:223], a[92:95], v[116:119], v[208:223]
    v_permlane32_swap_b32 v226, v224
    v_mfma_f32_32x32x16_bf16 v[160:175], a[96:99], v[120:123], v[160:175]
    v_permlane32_swap_b32 v227, v225
    v_add_f32 v224, v224, v226
    v_mfma_f32_32x32x16_bf16 v[176:191], a[100:103], v[120:123], v[176:191]
    v_add_f32 v225, v225, v227
    v_mfma_f32_32x32x16_bf16 v[192:207], a[104:107], v[120:123], v[192:207]
    v_mul_f32 v12, 0x3a800000, v224
    v_mfma_f32_32x32x16_bf16 v[208:223], a[108:111], v[120:123], v[208:223]
    v_mul_f32 v225, 0x3a800000, v225
    v_mfma_f32_32x32x16_bf16 v[160:175], a[112:115], v[124:127], v[160:175]
    v_fma_f32 v225, -v12, v12, v225
    v_mfma_f32_32x32x16_bf16 v[176:191], a[116:119], v[124:127], v[176:191]
    v_max_f32 v225, 0, v225
    v_mfma_f32_32x32x16_bf16 v[192:207], a[120:123], v[124:127], v[192:207]
    v_add_f32 v225, 0x3727c5ac, v225
    v_mfma_f32_32x32x16_bf16 v[208:223], a[124:127], v[124:127], v[208:223]
    v_rsq_f32 v13, v225
    s_waitcnt vmcnt(10)
    s_mov_b64 exec, 1
    buffer_store_byte v14, off, s[36:39], s47 sc1
    s_mov_b64 exec, -1
    s_mov_b32 s55, 1
    s_nop 1
    s_branch mega_kernel_G1_p2d
mega_kernel_G1_pre:
    s_lshl_b32 s56, s44, 13
    s_add_u32 s52, s56, s66
    s_add_u32 s54, s56, s67
    s_mul_i32 s53, s44, 229376
    s_add_u32 s53, s53, s68
    s_mul_i32 s69, s44, 65536
    s_add_u32 s69, s69, s46
mega_kernel_G1_pre2:
    s_add_u32 s56, s52, 8192
    buffer_load_dword v3, v2, s[36:39], s56 offen sc1
    s_waitcnt vmcnt(2)
    v_mfma_f32_32x32x16_bf16 v[160:175], a[0:3], v[96:99], 0
    v_add_f32 v224, v224, v226
    v_mfma_f32_32x32x16_bf16 v[176:191], a[4:7], v[96:99], 0
    v_add_f32 v225, v225, v227
    v_mfma_f32_32x32x16_bf16 v[192:207], a[8:11], v[96:99], 0
    v_add_f32 v224, v224, v228
    v_mfma_f32_32x32x16_bf16 v[208:223], a[12:15], v[96:99], 0
    v_add_f32 v225, v225, v229
    v_mfma_f32_32x32x16_bf16 v[160:175], a[16:19], v[100:103], v[160:175]
    v_add_f32 v224, v224, v230
    v_mfma_f32_32x32x16_bf16 v[176:191], a[20:23], v[100:103], v[176:191]
    v_mfma_f32_32x32x16_bf16 v[192:207], a[24:27], v[100:103], v[192:207]
    v_add_f32 v225, v225, v231
    v_mfma_f32_32x32x16_bf16 v[208:223], a[28:31], v[100:103], v[208:223]
    v_add_f32 v224, v224, v232
    v_mfma_f32_32x32x16_bf16 v[160:175], a[32:35], v[104:107], v[160:175]
    v_add_f32 v225, v225, v233
    v_mfma_f32_32x32x16_bf16 v[176:191], a[36:39], v[104:107], v[176:191]
    v_add_f32 v224, v224, v234
    v_mfma_f32_32x32x16_bf16 v[192:207], a[40:43], v[104:107], v[192:207]
    v_mfma_f32_32x32x16_bf16 v[208:223], a[44:47], v[104:107], v[208:223]
    v_add_f32 v225, v225, v235
    v_mfma_f32_32x32x16_bf16 v[160:175], a[48:51], v[108:111], v[160:175]
    v_add_f32 v224, v224, v236
    v_mfma_f32_32x32x16_bf16 v[176:191], a[52:55], v[108:111], v[176:191]
    v_add_f32 v225, v225, v237
    v_mfma_f32_32x32x16_bf16 v[192:207], a[56:59], v[108:111], v[192:207]
    v_add_f32 v224, v224, v238
    v_mfma_f32_32x32x16_bf16 v[208:223], a[60:63], v[108:111], v[208:223]
    v_mfma_f32_32x32x16_bf16 v[160:175], a[64:67], v[112:115], v[160:175]
    v_add_f32 v225, v225, v239
    v_mfma_f32_32x32x16_bf16 v[176:191], a[68:71], v[112:115], v[176:191]
    v_mov_b32 v226, v224
    v_mfma_f32_32x32x16_bf16 v[192:207], a[72:75], v[112:115], v[192:207]
    v_mov_b32 v227, v225
    v_mfma_f32_32x32x16_bf16 v[208:223], a[76:79], v[112:115], v[208:223]
    v_permlane32_swap_b32 v226, v224
    v_mfma_f32_32x32x16_bf16 v[160:175], a[80:83], v[116:119], v[160:175]
    v_permlane32_swap_b32 v227, v225
    v_mfma_f32_32x32x16_bf16 v[176:191], a[84:87], v[116:119], v[176:191]
    v_mfma_f32_32x32x16_bf16 v[192:207], a[88:91], v[116:119], v[192:207]
    v_add_f32 v224, v224, v226
    v_mfma_f32_32x32x16_bf16 v[208:223], a[92:95], v[116:119], v[208:223]
    v_add_f32 v225, v225, v227
    v_mfma_f32_32x32x16_bf16 v[160:175], a[96:99], v[120:123], v[160:175]
    v_mul_f32 v12, 0x3a800000, v224
    v_mfma_f32_32x32x16_bf16 v[176:191], a[100:103], v[120:123], v[176:191]
    v_mul_f32 v225, 0x3a800000, v225
    v_mfma_f32_32x32x16_bf16 v[192:207], a[104:107], v[120:123], v[192:207]
    v_mfma_f32_32x32x16_bf16 v[208:223], a[108:111], v[120:123], v[208:223]
    v_fma_f32 v225, -v12, v12, v225
    v_mfma_f32_32x32x16_bf16 v[160:175], a[112:115], v[124:127], v[160:175]
    v_max_f32 v225, 0, v225
    v_mfma_f32_32x32x16_bf16 v[176:191], a[116:119], v[124:127], v[176:191]
    v_add_f32 v225, 0x3727c5ac, v225
    v_mfma_f32_32x32x16_bf16 v[192:207], a[120:123], v[124:127], v[192:207]
    v_rsq_f32 v13, v225
    v_mfma_f32_32x32x16_bf16 v[208:223], a[124:127], v[124:127], v[208:223]
    s_waitcnt vmcnt(0)
    s_mov_b64 exec, 1
    buffer_store_byte v14, off, s[36:39], s47 sc1
    s_mov_b64 exec, -1
    s_branch mega_kernel_G1_mid
mega_kernel_G1_cold:
    s_add_u32 s48, s69, 0
    s_add_u32 s49, s69, 4096
    s_add_u32 s50, s69, 8192
    s_add_u32 s51, s69, 12288
    s_lshl_b32 s57, s44, 12
    buffer_load_dwordx4 v[224:227], v11, s[40:43], s57 offen offset:0 sc1
    buffer_load_dwordx4 v[228:231], v11, s[40:43], s57 offen offset:16 sc1
    buffer_load_dwordx4 v[232:235], v11, s[40:43], s57 offen offset:32 sc1
    buffer_load_dwordx4 v[236:239], v11, s[40:43], s57 offen offset:48 sc1
    buffer_load_dwordx4 v[96:99], v1, s[28:31], s48 offen offset:0 sc1
    buffer_load_dwordx4 v[100:103], v1, s[28:31], s48 offen offset:1024 sc1
    buffer_load_dwordx4 v[104:107], v1, s[28:31], s48 offen offset:2048 sc1
    buffer_load_dwordx4 v[108:111], v1, s[28:31], s48 offen offset:3072 sc1
    buffer_load_dwordx4 v[112:115], v1, s[28:31], s49 offen offset:0 sc1
    buffer_load_dwordx4 v[116:119], v1, s[28:31], s49 offen offset:1024 sc1
    buffer_load_dwordx4 v[120:123], v1, s[28:31], s49 offen offset:2048 sc1
    buffer_load_dwordx4 v[124:127], v1, s[28:31], s49 offen offset:3072 sc1
    s_waitcnt vmcnt(7)
    v_mfma_f32_32x32x16_bf16 v[160:175], a[0:3], v[96:99], 0
    buffer_load_dwordx4 v[128:131], v1, s[28:31], s50 offen offset:0 sc1
    v_mfma_f32_32x32x16_bf16 v[176:191], a[4:7], v[96:99], 0
    v_mfma_f32_32x32x16_bf16 v[192:207], a[8:11], v[96:99], 0
    buffer_load_dwordx4 v[132:135], v1, s[28:31], s50 offen offset:1024 sc1
    v_mfma_f32_32x32x16_bf16 v[208:223], a[12:15], v[96:99], 0
    s_waitcnt vmcnt(8)
    v_mfma_f32_32x32x16_bf16 v[160:175], a[16:19], v[100:103], v[160:175]
    buffer_load_dwordx4 v[136:139], v1, s[28:31], s50 offen offset:2048 sc1
    v_mfma_f32_32x32x16_bf16 v[176:191], a[20:23], v[100:103], v[176:191]
    v_mfma_f32_32x32x16_bf16 v[192:207], a[24:27], v[100:103], v[192:207]
    buffer_load_dwordx4 v[140:143], v1, s[28:31], s50 offen offset:3072 sc1
    v_mfma_f32_32x32x16_bf16 v[208:223], a[28:31], v[100:103], v[208:223]
    s_waitcnt vmcnt(9)
    v_mfma_f32_32x32x16_bf16 v[160:175], a[32:35], v[104:107], v[160:175]
    buffer_load_dwordx4 v[144:147], v1, s[28:31], s51 offen offset:0 sc1
    v_mfma_f32_32x32x16_bf16 v[176:191], a[36:39], v[104:107], v[176:191]
    v_mfma_f32_32x32x16_bf16 v[192:207], a[40:43], v[104:107], v[192:207]
    buffer_load_dwordx4 v[148:151], v1, s[28:31], s51 offen offset:1024 sc1
    v_mfma_f32_32x32x16_bf16 v[208:223], a[44:47], v[104:107], v[208:223]
    s_waitcnt vmcnt(10)
    v_mfma_f32_32x32x16_bf16 v[160:175], a[48:51], v[108:111], v[160:175]
    buffer_load_dwordx4 v[152:155], v1, s[28:31], s51 offen offset:2048 sc1
    v_mfma_f32_32x32x16_bf16 v[176:191], a[52:55], v[108:111], v[176:191]
    v_mfma_f32_32x32x16_bf16 v[192:207], a[56:59], v[108:111], v[192:207]
    buffer_load_dwordx4 v[156:159], v1, s[28:31], s51 offen offset:3072 sc1
    s_add_u32 s56, s52, 8192
    buffer_load_dword v3, v2, s[36:39], s56 offen sc1
    v_mfma_f32_32x32x16_bf16 v[208:223], a[60:63], v[108:111], v[208:223]
    s_waitcnt vmcnt(12)
    v_mfma_f32_32x32x16_bf16 v[160:175], a[64:67], v[112:115], v[160:175]
    v_add_f32 v224, v224, v226
    v_add_f32 v225, v225, v227
    v_mfma_f32_32x32x16_bf16 v[176:191], a[68:71], v[112:115], v[176:191]
    v_add_f32 v224, v224, v228
    v_add_f32 v225, v225, v229
    v_mfma_f32_32x32x16_bf16 v[192:207], a[72:75], v[112:115], v[192:207]
    v_add_f32 v224, v224, v230
    v_add_f32 v225, v225, v231
    v_mfma_f32_32x32x16_bf16 v[208:223], a[76:79], v[112:115], v[208:223]
    v_add_f32 v224, v224, v232
    v_add_f32 v225, v225, v233
    s_waitcnt vmcnt(11)
    v_mfma_f32_32x32x16_bf16 v[160:175], a[80:83], v[116:119], v[160:175]
    v_add_f32 v224, v224, v234
    v_add_f32 v225, v225, v235
    v_mfma_f32_32x32x16_bf16 v[176:191], a[84:87], v[116:119], v[176:191]
    v_add_f32 v224, v224, v236
    v_add_f32 v225, v225, v237
    v_mfma_f32_32x32x16_bf16 v[192:207], a[88:91], v[116:119], v[192:207]
    v_add_f32 v224, v224, v238
    v_add_f32 v225, v225, v239
    v_mfma_f32_32x32x16_bf16 v[208:223], a[92:95], v[116:119], v[208:223]
    v_mov_b32 v226, v224
    v_mov_b32 v227, v225
    s_waitcnt vmcnt(10)
    v_mfma_f32_32x32x16_bf16 v[160:175], a[96:99], v[120:123], v[160:175]
    v_permlane32_swap_b32 v226, v224
    v_permlane32_swap_b32 v227, v225
    v_mfma_f32_32x32x16_bf16 v[176:191], a[100:103], v[120:123], v[176:191]
    v_add_f32 v224, v224, v226
    v_add_f32 v225, v225, v227
    v_mfma_f32_32x32x16_bf16 v[192:207], a[104:107], v[120:123], v[192:207]
    v_mul_f32 v12, 0x3a800000, v224
    v_mul_f32 v225, 0x3a800000, v225
    v_mfma_f32_32x32x16_bf16 v[208:223], a[108:111], v[120:123], v[208:223]
    v_fma_f32 v225, -v12, v12, v225
    v_max_f32 v225, 0, v225
    s_waitcnt vmcnt(9)
    v_mfma_f32_32x32x16_bf16 v[160:175], a[112:115], v[124:127], v[160:175]
    v_add_f32 v225, 0x3727c5ac, v225
    v_rsq_f32 v13, v225
    v_mfma_f32_32x32x16_bf16 v[176:191], a[116:119], v[124:127], v[176:191]
    v_mfma_f32_32x32x16_bf16 v[192:207], a[120:123], v[124:127], v[192:207]
    v_mfma_f32_32x32x16_bf16 v[208:223], a[124:127], v[124:127], v[208:223]
    s_waitcnt vmcnt(0)
mega_kernel_G1_mid:
    s_mov_b32 s55, 0
    s_cmp_eq_u32 s44, 63
    s_cbranch_scc1 mega_kernel_G1_p2n
    v_cmp_eq_u32 vcc, 0, v3
    s_cbranch_vccnz mega_kernel_G1_p2n
    s_mov_b32 s55, 1
    s_add_u32 s48, s69, 65536
    s_add_u32 s49, s69, 69632
    s_add_u32 s50, s69, 73728
    s_add_u32 s51, s69, 77824
    s_lshl_b32 s57, s44, 12
    s_add_u32 s57, s57, 4096
    s_add_u32 s56, s52, 16384
    v_mfma_f32_32x32x16_bf16 v[160:175], a[128:131], v[128:131], v[160:175]
    v_mfma_f32_32x32x16_bf16 v[160:175], a[144:147], v[132:135], v[160:175]
    buffer_load_dwordx4 v[224:227], v11, s[40:43], s57 offen offset:0 sc1
    v_mfma_f32_32x32x16_bf16 v[160:175], a[160:163], v[136:139], v[160:175]
    v_mfma_f32_32x32x16_bf16 v[160:175], a[176:179], v[140:143], v[160:175]
    buffer_load_dwordx4 v[228:231], v11, s[40:43], s57 offen offset:16 sc1
    v_mfma_f32_32x32x16_bf16 v[160:175], a[192:195], v[144:147], v[160:175]
    v_mfma_f32_32x32x16_bf16 v[160:175], a[208:211], v[148:151], v[160:175]
    buffer_load_dwordx4 v[232:235], v11, s[40:43], s57 offen offset:32 sc1
    v_mfma_f32_32x32x16_bf16 v[160:175], a[224:227], v[152:155], v[160:175]
    v_mfma_f32_32x32x16_bf16 v[160:175], a[240:243], v[156:159], v[160:175]
    v_mfma_f32_32x32x16_bf16 v[176:191], a[132:135], v[128:131], v[176:191]
    v_mfma_f32_32x32x16_bf16 v[176:191], a[148:151], v[132:135], v[176:191]
    s_nop 9
    ds_write_b128 v7, v[160:163] offset:0
    v_mfma_f32_32x32x16_bf16 v[176:191], a[164:167], v[136:139], v[176:191]
    buffer_load_dwordx4 v[236:239], v11, s[40:43], s57 offen offset:48 sc1
    v_mfma_f32_32x32x16_bf16 v[176:191], a[180:183], v[140:143], v[176:191]
    ds_write_b128 v7, v[164:167] offset:1024
    v_mfma_f32_32x32x16_bf16 v[176:191], a[196:199], v[144:147], v[176:191]
    buffer_load_dwordx4 v[32:35], v1, s[28:31], s48 offen offset:0 sc1
    v_mfma_f32_32x32x16_bf16 v[176:191], a[212:215], v[148:151], v[176:191]
    ds_write_b128 v7, v[168:171] offset:2048
    v_mfma_f32_32x32x16_bf16 v[176:191], a[228:231], v[152:155], v[176:191]
    buffer_load_dwordx4 v[36:39], v1, s[28:31], s48 offen offset:1024 sc1
    v_mfma_f32_32x32x16_bf16 v[176:191], a[244:247], v[156:159], v[176:191]
    ds_write_b128 v7, v[172:175] offset:3072
    v_mfma_f32_32x32x16_bf16 v[192:207], a[136:139], v[128:131], v[192:207]
    v_mfma_f32_32x32x16_bf16 v[192:207], a[152:155], v[132:135], v[192:207]
    s_nop 8
    ds_write_b128 v7, v[176:179] offset:4096
    v_mfma_f32_32x32x16_bf16 v[192:207], a[168:171], v[136:139], v[192:207]
    buffer_load_dwordx4 v[40:43], v1, s[28:31], s48 offen offset:2048 sc1
    v_mfma_f32_32x32x16_bf16 v[192:207], a[184:187], v[140:143], v[192:207]
    ds_write_b128 v7, v[180:183] offset:5120
    v_mfma_f32_32x32x16_bf16 v[192:207], a[200:203], v[144:147], v[192:207]
    buffer_load_dwordx4 v[44:47], v1, s[28:31], s48 offen offset:3072 sc1
    v_mfma_f32_32x32x16_bf16 v[192:207], a[216:219], v[148:151], v[192:207]
    ds_write_b128 v7, v[184:187] offset:6144
    v_mfma_f32_32x32x16_bf16 v[192:207], a[232:235], v[152:155], v[192:207]
    buffer_load_dwordx4 v[48:51], v1, s[28:31], s49 offen offset:0 sc1
    v_mfma_f32_32x32x16_bf16 v[192:207], a[248:251], v[156:159], v[192:207]
    ds_write_b128 v7, v[188:191] offset:7168
    v_mfma_f32_32x32x16_bf16 v[208:223], a[140:143], v[128:131], v[208:223]
    v_mfma_f32_32x32x16_bf16 v[208:223], a[156:159], v[132:135], v[208:223]
    s_nop 8
    ds_write_b128 v7, v[192:195] offset:8192
    v_mfma_f32_32x32x16_bf16 v[208:223], a[172:175], v[136:139], v[208:223]
    buffer_load_dwordx4 v[52:55], v1, s[28:31], s49 offen offset:1024 sc1
    v_mfma_f32_32x32x16_bf16 v[208:223], a[188:191], v[140:143], v[208:223]
    ds_write_b128 v7, v[196:199] offset:9216
    v_mfma_f32_32x32x16_bf16 v[208:223], a[204:207], v[144:147], v[208:223]
    buffer_load_dwordx4 v[56:59], v1, s[28:31], s49 offen offset:2048 sc1
    v_mfma_f32_32x32x16_bf16 v[208:223], a[220:223], v[148:151], v[208:223]
    ds_write_b128 v7, v[200:203] offset:10240
    v_mfma_f32_32x32x16_bf16 v[208:223], a[236:239], v[152:155], v[208:223]
    ds_write_b128 v7, v[204:207] offset:11264
    v_mfma_f32_32x32x16_bf16 v[208:223], a[252:255], v[156:159], v[208:223]
    s_waitcnt lgkmcnt(0)
    s_barrier
    ds_read_b128 v[160:163], v8 offset:0
    ds_read_b128 v[164:167], v8 offset:1024
    ds_read_b128 v[168:171], v8 offset:2048
    ds_read_b128 v[172:175], v8 offset:3072
    ds_read_b128 v[176:179], v9 offset:0
    ds_read_b128 v[180:183], v9 offset:1024
    ds_read_b128 v[184:187], v9 offset:2048
    ds_read_b128 v[188:191], v9 offset:3072
    ds_read_b128 v[192:195], v10 offset:0
    ds_read_b128 v[196:199], v10 offset:1024
    ds_read_b128 v[200:203], v10 offset:2048
    ds_read_b128 v[204:207], v10 offset:3072
    buffer_load_dwordx4 v[60:63], v1, s[28:31], s49 offen offset:3072 sc1
    buffer_load_dwordx4 v[64:67], v1, s[28:31], s50 offen offset:0 sc1
    buffer_load_dwordx4 v[68:71], v1, s[28:31], s50 offen offset:1024 sc1
    buffer_load_dwordx4 v[72:75], v1, s[28:31], s50 offen offset:2048 sc1
    buffer_load_dwordx4 v[76:79], v1, s[28:31], s50 offen offset:3072 sc1
    s_waitcnt lgkmcnt(8)
    buffer_load_dwordx4 v[80:83], v1, s[28:31], s51 offen offset:0 sc1
    v_add_f32 v96, v208, v160
    v_add_f32 v97, v209, v161
    v_add_f32 v98, v210, v162
    v_add_f32 v99, v211, v163
    v_add_f32 v100, v212, v164
    v_add_f32 v101, v213, v165
    v_add_f32 v102, v214, v166
    v_add_f32 v103, v215, v167
    v_add_f32 v104, v216, v168
    v_add_f32 v105, v217, v169
    buffer_load_dwordx4 v[84:87], v1, s[28:31], s51 offen offset:1024 sc1
    v_add_f32 v106, v218, v170
    v_add_f32 v107, v219, v171
    v_add_f32 v108, v220, v172
    v_add_f32 v109, v221, v173
    v_add_f32 v110, v222, v174
    v_add_f32 v111, v223, v175
    s_waitcnt lgkmcnt(0)
    v_add_f32 v176, v176, v192
    v_add_f32 v177, v177, v193
    v_add_f32 v178, v178, v194
    v_add_f32 v179, v179, v195
    buffer_load_dwordx4 v[88:91], v1, s[28:31], s51 offen offset:2048 sc1
    v_add_f32 v180, v180, v196
    v_add_f32 v181, v181, v197
    v_add_f32 v182, v182, v198
    v_add_f32 v183, v183, v199
    v_add_f32 v184, v184, v200
    v_add_f32 v185, v185, v201
    v_add_f32 v186, v186, v202
    v_add_f32 v187, v187, v203
    v_add_f32 v188, v188, v204
    v_add_f32 v189, v189, v205
    v_add_f32 v190, v190, v206
    buffer_load_dwordx4 v[92:95], v1, s[28:31], s51 offen offset:3072 sc1
    v_add_f32 v191, v191, v207
    v_add_f32 v96, v96, v176
    v_add_f32 v97, v97, v177
    v_add_f32 v98, v98, v178
    v_add_f32 v99, v99, v179
    v_add_f32 v100, v100, v180
    v_add_f32 v101, v101, v181
    v_add_f32 v102, v102, v182
    v_add_f32 v103, v103, v183
    v_add_f32 v104, v104, v184
    v_add_f32 v105, v105, v185
    buffer_load_dword v3, v2, s[36:39], s56 offen sc1
    v_add_f32 v106, v106, v186
    v_add_f32 v107, v107, v187
    v_add_f32 v108, v108, v188
    v_add_f32 v109, v109, v189
    v_add_f32 v110, v110, v190
    v_add_f32 v111, v111, v191
    v_xor_b32 v7, 0x10000, v7
    v_xor_b32 v8, 0x10000, v8
    v_xor_b32 v9, 0x10000, v9
    v_xor_b32 v10, 0x10000, v10
    v_mul_f32 v15, 0xbfb8aa3b, v13
    v_fma_f32 v96, -v12, v16, v96
    v_fma_f32 v97, -v12, v17, v97
    v_fma_f32 v98, -v12, v18, v98
    v_fma_f32 v99, -v12, v19, v99
    v_fma_f32 v100, -v12, v20, v100
    v_fma_f32 v101, -v12, v21, v101
    v_fma_f32 v102, -v12, v22, v102
    v_fma_f32 v103, -v12, v23, v103
    v_fma_f32 v104, -v12, v24, v104
    v_fma_f32 v105, -v12, v25, v105
    v_fma_f32 v106, -v12, v26, v106
    v_fma_f32 v107, -v12, v27, v107
    v_fma_f32 v108, -v12, v28, v108
    v_fma_f32 v109, -v12, v29, v109
    v_fma_f32 v110, -v12, v30, v110
    v_fma_f32 v111, -v12, v31, v111
    v_mul_f32 v96, v96, v15
    v_mul_f32 v97, v97, v15
    v_mul_f32 v98, v98, v15
    v_mul_f32 v99, v99, v15
    v_mul_f32 v100, v100, v15
    v_mul_f32 v101, v101, v15
    v_mul_f32 v102, v102, v15
    v_mul_f32 v103, v103, v15
    v_exp_f32 v96, v96
    v_exp_f32 v97, v97
    v_exp_f32 v98, v98
    v_exp_f32 v99, v99
    v_exp_f32 v100, v100
    v_exp_f32 v101, v101
    v_exp_f32 v102, v102
    v_exp_f32 v103, v103
    v_mul_f32 v104, v104, v13
    v_mul_f32 v105, v105, v13
    v_mul_f32 v106, v106, v13
    v_mul_f32 v107, v107, v13
    v_mul_f32 v108, v108, v13
    v_mul_f32 v109, v109, v13
    v_mul_f32 v110, v110, v13
    v_mul_f32 v111, v111, v13
    v_add_f32 v96, 1.0, v96
    v_add_f32 v97, 1.0, v97
    v_add_f32 v98, 1.0, v98
    v_add_f32 v99, 1.0, v99
    v_add_f32 v100, 1.0, v100
    v_add_f32 v101, 1.0, v101
    v_add_f32 v102, 1.0, v102
    v_add_f32 v103, 1.0, v103
    v_rcp_f32 v96, v96
    v_rcp_f32 v97, v97
    v_rcp_f32 v98, v98
    v_rcp_f32 v99, v99
    v_rcp_f32 v100, v100
    v_rcp_f32 v101, v101
    v_rcp_f32 v102, v102
    v_rcp_f32 v103, v103
    v_mul_f32 v96, v96, v104
    v_mul_f32 v97, v97, v105
    v_mul_f32 v98, v98, v106
    v_mul_f32 v99, v99, v107
    v_mul_f32 v100, v100, v108
    v_mul_f32 v101, v101, v109
    v_mul_f32 v102, v102, v110
    v_mul_f32 v103, v103, v111
    v_cvt_pk_bf16_f32 v112, v96, v97
    v_cvt_pk_bf16_f32 v113, v98, v99
    v_cvt_pk_bf16_f32 v114, v100, v101
    v_cvt_pk_bf16_f32 v115, v102, v103
    buffer_store_dwordx4 v[112:115], v1, s[32:35], s53 offen sc1
    s_branch mega_kernel_G1_post
mega_kernel_G1_p2d:
    s_lshl_b32 s57, s44, 12
    s_add_u32 s57, s57, 4096
    s_add_u32 s56, s52, 16384
    v_mfma_f32_32x32x16_bf16 v[160:175], a[128:131], v[128:131], v[160:175]
    v_mfma_f32_32x32x16_bf16 v[160:175], a[144:147], v[132:135], v[160:175]
    buffer_load_dwordx4 v[72:75], v1, s[28:31], s50 offen offset:2048 sc1
    v_mfma_f32_32x32x16_bf16 v[160:175], a[160:163], v[136:139], v[160:175]
    v_mfma_f32_32x32x16_bf16 v[160:175], a[176:179], v[140:143], v[160:175]
    buffer_load_dwordx4 v[76:79], v1, s[28:31], s50 offen offset:3072 sc1
    v_mfma_f32_32x32x16_bf16 v[160:175], a[192:195], v[144:147], v[160:175]
    v_mfma_f32_32x32x16_bf16 v[160:175], a[208:211], v[148:151], v[160:175]
    buffer_load_dwordx4 v[224:227], v11, s[40:43], s57 offen offset:0 sc1
    v_mfma_f32_32x32x16_bf16 v[160:175], a[224:227], v[152:155], v[160:175]
    v_mfma_f32_32x32x16_bf16 v[160:175], a[240:243], v[156:159], v[160:175]
    v_mfma_f32_32x32x16_bf16 v[176:191], a[132:135], v[128:131], v[176:191]
    v_mfma_f32_32x32x16_bf16 v[176:191], a[148:151], v[132:135], v[176:191]
    s_nop 9
    ds_write_b128 v7, v[160:163] offset:0
    v_mfma_f32_32x32x16_bf16 v[176:191], a[164:167], v[136:139], v[176:191]
    buffer_load_dwordx4 v[228:231], v11, s[40:43], s57 offen offset:16 sc1
    v_mfma_f32_32x32x16_bf16 v[176:191], a[180:183], v[140:143], v[176:191]
    ds_write_b128 v7, v[164:167] offset:1024
    v_mfma_f32_32x32x16_bf16 v[176:191], a[196:199], v[144:147], v[176:191]
    buffer_load_dwordx4 v[232:235], v11, s[40:43], s57 offen offset:32 sc1
    v_mfma_f32_32x32x16_bf16 v[176:191], a[212:215], v[148:151], v[176:191]
    ds_write_b128 v7, v[168:171] offset:2048
    v_mfma_f32_32x32x16_bf16 v[176:191], a[228:231], v[152:155], v[176:191]
    buffer_load_dwordx4 v[236:239], v11, s[40:43], s57 offen offset:48 sc1
    v_mfma_f32_32x32x16_bf16 v[176:191], a[244:247], v[156:159], v[176:191]
    ds_write_b128 v7, v[172:175] offset:3072
    v_mfma_f32_32x32x16_bf16 v[192:207], a[136:139], v[128:131], v[192:207]
    v_mfma_f32_32x32x16_bf16 v[192:207], a[152:155], v[132:135], v[192:207]
    s_nop 8
    ds_write_b128 v7, v[176:179] offset:4096
    v_mfma_f32_32x32x16_bf16 v[192:207], a[168:171], v[136:139], v[192:207]
    buffer_load_dwordx4 v[80:83], v1, s[28:31], s51 offen offset:0 sc1
    v_mfma_f32_32x32x16_bf16 v[192:207], a[184:187], v[140:143], v[192:207]
    ds_write_b128 v7, v[180:183] offset:5120
    v_mfma_f32_32x32x16_bf16 v[192:207], a[200:203], v[144:147], v[192:207]
    buffer_load_dwordx4 v[84:87], v1, s[28:31], s51 offen offset:1024 sc1
    v_mfma_f32_32x32x16_bf16 v[192:207], a[216:219], v[148:151], v[192:207]
    ds_write_b128 v7, v[184:187] offset:6144
    v_mfma_f32_32x32x16_bf16 v[192:207], a[232:235], v[152:155], v[192:207]
    buffer_load_dwordx4 v[88:91], v1, s[28:31], s51 offen offset:2048 sc1
    v_mfma_f32_32x32x16_bf16 v[192:207], a[248:251], v[156:159], v[192:207]
    ds_write_b128 v7, v[188:191] offset:7168
    v_mfma_f32_32x32x16_bf16 v[208:223], a[140:143], v[128:131], v[208:223]
    v_mfma_f32_32x32x16_bf16 v[208:223], a[156:159], v[132:135], v[208:223]
    s_nop 8
    ds_write_b128 v7, v[192:195] offset:8192
    v_mfma_f32_32x32x16_bf16 v[208:223], a[172:175], v[136:139], v[208:223]
    buffer_load_dwordx4 v[92:95], v1, s[28:31], s51 offen offset:3072 sc1
    v_mfma_f32_32x32x16_bf16 v[208:223], a[188:191], v[140:143], v[208:223]
    ds_write_b128 v7, v[196:199] offset:9216
    v_mfma_f32_32x32x16_bf16 v[208:223], a[204:207], v[144:147], v[208:223]
    buffer_load_dword v3, v2, s[36:39], s56 offen sc1
    v_mfma_f32_32x32x16_bf16 v[208:223], a[220:223], v[148:151], v[208:223]
    ds_write_b128 v7, v[200:203] offset:10240
    v_mfma_f32_32x32x16_bf16 v[208:223], a[236:239], v[152:155], v[208:223]
    ds_write_b128 v7, v[204:207] offset:11264
    v_mfma_f32_32x32x16_bf16 v[208:223], a[252:255], v[156:159], v[208:223]
    s_branch mega_kernel_G1_red
mega_kernel_G1_p2n:
    v_mfma_f32_32x32x16_bf16 v[160:175], a[128:131], v[128:131], v[160:175]
    v_mfma_f32_32x32x16_bf16 v[160:175], a[144:147], v[132:135], v[160:175]
    v_mfma_f32_32x32x16_bf16 v[160:175], a[160:163], v[136:139], v[160:175]
    v_mfma_f32_32x32x16_bf16 v[160:175], a[176:179], v[140:143], v[160:175]
    v_mfma_f32_32x32x16_bf16 v[160:175], a[192:195], v[144:147], v[160:175]
    v_mfma_f32_32x32x16_bf16 v[160:175], a[208:211], v[148:151], v[160:175]
    v_mfma_f32_32x32x16_bf16 v[160:175], a[224:227], v[152:155], v[160:175]
    v_mfma_f32_32x32x16_bf16 v[160:175], a[240:243], v[156:159], v[160:175]
    s_add_u32 s56, s52, 8192
    buffer_load_dword v3, v2, s[36:39], s56 offen sc1
    v_mfma_f32_32x32x16_bf16 v[176:191], a[132:135], v[128:131], v[176:191]
    v_mfma_f32_32x32x16_bf16 v[176:191], a[148:151], v[132:135], v[176:191]
    s_nop 7
    ds_write_b128 v7, v[160:163] offset:0
    v_mfma_f32_32x32x16_bf16 v[176:191], a[164:167], v[136:139], v[176:191]
    ds_write_b128 v7, v[164:167] offset:1024
    v_mfma_f32_32x32x16_bf16 v[176:191], a[180:183], v[140:143], v[176:191]
    v_mfma_f32_32x32x16_bf16 v[176:191], a[196:199], v[144:147], v[176:191]
    ds_write_b128 v7, v[168:171] offset:2048
    v_mfma_f32_32x32x16_bf16 v[176:191], a[212:215], v[148:151], v[176:191]
    v_mfma_f32_32x32x16_bf16 v[176:191], a[228:231], v[152:155], v[176:191]
    ds_write_b128 v7, v[172:175] offset:3072
    v_mfma_f32_32x32x16_bf16 v[176:191], a[244:247], v[156:159], v[176:191]
    v_mfma_f32_32x32x16_bf16 v[192:207], a[136:139], v[128:131], v[192:207]
    v_mfma_f32_32x32x16_bf16 v[192:207], a[152:155], v[132:135], v[192:207]
    s_nop 9
    ds_write_b128 v7, v[176:179] offset:4096
    v_mfma_f32_32x32x16_bf16 v[192:207], a[168:171], v[136:139], v[192:207]
    ds_write_b128 v7, v[180:183] offset:5120
    v_mfma_f32_32x32x16_bf16 v[192:207], a[184:187], v[140:143], v[192:207]
    v_mfma_f32_32x32x16_bf16 v[192:207], a[200:203], v[144:147], v[192:207]
    ds_write_b128 v7, v[184:187] offset:6144
    v_mfma_f32_32x32x16_bf16 v[192:207], a[216:219], v[148:151], v[192:207]
    v_mfma_f32_32x32x16_bf16 v[192:207], a[232:235], v[152:155], v[192:207]
    ds_write_b128 v7, v[188:191] offset:7168
    v_mfma_f32_32x32x16_bf16 v[192:207], a[248:251], v[156:159], v[192:207]
    v_mfma_f32_32x32x16_bf16 v[208:223], a[140:143], v[128:131], v[208:223]
    v_mfma_f32_32x32x16_bf16 v[208:223], a[156:159], v[132:135], v[208:223]
    s_nop 9
    ds_write_b128 v7, v[192:195] offset:8192
    v_mfma_f32_32x32x16_bf16 v[208:223], a[172:175], v[136:139], v[208:223]
    ds_write_b128 v7, v[196:199] offset:9216
    v_mfma_f32_32x32x16_bf16 v[208:223], a[188:191], v[140:143], v[208:223]
    v_mfma_f32_32x32x16_bf16 v[208:223], a[204:207], v[144:147], v[208:223]
    ds_write_b128 v7, v[200:203] offset:10240
    v_mfma_f32_32x32x16_bf16 v[208:223], a[220:223], v[148:151], v[208:223]
    v_mfma_f32_32x32x16_bf16 v[208:223], a[236:239], v[152:155], v[208:223]
    ds_write_b128 v7, v[204:207] offset:11264
    v_mfma_f32_32x32x16_bf16 v[208:223], a[252:255], v[156:159], v[208:223]
    s_waitcnt lgkmcnt(0)
    s_barrier
    s_cmp_eq_u32 s44, 63
    s_cbranch_scc1 mega_kernel_G1_red2
    s_waitcnt vmcnt(0)
    v_cmp_eq_u32 vcc, 0, v3
    s_cbranch_vccnz mega_kernel_G1_red2
    s_mov_b32 s55, 1
    s_add_u32 s48, s69, 65536
    s_add_u32 s49, s69, 69632
    s_add_u32 s50, s69, 73728
    s_add_u32 s51, s69, 77824
    s_lshl_b32 s57, s44, 12
    s_add_u32 s57, s57, 4096
    s_add_u32 s56, s52, 16384
    ds_read_b128 v[160:163], v8 offset:0
    ds_read_b128 v[164:167], v8 offset:1024
    ds_read_b128 v[168:171], v8 offset:2048
    ds_read_b128 v[172:175], v8 offset:3072
    ds_read_b128 v[176:179], v9 offset:0
    ds_read_b128 v[180:183], v9 offset:1024
    ds_read_b128 v[184:187], v9 offset:2048
    ds_read_b128 v[188:191], v9 offset:3072
    ds_read_b128 v[192:195], v10 offset:0
    ds_read_b128 v[196:199], v10 offset:1024
    ds_read_b128 v[200:203], v10 offset:2048
    ds_read_b128 v[204:207], v10 offset:3072
    buffer_load_dwordx4 v[224:227], v11, s[40:43], s57 offen offset:0 sc1
    buffer_load_dwordx4 v[228:231], v11, s[40:43], s57 offen offset:16 sc1
    buffer_load_dwordx4 v[232:235], v11, s[40:43], s57 offen offset:32 sc1
    buffer_load_dwordx4 v[236:239], v11, s[40:43], s57 offen offset:48 sc1
    buffer_load_dwordx4 v[32:35], v1, s[28:31], s48 offen offset:0 sc1
    buffer_load_dwordx4 v[36:39], v1, s[28:31], s48 offen offset:1024 sc1
    buffer_load_dwordx4 v[40:43], v1, s[28:31], s48 offen offset:2048 sc1
    buffer_load_dwordx4 v[44:47], v1, s[28:31], s48 offen offset:3072 sc1
    s_waitcnt lgkmcnt(8)
    buffer_load_dwordx4 v[48:51], v1, s[28:31], s49 offen offset:0 sc1
    v_add_f32 v96, v208, v160
    v_add_f32 v97, v209, v161
    v_add_f32 v98, v210, v162
    v_add_f32 v99, v211, v163
    v_add_f32 v100, v212, v164
    v_add_f32 v101, v213, v165
    v_add_f32 v102, v214, v166
    v_add_f32 v103, v215, v167
    v_add_f32 v104, v216, v168
    buffer_load_dwordx4 v[52:55], v1, s[28:31], s49 offen offset:1024 sc1
    v_add_f32 v105, v217, v169
    v_add_f32 v106, v218, v170
    v_add_f32 v107, v219, v171
    v_add_f32 v108, v220, v172
    v_add_f32 v109, v221, v173
    v_add_f32 v110, v222, v174
    v_add_f32 v111, v223, v175
    s_waitcnt lgkmcnt(0)
    v_add_f32 v176, v176, v192
    buffer_load_dwordx4 v[56:59], v1, s[28:31], s49 offen offset:2048 sc1
    v_add_f32 v177, v177, v193
    v_add_f32 v178, v178, v194
    v_add_f32 v179, v179, v195
    v_add_f32 v180, v180, v196
    v_add_f32 v181, v181, v197
    v_add_f32 v182, v182, v198
    v_add_f32 v183, v183, v199
    v_add_f32 v184, v184, v200
    v_add_f32 v185, v185, v201
    buffer_load_dwordx4 v[60:63], v1, s[28:31], s49 offen offset:3072 sc1
    v_add_f32 v186, v186, v202
    v_add_f32 v187, v187, v203
    v_add_f32 v188, v188, v204
    v_add_f32 v189, v189, v205
    v_add_f32 v190, v190, v206
    v_add_f32 v191, v191, v207
    v_add_f32 v96, v96, v176
    v_add_f32 v97, v97, v177
    v_add_f32 v98, v98, v178
    buffer_load_dwordx4 v[64:67], v1, s[28:31], s50 offen offset:0 sc1
    v_add_f32 v99, v99, v179
    v_add_f32 v100, v100, v180
    v_add_f32 v101, v101, v181
    v_add_f32 v102, v102, v182
    v_add_f32 v103, v103, v183
    v_add_f32 v104, v104, v184
    v_add_f32 v105, v105, v185
    v_add_f32 v106, v106, v186
    v_add_f32 v107, v107, v187
    buffer_load_dwordx4 v[68:71], v1, s[28:31], s50 offen offset:1024 sc1
    v_add_f32 v108, v108, v188
    v_add_f32 v109, v109, v189
    v_add_f32 v110, v110, v190
    v_add_f32 v111, v111, v191
    v_xor_b32 v7, 0x10000, v7
    v_xor_b32 v8, 0x10000, v8
    v_xor_b32 v9, 0x10000, v9
    v_xor_b32 v10, 0x10000, v10
    v_mul_f32 v15, 0xbfb8aa3b, v13
    buffer_load_dwordx4 v[72:75], v1, s[28:31], s50 offen offset:2048 sc1
    v_fma_f32 v96, -v12, v16, v96
    v_fma_f32 v97, -v12, v17, v97
    v_fma_f32 v98, -v12, v18, v98
    v_fma_f32 v99, -v12, v19, v99
    v_fma_f32 v100, -v12, v20, v100
    v_fma_f32 v101, -v12, v21, v101
    v_fma_f32 v102, -v12, v22, v102
    v_fma_f32 v103, -v12, v23, v103
    v_fma_f32 v104, -v12, v24, v104
    buffer_load_dwordx4 v[76:79], v1, s[28:31], s50 offen offset:3072 sc1
    v_fma_f32 v105, -v12, v25, v105
    v_fma_f32 v106, -v12, v26, v106
    v_fma_f32 v107, -v12, v27, v107
    v_fma_f32 v108, -v12, v28, v108
    v_fma_f32 v109, -v12, v29, v109
    v_fma_f32 v110, -v12, v30, v110
    v_fma_f32 v111, -v12, v31, v111
    v_mul_f32 v96, v96, v15
    v_mul_f32 v97, v97, v15
    v_mul_f32 v98, v98, v15
    buffer_load_dwordx4 v[80:83], v1, s[28:31], s51 offen offset:0 sc1
    v_mul_f32 v99, v99, v15
    v_mul_f32 v100, v100, v15
    v_mul_f32 v101, v101, v15
    v_mul_f32 v102, v102, v15
    v_mul_f32 v103, v103, v15
    v_exp_f32 v96, v96
    v_exp_f32 v97, v97
    v_exp_f32 v98, v98
    v_exp_f32 v99, v99
    v_exp_f32 v100, v100
    buffer_load_dwordx4 v[84:87], v1, s[28:31], s51 offen offset:1024 sc1
    v_exp_f32 v101, v101
    v_exp_f32 v102, v102
    v_exp_f32 v103, v103
    v_mul_f32 v104, v104, v13
    v_mul_f32 v105, v105, v13
    v_mul_f32 v106, v106, v13
    v_mul_f32 v107, v107, v13
    v_mul_f32 v108, v108, v13
    v_mul_f32 v109, v109, v13
    v_mul_f32 v110, v110, v13
    buffer_load_dwordx4 v[88:91], v1, s[28:31], s51 offen offset:2048 sc1
    v_mul_f32 v111, v111, v13
    v_add_f32 v96, 1.0, v96
    v_add_f32 v97, 1.0, v97
    v_add_f32 v98, 1.0, v98
    v_add_f32 v99, 1.0, v99
    v_add_f32 v100, 1.0, v100
    v_add_f32 v101, 1.0, v101
    v_add_f32 v102, 1.0, v102
    v_add_f32 v103, 1.0, v103
    v_rcp_f32 v96, v96
    buffer_load_dwordx4 v[92:95], v1, s[28:31], s51 offen offset:3072 sc1
    v_rcp_f32 v97, v97
    v_rcp_f32 v98, v98
    v_rcp_f32 v99, v99
    v_rcp_f32 v100, v100
    v_rcp_f32 v101, v101
    v_rcp_f32 v102, v102
    v_rcp_f32 v103, v103
    v_mul_f32 v96, v96, v104
    v_mul_f32 v97, v97, v105
    v_mul_f32 v98, v98, v106
    buffer_load_dword v3, v2, s[36:39], s56 offen sc1
    v_mul_f32 v99, v99, v107
    v_mul_f32 v100, v100, v108
    v_mul_f32 v101, v101, v109
    v_mul_f32 v102, v102, v110
    v_mul_f32 v103, v103, v111
    v_cvt_pk_bf16_f32 v112, v96, v97
    v_cvt_pk_bf16_f32 v113, v98, v99
    v_cvt_pk_bf16_f32 v114, v100, v101
    v_cvt_pk_bf16_f32 v115, v102, v103
    buffer_store_dwordx4 v[112:115], v1, s[32:35], s53 offen sc1
    s_branch mega_kernel_G1_post
mega_kernel_G1_red:
    s_waitcnt lgkmcnt(0)
    s_barrier
mega_kernel_G1_red2:
    ds_read_b128 v[160:163], v8 offset:0
    ds_read_b128 v[164:167], v8 offset:1024
    ds_read_b128 v[168:171], v8 offset:2048
    ds_read_b128 v[172:175], v8 offset:3072
    ds_read_b128 v[176:179], v9 offset:0
    ds_read_b128 v[180:183], v9 offset:1024
    ds_read_b128 v[184:187], v9 offset:2048
    ds_read_b128 v[188:191], v9 offset:3072
    ds_read_b128 v[192:195], v10 offset:0
    ds_read_b128 v[196:199], v10 offset:1024
    ds_read_b128 v[200:203], v10 offset:2048
    ds_read_b128 v[204:207], v10 offset:3072
    s_waitcnt lgkmcnt(8)
    v_add_f32 v96, v208, v160
    v_add_f32 v97, v209, v161
    v_add_f32 v98, v210, v162
    v_add_f32 v99, v211, v163
    v_add_f32 v100, v212, v164
    v_add_f32 v101, v213, v165
    v_add_f32 v102, v214, v166
    v_add_f32 v103, v215, v167
    v_add_f32 v104, v216, v168
    v_add_f32 v105, v217, v169
    v_add_f32 v106, v218, v170
    v_add_f32 v107, v219, v171
    v_add_f32 v108, v220, v172
    v_add_f32 v109, v221, v173
    v_add_f32 v110, v222, v174
    v_add_f32 v111, v223, v175
    s_waitcnt lgkmcnt(0)
    v_add_f32 v176, v176, v192
    v_add_f32 v177, v177, v193
    v_add_f32 v178, v178, v194
    v_add_f32 v179, v179, v195
    v_add_f32 v180, v180, v196
    v_add_f32 v181, v181, v197
    v_add_f32 v182, v182, v198
    v_add_f32 v183, v183, v199
    v_add_f32 v184, v184, v200
    v_add_f32 v185, v185, v201
    v_add_f32 v186, v186, v202
    v_add_f32 v187, v187, v203
    v_add_f32 v188, v188, v204
    v_add_f32 v189, v189, v205
    v_add_f32 v190, v190, v206
    v_add_f32 v191, v191, v207
    v_add_f32 v96, v96, v176
    v_add_f32 v97, v97, v177
    v_add_f32 v98, v98, v178
    v_add_f32 v99, v99, v179
    v_add_f32 v100, v100, v180
    v_add_f32 v101, v101, v181
    v_add_f32 v102, v102, v182
    v_add_f32 v103, v103, v183
    v_add_f32 v104, v104, v184
    v_add_f32 v105, v105, v185
    v_add_f32 v106, v106, v186
    v_add_f32 v107, v107, v187
    v_add_f32 v108, v108, v188
    v_add_f32 v109, v109, v189
    v_add_f32 v110, v110, v190
    v_add_f32 v111, v111, v191
    v_xor_b32 v7, 0x10000, v7
    v_xor_b32 v8, 0x10000, v8
    v_xor_b32 v9, 0x10000, v9
    v_xor_b32 v10, 0x10000, v10
    v_mul_f32 v15, 0xbfb8aa3b, v13
    v_fma_f32 v96, -v12, v16, v96
    v_fma_f32 v97, -v12, v17, v97
    v_fma_f32 v98, -v12, v18, v98
    v_fma_f32 v99, -v12, v19, v99
    v_fma_f32 v100, -v12, v20, v100
    v_fma_f32 v101, -v12, v21, v101
    v_fma_f32 v102, -v12, v22, v102
    v_fma_f32 v103, -v12, v23, v103
    v_fma_f32 v104, -v12, v24, v104
    v_fma_f32 v105, -v12, v25, v105
    v_fma_f32 v106, -v12, v26, v106
    v_fma_f32 v107, -v12, v27, v107
    v_fma_f32 v108, -v12, v28, v108
    v_fma_f32 v109, -v12, v29, v109
    v_fma_f32 v110, -v12, v30, v110
    v_fma_f32 v111, -v12, v31, v111
    v_mul_f32 v96, v96, v15
    v_mul_f32 v97, v97, v15
    v_mul_f32 v98, v98, v15
    v_mul_f32 v99, v99, v15
    v_mul_f32 v100, v100, v15
    v_mul_f32 v101, v101, v15
    v_mul_f32 v102, v102, v15
    v_mul_f32 v103, v103, v15
    v_exp_f32 v96, v96
    v_exp_f32 v97, v97
    v_exp_f32 v98, v98
    v_exp_f32 v99, v99
    v_exp_f32 v100, v100
    v_exp_f32 v101, v101
    v_exp_f32 v102, v102
    v_exp_f32 v103, v103
    v_mul_f32 v104, v104, v13
    v_mul_f32 v105, v105, v13
    v_mul_f32 v106, v106, v13
    v_mul_f32 v107, v107, v13
    v_mul_f32 v108, v108, v13
    v_mul_f32 v109, v109, v13
    v_mul_f32 v110, v110, v13
    v_mul_f32 v111, v111, v13
    v_add_f32 v96, 1.0, v96
    v_add_f32 v97, 1.0, v97
    v_add_f32 v98, 1.0, v98
    v_add_f32 v99, 1.0, v99
    v_add_f32 v100, 1.0, v100
    v_add_f32 v101, 1.0, v101
    v_add_f32 v102, 1.0, v102
    v_add_f32 v103, 1.0, v103
    v_rcp_f32 v96, v96
    v_rcp_f32 v97, v97
    v_rcp_f32 v98, v98
    v_rcp_f32 v99, v99
    v_rcp_f32 v100, v100
    v_rcp_f32 v101, v101
    v_rcp_f32 v102, v102
    v_rcp_f32 v103, v103
    v_mul_f32 v96, v96, v104
    v_mul_f32 v97, v97, v105
    v_mul_f32 v98, v98, v106
    v_mul_f32 v99, v99, v107
    v_mul_f32 v100, v100, v108
    v_mul_f32 v101, v101, v109
    v_mul_f32 v102, v102, v110
    v_mul_f32 v103, v103, v111
    v_cvt_pk_bf16_f32 v112, v96, v97
    v_cvt_pk_bf16_f32 v113, v98, v99
    v_cvt_pk_bf16_f32 v114, v100, v101
    v_cvt_pk_bf16_f32 v115, v102, v103
    buffer_store_dwordx4 v[112:115], v1, s[32:35], s53 offen sc1
mega_kernel_G1_post:
    s_cmp_eq_u32 s44, 63
    s_cbranch_scc1 mega_kernel_G1_last
    s_cmp_lg_u32 s55, 0
    s_cbranch_scc0 mega_kernel_G1_np
    s_mov_b32 s47, s54
    s_add_u32 s44, s44, 1
    s_branch mega_kernel_G0_deep
mega_kernel_G1_np:
    s_add_u32 s56, s52, 8192
    buffer_load_dword v3, v2, s[36:39], s56 offen sc1
    s_waitcnt vmcnt(0)
    s_mov_b64 exec, 1
    buffer_store_byte v14, off, s[36:39], s54 sc1
    s_mov_b64 exec, -1
    v_cmp_eq_u32 vcc, 0, v3
    s_cbranch_vccz mega_kernel_G1_p_ok
mega_kernel_G1_p:
    buffer_load_dword v3, v2, s[36:39], s56 offen sc1
    s_waitcnt vmcnt(0)
    v_cmp_eq_u32 vcc, 0, v3
    s_cbranch_vccz mega_kernel_G1_p_ok
    s_cmp_eq_u32 s45, 0
    s_cbranch_scc1 mega_kernel_G1_p_ok
    s_sub_u32 s45, s45, 1
    s_sleep 1
    s_branch mega_kernel_G1_p
mega_kernel_G1_p_ok:
    s_add_u32 s44, s44, 1
    s_lshl_b32 s56, s44, 13
    s_add_u32 s52, s56, s66
    s_add_u32 s54, s56, s67
    s_mul_i32 s53, s44, 229376
    s_add_u32 s53, s53, s68
    s_mul_i32 s69, s44, 65536
    s_add_u32 s69, s69, s46
    s_branch mega_kernel_G0_cold
mega_kernel_G1_last:
    s_waitcnt vmcnt(0)
    s_mov_b64 exec, 1
    buffer_store_byte v14, off, s[36:39], s54 sc1
    s_mov_b64 exec, -1
    s_branch mega_kernel_G_fin
mega_kernel_G_fin:
    s_waitcnt vmcnt(0)
    s_branch mega_kernel_exit
mega_kernel_toX:
    s_sub_u32 s63, s61, 152
    s_load_dwordx2 s[4:5], s[0:1], 104
    s_lshl_b32 s36, s63, 2
    s_add_u32 s36, s36, s62
    s_waitcnt lgkmcnt(0)
    s_add_u32 s20, s4, 4194304
    s_addc_u32 s21, s5, 0
    s_mov_b32 s22, 50331648
    s_mov_b32 s23, 0x20000
    s_add_u32 s24, s4, 54525952
    s_addc_u32 s25, s5, 0
    s_mov_b32 s26, 8388608
    s_mov_b32 s27, 0x20000
    s_add_u32 s28, s4, 62914560
    s_addc_u32 s29, s5, 0
    s_mov_b32 s30, 16777216
    s_mov_b32 s31, 0x20000
    s_add_u32 s32, s4, 169607168
    s_addc_u32 s33, s5, 0
    s_mov_b32 s34, 548864
    s_mov_b32 s35, 0x20000
    v_and_b32 v10, 63, v0
    v_lshlrev_b32 v1, 4, v10
    v_and_b32 v11, 31, v10
    v_lshrrev_b32 v12, 5, v10
    v_lshlrev_b32 v4, 2, v12
    v_sub_u32 v4, v11, v4
    v_lshlrev_b32 v3, 3, v12
    v_lshl_add_u32 v3, v11, 4, v3
    v_add_u32 v3, 4194304, v3
    v_and_b32 v2, 7, v10
    v_lshlrev_b32 v2, 4, v2
    v_lshl_add_u32 v2, v12, 7, v2
    v_and_b32 v7, 1, v10
    v_lshlrev_b32 v7, 4, v7
    v_min_u32 v8, 2, v10
    v_lshlrev_b32 v8, 2, v8
    v_mov_b32 v9, 1
    v_mov_b32 v5, 0
    s_mov_b32 s38, 262144
    s_mov_b32 s37, 0
    s_lshl_b32 s39, s37, 18
    s_lshl_b32 s46, s36, 13
    s_add_u32 s39, s39, s46
    s_mov_b32 s44, s39
    s_lshr_b32 s40, s39, 2
    s_lshl_b32 s41, s37, 13
    s_lshl_b32 s46, s36, 4
    s_add_u32 s43, s41, s46
    s_add_u32 s43, s43, 16384
    s_lshl_b32 s46, s36, 5
    s_add_u32 s41, s41, s46
    s_add_u32 s41, s41, 17408
    s_add_u32 s46, s37, 0
    s_lshr_b32 s46, s46, 2
    s_lshl_b32 s46, s46, 10
    s_lshr_b32 s42, s36, 1
    s_lshl_b32 s42, s42, 6
    s_add_u32 s42, s42, s46
mega_kernel_xt0:
    buffer_load_dword v6, v8, s[32:35], s42 offen sc1
    s_waitcnt vmcnt(0)
    v_cmp_gt_u32 vcc, 4, v6
    s_cbranch_vccz mega_kernel_xt0_ok
    s_cmp_eq_u32 s38, 0
    s_cbranch_scc1 mega_kernel_xt0_ok
    s_sub_u32 s38, s38, 1
    s_sleep 1
    s_branch mega_kernel_xt0
mega_kernel_xt0_ok:
    s_add_u32 s47, s39, 0
    s_add_u32 s48, s47, 4096
    s_add_u32 s49, s47, 33554432
    s_add_u32 s50, s49, 4096
    s_add_u32 s51, s47, 16777216
    s_add_u32 s52, s51, 4096
    buffer_load_dwordx4 a[32:35], v1, s[20:23], s47 offen offset:0 sc1
    buffer_load_dwordx4 a[0:3], v1, s[20:23], s49 offen offset:0 sc1
    buffer_load_dwordx4 a[36:39], v1, s[20:23], s47 offen offset:1024 sc1
    buffer_load_dwordx4 a[4:7], v1, s[20:23], s49 offen offset:1024 sc1
    buffer_load_dwordx4 a[40:43], v1, s[20:23], s47 offen offset:2048 sc1
    buffer_load_dwordx4 a[8:11], v1, s[20:23], s49 offen offset:2048 sc1
    buffer_load_dwordx4 a[44:47], v1, s[20:23], s47 offen offset:3072 sc1
    buffer_load_dwordx4 a[12:15], v1, s[20:23], s49 offen offset:3072 sc1
    buffer_load_dwordx4 a[48:51], v1, s[20:23], s48 offen offset:0 sc1
    buffer_load_dwordx4 a[16:19], v1, s[20:23], s50 offen offset:0 sc1
    buffer_load_dwordx4 a[52:55], v1, s[20:23], s48 offen offset:1024 sc1
    buffer_load_dwordx4 a[20:23], v1, s[20:23], s50 offen offset:1024 sc1
    buffer_load_dwordx4 a[56:59], v1, s[20:23], s48 offen offset:2048 sc1
    buffer_load_dwordx4 a[24:27], v1, s[20:23], s50 offen offset:2048 sc1
    buffer_load_dwordx4 a[60:63], v1, s[20:23], s48 offen offset:3072 sc1
    buffer_load_dwordx4 a[28:31], v1, s[20:23], s50 offen offset:3072 sc1
    buffer_load_dwordx4 a[64:67], v1, s[20:23], s51 offen offset:0 sc1
    buffer_load_dwordx4 a[68:71], v1, s[20:23], s51 offen offset:1024 sc1
    buffer_load_dwordx4 a[72:75], v1, s[20:23], s51 offen offset:2048 sc1
    buffer_load_dwordx4 a[76:79], v1, s[20:23], s51 offen offset:3072 sc1
    buffer_load_dwordx4 a[80:83], v1, s[20:23], s52 offen offset:0 sc1
    buffer_load_dwordx4 a[84:87], v1, s[20:23], s52 offen offset:1024 sc1
    buffer_load_dwordx4 a[88:91], v1, s[20:23], s52 offen offset:2048 sc1
    buffer_load_dwordx4 a[92:95], v1, s[20:23], s52 offen offset:3072 sc1
mega_kernel_xloop:
mega_kernel_x0_top:
    s_lshl_b32 s39, s37, 18
    s_lshl_b32 s46, s36, 13
    s_add_u32 s39, s39, s46
    s_mov_b32 s44, s39
    s_lshr_b32 s40, s39, 2
    s_lshl_b32 s41, s37, 13
    s_lshl_b32 s46, s36, 4
    s_add_u32 s43, s41, s46
    s_add_u32 s43, s43, 16384
    s_lshl_b32 s46, s36, 5
    s_add_u32 s41, s41, s46
    s_add_u32 s41, s41, 17408
    v_cmp_eq_u32 vcc, 0, v5
    s_cbranch_vccnz mega_kernel_x0_B
    buffer_load_dwordx4 v[32:35], v2, s[24:27], s40 offen offset:0 sc1
    buffer_load_dwordx4 v[36:39], v2, s[24:27], s40 offen offset:256 sc1
    buffer_load_dwordx4 v[40:43], v2, s[24:27], s40 offen offset:512 sc1
    buffer_load_dwordx4 v[44:47], v2, s[24:27], s40 offen offset:768 sc1
    buffer_load_dwordx4 v[48:51], v2, s[24:27], s40 offen offset:1024 sc1
    buffer_load_dwordx4 v[52:55], v2, s[24:27], s40 offen offset:1280 sc1
    buffer_load_dwordx4 v[56:59], v2, s[24:27], s40 offen offset:1536 sc1
    buffer_load_dwordx4 v[60:63], v2, s[24:27], s40 offen offset:1792 sc1
    buffer_load_dwordx2 v[64:65], v3, s[24:27], s40 offen offset:0 sc1
    buffer_load_dwordx2 v[66:67], v3, s[24:27], s40 offen offset:512 sc1
    buffer_load_dwordx2 v[68:69], v3, s[24:27], s40 offen offset:1024 sc1
    buffer_load_dwordx2 v[70:71], v3, s[24:27], s40 offen offset:1536 sc1
    s_add_u32 s46, s41, 8192
    buffer_load_dword v5, v7, s[32:35], s46 offen sc1
    s_add_u32 s46, s37, 1
    s_lshr_b32 s46, s46, 2
    s_lshl_b32 s46, s46, 10
    s_lshr_b32 s42, s36, 1
    s_lshl_b32 s42, s42, 6
    s_add_u32 s42, s42, s46
    buffer_load_dword v6, v8, s[32:35], s42 offen sc1
    s_waitcnt vmcnt(22)
    v_mfma_f32_32x32x16_bf16 v[72:87], a[32:35], a[0:3], 0
    v_mfma_f32_32x32x16_bf16 v[72:87], a[36:39], a[4:7], v[72:87]
    v_mfma_f32_32x32x16_bf16 v[72:87], a[40:43], a[8:11], v[72:87]
    v_mfma_f32_32x32x16_bf16 v[72:87], a[44:47], a[12:15], v[72:87]
    v_mfma_f32_32x32x16_bf16 v[72:87], a[48:51], a[16:19], v[72:87]
    v_mfma_f32_32x32x16_bf16 v[72:87], a[52:55], a[20:23], v[72:87]
    v_mfma_f32_32x32x16_bf16 v[72:87], a[56:59], a[24:27], v[72:87]
    v_mfma_f32_32x32x16_bf16 v[72:87], a[60:63], a[28:31], v[72:87]
    s_waitcnt vmcnt(14)
    s_cmp_eq_u32 s37, 0
    s_cbranch_scc1 mega_kernel_x0_fa
    s_sub_u32 s46, s43, 8192
    s_mov_b64 exec, 1
    buffer_store_dword v9, off, s[32:35], s46 sc1
    s_mov_b64 exec, -1
mega_kernel_x0_fa:
    s_nop 3
    s_branch mega_kernel_x0_J
mega_kernel_x0_B:
    s_waitcnt vmcnt(0)
    s_cmp_eq_u32 s37, 0
    s_cbranch_scc1 mega_kernel_x0_fb
    s_sub_u32 s46, s43, 8192
    s_mov_b64 exec, 1
    buffer_store_dword v9, off, s[32:35], s46 sc1
    s_mov_b64 exec, -1
mega_kernel_x0_fb:
    s_nop 3
    v_mfma_f32_32x32x16_bf16 v[72:87], a[32:35], a[0:3], 0
    v_mfma_f32_32x32x16_bf16 v[72:87], a[36:39], a[4:7], v[72:87]
    v_mfma_f32_32x32x16_bf16 v[72:87], a[40:43], a[8:11], v[72:87]
    v_mfma_f32_32x32x16_bf16 v[72:87], a[44:47], a[12:15], v[72:87]
    v_mfma_f32_32x32x16_bf16 v[72:87], a[48:51], a[16:19], v[72:87]
    v_mfma_f32_32x32x16_bf16 v[72:87], a[52:55], a[20:23], v[72:87]
    v_mfma_f32_32x32x16_bf16 v[72:87], a[56:59], a[24:27], v[72:87]
    v_mfma_f32_32x32x16_bf16 v[72:87], a[60:63], a[28:31], v[72:87]
mega_kernel_x0_pc:
    buffer_load_dword v5, v7, s[32:35], s41 offen sc1
    s_waitcnt vmcnt(0)
    v_cmp_eq_u32 vcc, 0, v5
    s_cbranch_vccz mega_kernel_x0_pc_ok
    s_cmp_eq_u32 s38, 0
    s_cbranch_scc1 mega_kernel_x0_pc_ok
    s_sub_u32 s38, s38, 1
    s_sleep 1
    s_branch mega_kernel_x0_pc
mega_kernel_x0_pc_ok:
    buffer_load_dwordx4 v[32:35], v2, s[24:27], s40 offen offset:0 sc1
    buffer_load_dwordx4 v[36:39], v2, s[24:27], s40 offen offset:256 sc1
    buffer_load_dwordx4 v[40:43], v2, s[24:27], s40 offen offset:512 sc1
    buffer_load_dwordx4 v[44:47], v2, s[24:27], s40 offen offset:768 sc1
    buffer_load_dwordx4 v[48:51], v2, s[24:27], s40 offen offset:1024 sc1
    buffer_load_dwordx4 v[52:55], v2, s[24:27], s40 offen offset:1280 sc1
    buffer_load_dwordx4 v[56:59], v2, s[24:27], s40 offen offset:1536 sc1
    buffer_load_dwordx4 v[60:63], v2, s[24:27], s40 offen offset:1792 sc1
    buffer_load_dwordx2 v[64:65], v3, s[24:27], s40 offen offset:0 sc1
    buffer_load_dwordx2 v[66:67], v3, s[24:27], s40 offen offset:512 sc1
    buffer_load_dwordx2 v[68:69], v3, s[24:27], s40 offen offset:1024 sc1
    buffer_load_dwordx2 v[70:71], v3, s[24:27], s40 offen offset:1536 sc1
    s_add_u32 s46, s41, 8192
    buffer_load_dword v5, v7, s[32:35], s46 offen sc1
    s_add_u32 s46, s37, 1
    s_lshr_b32 s46, s46, 2
    s_lshl_b32 s46, s46, 10
    s_lshr_b32 s42, s36, 1
    s_lshl_b32 s42, s42, 6
    s_add_u32 s42, s42, s46
    buffer_load_dword v6, v8, s[32:35], s42 offen sc1
mega_kernel_x0_J:
    s_waitcnt vmcnt(13)
    v_mfma_f32_32x32x16_bf16 v[88:103], v[32:35], a[0:3], 0
    s_waitcnt vmcnt(12)
    v_mfma_f32_32x32x16_bf16 v[88:103], v[36:39], a[4:7], v[88:103]
    s_waitcnt vmcnt(11)
    v_mfma_f32_32x32x16_bf16 v[88:103], v[40:43], a[8:11], v[88:103]
    s_waitcnt vmcnt(10)
    v_mfma_f32_32x32x16_bf16 v[88:103], v[44:47], a[12:15], v[88:103]
    s_waitcnt vmcnt(9)
    v_mfma_f32_32x32x16_bf16 v[88:103], v[48:51], a[16:19], v[88:103]
    s_waitcnt vmcnt(8)
    v_mfma_f32_32x32x16_bf16 v[88:103], v[52:55], a[20:23], v[88:103]
    s_waitcnt vmcnt(7)
    v_mfma_f32_32x32x16_bf16 v[88:103], v[56:59], a[24:27], v[88:103]
    s_waitcnt vmcnt(6)
    v_mfma_f32_32x32x16_bf16 v[88:103], v[60:63], a[28:31], v[88:103]
    v_mov_b32 v12, 0xd028965f
    v_cmp_gt_i32 vcc, 0, v4
    s_nop 1
    v_cndmask_b32 v72, v72, v12, vcc
    v_cmp_gt_i32 vcc, 1, v4
    s_nop 1
    v_cndmask_b32 v73, v73, v12, vcc
    v_cmp_gt_i32 vcc, 2, v4
    s_nop 1
    v_cndmask_b32 v74, v74, v12, vcc
    v_cmp_gt_i32 vcc, 3, v4
    s_nop 1
    v_cndmask_b32 v75, v75, v12, vcc
    v_cmp_gt_i32 vcc, 8, v4
    s_nop 1
    v_cndmask_b32 v76, v76, v12, vcc
    v_cmp_gt_i32 vcc, 9, v4
    s_nop 1
    v_cndmask_b32 v77, v77, v12, vcc
    v_cmp_gt_i32 vcc, 10, v4
    s_nop 1
    v_cndmask_b32 v78, v78, v12, vcc
    v_cmp_gt_i32 vcc, 11, v4
    s_nop 1
    v_cndmask_b32 v79, v79, v12, vcc
    v_cmp_gt_i32 vcc, 16, v4
    s_nop 1
    v_cndmask_b32 v80, v80, v12, vcc
    v_cmp_gt_i32 vcc, 17, v4
    s_nop 1
    v_cndmask_b32 v81, v81, v12, vcc
    v_cmp_gt_i32 vcc, 18, v4
    s_nop 1
    v_cndmask_b32 v82, v82, v12, vcc
    v_cmp_gt_i32 vcc, 19, v4
    s_nop 1
    v_cndmask_b32 v83, v83, v12, vcc
    v_cmp_gt_i32 vcc, 24, v4
    s_nop 1
    v_cndmask_b32 v84, v84, v12, vcc
    v_cmp_gt_i32 vcc, 25, v4
    s_nop 1
    v_cndmask_b32 v85, v85, v12, vcc
    v_cmp_gt_i32 vcc, 26, v4
    s_nop 1
    v_cndmask_b32 v86, v86, v12, vcc
    v_cmp_gt_i32 vcc, 27, v4
    s_nop 1
    v_cndmask_b32 v87, v87, v12, vcc
    v_max3_f32 v13, v72, v73, v74
    v_max3_f32 v13, v13, v75, v76
    v_max3_f32 v13, v13, v77, v78
    v_max3_f32 v13, v13, v79, v80
    v_max3_f32 v13, v13, v81, v82
    v_max3_f32 v13, v13, v83, v84
    v_max3_f32 v13, v13, v85, v86
    v_max_f32 v13, v13, v87
    s_waitcnt vmcnt(0)
    s_cmp_eq_u32 s37, 63
    s_cbranch_scc1 mega_kernel_x0_nopf
    v_cmp_gt_u32 vcc, 4, v6
    s_cbranch_vccz mega_kernel_x0_tf_ok
mega_kernel_x0_tf:
    buffer_load_dword v6, v8, s[32:35], s42 offen sc1
    s_waitcnt vmcnt(0)
    v_cmp_gt_u32 vcc, 4, v6
    s_cbranch_vccz mega_kernel_x0_tf_ok
    s_cmp_eq_u32 s38, 0
    s_cbranch_scc1 mega_kernel_x0_tf_ok
    s_sub_u32 s38, s38, 1
    s_sleep 1
    s_branch mega_kernel_x0_tf
mega_kernel_x0_tf_ok:
    s_add_u32 s47, s39, 262144
    s_add_u32 s48, s47, 4096
    s_add_u32 s49, s47, 33554432
    s_add_u32 s50, s49, 4096
    s_add_u32 s51, s47, 16777216
    s_add_u32 s52, s51, 4096
    buffer_load_dwordx4 a[32:35], v1, s[20:23], s47 offen offset:0 sc1
    buffer_load_dwordx4 a[0:3], v1, s[20:23], s49 offen offset:0 sc1
    buffer_load_dwordx4 a[36:39], v1, s[20:23], s47 offen offset:1024 sc1
    buffer_load_dwordx4 a[4:7], v1, s[20:23], s49 offen offset:1024 sc1
    buffer_load_dwordx4 a[40:43], v1, s[20:23], s47 offen offset:2048 sc1
    buffer_load_dwordx4 a[8:11], v1, s[20:23], s49 offen offset:2048 sc1
    buffer_load_dwordx4 a[44:47], v1, s[20:23], s47 offen offset:3072 sc1
    buffer_load_dwordx4 a[12:15], v1, s[20:23], s49 offen offset:3072 sc1
    buffer_load_dwordx4 a[48:51], v1, s[20:23], s48 offen offset:0 sc1
    buffer_load_dwordx4 a[16:19], v1, s[20:23], s50 offen offset:0 sc1
    buffer_load_dwordx4 a[52:55], v1, s[20:23], s48 offen offset:1024 sc1
    buffer_load_dwordx4 a[20:23], v1, s[20:23], s50 offen offset:1024 sc1
    buffer_load_dwordx4 a[56:59], v1, s[20:23], s48 offen offset:2048 sc1
    buffer_load_dwordx4 a[24:27], v1, s[20:23], s50 offen offset:2048 sc1
    buffer_load_dwordx4 a[60:63], v1, s[20:23], s48 offen offset:3072 sc1
    buffer_load_dwordx4 a[28:31], v1, s[20:23], s50 offen offset:3072 sc1
    buffer_load_dwordx4 a[96:99], v1, s[20:23], s51 offen offset:0 sc1
    buffer_load_dwordx4 a[100:103], v1, s[20:23], s51 offen offset:1024 sc1
    buffer_load_dwordx4 a[104:107], v1, s[20:23], s51 offen offset:2048 sc1
    buffer_load_dwordx4 a[108:111], v1, s[20:23], s51 offen offset:3072 sc1
    buffer_load_dwordx4 a[112:115], v1, s[20:23], s52 offen offset:0 sc1
    buffer_load_dwordx4 a[116:119], v1, s[20:23], s52 offen offset:1024 sc1
    buffer_load_dwordx4 a[120:123], v1, s[20:23], s52 offen offset:2048 sc1
    buffer_load_dwordx4 a[124:127], v1, s[20:23], s52 offen offset:3072 sc1
mega_kernel_x0_nopf:
    v_max3_f32 v13, v13, v88, v89
    v_max3_f32 v13, v13, v90, v91
    v_mov_b32 v14, v13
    s_nop 1
    v_permlane32_swap_b32 v14, v13
    v_max_f32 v13, v13, v14
    s_mov_b32 s46, 0x3e0293ee
    v_mul_f32 v13, s46, v13
    v_fma_f32 v72, v72, s46, -v13
    v_fma_f32 v73, v73, s46, -v13
    v_fma_f32 v74, v74, s46, -v13
    v_fma_f32 v75, v75, s46, -v13
    v_fma_f32 v76, v76, s46, -v13
    v_fma_f32 v77, v77, s46, -v13
    v_fma_f32 v78, v78, s46, -v13
    v_fma_f32 v79, v79, s46, -v13
    v_fma_f32 v80, v80, s46, -v13
    v_fma_f32 v81, v81, s46, -v13
    v_fma_f32 v82, v82, s46, -v13
    v_fma_f32 v83, v83, s46, -v13
    v_fma_f32 v84, v84, s46, -v13
    v_fma_f32 v85, v85, s46, -v13
    v_fma_f32 v86, v86, s46, -v13
    v_fma_f32 v87, v87, s46, -v13
    v_fma_f32 v88, v88, s46, -v13
    v_fma_f32 v89, v89, s46, -v13
    v_fma_f32 v90, v90, s46, -v13
    v_fma_f32 v91, v91, s46, -v13
    v_exp_f32 v72, v72
    v_exp_f32 v73, v73
    v_exp_f32 v74, v74
    v_exp_f32 v75, v75
    v_exp_f32 v76, v76
    v_exp_f32 v77, v77
    v_exp_f32 v78, v78
    v_exp_f32 v79, v79
    v_exp_f32 v80, v80
    v_exp_f32 v81, v81
    v_exp_f32 v82, v82
    v_exp_f32 v83, v83
    v_exp_f32 v84, v84
    v_exp_f32 v85, v85
    v_exp_f32 v86, v86
    v_exp_f32 v87, v87
    v_exp_f32 v88, v88
    v_exp_f32 v89, v89
    v_exp_f32 v90, v90
    v_exp_f32 v91, v91
    v_cvt_pk_bf16_f32 v168, v72, v73
    v_cvt_pk_bf16_f32 v169, v74, v75
    v_cvt_pk_bf16_f32 v170, v76, v77
    v_cvt_pk_bf16_f32 v171, v78, v79
    v_cvt_pk_bf16_f32 v172, v80, v81
    v_cvt_pk_bf16_f32 v173, v82, v83
    v_cvt_pk_bf16_f32 v174, v84, v85
    v_cvt_pk_bf16_f32 v175, v86, v87
    v_cvt_pk_bf16_f32 v176, v88, v89
    v_cvt_pk_bf16_f32 v177, v90, v91
    v_mfma_f32_32x32x16_bf16 v[104:119], a[64:67], v[168:171], 0
    v_mfma_f32_32x32x16_bf16 v[120:135], a[72:75], v[168:171], 0
    v_mfma_f32_32x32x16_bf16 v[136:151], a[80:83], v[168:171], 0
    v_mfma_f32_32x32x16_bf16 v[152:167], a[88:91], v[168:171], 0
    v_mfma_f32_32x32x16_bf16 v[104:119], a[68:71], v[172:175], v[104:119]
    v_mfma_f32_32x32x16_bf16 v[120:135], a[76:79], v[172:175], v[120:135]
    v_mfma_f32_32x32x16_bf16 v[136:151], a[84:87], v[172:175], v[136:151]
    v_mfma_f32_32x32x16_bf16 v[152:167], a[92:95], v[172:175], v[152:167]
    s_nop 6
    v_mfma_f32_32x32x8bf16_1k v[104:119], v[64:65], v[176:177], v[104:119]
    v_mfma_f32_32x32x8bf16_1k v[120:135], v[66:67], v[176:177], v[120:135]
    v_mfma_f32_32x32x8bf16_1k v[136:151], v[68:69], v[176:177], v[136:151]
    v_mfma_f32_32x32x8bf16_1k v[152:167], v[70:71], v[176:177], v[152:167]
    v_add_f32 v15, v72, v73
    v_add_f32 v15, v15, v74
    v_add_f32 v15, v15, v75
    v_add_f32 v15, v15, v76
    v_add_f32 v15, v15, v77
    v_add_f32 v15, v15, v78
    v_add_f32 v15, v15, v79
    v_add_f32 v15, v15, v80
    v_add_f32 v15, v15, v81
    v_add_f32 v15, v15, v82
    v_add_f32 v15, v15, v83
    v_add_f32 v15, v15, v84
    v_add_f32 v15, v15, v85
    v_add_f32 v15, v15, v86
    v_add_f32 v15, v15, v87
    v_add_f32 v15, v15, v88
    v_add_f32 v15, v15, v89
    v_add_f32 v15, v15, v90
    v_add_f32 v15, v15, v91
    v_mov_b32 v14, v15
    s_nop 1
    v_permlane32_swap_b32 v14, v15
    v_add_f32 v15, v15, v14
    v_rcp_f32 v15, v15
    s_add_u32 s46, s44, 4096
    v_mul_f32 v104, v104, v15
    v_mul_f32 v105, v105, v15
    v_mul_f32 v106, v106, v15
    v_mul_f32 v107, v107, v15
    v_mul_f32 v108, v108, v15
    v_mul_f32 v109, v109, v15
    v_mul_f32 v110, v110, v15
    v_mul_f32 v111, v111, v15
    v_mul_f32 v112, v112, v15
    v_mul_f32 v113, v113, v15
    v_mul_f32 v114, v114, v15
    v_mul_f32 v115, v115, v15
    v_mul_f32 v116, v116, v15
    v_mul_f32 v117, v117, v15
    v_mul_f32 v118, v118, v15
    v_mul_f32 v119, v119, v15
    v_cvt_pk_bf16_f32 v180, v104, v105
    v_cvt_pk_bf16_f32 v181, v106, v107
    v_cvt_pk_bf16_f32 v182, v108, v109
    v_cvt_pk_bf16_f32 v183, v110, v111
    v_cvt_pk_bf16_f32 v184, v112, v113
    v_cvt_pk_bf16_f32 v185, v114, v115
    v_cvt_pk_bf16_f32 v186, v116, v117
    v_cvt_pk_bf16_f32 v187, v118, v119
    buffer_store_dwordx4 v[180:183], v1, s[28:31], s44 offen offset:0 sc1
    buffer_store_dwordx4 v[184:187], v1, s[28:31], s44 offen offset:1024 sc1
    v_mul_f32 v120, v120, v15
    v_mul_f32 v121, v121, v15
    v_mul_f32 v122, v122, v15
    v_mul_f32 v123, v123, v15
    v_mul_f32 v124, v124, v15
    v_mul_f32 v125, v125, v15
    v_mul_f32 v126, v126, v15
    v_mul_f32 v127, v127, v15
    v_mul_f32 v128, v128, v15
    v_mul_f32 v129, v129, v15
    v_mul_f32 v130, v130, v15
    v_mul_f32 v131, v131, v15
    v_mul_f32 v132, v132, v15
    v_mul_f32 v133, v133, v15
    v_mul_f32 v134, v134, v15
    v_mul_f32 v135, v135, v15
    v_cvt_pk_bf16_f32 v188, v120, v121
    v_cvt_pk_bf16_f32 v189, v122, v123
    v_cvt_pk_bf16_f32 v190, v124, v125
    v_cvt_pk_bf16_f32 v191, v126, v127
    v_cvt_pk_bf16_f32 v192, v128, v129
    v_cvt_pk_bf16_f32 v193, v130, v131
    v_cvt_pk_bf16_f32 v194, v132, v133
    v_cvt_pk_bf16_f32 v195, v134, v135
    buffer_store_dwordx4 v[188:191], v1, s[28:31], s44 offen offset:2048 sc1
    buffer_store_dwordx4 v[192:195], v1, s[28:31], s44 offen offset:3072 sc1
    v_mul_f32 v136, v136, v15
    v_mul_f32 v137, v137, v15
    v_mul_f32 v138, v138, v15
    v_mul_f32 v139, v139, v15
    v_mul_f32 v140, v140, v15
    v_mul_f32 v141, v141, v15
    v_mul_f32 v142, v142, v15
    v_mul_f32 v143, v143, v15
    v_mul_f32 v144, v144, v15
    v_mul_f32 v145, v145, v15
    v_mul_f32 v146, v146, v15
    v_mul_f32 v147, v147, v15
    v_mul_f32 v148, v148, v15
    v_mul_f32 v149, v149, v15
    v_mul_f32 v150, v150, v15
    v_mul_f32 v151, v151, v15
    v_cvt_pk_bf16_f32 v180, v136, v137
    v_cvt_pk_bf16_f32 v181, v138, v139
    v_cvt_pk_bf16_f32 v182, v140, v141
    v_cvt_pk_bf16_f32 v183, v142, v143
    v_cvt_pk_bf16_f32 v184, v144, v145
    v_cvt_pk_bf16_f32 v185, v146, v147
    v_cvt_pk_bf16_f32 v186, v148, v149
    v_cvt_pk_bf16_f32 v187, v150, v151
    buffer_store_dwordx4 v[180:183], v1, s[28:31], s46 offen offset:0 sc1
    buffer_store_dwordx4 v[184:187], v1, s[28:31], s46 offen offset:1024 sc1
    v_mul_f32 v152, v152, v15
    v_mul_f32 v153, v153, v15
    v_mul_f32 v154, v154, v15
    v_mul_f32 v155, v155, v15
    v_mul_f32 v156, v156, v15
    v_mul_f32 v157, v157, v15
    v_mul_f32 v158, v158, v15
    v_mul_f32 v159, v159, v15
    v_mul_f32 v160, v160, v15
    v_mul_f32 v161, v161, v15
    v_mul_f32 v162, v162, v15
    v_mul_f32 v163, v163, v15
    v_mul_f32 v164, v164, v15
    v_mul_f32 v165, v165, v15
    v_mul_f32 v166, v166, v15
    v_mul_f32 v167, v167, v15
    v_cvt_pk_bf16_f32 v188, v152, v153
    v_cvt_pk_bf16_f32 v189, v154, v155
    v_cvt_pk_bf16_f32 v190, v156, v157
    v_cvt_pk_bf16_f32 v191, v158, v159
    v_cvt_pk_bf16_f32 v192, v160, v161
    v_cvt_pk_bf16_f32 v193, v162, v163
    v_cvt_pk_bf16_f32 v194, v164, v165
    v_cvt_pk_bf16_f32 v195, v166, v167
    buffer_store_dwordx4 v[188:191], v1, s[28:31], s46 offen offset:2048 sc1
    buffer_store_dwordx4 v[192:195], v1, s[28:31], s46 offen offset:3072 sc1
    s_cmp_eq_u32 s37, 63
    s_cbranch_scc1 mega_kernel_xfin
    s_add_u32 s37, s37, 1
mega_kernel_x1_top:
    s_lshl_b32 s39, s37, 18
    s_lshl_b32 s46, s36, 13
    s_add_u32 s39, s39, s46
    s_mov_b32 s44, s39
    s_lshr_b32 s40, s39, 2
    s_lshl_b32 s41, s37, 13
    s_lshl_b32 s46, s36, 4
    s_add_u32 s43, s41, s46
    s_add_u32 s43, s43, 16384
    s_lshl_b32 s46, s36, 5
    s_add_u32 s41, s41, s46
    s_add_u32 s41, s41, 17408
    v_cmp_eq_u32 vcc, 0, v5
    s_cbranch_vccnz mega_kernel_x1_B
    buffer_load_dwordx4 v[32:35], v2, s[24:27], s40 offen offset:0 sc1
    buffer_load_dwordx4 v[36:39], v2, s[24:27], s40 offen offset:256 sc1
    buffer_load_dwordx4 v[40:43], v2, s[24:27], s40 offen offset:512 sc1
    buffer_load_dwordx4 v[44:47], v2, s[24:27], s40 offen offset:768 sc1
    buffer_load_dwordx4 v[48:51], v2, s[24:27], s40 offen offset:1024 sc1
    buffer_load_dwordx4 v[52:55], v2, s[24:27], s40 offen offset:1280 sc1
    buffer_load_dwordx4 v[56:59], v2, s[24:27], s40 offen offset:1536 sc1
    buffer_load_dwordx4 v[60:63], v2, s[24:27], s40 offen offset:1792 sc1
    buffer_load_dwordx2 v[64:65], v3, s[24:27], s40 offen offset:0 sc1
    buffer_load_dwordx2 v[66:67], v3, s[24:27], s40 offen offset:512 sc1
    buffer_load_dwordx2 v[68:69], v3, s[24:27], s40 offen offset:1024 sc1
    buffer_load_dwordx2 v[70:71], v3, s[24:27], s40 offen offset:1536 sc1
    s_add_u32 s46, s41, 8192
    buffer_load_dword v5, v7, s[32:35], s46 offen sc1
    s_add_u32 s46, s37, 1
    s_lshr_b32 s46, s46, 2
    s_lshl_b32 s46, s46, 10
    s_lshr_b32 s42, s36, 1
    s_lshl_b32 s42, s42, 6
    s_add_u32 s42, s42, s46
    buffer_load_dword v6, v8, s[32:35], s42 offen sc1
    s_waitcnt vmcnt(22)
    v_mfma_f32_32x32x16_bf16 v[72:87], a[32:35], a[0:3], 0
    v_mfma_f32_32x32x16_bf16 v[72:87], a[36:39], a[4:7], v[72:87]
    v_mfma_f32_32x32x16_bf16 v[72:87], a[40:43], a[8:11], v[72:87]
    v_mfma_f32_32x32x16_bf16 v[72:87], a[44:47], a[12:15], v[72:87]
    v_mfma_f32_32x32x16_bf16 v[72:87], a[48:51], a[16:19], v[72:87]
    v_mfma_f32_32x32x16_bf16 v[72:87], a[52:55], a[20:23], v[72:87]
    v_mfma_f32_32x32x16_bf16 v[72:87], a[56:59], a[24:27], v[72:87]
    v_mfma_f32_32x32x16_bf16 v[72:87], a[60:63], a[28:31], v[72:87]
    s_waitcnt vmcnt(14)
    s_cmp_eq_u32 s37, 0
    s_cbranch_scc1 mega_kernel_x1_fa
    s_sub_u32 s46, s43, 8192
    s_mov_b64 exec, 1
    buffer_store_dword v9, off, s[32:35], s46 sc1
    s_mov_b64 exec, -1
mega_kernel_x1_fa:
    s_nop 3
    s_branch mega_kernel_x1_J
mega_kernel_x1_B:
    s_waitcnt vmcnt(0)
    s_cmp_eq_u32 s37, 0
    s_cbranch_scc1 mega_kernel_x1_fb
    s_sub_u32 s46, s43, 8192
    s_mov_b64 exec, 1
    buffer_store_dword v9, off, s[32:35], s46 sc1
    s_mov_b64 exec, -1
mega_kernel_x1_fb:
    s_nop 3
    v_mfma_f32_32x32x16_bf16 v[72:87], a[32:35], a[0:3], 0
    v_mfma_f32_32x32x16_bf16 v[72:87], a[36:39], a[4:7], v[72:87]
    v_mfma_f32_32x32x16_bf16 v[72:87], a[40:43], a[8:11], v[72:87]
    v_mfma_f32_32x32x16_bf16 v[72:87], a[44:47], a[12:15], v[72:87]
    v_mfma_f32_32x32x16_bf16 v[72:87], a[48:51], a[16:19], v[72:87]
    v_mfma_f32_32x32x16_bf16 v[72:87], a[52:55], a[20:23], v[72:87]
    v_mfma_f32_32x32x16_bf16 v[72:87], a[56:59], a[24:27], v[72:87]
    v_mfma_f32_32x32x16_bf16 v[72:87], a[60:63], a[28:31], v[72:87]
mega_kernel_x1_pc:
    buffer_load_dword v5, v7, s[32:35], s41 offen sc1
    s_waitcnt vmcnt(0)
    v_cmp_eq_u32 vcc, 0, v5
    s_cbranch_vccz mega_kernel_x1_pc_ok
    s_cmp_eq_u32 s38, 0
    s_cbranch_scc1 mega_kernel_x1_pc_ok
    s_sub_u32 s38, s38, 1
    s_sleep 1
    s_branch mega_kernel_x1_pc
mega_kernel_x1_pc_ok:
    buffer_load_dwordx4 v[32:35], v2, s[24:27], s40 offen offset:0 sc1
    buffer_load_dwordx4 v[36:39], v2, s[24:27], s40 offen offset:256 sc1
    buffer_load_dwordx4 v[40:43], v2, s[24:27], s40 offen offset:512 sc1
    buffer_load_dwordx4 v[44:47], v2, s[24:27], s40 offen offset:768 sc1
    buffer_load_dwordx4 v[48:51], v2, s[24:27], s40 offen offset:1024 sc1
    buffer_load_dwordx4 v[52:55], v2, s[24:27], s40 offen offset:1280 sc1
    buffer_load_dwordx4 v[56:59], v2, s[24:27], s40 offen offset:1536 sc1
    buffer_load_dwordx4 v[60:63], v2, s[24:27], s40 offen offset:1792 sc1
    buffer_load_dwordx2 v[64:65], v3, s[24:27], s40 offen offset:0 sc1
    buffer_load_dwordx2 v[66:67], v3, s[24:27], s40 offen offset:512 sc1
    buffer_load_dwordx2 v[68:69], v3, s[24:27], s40 offen offset:1024 sc1
    buffer_load_dwordx2 v[70:71], v3, s[24:27], s40 offen offset:1536 sc1
    s_add_u32 s46, s41, 8192
    buffer_load_dword v5, v7, s[32:35], s46 offen sc1
    s_add_u32 s46, s37, 1
    s_lshr_b32 s46, s46, 2
    s_lshl_b32 s46, s46, 10
    s_lshr_b32 s42, s36, 1
    s_lshl_b32 s42, s42, 6
    s_add_u32 s42, s42, s46
    buffer_load_dword v6, v8, s[32:35], s42 offen sc1
mega_kernel_x1_J:
    s_waitcnt vmcnt(13)
    v_mfma_f32_32x32x16_bf16 v[88:103], v[32:35], a[0:3], 0
    s_waitcnt vmcnt(12)
    v_mfma_f32_32x32x16_bf16 v[88:103], v[36:39], a[4:7], v[88:103]
    s_waitcnt vmcnt(11)
    v_mfma_f32_32x32x16_bf16 v[88:103], v[40:43], a[8:11], v[88:103]
    s_waitcnt vmcnt(10)
    v_mfma_f32_32x32x16_bf16 v[88:103], v[44:47], a[12:15], v[88:103]
    s_waitcnt vmcnt(9)
    v_mfma_f32_32x32x16_bf16 v[88:103], v[48:51], a[16:19], v[88:103]
    s_waitcnt vmcnt(8)
    v_mfma_f32_32x32x16_bf16 v[88:103], v[52:55], a[20:23], v[88:103]
    s_waitcnt vmcnt(7)
    v_mfma_f32_32x32x16_bf16 v[88:103], v[56:59], a[24:27], v[88:103]
    s_waitcnt vmcnt(6)
    v_mfma_f32_32x32x16_bf16 v[88:103], v[60:63], a[28:31], v[88:103]
    v_mov_b32 v12, 0xd028965f
    v_cmp_gt_i32 vcc, 0, v4
    s_nop 1
    v_cndmask_b32 v72, v72, v12, vcc
    v_cmp_gt_i32 vcc, 1, v4
    s_nop 1
    v_cndmask_b32 v73, v73, v12, vcc
    v_cmp_gt_i32 vcc, 2, v4
    s_nop 1
    v_cndmask_b32 v74, v74, v12, vcc
    v_cmp_gt_i32 vcc, 3, v4
    s_nop 1
    v_cndmask_b32 v75, v75, v12, vcc
    v_cmp_gt_i32 vcc, 8, v4
    s_nop 1
    v_cndmask_b32 v76, v76, v12, vcc
    v_cmp_gt_i32 vcc, 9, v4
    s_nop 1
    v_cndmask_b32 v77, v77, v12, vcc
    v_cmp_gt_i32 vcc, 10, v4
    s_nop 1
    v_cndmask_b32 v78, v78, v12, vcc
    v_cmp_gt_i32 vcc, 11, v4
    s_nop 1
    v_cndmask_b32 v79, v79, v12, vcc
    v_cmp_gt_i32 vcc, 16, v4
    s_nop 1
    v_cndmask_b32 v80, v80, v12, vcc
    v_cmp_gt_i32 vcc, 17, v4
    s_nop 1
    v_cndmask_b32 v81, v81, v12, vcc
    v_cmp_gt_i32 vcc, 18, v4
    s_nop 1
    v_cndmask_b32 v82, v82, v12, vcc
    v_cmp_gt_i32 vcc, 19, v4
    s_nop 1
    v_cndmask_b32 v83, v83, v12, vcc
    v_cmp_gt_i32 vcc, 24, v4
    s_nop 1
    v_cndmask_b32 v84, v84, v12, vcc
    v_cmp_gt_i32 vcc, 25, v4
    s_nop 1
    v_cndmask_b32 v85, v85, v12, vcc
    v_cmp_gt_i32 vcc, 26, v4
    s_nop 1
    v_cndmask_b32 v86, v86, v12, vcc
    v_cmp_gt_i32 vcc, 27, v4
    s_nop 1
    v_cndmask_b32 v87, v87, v12, vcc
    v_max3_f32 v13, v72, v73, v74
    v_max3_f32 v13, v13, v75, v76
    v_max3_f32 v13, v13, v77, v78
    v_max3_f32 v13, v13, v79, v80
    v_max3_f32 v13, v13, v81, v82
    v_max3_f32 v13, v13, v83, v84
    v_max3_f32 v13, v13, v85, v86
    v_max_f32 v13, v13, v87
    s_waitcnt vmcnt(0)
    s_cmp_eq_u32 s37, 63
    s_cbranch_scc1 mega_kernel_x1_nopf
    v_cmp_gt_u32 vcc, 4, v6
    s_cbranch_vccz mega_kernel_x1_tf_ok
mega_kernel_x1_tf:
    buffer_load_dword v6, v8, s[32:35], s42 offen sc1
    s_waitcnt vmcnt(0)
    v_cmp_gt_u32 vcc, 4, v6
    s_cbranch_vccz mega_kernel_x1_tf_ok
    s_cmp_eq_u32 s38, 0
    s_cbranch_scc1 mega_kernel_x1_tf_ok
    s_sub_u32 s38, s38, 1
    s_sleep 1
    s_branch mega_kernel_x1_tf
mega_kernel_x1_tf_ok:
    s_add_u32 s47, s39, 262144
    s_add_u32 s48, s47, 4096
    s_add_u32 s49, s47, 33554432
    s_add_u32 s50, s49, 4096
    s_add_u32 s51, s47, 16777216
    s_add_u32 s52, s51, 4096
    buffer_load_dwordx4 a[32:35], v1, s[20:23], s47 offen offset:0 sc1
    buffer_load_dwordx4 a[0:3], v1, s[20:23], s49 offen offset:0 sc1
    buffer_load_dwordx4 a[36:39], v1, s[20:23], s47 offen offset:1024 sc1
    buffer_load_dwordx4 a[4:7], v1, s[20:23], s49 offen offset:1024 sc1
    buffer_load_dwordx4 a[40:43], v1, s[20:23], s47 offen offset:2048 sc1
    buffer_load_dwordx4 a[8:11], v1, s[20:23], s49 offen offset:2048 sc1
    buffer_load_dwordx4 a[44:47], v1, s[20:23], s47 offen offset:3072 sc1
    buffer_load_dwordx4 a[12:15], v1, s[20:23], s49 offen offset:3072 sc1
    buffer_load_dwordx4 a[48:51], v1, s[20:23], s48 offen offset:0 sc1
    buffer_load_dwordx4 a[16:19], v1, s[20:23], s50 offen offset:0 sc1
    buffer_load_dwordx4 a[52:55], v1, s[20:23], s48 offen offset:1024 sc1
    buffer_load_dwordx4 a[20:23], v1, s[20:23], s50 offen offset:1024 sc1
    buffer_load_dwordx4 a[56:59], v1, s[20:23], s48 offen offset:2048 sc1
    buffer_load_dwordx4 a[24:27], v1, s[20:23], s50 offen offset:2048 sc1
    buffer_load_dwordx4 a[60:63], v1, s[20:23], s48 offen offset:3072 sc1
    buffer_load_dwordx4 a[28:31], v1, s[20:23], s50 offen offset:3072 sc1
    buffer_load_dwordx4 a[64:67], v1, s[20:23], s51 offen offset:0 sc1
    buffer_load_dwordx4 a[68:71], v1, s[20:23], s51 offen offset:1024 sc1
    buffer_load_dwordx4 a[72:75], v1, s[20:23], s51 offen offset:2048 sc1
    buffer_load_dwordx4 a[76:79], v1, s[20:23], s51 offen offset:3072 sc1
    buffer_load_dwordx4 a[80:83], v1, s[20:23], s52 offen offset:0 sc1
    buffer_load_dwordx4 a[84:87], v1, s[20:23], s52 offen offset:1024 sc1
    buffer_load_dwordx4 a[88:91], v1, s[20:23], s52 offen offset:2048 sc1
    buffer_load_dwordx4 a[92:95], v1, s[20:23], s52 offen offset:3072 sc1
mega_kernel_x1_nopf:
    v_max3_f32 v13, v13, v88, v89
    v_max3_f32 v13, v13, v90, v91
    v_mov_b32 v14, v13
    s_nop 1
    v_permlane32_swap_b32 v14, v13
    v_max_f32 v13, v13, v14
    s_mov_b32 s46, 0x3e0293ee
    v_mul_f32 v13, s46, v13
    v_fma_f32 v72, v72, s46, -v13
    v_fma_f32 v73, v73, s46, -v13
    v_fma_f32 v74, v74, s46, -v13
    v_fma_f32 v75, v75, s46, -v13
    v_fma_f32 v76, v76, s46, -v13
    v_fma_f32 v77, v77, s46, -v13
    v_fma_f32 v78, v78, s46, -v13
    v_fma_f32 v79, v79, s46, -v13
    v_fma_f32 v80, v80, s46, -v13
    v_fma_f32 v81, v81, s46, -v13
    v_fma_f32 v82, v82, s46, -v13
    v_fma_f32 v83, v83, s46, -v13
    v_fma_f32 v84, v84, s46, -v13
    v_fma_f32 v85, v85, s46, -v13
    v_fma_f32 v86, v86, s46, -v13
    v_fma_f32 v87, v87, s46, -v13
    v_fma_f32 v88, v88, s46, -v13
    v_fma_f32 v89, v89, s46, -v13
    v_fma_f32 v90, v90, s46, -v13
    v_fma_f32 v91, v91, s46, -v13
    v_exp_f32 v72, v72
    v_exp_f32 v73, v73
    v_exp_f32 v74, v74
    v_exp_f32 v75, v75
    v_exp_f32 v76, v76
    v_exp_f32 v77, v77
    v_exp_f32 v78, v78
    v_exp_f32 v79, v79
    v_exp_f32 v80, v80
    v_exp_f32 v81, v81
    v_exp_f32 v82, v82
    v_exp_f32 v83, v83
    v_exp_f32 v84, v84
    v_exp_f32 v85, v85
    v_exp_f32 v86, v86
    v_exp_f32 v87, v87
    v_exp_f32 v88, v88
    v_exp_f32 v89, v89
    v_exp_f32 v90, v90
    v_exp_f32 v91, v91
    v_cvt_pk_bf16_f32 v168, v72, v73
    v_cvt_pk_bf16_f32 v169, v74, v75
    v_cvt_pk_bf16_f32 v170, v76, v77
    v_cvt_pk_bf16_f32 v171, v78, v79
    v_cvt_pk_bf16_f32 v172, v80, v81
    v_cvt_pk_bf16_f32 v173, v82, v83
    v_cvt_pk_bf16_f32 v174, v84, v85
    v_cvt_pk_bf16_f32 v175, v86, v87
    v_cvt_pk_bf16_f32 v176, v88, v89
    v_cvt_pk_bf16_f32 v177, v90, v91
    v_mfma_f32_32x32x16_bf16 v[104:119], a[96:99], v[168:171], 0
    v_mfma_f32_32x32x16_bf16 v[120:135], a[104:107], v[168:171], 0
    v_mfma_f32_32x32x16_bf16 v[136:151], a[112:115], v[168:171], 0
    v_mfma_f32_32x32x16_bf16 v[152:167], a[120:123], v[168:171], 0
    v_mfma_f32_32x32x16_bf16 v[104:119], a[100:103], v[172:175], v[104:119]
    v_mfma_f32_32x32x16_bf16 v[120:135], a[108:111], v[172:175], v[120:135]
    v_mfma_f32_32x32x16_bf16 v[136:151], a[116:119], v[172:175], v[136:151]
    v_mfma_f32_32x32x16_bf16 v[152:167], a[124:127], v[172:175], v[152:167]
    s_nop 6
    v_mfma_f32_32x32x8bf16_1k v[104:119], v[64:65], v[176:177], v[104:119]
    v_mfma_f32_32x32x8bf16_1k v[120:135], v[66:67], v[176:177], v[120:135]
    v_mfma_f32_32x32x8bf16_1k v[136:151], v[68:69], v[176:177], v[136:151]
    v_mfma_f32_32x32x8bf16_1k v[152:167], v[70:71], v[176:177], v[152:167]
    v_add_f32 v15, v72, v73
    v_add_f32 v15, v15, v74
    v_add_f32 v15, v15, v75
    v_add_f32 v15, v15, v76
    v_add_f32 v15, v15, v77
    v_add_f32 v15, v15, v78
    v_add_f32 v15, v15, v79
    v_add_f32 v15, v15, v80
    v_add_f32 v15, v15, v81
    v_add_f32 v15, v15, v82
    v_add_f32 v15, v15, v83
    v_add_f32 v15, v15, v84
    v_add_f32 v15, v15, v85
    v_add_f32 v15, v15, v86
    v_add_f32 v15, v15, v87
    v_add_f32 v15, v15, v88
    v_add_f32 v15, v15, v89
    v_add_f32 v15, v15, v90
    v_add_f32 v15, v15, v91
    v_mov_b32 v14, v15
    s_nop 1
    v_permlane32_swap_b32 v14, v15
    v_add_f32 v15, v15, v14
    v_rcp_f32 v15, v15
    s_add_u32 s46, s44, 4096
    v_mul_f32 v104, v104, v15
    v_mul_f32 v105, v105, v15
    v_mul_f32 v106, v106, v15
    v_mul_f32 v107, v107, v15
    v_mul_f32 v108, v108, v15
    v_mul_f32 v109, v109, v15
    v_mul_f32 v110, v110, v15
    v_mul_f32 v111, v111, v15
    v_mul_f32 v112, v112, v15
    v_mul_f32 v113, v113, v15
    v_mul_f32 v114, v114, v15
    v_mul_f32 v115, v115, v15
    v_mul_f32 v116, v116, v15
    v_mul_f32 v117, v117, v15
    v_mul_f32 v118, v118, v15
    v_mul_f32 v119, v119, v15
    v_cvt_pk_bf16_f32 v180, v104, v105
    v_cvt_pk_bf16_f32 v181, v106, v107
    v_cvt_pk_bf16_f32 v182, v108, v109
    v_cvt_pk_bf16_f32 v183, v110, v111
    v_cvt_pk_bf16_f32 v184, v112, v113
    v_cvt_pk_bf16_f32 v185, v114, v115
    v_cvt_pk_bf16_f32 v186, v116, v117
    v_cvt_pk_bf16_f32 v187, v118, v119
    buffer_store_dwordx4 v[180:183], v1, s[28:31], s44 offen offset:0 sc1
    buffer_store_dwordx4 v[184:187], v1, s[28:31], s44 offen offset:1024 sc1
    v_mul_f32 v120, v120, v15
    v_mul_f32 v121, v121, v15
    v_mul_f32 v122, v122, v15
    v_mul_f32 v123, v123, v15
    v_mul_f32 v124, v124, v15
    v_mul_f32 v125, v125, v15
    v_mul_f32 v126, v126, v15
    v_mul_f32 v127, v127, v15
    v_mul_f32 v128, v128, v15
    v_mul_f32 v129, v129, v15
    v_mul_f32 v130, v130, v15
    v_mul_f32 v131, v131, v15
    v_mul_f32 v132, v132, v15
    v_mul_f32 v133, v133, v15
    v_mul_f32 v134, v134, v15
    v_mul_f32 v135, v135, v15
    v_cvt_pk_bf16_f32 v188, v120, v121
    v_cvt_pk_bf16_f32 v189, v122, v123
    v_cvt_pk_bf16_f32 v190, v124, v125
    v_cvt_pk_bf16_f32 v191, v126, v127
    v_cvt_pk_bf16_f32 v192, v128, v129
    v_cvt_pk_bf16_f32 v193, v130, v131
    v_cvt_pk_bf16_f32 v194, v132, v133
    v_cvt_pk_bf16_f32 v195, v134, v135
    buffer_store_dwordx4 v[188:191], v1, s[28:31], s44 offen offset:2048 sc1
    buffer_store_dwordx4 v[192:195], v1, s[28:31], s44 offen offset:3072 sc1
    v_mul_f32 v136, v136, v15
    v_mul_f32 v137, v137, v15
    v_mul_f32 v138, v138, v15
    v_mul_f32 v139, v139, v15
    v_mul_f32 v140, v140, v15
    v_mul_f32 v141, v141, v15
    v_mul_f32 v142, v142, v15
    v_mul_f32 v143, v143, v15
    v_mul_f32 v144, v144, v15
    v_mul_f32 v145, v145, v15
    v_mul_f32 v146, v146, v15
    v_mul_f32 v147, v147, v15
    v_mul_f32 v148, v148, v15
    v_mul_f32 v149, v149, v15
    v_mul_f32 v150, v150, v15
    v_mul_f32 v151, v151, v15
    v_cvt_pk_bf16_f32 v180, v136, v137
    v_cvt_pk_bf16_f32 v181, v138, v139
    v_cvt_pk_bf16_f32 v182, v140, v141
    v_cvt_pk_bf16_f32 v183, v142, v143
    v_cvt_pk_bf16_f32 v184, v144, v145
    v_cvt_pk_bf16_f32 v185, v146, v147
    v_cvt_pk_bf16_f32 v186, v148, v149
    v_cvt_pk_bf16_f32 v187, v150, v151
    buffer_store_dwordx4 v[180:183], v1, s[28:31], s46 offen offset:0 sc1
    buffer_store_dwordx4 v[184:187], v1, s[28:31], s46 offen offset:1024 sc1
    v_mul_f32 v152, v152, v15
    v_mul_f32 v153, v153, v15
    v_mul_f32 v154, v154, v15
    v_mul_f32 v155, v155, v15
    v_mul_f32 v156, v156, v15
    v_mul_f32 v157, v157, v15
    v_mul_f32 v158, v158, v15
    v_mul_f32 v159, v159, v15
    v_mul_f32 v160, v160, v15
    v_mul_f32 v161, v161, v15
    v_mul_f32 v162, v162, v15
    v_mul_f32 v163, v163, v15
    v_mul_f32 v164, v164, v15
    v_mul_f32 v165, v165, v15
    v_mul_f32 v166, v166, v15
    v_mul_f32 v167, v167, v15
    v_cvt_pk_bf16_f32 v188, v152, v153
    v_cvt_pk_bf16_f32 v189, v154, v155
    v_cvt_pk_bf16_f32 v190, v156, v157
    v_cvt_pk_bf16_f32 v191, v158, v159
    v_cvt_pk_bf16_f32 v192, v160, v161
    v_cvt_pk_bf16_f32 v193, v162, v163
    v_cvt_pk_bf16_f32 v194, v164, v165
    v_cvt_pk_bf16_f32 v195, v166, v167
    buffer_store_dwordx4 v[188:191], v1, s[28:31], s46 offen offset:2048 sc1
    buffer_store_dwordx4 v[192:195], v1, s[28:31], s46 offen offset:3072 sc1
    s_cmp_eq_u32 s37, 63
    s_cbranch_scc1 mega_kernel_xfin
    s_add_u32 s37, s37, 1
    s_branch mega_kernel_xloop
mega_kernel_xfin:
    s_waitcnt vmcnt(0)
    s_mov_b64 exec, 1
    buffer_store_dword v9, off, s[32:35], s43 sc1
    s_mov_b64 exec, -1
    s_waitcnt vmcnt(0)
    s_branch mega_kernel_exit
mega_kernel_toD:
    s_sub_u32 s63, s61, 160
    s_load_dwordx2 s[4:5], s[0:1], 104
    s_load_dwordx2 s[6:7], s[0:1], 80
    s_waitcnt lgkmcnt(0)
    s_mov_b32 s20, s6
    s_mov_b32 s21, s7
    s_mov_b32 s22, 7340032
    s_mov_b32 s23, 0x20000
    s_add_u32 s28, s4, 83886080
    s_addc_u32 s29, s5, 0
    s_mov_b32 s30, 14680064
    s_mov_b32 s31, 0x20000
    s_add_u32 s32, s4, 132382720
    s_addc_u32 s33, s5, 0
    s_mov_b32 s34, 33554432
    s_mov_b32 s35, 0x20000
    s_add_u32 s36, s4, 169607168
    s_addc_u32 s37, s5, 0
    s_mov_b32 s38, 548864
    s_mov_b32 s39, 0x20000
    s_and_b32 s56, s63, 7
    s_lshr_b32 s57, s63, 3
    s_mul_i32 s64, s57, 896
    s_mul_i32 s58, s62, 224
    s_add_u32 s64, s64, s58
    s_lshl_b32 s65, s56, 8
    s_lshl_b32 s46, s64, 6
    s_lshl_b32 s68, s56, 16
    s_lshl_b32 s58, s62, 14
    s_add_u32 s68, s68, s58
    s_lshl_b32 s58, s57, 12
    s_add_u32 s68, s68, s58
    s_lshr_b32 s67, s68, 8
    s_add_u32 s67, s67, 20480
    s_lshr_b32 s66, s64, 1
    s_add_u32 s66, s66, 22528
    v_and_b32 v224, 63, v0
    v_lshlrev_b32 v1, 4, v224
    v_min_u32 v2, 13, v224
    v_lshlrev_b32 v2, 3, v2
    v_lshrrev_b32 v225, 3, v224
    v_lshrrev_b32 v226, 4, v224
    v_and_b32 v226, 1, v226
    v_lshlrev_b32 v226, 2, v226
    v_and_b32 v227, 7, v224
    v_xor_b32 v226, v226, v227
    v_mul_u32_u24 v225, 2048, v225
    v_lshl_add_u32 v6, v226, 4, v225
    v_lshrrev_b32 v225, 5, v224
    v_lshrrev_b32 v226, 2, v224
    v_and_b32 v226, 3, v226
    v_lshl_add_u32 v225, v225, 2, v226
    v_lshlrev_b32 v225, 7, v225
    v_lshrrev_b32 v227, 4, v224
    v_and_b32 v227, 1, v227
    v_lshl_add_u32 v225, v227, 5, v225
    v_and_b32 v227, 3, v224
    v_lshl_add_u32 v225, v227, 3, v225
    s_lshl_b32 s56, s62, 15
    v_add_u32 v225, s56, v225
    v_lshrrev_b32 v226, 1, v226
    v_lshl_add_u32 v4, v226, 6, v225
    v_xor_b32 v5, 64, v4
    s_lshl_b32 s56, s62, 14
    v_add_u32 v7, s56, v1
    v_add_u32 v8, 0x10000, v7
    s_lshl_b32 s56, s62, 12
    v_add_u32 v9, s56, v1
    v_add_u32 v10, 0x10000, v9
    v_lshrrev_b32 v225, 5, v224
    v_lshrrev_b32 v226, 2, v224
    v_and_b32 v226, 3, v226
    v_lshl_add_u32 v225, v225, 2, v226
    v_lshlrev_b32 v225, 7, v225
    v_lshrrev_b32 v227, 4, v224
    v_and_b32 v227, 1, v227
    v_lshl_add_u32 v225, v227, 5, v225
    v_and_b32 v227, 3, v224
    v_lshl_add_u32 v225, v227, 3, v225
    s_lshl_b32 s56, s62, 15
    v_add_u32 v225, s56, v225
    v_lshrrev_b32 v226, 1, v226
    v_lshlrev_b32 v226, 6, v226
    s_add_u32 s56, s62, 1
    s_and_b32 s56, s56, 3
    s_and_b32 s57, s56, 1
    s_lshl_b32 s57, s57, 6
    s_lshr_b32 s58, s56, 1
    s_lshl_b32 s58, s58, 13
    s_add_u32 s57, s57, s58
    v_xor_b32 v228, s57, v226
    v_add_u32 v228, v228, v225
    s_add_u32 s56, s62, 2
    s_and_b32 s56, s56, 3
    s_and_b32 s57, s56, 1
    s_lshl_b32 s57, s57, 6
    s_lshr_b32 s58, s56, 1
    s_lshl_b32 s58, s58, 13
    s_add_u32 s57, s57, s58
    v_xor_b32 v229, s57, v226
    v_add_u32 v229, v229, v225
    s_add_u32 s56, s62, 3
    s_and_b32 s56, s56, 3
    s_and_b32 s57, s56, 1
    s_lshl_b32 s57, s57, 6
    s_lshr_b32 s58, s56, 1
    s_lshl_b32 s58, s58, 13
    s_add_u32 s57, s57, s58
    v_xor_b32 v230, s57, v226
    v_add_u32 v230, v230, v225
    s_add_u32 s56, s62, 4
    s_and_b32 s56, s56, 3
    s_and_b32 s57, s56, 1
    s_lshl_b32 s57, s57, 6
    s_lshr_b32 s58, s56, 1
    s_lshl_b32 s58, s58, 13
    s_add_u32 s57, s57, s58
    v_xor_b32 v231, s57, v226
    v_add_u32 v231, v231, v225
    s_lshl_b32 s56, s62, 14
    v_add_u32 v7, s56, v1
    s_add_u32 s56, s62, 1
    s_and_b32 s56, s56, 3
    s_lshl_b32 s56, s56, 14
    s_add_u32 s56, s56, 8192
    v_add_u32 v8, s56, v1
    s_add_u32 s56, s62, 2
    s_and_b32 s56, s56, 3
    s_lshl_b32 s56, s56, 14
    s_add_u32 s56, s56, 4096
    v_add_u32 v9, s56, v1
    s_add_u32 s56, s62, 3
    s_and_b32 s56, s56, 3
    s_lshl_b32 s56, s56, 14
    s_add_u32 s56, s56, 0
    v_add_u32 v10, s56, v1
    v_mov_b32 v14, 1
    s_lshl_b32 s56, s62, 15
    s_add_u32 s56, s56, 0
    s_add_u32 s57, s64, 0
    s_mul_i32 s57, s57, 2048
    s_add_u32 s57, s57, s65
    s_add_u32 m0, s56, 0
    s_nop 0
    buffer_load_dwordx4 v6, s[20:23], s57 offen offset:0 lds
    s_add_u32 m0, s56, 8064
    s_nop 0
    buffer_load_dwordx4 v6, s[20:23], s57 offen offset:128 lds
    s_add_u32 s57, s57, 16384
    s_add_u32 m0, s56, 1024
    s_nop 0
    buffer_load_dwordx4 v6, s[20:23], s57 offen offset:0 lds
    s_add_u32 m0, s56, 9088
    s_nop 0
    buffer_load_dwordx4 v6, s[20:23], s57 offen offset:128 lds
    s_add_u32 s57, s57, 16384
    s_add_u32 m0, s56, 2048
    s_nop 0
    buffer_load_dwordx4 v6, s[20:23], s57 offen offset:0 lds
    s_add_u32 m0, s56, 10112
    s_nop 0
    buffer_load_dwordx4 v6, s[20:23], s57 offen offset:128 lds
    s_add_u32 s57, s57, 16384
    s_add_u32 m0, s56, 3072
    s_nop 0
    buffer_load_dwordx4 v6, s[20:23], s57 offen offset:0 lds
    s_add_u32 m0, s56, 11136
    s_nop 0
    buffer_load_dwordx4 v6, s[20:23], s57 offen offset:128 lds
    s_add_u32 s57, s57, 16384
    s_add_u32 m0, s56, 4096
    s_nop 0
    buffer_load_dwordx4 v6, s[20:23], s57 offen offset:0 lds
    s_add_u32 m0, s56, 12160
    s_nop 0
    buffer_load_dwordx4 v6, s[20:23], s57 offen offset:128 lds
    s_add_u32 s57, s57, 16384
    s_add_u32 m0, s56, 5120
    s_nop 0
    buffer_load_dwordx4 v6, s[20:23], s57 offen offset:0 lds
    s_add_u32 m0, s56, 13184
    s_nop 0
    buffer_load_dwordx4 v6, s[20:23], s57 offen offset:128 lds
    s_add_u32 s57, s57, 16384
    s_add_u32 m0, s56, 6144
    s_nop 0
    buffer_load_dwordx4 v6, s[20:23], s57 offen offset:0 lds
    s_add_u32 m0, s56, 14208
    s_nop 0
    buffer_load_dwordx4 v6, s[20:23], s57 offen offset:128 lds
    s_add_u32 s57, s57, 16384
    s_add_u32 m0, s56, 7168
    s_nop 0
    buffer_load_dwordx4 v6, s[20:23], s57 offen offset:0 lds
    s_add_u32 m0, s56, 15232
    s_nop 0
    buffer_load_dwordx4 v6, s[20:23], s57 offen offset:128 lds
    s_lshl_b32 s56, s62, 15
    s_add_u32 s56, s56, 16384
    s_add_u32 s57, s64, 64
    s_mul_i32 s57, s57, 2048
    s_add_u32 s57, s57, s65
    s_add_u32 m0, s56, 0
    s_nop 0
    buffer_load_dwordx4 v6, s[20:23], s57 offen offset:0 lds
    s_add_u32 m0, s56, 8064
    s_nop 0
    buffer_load_dwordx4 v6, s[20:23], s57 offen offset:128 lds
    s_add_u32 s57, s57, 16384
    s_add_u32 m0, s56, 1024
    s_nop 0
    buffer_load_dwordx4 v6, s[20:23], s57 offen offset:0 lds
    s_add_u32 m0, s56, 9088
    s_nop 0
    buffer_load_dwordx4 v6, s[20:23], s57 offen offset:128 lds
    s_add_u32 s57, s57, 16384
    s_add_u32 m0, s56, 2048
    s_nop 0
    buffer_load_dwordx4 v6, s[20:23], s57 offen offset:0 lds
    s_add_u32 m0, s56, 10112
    s_nop 0
    buffer_load_dwordx4 v6, s[20:23], s57 offen offset:128 lds
    s_add_u32 s57, s57, 16384
    s_add_u32 m0, s56, 3072
    s_nop 0
    buffer_load_dwordx4 v6, s[20:23], s57 offen offset:0 lds
    s_add_u32 m0, s56, 11136
    s_nop 0
    buffer_load_dwordx4 v6, s[20:23], s57 offen offset:128 lds
    s_add_u32 s57, s57, 16384
    s_add_u32 m0, s56, 4096
    s_nop 0
    buffer_load_dwordx4 v6, s[20:23], s57 offen offset:0 lds
    s_add_u32 m0, s56, 12160
    s_nop 0
    buffer_load_dwordx4 v6, s[20:23], s57 offen offset:128 lds
    s_add_u32 s57, s57, 16384
    s_add_u32 m0, s56, 5120
    s_nop 0
    buffer_load_dwordx4 v6, s[20:23], s57 offen offset:0 lds
    s_add_u32 m0, s56, 13184
    s_nop 0
    buffer_load_dwordx4 v6, s[20:23], s57 offen offset:128 lds
    s_add_u32 s57, s57, 16384
    s_add_u32 m0, s56, 6144
    s_nop 0
    buffer_load_dwordx4 v6, s[20:23], s57 offen offset:0 lds
    s_add_u32 m0, s56, 14208
    s_nop 0
    buffer_load_dwordx4 v6, s[20:23], s57 offen offset:128 lds
    s_add_u32 s57, s57, 16384
    s_add_u32 m0, s56, 7168
    s_nop 0
    buffer_load_dwordx4 v6, s[20:23], s57 offen offset:0 lds
    s_add_u32 m0, s56, 15232
    s_nop 0
    buffer_load_dwordx4 v6, s[20:23], s57 offen offset:128 lds
    s_waitcnt vmcnt(16)
    ds_read_b64_tr_b16 a[0:1], v228 offset:0
    ds_read_b64_tr_b16 a[2:3], v228 offset:1024
    ds_read_b64_tr_b16 a[4:5], v229 offset:0
    ds_read_b64_tr_b16 a[6:7], v229 offset:1024
    ds_read_b64_tr_b16 a[8:9], v230 offset:0
    ds_read_b64_tr_b16 a[10:11], v230 offset:1024
    ds_read_b64_tr_b16 a[12:13], v231 offset:0
    ds_read_b64_tr_b16 a[14:15], v231 offset:1024
    ds_read_b64_tr_b16 a[16:17], v228 offset:2048
    ds_read_b64_tr_b16 a[18:19], v228 offset:3072
    ds_read_b64_tr_b16 a[20:21], v229 offset:2048
    ds_read_b64_tr_b16 a[22:23], v229 offset:3072
    ds_read_b64_tr_b16 a[24:25], v230 offset:2048
    ds_read_b64_tr_b16 a[26:27], v230 offset:3072
    ds_read_b64_tr_b16 a[28:29], v231 offset:2048
    ds_read_b64_tr_b16 a[30:31], v231 offset:3072
    ds_read_b64_tr_b16 a[32:33], v228 offset:4096
    ds_read_b64_tr_b16 a[34:35], v228 offset:5120
    ds_read_b64_tr_b16 a[36:37], v229 offset:4096
    ds_read_b64_tr_b16 a[38:39], v229 offset:5120
    ds_read_b64_tr_b16 a[40:41], v230 offset:4096
    ds_read_b64_tr_b16 a[42:43], v230 offset:5120
    ds_read_b64_tr_b16 a[44:45], v231 offset:4096
    ds_read_b64_tr_b16 a[46:47], v231 offset:5120
    ds_read_b64_tr_b16 a[48:49], v228 offset:6144
    ds_read_b64_tr_b16 a[50:51], v228 offset:7168
    ds_read_b64_tr_b16 a[52:53], v229 offset:6144
    ds_read_b64_tr_b16 a[54:55], v229 offset:7168
    ds_read_b64_tr_b16 a[56:57], v230 offset:6144
    ds_read_b64_tr_b16 a[58:59], v230 offset:7168
    ds_read_b64_tr_b16 a[60:61], v231 offset:6144
    ds_read_b64_tr_b16 a[62:63], v231 offset:7168
    s_waitcnt lgkmcnt(0)
    s_lshl_b32 s56, s62, 15
    s_add_u32 s56, s56, 0
    s_add_u32 s57, s64, 128
    s_mul_i32 s57, s57, 2048
    s_add_u32 s57, s57, s65
    s_add_u32 m0, s56, 0
    s_nop 0
    buffer_load_dwordx4 v6, s[20:23], s57 offen offset:0 lds
    s_add_u32 m0, s56, 8064
    s_nop 0
    buffer_load_dwordx4 v6, s[20:23], s57 offen offset:128 lds
    s_add_u32 s57, s57, 16384
    s_add_u32 m0, s56, 1024
    s_nop 0
    buffer_load_dwordx4 v6, s[20:23], s57 offen offset:0 lds
    s_add_u32 m0, s56, 9088
    s_nop 0
    buffer_load_dwordx4 v6, s[20:23], s57 offen offset:128 lds
    s_add_u32 s57, s57, 16384
    s_add_u32 m0, s56, 2048
    s_nop 0
    buffer_load_dwordx4 v6, s[20:23], s57 offen offset:0 lds
    s_add_u32 m0, s56, 10112
    s_nop 0
    buffer_load_dwordx4 v6, s[20:23], s57 offen offset:128 lds
    s_add_u32 s57, s57, 16384
    s_add_u32 m0, s56, 3072
    s_nop 0
    buffer_load_dwordx4 v6, s[20:23], s57 offen offset:0 lds
    s_add_u32 m0, s56, 11136
    s_nop 0
    buffer_load_dwordx4 v6, s[20:23], s57 offen offset:128 lds
    s_add_u32 s57, s57, 16384
    s_add_u32 m0, s56, 4096
    s_nop 0
    buffer_load_dwordx4 v6, s[20:23], s57 offen offset:0 lds
    s_add_u32 m0, s56, 12160
    s_nop 0
    buffer_load_dwordx4 v6, s[20:23], s57 offen offset:128 lds
    s_add_u32 s57, s57, 16384
    s_add_u32 m0, s56, 5120
    s_nop 0
    buffer_load_dwordx4 v6, s[20:23], s57 offen offset:0 lds
    s_add_u32 m0, s56, 13184
    s_nop 0
    buffer_load_dwordx4 v6, s[20:23], s57 offen offset:128 lds
    s_add_u32 s57, s57, 16384
    s_add_u32 m0, s56, 6144
    s_nop 0
    buffer_load_dwordx4 v6, s[20:23], s57 offen offset:0 lds
    s_add_u32 m0, s56, 14208
    s_nop 0
    buffer_load_dwordx4 v6, s[20:23], s57 offen offset:128 lds
    s_add_u32 s57, s57, 16384
    s_add_u32 m0, s56, 7168
    s_nop 0
    buffer_load_dwordx4 v6, s[20:23], s57 offen offset:0 lds
    s_add_u32 m0, s56, 15232
    s_nop 0
    buffer_load_dwordx4 v6, s[20:23], s57 offen offset:128 lds
    s_waitcnt vmcnt(16)
    ds_read_b64_tr_b16 a[64:65], v228 offset:16384
    ds_read_b64_tr_b16 a[66:67], v228 offset:17408
    ds_read_b64_tr_b16 a[68:69], v229 offset:16384
    ds_read_b64_tr_b16 a[70:71], v229 offset:17408
    ds_read_b64_tr_b16 a[72:73], v230 offset:16384
    ds_read_b64_tr_b16 a[74:75], v230 offset:17408
    ds_read_b64_tr_b16 a[76:77], v231 offset:16384
    ds_read_b64_tr_b16 a[78:79], v231 offset:17408
    ds_read_b64_tr_b16 a[80:81], v228 offset:18432
    ds_read_b64_tr_b16 a[82:83], v228 offset:19456
    ds_read_b64_tr_b16 a[84:85], v229 offset:18432
    ds_read_b64_tr_b16 a[86:87], v229 offset:19456
    ds_read_b64_tr_b16 a[88:89], v230 offset:18432
    ds_read_b64_tr_b16 a[90:91], v230 offset:19456
    ds_read_b64_tr_b16 a[92:93], v231 offset:18432
    ds_read_b64_tr_b16 a[94:95], v231 offset:19456
    ds_read_b64_tr_b16 a[96:97], v228 offset:20480
    ds_read_b64_tr_b16 a[98:99], v228 offset:21504
    ds_read_b64_tr_b16 a[100:101], v229 offset:20480
    ds_read_b64_tr_b16 a[102:103], v229 offset:21504
    ds_read_b64_tr_b16 a[104:105], v230 offset:20480
    ds_read_b64_tr_b16 a[106:107], v230 offset:21504
    ds_read_b64_tr_b16 a[108:109], v231 offset:20480
    ds_read_b64_tr_b16 a[110:111], v231 offset:21504
    ds_read_b64_tr_b16 a[112:113], v228 offset:22528
    ds_read_b64_tr_b16 a[114:115], v228 offset:23552
    ds_read_b64_tr_b16 a[116:117], v229 offset:22528
    ds_read_b64_tr_b16 a[118:119], v229 offset:23552
    ds_read_b64_tr_b16 a[120:121], v230 offset:22528
    ds_read_b64_tr_b16 a[122:123], v230 offset:23552
    ds_read_b64_tr_b16 a[124:125], v231 offset:22528
    ds_read_b64_tr_b16 a[126:127], v231 offset:23552
    s_waitcnt lgkmcnt(0)
    s_lshl_b32 s56, s62, 15
    s_add_u32 s56, s56, 16384
    s_add_u32 s57, s64, 192
    s_mul_i32 s57, s57, 2048
    s_add_u32 s57, s57, s65
    s_add_u32 m0, s56, 0
    s_nop 0
    buffer_load_dwordx4 v6, s[20:23], s57 offen offset:0 lds
    s_add_u32 m0, s56, 8064
    s_nop 0
    buffer_load_dwordx4 v6, s[20:23], s57 offen offset:128 lds
    s_add_u32 s57, s57, 16384
    s_add_u32 m0, s56, 1024
    s_nop 0
    buffer_load_dwordx4 v6, s[20:23], s57 offen offset:0 lds
    s_add_u32 m0, s56, 9088
    s_nop 0
    buffer_load_dwordx4 v6, s[20:23], s57 offen offset:128 lds
    s_add_u32 s57, s57, 16384
    s_add_u32 m0, s56, 2048
    s_nop 0
    buffer_load_dwordx4 v6, s[20:23], s57 offen offset:0 lds
    s_add_u32 m0, s56, 10112
    s_nop 0
    buffer_load_dwordx4 v6, s[20:23], s57 offen offset:128 lds
    s_add_u32 s57, s57, 16384
    s_add_u32 m0, s56, 3072
    s_nop 0
    buffer_load_dwordx4 v6, s[20:23], s57 offen offset:0 lds
    s_add_u32 m0, s56, 11136
    s_nop 0
    buffer_load_dwordx4 v6, s[20:23], s57 offen offset:128 lds
    s_waitcnt vmcnt(8)
    ds_read_b64_tr_b16 a[128:129], v228 offset:0
    ds_read_b64_tr_b16 a[130:131], v228 offset:1024
    ds_read_b64_tr_b16 a[132:133], v229 offset:0
    ds_read_b64_tr_b16 a[134:135], v229 offset:1024
    ds_read_b64_tr_b16 a[136:137], v230 offset:0
    ds_read_b64_tr_b16 a[138:139], v230 offset:1024
    ds_read_b64_tr_b16 a[140:141], v231 offset:0
    ds_read_b64_tr_b16 a[142:143], v231 offset:1024
    ds_read_b64_tr_b16 a[144:145], v228 offset:2048
    ds_read_b64_tr_b16 a[146:147], v228 offset:3072
    ds_read_b64_tr_b16 a[148:149], v229 offset:2048
    ds_read_b64_tr_b16 a[150:151], v229 offset:3072
    ds_read_b64_tr_b16 a[152:153], v230 offset:2048
    ds_read_b64_tr_b16 a[154:155], v230 offset:3072
    ds_read_b64_tr_b16 a[156:157], v231 offset:2048
    ds_read_b64_tr_b16 a[158:159], v231 offset:3072
    ds_read_b64_tr_b16 a[160:161], v228 offset:4096
    ds_read_b64_tr_b16 a[162:163], v228 offset:5120
    ds_read_b64_tr_b16 a[164:165], v229 offset:4096
    ds_read_b64_tr_b16 a[166:167], v229 offset:5120
    ds_read_b64_tr_b16 a[168:169], v230 offset:4096
    ds_read_b64_tr_b16 a[170:171], v230 offset:5120
    ds_read_b64_tr_b16 a[172:173], v231 offset:4096
    ds_read_b64_tr_b16 a[174:175], v231 offset:5120
    ds_read_b64_tr_b16 a[176:177], v228 offset:6144
    ds_read_b64_tr_b16 a[178:179], v228 offset:7168
    ds_read_b64_tr_b16 a[180:181], v229 offset:6144
    ds_read_b64_tr_b16 a[182:183], v229 offset:7168
    ds_read_b64_tr_b16 a[184:185], v230 offset:6144
    ds_read_b64_tr_b16 a[186:187], v230 offset:7168
    ds_read_b64_tr_b16 a[188:189], v231 offset:6144
    ds_read_b64_tr_b16 a[190:191], v231 offset:7168
    s_waitcnt lgkmcnt(0)
    s_waitcnt vmcnt(0)
    ds_read_b64_tr_b16 a[192:193], v228 offset:16384
    ds_read_b64_tr_b16 a[194:195], v228 offset:17408
    ds_read_b64_tr_b16 a[196:197], v229 offset:16384
    ds_read_b64_tr_b16 a[198:199], v229 offset:17408
    ds_read_b64_tr_b16 a[200:201], v230 offset:16384
    ds_read_b64_tr_b16 a[202:203], v230 offset:17408
    ds_read_b64_tr_b16 a[204:205], v231 offset:16384
    ds_read_b64_tr_b16 a[206:207], v231 offset:17408
    ds_read_b64_tr_b16 a[208:209], v228 offset:18432
    ds_read_b64_tr_b16 a[210:211], v228 offset:19456
    ds_read_b64_tr_b16 a[212:213], v229 offset:18432
    ds_read_b64_tr_b16 a[214:215], v229 offset:19456
    ds_read_b64_tr_b16 a[216:217], v230 offset:18432
    ds_read_b64_tr_b16 a[218:219], v230 offset:19456
    ds_read_b64_tr_b16 a[220:221], v231 offset:18432
    ds_read_b64_tr_b16 a[222:223], v231 offset:19456
    s_waitcnt lgkmcnt(0)
    s_barrier
    s_mov_b32 s45, 262144
    s_mov_b32 s44, 0
    s_lshl_b32 s56, s44, 13
    s_add_u32 s52, s56, s66
    s_add_u32 s54, s56, s67
    s_mul_i32 s53, s44, 524288
    s_add_u32 s53, s53, s68
    s_mul_i32 s69, s44, 229376
    s_add_u32 s69, s69, s46
mega_kernel_D_p0:
    buffer_load_ubyte v3, v2, s[36:39], s52 offen sc1
    s_waitcnt vmcnt(0)
    v_cmp_eq_u32 vcc, 0, v3
    s_cbranch_vccz mega_kernel_D_p0_ok
    s_cmp_eq_u32 s45, 0
    s_cbranch_scc1 mega_kernel_D_p0_ok
    s_sub_u32 s45, s45, 1
    s_sleep 1
    s_branch mega_kernel_D_p0
mega_kernel_D_p0_ok:
    s_branch mega_kernel_D0_cold
mega_kernel_D0_deep:
    s_lshl_b32 s56, s44, 13
    s_add_u32 s52, s56, s66
    s_add_u32 s54, s56, s67
    s_mul_i32 s53, s44, 524288
    s_add_u32 s53, s53, s68
    s_mul_i32 s69, s44, 229376
    s_add_u32 s69, s69, s46
    s_waitcnt vmcnt(4)
    s_cmp_eq_u32 s44, 63
    s_cbranch_scc1 mega_kernel_D0_pre2
    v_cmp_eq_u32 vcc, 0, v3
    s_cbranch_vccnz mega_kernel_D0_pre2
    s_add_u32 s48, s69, 229376
    s_add_u32 s49, s69, 233472
    s_add_u32 s50, s69, 237568
    s_add_u32 s51, s69, 241664
    v_mfma_f32_32x32x16_bf16 v[160:175], a[0:3], v[32:35], 0
    buffer_load_dwordx4 v[96:99], v1, s[28:31], s48 offen offset:0 sc1
    v_mfma_f32_32x32x16_bf16 v[176:191], a[4:7], v[32:35], 0
    v_mfma_f32_32x32x16_bf16 v[192:207], a[8:11], v[32:35], 0
    v_mfma_f32_32x32x16_bf16 v[208:223], a[12:15], v[32:35], 0
    v_mfma_f32_32x32x16_bf16 v[160:175], a[16:19], v[36:39], v[160:175]
    buffer_load_dwordx4 v[100:103], v1, s[28:31], s48 offen offset:1024 sc1
    v_mfma_f32_32x32x16_bf16 v[176:191], a[20:23], v[36:39], v[176:191]
    v_mfma_f32_32x32x16_bf16 v[192:207], a[24:27], v[36:39], v[192:207]
    v_mfma_f32_32x32x16_bf16 v[208:223], a[28:31], v[36:39], v[208:223]
    v_mfma_f32_32x32x16_bf16 v[160:175], a[32:35], v[40:43], v[160:175]
    buffer_load_dwordx4 v[104:107], v1, s[28:31], s48 offen offset:2048 sc1
    v_mfma_f32_32x32x16_bf16 v[176:191], a[36:39], v[40:43], v[176:191]
    v_mfma_f32_32x32x16_bf16 v[192:207], a[40:43], v[40:43], v[192:207]
    v_mfma_f32_32x32x16_bf16 v[208:223], a[44:47], v[40:43], v[208:223]
    v_mfma_f32_32x32x16_bf16 v[160:175], a[48:51], v[44:47], v[160:175]
    buffer_load_dwordx4 v[108:111], v1, s[28:31], s48 offen offset:3072 sc1
    v_mfma_f32_32x32x16_bf16 v[176:191], a[52:55], v[44:47], v[176:191]
    v_mfma_f32_32x32x16_bf16 v[192:207], a[56:59], v[44:47], v[192:207]
    v_mfma_f32_32x32x16_bf16 v[208:223], a[60:63], v[44:47], v[208:223]
    v_mfma_f32_32x32x16_bf16 v[160:175], a[64:67], v[48:51], v[160:175]
    buffer_load_dwordx4 v[112:115], v1, s[28:31], s49 offen offset:0 sc1
    v_mfma_f32_32x32x16_bf16 v[176:191], a[68:71], v[48:51], v[176:191]
    v_mfma_f32_32x32x16_bf16 v[192:207], a[72:75], v[48:51], v[192:207]
    v_mfma_f32_32x32x16_bf16 v[208:223], a[76:79], v[48:51], v[208:223]
    v_mfma_f32_32x32x16_bf16 v[160:175], a[80:83], v[52:55], v[160:175]
    buffer_load_dwordx4 v[116:119], v1, s[28:31], s49 offen offset:1024 sc1
    v_mfma_f32_32x32x16_bf16 v[176:191], a[84:87], v[52:55], v[176:191]
    v_mfma_f32_32x32x16_bf16 v[192:207], a[88:91], v[52:55], v[192:207]
    v_mfma_f32_32x32x16_bf16 v[208:223], a[92:95], v[52:55], v[208:223]
    v_mfma_f32_32x32x16_bf16 v[160:175], a[96:99], v[56:59], v[160:175]
    buffer_load_dwordx4 v[120:123], v1, s[28:31], s49 offen offset:2048 sc1
    v_mfma_f32_32x32x16_bf16 v[176:191], a[100:103], v[56:59], v[176:191]
    v_mfma_f32_32x32x16_bf16 v[192:207], a[104:107], v[56:59], v[192:207]
    v_mfma_f32_32x32x16_bf16 v[208:223], a[108:111], v[56:59], v[208:223]
    s_waitcnt vmcnt(7)
    s_mov_b64 exec, 1
    buffer_store_dword v14, off, s[36:39], s47 sc1
    s_mov_b64 exec, -1
    s_mov_b32 s55, 1
    s_nop 1
    s_branch mega_kernel_D0_p2d
mega_kernel_D0_pre:
    s_lshl_b32 s56, s44, 13
    s_add_u32 s52, s56, s66
    s_add_u32 s54, s56, s67
    s_mul_i32 s53, s44, 524288
    s_add_u32 s53, s53, s68
    s_mul_i32 s69, s44, 229376
    s_add_u32 s69, s69, s46
mega_kernel_D0_pre2:
    s_add_u32 s56, s52, 8192
    buffer_load_ubyte v3, v2, s[36:39], s56 offen sc1
    s_waitcnt vmcnt(5)
    v_mfma_f32_32x32x16_bf16 v[160:175], a[0:3], v[32:35], 0
    v_mfma_f32_32x32x16_bf16 v[176:191], a[4:7], v[32:35], 0
    v_mfma_f32_32x32x16_bf16 v[192:207], a[8:11], v[32:35], 0
    v_mfma_f32_32x32x16_bf16 v[208:223], a[12:15], v[32:35], 0
    v_mfma_f32_32x32x16_bf16 v[160:175], a[16:19], v[36:39], v[160:175]
    v_mfma_f32_32x32x16_bf16 v[176:191], a[20:23], v[36:39], v[176:191]
    v_mfma_f32_32x32x16_bf16 v[192:207], a[24:27], v[36:39], v[192:207]
    v_mfma_f32_32x32x16_bf16 v[208:223], a[28:31], v[36:39], v[208:223]
    v_mfma_f32_32x32x16_bf16 v[160:175], a[32:35], v[40:43], v[160:175]
    v_mfma_f32_32x32x16_bf16 v[176:191], a[36:39], v[40:43], v[176:191]
    v_mfma_f32_32x32x16_bf16 v[192:207], a[40:43], v[40:43], v[192:207]
    v_mfma_f32_32x32x16_bf16 v[208:223], a[44:47], v[40:43], v[208:223]
    v_mfma_f32_32x32x16_bf16 v[160:175], a[48:51], v[44:47], v[160:175]
    v_mfma_f32_32x32x16_bf16 v[176:191], a[52:55], v[44:47], v[176:191]
    v_mfma_f32_32x32x16_bf16 v[192:207], a[56:59], v[44:47], v[192:207]
    v_mfma_f32_32x32x16_bf16 v[208:223], a[60:63], v[44:47], v[208:223]
    v_mfma_f32_32x32x16_bf16 v[160:175], a[64:67], v[48:51], v[160:175]
    v_mfma_f32_32x32x16_bf16 v[176:191], a[68:71], v[48:51], v[176:191]
    v_mfma_f32_32x32x16_bf16 v[192:207], a[72:75], v[48:51], v[192:207]
    v_mfma_f32_32x32x16_bf16 v[208:223], a[76:79], v[48:51], v[208:223]
    v_mfma_f32_32x32x16_bf16 v[160:175], a[80:83], v[52:55], v[160:175]
    v_mfma_f32_32x32x16_bf16 v[176:191], a[84:87], v[52:55], v[176:191]
    v_mfma_f32_32x32x16_bf16 v[192:207], a[88:91], v[52:55], v[192:207]
    v_mfma_f32_32x32x16_bf16 v[208:223], a[92:95], v[52:55], v[208:223]
    v_mfma_f32_32x32x16_bf16 v[160:175], a[96:99], v[56:59], v[160:175]
    v_mfma_f32_32x32x16_bf16 v[176:191], a[100:103], v[56:59], v[176:191]
    v_mfma_f32_32x32x16_bf16 v[192:207], a[104:107], v[56:59], v[192:207]
    v_mfma_f32_32x32x16_bf16 v[208:223], a[108:111], v[56:59], v[208:223]
    s_waitcnt vmcnt(0)
    s_mov_b64 exec, 1
    buffer_store_dword v14, off, s[36:39], s47 sc1
    s_mov_b64 exec, -1
    s_branch mega_kernel_D0_mid
mega_kernel_D0_cold:
    s_add_u32 s48, s69, 0
    s_add_u32 s49, s69, 4096
    s_add_u32 s50, s69, 8192
    s_add_u32 s51, s69, 12288
    buffer_load_dwordx4 v[32:35], v1, s[28:31], s48 offen offset:0 sc1
    buffer_load_dwordx4 v[36:39], v1, s[28:31], s48 offen offset:1024 sc1
    buffer_load_dwordx4 v[40:43], v1, s[28:31], s48 offen offset:2048 sc1
    buffer_load_dwordx4 v[44:47], v1, s[28:31], s48 offen offset:3072 sc1
    buffer_load_dwordx4 v[48:51], v1, s[28:31], s49 offen offset:0 sc1
    buffer_load_dwordx4 v[52:55], v1, s[28:31], s49 offen offset:1024 sc1
    buffer_load_dwordx4 v[56:59], v1, s[28:31], s49 offen offset:2048 sc1
    buffer_load_dwordx4 v[60:63], v1, s[28:31], s49 offen offset:3072 sc1
    s_waitcnt vmcnt(7)
    v_mfma_f32_32x32x16_bf16 v[160:175], a[0:3], v[32:35], 0
    buffer_load_dwordx4 v[64:67], v1, s[28:31], s50 offen offset:0 sc1
    v_mfma_f32_32x32x16_bf16 v[176:191], a[4:7], v[32:35], 0
    v_mfma_f32_32x32x16_bf16 v[192:207], a[8:11], v[32:35], 0
    buffer_load_dwordx4 v[68:71], v1, s[28:31], s50 offen offset:1024 sc1
    v_mfma_f32_32x32x16_bf16 v[208:223], a[12:15], v[32:35], 0
    s_waitcnt vmcnt(8)
    v_mfma_f32_32x32x16_bf16 v[160:175], a[16:19], v[36:39], v[160:175]
    buffer_load_dwordx4 v[72:75], v1, s[28:31], s50 offen offset:2048 sc1
    v_mfma_f32_32x32x16_bf16 v[176:191], a[20:23], v[36:39], v[176:191]
    v_mfma_f32_32x32x16_bf16 v[192:207], a[24:27], v[36:39], v[192:207]
    buffer_load_dwordx4 v[76:79], v1, s[28:31], s50 offen offset:3072 sc1
    v_mfma_f32_32x32x16_bf16 v[208:223], a[28:31], v[36:39], v[208:223]
    s_waitcnt vmcnt(9)
    v_mfma_f32_32x32x16_bf16 v[160:175], a[32:35], v[40:43], v[160:175]
    buffer_load_dwordx4 v[80:83], v1, s[28:31], s51 offen offset:0 sc1
    v_mfma_f32_32x32x16_bf16 v[176:191], a[36:39], v[40:43], v[176:191]
    v_mfma_f32_32x32x16_bf16 v[192:207], a[40:43], v[40:43], v[192:207]
    buffer_load_dwordx4 v[84:87], v1, s[28:31], s51 offen offset:1024 sc1
    s_add_u32 s56, s52, 8192
    buffer_load_ubyte v3, v2, s[36:39], s56 offen sc1
    v_mfma_f32_32x32x16_bf16 v[208:223], a[44:47], v[40:43], v[208:223]
    s_waitcnt vmcnt(11)
    v_mfma_f32_32x32x16_bf16 v[160:175], a[48:51], v[44:47], v[160:175]
    v_mfma_f32_32x32x16_bf16 v[176:191], a[52:55], v[44:47], v[176:191]
    v_mfma_f32_32x32x16_bf16 v[192:207], a[56:59], v[44:47], v[192:207]
    v_mfma_f32_32x32x16_bf16 v[208:223], a[60:63], v[44:47], v[208:223]
    s_waitcnt vmcnt(10)
    v_mfma_f32_32x32x16_bf16 v[160:175], a[64:67], v[48:51], v[160:175]
    v_mfma_f32_32x32x16_bf16 v[176:191], a[68:71], v[48:51], v[176:191]
    v_mfma_f32_32x32x16_bf16 v[192:207], a[72:75], v[48:51], v[192:207]
    v_mfma_f32_32x32x16_bf16 v[208:223], a[76:79], v[48:51], v[208:223]
    s_waitcnt vmcnt(9)
    v_mfma_f32_32x32x16_bf16 v[160:175], a[80:83], v[52:55], v[160:175]
    v_mfma_f32_32x32x16_bf16 v[176:191], a[84:87], v[52:55], v[176:191]
    v_mfma_f32_32x32x16_bf16 v[192:207], a[88:91], v[52:55], v[192:207]
    v_mfma_f32_32x32x16_bf16 v[208:223], a[92:95], v[52:55], v[208:223]
    s_waitcnt vmcnt(8)
    v_mfma_f32_32x32x16_bf16 v[160:175], a[96:99], v[56:59], v[160:175]
    v_mfma_f32_32x32x16_bf16 v[176:191], a[100:103], v[56:59], v[176:191]
    v_mfma_f32_32x32x16_bf16 v[192:207], a[104:107], v[56:59], v[192:207]
    v_mfma_f32_32x32x16_bf16 v[208:223], a[108:111], v[56:59], v[208:223]
    s_waitcnt vmcnt(0)
mega_kernel_D0_mid:
    s_mov_b32 s55, 0
    s_cmp_eq_u32 s44, 63
    s_cbranch_scc1 mega_kernel_D0_p2n
    v_cmp_eq_u32 vcc, 0, v3
    s_cbranch_vccnz mega_kernel_D0_p2n
    s_mov_b32 s55, 1
    s_add_u32 s48, s69, 229376
    s_add_u32 s49, s69, 233472
    s_add_u32 s50, s69, 237568
    s_add_u32 s51, s69, 241664
    s_add_u32 s56, s52, 16384
    v_mfma_f32_32x32x16_bf16 v[160:175], a[112:115], v[60:63], v[160:175]
    v_mfma_f32_32x32x16_bf16 v[160:175], a[128:131], v[64:67], v[160:175]
    buffer_load_dwordx4 v[96:99], v1, s[28:31], s48 offen offset:0 sc1
    v_mfma_f32_32x32x16_bf16 v[160:175], a[144:147], v[68:71], v[160:175]
    v_mfma_f32_32x32x16_bf16 v[160:175], a[160:163], v[72:75], v[160:175]
    v_mfma_f32_32x32x16_bf16 v[160:175], a[176:179], v[76:79], v[160:175]
    buffer_load_dwordx4 v[100:103], v1, s[28:31], s48 offen offset:1024 sc1
    v_mfma_f32_32x32x16_bf16 v[160:175], a[192:195], v[80:83], v[160:175]
    v_mfma_f32_32x32x16_bf16 v[160:175], a[208:211], v[84:87], v[160:175]
    v_mfma_f32_32x32x16_bf16 v[176:191], a[116:119], v[60:63], v[176:191]
    v_mfma_f32_32x32x16_bf16 v[176:191], a[132:135], v[64:67], v[176:191]
    s_nop 9
    ds_write_b128 v7, v[160:163] offset:0
    v_mfma_f32_32x32x16_bf16 v[176:191], a[148:151], v[68:71], v[176:191]
    buffer_load_dwordx4 v[104:107], v1, s[28:31], s48 offen offset:2048 sc1
    v_mfma_f32_32x32x16_bf16 v[176:191], a[164:167], v[72:75], v[176:191]
    ds_write_b128 v7, v[164:167] offset:1024
    v_mfma_f32_32x32x16_bf16 v[176:191], a[180:183], v[76:79], v[176:191]
    buffer_load_dwordx4 v[108:111], v1, s[28:31], s48 offen offset:3072 sc1
    v_mfma_f32_32x32x16_bf16 v[176:191], a[196:199], v[80:83], v[176:191]
    ds_write_b128 v7, v[168:171] offset:2048
    v_mfma_f32_32x32x16_bf16 v[176:191], a[212:215], v[84:87], v[176:191]
    ds_write_b128 v7, v[172:175] offset:3072
    v_mfma_f32_32x32x16_bf16 v[192:207], a[120:123], v[60:63], v[192:207]
    v_mfma_f32_32x32x16_bf16 v[192:207], a[136:139], v[64:67], v[192:207]
    s_nop 8
    ds_write_b128 v7, v[176:179] offset:4096
    v_mfma_f32_32x32x16_bf16 v[192:207], a[152:155], v[68:71], v[192:207]
    buffer_load_dwordx4 v[112:115], v1, s[28:31], s49 offen offset:0 sc1
    v_mfma_f32_32x32x16_bf16 v[192:207], a[168:171], v[72:75], v[192:207]
    ds_write_b128 v7, v[180:183] offset:5120
    v_mfma_f32_32x32x16_bf16 v[192:207], a[184:187], v[76:79], v[192:207]
    buffer_load_dwordx4 v[116:119], v1, s[28:31], s49 offen offset:1024 sc1
    v_mfma_f32_32x32x16_bf16 v[192:207], a[200:203], v[80:83], v[192:207]
    ds_write_b128 v7, v[184:187] offset:6144
    v_mfma_f32_32x32x16_bf16 v[192:207], a[216:219], v[84:87], v[192:207]
    ds_write_b128 v7, v[188:191] offset:7168
    v_mfma_f32_32x32x16_bf16 v[208:223], a[124:127], v[60:63], v[208:223]
    v_mfma_f32_32x32x16_bf16 v[208:223], a[140:143], v[64:67], v[208:223]
    s_nop 8
    ds_write_b128 v7, v[192:195] offset:8192
    v_mfma_f32_32x32x16_bf16 v[208:223], a[156:159], v[68:71], v[208:223]
    buffer_load_dwordx4 v[120:123], v1, s[28:31], s49 offen offset:2048 sc1
    v_mfma_f32_32x32x16_bf16 v[208:223], a[172:175], v[72:75], v[208:223]
    ds_write_b128 v7, v[196:199] offset:9216
    v_mfma_f32_32x32x16_bf16 v[208:223], a[188:191], v[76:79], v[208:223]
    buffer_load_dwordx4 v[124:127], v1, s[28:31], s49 offen offset:3072 sc1
    v_mfma_f32_32x32x16_bf16 v[208:223], a[204:207], v[80:83], v[208:223]
    ds_write_b128 v7, v[200:203] offset:10240
    v_mfma_f32_32x32x16_bf16 v[208:223], a[220:223], v[84:87], v[208:223]
    ds_write_b128 v7, v[204:207] offset:11264
    s_waitcnt lgkmcnt(0)
    s_barrier
    ds_read_b128 v[160:163], v8 offset:0
    ds_read_b128 v[164:167], v8 offset:1024
    ds_read_b128 v[168:171], v8 offset:2048
    ds_read_b128 v[172:175], v8 offset:3072
    ds_read_b128 v[176:179], v9 offset:0
    ds_read_b128 v[180:183], v9 offset:1024
    ds_read_b128 v[184:187], v9 offset:2048
    ds_read_b128 v[188:191], v9 offset:3072
    ds_read_b128 v[192:195], v10 offset:0
    ds_read_b128 v[196:199], v10 offset:1024
    ds_read_b128 v[200:203], v10 offset:2048
    ds_read_b128 v[204:207], v10 offset:3072
    buffer_load_dwordx4 v[128:131], v1, s[28:31], s50 offen offset:0 sc1
    buffer_load_dwordx4 v[132:135], v1, s[28:31], s50 offen offset:1024 sc1
    buffer_load_dwordx4 v[136:139], v1, s[28:31], s50 offen offset:2048 sc1
    buffer_load_dwordx4 v[140:143], v1, s[28:31], s50 offen offset:3072 sc1
    buffer_load_dwordx4 v[144:147], v1, s[28:31], s51 offen offset:0 sc1
    s_waitcnt lgkmcnt(8)
    buffer_load_dwordx4 v[148:151], v1, s[28:31], s51 offen offset:1024 sc1
    v_add_f32 v32, v208, v160
    v_add_f32 v33, v209, v161
    v_add_f32 v34, v210, v162
    v_add_f32 v35, v211, v163
    v_add_f32 v36, v212, v164
    v_add_f32 v37, v213, v165
    v_add_f32 v38, v214, v166
    v_add_f32 v39, v215, v167
    v_add_f32 v40, v216, v168
    v_add_f32 v41, v217, v169
    v_add_f32 v42, v218, v170
    v_add_f32 v43, v219, v171
    v_add_f32 v44, v220, v172
    v_add_f32 v45, v221, v173
    v_add_f32 v46, v222, v174
    v_add_f32 v47, v223, v175
    s_waitcnt lgkmcnt(0)
    v_add_f32 v176, v176, v192
    v_add_f32 v177, v177, v193
    v_add_f32 v178, v178, v194
    v_add_f32 v179, v179, v195
    v_add_f32 v180, v180, v196
    v_add_f32 v181, v181, v197
    v_add_f32 v182, v182, v198
    v_add_f32 v183, v183, v199
    v_add_f32 v184, v184, v200
    v_add_f32 v185, v185, v201
    buffer_load_ubyte v3, v2, s[36:39], s56 offen sc1
    v_add_f32 v186, v186, v202
    v_add_f32 v187, v187, v203
    v_add_f32 v188, v188, v204
    v_add_f32 v189, v189, v205
    v_add_f32 v190, v190, v206
    v_add_f32 v191, v191, v207
    v_add_f32 v32, v32, v176
    v_add_f32 v33, v33, v177
    v_add_f32 v34, v34, v178
    v_add_f32 v35, v35, v179
    v_add_f32 v36, v36, v180
    v_add_f32 v37, v37, v181
    v_add_f32 v38, v38, v182
    v_add_f32 v39, v39, v183
    v_add_f32 v40, v40, v184
    v_add_f32 v41, v41, v185
    v_add_f32 v42, v42, v186
    v_add_f32 v43, v43, v187
    v_add_f32 v44, v44, v188
    v_add_f32 v45, v45, v189
    v_add_f32 v46, v46, v190
    v_add_f32 v47, v47, v191
    v_xor_b32 v7, 0x10000, v7
    v_xor_b32 v8, 0x10000, v8
    v_xor_b32 v9, 0x10000, v9
    v_xor_b32 v10, 0x10000, v10
    buffer_store_dwordx4 v[32:35], v1, s[32:35], s53 offen offset:0 sc1
    buffer_store_dwordx4 v[36:39], v1, s[32:35], s53 offen offset:1024 sc1
    buffer_store_dwordx4 v[40:43], v1, s[32:35], s53 offen offset:2048 sc1
    buffer_store_dwordx4 v[44:47], v1, s[32:35], s53 offen offset:3072 sc1
    s_branch mega_kernel_D0_post
mega_kernel_D0_p2d:
    s_add_u32 s56, s52, 16384
    v_mfma_f32_32x32x16_bf16 v[160:175], a[112:115], v[60:63], v[160:175]
    v_mfma_f32_32x32x16_bf16 v[160:175], a[128:131], v[64:67], v[160:175]
    buffer_load_dwordx4 v[124:127], v1, s[28:31], s49 offen offset:3072 sc1
    v_mfma_f32_32x32x16_bf16 v[160:175], a[144:147], v[68:71], v[160:175]
    v_mfma_f32_32x32x16_bf16 v[160:175], a[160:163], v[72:75], v[160:175]
    v_mfma_f32_32x32x16_bf16 v[160:175], a[176:179], v[76:79], v[160:175]
    buffer_load_dwordx4 v[128:131], v1, s[28:31], s50 offen offset:0 sc1
    v_mfma_f32_32x32x16_bf16 v[160:175], a[192:195], v[80:83], v[160:175]
    v_mfma_f32_32x32x16_bf16 v[160:175], a[208:211], v[84:87], v[160:175]
    v_mfma_f32_32x32x16_bf16 v[176:191], a[116:119], v[60:63], v[176:191]
    v_mfma_f32_32x32x16_bf16 v[176:191], a[132:135], v[64:67], v[176:191]
    s_nop 9
    ds_write_b128 v7, v[160:163] offset:0
    v_mfma_f32_32x32x16_bf16 v[176:191], a[148:151], v[68:71], v[176:191]
    buffer_load_dwordx4 v[132:135], v1, s[28:31], s50 offen offset:1024 sc1
    v_mfma_f32_32x32x16_bf16 v[176:191], a[164:167], v[72:75], v[176:191]
    ds_write_b128 v7, v[164:167] offset:1024
    v_mfma_f32_32x32x16_bf16 v[176:191], a[180:183], v[76:79], v[176:191]
    buffer_load_dwordx4 v[136:139], v1, s[28:31], s50 offen offset:2048 sc1
    v_mfma_f32_32x32x16_bf16 v[176:191], a[196:199], v[80:83], v[176:191]
    ds_write_b128 v7, v[168:171] offset:2048
    v_mfma_f32_32x32x16_bf16 v[176:191], a[212:215], v[84:87], v[176:191]
    ds_write_b128 v7, v[172:175] offset:3072
    v_mfma_f32_32x32x16_bf16 v[192:207], a[120:123], v[60:63], v[192:207]
    v_mfma_f32_32x32x16_bf16 v[192:207], a[136:139], v[64:67], v[192:207]
    s_nop 8
    ds_write_b128 v7, v[176:179] offset:4096
    v_mfma_f32_32x32x16_bf16 v[192:207], a[152:155], v[68:71], v[192:207]
    buffer_load_dwordx4 v[140:143], v1, s[28:31], s50 offen offset:3072 sc1
    v_mfma_f32_32x32x16_bf16 v[192:207], a[168:171], v[72:75], v[192:207]
    ds_write_b128 v7, v[180:183] offset:5120
    v_mfma_f32_32x32x16_bf16 v[192:207], a[184:187], v[76:79], v[192:207]
    buffer_load_dwordx4 v[144:147], v1, s[28:31], s51 offen offset:0 sc1
    v_mfma_f32_32x32x16_bf16 v[192:207], a[200:203], v[80:83], v[192:207]
    ds_write_b128 v7, v[184:187] offset:6144
    v_mfma_f32_32x32x16_bf16 v[192:207], a[216:219], v[84:87], v[192:207]
    ds_write_b128 v7, v[188:191] offset:7168
    v_mfma_f32_32x32x16_bf16 v[208:223], a[124:127], v[60:63], v[208:223]
    v_mfma_f32_32x32x16_bf16 v[208:223], a[140:143], v[64:67], v[208:223]
    s_nop 8
    ds_write_b128 v7, v[192:195] offset:8192
    v_mfma_f32_32x32x16_bf16 v[208:223], a[156:159], v[68:71], v[208:223]
    buffer_load_dwordx4 v[148:151], v1, s[28:31], s51 offen offset:1024 sc1
    v_mfma_f32_32x32x16_bf16 v[208:223], a[172:175], v[72:75], v[208:223]
    ds_write_b128 v7, v[196:199] offset:9216
    v_mfma_f32_32x32x16_bf16 v[208:223], a[188:191], v[76:79], v[208:223]
    buffer_load_ubyte v3, v2, s[36:39], s56 offen sc1
    v_mfma_f32_32x32x16_bf16 v[208:223], a[204:207], v[80:83], v[208:223]
    ds_write_b128 v7, v[200:203] offset:10240
    v_mfma_f32_32x32x16_bf16 v[208:223], a[220:223], v[84:87], v[208:223]
    ds_write_b128 v7, v[204:207] offset:11264
    s_branch mega_kernel_D0_red
mega_kernel_D0_p2n:
    v_mfma_f32_32x32x16_bf16 v[160:175], a[112:115], v[60:63], v[160:175]
    v_mfma_f32_32x32x16_bf16 v[160:175], a[128:131], v[64:67], v[160:175]
    v_mfma_f32_32x32x16_bf16 v[160:175], a[144:147], v[68:71], v[160:175]
    v_mfma_f32_32x32x16_bf16 v[160:175], a[160:163], v[72:75], v[160:175]
    v_mfma_f32_32x32x16_bf16 v[160:175], a[176:179], v[76:79], v[160:175]
    v_mfma_f32_32x32x16_bf16 v[160:175], a[192:195], v[80:83], v[160:175]
    v_mfma_f32_32x32x16_bf16 v[160:175], a[208:211], v[84:87], v[160:175]
    s_add_u32 s56, s52, 8192
    buffer_load_ubyte v3, v2, s[36:39], s56 offen sc1
    v_mfma_f32_32x32x16_bf16 v[176:191], a[116:119], v[60:63], v[176:191]
    v_mfma_f32_32x32x16_bf16 v[176:191], a[132:135], v[64:67], v[176:191]
    s_nop 7
    ds_write_b128 v7, v[160:163] offset:0
    v_mfma_f32_32x32x16_bf16 v[176:191], a[148:151], v[68:71], v[176:191]
    ds_write_b128 v7, v[164:167] offset:1024
    v_mfma_f32_32x32x16_bf16 v[176:191], a[164:167], v[72:75], v[176:191]
    v_mfma_f32_32x32x16_bf16 v[176:191], a[180:183], v[76:79], v[176:191]
    ds_write_b128 v7, v[168:171] offset:2048
    v_mfma_f32_32x32x16_bf16 v[176:191], a[196:199], v[80:83], v[176:191]
    ds_write_b128 v7, v[172:175] offset:3072
    v_mfma_f32_32x32x16_bf16 v[176:191], a[212:215], v[84:87], v[176:191]
    v_mfma_f32_32x32x16_bf16 v[192:207], a[120:123], v[60:63], v[192:207]
    v_mfma_f32_32x32x16_bf16 v[192:207], a[136:139], v[64:67], v[192:207]
    s_nop 9
    ds_write_b128 v7, v[176:179] offset:4096
    v_mfma_f32_32x32x16_bf16 v[192:207], a[152:155], v[68:71], v[192:207]
    ds_write_b128 v7, v[180:183] offset:5120
    v_mfma_f32_32x32x16_bf16 v[192:207], a[168:171], v[72:75], v[192:207]
    v_mfma_f32_32x32x16_bf16 v[192:207], a[184:187], v[76:79], v[192:207]
    ds_write_b128 v7, v[184:187] offset:6144
    v_mfma_f32_32x32x16_bf16 v[192:207], a[200:203], v[80:83], v[192:207]
    ds_write_b128 v7, v[188:191] offset:7168
    v_mfma_f32_32x32x16_bf16 v[192:207], a[216:219], v[84:87], v[192:207]
    v_mfma_f32_32x32x16_bf16 v[208:223], a[124:127], v[60:63], v[208:223]
    v_mfma_f32_32x32x16_bf16 v[208:223], a[140:143], v[64:67], v[208:223]
    s_nop 9
    ds_write_b128 v7, v[192:195] offset:8192
    v_mfma_f32_32x32x16_bf16 v[208:223], a[156:159], v[68:71], v[208:223]
    ds_write_b128 v7, v[196:199] offset:9216
    v_mfma_f32_32x32x16_bf16 v[208:223], a[172:175], v[72:75], v[208:223]
    v_mfma_f32_32x32x16_bf16 v[208:223], a[188:191], v[76:79], v[208:223]
    ds_write_b128 v7, v[200:203] offset:10240
    v_mfma_f32_32x32x16_bf16 v[208:223], a[204:207], v[80:83], v[208:223]
    ds_write_b128 v7, v[204:207] offset:11264
    v_mfma_f32_32x32x16_bf16 v[208:223], a[220:223], v[84:87], v[208:223]
    s_waitcnt lgkmcnt(0)
    s_barrier
    s_cmp_eq_u32 s44, 63
    s_cbranch_scc1 mega_kernel_D0_red2
    s_waitcnt vmcnt(0)
    v_cmp_eq_u32 vcc, 0, v3
    s_cbranch_vccnz mega_kernel_D0_red2
    s_mov_b32 s55, 1
    s_add_u32 s48, s69, 229376
    s_add_u32 s49, s69, 233472
    s_add_u32 s50, s69, 237568
    s_add_u32 s51, s69, 241664
    s_add_u32 s56, s52, 16384
    ds_read_b128 v[160:163], v8 offset:0
    ds_read_b128 v[164:167], v8 offset:1024
    ds_read_b128 v[168:171], v8 offset:2048
    ds_read_b128 v[172:175], v8 offset:3072
    ds_read_b128 v[176:179], v9 offset:0
    ds_read_b128 v[180:183], v9 offset:1024
    ds_read_b128 v[184:187], v9 offset:2048
    ds_read_b128 v[188:191], v9 offset:3072
    ds_read_b128 v[192:195], v10 offset:0
    ds_read_b128 v[196:199], v10 offset:1024
    ds_read_b128 v[200:203], v10 offset:2048
    ds_read_b128 v[204:207], v10 offset:3072
    buffer_load_dwordx4 v[96:99], v1, s[28:31], s48 offen offset:0 sc1
    buffer_load_dwordx4 v[100:103], v1, s[28:31], s48 offen offset:1024 sc1
    buffer_load_dwordx4 v[104:107], v1, s[28:31], s48 offen offset:2048 sc1
    buffer_load_dwordx4 v[108:111], v1, s[28:31], s48 offen offset:3072 sc1
    buffer_load_dwordx4 v[112:115], v1, s[28:31], s49 offen offset:0 sc1
    buffer_load_dwordx4 v[116:119], v1, s[28:31], s49 offen offset:1024 sc1
    buffer_load_dwordx4 v[120:123], v1, s[28:31], s49 offen offset:2048 sc1
    buffer_load_dwordx4 v[124:127], v1, s[28:31], s49 offen offset:3072 sc1
    s_waitcnt lgkmcnt(8)
    buffer_load_dwordx4 v[128:131], v1, s[28:31], s50 offen offset:0 sc1
    v_add_f32 v32, v208, v160
    v_add_f32 v33, v209, v161
    v_add_f32 v34, v210, v162
    v_add_f32 v35, v211, v163
    v_add_f32 v36, v212, v164
    v_add_f32 v37, v213, v165
    v_add_f32 v38, v214, v166
    buffer_load_dwordx4 v[132:135], v1, s[28:31], s50 offen offset:1024 sc1
    v_add_f32 v39, v215, v167
    v_add_f32 v40, v216, v168
    v_add_f32 v41, v217, v169
    v_add_f32 v42, v218, v170
    v_add_f32 v43, v219, v171
    v_add_f32 v44, v220, v172
    v_add_f32 v45, v221, v173
    v_add_f32 v46, v222, v174
    buffer_load_dwordx4 v[136:139], v1, s[28:31], s50 offen offset:2048 sc1
    v_add_f32 v47, v223, v175
    s_waitcnt lgkmcnt(0)
    v_add_f32 v176, v176, v192
    v_add_f32 v177, v177, v193
    v_add_f32 v178, v178, v194
    v_add_f32 v179, v179, v195
    v_add_f32 v180, v180, v196
    v_add_f32 v181, v181, v197
    buffer_load_dwordx4 v[140:143], v1, s[28:31], s50 offen offset:3072 sc1
    v_add_f32 v182, v182, v198
    v_add_f32 v183, v183, v199
    v_add_f32 v184, v184, v200
    v_add_f32 v185, v185, v201
    v_add_f32 v186, v186, v202
    v_add_f32 v187, v187, v203
    v_add_f32 v188, v188, v204
    buffer_load_dwordx4 v[144:147], v1, s[28:31], s51 offen offset:0 sc1
    v_add_f32 v189, v189, v205
    v_add_f32 v190, v190, v206
    v_add_f32 v191, v191, v207
    v_add_f32 v32, v32, v176
    v_add_f32 v33, v33, v177
    v_add_f32 v34, v34, v178
    v_add_f32 v35, v35, v179
    v_add_f32 v36, v36, v180
    buffer_load_dwordx4 v[148:151], v1, s[28:31], s51 offen offset:1024 sc1
    v_add_f32 v37, v37, v181
    v_add_f32 v38, v38, v182
    v_add_f32 v39, v39, v183
    v_add_f32 v40, v40, v184
    v_add_f32 v41, v41, v185
    v_add_f32 v42, v42, v186
    v_add_f32 v43, v43, v187
    v_add_f32 v44, v44, v188
    buffer_load_ubyte v3, v2, s[36:39], s56 offen sc1
    v_add_f32 v45, v45, v189
    v_add_f32 v46, v46, v190
    v_add_f32 v47, v47, v191
    v_xor_b32 v7, 0x10000, v7
    v_xor_b32 v8, 0x10000, v8
    v_xor_b32 v9, 0x10000, v9
    v_xor_b32 v10, 0x10000, v10
    buffer_store_dwordx4 v[32:35], v1, s[32:35], s53 offen offset:0 sc1
    buffer_store_dwordx4 v[36:39], v1, s[32:35], s53 offen offset:1024 sc1
    buffer_store_dwordx4 v[40:43], v1, s[32:35], s53 offen offset:2048 sc1
    buffer_store_dwordx4 v[44:47], v1, s[32:35], s53 offen offset:3072 sc1
    s_branch mega_kernel_D0_post
mega_kernel_D0_red:
    s_waitcnt lgkmcnt(0)
    s_barrier
mega_kernel_D0_red2:
    ds_read_b128 v[160:163], v8 offset:0
    ds_read_b128 v[164:167], v8 offset:1024
    ds_read_b128 v[168:171], v8 offset:2048
    ds_read_b128 v[172:175], v8 offset:3072
    ds_read_b128 v[176:179], v9 offset:0
    ds_read_b128 v[180:183], v9 offset:1024
    ds_read_b128 v[184:187], v9 offset:2048
    ds_read_b128 v[188:191], v9 offset:3072
    ds_read_b128 v[192:195], v10 offset:0
    ds_read_b128 v[196:199], v10 offset:1024
    ds_read_b128 v[200:203], v10 offset:2048
    ds_read_b128 v[204:207], v10 offset:3072
    s_waitcnt lgkmcnt(8)
    v_add_f32 v32, v208, v160
    v_add_f32 v33, v209, v161
    v_add_f32 v34, v210, v162
    v_add_f32 v35, v211, v163
    v_add_f32 v36, v212, v164
    v_add_f32 v37, v213, v165
    v_add_f32 v38, v214, v166
    v_add_f32 v39, v215, v167
    v_add_f32 v40, v216, v168
    v_add_f32 v41, v217, v169
    v_add_f32 v42, v218, v170
    v_add_f32 v43, v219, v171
    v_add_f32 v44, v220, v172
    v_add_f32 v45, v221, v173
    v_add_f32 v46, v222, v174
    v_add_f32 v47, v223, v175
    s_waitcnt lgkmcnt(0)
    v_add_f32 v176, v176, v192
    v_add_f32 v177, v177, v193
    v_add_f32 v178, v178, v194
    v_add_f32 v179, v179, v195
    v_add_f32 v180, v180, v196
    v_add_f32 v181, v181, v197
    v_add_f32 v182, v182, v198
    v_add_f32 v183, v183, v199
    v_add_f32 v184, v184, v200
    v_add_f32 v185, v185, v201
    v_add_f32 v186, v186, v202
    v_add_f32 v187, v187, v203
    v_add_f32 v188, v188, v204
    v_add_f32 v189, v189, v205
    v_add_f32 v190, v190, v206
    v_add_f32 v191, v191, v207
    v_add_f32 v32, v32, v176
    v_add_f32 v33, v33, v177
    v_add_f32 v34, v34, v178
    v_add_f32 v35, v35, v179
    v_add_f32 v36, v36, v180
    v_add_f32 v37, v37, v181
    v_add_f32 v38, v38, v182
    v_add_f32 v39, v39, v183
    v_add_f32 v40, v40, v184
    v_add_f32 v41, v41, v185
    v_add_f32 v42, v42, v186
    v_add_f32 v43, v43, v187
    v_add_f32 v44, v44, v188
    v_add_f32 v45, v45, v189
    v_add_f32 v46, v46, v190
    v_add_f32 v47, v47, v191
    v_xor_b32 v7, 0x10000, v7
    v_xor_b32 v8, 0x10000, v8
    v_xor_b32 v9, 0x10000, v9
    v_xor_b32 v10, 0x10000, v10
    buffer_store_dwordx4 v[32:35], v1, s[32:35], s53 offen offset:0 sc1
    buffer_store_dwordx4 v[36:39], v1, s[32:35], s53 offen offset:1024 sc1
    buffer_store_dwordx4 v[40:43], v1, s[32:35], s53 offen offset:2048 sc1
    buffer_store_dwordx4 v[44:47], v1, s[32:35], s53 offen offset:3072 sc1
mega_kernel_D0_post:
    s_cmp_eq_u32 s44, 63
    s_cbranch_scc1 mega_kernel_D0_last
    s_cmp_lg_u32 s55, 0
    s_cbranch_scc0 mega_kernel_D0_np
    s_mov_b32 s47, s54
    s_add_u32 s44, s44, 1
    s_branch mega_kernel_D1_deep
mega_kernel_D0_np:
    s_add_u32 s56, s52, 8192
    buffer_load_ubyte v3, v2, s[36:39], s56 offen sc1
    s_waitcnt vmcnt(0)
    s_mov_b64 exec, 1
    buffer_store_dword v14, off, s[36:39], s54 sc1
    s_mov_b64 exec, -1
    v_cmp_eq_u32 vcc, 0, v3
    s_cbranch_vccz mega_kernel_D0_p_ok
mega_kernel_D0_p:
    buffer_load_ubyte v3, v2, s[36:39], s56 offen sc1
    s_waitcnt vmcnt(0)
    v_cmp_eq_u32 vcc, 0, v3
    s_cbranch_vccz mega_kernel_D0_p_ok
    s_cmp_eq_u32 s45, 0
    s_cbranch_scc1 mega_kernel_D0_p_ok
    s_sub_u32 s45, s45, 1
    s_sleep 1
    s_branch mega_kernel_D0_p
mega_kernel_D0_p_ok:
    s_add_u32 s44, s44, 1
    s_lshl_b32 s56, s44, 13
    s_add_u32 s52, s56, s66
    s_add_u32 s54, s56, s67
    s_mul_i32 s53, s44, 524288
    s_add_u32 s53, s53, s68
    s_mul_i32 s69, s44, 229376
    s_add_u32 s69, s69, s46
    s_branch mega_kernel_D1_cold
mega_kernel_D0_last:
    s_waitcnt vmcnt(0)
    s_mov_b64 exec, 1
    buffer_store_dword v14, off, s[36:39], s54 sc1
    s_mov_b64 exec, -1
    s_branch mega_kernel_D_fin
mega_kernel_D1_deep:
    s_lshl_b32 s56, s44, 13
    s_add_u32 s52, s56, s66
    s_add_u32 s54, s56, s67
    s_mul_i32 s53, s44, 524288
    s_add_u32 s53, s53, s68
    s_mul_i32 s69, s44, 229376
    s_add_u32 s69, s69, s46
    s_waitcnt vmcnt(4)
    s_cmp_eq_u32 s44, 63
    s_cbranch_scc1 mega_kernel_D1_pre2
    v_cmp_eq_u32 vcc, 0, v3
    s_cbranch_vccnz mega_kernel_D1_pre2
    s_add_u32 s48, s69, 229376
    s_add_u32 s49, s69, 233472
    s_add_u32 s50, s69, 237568
    s_add_u32 s51, s69, 241664
    v_mfma_f32_32x32x16_bf16 v[160:175], a[0:3], v[96:99], 0
    buffer_load_dwordx4 v[32:35], v1, s[28:31], s48 offen offset:0 sc1
    v_mfma_f32_32x32x16_bf16 v[176:191], a[4:7], v[96:99], 0
    v_mfma_f32_32x32x16_bf16 v[192:207], a[8:11], v[96:99], 0
    v_mfma_f32_32x32x16_bf16 v[208:223], a[12:15], v[96:99], 0
    v_mfma_f32_32x32x16_bf16 v[160:175], a[16:19], v[100:103], v[160:175]
    buffer_load_dwordx4 v[36:39], v1, s[28:31], s48 offen offset:1024 sc1
    v_mfma_f32_32x32x16_bf16 v[176:191], a[20:23], v[100:103], v[176:191]
    v_mfma_f32_32x32x16_bf16 v[192:207], a[24:27], v[100:103], v[192:207]
    v_mfma_f32_32x32x16_bf16 v[208:223], a[28:31], v[100:103], v[208:223]
    v_mfma_f32_32x32x16_bf16 v[160:175], a[32:35], v[104:107], v[160:175]
    buffer_load_dwordx4 v[40:43], v1, s[28:31], s48 offen offset:2048 sc1
    v_mfma_f32_32x32x16_bf16 v[176:191], a[36:39], v[104:107], v[176:191]
    v_mfma_f32_32x32x16_bf16 v[192:207], a[40:43], v[104:107], v[192:207]
    v_mfma_f32_32x32x16_bf16 v[208:223], a[44:47], v[104:107], v[208:223]
    v_mfma_f32_32x32x16_bf16 v[160:175], a[48:51], v[108:111], v[160:175]
    buffer_load_dwordx4 v[44:47], v1, s[28:31], s48 offen offset:3072 sc1
    v_mfma_f32_32x32x16_bf16 v[176:191], a[52:55], v[108:111], v[176:191]
    v_mfma_f32_32x32x16_bf16 v[192:207], a[56:59], v[108:111], v[192:207]
    v_mfma_f32_32x32x16_bf16 v[208:223], a[60:63], v[108:111], v[208:223]
    v_mfma_f32_32x32x16_bf16 v[160:175], a[64:67], v[112:115], v[160:175]
    buffer_load_dwordx4 v[48:51], v1, s[28:31], s49 offen offset:0 sc1
    v_mfma_f32_32x32x16_bf16 v[176:191], a[68:71], v[112:115], v[176:191]
    v_mfma_f32_32x32x16_bf16 v[192:207], a[72:75], v[112:115], v[192:207]
    v_mfma_f32_32x32x16_bf16 v[208:223], a[76:79], v[112:115], v[208:223]
    v_mfma_f32_32x32x16_bf16 v[160:175], a[80:83], v[116:119], v[160:175]
    buffer_load_dwordx4 v[52:55], v1, s[28:31], s49 offen offset:1024 sc1
    v_mfma_f32_32x32x16_bf16 v[176:191], a[84:87], v[116:119], v[176:191]
    v_mfma_f32_32x32x16_bf16 v[192:207], a[88:91], v[116:119], v[192:207]
    v_mfma_f32_32x32x16_bf16 v[208:223], a[92:95], v[116:119], v[208:223]
    v_mfma_f32_32x32x16_bf16 v[160:175], a[96:99], v[120:123], v[160:175]
    buffer_load_dwordx4 v[56:59], v1, s[28:31], s49 offen offset:2048 sc1
    v_mfma_f32_32x32x16_bf16 v[176:191], a[100:103], v[120:123], v[176:191]
    v_mfma_f32_32x32x16_bf16 v[192:207], a[104:107], v[120:123], v[192:207]
    v_mfma_f32_32x32x16_bf16 v[208:223], a[108:111], v[120:123], v[208:223]
    s_waitcnt vmcnt(7)
    s_mov_b64 exec, 1
    buffer_store_dword v14, off, s[36:39], s47 sc1
    s_mov_b64 exec, -1
    s_mov_b32 s55, 1
    s_nop 1
    s_branch mega_kernel_D1_p2d
mega_kernel_D1_pre:
    s_lshl_b32 s56, s44, 13
    s_add_u32 s52, s56, s66
    s_add_u32 s54, s56, s67
    s_mul_i32 s53, s44, 524288
    s_add_u32 s53, s53, s68
    s_mul_i32 s69, s44, 229376
    s_add_u32 s69, s69, s46
mega_kernel_D1_pre2:
    s_add_u32 s56, s52, 8192
    buffer_load_ubyte v3, v2, s[36:39], s56 offen sc1
    s_waitcnt vmcnt(5)
    v_mfma_f32_32x32x16_bf16 v[160:175], a[0:3], v[96:99], 0
    v_mfma_f32_32x32x16_bf16 v[176:191], a[4:7], v[96:99], 0
    v_mfma_f32_32x32x16_bf16 v[192:207], a[8:11], v[96:99], 0
    v_mfma_f32_32x32x16_bf16 v[208:223], a[12:15], v[96:99], 0
    v_mfma_f32_32x32x16_bf16 v[160:175], a[16:19], v[100:103], v[160:175]
    v_mfma_f32_32x32x16_bf16 v[176:191], a[20:23], v[100:103], v[176:191]
    v_mfma_f32_32x32x16_bf16 v[192:207], a[24:27], v[100:103], v[192:207]
    v_mfma_f32_32x32x16_bf16 v[208:223], a[28:31], v[100:103], v[208:223]
    v_mfma_f32_32x32x16_bf16 v[160:175], a[32:35], v[104:107], v[160:175]
    v_mfma_f32_32x32x16_bf16 v[176:191], a[36:39], v[104:107], v[176:191]
    v_mfma_f32_32x32x16_bf16 v[192:207], a[40:43], v[104:107], v[192:207]
    v_mfma_f32_32x32x16_bf16 v[208:223], a[44:47], v[104:107], v[208:223]
    v_mfma_f32_32x32x16_bf16 v[160:175], a[48:51], v[108:111], v[160:175]
    v_mfma_f32_32x32x16_bf16 v[176:191], a[52:55], v[108:111], v[176:191]
    v_mfma_f32_32x32x16_bf16 v[192:207], a[56:59], v[108:111], v[192:207]
    v_mfma_f32_32x32x16_bf16 v[208:223], a[60:63], v[108:111], v[208:223]
    v_mfma_f32_32x32x16_bf16 v[160:175], a[64:67], v[112:115], v[160:175]
    v_mfma_f32_32x32x16_bf16 v[176:191], a[68:71], v[112:115], v[176:191]
    v_mfma_f32_32x32x16_bf16 v[192:207], a[72:75], v[112:115], v[192:207]
    v_mfma_f32_32x32x16_bf16 v[208:223], a[76:79], v[112:115], v[208:223]
    v_mfma_f32_32x32x16_bf16 v[160:175], a[80:83], v[116:119], v[160:175]
    v_mfma_f32_32x32x16_bf16 v[176:191], a[84:87], v[116:119], v[176:191]
    v_mfma_f32_32x32x16_bf16 v[192:207], a[88:91], v[116:119], v[192:207]
    v_mfma_f32_32x32x16_bf16 v[208:223], a[92:95], v[116:119], v[208:223]
    v_mfma_f32_32x32x16_bf16 v[160:175], a[96:99], v[120:123], v[160:175]
    v_mfma_f32_32x32x16_bf16 v[176:191], a[100:103], v[120:123], v[176:191]
    v_mfma_f32_32x32x16_bf16 v[192:207], a[104:107], v[120:123], v[192:207]
    v_mfma_f32_32x32x16_bf16 v[208:223], a[108:111], v[120:123], v[208:223]
    s_waitcnt vmcnt(0)
    s_mov_b64 exec, 1
    buffer_store_dword v14, off, s[36:39], s47 sc1
    s_mov_b64 exec, -1
    s_branch mega_kernel_D1_mid
mega_kernel_D1_cold:
    s_add_u32 s48, s69, 0
    s_add_u32 s49, s69, 4096
    s_add_u32 s50, s69, 8192
    s_add_u32 s51, s69, 12288
    buffer_load_dwordx4 v[96:99], v1, s[28:31], s48 offen offset:0 sc1
    buffer_load_dwordx4 v[100:103], v1, s[28:31], s48 offen offset:1024 sc1
    buffer_load_dwordx4 v[104:107], v1, s[28:31], s48 offen offset:2048 sc1
    buffer_load_dwordx4 v[108:111], v1, s[28:31], s48 offen offset:3072 sc1
    buffer_load_dwordx4 v[112:115], v1, s[28:31], s49 offen offset:0 sc1
    buffer_load_dwordx4 v[116:119], v1, s[28:31], s49 offen offset:1024 sc1
    buffer_load_dwordx4 v[120:123], v1, s[28:31], s49 offen offset:2048 sc1
    buffer_load_dwordx4 v[124:127], v1, s[28:31], s49 offen offset:3072 sc1
    s_waitcnt vmcnt(7)
    v_mfma_f32_32x32x16_bf16 v[160:175], a[0:3], v[96:99], 0
    buffer_load_dwordx4 v[128:131], v1, s[28:31], s50 offen offset:0 sc1
    v_mfma_f32_32x32x16_bf16 v[176:191], a[4:7], v[96:99], 0
    v_mfma_f32_32x32x16_bf16 v[192:207], a[8:11], v[96:99], 0
    buffer_load_dwordx4 v[132:135], v1, s[28:31], s50 offen offset:1024 sc1
    v_mfma_f32_32x32x16_bf16 v[208:223], a[12:15], v[96:99], 0
    s_waitcnt vmcnt(8)
    v_mfma_f32_32x32x16_bf16 v[160:175], a[16:19], v[100:103], v[160:175]
    buffer_load_dwordx4 v[136:139], v1, s[28:31], s50 offen offset:2048 sc1
    v_mfma_f32_32x32x16_bf16 v[176:191], a[20:23], v[100:103], v[176:191]
    v_mfma_f32_32x32x16_bf16 v[192:207], a[24:27], v[100:103], v[192:207]
    buffer_load_dwordx4 v[140:143], v1, s[28:31], s50 offen offset:3072 sc1
    v_mfma_f32_32x32x16_bf16 v[208:223], a[28:31], v[100:103], v[208:223]
    s_waitcnt vmcnt(9)
    v_mfma_f32_32x32x16_bf16 v[160:175], a[32:35], v[104:107], v[160:175]
    buffer_load_dwordx4 v[144:147], v1, s[28:31], s51 offen offset:0 sc1
    v_mfma_f32_32x32x16_bf16 v[176:191], a[36:39], v[104:107], v[176:191]
    v_mfma_f32_32x32x16_bf16 v[192:207], a[40:43], v[104:107], v[192:207]
    buffer_load_dwordx4 v[148:151], v1, s[28:31], s51 offen offset:1024 sc1
    s_add_u32 s56, s52, 8192
    buffer_load_ubyte v3, v2, s[36:39], s56 offen sc1
    v_mfma_f32_32x32x16_bf16 v[208:223], a[44:47], v[104:107], v[208:223]
    s_waitcnt vmcnt(11)
    v_mfma_f32_32x32x16_bf16 v[160:175], a[48:51], v[108:111], v[160:175]
    v_mfma_f32_32x32x16_bf16 v[176:191], a[52:55], v[108:111], v[176:191]
    v_mfma_f32_32x32x16_bf16 v[192:207], a[56:59], v[108:111], v[192:207]
    v_mfma_f32_32x32x16_bf16 v[208:223], a[60:63], v[108:111], v[208:223]
    s_waitcnt vmcnt(10)
    v_mfma_f32_32x32x16_bf16 v[160:175], a[64:67], v[112:115], v[160:175]
    v_mfma_f32_32x32x16_bf16 v[176:191], a[68:71], v[112:115], v[176:191]
    v_mfma_f32_32x32x16_bf16 v[192:207], a[72:75], v[112:115], v[192:207]
    v_mfma_f32_32x32x16_bf16 v[208:223], a[76:79], v[112:115], v[208:223]
    s_waitcnt vmcnt(9)
    v_mfma_f32_32x32x16_bf16 v[160:175], a[80:83], v[116:119], v[160:175]
    v_mfma_f32_32x32x16_bf16 v[176:191], a[84:87], v[116:119], v[176:191]
    v_mfma_f32_32x32x16_bf16 v[192:207], a[88:91], v[116:119], v[192:207]
    v_mfma_f32_32x32x16_bf16 v[208:223], a[92:95], v[116:119], v[208:223]
    s_waitcnt vmcnt(8)
    v_mfma_f32_32x32x16_bf16 v[160:175], a[96:99], v[120:123], v[160:175]
    v_mfma_f32_32x32x16_bf16 v[176:191], a[100:103], v[120:123], v[176:191]
    v_mfma_f32_32x32x16_bf16 v[192:207], a[104:107], v[120:123], v[192:207]
    v_mfma_f32_32x32x16_bf16 v[208:223], a[108:111], v[120:123], v[208:223]
    s_waitcnt vmcnt(0)
mega_kernel_D1_mid:
    s_mov_b32 s55, 0
    s_cmp_eq_u32 s44, 63
    s_cbranch_scc1 mega_kernel_D1_p2n
    v_cmp_eq_u32 vcc, 0, v3
    s_cbranch_vccnz mega_kernel_D1_p2n
    s_mov_b32 s55, 1
    s_add_u32 s48, s69, 229376
    s_add_u32 s49, s69, 233472
    s_add_u32 s50, s69, 237568
    s_add_u32 s51, s69, 241664
    s_add_u32 s56, s52, 16384
    v_mfma_f32_32x32x16_bf16 v[160:175], a[112:115], v[124:127], v[160:175]
    v_mfma_f32_32x32x16_bf16 v[160:175], a[128:131], v[128:131], v[160:175]
    buffer_load_dwordx4 v[32:35], v1, s[28:31], s48 offen offset:0 sc1
    v_mfma_f32_32x32x16_bf16 v[160:175], a[144:147], v[132:135], v[160:175]
    v_mfma_f32_32x32x16_bf16 v[160:175], a[160:163], v[136:139], v[160:175]
    v_mfma_f32_32x32x16_bf16 v[160:175], a[176:179], v[140:143], v[160:175]
    buffer_load_dwordx4 v[36:39], v1, s[28:31], s48 offen offset:1024 sc1
    v_mfma_f32_32x32x16_bf16 v[160:175], a[192:195], v[144:147], v[160:175]
    v_mfma_f32_32x32x16_bf16 v[160:175], a[208:211], v[148:151], v[160:175]
    v_mfma_f32_32x32x16_bf16 v[176:191], a[116:119], v[124:127], v[176:191]
    v_mfma_f32_32x32x16_bf16 v[176:191], a[132:135], v[128:131], v[176:191]
    s_nop 9
    ds_write_b128 v7, v[160:163] offset:0
    v_mfma_f32_32x32x16_bf16 v[176:191], a[148:151], v[132:135], v[176:191]
    buffer_load_dwordx4 v[40:43], v1, s[28:31], s48 offen offset:2048 sc1
    v_mfma_f32_32x32x16_bf16 v[176:191], a[164:167], v[136:139], v[176:191]
    ds_write_b128 v7, v[164:167] offset:1024
    v_mfma_f32_32x32x16_bf16 v[176:191], a[180:183], v[140:143], v[176:191]
    buffer_load_dwordx4 v[44:47], v1, s[28:31], s48 offen offset:3072 sc1
    v_mfma_f32_32x32x16_bf16 v[176:191], a[196:199], v[144:147], v[176:191]
    ds_write_b128 v7, v[168:171] offset:2048
    v_mfma_f32_32x32x16_bf16 v[176:191], a[212:215], v[148:151], v[176:191]
    ds_write_b128 v7, v[172:175] offset:3072
    v_mfma_f32_32x32x16_bf16 v[192:207], a[120:123], v[124:127], v[192:207]
    v_mfma_f32_32x32x16_bf16 v[192:207], a[136:139], v[128:131], v[192:207]
    s_nop 8
    ds_write_b128 v7, v[176:179] offset:4096
    v_mfma_f32_32x32x16_bf16 v[192:207], a[152:155], v[132:135], v[192:207]
    buffer_load_dwordx4 v[48:51], v1, s[28:31], s49 offen offset:0 sc1
    v_mfma_f32_32x32x16_bf16 v[192:207], a[168:171], v[136:139], v[192:207]
    ds_write_b128 v7, v[180:183] offset:5120
    v_mfma_f32_32x32x16_bf16 v[192:207], a[184:187], v[140:143], v[192:207]
    buffer_load_dwordx4 v[52:55], v1, s[28:31], s49 offen offset:1024 sc1
    v_mfma_f32_32x32x16_bf16 v[192:207], a[200:203], v[144:147], v[192:207]
    ds_write_b128 v7, v[184:187] offset:6144
    v_mfma_f32_32x32x16_bf16 v[192:207], a[216:219], v[148:151], v[192:207]
    ds_write_b128 v7, v[188:191] offset:7168
    v_mfma_f32_32x32x16_bf16 v[208:223], a[124:127], v[124:127], v[208:223]
    v_mfma_f32_32x32x16_bf16 v[208:223], a[140:143], v[128:131], v[208:223]
    s_nop 8
    ds_write_b128 v7, v[192:195] offset:8192
    v_mfma_f32_32x32x16_bf16 v[208:223], a[156:159], v[132:135], v[208:223]
    buffer_load_dwordx4 v[56:59], v1, s[28:31], s49 offen offset:2048 sc1
    v_mfma_f32_32x32x16_bf16 v[208:223], a[172:175], v[136:139], v[208:223]
    ds_write_b128 v7, v[196:199] offset:9216
    v_mfma_f32_32x32x16_bf16 v[208:223], a[188:191], v[140:143], v[208:223]
    buffer_load_dwordx4 v[60:63], v1, s[28:31], s49 offen offset:3072 sc1
    v_mfma_f32_32x32x16_bf16 v[208:223], a[204:207], v[144:147], v[208:223]
    ds_write_b128 v7, v[200:203] offset:10240
    v_mfma_f32_32x32x16_bf16 v[208:223], a[220:223], v[148:151], v[208:223]
    ds_write_b128 v7, v[204:207] offset:11264
    s_waitcnt lgkmcnt(0)
    s_barrier
    ds_read_b128 v[160:163], v8 offset:0
    ds_read_b128 v[164:167], v8 offset:1024
    ds_read_b128 v[168:171], v8 offset:2048
    ds_read_b128 v[172:175], v8 offset:3072
    ds_read_b128 v[176:179], v9 offset:0
    ds_read_b128 v[180:183], v9 offset:1024
    ds_read_b128 v[184:187], v9 offset:2048
    ds_read_b128 v[188:191], v9 offset:3072
    ds_read_b128 v[192:195], v10 offset:0
    ds_read_b128 v[196:199], v10 offset:1024
    ds_read_b128 v[200:203], v10 offset:2048
    ds_read_b128 v[204:207], v10 offset:3072
    buffer_load_dwordx4 v[64:67], v1, s[28:31], s50 offen offset:0 sc1
    buffer_load_dwordx4 v[68:71], v1, s[28:31], s50 offen offset:1024 sc1
    buffer_load_dwordx4 v[72:75], v1, s[28:31], s50 offen offset:2048 sc1
    buffer_load_dwordx4 v[76:79], v1, s[28:31], s50 offen offset:3072 sc1
    buffer_load_dwordx4 v[80:83], v1, s[28:31], s51 offen offset:0 sc1
    s_waitcnt lgkmcnt(8)
    buffer_load_dwordx4 v[84:87], v1, s[28:31], s51 offen offset:1024 sc1
    v_add_f32 v96, v208, v160
    v_add_f32 v97, v209, v161
    v_add_f32 v98, v210, v162
    v_add_f32 v99, v211, v163
    v_add_f32 v100, v212, v164
    v_add_f32 v101, v213, v165
    v_add_f32 v102, v214, v166
    v_add_f32 v103, v215, v167
    v_add_f32 v104, v216, v168
    v_add_f32 v105, v217, v169
    v_add_f32 v106, v218, v170
    v_add_f32 v107, v219, v171
    v_add_f32 v108, v220, v172
    v_add_f32 v109, v221, v173
    v_add_f32 v110, v222, v174
    v_add_f32 v111, v223, v175
    s_waitcnt lgkmcnt(0)
    v_add_f32 v176, v176, v192
    v_add_f32 v177, v177, v193
    v_add_f32 v178, v178, v194
    v_add_f32 v179, v179, v195
    v_add_f32 v180, v180, v196
    v_add_f32 v181, v181, v197
    v_add_f32 v182, v182, v198
    v_add_f32 v183, v183, v199
    v_add_f32 v184, v184, v200
    v_add_f32 v185, v185, v201
    buffer_load_ubyte v3, v2, s[36:39], s56 offen sc1
    v_add_f32 v186, v186, v202
    v_add_f32 v187, v187, v203
    v_add_f32 v188, v188, v204
    v_add_f32 v189, v189, v205
    v_add_f32 v190, v190, v206
    v_add_f32 v191, v191, v207
    v_add_f32 v96, v96, v176
    v_add_f32 v97, v97, v177
    v_add_f32 v98, v98, v178
    v_add_f32 v99, v99, v179
    v_add_f32 v100, v100, v180
    v_add_f32 v101, v101, v181
    v_add_f32 v102, v102, v182
    v_add_f32 v103, v103, v183
    v_add_f32 v104, v104, v184
    v_add_f32 v105, v105, v185
    v_add_f32 v106, v106, v186
    v_add_f32 v107, v107, v187
    v_add_f32 v108, v108, v188
    v_add_f32 v109, v109, v189
    v_add_f32 v110, v110, v190
    v_add_f32 v111, v111, v191
    v_xor_b32 v7, 0x10000, v7
    v_xor_b32 v8, 0x10000, v8
    v_xor_b32 v9, 0x10000, v9
    v_xor_b32 v10, 0x10000, v10
    buffer_store_dwordx4 v[96:99], v1, s[32:35], s53 offen offset:0 sc1
    buffer_store_dwordx4 v[100:103], v1, s[32:35], s53 offen offset:1024 sc1
    buffer_store_dwordx4 v[104:107], v1, s[32:35], s53 offen offset:2048 sc1
    buffer_store_dwordx4 v[108:111], v1, s[32:35], s53 offen offset:3072 sc1
    s_branch mega_kernel_D1_post
mega_kernel_D1_p2d:
    s_add_u32 s56, s52, 16384
    v_mfma_f32_32x32x16_bf16 v[160:175], a[112:115], v[124:127], v[160:175]
    v_mfma_f32_32x32x16_bf16 v[160:175], a[128:131], v[128:131], v[160:175]
    buffer_load_dwordx4 v[60:63], v1, s[28:31], s49 offen offset:3072 sc1
    v_mfma_f32_32x32x16_bf16 v[160:175], a[144:147], v[132:135], v[160:175]
    v_mfma_f32_32x32x16_bf16 v[160:175], a[160:163], v[136:139], v[160:175]
    v_mfma_f32_32x32x16_bf16 v[160:175], a[176:179], v[140:143], v[160:175]
    buffer_load_dwordx4 v[64:67], v1, s[28:31], s50 offen offset:0 sc1
    v_mfma_f32_32x32x16_bf16 v[160:175], a[192:195], v[144:147], v[160:175]
    v_mfma_f32_32x32x16_bf16 v[160:175], a[208:211], v[148:151], v[160:175]
    v_mfma_f32_32x32x16_bf16 v[176:191], a[116:119], v[124:127], v[176:191]
    v_mfma_f32_32x32x16_bf16 v[176:191], a[132:135], v[128:131], v[176:191]
    s_nop 9
    ds_write_b128 v7, v[160:163] offset:0
    v_mfma_f32_32x32x16_bf16 v[176:191], a[148:151], v[132:135], v[176:191]
    buffer_load_dwordx4 v[68:71], v1, s[28:31], s50 offen offset:1024 sc1
    v_mfma_f32_32x32x16_bf16 v[176:191], a[164:167], v[136:139], v[176:191]
    ds_write_b128 v7, v[164:167] offset:1024
    v_mfma_f32_32x32x16_bf16 v[176:191], a[180:183], v[140:143], v[176:191]
    buffer_load_dwordx4 v[72:75], v1, s[28:31], s50 offen offset:2048 sc1
    v_mfma_f32_32x32x16_bf16 v[176:191], a[196:199], v[144:147], v[176:191]
    ds_write_b128 v7, v[168:171] offset:2048
    v_mfma_f32_32x32x16_bf16 v[176:191], a[212:215], v[148:151], v[176:191]
    ds_write_b128 v7, v[172:175] offset:3072
    v_mfma_f32_32x32x16_bf16 v[192:207], a[120:123], v[124:127], v[192:207]
    v_mfma_f32_32x32x16_bf16 v[192:207], a[136:139], v[128:131], v[192:207]
    s_nop 8
    ds_write_b128 v7, v[176:179] offset:4096
    v_mfma_f32_32x32x16_bf16 v[192:207], a[152:155], v[132:135], v[192:207]
    buffer_load_dwordx4 v[76:79], v1, s[28:31], s50 offen offset:3072 sc1
    v_mfma_f32_32x32x16_bf16 v[192:207], a[168:171], v[136:139], v[192:207]
    ds_write_b128 v7, v[180:183] offset:5120
    v_mfma_f32_32x32x16_bf16 v[192:207], a[184:187], v[140:143], v[192:207]
    buffer_load_dwordx4 v[80:83], v1, s[28:31], s51 offen offset:0 sc1
    v_mfma_f32_32x32x16_bf16 v[192:207], a[200:203], v[144:147], v[192:207]
    ds_write_b128 v7, v[184:187] offset:6144
    v_mfma_f32_32x32x16_bf16 v[192:207], a[216:219], v[148:151], v[192:207]
    ds_write_b128 v7, v[188:191] offset:7168
    v_mfma_f32_32x32x16_bf16 v[208:223], a[124:127], v[124:127], v[208:223]
    v_mfma_f32_32x32x16_bf16 v[208:223], a[140:143], v[128:131], v[208:223]
    s_nop 8
    ds_write_b128 v7, v[192:195] offset:8192
    v_mfma_f32_32x32x16_bf16 v[208:223], a[156:159], v[132:135], v[208:223]
    buffer_load_dwordx4 v[84:87], v1, s[28:31], s51 offen offset:1024 sc1
    v_mfma_f32_32x32x16_bf16 v[208:223], a[172:175], v[136:139], v[208:223]
    ds_write_b128 v7, v[196:199] offset:9216
    v_mfma_f32_32x32x16_bf16 v[208:223], a[188:191], v[140:143], v[208:223]
    buffer_load_ubyte v3, v2, s[36:39], s56 offen sc1
    v_mfma_f32_32x32x16_bf16 v[208:223], a[204:207], v[144:147], v[208:223]
    ds_write_b128 v7, v[200:203] offset:10240
    v_mfma_f32_32x32x16_bf16 v[208:223], a[220:223], v[148:151], v[208:223]
    ds_write_b128 v7, v[204:207] offset:11264
    s_branch mega_kernel_D1_red
mega_kernel_D1_p2n:
    v_mfma_f32_32x32x16_bf16 v[160:175], a[112:115], v[124:127], v[160:175]
    v_mfma_f32_32x32x16_bf16 v[160:175], a[128:131], v[128:131], v[160:175]
    v_mfma_f32_32x32x16_bf16 v[160:175], a[144:147], v[132:135], v[160:175]
    v_mfma_f32_32x32x16_bf16 v[160:175], a[160:163], v[136:139], v[160:175]
    v_mfma_f32_32x32x16_bf16 v[160:175], a[176:179], v[140:143], v[160:175]
    v_mfma_f32_32x32x16_bf16 v[160:175], a[192:195], v[144:147], v[160:175]
    v_mfma_f32_32x32x16_bf16 v[160:175], a[208:211], v[148:151], v[160:175]
    s_add_u32 s56, s52, 8192
    buffer_load_ubyte v3, v2, s[36:39], s56 offen sc1
    v_mfma_f32_32x32x16_bf16 v[176:191], a[116:119], v[124:127], v[176:191]
    v_mfma_f32_32x32x16_bf16 v[176:191], a[132:135], v[128:131], v[176:191]
    s_nop 7
    ds_write_b128 v7, v[160:163] offset:0
    v_mfma_f32_32x32x16_bf16 v[176:191], a[148:151], v[132:135], v[176:191]
    ds_write_b128 v7, v[164:167] offset:1024
    v_mfma_f32_32x32x16_bf16 v[176:191], a[164:167], v[136:139], v[176:191]
    v_mfma_f32_32x32x16_bf16 v[176:191], a[180:183], v[140:143], v[176:191]
    ds_write_b128 v7, v[168:171] offset:2048
    v_mfma_f32_32x32x16_bf16 v[176:191], a[196:199], v[144:147], v[176:191]
    ds_write_b128 v7, v[172:175] offset:3072
    v_mfma_f32_32x32x16_bf16 v[176:191], a[212:215], v[148:151], v[176:191]
    v_mfma_f32_32x32x16_bf16 v[192:207], a[120:123], v[124:127], v[192:207]
    v_mfma_f32_32x32x16_bf16 v[192:207], a[136:139], v[128:131], v[192:207]
    s_nop 9
    ds_write_b128 v7, v[176:179] offset:4096
    v_mfma_f32_32x32x16_bf16 v[192:207], a[152:155], v[132:135], v[192:207]
    ds_write_b128 v7, v[180:183] offset:5120
    v_mfma_f32_32x32x16_bf16 v[192:207], a[168:171], v[136:139], v[192:207]
    v_mfma_f32_32x32x16_bf16 v[192:207], a[184:187], v[140:143], v[192:207]
    ds_write_b128 v7, v[184:187] offset:6144
    v_mfma_f32_32x32x16_bf16 v[192:207], a[200:203], v[144:147], v[192:207]
    ds_write_b128 v7, v[188:191] offset:7168
    v_mfma_f32_32x32x16_bf16 v[192:207], a[216:219], v[148:151], v[192:207]
    v_mfma_f32_32x32x16_bf16 v[208:223], a[124:127], v[124:127], v[208:223]
    v_mfma_f32_32x32x16_bf16 v[208:223], a[140:143], v[128:131], v[208:223]
    s_nop 9
    ds_write_b128 v7, v[192:195] offset:8192
    v_mfma_f32_32x32x16_bf16 v[208:223], a[156:159], v[132:135], v[208:223]
    ds_write_b128 v7, v[196:199] offset:9216
    v_mfma_f32_32x32x16_bf16 v[208:223], a[172:175], v[136:139], v[208:223]
    v_mfma_f32_32x32x16_bf16 v[208:223], a[188:191], v[140:143], v[208:223]
    ds_write_b128 v7, v[200:203] offset:10240
    v_mfma_f32_32x32x16_bf16 v[208:223], a[204:207], v[144:147], v[208:223]
    ds_write_b128 v7, v[204:207] offset:11264
    v_mfma_f32_32x32x16_bf16 v[208:223], a[220:223], v[148:151], v[208:223]
    s_waitcnt lgkmcnt(0)
    s_barrier
    s_cmp_eq_u32 s44, 63
    s_cbranch_scc1 mega_kernel_D1_red2
    s_waitcnt vmcnt(0)
    v_cmp_eq_u32 vcc, 0, v3
    s_cbranch_vccnz mega_kernel_D1_red2
    s_mov_b32 s55, 1
    s_add_u32 s48, s69, 229376
    s_add_u32 s49, s69, 233472
    s_add_u32 s50, s69, 237568
    s_add_u32 s51, s69, 241664
    s_add_u32 s56, s52, 16384
    ds_read_b128 v[160:163], v8 offset:0
    ds_read_b128 v[164:167], v8 offset:1024
    ds_read_b128 v[168:171], v8 offset:2048
    ds_read_b128 v[172:175], v8 offset:3072
    ds_read_b128 v[176:179], v9 offset:0
    ds_read_b128 v[180:183], v9 offset:1024
    ds_read_b128 v[184:187], v9 offset:2048
    ds_read_b128 v[188:191], v9 offset:3072
    ds_read_b128 v[192:195], v10 offset:0
    ds_read_b128 v[196:199], v10 offset:1024
    ds_read_b128 v[200:203], v10 offset:2048
    ds_read_b128 v[204:207], v10 offset:3072
    buffer_load_dwordx4 v[32:35], v1, s[28:31], s48 offen offset:0 sc1
    buffer_load_dwordx4 v[36:39], v1, s[28:31], s48 offen offset:1024 sc1
    buffer_load_dwordx4 v[40:43], v1, s[28:31], s48 offen offset:2048 sc1
    buffer_load_dwordx4 v[44:47], v1, s[28:31], s48 offen offset:3072 sc1
    buffer_load_dwordx4 v[48:51], v1, s[28:31], s49 offen offset:0 sc1
    buffer_load_dwordx4 v[52:55], v1, s[28:31], s49 offen offset:1024 sc1
    buffer_load_dwordx4 v[56:59], v1, s[28:31], s49 offen offset:2048 sc1
    buffer_load_dwordx4 v[60:63], v1, s[28:31], s49 offen offset:3072 sc1
    s_waitcnt lgkmcnt(8)
    buffer_load_dwordx4 v[64:67], v1, s[28:31], s50 offen offset:0 sc1
    v_add_f32 v96, v208, v160
    v_add_f32 v97, v209, v161
    v_add_f32 v98, v210, v162
    v_add_f32 v99, v211, v163
    v_add_f32 v100, v212, v164
    v_add_f32 v101, v213, v165
    v_add_f32 v102, v214, v166
    buffer_load_dwordx4 v[68:71], v1, s[28:31], s50 offen offset:1024 sc1
    v_add_f32 v103, v215, v167
    v_add_f32 v104, v216, v168
    v_add_f32 v105, v217, v169
    v_add_f32 v106, v218, v170
    v_add_f32 v107, v219, v171
    v_add_f32 v108, v220, v172
    v_add_f32 v109, v221, v173
    v_add_f32 v110, v222, v174
    buffer_load_dwordx4 v[72:75], v1, s[28:31], s50 offen offset:2048 sc1
    v_add_f32 v111, v223, v175
    s_waitcnt lgkmcnt(0)
    v_add_f32 v176, v176, v192
    v_add_f32 v177, v177, v193
    v_add_f32 v178, v178, v194
    v_add_f32 v179, v179, v195
    v_add_f32 v180, v180, v196
    v_add_f32 v181, v181, v197
    buffer_load_dwordx4 v[76:79], v1, s[28:31], s50 offen offset:3072 sc1
    v_add_f32 v182, v182, v198
    v_add_f32 v183, v183, v199
    v_add_f32 v184, v184, v200
    v_add_f32 v185, v185, v201
    v_add_f32 v186, v186, v202
    v_add_f32 v187, v187, v203
    v_add_f32 v188, v188, v204
    buffer_load_dwordx4 v[80:83], v1, s[28:31], s51 offen offset:0 sc1
    v_add_f32 v189, v189, v205
    v_add_f32 v190, v190, v206
    v_add_f32 v191, v191, v207
    v_add_f32 v96, v96, v176
    v_add_f32 v97, v97, v177
    v_add_f32 v98, v98, v178
    v_add_f32 v99, v99, v179
    v_add_f32 v100, v100, v180
    buffer_load_dwordx4 v[84:87], v1, s[28:31], s51 offen offset:1024 sc1
    v_add_f32 v101, v101, v181
    v_add_f32 v102, v102, v182
    v_add_f32 v103, v103, v183
    v_add_f32 v104, v104, v184
    v_add_f32 v105, v105, v185
    v_add_f32 v106, v106, v186
    v_add_f32 v107, v107, v187
    v_add_f32 v108, v108, v188
    buffer_load_ubyte v3, v2, s[36:39], s56 offen sc1
    v_add_f32 v109, v109, v189
    v_add_f32 v110, v110, v190
    v_add_f32 v111, v111, v191
    v_xor_b32 v7, 0x10000, v7
    v_xor_b32 v8, 0x10000, v8
    v_xor_b32 v9, 0x10000, v9
    v_xor_b32 v10, 0x10000, v10
    buffer_store_dwordx4 v[96:99], v1, s[32:35], s53 offen offset:0 sc1
    buffer_store_dwordx4 v[100:103], v1, s[32:35], s53 offen offset:1024 sc1
    buffer_store_dwordx4 v[104:107], v1, s[32:35], s53 offen offset:2048 sc1
    buffer_store_dwordx4 v[108:111], v1, s[32:35], s53 offen offset:3072 sc1
    s_branch mega_kernel_D1_post
mega_kernel_D1_red:
    s_waitcnt lgkmcnt(0)
    s_barrier
mega_kernel_D1_red2:
    ds_read_b128 v[160:163], v8 offset:0
    ds_read_b128 v[164:167], v8 offset:1024
    ds_read_b128 v[168:171], v8 offset:2048
    ds_read_b128 v[172:175], v8 offset:3072
    ds_read_b128 v[176:179], v9 offset:0
    ds_read_b128 v[180:183], v9 offset:1024
    ds_read_b128 v[184:187], v9 offset:2048
    ds_read_b128 v[188:191], v9 offset:3072
    ds_read_b128 v[192:195], v10 offset:0
    ds_read_b128 v[196:199], v10 offset:1024
    ds_read_b128 v[200:203], v10 offset:2048
    ds_read_b128 v[204:207], v10 offset:3072
    s_waitcnt lgkmcnt(8)
    v_add_f32 v96, v208, v160
    v_add_f32 v97, v209, v161
    v_add_f32 v98, v210, v162
    v_add_f32 v99, v211, v163
    v_add_f32 v100, v212, v164
    v_add_f32 v101, v213, v165
    v_add_f32 v102, v214, v166
    v_add_f32 v103, v215, v167
    v_add_f32 v104, v216, v168
    v_add_f32 v105, v217, v169
    v_add_f32 v106, v218, v170
    v_add_f32 v107, v219, v171
    v_add_f32 v108, v220, v172
    v_add_f32 v109, v221, v173
    v_add_f32 v110, v222, v174
    v_add_f32 v111, v223, v175
    s_waitcnt lgkmcnt(0)
    v_add_f32 v176, v176, v192
    v_add_f32 v177, v177, v193
    v_add_f32 v178, v178, v194
    v_add_f32 v179, v179, v195
    v_add_f32 v180, v180, v196
    v_add_f32 v181, v181, v197
    v_add_f32 v182, v182, v198
    v_add_f32 v183, v183, v199
    v_add_f32 v184, v184, v200
    v_add_f32 v185, v185, v201
    v_add_f32 v186, v186, v202
    v_add_f32 v187, v187, v203
    v_add_f32 v188, v188, v204
    v_add_f32 v189, v189, v205
    v_add_f32 v190, v190, v206
    v_add_f32 v191, v191, v207
    v_add_f32 v96, v96, v176
    v_add_f32 v97, v97, v177
    v_add_f32 v98, v98, v178
    v_add_f32 v99, v99, v179
    v_add_f32 v100, v100, v180
    v_add_f32 v101, v101, v181
    v_add_f32 v102, v102, v182
    v_add_f32 v103, v103, v183
    v_add_f32 v104, v104, v184
    v_add_f32 v105, v105, v185
    v_add_f32 v106, v106, v186
    v_add_f32 v107, v107, v187
    v_add_f32 v108, v108, v188
    v_add_f32 v109, v109, v189
    v_add_f32 v110, v110, v190
    v_add_f32 v111, v111, v191
    v_xor_b32 v7, 0x10000, v7
    v_xor_b32 v8, 0x10000, v8
    v_xor_b32 v9, 0x10000, v9
    v_xor_b32 v10, 0x10000, v10
    buffer_store_dwordx4 v[96:99], v1, s[32:35], s53 offen offset:0 sc1
    buffer_store_dwordx4 v[100:103], v1, s[32:35], s53 offen offset:1024 sc1
    buffer_store_dwordx4 v[104:107], v1, s[32:35], s53 offen offset:2048 sc1
    buffer_store_dwordx4 v[108:111], v1, s[32:35], s53 offen offset:3072 sc1
mega_kernel_D1_post:
    s_cmp_eq_u32 s44, 63
    s_cbranch_scc1 mega_kernel_D1_last
    s_cmp_lg_u32 s55, 0
    s_cbranch_scc0 mega_kernel_D1_np
    s_mov_b32 s47, s54
    s_add_u32 s44, s44, 1
    s_branch mega_kernel_D0_deep
mega_kernel_D1_np:
    s_add_u32 s56, s52, 8192
    buffer_load_ubyte v3, v2, s[36:39], s56 offen sc1
    s_waitcnt vmcnt(0)
    s_mov_b64 exec, 1
    buffer_store_dword v14, off, s[36:39], s54 sc1
    s_mov_b64 exec, -1
    v_cmp_eq_u32 vcc, 0, v3
    s_cbranch_vccz mega_kernel_D1_p_ok
mega_kernel_D1_p:
    buffer_load_ubyte v3, v2, s[36:39], s56 offen sc1
    s_waitcnt vmcnt(0)
    v_cmp_eq_u32 vcc, 0, v3
    s_cbranch_vccz mega_kernel_D1_p_ok
    s_cmp_eq_u32 s45, 0
    s_cbranch_scc1 mega_kernel_D1_p_ok
    s_sub_u32 s45, s45, 1
    s_sleep 1
    s_branch mega_kernel_D1_p
mega_kernel_D1_p_ok:
    s_add_u32 s44, s44, 1
    s_lshl_b32 s56, s44, 13
    s_add_u32 s52, s56, s66
    s_add_u32 s54, s56, s67
    s_mul_i32 s53, s44, 524288
    s_add_u32 s53, s53, s68
    s_mul_i32 s69, s44, 229376
    s_add_u32 s69, s69, s46
    s_branch mega_kernel_D0_cold
mega_kernel_D1_last:
    s_waitcnt vmcnt(0)
    s_mov_b64 exec, 1
    buffer_store_dword v14, off, s[36:39], s54 sc1
    s_mov_b64 exec, -1
    s_branch mega_kernel_D_fin
mega_kernel_D_fin:
    s_waitcnt vmcnt(0)
    s_branch mega_kernel_exit
mega_kernel_toR:
    s_sub_u32 s63, s61, 192
    s_load_dwordx2 s[4:5], s[0:1], 104
    s_load_dwordx2 s[6:7], s[0:1], 0
    s_load_dwordx2 s[8:9], s[0:1], 88
    s_cmp_ge_u32 s62, 2
    s_cbranch_scc1 mega_kernel_rfin
    s_mov_b32 s48, s63
    s_lshl_b32 s64, s48, 15
    s_lshl_b32 s68, s48, 7
    s_lshl_b32 s69, s48, 12
    s_lshl_b32 s49, s48, 4
    s_add_u32 s66, s49, 16896
    s_lshl_b32 s67, s48, 3
    s_lshl_b32 s65, s48, 7
    v_and_b32 v16, 63, v0
    v_lshlrev_b32 v1, 4, v16
    v_min_u32 v2, 7, v16
    v_lshlrev_b32 v2, 4, v2
    v_and_b32 v17, 31, v16
    v_lshrrev_b32 v18, 5, v16
    v_lshlrev_b32 v4, 11, v17
    v_lshl_add_u32 v4, v18, 4, v4
    v_lshlrev_b32 v5, 7, v17
    v_mov_b32 v17, 0x40000000
    v_cmp_gt_u32 vcc, 32, v16
    s_nop 1
    v_cndmask_b32 v5, v17, v5, vcc
    v_mov_b32 v6, 1
    s_mov_b32 s41, 262144
    s_mov_b32 s40, 0
    s_mov_b32 s59, 0
    s_waitcnt lgkmcnt(0)
    s_add_u32 s32, s4, 169607168
    s_addc_u32 s33, s5, 0
    s_mov_b32 s34, 548864
    s_mov_b32 s35, 0x20000
    s_cmp_ge_u32 s62, 1
    s_cbranch_scc1 mega_kernel_rD
    s_add_u32 s65, s65, 18432
    s_add_u32 s20, s4, 98828288
    s_addc_u32 s21, s5, 0
    s_mov_b32 s22, 33554432
    s_mov_b32 s23, 0x20000
    s_mov_b32 s24, s6
    s_mov_b32 s25, s7
    s_mov_b32 s26, 4194304
    s_mov_b32 s27, 0x20000
    s_add_u32 s28, s4, 79691776
    s_addc_u32 s29, s5, 0
    s_mov_b32 s30, 4194304
    s_mov_b32 s31, 0x20000
    s_add_u32 s36, s4, 98566144
    s_addc_u32 s37, s5, 0
    s_mov_b32 s38, 262144
    s_mov_b32 s39, 0x20000
mega_kernel_rW_top:
    s_lshl_b32 s42, s40, 19
    s_add_u32 s42, s42, s64
    s_lshl_b32 s48, s40, 13
    s_add_u32 s43, s48, s65
    s_add_u32 s46, s48, s66
    s_lshl_b32 s48, s40, 12
    s_add_u32 s47, s48, s67
    s_lshl_b32 s48, s40, 16
    s_add_u32 s49, s48, s68
    s_add_u32 s50, s48, s69
    s_mov_b32 s44, s49
    s_mov_b32 s45, s50
    buffer_load_dwordx4 v[16:19], v4, s[24:27], s44 offen offset:0
    buffer_load_dwordx4 v[20:23], v4, s[24:27], s44 offen offset:32
    buffer_load_dwordx4 v[24:27], v4, s[24:27], s44 offen offset:64
    buffer_load_dwordx4 v[28:31], v4, s[24:27], s44 offen offset:96
mega_kernel_rW_p:
    buffer_load_dword v3, v2, s[32:35], s43 offen sc1
    s_waitcnt vmcnt(0)
    v_cmp_eq_u32 vcc, 0, v3
    s_cbranch_vccz mega_kernel_rW_p_ok
    s_cmp_eq_u32 s41, 0
    s_cbranch_scc1 mega_kernel_rW_p_ok
    s_sub_u32 s41, s41, 1
    s_sleep 1
    s_branch mega_kernel_rW_p
mega_kernel_rW_p_ok:
mega_kernel_rW_go:
    s_add_u32 s51, s43, 8192
    buffer_load_dword v3, v2, s[32:35], s51 offen sc1
    s_add_u32 s48, s42, 0
    buffer_load_dwordx4 v[64:67], v1, s[20:23], s48 offen offset:0 sc1
    buffer_load_dwordx4 v[68:71], v1, s[20:23], s48 offen offset:1024 sc1
    buffer_load_dwordx4 v[72:75], v1, s[20:23], s48 offen offset:2048 sc1
    buffer_load_dwordx4 v[76:79], v1, s[20:23], s48 offen offset:3072 sc1
    s_add_u32 s48, s42, 4096
    buffer_load_dwordx4 v[80:83], v1, s[20:23], s48 offen offset:0 sc1
    buffer_load_dwordx4 v[84:87], v1, s[20:23], s48 offen offset:1024 sc1
    buffer_load_dwordx4 v[88:91], v1, s[20:23], s48 offen offset:2048 sc1
    buffer_load_dwordx4 v[92:95], v1, s[20:23], s48 offen offset:3072 sc1
    s_add_u32 s48, s42, 8192
    buffer_load_dwordx4 v[96:99], v1, s[20:23], s48 offen offset:0 sc1
    buffer_load_dwordx4 v[100:103], v1, s[20:23], s48 offen offset:1024 sc1
    buffer_load_dwordx4 v[104:107], v1, s[20:23], s48 offen offset:2048 sc1
    buffer_load_dwordx4 v[108:111], v1, s[20:23], s48 offen offset:3072 sc1
    s_add_u32 s48, s42, 12288
    buffer_load_dwordx4 v[112:115], v1, s[20:23], s48 offen offset:0 sc1
    buffer_load_dwordx4 v[116:119], v1, s[20:23], s48 offen offset:1024 sc1
    buffer_load_dwordx4 v[120:123], v1, s[20:23], s48 offen offset:2048 sc1
    buffer_load_dwordx4 v[124:127], v1, s[20:23], s48 offen offset:3072 sc1
    s_add_u32 s48, s42, 16384
    buffer_load_dwordx4 v[128:131], v1, s[20:23], s48 offen offset:0 sc1
    buffer_load_dwordx4 v[132:135], v1, s[20:23], s48 offen offset:1024 sc1
    buffer_load_dwordx4 v[136:139], v1, s[20:23], s48 offen offset:2048 sc1
    buffer_load_dwordx4 v[140:143], v1, s[20:23], s48 offen offset:3072 sc1
    s_add_u32 s48, s42, 20480
    buffer_load_dwordx4 v[144:147], v1, s[20:23], s48 offen offset:0 sc1
    buffer_load_dwordx4 v[148:151], v1, s[20:23], s48 offen offset:1024 sc1
    buffer_load_dwordx4 v[152:155], v1, s[20:23], s48 offen offset:2048 sc1
    buffer_load_dwordx4 v[156:159], v1, s[20:23], s48 offen offset:3072 sc1
    s_add_u32 s48, s42, 24576
    buffer_load_dwordx4 v[160:163], v1, s[20:23], s48 offen offset:0 sc1
    buffer_load_dwordx4 v[164:167], v1, s[20:23], s48 offen offset:1024 sc1
    buffer_load_dwordx4 v[168:171], v1, s[20:23], s48 offen offset:2048 sc1
    buffer_load_dwordx4 v[172:175], v1, s[20:23], s48 offen offset:3072 sc1
    s_add_u32 s48, s42, 28672
    buffer_load_dwordx4 v[176:179], v1, s[20:23], s48 offen offset:0 sc1
    buffer_load_dwordx4 v[180:183], v1, s[20:23], s48 offen offset:1024 sc1
    buffer_load_dwordx4 v[184:187], v1, s[20:23], s48 offen offset:2048 sc1
    buffer_load_dwordx4 v[188:191], v1, s[20:23], s48 offen offset:3072 sc1
    s_waitcnt vmcnt(33)
    v_permlane32_swap_b32 v16, v18
    v_permlane32_swap_b32 v17, v19
    v_permlane32_swap_b32 v20, v22
    v_permlane32_swap_b32 v21, v23
    v_permlane32_swap_b32 v24, v26
    v_permlane32_swap_b32 v25, v27
    v_permlane32_swap_b32 v28, v30
    v_permlane32_swap_b32 v29, v31
    s_waitcnt vmcnt(16)
    v_add_f32 v64, v64, v80
    v_add_f32 v65, v65, v81
    v_add_f32 v66, v66, v82
    v_add_f32 v67, v67, v83
    v_add_f32 v68, v68, v84
    v_add_f32 v69, v69, v85
    v_add_f32 v70, v70, v86
    v_add_f32 v71, v71, v87
    v_add_f32 v72, v72, v88
    v_add_f32 v73, v73, v89
    v_add_f32 v74, v74, v90
    v_add_f32 v75, v75, v91
    v_add_f32 v76, v76, v92
    v_add_f32 v77, v77, v93
    v_add_f32 v78, v78, v94
    v_add_f32 v79, v79, v95
    v_add_f32 v96, v96, v112
    v_add_f32 v97, v97, v113
    v_add_f32 v98, v98, v114
    v_add_f32 v99, v99, v115
    v_add_f32 v100, v100, v116
    v_add_f32 v101, v101, v117
    v_add_f32 v102, v102, v118
    v_add_f32 v103, v103, v119
    v_add_f32 v104, v104, v120
    v_add_f32 v105, v105, v121
    v_add_f32 v106, v106, v122
    v_add_f32 v107, v107, v123
    v_add_f32 v108, v108, v124
    v_add_f32 v109, v109, v125
    v_add_f32 v110, v110, v126
    v_add_f32 v111, v111, v127
    v_add_f32 v64, v64, v96
    v_add_f32 v65, v65, v97
    v_add_f32 v66, v66, v98
    v_add_f32 v67, v67, v99
    v_add_f32 v68, v68, v100
    v_add_f32 v69, v69, v101
    v_add_f32 v70, v70, v102
    v_add_f32 v71, v71, v103
    v_add_f32 v72, v72, v104
    v_add_f32 v73, v73, v105
    v_add_f32 v74, v74, v106
    v_add_f32 v75, v75, v107
    v_add_f32 v76, v76, v108
    v_add_f32 v77, v77, v109
    v_add_f32 v78, v78, v110
    v_add_f32 v79, v79, v111
    s_waitcnt vmcnt(0)
    v_add_f32 v128, v128, v144
    v_add_f32 v129, v129, v145
    v_add_f32 v130, v130, v146
    v_add_f32 v131, v131, v147
    v_add_f32 v132, v132, v148
    v_add_f32 v133, v133, v149
    v_add_f32 v134, v134, v150
    v_add_f32 v135, v135, v151
    v_add_f32 v136, v136, v152
    v_add_f32 v137, v137, v153
    v_add_f32 v138, v138, v154
    v_add_f32 v139, v139, v155
    v_add_f32 v140, v140, v156
    v_add_f32 v141, v141, v157
    v_add_f32 v142, v142, v158
    v_add_f32 v143, v143, v159
    v_add_f32 v160, v160, v176
    v_add_f32 v161, v161, v177
    v_add_f32 v162, v162, v178
    v_add_f32 v163, v163, v179
    v_add_f32 v164, v164, v180
    v_add_f32 v165, v165, v181
    v_add_f32 v166, v166, v182
    v_add_f32 v167, v167, v183
    v_add_f32 v168, v168, v184
    v_add_f32 v169, v169, v185
    v_add_f32 v170, v170, v186
    v_add_f32 v171, v171, v187
    v_add_f32 v172, v172, v188
    v_add_f32 v173, v173, v189
    v_add_f32 v174, v174, v190
    v_add_f32 v175, v175, v191
    v_add_f32 v128, v128, v160
    v_add_f32 v129, v129, v161
    v_add_f32 v130, v130, v162
    v_add_f32 v131, v131, v163
    v_add_f32 v132, v132, v164
    v_add_f32 v133, v133, v165
    v_add_f32 v134, v134, v166
    v_add_f32 v135, v135, v167
    v_add_f32 v136, v136, v168
    v_add_f32 v137, v137, v169
    v_add_f32 v138, v138, v170
    v_add_f32 v139, v139, v171
    v_add_f32 v140, v140, v172
    v_add_f32 v141, v141, v173
    v_add_f32 v142, v142, v174
    v_add_f32 v143, v143, v175
    s_cmp_eq_u32 s59, 0
    s_cbranch_scc1 mega_kernel_rW_nop
    s_mov_b64 exec, 1
    buffer_store_dword v6, off, s[32:35], s58 sc1
    s_mov_b64 exec, -1
    s_mov_b32 s59, 0
mega_kernel_rW_nop:
    v_lshlrev_b32 v192, 16, v16
    v_and_b32 v193, 0xffff0000, v16
    v_add_f32 v64, v64, v192
    v_add_f32 v65, v65, v193
    v_lshlrev_b32 v192, 16, v17
    v_and_b32 v193, 0xffff0000, v17
    v_add_f32 v66, v66, v192
    v_add_f32 v67, v67, v193
    v_lshlrev_b32 v192, 16, v18
    v_and_b32 v193, 0xffff0000, v18
    v_add_f32 v68, v68, v192
    v_add_f32 v69, v69, v193
    v_lshlrev_b32 v192, 16, v19
    v_and_b32 v193, 0xffff0000, v19
    v_add_f32 v70, v70, v192
    v_add_f32 v71, v71, v193
    v_lshlrev_b32 v192, 16, v20
    v_and_b32 v193, 0xffff0000, v20
    v_add_f32 v72, v72, v192
    v_add_f32 v73, v73, v193
    v_lshlrev_b32 v192, 16, v21
    v_and_b32 v193, 0xffff0000, v21
    v_add_f32 v74, v74, v192
    v_add_f32 v75, v75, v193
    v_lshlrev_b32 v192, 16, v22
    v_and_b32 v193, 0xffff0000, v22
    v_add_f32 v76, v76, v192
    v_add_f32 v77, v77, v193
    v_lshlrev_b32 v192, 16, v23
    v_and_b32 v193, 0xffff0000, v23
    v_add_f32 v78, v78, v192
    v_add_f32 v79, v79, v193
    v_lshlrev_b32 v192, 16, v24
    v_and_b32 v193, 0xffff0000, v24
    v_add_f32 v128, v128, v192
    v_add_f32 v129, v129, v193
    v_lshlrev_b32 v192, 16, v25
    v_and_b32 v193, 0xffff0000, v25
    v_add_f32 v130, v130, v192
    v_add_f32 v131, v131, v193
    v_lshlrev_b32 v192, 16, v26
    v_and_b32 v193, 0xffff0000, v26
    v_add_f32 v132, v132, v192
    v_add_f32 v133, v133, v193
    v_lshlrev_b32 v192, 16, v27
    v_and_b32 v193, 0xffff0000, v27
    v_add_f32 v134, v134, v192
    v_add_f32 v135, v135, v193
    v_lshlrev_b32 v192, 16, v28
    v_and_b32 v193, 0xffff0000, v28
    v_add_f32 v136, v136, v192
    v_add_f32 v137, v137, v193
    v_lshlrev_b32 v192, 16, v29
    v_and_b32 v193, 0xffff0000, v29
    v_add_f32 v138, v138, v192
    v_add_f32 v139, v139, v193
    v_lshlrev_b32 v192, 16, v30
    v_and_b32 v193, 0xffff0000, v30
    v_add_f32 v140, v140, v192
    v_add_f32 v141, v141, v193
    v_lshlrev_b32 v192, 16, v31
    v_and_b32 v193, 0xffff0000, v31
    v_add_f32 v142, v142, v192
    v_add_f32 v143, v143, v193
    v_cvt_pk_bf16_f32 v196, v64, v65
    v_cvt_pk_bf16_f32 v197, v66, v67
    v_cvt_pk_bf16_f32 v198, v68, v69
    v_cvt_pk_bf16_f32 v199, v70, v71
    v_cvt_pk_bf16_f32 v200, v72, v73
    v_cvt_pk_bf16_f32 v201, v74, v75
    v_cvt_pk_bf16_f32 v202, v76, v77
    v_cvt_pk_bf16_f32 v203, v78, v79
    v_cvt_pk_bf16_f32 v204, v128, v129
    v_cvt_pk_bf16_f32 v205, v130, v131
    v_cvt_pk_bf16_f32 v206, v132, v133
    v_cvt_pk_bf16_f32 v207, v134, v135
    v_cvt_pk_bf16_f32 v208, v136, v137
    v_cvt_pk_bf16_f32 v209, v138, v139
    v_cvt_pk_bf16_f32 v210, v140, v141
    v_cvt_pk_bf16_f32 v211, v142, v143
    buffer_store_dwordx4 v[196:199], v1, s[28:31], s45 offen offset:0 sc1
    buffer_store_dwordx4 v[200:203], v1, s[28:31], s45 offen offset:1024 sc1
    buffer_store_dwordx4 v[204:207], v1, s[28:31], s45 offen offset:2048 sc1
    buffer_store_dwordx4 v[208:211], v1, s[28:31], s45 offen offset:3072 sc1
    v_mov_b32 v212, 0
    v_mov_b32 v213, 0
    v_lshlrev_b32 v192, 16, v196
    v_and_b32 v193, 0xffff0000, v196
    v_add_f32 v212, v212, v192
    v_fmac_f32 v213, v192, v192
    v_add_f32 v212, v212, v193
    v_fmac_f32 v213, v193, v193
    v_lshlrev_b32 v192, 16, v197
    v_and_b32 v193, 0xffff0000, v197
    v_add_f32 v212, v212, v192
    v_fmac_f32 v213, v192, v192
    v_add_f32 v212, v212, v193
    v_fmac_f32 v213, v193, v193
    v_lshlrev_b32 v192, 16, v198
    v_and_b32 v193, 0xffff0000, v198
    v_add_f32 v212, v212, v192
    v_fmac_f32 v213, v192, v192
    v_add_f32 v212, v212, v193
    v_fmac_f32 v213, v193, v193
    v_lshlrev_b32 v192, 16, v199
    v_and_b32 v193, 0xffff0000, v199
    v_add_f32 v212, v212, v192
    v_fmac_f32 v213, v192, v192
    v_add_f32 v212, v212, v193
    v_fmac_f32 v213, v193, v193
    v_lshlrev_b32 v192, 16, v200
    v_and_b32 v193, 0xffff0000, v200
    v_add_f32 v212, v212, v192
    v_fmac_f32 v213, v192, v192
    v_add_f32 v212, v212, v193
    v_fmac_f32 v213, v193, v193
    v_lshlrev_b32 v192, 16, v201
    v_and_b32 v193, 0xffff0000, v201
    v_add_f32 v212, v212, v192
    v_fmac_f32 v213, v192, v192
    v_add_f32 v212, v212, v193
    v_fmac_f32 v213, v193, v193
    v_lshlrev_b32 v192, 16, v202
    v_and_b32 v193, 0xffff0000, v202
    v_add_f32 v212, v212, v192
    v_fmac_f32 v213, v192, v192
    v_add_f32 v212, v212, v193
    v_fmac_f32 v213, v193, v193
    v_lshlrev_b32 v192, 16, v203
    v_and_b32 v193, 0xffff0000, v203
    v_add_f32 v212, v212, v192
    v_fmac_f32 v213, v192, v192
    v_add_f32 v212, v212, v193
    v_fmac_f32 v213, v193, v193
    v_lshlrev_b32 v192, 16, v204
    v_and_b32 v193, 0xffff0000, v204
    v_add_f32 v212, v212, v192
    v_fmac_f32 v213, v192, v192
    v_add_f32 v212, v212, v193
    v_fmac_f32 v213, v193, v193
    v_lshlrev_b32 v192, 16, v205
    v_and_b32 v193, 0xffff0000, v205
    v_add_f32 v212, v212, v192
    v_fmac_f32 v213, v192, v192
    v_add_f32 v212, v212, v193
    v_fmac_f32 v213, v193, v193
    v_lshlrev_b32 v192, 16, v206
    v_and_b32 v193, 0xffff0000, v206
    v_add_f32 v212, v212, v192
    v_fmac_f32 v213, v192, v192
    v_add_f32 v212, v212, v193
    v_fmac_f32 v213, v193, v193
    v_lshlrev_b32 v192, 16, v207
    v_and_b32 v193, 0xffff0000, v207
    v_add_f32 v212, v212, v192
    v_fmac_f32 v213, v192, v192
    v_add_f32 v212, v212, v193
    v_fmac_f32 v213, v193, v193
    v_lshlrev_b32 v192, 16, v208
    v_and_b32 v193, 0xffff0000, v208
    v_add_f32 v212, v212, v192
    v_fmac_f32 v213, v192, v192
    v_add_f32 v212, v212, v193
    v_fmac_f32 v213, v193, v193
    v_lshlrev_b32 v192, 16, v209
    v_and_b32 v193, 0xffff0000, v209
    v_add_f32 v212, v212, v192
    v_fmac_f32 v213, v192, v192
    v_add_f32 v212, v212, v193
    v_fmac_f32 v213, v193, v193
    v_lshlrev_b32 v192, 16, v210
    v_and_b32 v193, 0xffff0000, v210
    v_add_f32 v212, v212, v192
    v_fmac_f32 v213, v192, v192
    v_add_f32 v212, v212, v193
    v_fmac_f32 v213, v193, v193
    v_lshlrev_b32 v192, 16, v211
    v_and_b32 v193, 0xffff0000, v211
    v_add_f32 v212, v212, v192
    v_fmac_f32 v213, v192, v192
    v_add_f32 v212, v212, v193
    v_fmac_f32 v213, v193, v193
    v_mov_b32 v192, v212
    v_mov_b32 v193, v213
    s_nop 0
    v_permlane32_swap_b32 v192, v212
    v_permlane32_swap_b32 v193, v213
    v_add_f32 v214, v212, v192
    v_add_f32 v215, v213, v193
    buffer_store_dwordx2 v[214:215], v5, s[36:39], s47 offen sc1
    s_cmp_eq_u32 s40, 63
    s_cbranch_scc1 mega_kernel_rW_ce
    v_cmp_eq_u32 vcc, 0, v3
    s_cbranch_vccnz mega_kernel_rW_ce
    s_mov_b32 s58, s46
    s_mov_b32 s59, 1
    s_add_u32 s40, s40, 1
    s_lshl_b32 s42, s40, 19
    s_add_u32 s42, s42, s64
    s_lshl_b32 s48, s40, 13
    s_add_u32 s43, s48, s65
    s_add_u32 s46, s48, s66
    s_lshl_b32 s48, s40, 12
    s_add_u32 s47, s48, s67
    s_lshl_b32 s48, s40, 16
    s_add_u32 s49, s48, s68
    s_add_u32 s50, s48, s69
    s_mov_b32 s44, s49
    s_mov_b32 s45, s50
    buffer_load_dwordx4 v[16:19], v4, s[24:27], s44 offen offset:0
    buffer_load_dwordx4 v[20:23], v4, s[24:27], s44 offen offset:32
    buffer_load_dwordx4 v[24:27], v4, s[24:27], s44 offen offset:64
    buffer_load_dwordx4 v[28:31], v4, s[24:27], s44 offen offset:96
    s_branch mega_kernel_rW_go
mega_kernel_rW_ce:
    s_waitcnt vmcnt(0)
    s_mov_b64 exec, 1
    buffer_store_dword v6, off, s[32:35], s46 sc1
    s_mov_b64 exec, -1
    s_add_u32 s40, s40, 1
    s_cmp_lt_u32 s40, 64
    s_cbranch_scc1 mega_kernel_rW_top
    s_waitcnt vmcnt(0)
    s_branch mega_kernel_rfin
mega_kernel_rD:
    s_add_u32 s65, s65, 20480
    s_add_u32 s20, s4, 132382720
    s_addc_u32 s21, s5, 0
    s_mov_b32 s22, 33554432
    s_mov_b32 s23, 0x20000
    s_add_u32 s24, s4, 79691776
    s_addc_u32 s25, s5, 0
    s_mov_b32 s26, 4194304
    s_mov_b32 s27, 0x20000
    s_mov_b32 s28, s8
    s_mov_b32 s29, s9
    s_mov_b32 s30, 4194304
    s_mov_b32 s31, 0x20000
mega_kernel_rD_top:
    s_lshl_b32 s42, s40, 19
    s_add_u32 s42, s42, s64
    s_lshl_b32 s48, s40, 13
    s_add_u32 s43, s48, s65
    s_lshl_b32 s48, s40, 16
    s_add_u32 s49, s48, s68
    s_add_u32 s50, s48, s69
    s_mov_b32 s44, s50
    s_mov_b32 s45, s49
mega_kernel_rD_p:
    buffer_load_dword v3, v2, s[32:35], s43 offen sc1
    s_waitcnt vmcnt(0)
    v_cmp_eq_u32 vcc, 0, v3
    s_cbranch_vccz mega_kernel_rD_p_ok
    s_cmp_eq_u32 s41, 0
    s_cbranch_scc1 mega_kernel_rD_p_ok
    s_sub_u32 s41, s41, 1
    s_sleep 1
    s_branch mega_kernel_rD_p
mega_kernel_rD_p_ok:
mega_kernel_rD_go:
    s_add_u32 s51, s43, 8192
    buffer_load_dword v3, v2, s[32:35], s51 offen sc1
    buffer_load_dwordx4 v[16:19], v1, s[24:27], s44 offen offset:0 sc1
    buffer_load_dwordx4 v[20:23], v1, s[24:27], s44 offen offset:1024 sc1
    buffer_load_dwordx4 v[24:27], v1, s[24:27], s44 offen offset:2048 sc1
    buffer_load_dwordx4 v[28:31], v1, s[24:27], s44 offen offset:3072 sc1
    s_add_u32 s48, s42, 0
    buffer_load_dwordx4 v[64:67], v1, s[20:23], s48 offen offset:0 sc1
    buffer_load_dwordx4 v[68:71], v1, s[20:23], s48 offen offset:1024 sc1
    buffer_load_dwordx4 v[72:75], v1, s[20:23], s48 offen offset:2048 sc1
    buffer_load_dwordx4 v[76:79], v1, s[20:23], s48 offen offset:3072 sc1
    s_add_u32 s48, s42, 4096
    buffer_load_dwordx4 v[80:83], v1, s[20:23], s48 offen offset:0 sc1
    buffer_load_dwordx4 v[84:87], v1, s[20:23], s48 offen offset:1024 sc1
    buffer_load_dwordx4 v[88:91], v1, s[20:23], s48 offen offset:2048 sc1
    buffer_load_dwordx4 v[92:95], v1, s[20:23], s48 offen offset:3072 sc1
    s_add_u32 s48, s42, 8192
    buffer_load_dwordx4 v[96:99], v1, s[20:23], s48 offen offset:0 sc1
    buffer_load_dwordx4 v[100:103], v1, s[20:23], s48 offen offset:1024 sc1
    buffer_load_dwordx4 v[104:107], v1, s[20:23], s48 offen offset:2048 sc1
    buffer_load_dwordx4 v[108:111], v1, s[20:23], s48 offen offset:3072 sc1
    s_add_u32 s48, s42, 12288
    buffer_load_dwordx4 v[112:115], v1, s[20:23], s48 offen offset:0 sc1
    buffer_load_dwordx4 v[116:119], v1, s[20:23], s48 offen offset:1024 sc1
    buffer_load_dwordx4 v[120:123], v1, s[20:23], s48 offen offset:2048 sc1
    buffer_load_dwordx4 v[124:127], v1, s[20:23], s48 offen offset:3072 sc1
    s_add_u32 s48, s42, 16384
    buffer_load_dwordx4 v[128:131], v1, s[20:23], s48 offen offset:0 sc1
    buffer_load_dwordx4 v[132:135], v1, s[20:23], s48 offen offset:1024 sc1
    buffer_load_dwordx4 v[136:139], v1, s[20:23], s48 offen offset:2048 sc1
    buffer_load_dwordx4 v[140:143], v1, s[20:23], s48 offen offset:3072 sc1
    s_add_u32 s48, s42, 20480
    buffer_load_dwordx4 v[144:147], v1, s[20:23], s48 offen offset:0 sc1
    buffer_load_dwordx4 v[148:151], v1, s[20:23], s48 offen offset:1024 sc1
    buffer_load_dwordx4 v[152:155], v1, s[20:23], s48 offen offset:2048 sc1
    buffer_load_dwordx4 v[156:159], v1, s[20:23], s48 offen offset:3072 sc1
    s_add_u32 s48, s42, 24576
    buffer_load_dwordx4 v[160:163], v1, s[20:23], s48 offen offset:0 sc1
    buffer_load_dwordx4 v[164:167], v1, s[20:23], s48 offen offset:1024 sc1
    buffer_load_dwordx4 v[168:171], v1, s[20:23], s48 offen offset:2048 sc1
    buffer_load_dwordx4 v[172:175], v1, s[20:23], s48 offen offset:3072 sc1
    s_add_u32 s48, s42, 28672
    buffer_load_dwordx4 v[176:179], v1, s[20:23], s48 offen offset:0 sc1
    buffer_load_dwordx4 v[180:183], v1, s[20:23], s48 offen offset:1024 sc1
    buffer_load_dwordx4 v[184:187], v1, s[20:23], s48 offen offset:2048 sc1
    buffer_load_dwordx4 v[188:191], v1, s[20:23], s48 offen offset:3072 sc1
    s_waitcnt vmcnt(16)
    v_add_f32 v64, v64, v80
    v_add_f32 v65, v65, v81
    v_add_f32 v66, v66, v82
    v_add_f32 v67, v67, v83
    v_add_f32 v68, v68, v84
    v_add_f32 v69, v69, v85
    v_add_f32 v70, v70, v86
    v_add_f32 v71, v71, v87
    v_add_f32 v72, v72, v88
    v_add_f32 v73, v73, v89
    v_add_f32 v74, v74, v90
    v_add_f32 v75, v75, v91
    v_add_f32 v76, v76, v92
    v_add_f32 v77, v77, v93
    v_add_f32 v78, v78, v94
    v_add_f32 v79, v79, v95
    v_add_f32 v96, v96, v112
    v_add_f32 v97, v97, v113
    v_add_f32 v98, v98, v114
    v_add_f32 v99, v99, v115
    v_add_f32 v100, v100, v116
    v_add_f32 v101, v101, v117
    v_add_f32 v102, v102, v118
    v_add_f32 v103, v103, v119
    v_add_f32 v104, v104, v120
    v_add_f32 v105, v105, v121
    v_add_f32 v106, v106, v122
    v_add_f32 v107, v107, v123
    v_add_f32 v108, v108, v124
    v_add_f32 v109, v109, v125
    v_add_f32 v110, v110, v126
    v_add_f32 v111, v111, v127
    v_add_f32 v64, v64, v96
    v_add_f32 v65, v65, v97
    v_add_f32 v66, v66, v98
    v_add_f32 v67, v67, v99
    v_add_f32 v68, v68, v100
    v_add_f32 v69, v69, v101
    v_add_f32 v70, v70, v102
    v_add_f32 v71, v71, v103
    v_add_f32 v72, v72, v104
    v_add_f32 v73, v73, v105
    v_add_f32 v74, v74, v106
    v_add_f32 v75, v75, v107
    v_add_f32 v76, v76, v108
    v_add_f32 v77, v77, v109
    v_add_f32 v78, v78, v110
    v_add_f32 v79, v79, v111
    s_waitcnt vmcnt(0)
    v_add_f32 v128, v128, v144
    v_add_f32 v129, v129, v145
    v_add_f32 v130, v130, v146
    v_add_f32 v131, v131, v147
    v_add_f32 v132, v132, v148
    v_add_f32 v133, v133, v149
    v_add_f32 v134, v134, v150
    v_add_f32 v135, v135, v151
    v_add_f32 v136, v136, v152
    v_add_f32 v137, v137, v153
    v_add_f32 v138, v138, v154
    v_add_f32 v139, v139, v155
    v_add_f32 v140, v140, v156
    v_add_f32 v141, v141, v157
    v_add_f32 v142, v142, v158
    v_add_f32 v143, v143, v159
    v_add_f32 v160, v160, v176
    v_add_f32 v161, v161, v177
    v_add_f32 v162, v162, v178
    v_add_f32 v163, v163, v179
    v_add_f32 v164, v164, v180
    v_add_f32 v165, v165, v181
    v_add_f32 v166, v166, v182
    v_add_f32 v167, v167, v183
    v_add_f32 v168, v168, v184
    v_add_f32 v169, v169, v185
    v_add_f32 v170, v170, v186
    v_add_f32 v171, v171, v187
    v_add_f32 v172, v172, v188
    v_add_f32 v173, v173, v189
    v_add_f32 v174, v174, v190
    v_add_f32 v175, v175, v191
    v_add_f32 v128, v128, v160
    v_add_f32 v129, v129, v161
    v_add_f32 v130, v130, v162
    v_add_f32 v131, v131, v163
    v_add_f32 v132, v132, v164
    v_add_f32 v133, v133, v165
    v_add_f32 v134, v134, v166
    v_add_f32 v135, v135, v167
    v_add_f32 v136, v136, v168
    v_add_f32 v137, v137, v169
    v_add_f32 v138, v138, v170
    v_add_f32 v139, v139, v171
    v_add_f32 v140, v140, v172
    v_add_f32 v141, v141, v173
    v_add_f32 v142, v142, v174
    v_add_f32 v143, v143, v175
    v_lshlrev_b32 v192, 16, v16
    v_and_b32 v193, 0xffff0000, v16
    v_add_f32 v64, v64, v192
    v_add_f32 v65, v65, v193
    v_lshlrev_b32 v192, 16, v17
    v_and_b32 v193, 0xffff0000, v17
    v_add_f32 v66, v66, v192
    v_add_f32 v67, v67, v193
    v_lshlrev_b32 v192, 16, v18
    v_and_b32 v193, 0xffff0000, v18
    v_add_f32 v68, v68, v192
    v_add_f32 v69, v69, v193
    v_lshlrev_b32 v192, 16, v19
    v_and_b32 v193, 0xffff0000, v19
    v_add_f32 v70, v70, v192
    v_add_f32 v71, v71, v193
    v_lshlrev_b32 v192, 16, v20
    v_and_b32 v193, 0xffff0000, v20
    v_add_f32 v72, v72, v192
    v_add_f32 v73, v73, v193
    v_lshlrev_b32 v192, 16, v21
    v_and_b32 v193, 0xffff0000, v21
    v_add_f32 v74, v74, v192
    v_add_f32 v75, v75, v193
    v_lshlrev_b32 v192, 16, v22
    v_and_b32 v193, 0xffff0000, v22
    v_add_f32 v76, v76, v192
    v_add_f32 v77, v77, v193
    v_lshlrev_b32 v192, 16, v23
    v_and_b32 v193, 0xffff0000, v23
    v_add_f32 v78, v78, v192
    v_add_f32 v79, v79, v193
    v_lshlrev_b32 v192, 16, v24
    v_and_b32 v193, 0xffff0000, v24
    v_add_f32 v128, v128, v192
    v_add_f32 v129, v129, v193
    v_lshlrev_b32 v192, 16, v25
    v_and_b32 v193, 0xffff0000, v25
    v_add_f32 v130, v130, v192
    v_add_f32 v131, v131, v193
    v_lshlrev_b32 v192, 16, v26
    v_and_b32 v193, 0xffff0000, v26
    v_add_f32 v132, v132, v192
    v_add_f32 v133, v133, v193
    v_lshlrev_b32 v192, 16, v27
    v_and_b32 v193, 0xffff0000, v27
    v_add_f32 v134, v134, v192
    v_add_f32 v135, v135, v193
    v_lshlrev_b32 v192, 16, v28
    v_and_b32 v193, 0xffff0000, v28
    v_add_f32 v136, v136, v192
    v_add_f32 v137, v137, v193
    v_lshlrev_b32 v192, 16, v29
    v_and_b32 v193, 0xffff0000, v29
    v_add_f32 v138, v138, v192
    v_add_f32 v139, v139, v193
    v_lshlrev_b32 v192, 16, v30
    v_and_b32 v193, 0xffff0000, v30
    v_add_f32 v140, v140, v192
    v_add_f32 v141, v141, v193
    v_lshlrev_b32 v192, 16, v31
    v_and_b32 v193, 0xffff0000, v31
    v_add_f32 v142, v142, v192
    v_add_f32 v143, v143, v193
    v_cvt_pk_bf16_f32 v196, v64, v65
    v_cvt_pk_bf16_f32 v197, v66, v67
    v_cvt_pk_bf16_f32 v198, v68, v69
    v_cvt_pk_bf16_f32 v199, v70, v71
    v_cvt_pk_bf16_f32 v200, v72, v73
    v_cvt_pk_bf16_f32 v201, v74, v75
    v_cvt_pk_bf16_f32 v202, v76, v77
    v_cvt_pk_bf16_f32 v203, v78, v79
    v_cvt_pk_bf16_f32 v204, v128, v129
    v_cvt_pk_bf16_f32 v205, v130, v131
    v_cvt_pk_bf16_f32 v206, v132, v133
    v_cvt_pk_bf16_f32 v207, v134, v135
    v_cvt_pk_bf16_f32 v208, v136, v137
    v_cvt_pk_bf16_f32 v209, v138, v139
    v_cvt_pk_bf16_f32 v210, v140, v141
    v_cvt_pk_bf16_f32 v211, v142, v143
    v_permlane32_swap_b32 v196, v198
    v_permlane32_swap_b32 v197, v199
    v_permlane32_swap_b32 v200, v202
    v_permlane32_swap_b32 v201, v203
    v_permlane32_swap_b32 v204, v206
    v_permlane32_swap_b32 v205, v207
    v_permlane32_swap_b32 v208, v210
    v_permlane32_swap_b32 v209, v211
    buffer_store_dwordx4 v[196:199], v4, s[28:31], s45 offen offset:0
    buffer_store_dwordx4 v[200:203], v4, s[28:31], s45 offen offset:32
    buffer_store_dwordx4 v[204:207], v4, s[28:31], s45 offen offset:64
    buffer_store_dwordx4 v[208:211], v4, s[28:31], s45 offen offset:96
    s_cmp_eq_u32 s40, 63
    s_cbranch_scc1 mega_kernel_rD_ce
    v_cmp_eq_u32 vcc, 0, v3
    s_cbranch_vccnz mega_kernel_rD_ce
    s_add_u32 s40, s40, 1
    s_lshl_b32 s42, s40, 19
    s_add_u32 s42, s42, s64
    s_lshl_b32 s48, s40, 13
    s_add_u32 s43, s48, s65
    s_lshl_b32 s48, s40, 16
    s_add_u32 s49, s48, s68
    s_add_u32 s50, s48, s69
    s_mov_b32 s44, s50
    s_mov_b32 s45, s49
    s_branch mega_kernel_rD_go
mega_kernel_rD_ce:
    s_add_u32 s40, s40, 1
    s_cmp_lt_u32 s40, 64
    s_cbranch_scc1 mega_kernel_rD_top
    s_waitcnt vmcnt(0)
mega_kernel_rfin:
mega_kernel_exit:
mega_kernel_exit0:
    s_endpgm
.section .rodata,"a"
.p2align 6
.amdhsa_kernel mega_kernel
  .amdhsa_next_free_vgpr 512
  .amdhsa_next_free_sgpr 102
  .amdhsa_accum_offset 256
  .amdhsa_group_segment_fixed_size 0
  .amdhsa_kernarg_size 112
  .amdhsa_user_sgpr_count 2
  .amdhsa_user_sgpr_kernarg_segment_ptr 1
  .amdhsa_system_sgpr_workgroup_id_x 1
.end_amdhsa_kernel
```
